```python
import torch

def _softmax(x, axis=-1):
    return torch.softmax(x, dim=axis)
def _gelu(x):
    return torch.nn.functional.gelu(x, approximate="tanh")
def _silu(x):
    return torch.nn.functional.silu(x)
def _sigmoid(x):
    return torch.sigmoid(x)
def _layernorm(x, axis=-1, eps=1e-5):
    m = x.mean(dim=axis, keepdim=True)
    v = x.var(dim=axis, keepdim=True, unbiased=False)
    return (x - m) / torch.sqrt(v + eps)
def _scatter_add(tgt, idx, src, axis=0):
    return tgt.clone().index_add_(axis, idx, src)
def _segment_sum(src, seg, n):
    out = torch.zeros((n,) + src.shape[1:], dtype=src.dtype)
    return out.index_add_(0, seg, src)
def _pad(x, pw):
    flat = tuple(v for pair in reversed(pw) for v in pair)
    return torch.nn.functional.pad(x, flat)

kernel_name = 'standalone__modern_conv_block_convnext_v2__vision'

def setup_inputs():

    _w = (lambda a: (lambda t: t.to(torch.bfloat16) if t.is_floating_point() else t)(torch.as_tensor(a)))
    H = W = 512
    C = 96
    K = 1
    return {
        "x": _w((lambda *s: torch.randn(*s, dtype=torch.bfloat16) * 0.05)(1, H, W, C)),
        "dw": _w((lambda *s: torch.randn(*s, dtype=torch.bfloat16) * 0.05)(K, K, C)),
        "w1": _w((lambda *s: torch.randn(*s, dtype=torch.bfloat16) * 0.05)(C, 4 * C)),
        "w2": _w((lambda *s: torch.randn(*s, dtype=torch.bfloat16) * 0.05)(4 * C, C)),
        "grn_gamma": _w((lambda *s: torch.randn(*s, dtype=torch.bfloat16) * 0.05)(4 * C)),
        "grn_beta": _w((lambda *s: torch.randn(*s, dtype=torch.bfloat16) * 0.05)(4 * C)),
    }

def reference(x, dw, w1, w2, grn_gamma, grn_beta):
    B, H, W, C = x.shape
    K = dw.shape[0]
    pad = K // 2
    xp = _pad(x, ((0,0),(pad,pad),(pad,pad),(0,0)))
    out = torch.zeros_like(x)
    for i in range(K):
        for j in range(K):
            out = out + xp[:, i:i+H, j:j+W, :] * dw[i, j][None, None, None, :]
    h = _layernorm(out, axis=-1)
    h = torch.einsum('bhwc,ce->bhwe', h, w1)
    h = _gelu(h)
    gx = torch.sqrt((h * h).sum(axis=(1, 2), keepdims=True) + 1e-6)
    nx = gx / (gx.mean(axis=-1, keepdims=True) + 1e-6)
    h = grn_gamma * (h * nx) + grn_beta + h
    h = torch.einsum('bhwe,ec->bhwc', h, w2)
    return x + h
```

```asm
; @launch grid=(256,1,1) block=(256,1,1) lds=163840
.amdgcn_target "amdgcn-amd-amdhsa--gfx950"
.text
.globl standalone__modern_conv_block_convnext_v2__vision_kernel
.p2align 8
.type standalone__modern_conv_block_convnext_v2__vision_kernel,@function
standalone__modern_conv_block_convnext_v2__vision_kernel:
    s_cmp_lt_u32 s2, 256
    s_cbranch_scc1 L_go
    s_endpgm
L_go:
    s_load_dwordx16 s[4:19], s[0:1], 0
    s_load_dwordx2 s[20:21], s[0:1], 64
    s_getpc_b64 s[68:69]
L_pc:
    s_mov_b32 s70, L_end-L_pc
    s_mov_b32 s71, 0x20000
    v_lshrrev_b32 v120, 6, v0
    v_and_b32 v121, 31, v0
    v_lshl_add_u32 v122, v120, 5, v121
    v_lshlrev_b32_e64 v7, 6, v122
    v_and_b32 v122, 32, v0
    v_lshl_or_b32 v7, v122, 24, v7
    s_mov_b32 s63, 0
    buffer_load_dword v6, v7, s[68:71], s63 offen
    s_mov_b32 s63, 8192
    buffer_load_dword v6, v7, s[68:71], s63 offen
    v_readfirstlane_b32 s57, v120
    v_bfe_u32 v122, v0, 5, 1
    v_mul_u32_u24 v1, 192, v121
    v_lshl_add_u32 v1, v122, 4, v1
    v_bfe_u32 v123, v121, 3, 1
    v_and_b32 v124, 3, v0
    v_lshl_add_u32 v123, v123, 2, v124
    v_lshl_add_u32 v125, v122, 3, v123
    v_lshlrev_b32 v125, 1, v125
    v_and_b32 v3, 63, v0
    v_lshlrev_b32 v2, 4, v3
    s_mul_i32 s56, s2, 196608
    s_mul_i32 s59, s57, 6144
    s_add_u32 s56, s56, s59
    s_add_u32 s60, s59, 4096
    s_add_u32 s61, s56, 4096
    s_add_u32 m0, s59, 0
    v_add_u32 v126, s59, v1
    s_mul_i32 s22, s57, 18432
    s_add_u32 s23, s22, 73728
    s_waitcnt lgkmcnt(0)
    s_mov_b32 s24, s4
    s_mov_b32 s25, s5
    s_mov_b32 s26, 50331648
    s_mov_b32 s27, 0x20000
    buffer_load_dwordx4 v2, s[24:27], s56 offen offset:0  lds
    buffer_load_dwordx4 v2, s[24:27], s56 offen offset:1024  lds
    buffer_load_dwordx4 v2, s[24:27], s56 offen offset:2048  lds
    buffer_load_dwordx4 v2, s[24:27], s56 offen offset:3072  lds
    s_mov_b32 m0, s60
    s_nop 0
    buffer_load_dwordx4 v2, s[24:27], s61 offen offset:0  lds
    buffer_load_dwordx4 v2, s[24:27], s61 offen offset:1024  lds
    s_mov_b32 s40, s6
    s_mov_b32 s41, s7
    s_mov_b32 s42, 192
    s_mov_b32 s43, 0x20000
    buffer_load_ushort v144, v125, s[40:43], 0 offen offset:0
    buffer_load_ushort v145, v125, s[40:43], 0 offen offset:32
    buffer_load_ushort v146, v125, s[40:43], 0 offen offset:64
    buffer_load_ushort v147, v125, s[40:43], 0 offen offset:96
    buffer_load_ushort v148, v125, s[40:43], 0 offen offset:128
    buffer_load_ushort v149, v125, s[40:43], 0 offen offset:160
    s_mov_b32 s32, s8
    s_mov_b32 s33, s9
    s_mov_b32 s34, 73728
    s_mov_b32 s35, 0x20000
    v_add_u32 v120, 0, v3
    v_mul_u32_u24 v125, 1366, v120
    v_lshrrev_b32 v125, 16, v125
    v_mul_u32_u24 v4, 48, v125
    v_sub_u32 v120, v120, v4
    v_lshlrev_b32 v4, 2, v125
    v_xor_b32 v120, v120, v4
    v_mul_u32_u24 v125, 768, v125
    v_lshl_add_u32 v132, v120, 4, v125
    v_add_u32 v120, 64, v3
    v_mul_u32_u24 v125, 1366, v120
    v_lshrrev_b32 v125, 16, v125
    v_mul_u32_u24 v4, 48, v125
    v_sub_u32 v120, v120, v4
    v_lshlrev_b32 v4, 2, v125
    v_xor_b32 v120, v120, v4
    v_mul_u32_u24 v125, 768, v125
    v_lshl_add_u32 v133, v120, 4, v125
    v_add_u32 v120, 128, v3
    v_mul_u32_u24 v125, 1366, v120
    v_lshrrev_b32 v125, 16, v125
    v_mul_u32_u24 v4, 48, v125
    v_sub_u32 v120, v120, v4
    v_lshlrev_b32 v4, 2, v125
    v_xor_b32 v120, v120, v4
    v_mul_u32_u24 v125, 768, v125
    v_lshl_add_u32 v134, v120, 4, v125
    s_mov_b32 m0, s23
    s_add_u32 s23, s23, 1024
    buffer_load_dwordx4 v132, s[32:35], s22 offen  lds
    s_mov_b32 m0, s23
    s_add_u32 s23, s23, 1024
    buffer_load_dwordx4 v133, s[32:35], s22 offen  lds
    s_mov_b32 m0, s23
    s_add_u32 s23, s23, 1024
    buffer_load_dwordx4 v134, s[32:35], s22 offen  lds
    s_add_u32 s22, s22, 3072
    s_mov_b32 m0, s23
    s_add_u32 s23, s23, 1024
    buffer_load_dwordx4 v132, s[32:35], s22 offen  lds
    s_mov_b32 m0, s23
    s_add_u32 s23, s23, 1024
    buffer_load_dwordx4 v133, s[32:35], s22 offen  lds
    s_mov_b32 m0, s23
    s_add_u32 s23, s23, 1024
    buffer_load_dwordx4 v134, s[32:35], s22 offen  lds
    s_add_u32 s22, s22, 3072
    s_mov_b32 m0, s23
    s_add_u32 s23, s23, 1024
    buffer_load_dwordx4 v132, s[32:35], s22 offen  lds
    s_mov_b32 m0, s23
    s_add_u32 s23, s23, 1024
    buffer_load_dwordx4 v133, s[32:35], s22 offen  lds
    s_mov_b32 m0, s23
    s_add_u32 s23, s23, 1024
    buffer_load_dwordx4 v134, s[32:35], s22 offen  lds
    s_add_u32 s22, s22, 3072
    s_mov_b32 m0, s23
    s_add_u32 s23, s23, 1024
    buffer_load_dwordx4 v132, s[32:35], s22 offen  lds
    s_mov_b32 m0, s23
    s_add_u32 s23, s23, 1024
    buffer_load_dwordx4 v133, s[32:35], s22 offen  lds
    s_mov_b32 m0, s23
    s_add_u32 s23, s23, 1024
    buffer_load_dwordx4 v134, s[32:35], s22 offen  lds
    s_add_u32 s22, s22, 3072
    s_mov_b32 s36, s10
    s_mov_b32 s37, s11
    s_mov_b32 s38, 73728
    s_mov_b32 s39, 0x20000
    s_mov_b32 s28, s16
    s_mov_b32 s29, s17
    s_mov_b32 s30, 50331648
    s_mov_b32 s31, 0x20000
    s_mov_b32 s44, s20
    s_mov_b32 s45, s21
    s_mov_b32 s46, 268435456
    s_mov_b32 s47, 0x20000
    s_mov_b32 s48, s18
    s_mov_b32 s49, s19
    s_mov_b32 s50, 256
    s_mov_b32 s51, 0x20000
    v_add_u32 v3, 0x10000, v2
    v_add_u32 v4, 0x20000, v2
    v_lshlrev_b32 v5, 5, v122
    v_add_u32 v5, 161280, v5
    s_mov_b32 s52, 0x409d30fc
    s_mov_b32 s53, 0x409d30fc
    s_mov_b32 s66, 0x40000
    s_lshl_b32 s58, s2, 2
    s_add_u32 s58, s58, s57
    s_lshl_b32 s58, s58, 12
    s_mul_i32 s3, s58, 6
    s_add_u32 s3, s3, 67108864
    s_add_u32 s58, s58, 2097152
    v_bfe_u32 v131, v0, 2, 2
    v_lshl_add_u32 v120, v122, 3, v131
    v_mul_u32_u24 v120, 768, v120
    v_bfe_u32 v125, v0, 4, 1
    v_lshl_add_u32 v120, v125, 5, v120
    v_lshl_add_u32 v120, v124, 3, v120
    v_add_u32 v120, 73728, v120
    v_lshl_add_u32 v128, v131, 6, v120
    v_xor_b32 v125, 1, v131
    v_lshl_add_u32 v129, v125, 6, v120
    v_xor_b32 v125, 2, v131
    v_lshl_add_u32 v130, v125, 6, v120
    v_xor_b32 v125, 3, v131
    v_lshl_add_u32 v131, v125, 6, v120
    v_bfe_u32 v120, v121, 2, 1
    v_cmp_eq_u32 vcc, v120, v122
    v_and_b32 v120, 1, v123
    v_lshlrev_b32 v120, 4, v120
    v_mov_b32 v124, 0xffff
    v_lshlrev_b32 v120, v120, v124
    v_cndmask_b32 v120, 0, v120, vcc
    v_lshrrev_b32 v123, 1, v123
    v_lshrrev_b32 v121, 4, v121
    v_lshl_add_u32 v123, v121, 2, v123
    v_cmp_eq_u32 vcc, 0, v123
    v_mov_b32 v96, 0
    v_mov_b32 v97, 0
    v_cndmask_b32 v136, 0, v120, vcc
    v_mov_b32 v98, 0
    v_cmp_eq_u32 vcc, 1, v123
    v_mov_b32 v99, 0
    v_mov_b32 v100, 0
    v_cndmask_b32 v137, 0, v120, vcc
    v_mov_b32 v101, 0
    v_cmp_eq_u32 vcc, 2, v123
    v_mov_b32 v102, 0
    v_mov_b32 v103, 0
    v_cndmask_b32 v138, 0, v120, vcc
    v_mov_b32 v104, 0
    v_cmp_eq_u32 vcc, 3, v123
    v_mov_b32 v105, 0
    v_mov_b32 v106, 0
    v_cndmask_b32 v139, 0, v120, vcc
    v_mov_b32 v107, 0
    v_cmp_eq_u32 vcc, 4, v123
    v_mov_b32 v108, 0
    v_mov_b32 v109, 0
    v_cndmask_b32 v140, 0, v120, vcc
    v_mov_b32 v110, 0
    v_cmp_eq_u32 vcc, 5, v123
    v_mov_b32 v111, 0
    v_mov_b32 v112, 0
    v_cndmask_b32 v141, 0, v120, vcc
    v_mov_b32 v113, 0
    v_cmp_eq_u32 vcc, 6, v123
    v_mov_b32 v114, 0
    v_mov_b32 v115, 0
    v_cndmask_b32 v142, 0, v120, vcc
    v_mov_b32 v116, 0
    v_cmp_eq_u32 vcc, 7, v123
    v_mov_b32 v117, 0
    v_mov_b32 v118, 0
    v_cndmask_b32 v143, 0, v120, vcc
    v_mov_b32 v119, 0
    v_and_b32 v121, 0x3f803f80, v136
    v_accvgpr_write_b32 a24, v121
    v_and_b32 v122, 0x3f803f80, v137
    v_accvgpr_write_b32 a25, v122
    v_and_b32 v121, 0x3f803f80, v138
    v_accvgpr_write_b32 a26, v121
    v_and_b32 v122, 0x3f803f80, v139
    v_accvgpr_write_b32 a27, v122
    v_and_b32 v121, 0x3f803f80, v140
    v_accvgpr_write_b32 a28, v121
    v_and_b32 v122, 0x3f803f80, v141
    v_accvgpr_write_b32 a29, v122
    v_and_b32 v121, 0x3f803f80, v142
    v_accvgpr_write_b32 a30, v121
    v_and_b32 v122, 0x3f803f80, v143
    v_accvgpr_write_b32 a31, v122
    s_waitcnt vmcnt(17)
    v_lshl_or_b32 v144, v144, 16, v144
    s_waitcnt vmcnt(16)
    v_lshl_or_b32 v145, v145, 16, v145
    s_waitcnt vmcnt(15)
    v_lshl_or_b32 v146, v146, 16, v146
    s_waitcnt vmcnt(14)
    v_lshl_or_b32 v147, v147, 16, v147
    s_waitcnt vmcnt(13)
    v_lshl_or_b32 v148, v148, 16, v148
    s_waitcnt vmcnt(12)
    v_lshl_or_b32 v149, v149, 16, v149
    v_and_b32 v160, v136, v144
    v_and_b32 v161, v137, v144
    v_and_b32 v162, v138, v144
    v_and_b32 v163, v139, v144
    v_and_b32 v164, v140, v145
    v_and_b32 v165, v141, v145
    v_and_b32 v166, v142, v145
    v_and_b32 v167, v143, v145
    v_and_b32 v168, v136, v146
    v_and_b32 v169, v137, v146
    v_and_b32 v170, v138, v146
    v_and_b32 v171, v139, v146
    v_and_b32 v172, v140, v147
    v_and_b32 v173, v141, v147
    v_and_b32 v174, v142, v147
    v_and_b32 v175, v143, v147
    v_and_b32 v176, v136, v148
    v_and_b32 v177, v137, v148
    v_and_b32 v178, v138, v148
    v_and_b32 v179, v139, v148
    v_and_b32 v180, v140, v149
    v_and_b32 v181, v141, v149
    v_and_b32 v182, v142, v149
    v_and_b32 v183, v143, v149
    ds_write_b128 v4, v[160:163] offset:16384
    ds_write_b128 v4, v[164:167] offset:17408
    ds_write_b128 v4, v[168:171] offset:18432
    ds_write_b128 v4, v[172:175] offset:19456
    ds_write_b128 v4, v[176:179] offset:20480
    ds_write_b128 v4, v[180:183] offset:21504
    s_mov_b32 m0, s23
    s_add_u32 s23, s23, 1024
    buffer_load_dwordx4 v132, s[32:35], s22 offen  lds
    s_mov_b32 m0, s23
    s_add_u32 s23, s23, 1024
    buffer_load_dwordx4 v133, s[32:35], s22 offen  lds
    s_mov_b32 m0, s23
    s_add_u32 s23, s23, 1024
    buffer_load_dwordx4 v134, s[32:35], s22 offen  lds
    s_add_u32 s22, s22, 3072
    s_mov_b32 m0, s23
    s_add_u32 s23, s23, 1024
    buffer_load_dwordx4 v132, s[32:35], s22 offen  lds
    s_mov_b32 m0, s23
    s_add_u32 s23, s23, 1024
    buffer_load_dwordx4 v133, s[32:35], s22 offen  lds
    s_mov_b32 m0, s23
    s_add_u32 s23, s23, 1024
    buffer_load_dwordx4 v134, s[32:35], s22 offen  lds
    s_add_u32 s22, s22, 3072
    ds_read_b128 a[224:227], v126 offset:0
    ds_read_b128 a[228:231], v126 offset:32
    ds_read_b128 a[232:235], v126 offset:64
    ds_read_b128 a[236:239], v126 offset:96
    ds_read_b128 a[240:243], v126 offset:128
    ds_read_b128 a[244:247], v126 offset:160
    s_waitcnt lgkmcnt(0)
    s_waitcnt vmcnt(0)
    s_barrier
    ds_read_b64_tr_b16 a[32:33], v128 offset:0
    ds_read_b64_tr_b16 a[34:35], v128 offset:3072
    ds_read_b64_tr_b16 a[36:37], v128 offset:12288
    ds_read_b64_tr_b16 a[38:39], v128 offset:15360
    ds_read_b64_tr_b16 a[40:41], v128 offset:24576
    ds_read_b64_tr_b16 a[42:43], v128 offset:27648
    ds_read_b64_tr_b16 a[44:45], v128 offset:36864
    ds_read_b64_tr_b16 a[46:47], v128 offset:39936
    ds_read_b64_tr_b16 a[48:49], v128 offset:49152
    ds_read_b64_tr_b16 a[50:51], v128 offset:52224
    ds_read_b64_tr_b16 a[52:53], v128 offset:61440
    ds_read_b64_tr_b16 a[54:55], v128 offset:64512
    ds_read_b64_tr_b16 a[56:57], v129 offset:0
    ds_read_b64_tr_b16 a[58:59], v129 offset:3072
    ds_read_b64_tr_b16 a[60:61], v129 offset:12288
    ds_read_b64_tr_b16 a[62:63], v129 offset:15360
    ds_read_b64_tr_b16 a[64:65], v129 offset:24576
    ds_read_b64_tr_b16 a[66:67], v129 offset:27648
    ds_read_b64_tr_b16 a[68:69], v129 offset:36864
    ds_read_b64_tr_b16 a[70:71], v129 offset:39936
    ds_read_b64_tr_b16 a[72:73], v129 offset:49152
    ds_read_b64_tr_b16 a[74:75], v129 offset:52224
    ds_read_b64_tr_b16 a[76:77], v129 offset:61440
    ds_read_b64_tr_b16 a[78:79], v129 offset:64512
    v_mfma_f32_32x32x16_bf16 v[16:31], v[160:163], a[224:227], 0
    v_mfma_f32_32x32x16_bf16 v[16:31], v[164:167], a[228:231], v[16:31]
    v_mfma_f32_32x32x16_bf16 v[32:47], v[168:171], a[232:235], 0
    v_mfma_f32_32x32x16_bf16 v[32:47], v[172:175], a[236:239], v[32:47]
    v_mfma_f32_32x32x16_bf16 v[48:63], v[176:179], a[240:243], 0
    v_mfma_f32_32x32x16_bf16 v[48:63], v[180:183], a[244:247], v[48:63]
    s_add_u32 s54, s56, 24576
    buffer_load_dwordx4 a[224:227], v1, s[24:27], s54 offen offset:0
    buffer_load_dwordx4 a[228:231], v1, s[24:27], s54 offen offset:32
    buffer_load_dwordx4 a[232:235], v1, s[24:27], s54 offen offset:64
    buffer_load_dwordx4 a[236:239], v1, s[24:27], s54 offen offset:96
    buffer_load_dwordx4 a[240:243], v1, s[24:27], s54 offen offset:128
    buffer_load_dwordx4 a[244:247], v1, s[24:27], s54 offen offset:160
    v_pk_mul_f32 v[10:11], v[16:17], v[16:17]
    v_pk_add_f32 v[8:9], v[16:17], v[18:19]
    v_pk_fma_f32 v[10:11], v[18:19], v[18:19], v[10:11]
    v_pk_add_f32 v[8:9], v[8:9], v[20:21]
    v_pk_fma_f32 v[10:11], v[20:21], v[20:21], v[10:11]
    v_pk_add_f32 v[8:9], v[8:9], v[22:23]
    v_pk_fma_f32 v[10:11], v[22:23], v[22:23], v[10:11]
    v_pk_add_f32 v[8:9], v[8:9], v[24:25]
    v_pk_fma_f32 v[10:11], v[24:25], v[24:25], v[10:11]
    v_pk_add_f32 v[8:9], v[8:9], v[26:27]
    v_pk_fma_f32 v[10:11], v[26:27], v[26:27], v[10:11]
    v_pk_add_f32 v[8:9], v[8:9], v[28:29]
    v_pk_fma_f32 v[10:11], v[28:29], v[28:29], v[10:11]
    v_pk_add_f32 v[8:9], v[8:9], v[30:31]
    v_pk_fma_f32 v[10:11], v[30:31], v[30:31], v[10:11]
    v_pk_add_f32 v[8:9], v[8:9], v[32:33]
    v_pk_fma_f32 v[10:11], v[32:33], v[32:33], v[10:11]
    v_pk_add_f32 v[8:9], v[8:9], v[34:35]
    v_pk_fma_f32 v[10:11], v[34:35], v[34:35], v[10:11]
    v_pk_add_f32 v[8:9], v[8:9], v[36:37]
    v_pk_fma_f32 v[10:11], v[36:37], v[36:37], v[10:11]
    v_pk_add_f32 v[8:9], v[8:9], v[38:39]
    v_pk_fma_f32 v[10:11], v[38:39], v[38:39], v[10:11]
    v_pk_add_f32 v[8:9], v[8:9], v[40:41]
    v_pk_fma_f32 v[10:11], v[40:41], v[40:41], v[10:11]
    v_pk_add_f32 v[8:9], v[8:9], v[42:43]
    v_pk_fma_f32 v[10:11], v[42:43], v[42:43], v[10:11]
    v_pk_add_f32 v[8:9], v[8:9], v[44:45]
    v_pk_fma_f32 v[10:11], v[44:45], v[44:45], v[10:11]
    v_pk_add_f32 v[8:9], v[8:9], v[46:47]
    v_pk_fma_f32 v[10:11], v[46:47], v[46:47], v[10:11]
    v_pk_add_f32 v[8:9], v[8:9], v[48:49]
    v_pk_fma_f32 v[10:11], v[48:49], v[48:49], v[10:11]
    v_pk_add_f32 v[8:9], v[8:9], v[50:51]
    v_pk_fma_f32 v[10:11], v[50:51], v[50:51], v[10:11]
    v_pk_add_f32 v[8:9], v[8:9], v[52:53]
    v_pk_fma_f32 v[10:11], v[52:53], v[52:53], v[10:11]
    v_pk_add_f32 v[8:9], v[8:9], v[54:55]
    v_pk_fma_f32 v[10:11], v[54:55], v[54:55], v[10:11]
    v_pk_add_f32 v[8:9], v[8:9], v[56:57]
    v_pk_fma_f32 v[10:11], v[56:57], v[56:57], v[10:11]
    v_pk_add_f32 v[8:9], v[8:9], v[58:59]
    v_pk_fma_f32 v[10:11], v[58:59], v[58:59], v[10:11]
    v_pk_add_f32 v[8:9], v[8:9], v[60:61]
    v_pk_fma_f32 v[10:11], v[60:61], v[60:61], v[10:11]
    v_pk_add_f32 v[8:9], v[8:9], v[62:63]
    v_pk_fma_f32 v[10:11], v[62:63], v[62:63], v[10:11]
    v_add_f32 v8, v8, v9
    v_add_f32 v10, v10, v11
    s_nop 1
    v_permlane32_swap_b32 v8, v10
    v_add_f32 v8, v8, v10
    v_mov_b32_e64 v10, v8
    s_nop 1
    v_permlane32_swap_b32 v8, v10
    v_mul_f32 v8, 0x3c2aaaab, v8
    v_mul_f32 v10, 0x3c2aaaab, v10
    v_fma_f32 v10, -v8, v8, v10
    v_max_f32 v10, 0, v10
    v_add_f32 v10, 0x3727c5ac, v10
    v_rsq_f32_e64 v10, v10
    s_nop 0
    v_mul_f32 v12, 0x3eeff558, v10
    v_mul_f32_e64 v13, -v8, v12
    v_pk_fma_f32 v[16:17], v[16:17], v[12:13], v[12:13] op_sel:[0,0,1] op_sel_hi:[1,0,1]
    v_pk_fma_f32 v[18:19], v[18:19], v[12:13], v[12:13] op_sel:[0,0,1] op_sel_hi:[1,0,1]
    v_pk_fma_f32 v[20:21], v[20:21], v[12:13], v[12:13] op_sel:[0,0,1] op_sel_hi:[1,0,1]
    v_pk_fma_f32 v[22:23], v[22:23], v[12:13], v[12:13] op_sel:[0,0,1] op_sel_hi:[1,0,1]
    v_pk_fma_f32 v[24:25], v[24:25], v[12:13], v[12:13] op_sel:[0,0,1] op_sel_hi:[1,0,1]
    v_pk_fma_f32 v[26:27], v[26:27], v[12:13], v[12:13] op_sel:[0,0,1] op_sel_hi:[1,0,1]
    v_pk_fma_f32 v[28:29], v[28:29], v[12:13], v[12:13] op_sel:[0,0,1] op_sel_hi:[1,0,1]
    v_pk_fma_f32 v[30:31], v[30:31], v[12:13], v[12:13] op_sel:[0,0,1] op_sel_hi:[1,0,1]
    v_cvt_pk_bf16_f32 v72, v16, v17
    v_cvt_pk_bf16_f32 v73, v18, v19
    v_cvt_pk_bf16_f32 v74, v20, v21
    v_cvt_pk_bf16_f32 v75, v22, v23
    v_cvt_pk_bf16_f32 v76, v24, v25
    v_cvt_pk_bf16_f32 v77, v26, v27
    v_cvt_pk_bf16_f32 v78, v28, v29
    v_cvt_pk_bf16_f32 v79, v30, v31
    v_pk_fma_f32 v[32:33], v[32:33], v[12:13], v[12:13] op_sel:[0,0,1] op_sel_hi:[1,0,1]
    v_pk_fma_f32 v[34:35], v[34:35], v[12:13], v[12:13] op_sel:[0,0,1] op_sel_hi:[1,0,1]
    v_pk_fma_f32 v[36:37], v[36:37], v[12:13], v[12:13] op_sel:[0,0,1] op_sel_hi:[1,0,1]
    v_pk_fma_f32 v[38:39], v[38:39], v[12:13], v[12:13] op_sel:[0,0,1] op_sel_hi:[1,0,1]
    v_pk_fma_f32 v[40:41], v[40:41], v[12:13], v[12:13] op_sel:[0,0,1] op_sel_hi:[1,0,1]
    v_pk_fma_f32 v[42:43], v[42:43], v[12:13], v[12:13] op_sel:[0,0,1] op_sel_hi:[1,0,1]
    v_pk_fma_f32 v[44:45], v[44:45], v[12:13], v[12:13] op_sel:[0,0,1] op_sel_hi:[1,0,1]
    v_pk_fma_f32 v[46:47], v[46:47], v[12:13], v[12:13] op_sel:[0,0,1] op_sel_hi:[1,0,1]
    v_cvt_pk_bf16_f32 v80, v32, v33
    v_cvt_pk_bf16_f32 v81, v34, v35
    v_cvt_pk_bf16_f32 v82, v36, v37
    v_cvt_pk_bf16_f32 v83, v38, v39
    v_cvt_pk_bf16_f32 v84, v40, v41
    v_cvt_pk_bf16_f32 v85, v42, v43
    v_cvt_pk_bf16_f32 v86, v44, v45
    v_cvt_pk_bf16_f32 v87, v46, v47
    v_pk_fma_f32 v[48:49], v[48:49], v[12:13], v[12:13] op_sel:[0,0,1] op_sel_hi:[1,0,1]
    v_pk_fma_f32 v[50:51], v[50:51], v[12:13], v[12:13] op_sel:[0,0,1] op_sel_hi:[1,0,1]
    v_pk_fma_f32 v[52:53], v[52:53], v[12:13], v[12:13] op_sel:[0,0,1] op_sel_hi:[1,0,1]
    v_pk_fma_f32 v[54:55], v[54:55], v[12:13], v[12:13] op_sel:[0,0,1] op_sel_hi:[1,0,1]
    v_pk_fma_f32 v[56:57], v[56:57], v[12:13], v[12:13] op_sel:[0,0,1] op_sel_hi:[1,0,1]
    v_pk_fma_f32 v[58:59], v[58:59], v[12:13], v[12:13] op_sel:[0,0,1] op_sel_hi:[1,0,1]
    v_pk_fma_f32 v[60:61], v[60:61], v[12:13], v[12:13] op_sel:[0,0,1] op_sel_hi:[1,0,1]
    v_pk_fma_f32 v[62:63], v[62:63], v[12:13], v[12:13] op_sel:[0,0,1] op_sel_hi:[1,0,1]
    v_cvt_pk_bf16_f32 v88, v48, v49
    v_cvt_pk_bf16_f32 v89, v50, v51
    v_cvt_pk_bf16_f32 v90, v52, v53
    v_cvt_pk_bf16_f32 v91, v54, v55
    v_cvt_pk_bf16_f32 v92, v56, v57
    v_cvt_pk_bf16_f32 v93, v58, v59
    v_cvt_pk_bf16_f32 v94, v60, v61
    v_cvt_pk_bf16_f32 v95, v62, v63
    buffer_store_dwordx4 v[12:15], v2, s[44:47], s58 offen offset:0 sc1
    s_lshr_b32 s22, s2, 3
    s_xor_b32 s22, s22, s2
    s_and_b32 s22, s22, 7
    s_lshl_b32 s22, s22, 2
    s_add_u32 s22, s22, s57
    s_mul_i32 s22, s22, 2304
    v_lshlrev_b32 v127, 2, v2
    v_cmp_gt_u32 vcc, 576, v2
    s_nop 1
    v_cndmask_b32 v127, -1, v127, vcc
    v_and_b32 v127, 0x7fffffff, v127
    s_mov_b32 s40, s14
    s_mov_b32 s41, s15
    s_mov_b32 s42, 768
    s_mov_b32 s43, 0x20000
    v_lshlrev_b32 v120, 4, v0
    buffer_load_dwordx4 v[132:135], v120, s[40:43], 0 offen
    v_mov_b32 v136, -1
    v_mov_b32 v137, -1
    v_mov_b32 v138, -1
    v_mov_b32 v139, -1
    s_lshl_b32 s59, s2, 6
    v_lshrrev_b32 v122, 2, v0
    v_and_b32 v123, 3, v0
    v_lshlrev_b32 v123, 4, v123
    v_lshl_or_b32 v121, v122, 14, v123
    v_lshl_or_b32 v122, v122, 12, v123
    s_lshl_b32 s60, s2, 6
    s_add_u32 s60, s60, 1048576
    s_cmp_lt_u32 s2, 48
    s_cselect_b32 s61, 32, 0
    v_cmp_gt_u32 vcc, 96, v0
    s_nop 4
    s_and_saveexec_b64 s[64:65], vcc
    s_cbranch_execz L_clr0
    buffer_store_dwordx4 v[136:139], v121, s[44:47], s59 offen sc1
L_clr0:
    s_mov_b64 exec, s[64:65]
    v_cmp_gt_u32 vcc, s61, v0
    s_nop 4
    s_and_saveexec_b64 s[64:65], vcc
    s_cbranch_execz L_clr1
    buffer_store_dwordx4 v[136:139], v122, s[44:47], s60 offen sc1
L_clr1:
    s_mov_b64 exec, s[64:65]
    s_mul_i32 s59, s57, 18432
    v_add_u32 v123, s59, v2
    s_mul_i32 s59, s57, 3
    v_bfe_u32 v124, v0, 2, 2
    v_lshlrev_b32_e64 v125, 6, v124
    v_sub_u32 v125, v128, v125
    s_add_u32 s60, s59, 0
    v_xor_b32 v120, s60, v124
    v_lshl_add_u32 v120, v120, 6, v125
    s_add_u32 s60, s59, 1
    v_xor_b32 v121, s60, v124
    v_lshl_add_u32 v121, v121, 6, v125
    s_add_u32 s60, s59, 2
    v_xor_b32 v122, s60, v124
    v_lshl_add_u32 v122, v122, 6, v125
    ds_read_b128 a[0:3], v4 offset:16384
    ds_read_b128 a[4:7], v4 offset:17408
    ds_read_b128 a[8:11], v4 offset:18432
    ds_read_b128 a[12:15], v4 offset:19456
    ds_read_b128 a[16:19], v4 offset:20480
    s_waitcnt lgkmcnt(15)
    v_mfma_f32_32x32x16_bf16 v[16:31], v[72:75], a[32:35], 0
    v_mfma_f32_32x32x16_bf16 v[16:31], v[76:79], a[36:39], v[16:31]
    v_mfma_f32_32x32x16_bf16 v[16:31], v[80:83], a[40:43], v[16:31]
    v_mfma_f32_32x32x16_bf16 v[16:31], v[84:87], a[44:47], v[16:31]
    v_mfma_f32_32x32x16_bf16 v[16:31], v[88:91], a[48:51], v[16:31]
    v_mfma_f32_32x32x16_bf16 v[16:31], v[92:95], a[52:55], v[16:31]
    s_nop 11
    v_pk_fma_f32 v[48:49], v[16:17], v[16:17], s[52:53]
    v_pk_fma_f32 v[50:51], v[18:19], v[18:19], s[52:53]
    v_pk_fma_f32 v[52:53], v[20:21], v[20:21], s[52:53]
    v_pk_fma_f32 v[54:55], v[22:23], v[22:23], s[52:53]
    v_pk_fma_f32 v[56:57], v[24:25], v[24:25], s[52:53]
    v_pk_fma_f32 v[58:59], v[26:27], v[26:27], s[52:53]
    v_pk_fma_f32 v[60:61], v[28:29], v[28:29], s[52:53]
    v_pk_fma_f32 v[62:63], v[30:31], v[30:31], s[52:53]
    v_pk_mul_f32 v[48:49], v[48:49], v[16:17] neg_lo:[1,0] neg_hi:[1,0]
    v_pk_mul_f32 v[50:51], v[50:51], v[18:19] neg_lo:[1,0] neg_hi:[1,0]
    v_pk_mul_f32 v[52:53], v[52:53], v[20:21] neg_lo:[1,0] neg_hi:[1,0]
    v_pk_mul_f32 v[54:55], v[54:55], v[22:23] neg_lo:[1,0] neg_hi:[1,0]
    v_pk_mul_f32 v[56:57], v[56:57], v[24:25] neg_lo:[1,0] neg_hi:[1,0]
    v_pk_mul_f32 v[58:59], v[58:59], v[26:27] neg_lo:[1,0] neg_hi:[1,0]
    v_pk_mul_f32 v[60:61], v[60:61], v[28:29] neg_lo:[1,0] neg_hi:[1,0]
    v_pk_mul_f32 v[62:63], v[62:63], v[30:31] neg_lo:[1,0] neg_hi:[1,0]
    s_waitcnt lgkmcnt(5)
    v_mfma_f32_32x32x16_bf16 v[32:47], v[72:75], a[56:59], 0
    ds_read_b64_tr_b16 a[80:81], v130 offset:0
    ds_read_b64_tr_b16 a[82:83], v130 offset:3072
    v_exp_f32 v48, v48
    v_exp_f32 v49, v49
    v_mfma_f32_32x32x16_bf16 v[32:47], v[76:79], a[60:63], v[32:47]
    ds_read_b64_tr_b16 a[84:85], v130 offset:12288
    ds_read_b64_tr_b16 a[86:87], v130 offset:15360
    v_exp_f32 v50, v50
    v_exp_f32 v51, v51
    v_exp_f32 v52, v52
    v_exp_f32 v53, v53
    v_exp_f32 v54, v54
    v_exp_f32 v55, v55
    v_exp_f32 v56, v56
    v_exp_f32 v57, v57
    v_exp_f32 v58, v58
    v_exp_f32 v59, v59
    v_exp_f32 v60, v60
    v_exp_f32 v61, v61
    v_exp_f32 v62, v62
    v_exp_f32_e64 v63, v63
    v_pk_add_f32 v[48:49], v[48:49], 1.0 op_sel_hi:[1,0]
    v_pk_add_f32 v[50:51], v[50:51], 1.0 op_sel_hi:[1,0]
    v_pk_add_f32 v[52:53], v[52:53], 1.0 op_sel_hi:[1,0]
    v_pk_add_f32 v[54:55], v[54:55], 1.0 op_sel_hi:[1,0]
    v_pk_add_f32 v[56:57], v[56:57], 1.0 op_sel_hi:[1,0]
    v_pk_add_f32 v[58:59], v[58:59], 1.0 op_sel_hi:[1,0]
    v_pk_add_f32 v[60:61], v[60:61], 1.0 op_sel_hi:[1,0]
    v_pk_add_f32 v[62:63], v[62:63], 1.0 op_sel_hi:[1,0]
    v_mfma_f32_32x32x16_bf16 v[32:47], v[80:83], a[64:67], v[32:47]
    ds_read_b64_tr_b16 a[88:89], v130 offset:24576
    ds_read_b64_tr_b16 a[90:91], v130 offset:27648
    v_rcp_f32 v48, v48
    v_rcp_f32 v49, v49
    v_mfma_f32_32x32x16_bf16 v[32:47], v[84:87], a[68:71], v[32:47]
    ds_read_b64_tr_b16 a[92:93], v130 offset:36864
    ds_read_b64_tr_b16 a[94:95], v130 offset:39936
    v_rcp_f32 v50, v50
    v_rcp_f32 v51, v51
    v_mfma_f32_32x32x16_bf16 v[32:47], v[88:91], a[72:75], v[32:47]
    ds_read_b64_tr_b16 a[96:97], v130 offset:49152
    ds_read_b64_tr_b16 a[98:99], v130 offset:52224
    v_rcp_f32 v52, v52
    v_rcp_f32 v53, v53
    v_mfma_f32_32x32x16_bf16 v[32:47], v[92:95], a[76:79], v[32:47]
    ds_read_b64_tr_b16 a[100:101], v130 offset:61440
    ds_read_b64_tr_b16 a[102:103], v130 offset:64512
    v_rcp_f32 v54, v54
    v_rcp_f32 v55, v55
    v_rcp_f32 v56, v56
    v_rcp_f32 v57, v57
    v_rcp_f32 v58, v58
    v_rcp_f32 v59, v59
    v_rcp_f32 v60, v60
    v_rcp_f32 v61, v61
    v_rcp_f32 v62, v62
    v_rcp_f32 v63, v63
    v_pk_mul_f32 v[48:49], v[16:17], v[48:49]
    v_pk_mul_f32 v[50:51], v[18:19], v[50:51]
    v_pk_mul_f32 v[52:53], v[20:21], v[52:53]
    v_pk_mul_f32 v[54:55], v[22:23], v[54:55]
    v_pk_mul_f32 v[56:57], v[24:25], v[56:57]
    v_pk_mul_f32 v[58:59], v[26:27], v[58:59]
    v_pk_mul_f32 v[60:61], v[28:29], v[60:61]
    v_pk_mul_f32 v[62:63], v[30:31], v[62:63]
    v_pk_fma_f32 v[96:97], v[48:49], v[48:49], v[96:97]
    v_pk_fma_f32 v[96:97], v[50:51], v[50:51], v[96:97]
    v_pk_fma_f32 v[96:97], v[52:53], v[52:53], v[96:97]
    v_pk_fma_f32 v[96:97], v[54:55], v[54:55], v[96:97]
    v_pk_fma_f32 v[96:97], v[56:57], v[56:57], v[96:97]
    v_pk_fma_f32 v[96:97], v[58:59], v[58:59], v[96:97]
    v_pk_fma_f32 v[96:97], v[60:61], v[60:61], v[96:97]
    v_pk_fma_f32 v[96:97], v[62:63], v[62:63], v[96:97]
    v_pk_fma_f32 v[48:49], v[32:33], v[32:33], s[52:53]
    v_pk_fma_f32 v[50:51], v[34:35], v[34:35], s[52:53]
    v_pk_fma_f32 v[52:53], v[36:37], v[36:37], s[52:53]
    v_pk_fma_f32 v[54:55], v[38:39], v[38:39], s[52:53]
    v_pk_fma_f32 v[56:57], v[40:41], v[40:41], s[52:53]
    v_pk_fma_f32 v[58:59], v[42:43], v[42:43], s[52:53]
    v_pk_fma_f32 v[60:61], v[44:45], v[44:45], s[52:53]
    v_pk_fma_f32 v[62:63], v[46:47], v[46:47], s[52:53]
    v_pk_mul_f32 v[48:49], v[48:49], v[32:33] neg_lo:[1,0] neg_hi:[1,0]
    v_pk_mul_f32 v[50:51], v[50:51], v[34:35] neg_lo:[1,0] neg_hi:[1,0]
    v_pk_mul_f32 v[52:53], v[52:53], v[36:37] neg_lo:[1,0] neg_hi:[1,0]
    v_pk_mul_f32 v[54:55], v[54:55], v[38:39] neg_lo:[1,0] neg_hi:[1,0]
    v_pk_mul_f32 v[56:57], v[56:57], v[40:41] neg_lo:[1,0] neg_hi:[1,0]
    v_pk_mul_f32 v[58:59], v[58:59], v[42:43] neg_lo:[1,0] neg_hi:[1,0]
    v_pk_mul_f32 v[60:61], v[60:61], v[44:45] neg_lo:[1,0] neg_hi:[1,0]
    v_pk_mul_f32 v[62:63], v[62:63], v[46:47] neg_lo:[1,0] neg_hi:[1,0]
L_pf1:
    s_waitcnt lgkmcnt(0)
    v_mfma_f32_32x32x16_bf16 v[16:31], v[72:75], a[80:83], 0
    ds_read_b64_tr_b16 v[136:137], v120 offset:0
    ds_read_b64_tr_b16 v[138:139], v120 offset:3072
    ds_read_b64_tr_b16 a[104:105], v131 offset:0
    ds_read_b64_tr_b16 a[106:107], v131 offset:3072
    v_exp_f32 v48, v48
    v_mfma_f32_32x32x16_bf16 v[16:31], v[76:79], a[84:87], v[16:31]
    ds_read_b64_tr_b16 a[108:109], v131 offset:12288
    ds_read_b64_tr_b16 a[110:111], v131 offset:15360
    s_mov_b32 s63, L_pf1-L_pc+12288
    buffer_load_dword v6, v7, s[68:71], s63 offen
    v_exp_f32 v49, v49
    v_exp_f32 v50, v50
    v_exp_f32 v51, v51
    v_exp_f32 v52, v52
    v_exp_f32 v53, v53
    v_exp_f32 v54, v54
    v_exp_f32 v55, v55
    v_exp_f32 v56, v56
    v_exp_f32 v57, v57
    v_exp_f32 v58, v58
    v_exp_f32 v59, v59
    v_exp_f32 v60, v60
    v_exp_f32 v61, v61
    v_exp_f32 v62, v62
    v_exp_f32_e64 v63, v63
    v_pk_add_f32 v[48:49], v[48:49], 1.0 op_sel_hi:[1,0]
    v_pk_add_f32 v[50:51], v[50:51], 1.0 op_sel_hi:[1,0]
    v_pk_add_f32 v[52:53], v[52:53], 1.0 op_sel_hi:[1,0]
    v_pk_add_f32 v[54:55], v[54:55], 1.0 op_sel_hi:[1,0]
    v_pk_add_f32 v[56:57], v[56:57], 1.0 op_sel_hi:[1,0]
    v_pk_add_f32 v[58:59], v[58:59], 1.0 op_sel_hi:[1,0]
    v_pk_add_f32 v[60:61], v[60:61], 1.0 op_sel_hi:[1,0]
    v_pk_add_f32 v[62:63], v[62:63], 1.0 op_sel_hi:[1,0]
    v_mfma_f32_32x32x16_bf16 v[16:31], v[80:83], a[88:91], v[16:31]
    ds_read_b64_tr_b16 v[140:141], v120 offset:12288
    ds_read_b64_tr_b16 v[142:143], v120 offset:15360
    ds_read_b64_tr_b16 a[112:113], v131 offset:24576
    ds_read_b64_tr_b16 a[114:115], v131 offset:27648
    v_rcp_f32 v48, v48
    v_mfma_f32_32x32x16_bf16 v[16:31], v[84:87], a[92:95], v[16:31]
    ds_read_b64_tr_b16 a[116:117], v131 offset:36864
    ds_read_b64_tr_b16 a[118:119], v131 offset:39936
    ds_read_b64_tr_b16 a[120:121], v131 offset:49152
    ds_read_b64_tr_b16 a[122:123], v131 offset:52224
    v_rcp_f32 v49, v49
    v_mfma_f32_32x32x16_bf16 v[16:31], v[88:91], a[96:99], v[16:31]
    ds_read_b64_tr_b16 a[124:125], v131 offset:61440
    ds_read_b64_tr_b16 a[126:127], v131 offset:64512
    v_rcp_f32 v50, v50
    v_rcp_f32 v51, v51
    v_mfma_f32_32x32x16_bf16 v[16:31], v[92:95], a[100:103], v[16:31]
    s_waitcnt lgkmcnt(14)
    ds_write_b128 v123, v[136:139] offset:0
    v_rcp_f32 v52, v52
    v_rcp_f32 v53, v53
    v_rcp_f32 v54, v54
    v_rcp_f32 v55, v55
    v_rcp_f32 v56, v56
    v_rcp_f32 v57, v57
    v_rcp_f32 v58, v58
    v_rcp_f32 v59, v59
    v_rcp_f32 v60, v60
    v_rcp_f32 v61, v61
    v_rcp_f32 v62, v62
    v_rcp_f32_e64 v63, v63
    v_pk_mul_f32 v[48:49], v[32:33], v[48:49]
    v_pk_mul_f32 v[50:51], v[34:35], v[50:51]
    v_pk_mul_f32 v[52:53], v[36:37], v[52:53]
    v_pk_mul_f32 v[54:55], v[38:39], v[54:55]
    v_pk_mul_f32 v[56:57], v[40:41], v[56:57]
    v_pk_mul_f32 v[58:59], v[42:43], v[58:59]
    v_pk_mul_f32 v[60:61], v[44:45], v[60:61]
    v_pk_mul_f32 v[62:63], v[46:47], v[62:63]
    v_pk_fma_f32 v[98:99], v[48:49], v[48:49], v[98:99]
    v_pk_fma_f32 v[98:99], v[50:51], v[50:51], v[98:99]
    v_pk_fma_f32 v[98:99], v[52:53], v[52:53], v[98:99]
    v_pk_fma_f32 v[98:99], v[54:55], v[54:55], v[98:99]
    v_pk_fma_f32 v[98:99], v[56:57], v[56:57], v[98:99]
    v_pk_fma_f32 v[98:99], v[58:59], v[58:59], v[98:99]
    v_pk_fma_f32 v[98:99], v[60:61], v[60:61], v[98:99]
    v_pk_fma_f32 v[98:99], v[62:63], v[62:63], v[98:99]
    v_pk_fma_f32 v[48:49], v[16:17], v[16:17], s[52:53]
    v_pk_fma_f32 v[50:51], v[18:19], v[18:19], s[52:53]
    v_pk_fma_f32 v[52:53], v[20:21], v[20:21], s[52:53]
    v_pk_fma_f32 v[54:55], v[22:23], v[22:23], s[52:53]
    v_pk_fma_f32 v[56:57], v[24:25], v[24:25], s[52:53]
    v_pk_fma_f32 v[58:59], v[26:27], v[26:27], s[52:53]
    v_pk_fma_f32 v[60:61], v[28:29], v[28:29], s[52:53]
    v_pk_fma_f32 v[62:63], v[30:31], v[30:31], s[52:53]
    v_pk_mul_f32 v[48:49], v[48:49], v[16:17] neg_lo:[1,0] neg_hi:[1,0]
    v_pk_mul_f32 v[50:51], v[50:51], v[18:19] neg_lo:[1,0] neg_hi:[1,0]
    v_pk_mul_f32 v[52:53], v[52:53], v[20:21] neg_lo:[1,0] neg_hi:[1,0]
    v_pk_mul_f32 v[54:55], v[54:55], v[22:23] neg_lo:[1,0] neg_hi:[1,0]
    v_pk_mul_f32 v[56:57], v[56:57], v[24:25] neg_lo:[1,0] neg_hi:[1,0]
    v_pk_mul_f32 v[58:59], v[58:59], v[26:27] neg_lo:[1,0] neg_hi:[1,0]
    v_pk_mul_f32 v[60:61], v[60:61], v[28:29] neg_lo:[1,0] neg_hi:[1,0]
    v_pk_mul_f32 v[62:63], v[62:63], v[30:31] neg_lo:[1,0] neg_hi:[1,0]
    s_waitcnt lgkmcnt(1)
    v_mfma_f32_32x32x16_bf16 v[32:47], v[72:75], a[104:107], 0
    ds_read_b64_tr_b16 v[136:137], v120 offset:24576
    ds_read_b64_tr_b16 v[138:139], v120 offset:27648
    ds_read_b64_tr_b16 a[128:129], v128 offset:256
    ds_read_b64_tr_b16 a[130:131], v128 offset:3328
    ds_read_b64_tr_b16 a[132:133], v128 offset:12544
    ds_read_b64_tr_b16 a[134:135], v128 offset:15616
    v_mfma_f32_32x32x16_bf16 v[32:47], v[76:79], a[108:111], v[32:47]
    ds_write_b128 v123, v[140:143] offset:1024
    v_exp_f32 v48, v48
    v_exp_f32 v49, v49
    v_exp_f32 v50, v50
    v_exp_f32 v51, v51
    v_exp_f32 v52, v52
    v_exp_f32 v53, v53
    v_exp_f32 v54, v54
    v_exp_f32 v55, v55
    v_exp_f32 v56, v56
    v_exp_f32 v57, v57
    v_exp_f32 v58, v58
    v_exp_f32 v59, v59
    v_exp_f32 v60, v60
    v_exp_f32 v61, v61
    v_exp_f32 v62, v62
    v_exp_f32_e64 v63, v63
    v_pk_add_f32 v[48:49], v[48:49], 1.0 op_sel_hi:[1,0]
    v_pk_add_f32 v[50:51], v[50:51], 1.0 op_sel_hi:[1,0]
    v_pk_add_f32 v[52:53], v[52:53], 1.0 op_sel_hi:[1,0]
    v_pk_add_f32 v[54:55], v[54:55], 1.0 op_sel_hi:[1,0]
    v_pk_add_f32 v[56:57], v[56:57], 1.0 op_sel_hi:[1,0]
    v_pk_add_f32 v[58:59], v[58:59], 1.0 op_sel_hi:[1,0]
    v_pk_add_f32 v[60:61], v[60:61], 1.0 op_sel_hi:[1,0]
    v_pk_add_f32 v[62:63], v[62:63], 1.0 op_sel_hi:[1,0]
    v_mfma_f32_32x32x16_bf16 v[32:47], v[80:83], a[112:115], v[32:47]
    ds_read_b64_tr_b16 v[140:141], v120 offset:36864
    ds_read_b64_tr_b16 v[142:143], v120 offset:39936
    ds_read_b64_tr_b16 a[136:137], v128 offset:24832
    ds_read_b64_tr_b16 a[138:139], v128 offset:27904
    v_rcp_f32 v48, v48
    v_mfma_f32_32x32x16_bf16 v[32:47], v[84:87], a[116:119], v[32:47]
    ds_read_b64_tr_b16 a[140:141], v128 offset:37120
    ds_read_b64_tr_b16 a[142:143], v128 offset:40192
    ds_read_b64_tr_b16 a[144:145], v128 offset:49408
    ds_read_b64_tr_b16 a[146:147], v128 offset:52480
    v_rcp_f32 v49, v49
    v_mfma_f32_32x32x16_bf16 v[32:47], v[88:91], a[120:123], v[32:47]
    ds_read_b64_tr_b16 a[148:149], v128 offset:61696
    ds_read_b64_tr_b16 a[150:151], v128 offset:64768
    v_rcp_f32 v50, v50
    v_rcp_f32 v51, v51
    v_mfma_f32_32x32x16_bf16 v[32:47], v[92:95], a[124:127], v[32:47]
    s_waitcnt lgkmcnt(15)
    ds_write_b128 v123, v[136:139] offset:2048
    v_rcp_f32 v52, v52
    v_rcp_f32 v53, v53
    v_rcp_f32 v54, v54
    v_rcp_f32 v55, v55
    v_rcp_f32 v56, v56
    v_rcp_f32 v57, v57
    v_rcp_f32 v58, v58
    v_rcp_f32 v59, v59
    v_rcp_f32 v60, v60
    v_rcp_f32 v61, v61
    v_rcp_f32 v62, v62
    v_rcp_f32_e64 v63, v63
    v_pk_mul_f32 v[48:49], v[16:17], v[48:49]
    v_pk_mul_f32 v[50:51], v[18:19], v[50:51]
    v_pk_mul_f32 v[52:53], v[20:21], v[52:53]
    v_pk_mul_f32 v[54:55], v[22:23], v[54:55]
    v_pk_mul_f32 v[56:57], v[24:25], v[56:57]
    v_pk_mul_f32 v[58:59], v[26:27], v[58:59]
    v_pk_mul_f32 v[60:61], v[28:29], v[60:61]
    v_pk_mul_f32 v[62:63], v[30:31], v[62:63]
    v_pk_fma_f32 v[100:101], v[48:49], v[48:49], v[100:101]
    v_pk_fma_f32 v[100:101], v[50:51], v[50:51], v[100:101]
    v_pk_fma_f32 v[100:101], v[52:53], v[52:53], v[100:101]
    v_pk_fma_f32 v[100:101], v[54:55], v[54:55], v[100:101]
    v_pk_fma_f32 v[100:101], v[56:57], v[56:57], v[100:101]
    v_pk_fma_f32 v[100:101], v[58:59], v[58:59], v[100:101]
    v_pk_fma_f32 v[100:101], v[60:61], v[60:61], v[100:101]
    v_pk_fma_f32 v[100:101], v[62:63], v[62:63], v[100:101]
    v_pk_fma_f32 v[48:49], v[32:33], v[32:33], s[52:53]
    v_pk_fma_f32 v[50:51], v[34:35], v[34:35], s[52:53]
    v_pk_fma_f32 v[52:53], v[36:37], v[36:37], s[52:53]
    v_pk_fma_f32 v[54:55], v[38:39], v[38:39], s[52:53]
    v_pk_fma_f32 v[56:57], v[40:41], v[40:41], s[52:53]
    v_pk_fma_f32 v[58:59], v[42:43], v[42:43], s[52:53]
    v_pk_fma_f32 v[60:61], v[44:45], v[44:45], s[52:53]
    v_pk_fma_f32 v[62:63], v[46:47], v[46:47], s[52:53]
    v_pk_mul_f32 v[48:49], v[48:49], v[32:33] neg_lo:[1,0] neg_hi:[1,0]
    v_pk_mul_f32 v[50:51], v[50:51], v[34:35] neg_lo:[1,0] neg_hi:[1,0]
    v_pk_mul_f32 v[52:53], v[52:53], v[36:37] neg_lo:[1,0] neg_hi:[1,0]
    v_pk_mul_f32 v[54:55], v[54:55], v[38:39] neg_lo:[1,0] neg_hi:[1,0]
    v_pk_mul_f32 v[56:57], v[56:57], v[40:41] neg_lo:[1,0] neg_hi:[1,0]
    v_pk_mul_f32 v[58:59], v[58:59], v[42:43] neg_lo:[1,0] neg_hi:[1,0]
    v_pk_mul_f32 v[60:61], v[60:61], v[44:45] neg_lo:[1,0] neg_hi:[1,0]
    v_pk_mul_f32 v[62:63], v[62:63], v[46:47] neg_lo:[1,0] neg_hi:[1,0]
    s_waitcnt lgkmcnt(1)
    v_mfma_f32_32x32x16_bf16 v[16:31], v[72:75], a[128:131], 0
    ds_read_b64_tr_b16 v[136:137], v120 offset:49152
    ds_read_b64_tr_b16 v[138:139], v120 offset:52224
    ds_read_b64_tr_b16 a[152:153], v129 offset:256
    ds_read_b64_tr_b16 a[154:155], v129 offset:3328
    ds_read_b64_tr_b16 a[156:157], v129 offset:12544
    ds_read_b64_tr_b16 a[158:159], v129 offset:15616
    v_mfma_f32_32x32x16_bf16 v[16:31], v[76:79], a[132:135], v[16:31]
    ds_write_b128 v123, v[140:143] offset:3072
    v_exp_f32 v48, v48
    v_exp_f32 v49, v49
    v_exp_f32 v50, v50
    v_exp_f32 v51, v51
    v_exp_f32 v52, v52
    v_exp_f32 v53, v53
    v_exp_f32 v54, v54
    v_exp_f32 v55, v55
    v_exp_f32 v56, v56
    v_exp_f32 v57, v57
    v_exp_f32 v58, v58
    v_exp_f32 v59, v59
    v_exp_f32 v60, v60
    v_exp_f32 v61, v61
    v_exp_f32 v62, v62
    v_exp_f32_e64 v63, v63
    v_pk_add_f32 v[48:49], v[48:49], 1.0 op_sel_hi:[1,0]
    v_pk_add_f32 v[50:51], v[50:51], 1.0 op_sel_hi:[1,0]
    v_pk_add_f32 v[52:53], v[52:53], 1.0 op_sel_hi:[1,0]
    v_pk_add_f32 v[54:55], v[54:55], 1.0 op_sel_hi:[1,0]
    v_pk_add_f32 v[56:57], v[56:57], 1.0 op_sel_hi:[1,0]
    v_pk_add_f32 v[58:59], v[58:59], 1.0 op_sel_hi:[1,0]
    v_pk_add_f32 v[60:61], v[60:61], 1.0 op_sel_hi:[1,0]
    v_pk_add_f32 v[62:63], v[62:63], 1.0 op_sel_hi:[1,0]
    v_mfma_f32_32x32x16_bf16 v[16:31], v[80:83], a[136:139], v[16:31]
    ds_read_b64_tr_b16 v[140:141], v120 offset:61440
    ds_read_b64_tr_b16 v[142:143], v120 offset:64512
    ds_read_b64_tr_b16 a[160:161], v129 offset:24832
    ds_read_b64_tr_b16 a[162:163], v129 offset:27904
    v_rcp_f32 v48, v48
    v_mfma_f32_32x32x16_bf16 v[16:31], v[84:87], a[140:143], v[16:31]
    ds_read_b64_tr_b16 a[164:165], v129 offset:37120
    ds_read_b64_tr_b16 a[166:167], v129 offset:40192
    ds_read_b64_tr_b16 a[168:169], v129 offset:49408
    ds_read_b64_tr_b16 a[170:171], v129 offset:52480
    v_rcp_f32 v49, v49
    v_mfma_f32_32x32x16_bf16 v[16:31], v[88:91], a[144:147], v[16:31]
    ds_read_b64_tr_b16 a[172:173], v129 offset:61696
    ds_read_b64_tr_b16 a[174:175], v129 offset:64768
    v_rcp_f32 v50, v50
    v_rcp_f32 v51, v51
    v_mfma_f32_32x32x16_bf16 v[16:31], v[92:95], a[148:151], v[16:31]
    s_waitcnt lgkmcnt(15)
    ds_write_b128 v123, v[136:139] offset:4096
    v_rcp_f32 v52, v52
    v_rcp_f32 v53, v53
    v_rcp_f32 v54, v54
    v_rcp_f32 v55, v55
    v_rcp_f32 v56, v56
    v_rcp_f32 v57, v57
    v_rcp_f32 v58, v58
    v_rcp_f32 v59, v59
    v_rcp_f32 v60, v60
    v_rcp_f32 v61, v61
    v_rcp_f32 v62, v62
    v_rcp_f32_e64 v63, v63
    v_pk_mul_f32 v[48:49], v[32:33], v[48:49]
    v_pk_mul_f32 v[50:51], v[34:35], v[50:51]
    v_pk_mul_f32 v[52:53], v[36:37], v[52:53]
    v_pk_mul_f32 v[54:55], v[38:39], v[54:55]
    v_pk_mul_f32 v[56:57], v[40:41], v[56:57]
    v_pk_mul_f32 v[58:59], v[42:43], v[58:59]
    v_pk_mul_f32 v[60:61], v[44:45], v[60:61]
    v_pk_mul_f32 v[62:63], v[46:47], v[62:63]
    v_pk_fma_f32 v[102:103], v[48:49], v[48:49], v[102:103]
    v_pk_fma_f32 v[102:103], v[50:51], v[50:51], v[102:103]
    v_pk_fma_f32 v[102:103], v[52:53], v[52:53], v[102:103]
    v_pk_fma_f32 v[102:103], v[54:55], v[54:55], v[102:103]
    v_pk_fma_f32 v[102:103], v[56:57], v[56:57], v[102:103]
    v_pk_fma_f32 v[102:103], v[58:59], v[58:59], v[102:103]
    v_pk_fma_f32 v[102:103], v[60:61], v[60:61], v[102:103]
    v_pk_fma_f32 v[102:103], v[62:63], v[62:63], v[102:103]
    v_pk_fma_f32 v[48:49], v[16:17], v[16:17], s[52:53]
    v_pk_fma_f32 v[50:51], v[18:19], v[18:19], s[52:53]
    v_pk_fma_f32 v[52:53], v[20:21], v[20:21], s[52:53]
    v_pk_fma_f32 v[54:55], v[22:23], v[22:23], s[52:53]
    v_pk_fma_f32 v[56:57], v[24:25], v[24:25], s[52:53]
    v_pk_fma_f32 v[58:59], v[26:27], v[26:27], s[52:53]
    v_pk_fma_f32 v[60:61], v[28:29], v[28:29], s[52:53]
    v_pk_fma_f32 v[62:63], v[30:31], v[30:31], s[52:53]
    v_pk_mul_f32 v[48:49], v[48:49], v[16:17] neg_lo:[1,0] neg_hi:[1,0]
    v_pk_mul_f32 v[50:51], v[50:51], v[18:19] neg_lo:[1,0] neg_hi:[1,0]
    v_pk_mul_f32 v[52:53], v[52:53], v[20:21] neg_lo:[1,0] neg_hi:[1,0]
    v_pk_mul_f32 v[54:55], v[54:55], v[22:23] neg_lo:[1,0] neg_hi:[1,0]
    v_pk_mul_f32 v[56:57], v[56:57], v[24:25] neg_lo:[1,0] neg_hi:[1,0]
    v_pk_mul_f32 v[58:59], v[58:59], v[26:27] neg_lo:[1,0] neg_hi:[1,0]
    v_pk_mul_f32 v[60:61], v[60:61], v[28:29] neg_lo:[1,0] neg_hi:[1,0]
    v_pk_mul_f32 v[62:63], v[62:63], v[30:31] neg_lo:[1,0] neg_hi:[1,0]
    s_waitcnt lgkmcnt(1)
    v_mfma_f32_32x32x16_bf16 v[32:47], v[72:75], a[152:155], 0
    ds_read_b64_tr_b16 v[136:137], v121 offset:0
    ds_read_b64_tr_b16 v[138:139], v121 offset:3072
    ds_read_b64_tr_b16 a[176:177], v130 offset:256
    ds_read_b64_tr_b16 a[178:179], v130 offset:3328
    ds_read_b64_tr_b16 a[180:181], v130 offset:12544
    ds_read_b64_tr_b16 a[182:183], v130 offset:15616
    v_mfma_f32_32x32x16_bf16 v[32:47], v[76:79], a[156:159], v[32:47]
    ds_write_b128 v123, v[140:143] offset:5120
    v_exp_f32 v48, v48
    v_exp_f32 v49, v49
    v_exp_f32 v50, v50
    v_exp_f32 v51, v51
    v_exp_f32 v52, v52
    v_exp_f32 v53, v53
    v_exp_f32 v54, v54
    v_exp_f32 v55, v55
    v_exp_f32 v56, v56
    v_exp_f32 v57, v57
    v_exp_f32 v58, v58
    v_exp_f32 v59, v59
    v_exp_f32 v60, v60
    v_exp_f32 v61, v61
    v_exp_f32 v62, v62
    v_exp_f32_e64 v63, v63
    v_pk_add_f32 v[48:49], v[48:49], 1.0 op_sel_hi:[1,0]
    v_pk_add_f32 v[50:51], v[50:51], 1.0 op_sel_hi:[1,0]
    v_pk_add_f32 v[52:53], v[52:53], 1.0 op_sel_hi:[1,0]
    v_pk_add_f32 v[54:55], v[54:55], 1.0 op_sel_hi:[1,0]
    v_pk_add_f32 v[56:57], v[56:57], 1.0 op_sel_hi:[1,0]
    v_pk_add_f32 v[58:59], v[58:59], 1.0 op_sel_hi:[1,0]
    v_pk_add_f32 v[60:61], v[60:61], 1.0 op_sel_hi:[1,0]
    v_pk_add_f32 v[62:63], v[62:63], 1.0 op_sel_hi:[1,0]
    v_mfma_f32_32x32x16_bf16 v[32:47], v[80:83], a[160:163], v[32:47]
    ds_read_b64_tr_b16 v[140:141], v121 offset:12288
    ds_read_b64_tr_b16 v[142:143], v121 offset:15360
    ds_read_b64_tr_b16 a[184:185], v130 offset:24832
    ds_read_b64_tr_b16 a[186:187], v130 offset:27904
    v_rcp_f32 v48, v48
    v_mfma_f32_32x32x16_bf16 v[32:47], v[84:87], a[164:167], v[32:47]
    ds_read_b64_tr_b16 a[188:189], v130 offset:37120
    ds_read_b64_tr_b16 a[190:191], v130 offset:40192
    ds_read_b64_tr_b16 a[192:193], v130 offset:49408
    ds_read_b64_tr_b16 a[194:195], v130 offset:52480
    v_rcp_f32 v49, v49
    v_mfma_f32_32x32x16_bf16 v[32:47], v[88:91], a[168:171], v[32:47]
    ds_read_b64_tr_b16 a[196:197], v130 offset:61696
    ds_read_b64_tr_b16 a[198:199], v130 offset:64768
    buffer_load_dword v6, v127, s[36:39], s22 offen
    v_rcp_f32 v50, v50
    v_rcp_f32 v51, v51
    v_mfma_f32_32x32x16_bf16 v[32:47], v[92:95], a[172:175], v[32:47]
    s_waitcnt lgkmcnt(15)
    ds_write_b128 v123, v[136:139] offset:6144
    v_rcp_f32 v52, v52
    v_rcp_f32 v53, v53
    v_rcp_f32 v54, v54
    v_rcp_f32 v55, v55
    v_rcp_f32 v56, v56
    v_rcp_f32 v57, v57
    v_rcp_f32 v58, v58
    v_rcp_f32 v59, v59
    v_rcp_f32 v60, v60
    v_rcp_f32 v61, v61
    v_rcp_f32 v62, v62
    v_rcp_f32_e64 v63, v63
    v_pk_mul_f32 v[48:49], v[16:17], v[48:49]
    v_pk_mul_f32 v[50:51], v[18:19], v[50:51]
    v_pk_mul_f32 v[52:53], v[20:21], v[52:53]
    v_pk_mul_f32 v[54:55], v[22:23], v[54:55]
    v_pk_mul_f32 v[56:57], v[24:25], v[56:57]
    v_pk_mul_f32 v[58:59], v[26:27], v[58:59]
    v_pk_mul_f32 v[60:61], v[28:29], v[60:61]
    v_pk_mul_f32 v[62:63], v[30:31], v[62:63]
    v_pk_fma_f32 v[104:105], v[48:49], v[48:49], v[104:105]
    v_pk_fma_f32 v[104:105], v[50:51], v[50:51], v[104:105]
    v_pk_fma_f32 v[104:105], v[52:53], v[52:53], v[104:105]
    v_pk_fma_f32 v[104:105], v[54:55], v[54:55], v[104:105]
    v_pk_fma_f32 v[104:105], v[56:57], v[56:57], v[104:105]
    v_pk_fma_f32 v[104:105], v[58:59], v[58:59], v[104:105]
    v_pk_fma_f32 v[104:105], v[60:61], v[60:61], v[104:105]
    v_pk_fma_f32 v[104:105], v[62:63], v[62:63], v[104:105]
    v_pk_fma_f32 v[48:49], v[32:33], v[32:33], s[52:53]
    v_pk_fma_f32 v[50:51], v[34:35], v[34:35], s[52:53]
    v_pk_fma_f32 v[52:53], v[36:37], v[36:37], s[52:53]
    v_pk_fma_f32 v[54:55], v[38:39], v[38:39], s[52:53]
    v_pk_fma_f32 v[56:57], v[40:41], v[40:41], s[52:53]
    v_pk_fma_f32 v[58:59], v[42:43], v[42:43], s[52:53]
    v_pk_fma_f32 v[60:61], v[44:45], v[44:45], s[52:53]
    v_pk_fma_f32 v[62:63], v[46:47], v[46:47], s[52:53]
    v_pk_mul_f32 v[48:49], v[48:49], v[32:33] neg_lo:[1,0] neg_hi:[1,0]
    v_pk_mul_f32 v[50:51], v[50:51], v[34:35] neg_lo:[1,0] neg_hi:[1,0]
    v_pk_mul_f32 v[52:53], v[52:53], v[36:37] neg_lo:[1,0] neg_hi:[1,0]
    v_pk_mul_f32 v[54:55], v[54:55], v[38:39] neg_lo:[1,0] neg_hi:[1,0]
    v_pk_mul_f32 v[56:57], v[56:57], v[40:41] neg_lo:[1,0] neg_hi:[1,0]
    v_pk_mul_f32 v[58:59], v[58:59], v[42:43] neg_lo:[1,0] neg_hi:[1,0]
    v_pk_mul_f32 v[60:61], v[60:61], v[44:45] neg_lo:[1,0] neg_hi:[1,0]
    v_pk_mul_f32 v[62:63], v[62:63], v[46:47] neg_lo:[1,0] neg_hi:[1,0]
    s_waitcnt lgkmcnt(1)
    v_mfma_f32_32x32x16_bf16 v[16:31], v[72:75], a[176:179], 0
    ds_read_b64_tr_b16 v[136:137], v121 offset:24576
    ds_read_b64_tr_b16 v[138:139], v121 offset:27648
    ds_read_b64_tr_b16 a[200:201], v131 offset:256
    ds_read_b64_tr_b16 a[202:203], v131 offset:3328
    ds_read_b64_tr_b16 a[204:205], v131 offset:12544
    ds_read_b64_tr_b16 a[206:207], v131 offset:15616
    v_mfma_f32_32x32x16_bf16 v[16:31], v[76:79], a[180:183], v[16:31]
    ds_write_b128 v123, v[140:143] offset:7168
    v_exp_f32 v48, v48
    v_exp_f32 v49, v49
    v_exp_f32 v50, v50
    v_exp_f32 v51, v51
    v_exp_f32 v52, v52
    v_exp_f32 v53, v53
    v_exp_f32 v54, v54
    v_exp_f32 v55, v55
    v_exp_f32 v56, v56
    v_exp_f32 v57, v57
    v_exp_f32 v58, v58
    v_exp_f32 v59, v59
    v_exp_f32 v60, v60
    v_exp_f32 v61, v61
    v_exp_f32 v62, v62
    v_exp_f32_e64 v63, v63
    v_pk_add_f32 v[48:49], v[48:49], 1.0 op_sel_hi:[1,0]
    v_pk_add_f32 v[50:51], v[50:51], 1.0 op_sel_hi:[1,0]
    v_pk_add_f32 v[52:53], v[52:53], 1.0 op_sel_hi:[1,0]
    v_pk_add_f32 v[54:55], v[54:55], 1.0 op_sel_hi:[1,0]
    v_pk_add_f32 v[56:57], v[56:57], 1.0 op_sel_hi:[1,0]
    v_pk_add_f32 v[58:59], v[58:59], 1.0 op_sel_hi:[1,0]
    v_pk_add_f32 v[60:61], v[60:61], 1.0 op_sel_hi:[1,0]
    v_pk_add_f32 v[62:63], v[62:63], 1.0 op_sel_hi:[1,0]
    v_mfma_f32_32x32x16_bf16 v[16:31], v[80:83], a[184:187], v[16:31]
    ds_read_b64_tr_b16 v[140:141], v121 offset:36864
    ds_read_b64_tr_b16 v[142:143], v121 offset:39936
    ds_read_b64_tr_b16 a[208:209], v131 offset:24832
    ds_read_b64_tr_b16 a[210:211], v131 offset:27904
    v_rcp_f32 v48, v48
    v_mfma_f32_32x32x16_bf16 v[16:31], v[84:87], a[188:191], v[16:31]
    ds_read_b64_tr_b16 a[212:213], v131 offset:37120
    ds_read_b64_tr_b16 a[214:215], v131 offset:40192
    ds_read_b64_tr_b16 a[216:217], v131 offset:49408
    ds_read_b64_tr_b16 a[218:219], v131 offset:52480
    v_rcp_f32 v49, v49
    v_mfma_f32_32x32x16_bf16 v[16:31], v[88:91], a[192:195], v[16:31]
    ds_read_b64_tr_b16 a[220:221], v131 offset:61696
    ds_read_b64_tr_b16 a[222:223], v131 offset:64768
    v_rcp_f32 v50, v50
    v_rcp_f32 v51, v51
    v_mfma_f32_32x32x16_bf16 v[16:31], v[92:95], a[196:199], v[16:31]
    s_waitcnt lgkmcnt(15)
    ds_write_b128 v123, v[136:139] offset:8192
    v_rcp_f32 v52, v52
    v_rcp_f32 v53, v53
    v_rcp_f32 v54, v54
    v_rcp_f32 v55, v55
    v_rcp_f32 v56, v56
    v_rcp_f32 v57, v57
    v_rcp_f32 v58, v58
    v_rcp_f32 v59, v59
    v_rcp_f32 v60, v60
    v_rcp_f32 v61, v61
    v_rcp_f32 v62, v62
    v_rcp_f32_e64 v63, v63
    v_pk_mul_f32 v[48:49], v[32:33], v[48:49]
    v_pk_mul_f32 v[50:51], v[34:35], v[50:51]
    v_pk_mul_f32 v[52:53], v[36:37], v[52:53]
    v_pk_mul_f32 v[54:55], v[38:39], v[54:55]
    v_pk_mul_f32 v[56:57], v[40:41], v[56:57]
    v_pk_mul_f32 v[58:59], v[42:43], v[58:59]
    v_pk_mul_f32 v[60:61], v[44:45], v[60:61]
    v_pk_mul_f32 v[62:63], v[46:47], v[62:63]
    v_pk_fma_f32 v[106:107], v[48:49], v[48:49], v[106:107]
    v_pk_fma_f32 v[106:107], v[50:51], v[50:51], v[106:107]
    v_pk_fma_f32 v[106:107], v[52:53], v[52:53], v[106:107]
    v_pk_fma_f32 v[106:107], v[54:55], v[54:55], v[106:107]
    v_pk_fma_f32 v[106:107], v[56:57], v[56:57], v[106:107]
    v_pk_fma_f32 v[106:107], v[58:59], v[58:59], v[106:107]
    v_pk_fma_f32 v[106:107], v[60:61], v[60:61], v[106:107]
    v_pk_fma_f32 v[106:107], v[62:63], v[62:63], v[106:107]
    v_pk_fma_f32 v[48:49], v[16:17], v[16:17], s[52:53]
    v_pk_fma_f32 v[50:51], v[18:19], v[18:19], s[52:53]
    v_pk_fma_f32 v[52:53], v[20:21], v[20:21], s[52:53]
    v_pk_fma_f32 v[54:55], v[22:23], v[22:23], s[52:53]
    v_pk_fma_f32 v[56:57], v[24:25], v[24:25], s[52:53]
    v_pk_fma_f32 v[58:59], v[26:27], v[26:27], s[52:53]
    v_pk_fma_f32 v[60:61], v[28:29], v[28:29], s[52:53]
    v_pk_fma_f32 v[62:63], v[30:31], v[30:31], s[52:53]
    v_pk_mul_f32 v[48:49], v[48:49], v[16:17] neg_lo:[1,0] neg_hi:[1,0]
    v_pk_mul_f32 v[50:51], v[50:51], v[18:19] neg_lo:[1,0] neg_hi:[1,0]
    v_pk_mul_f32 v[52:53], v[52:53], v[20:21] neg_lo:[1,0] neg_hi:[1,0]
    v_pk_mul_f32 v[54:55], v[54:55], v[22:23] neg_lo:[1,0] neg_hi:[1,0]
    v_pk_mul_f32 v[56:57], v[56:57], v[24:25] neg_lo:[1,0] neg_hi:[1,0]
    v_pk_mul_f32 v[58:59], v[58:59], v[26:27] neg_lo:[1,0] neg_hi:[1,0]
    v_pk_mul_f32 v[60:61], v[60:61], v[28:29] neg_lo:[1,0] neg_hi:[1,0]
    v_pk_mul_f32 v[62:63], v[62:63], v[30:31] neg_lo:[1,0] neg_hi:[1,0]
    s_waitcnt lgkmcnt(1)
    v_mfma_f32_32x32x16_bf16 v[32:47], v[72:75], a[200:203], 0
    ds_read_b64_tr_b16 v[136:137], v121 offset:49152
    ds_read_b64_tr_b16 v[138:139], v121 offset:52224
    ds_read_b64_tr_b16 v[160:161], v128 offset:512
    ds_read_b64_tr_b16 v[162:163], v128 offset:3584
    ds_read_b64_tr_b16 v[164:165], v128 offset:12800
    ds_read_b64_tr_b16 v[166:167], v128 offset:15872
    v_mfma_f32_32x32x16_bf16 v[32:47], v[76:79], a[204:207], v[32:47]
    ds_write_b128 v123, v[140:143] offset:9216
    v_exp_f32 v48, v48
    v_exp_f32 v49, v49
    v_exp_f32 v50, v50
    v_exp_f32 v51, v51
    v_exp_f32 v52, v52
    v_exp_f32 v53, v53
    v_exp_f32 v54, v54
    v_exp_f32 v55, v55
    v_exp_f32 v56, v56
    v_exp_f32 v57, v57
    v_exp_f32 v58, v58
    v_exp_f32 v59, v59
    v_exp_f32 v60, v60
    v_exp_f32 v61, v61
    v_exp_f32 v62, v62
    v_exp_f32_e64 v63, v63
    v_pk_add_f32 v[48:49], v[48:49], 1.0 op_sel_hi:[1,0]
    v_pk_add_f32 v[50:51], v[50:51], 1.0 op_sel_hi:[1,0]
    v_pk_add_f32 v[52:53], v[52:53], 1.0 op_sel_hi:[1,0]
    v_pk_add_f32 v[54:55], v[54:55], 1.0 op_sel_hi:[1,0]
    v_pk_add_f32 v[56:57], v[56:57], 1.0 op_sel_hi:[1,0]
    v_pk_add_f32 v[58:59], v[58:59], 1.0 op_sel_hi:[1,0]
    v_pk_add_f32 v[60:61], v[60:61], 1.0 op_sel_hi:[1,0]
    v_pk_add_f32 v[62:63], v[62:63], 1.0 op_sel_hi:[1,0]
    v_mfma_f32_32x32x16_bf16 v[32:47], v[80:83], a[208:211], v[32:47]
    ds_read_b64_tr_b16 v[140:141], v121 offset:61440
    ds_read_b64_tr_b16 v[142:143], v121 offset:64512
    ds_read_b64_tr_b16 v[168:169], v128 offset:25088
    ds_read_b64_tr_b16 v[170:171], v128 offset:28160
    v_rcp_f32 v48, v48
    v_mfma_f32_32x32x16_bf16 v[32:47], v[84:87], a[212:215], v[32:47]
    ds_read_b64_tr_b16 v[172:173], v128 offset:37376
    ds_read_b64_tr_b16 v[174:175], v128 offset:40448
    ds_read_b64_tr_b16 v[176:177], v128 offset:49664
    ds_read_b64_tr_b16 v[178:179], v128 offset:52736
    v_rcp_f32 v49, v49
    v_mfma_f32_32x32x16_bf16 v[32:47], v[88:91], a[216:219], v[32:47]
    ds_read_b64_tr_b16 v[180:181], v128 offset:61952
    ds_read_b64_tr_b16 v[182:183], v128 offset:65024
    v_rcp_f32 v50, v50
    v_rcp_f32 v51, v51
    v_mfma_f32_32x32x16_bf16 v[32:47], v[92:95], a[220:223], v[32:47]
    s_waitcnt lgkmcnt(15)
    ds_write_b128 v123, v[136:139] offset:10240
    v_rcp_f32 v52, v52
    v_rcp_f32 v53, v53
    v_rcp_f32 v54, v54
    v_rcp_f32 v55, v55
    v_rcp_f32 v56, v56
    v_rcp_f32 v57, v57
    v_rcp_f32 v58, v58
    v_rcp_f32 v59, v59
    v_rcp_f32 v60, v60
    v_rcp_f32 v61, v61
    v_rcp_f32 v62, v62
    v_rcp_f32_e64 v63, v63
    v_pk_mul_f32 v[48:49], v[16:17], v[48:49]
    v_pk_mul_f32 v[50:51], v[18:19], v[50:51]
    v_pk_mul_f32 v[52:53], v[20:21], v[52:53]
    v_pk_mul_f32 v[54:55], v[22:23], v[54:55]
    v_pk_mul_f32 v[56:57], v[24:25], v[56:57]
    v_pk_mul_f32 v[58:59], v[26:27], v[58:59]
    v_pk_mul_f32 v[60:61], v[28:29], v[60:61]
    v_pk_mul_f32 v[62:63], v[30:31], v[62:63]
    v_pk_fma_f32 v[108:109], v[48:49], v[48:49], v[108:109]
    v_pk_fma_f32 v[108:109], v[50:51], v[50:51], v[108:109]
    v_pk_fma_f32 v[108:109], v[52:53], v[52:53], v[108:109]
    v_pk_fma_f32 v[108:109], v[54:55], v[54:55], v[108:109]
    v_pk_fma_f32 v[108:109], v[56:57], v[56:57], v[108:109]
    v_pk_fma_f32 v[108:109], v[58:59], v[58:59], v[108:109]
    v_pk_fma_f32 v[108:109], v[60:61], v[60:61], v[108:109]
    v_pk_fma_f32 v[108:109], v[62:63], v[62:63], v[108:109]
    v_pk_fma_f32 v[48:49], v[32:33], v[32:33], s[52:53]
    v_pk_fma_f32 v[50:51], v[34:35], v[34:35], s[52:53]
    v_pk_fma_f32 v[52:53], v[36:37], v[36:37], s[52:53]
    v_pk_fma_f32 v[54:55], v[38:39], v[38:39], s[52:53]
    v_pk_fma_f32 v[56:57], v[40:41], v[40:41], s[52:53]
    v_pk_fma_f32 v[58:59], v[42:43], v[42:43], s[52:53]
    v_pk_fma_f32 v[60:61], v[44:45], v[44:45], s[52:53]
    v_pk_fma_f32 v[62:63], v[46:47], v[46:47], s[52:53]
    v_pk_mul_f32 v[48:49], v[48:49], v[32:33] neg_lo:[1,0] neg_hi:[1,0]
    v_pk_mul_f32 v[50:51], v[50:51], v[34:35] neg_lo:[1,0] neg_hi:[1,0]
    v_pk_mul_f32 v[52:53], v[52:53], v[36:37] neg_lo:[1,0] neg_hi:[1,0]
    v_pk_mul_f32 v[54:55], v[54:55], v[38:39] neg_lo:[1,0] neg_hi:[1,0]
    v_pk_mul_f32 v[56:57], v[56:57], v[40:41] neg_lo:[1,0] neg_hi:[1,0]
    v_pk_mul_f32 v[58:59], v[58:59], v[42:43] neg_lo:[1,0] neg_hi:[1,0]
    v_pk_mul_f32 v[60:61], v[60:61], v[44:45] neg_lo:[1,0] neg_hi:[1,0]
    v_pk_mul_f32 v[62:63], v[62:63], v[46:47] neg_lo:[1,0] neg_hi:[1,0]
    s_waitcnt lgkmcnt(1)
    v_mfma_f32_32x32x16_bf16 v[16:31], v[72:75], v[160:163], 0
    ds_read_b64_tr_b16 v[136:137], v122 offset:0
    ds_read_b64_tr_b16 v[138:139], v122 offset:3072
    ds_read_b64_tr_b16 v[184:185], v129 offset:512
    ds_read_b64_tr_b16 v[186:187], v129 offset:3584
    ds_read_b64_tr_b16 v[188:189], v129 offset:12800
    ds_read_b64_tr_b16 v[190:191], v129 offset:15872
    v_mfma_f32_32x32x16_bf16 v[16:31], v[76:79], v[164:167], v[16:31]
    ds_write_b128 v123, v[140:143] offset:11264
    v_exp_f32 v48, v48
    v_exp_f32 v49, v49
    v_exp_f32 v50, v50
    v_exp_f32 v51, v51
    v_exp_f32 v52, v52
    v_exp_f32 v53, v53
    v_exp_f32 v54, v54
    v_exp_f32 v55, v55
    v_exp_f32 v56, v56
    v_exp_f32 v57, v57
    v_exp_f32 v58, v58
    v_exp_f32 v59, v59
    v_exp_f32 v60, v60
    v_exp_f32 v61, v61
    v_exp_f32 v62, v62
    v_exp_f32_e64 v63, v63
    v_pk_add_f32 v[48:49], v[48:49], 1.0 op_sel_hi:[1,0]
    v_pk_add_f32 v[50:51], v[50:51], 1.0 op_sel_hi:[1,0]
    v_pk_add_f32 v[52:53], v[52:53], 1.0 op_sel_hi:[1,0]
    v_pk_add_f32 v[54:55], v[54:55], 1.0 op_sel_hi:[1,0]
    v_pk_add_f32 v[56:57], v[56:57], 1.0 op_sel_hi:[1,0]
    v_pk_add_f32 v[58:59], v[58:59], 1.0 op_sel_hi:[1,0]
    v_pk_add_f32 v[60:61], v[60:61], 1.0 op_sel_hi:[1,0]
    v_pk_add_f32 v[62:63], v[62:63], 1.0 op_sel_hi:[1,0]
    v_mfma_f32_32x32x16_bf16 v[16:31], v[80:83], v[168:171], v[16:31]
    s_waitcnt vmcnt(4)
    ds_read_b64_tr_b16 v[140:141], v122 offset:12288
    ds_read_b64_tr_b16 v[142:143], v122 offset:15360
    ds_read_b64_tr_b16 v[192:193], v129 offset:25088
    ds_read_b64_tr_b16 v[194:195], v129 offset:28160
    v_rcp_f32 v48, v48
    v_mfma_f32_32x32x16_bf16 v[16:31], v[84:87], v[172:175], v[16:31]
    ds_read_b64_tr_b16 v[196:197], v129 offset:37376
    ds_read_b64_tr_b16 v[198:199], v129 offset:40448
    ds_read_b64_tr_b16 v[200:201], v129 offset:49664
    ds_read_b64_tr_b16 v[202:203], v129 offset:52736
    v_rcp_f32 v49, v49
    v_mfma_f32_32x32x16_bf16 v[16:31], v[88:91], v[176:179], v[16:31]
    ds_read_b64_tr_b16 v[204:205], v129 offset:61952
    ds_read_b64_tr_b16 v[206:207], v129 offset:65024
    v_rcp_f32 v50, v50
    v_rcp_f32 v51, v51
    v_mfma_f32_32x32x16_bf16 v[16:31], v[92:95], v[180:183], v[16:31]
    s_waitcnt lgkmcnt(15)
    ds_write_b128 v123, v[136:139] offset:12288
    v_rcp_f32 v52, v52
    v_rcp_f32 v53, v53
    v_rcp_f32 v54, v54
    v_rcp_f32 v55, v55
    v_rcp_f32 v56, v56
    v_rcp_f32 v57, v57
    v_rcp_f32 v58, v58
    v_rcp_f32 v59, v59
    v_rcp_f32 v60, v60
    v_rcp_f32 v61, v61
    v_rcp_f32 v62, v62
    v_rcp_f32 v63, v63
    v_pk_mul_f32 v[48:49], v[32:33], v[48:49]
    v_pk_mul_f32 v[50:51], v[34:35], v[50:51]
    v_pk_mul_f32 v[52:53], v[36:37], v[52:53]
    v_pk_mul_f32 v[54:55], v[38:39], v[54:55]
    v_pk_mul_f32 v[56:57], v[40:41], v[56:57]
    v_pk_mul_f32 v[58:59], v[42:43], v[58:59]
    v_pk_mul_f32 v[60:61], v[44:45], v[60:61]
    v_pk_mul_f32 v[62:63], v[46:47], v[62:63]
    v_pk_fma_f32 v[110:111], v[48:49], v[48:49], v[110:111]
    v_pk_fma_f32 v[110:111], v[50:51], v[50:51], v[110:111]
    v_pk_fma_f32 v[110:111], v[52:53], v[52:53], v[110:111]
    v_pk_fma_f32 v[110:111], v[54:55], v[54:55], v[110:111]
    v_pk_fma_f32 v[110:111], v[56:57], v[56:57], v[110:111]
    v_pk_fma_f32 v[110:111], v[58:59], v[58:59], v[110:111]
    v_pk_fma_f32 v[110:111], v[60:61], v[60:61], v[110:111]
    v_pk_fma_f32 v[110:111], v[62:63], v[62:63], v[110:111]
    v_pk_fma_f32 v[48:49], v[16:17], v[16:17], s[52:53]
    v_pk_fma_f32 v[50:51], v[18:19], v[18:19], s[52:53]
    v_pk_fma_f32 v[52:53], v[20:21], v[20:21], s[52:53]
    v_pk_fma_f32 v[54:55], v[22:23], v[22:23], s[52:53]
    v_pk_fma_f32 v[56:57], v[24:25], v[24:25], s[52:53]
    v_pk_fma_f32 v[58:59], v[26:27], v[26:27], s[52:53]
    v_pk_fma_f32 v[60:61], v[28:29], v[28:29], s[52:53]
    v_pk_fma_f32 v[62:63], v[30:31], v[30:31], s[52:53]
    v_pk_mul_f32 v[48:49], v[48:49], v[16:17] neg_lo:[1,0] neg_hi:[1,0]
    v_pk_mul_f32 v[50:51], v[50:51], v[18:19] neg_lo:[1,0] neg_hi:[1,0]
    v_pk_mul_f32 v[52:53], v[52:53], v[20:21] neg_lo:[1,0] neg_hi:[1,0]
    v_pk_mul_f32 v[54:55], v[54:55], v[22:23] neg_lo:[1,0] neg_hi:[1,0]
    v_pk_mul_f32 v[56:57], v[56:57], v[24:25] neg_lo:[1,0] neg_hi:[1,0]
    v_pk_mul_f32 v[58:59], v[58:59], v[26:27] neg_lo:[1,0] neg_hi:[1,0]
    v_pk_mul_f32 v[60:61], v[60:61], v[28:29] neg_lo:[1,0] neg_hi:[1,0]
    v_pk_mul_f32 v[62:63], v[62:63], v[30:31] neg_lo:[1,0] neg_hi:[1,0]
    s_waitcnt lgkmcnt(1)
    v_mfma_f32_32x32x16_bf16 v[32:47], v[72:75], v[184:187], 0
    ds_read_b64_tr_b16 v[136:137], v122 offset:24576
    ds_read_b64_tr_b16 v[138:139], v122 offset:27648
    ds_read_b64_tr_b16 v[208:209], v130 offset:512
    v_exp_f32 v48, v48
    v_exp_f32 v49, v49
    v_mfma_f32_32x32x16_bf16 v[32:47], v[76:79], v[188:191], v[32:47]
    ds_read_b64_tr_b16 v[210:211], v130 offset:3584
    ds_read_b64_tr_b16 v[212:213], v130 offset:12800
    ds_read_b64_tr_b16 v[214:215], v130 offset:15872
    v_exp_f32 v50, v50
    v_exp_f32 v51, v51
    v_mfma_f32_32x32x16_bf16 v[144:159], a[0:3], a[224:227], 0
    ds_read_b128 a[20:23], v4 offset:21504
    ds_read_b128 a[0:3], v4 offset:16384
    v_exp_f32 v52, v52
    v_exp_f32 v53, v53
    v_mfma_f32_32x32x16_bf16 v[144:159], a[4:7], a[228:231], v[144:159]
    ds_write_b128 v123, v[140:143] offset:13312
    v_exp_f32 v54, v54
    v_exp_f32 v55, v55
    v_exp_f32 v56, v56
    v_exp_f32 v57, v57
    v_exp_f32 v58, v58
    v_exp_f32 v59, v59
    v_exp_f32 v60, v60
    v_exp_f32 v61, v61
    v_exp_f32 v62, v62
    v_exp_f32_e64 v63, v63
    v_pk_add_f32 v[48:49], v[48:49], 1.0 op_sel_hi:[1,0]
    v_pk_add_f32 v[50:51], v[50:51], 1.0 op_sel_hi:[1,0]
    v_pk_add_f32 v[52:53], v[52:53], 1.0 op_sel_hi:[1,0]
    v_pk_add_f32 v[54:55], v[54:55], 1.0 op_sel_hi:[1,0]
    v_pk_add_f32 v[56:57], v[56:57], 1.0 op_sel_hi:[1,0]
    v_pk_add_f32 v[58:59], v[58:59], 1.0 op_sel_hi:[1,0]
    v_pk_add_f32 v[60:61], v[60:61], 1.0 op_sel_hi:[1,0]
    v_pk_add_f32 v[62:63], v[62:63], 1.0 op_sel_hi:[1,0]
    v_pk_mul_f32 v[10:11], v[144:145], v[144:145]
    v_pk_add_f32 v[8:9], v[144:145], v[146:147]
    v_pk_fma_f32 v[10:11], v[146:147], v[146:147], v[10:11]
    v_pk_add_f32 v[8:9], v[8:9], v[148:149]
    v_pk_fma_f32 v[10:11], v[148:149], v[148:149], v[10:11]
    v_pk_add_f32 v[8:9], v[8:9], v[150:151]
    v_pk_fma_f32 v[10:11], v[150:151], v[150:151], v[10:11]
    v_pk_add_f32 v[8:9], v[8:9], v[152:153]
    v_pk_fma_f32 v[10:11], v[152:153], v[152:153], v[10:11]
    v_pk_add_f32 v[8:9], v[8:9], v[154:155]
    v_pk_fma_f32 v[10:11], v[154:155], v[154:155], v[10:11]
    v_pk_add_f32 v[8:9], v[8:9], v[156:157]
    v_pk_fma_f32 v[10:11], v[156:157], v[156:157], v[10:11]
    v_pk_add_f32 v[8:9], v[8:9], v[158:159]
    v_pk_fma_f32 v[10:11], v[158:159], v[158:159], v[10:11]
    v_mfma_f32_32x32x16_bf16 v[32:47], v[80:83], v[192:195], v[32:47]
    ds_read_b64_tr_b16 v[140:141], v122 offset:36864
    ds_read_b64_tr_b16 v[142:143], v122 offset:39936
    ds_read_b64_tr_b16 v[216:217], v130 offset:25088
    ds_read_b64_tr_b16 v[218:219], v130 offset:28160
    v_rcp_f32 v48, v48
    v_mfma_f32_32x32x16_bf16 v[32:47], v[84:87], v[196:199], v[32:47]
    ds_read_b64_tr_b16 v[220:221], v130 offset:37376
    ds_read_b64_tr_b16 v[222:223], v130 offset:40448
    ds_read_b64_tr_b16 v[224:225], v130 offset:49664
    ds_read_b64_tr_b16 v[226:227], v130 offset:52736
    v_rcp_f32 v49, v49
    v_mfma_f32_32x32x16_bf16 v[32:47], v[88:91], v[200:203], v[32:47]
    ds_read_b64_tr_b16 v[228:229], v130 offset:61952
    ds_read_b64_tr_b16 v[230:231], v130 offset:65024
    v_rcp_f32 v50, v50
    v_rcp_f32 v51, v51
    v_mfma_f32_32x32x16_bf16 v[32:47], v[92:95], v[204:207], v[32:47]
    s_waitcnt lgkmcnt(15)
    ds_write_b128 v123, v[136:139] offset:14336
    v_rcp_f32 v52, v52
    v_rcp_f32 v53, v53
    v_rcp_f32 v54, v54
    v_rcp_f32 v55, v55
    v_rcp_f32 v56, v56
    v_rcp_f32 v57, v57
    v_rcp_f32 v58, v58
    v_rcp_f32 v59, v59
    v_rcp_f32 v60, v60
    v_rcp_f32 v61, v61
    v_rcp_f32 v62, v62
    v_rcp_f32_e64 v63, v63
    v_pk_mul_f32 v[48:49], v[16:17], v[48:49]
    v_pk_mul_f32 v[50:51], v[18:19], v[50:51]
    v_pk_mul_f32 v[52:53], v[20:21], v[52:53]
    v_pk_mul_f32 v[54:55], v[22:23], v[54:55]
    v_pk_mul_f32 v[56:57], v[24:25], v[56:57]
    v_pk_mul_f32 v[58:59], v[26:27], v[58:59]
    v_pk_mul_f32 v[60:61], v[28:29], v[60:61]
    v_pk_mul_f32 v[62:63], v[30:31], v[62:63]
    v_pk_fma_f32 v[112:113], v[48:49], v[48:49], v[112:113]
    v_pk_fma_f32 v[112:113], v[50:51], v[50:51], v[112:113]
    v_pk_fma_f32 v[112:113], v[52:53], v[52:53], v[112:113]
    v_pk_fma_f32 v[112:113], v[54:55], v[54:55], v[112:113]
    v_pk_fma_f32 v[112:113], v[56:57], v[56:57], v[112:113]
    v_pk_fma_f32 v[112:113], v[58:59], v[58:59], v[112:113]
    v_pk_fma_f32 v[112:113], v[60:61], v[60:61], v[112:113]
    v_pk_fma_f32 v[112:113], v[62:63], v[62:63], v[112:113]
    v_pk_fma_f32 v[48:49], v[32:33], v[32:33], s[52:53]
    v_pk_fma_f32 v[50:51], v[34:35], v[34:35], s[52:53]
    v_pk_fma_f32 v[52:53], v[36:37], v[36:37], s[52:53]
    v_pk_fma_f32 v[54:55], v[38:39], v[38:39], s[52:53]
    v_pk_fma_f32 v[56:57], v[40:41], v[40:41], s[52:53]
    v_pk_fma_f32 v[58:59], v[42:43], v[42:43], s[52:53]
    v_pk_fma_f32 v[60:61], v[44:45], v[44:45], s[52:53]
    v_pk_fma_f32 v[62:63], v[46:47], v[46:47], s[52:53]
    v_pk_mul_f32 v[48:49], v[48:49], v[32:33] neg_lo:[1,0] neg_hi:[1,0]
    v_pk_mul_f32 v[50:51], v[50:51], v[34:35] neg_lo:[1,0] neg_hi:[1,0]
    v_pk_mul_f32 v[52:53], v[52:53], v[36:37] neg_lo:[1,0] neg_hi:[1,0]
    v_pk_mul_f32 v[54:55], v[54:55], v[38:39] neg_lo:[1,0] neg_hi:[1,0]
    v_pk_mul_f32 v[56:57], v[56:57], v[40:41] neg_lo:[1,0] neg_hi:[1,0]
    v_pk_mul_f32 v[58:59], v[58:59], v[42:43] neg_lo:[1,0] neg_hi:[1,0]
    v_pk_mul_f32 v[60:61], v[60:61], v[44:45] neg_lo:[1,0] neg_hi:[1,0]
    v_pk_mul_f32 v[62:63], v[62:63], v[46:47] neg_lo:[1,0] neg_hi:[1,0]
L_pf2:
    s_waitcnt lgkmcnt(1)
    v_mfma_f32_32x32x16_bf16 v[16:31], v[72:75], v[208:211], 0
    ds_read_b64_tr_b16 v[136:137], v122 offset:49152
    ds_read_b64_tr_b16 v[138:139], v122 offset:52224
    ds_read_b64_tr_b16 v[232:233], v131 offset:512
    ds_read_b64_tr_b16 v[234:235], v131 offset:3584
    v_exp_f32 v48, v48
    v_mfma_f32_32x32x16_bf16 v[16:31], v[76:79], v[212:215], v[16:31]
    ds_read_b64_tr_b16 v[236:237], v131 offset:12800
    ds_read_b64_tr_b16 v[238:239], v131 offset:15872
    s_mov_b32 s63, L_pf2-L_pc+12288
    buffer_load_dword v6, v7, s[68:71], s63 offen
    v_exp_f32 v49, v49
    v_mfma_f32_32x32x16_bf16 v[144:159], a[8:11], a[232:235], 0
    ds_read_b128 a[4:7], v4 offset:17408
    ds_read_b128 a[8:11], v4 offset:18432
    v_exp_f32 v50, v50
    v_exp_f32 v51, v51
    v_mfma_f32_32x32x16_bf16 v[144:159], a[12:15], a[236:239], v[144:159]
    ds_write_b128 v123, v[140:143] offset:15360
    v_exp_f32 v52, v52
    v_exp_f32 v53, v53
    v_exp_f32 v54, v54
    v_exp_f32 v55, v55
    v_exp_f32 v56, v56
    v_exp_f32 v57, v57
    v_exp_f32 v58, v58
    v_exp_f32 v59, v59
    v_exp_f32 v60, v60
    v_exp_f32 v61, v61
    v_exp_f32 v62, v62
    v_exp_f32_e64 v63, v63
    v_pk_add_f32 v[48:49], v[48:49], 1.0 op_sel_hi:[1,0]
    v_pk_add_f32 v[50:51], v[50:51], 1.0 op_sel_hi:[1,0]
    v_pk_add_f32 v[52:53], v[52:53], 1.0 op_sel_hi:[1,0]
    v_pk_add_f32 v[54:55], v[54:55], 1.0 op_sel_hi:[1,0]
    v_pk_add_f32 v[56:57], v[56:57], 1.0 op_sel_hi:[1,0]
    v_pk_add_f32 v[58:59], v[58:59], 1.0 op_sel_hi:[1,0]
    v_pk_add_f32 v[60:61], v[60:61], 1.0 op_sel_hi:[1,0]
    v_pk_add_f32 v[62:63], v[62:63], 1.0 op_sel_hi:[1,0]
    v_pk_add_f32 v[8:9], v[8:9], v[144:145]
    v_pk_fma_f32 v[10:11], v[144:145], v[144:145], v[10:11]
    v_pk_add_f32 v[8:9], v[8:9], v[146:147]
    v_pk_fma_f32 v[10:11], v[146:147], v[146:147], v[10:11]
    v_pk_add_f32 v[8:9], v[8:9], v[148:149]
    v_pk_fma_f32 v[10:11], v[148:149], v[148:149], v[10:11]
    v_pk_add_f32 v[8:9], v[8:9], v[150:151]
    v_pk_fma_f32 v[10:11], v[150:151], v[150:151], v[10:11]
    v_pk_add_f32 v[8:9], v[8:9], v[152:153]
    v_pk_fma_f32 v[10:11], v[152:153], v[152:153], v[10:11]
    v_pk_add_f32 v[8:9], v[8:9], v[154:155]
    v_pk_fma_f32 v[10:11], v[154:155], v[154:155], v[10:11]
    v_pk_add_f32 v[8:9], v[8:9], v[156:157]
    v_pk_fma_f32 v[10:11], v[156:157], v[156:157], v[10:11]
    v_pk_add_f32 v[8:9], v[8:9], v[158:159]
    v_pk_fma_f32 v[10:11], v[158:159], v[158:159], v[10:11]
    v_mfma_f32_32x32x16_bf16 v[16:31], v[80:83], v[216:219], v[16:31]
    ds_read_b64_tr_b16 v[140:141], v122 offset:61440
    ds_read_b64_tr_b16 v[142:143], v122 offset:64512
    ds_read_b64_tr_b16 v[240:241], v131 offset:25088
    ds_read_b64_tr_b16 v[242:243], v131 offset:28160
    v_rcp_f32 v48, v48
    v_mfma_f32_32x32x16_bf16 v[16:31], v[84:87], v[220:223], v[16:31]
    ds_read_b64_tr_b16 v[244:245], v131 offset:37376
    ds_read_b64_tr_b16 v[246:247], v131 offset:40448
    ds_read_b64_tr_b16 v[248:249], v131 offset:49664
    ds_read_b64_tr_b16 v[250:251], v131 offset:52736
    v_rcp_f32 v49, v49
    v_mfma_f32_32x32x16_bf16 v[16:31], v[88:91], v[224:227], v[16:31]
    ds_read_b64_tr_b16 v[252:253], v131 offset:61952
    ds_read_b64_tr_b16 v[254:255], v131 offset:65024
    v_rcp_f32 v50, v50
    v_rcp_f32 v51, v51
    v_mfma_f32_32x32x16_bf16 v[16:31], v[92:95], v[228:231], v[16:31]
    s_waitcnt lgkmcnt(15)
    ds_write_b128 v123, v[136:139] offset:16384
    v_rcp_f32 v52, v52
    v_rcp_f32 v53, v53
    v_rcp_f32 v54, v54
    v_rcp_f32 v55, v55
    v_rcp_f32 v56, v56
    v_rcp_f32 v57, v57
    v_rcp_f32 v58, v58
    v_rcp_f32 v59, v59
    v_rcp_f32 v60, v60
    v_rcp_f32 v61, v61
    v_rcp_f32 v62, v62
    v_rcp_f32_e64 v63, v63
    v_pk_mul_f32 v[48:49], v[32:33], v[48:49]
    v_pk_mul_f32 v[50:51], v[34:35], v[50:51]
    v_pk_mul_f32 v[52:53], v[36:37], v[52:53]
    v_pk_mul_f32 v[54:55], v[38:39], v[54:55]
    v_pk_mul_f32 v[56:57], v[40:41], v[56:57]
    v_pk_mul_f32 v[58:59], v[42:43], v[58:59]
    v_pk_mul_f32 v[60:61], v[44:45], v[60:61]
    v_pk_mul_f32 v[62:63], v[46:47], v[62:63]
    v_pk_fma_f32 v[114:115], v[48:49], v[48:49], v[114:115]
    v_pk_fma_f32 v[114:115], v[50:51], v[50:51], v[114:115]
    v_pk_fma_f32 v[114:115], v[52:53], v[52:53], v[114:115]
    v_pk_fma_f32 v[114:115], v[54:55], v[54:55], v[114:115]
    v_pk_fma_f32 v[114:115], v[56:57], v[56:57], v[114:115]
    v_pk_fma_f32 v[114:115], v[58:59], v[58:59], v[114:115]
    v_pk_fma_f32 v[114:115], v[60:61], v[60:61], v[114:115]
    v_pk_fma_f32 v[114:115], v[62:63], v[62:63], v[114:115]
    v_pk_fma_f32 v[48:49], v[16:17], v[16:17], s[52:53]
    v_pk_fma_f32 v[50:51], v[18:19], v[18:19], s[52:53]
    v_pk_fma_f32 v[52:53], v[20:21], v[20:21], s[52:53]
    v_pk_fma_f32 v[54:55], v[22:23], v[22:23], s[52:53]
    v_pk_fma_f32 v[56:57], v[24:25], v[24:25], s[52:53]
    v_pk_fma_f32 v[58:59], v[26:27], v[26:27], s[52:53]
    v_pk_fma_f32 v[60:61], v[28:29], v[28:29], s[52:53]
    v_pk_fma_f32 v[62:63], v[30:31], v[30:31], s[52:53]
    v_pk_mul_f32 v[48:49], v[48:49], v[16:17] neg_lo:[1,0] neg_hi:[1,0]
    v_pk_mul_f32 v[50:51], v[50:51], v[18:19] neg_lo:[1,0] neg_hi:[1,0]
    v_pk_mul_f32 v[52:53], v[52:53], v[20:21] neg_lo:[1,0] neg_hi:[1,0]
    v_pk_mul_f32 v[54:55], v[54:55], v[22:23] neg_lo:[1,0] neg_hi:[1,0]
    v_pk_mul_f32 v[56:57], v[56:57], v[24:25] neg_lo:[1,0] neg_hi:[1,0]
    v_pk_mul_f32 v[58:59], v[58:59], v[26:27] neg_lo:[1,0] neg_hi:[1,0]
    v_pk_mul_f32 v[60:61], v[60:61], v[28:29] neg_lo:[1,0] neg_hi:[1,0]
    v_pk_mul_f32 v[62:63], v[62:63], v[30:31] neg_lo:[1,0] neg_hi:[1,0]
    s_waitcnt lgkmcnt(1)
    v_mfma_f32_32x32x16_bf16 v[32:47], v[72:75], v[232:235], 0
    v_exp_f32 v48, v48
    v_exp_f32 v49, v49
    v_exp_f32 v50, v50
    v_mfma_f32_32x32x16_bf16 v[32:47], v[76:79], v[236:239], v[32:47]
    v_exp_f32 v51, v51
    v_exp_f32 v52, v52
    v_exp_f32 v53, v53
    v_mfma_f32_32x32x16_bf16 v[32:47], v[80:83], v[240:243], v[32:47]
    v_exp_f32 v54, v54
    v_exp_f32 v55, v55
    v_exp_f32 v56, v56
    v_mfma_f32_32x32x16_bf16 v[32:47], v[84:87], v[244:247], v[32:47]
    v_exp_f32 v57, v57
    v_exp_f32 v58, v58
    v_exp_f32 v59, v59
    v_mfma_f32_32x32x16_bf16 v[144:159], a[16:19], a[240:243], 0
    ds_read_b128 a[12:15], v4 offset:19456
    ds_read_b128 a[16:19], v4 offset:20480
    v_exp_f32 v60, v60
    v_exp_f32 v61, v61
    v_mfma_f32_32x32x16_bf16 v[144:159], a[20:23], a[244:247], v[144:159]
    ds_write_b128 v123, v[140:143] offset:17408
    v_exp_f32 v62, v62
    v_exp_f32_e64 v63, v63
    v_pk_add_f32 v[48:49], v[48:49], 1.0 op_sel_hi:[1,0]
    v_pk_add_f32 v[50:51], v[50:51], 1.0 op_sel_hi:[1,0]
    v_pk_add_f32 v[52:53], v[52:53], 1.0 op_sel_hi:[1,0]
    v_pk_add_f32 v[54:55], v[54:55], 1.0 op_sel_hi:[1,0]
    v_pk_add_f32 v[56:57], v[56:57], 1.0 op_sel_hi:[1,0]
    v_pk_add_f32 v[58:59], v[58:59], 1.0 op_sel_hi:[1,0]
    v_pk_add_f32 v[60:61], v[60:61], 1.0 op_sel_hi:[1,0]
    v_pk_add_f32 v[62:63], v[62:63], 1.0 op_sel_hi:[1,0]
    v_pk_add_f32 v[8:9], v[8:9], v[144:145]
    v_pk_fma_f32 v[10:11], v[144:145], v[144:145], v[10:11]
    v_pk_add_f32 v[8:9], v[8:9], v[146:147]
    v_pk_fma_f32 v[10:11], v[146:147], v[146:147], v[10:11]
    v_pk_add_f32 v[8:9], v[8:9], v[148:149]
    v_pk_fma_f32 v[10:11], v[148:149], v[148:149], v[10:11]
    v_pk_add_f32 v[8:9], v[8:9], v[150:151]
    v_pk_fma_f32 v[10:11], v[150:151], v[150:151], v[10:11]
    v_pk_add_f32 v[8:9], v[8:9], v[152:153]
    v_pk_fma_f32 v[10:11], v[152:153], v[152:153], v[10:11]
    v_pk_add_f32 v[8:9], v[8:9], v[154:155]
    v_pk_fma_f32 v[10:11], v[154:155], v[154:155], v[10:11]
    v_pk_add_f32 v[8:9], v[8:9], v[156:157]
    v_pk_fma_f32 v[10:11], v[156:157], v[156:157], v[10:11]
    v_pk_add_f32 v[8:9], v[8:9], v[158:159]
    v_pk_fma_f32 v[10:11], v[158:159], v[158:159], v[10:11]
    v_mfma_f32_32x32x16_bf16 v[32:47], v[88:91], v[248:251], v[32:47]
    v_rcp_f32 v48, v48
    v_rcp_f32 v49, v49
    v_rcp_f32 v50, v50
    v_mfma_f32_32x32x16_bf16 v[32:47], v[92:95], v[252:255], v[32:47]
    v_rcp_f32 v51, v51
    v_rcp_f32 v52, v52
    v_rcp_f32 v53, v53
    v_mfma_f32_32x32x16_bf16 v[144:159], a[0:3], a[224:227], 0
    ds_read_b128 a[20:23], v4 offset:21504
    ds_read_b128 a[0:3], v2 offset:0
    v_rcp_f32 v54, v54
    v_rcp_f32 v55, v55
    v_mfma_f32_32x32x16_bf16 v[144:159], a[4:7], a[228:231], v[144:159]
    v_add_f32 v8, v8, v9
    v_add_f32 v10, v10, v11
    s_nop 1
    v_permlane32_swap_b32 v8, v10
    v_add_f32 v8, v8, v10
    v_mov_b32 v10, v8
    s_nop 1
    v_permlane32_swap_b32 v8, v10
    v_mul_f32 v8, 0x3c2aaaab, v8
    v_rcp_f32 v56, v56
    v_rcp_f32 v57, v57
    v_mul_f32 v10, 0x3c2aaaab, v10
    v_rcp_f32 v58, v58
    v_fma_f32 v10, -v8, v8, v10
    v_rcp_f32 v59, v59
    v_max_f32 v10, 0, v10
    v_rcp_f32 v60, v60
    v_add_f32 v10, 0x3727c5ac, v10
    v_rcp_f32 v61, v61
    v_rsq_f32 v10, v10
    v_rcp_f32 v62, v62
    v_mul_f32 v12, 0x3eeff558, v10
    v_rcp_f32 v63, v63
    v_mul_f32_e64 v13, -v8, v12
    v_pk_mul_f32 v[48:49], v[16:17], v[48:49]
    v_pk_mul_f32 v[50:51], v[18:19], v[50:51]
    v_pk_mul_f32 v[52:53], v[20:21], v[52:53]
    v_pk_mul_f32 v[54:55], v[22:23], v[54:55]
    v_pk_mul_f32 v[56:57], v[24:25], v[56:57]
    v_pk_mul_f32 v[58:59], v[26:27], v[58:59]
    v_pk_mul_f32 v[60:61], v[28:29], v[60:61]
    v_pk_mul_f32 v[62:63], v[30:31], v[62:63]
    v_pk_fma_f32 v[116:117], v[48:49], v[48:49], v[116:117]
    v_pk_fma_f32 v[116:117], v[50:51], v[50:51], v[116:117]
    v_pk_fma_f32 v[116:117], v[52:53], v[52:53], v[116:117]
    v_pk_fma_f32 v[116:117], v[54:55], v[54:55], v[116:117]
    v_pk_fma_f32 v[116:117], v[56:57], v[56:57], v[116:117]
    v_pk_fma_f32 v[116:117], v[58:59], v[58:59], v[116:117]
    v_pk_fma_f32 v[116:117], v[60:61], v[60:61], v[116:117]
    v_pk_fma_f32 v[116:117], v[62:63], v[62:63], v[116:117]
    v_pk_fma_f32 v[144:145], v[144:145], v[12:13], v[12:13] op_sel:[0,0,1] op_sel_hi:[1,0,1]
    v_pk_fma_f32 v[146:147], v[146:147], v[12:13], v[12:13] op_sel:[0,0,1] op_sel_hi:[1,0,1]
    v_pk_fma_f32 v[148:149], v[148:149], v[12:13], v[12:13] op_sel:[0,0,1] op_sel_hi:[1,0,1]
    v_pk_fma_f32 v[150:151], v[150:151], v[12:13], v[12:13] op_sel:[0,0,1] op_sel_hi:[1,0,1]
    v_pk_fma_f32 v[152:153], v[152:153], v[12:13], v[12:13] op_sel:[0,0,1] op_sel_hi:[1,0,1]
    v_pk_fma_f32 v[154:155], v[154:155], v[12:13], v[12:13] op_sel:[0,0,1] op_sel_hi:[1,0,1]
    v_pk_fma_f32 v[156:157], v[156:157], v[12:13], v[12:13] op_sel:[0,0,1] op_sel_hi:[1,0,1]
    v_pk_fma_f32 v[158:159], v[158:159], v[12:13], v[12:13] op_sel:[0,0,1] op_sel_hi:[1,0,1]
    v_cvt_pk_bf16_f32 v72, v144, v145
    v_cvt_pk_bf16_f32 v73, v146, v147
    v_cvt_pk_bf16_f32 v74, v148, v149
    v_cvt_pk_bf16_f32 v75, v150, v151
    v_cvt_pk_bf16_f32 v76, v152, v153
    v_cvt_pk_bf16_f32 v77, v154, v155
    v_cvt_pk_bf16_f32 v78, v156, v157
    v_cvt_pk_bf16_f32 v79, v158, v159
    v_pk_fma_f32 v[48:49], v[32:33], v[32:33], s[52:53]
    v_pk_fma_f32 v[50:51], v[34:35], v[34:35], s[52:53]
    v_pk_fma_f32 v[52:53], v[36:37], v[36:37], s[52:53]
    v_pk_fma_f32 v[54:55], v[38:39], v[38:39], s[52:53]
    v_pk_fma_f32 v[56:57], v[40:41], v[40:41], s[52:53]
    v_pk_fma_f32 v[58:59], v[42:43], v[42:43], s[52:53]
    v_pk_fma_f32 v[60:61], v[44:45], v[44:45], s[52:53]
    v_pk_fma_f32 v[62:63], v[46:47], v[46:47], s[52:53]
    v_pk_mul_f32 v[48:49], v[48:49], v[32:33] neg_lo:[1,0] neg_hi:[1,0]
    v_pk_mul_f32 v[50:51], v[50:51], v[34:35] neg_lo:[1,0] neg_hi:[1,0]
    v_pk_mul_f32 v[52:53], v[52:53], v[36:37] neg_lo:[1,0] neg_hi:[1,0]
    v_pk_mul_f32 v[54:55], v[54:55], v[38:39] neg_lo:[1,0] neg_hi:[1,0]
    v_pk_mul_f32 v[56:57], v[56:57], v[40:41] neg_lo:[1,0] neg_hi:[1,0]
    v_pk_mul_f32 v[58:59], v[58:59], v[42:43] neg_lo:[1,0] neg_hi:[1,0]
    v_pk_mul_f32 v[60:61], v[60:61], v[44:45] neg_lo:[1,0] neg_hi:[1,0]
    v_pk_mul_f32 v[62:63], v[62:63], v[46:47] neg_lo:[1,0] neg_hi:[1,0]
    v_mfma_f32_32x32x16_bf16 v[144:159], a[8:11], a[232:235], 0
    s_waitcnt lgkmcnt(4)
    ds_read_b128 a[4:7], v2 offset:1024
    ds_read_b128 a[8:11], v2 offset:2048
    v_exp_f32 v48, v48
    v_exp_f32 v49, v49
    v_mfma_f32_32x32x16_bf16 v[144:159], a[12:15], a[236:239], v[144:159]
    s_waitcnt lgkmcnt(5)
    v_exp_f32 v50, v50
    v_exp_f32 v51, v51
    v_exp_f32 v52, v52
    v_mfma_f32_32x32x16_bf16 v[16:31], a[16:19], a[240:243], 0
    s_waitcnt lgkmcnt(3)
    ds_read_b128 a[12:15], v2 offset:3072
    ds_read_b128 a[16:19], v2 offset:4096
    v_exp_f32 v53, v53
    v_exp_f32 v54, v54
    v_mfma_f32_32x32x16_bf16 v[16:31], a[20:23], a[244:247], v[16:31]
    s_waitcnt lgkmcnt(4)
    v_exp_f32 v55, v55
    v_exp_f32 v56, v56
    v_exp_f32 v57, v57
    v_exp_f32 v58, v58
    v_exp_f32 v59, v59
    v_exp_f32 v60, v60
    v_exp_f32 v61, v61
    v_exp_f32 v62, v62
    v_exp_f32 v63, v63
    v_pk_add_f32 v[48:49], v[48:49], 1.0 op_sel_hi:[1,0]
    v_pk_add_f32 v[50:51], v[50:51], 1.0 op_sel_hi:[1,0]
    v_pk_add_f32 v[52:53], v[52:53], 1.0 op_sel_hi:[1,0]
    v_pk_add_f32 v[54:55], v[54:55], 1.0 op_sel_hi:[1,0]
    v_pk_add_f32 v[56:57], v[56:57], 1.0 op_sel_hi:[1,0]
    v_pk_add_f32 v[58:59], v[58:59], 1.0 op_sel_hi:[1,0]
    v_pk_add_f32 v[60:61], v[60:61], 1.0 op_sel_hi:[1,0]
    v_pk_add_f32 v[62:63], v[62:63], 1.0 op_sel_hi:[1,0]
    v_pk_fma_f32 v[144:145], v[144:145], v[12:13], v[12:13] op_sel:[0,0,1] op_sel_hi:[1,0,1]
    v_pk_fma_f32 v[146:147], v[146:147], v[12:13], v[12:13] op_sel:[0,0,1] op_sel_hi:[1,0,1]
    v_pk_fma_f32 v[148:149], v[148:149], v[12:13], v[12:13] op_sel:[0,0,1] op_sel_hi:[1,0,1]
    v_pk_fma_f32 v[150:151], v[150:151], v[12:13], v[12:13] op_sel:[0,0,1] op_sel_hi:[1,0,1]
    v_pk_fma_f32 v[152:153], v[152:153], v[12:13], v[12:13] op_sel:[0,0,1] op_sel_hi:[1,0,1]
    v_pk_fma_f32 v[154:155], v[154:155], v[12:13], v[12:13] op_sel:[0,0,1] op_sel_hi:[1,0,1]
    v_pk_fma_f32 v[156:157], v[156:157], v[12:13], v[12:13] op_sel:[0,0,1] op_sel_hi:[1,0,1]
    v_pk_fma_f32 v[158:159], v[158:159], v[12:13], v[12:13] op_sel:[0,0,1] op_sel_hi:[1,0,1]
    v_cvt_pk_bf16_f32 v80, v144, v145
    v_cvt_pk_bf16_f32 v81, v146, v147
    v_cvt_pk_bf16_f32 v82, v148, v149
    v_cvt_pk_bf16_f32 v83, v150, v151
    v_cvt_pk_bf16_f32 v84, v152, v153
    v_cvt_pk_bf16_f32 v85, v154, v155
    v_cvt_pk_bf16_f32 v86, v156, v157
    v_cvt_pk_bf16_f32 v87, v158, v159
    v_pk_fma_f32 v[16:17], v[16:17], v[12:13], v[12:13] op_sel:[0,0,1] op_sel_hi:[1,0,1]
    v_pk_fma_f32 v[18:19], v[18:19], v[12:13], v[12:13] op_sel:[0,0,1] op_sel_hi:[1,0,1]
    v_pk_fma_f32 v[20:21], v[20:21], v[12:13], v[12:13] op_sel:[0,0,1] op_sel_hi:[1,0,1]
    v_pk_fma_f32 v[22:23], v[22:23], v[12:13], v[12:13] op_sel:[0,0,1] op_sel_hi:[1,0,1]
    v_pk_fma_f32 v[24:25], v[24:25], v[12:13], v[12:13] op_sel:[0,0,1] op_sel_hi:[1,0,1]
    v_pk_fma_f32 v[26:27], v[26:27], v[12:13], v[12:13] op_sel:[0,0,1] op_sel_hi:[1,0,1]
    v_pk_fma_f32 v[28:29], v[28:29], v[12:13], v[12:13] op_sel:[0,0,1] op_sel_hi:[1,0,1]
    v_pk_fma_f32 v[30:31], v[30:31], v[12:13], v[12:13] op_sel:[0,0,1] op_sel_hi:[1,0,1]
    v_cvt_pk_bf16_f32 v88, v16, v17
    v_cvt_pk_bf16_f32 v89, v18, v19
    v_cvt_pk_bf16_f32 v90, v20, v21
    v_cvt_pk_bf16_f32 v91, v22, v23
    v_cvt_pk_bf16_f32 v92, v24, v25
    v_cvt_pk_bf16_f32 v93, v26, v27
    v_cvt_pk_bf16_f32 v94, v28, v29
    v_cvt_pk_bf16_f32 v95, v30, v31
    v_mfma_f32_32x32x16_bf16 v[16:31], v[72:75], a[32:35], 0
    buffer_store_dwordx4 v[12:15], v2, s[44:47], s58 offen offset:1024 sc1
    s_add_u32 s54, s56, 49152
    v_rcp_f32 v48, v48
    v_rcp_f32 v49, v49
    v_mfma_f32_32x32x16_bf16 v[16:31], v[76:79], a[36:39], v[16:31]
    buffer_load_dwordx4 a[224:227], v1, s[24:27], s54 offen offset:0
    buffer_load_dwordx4 a[228:231], v1, s[24:27], s54 offen offset:32
    v_rcp_f32 v50, v50
    v_rcp_f32 v51, v51
    v_mfma_f32_32x32x16_bf16 v[16:31], v[80:83], a[40:43], v[16:31]
    buffer_load_dwordx4 a[232:235], v1, s[24:27], s54 offen offset:64
    buffer_load_dwordx4 a[236:239], v1, s[24:27], s54 offen offset:96
    v_rcp_f32 v52, v52
    v_rcp_f32 v53, v53
    v_mfma_f32_32x32x16_bf16 v[16:31], v[84:87], a[44:47], v[16:31]
    buffer_load_dwordx4 a[240:243], v1, s[24:27], s54 offen offset:128
    buffer_load_dwordx4 a[244:247], v1, s[24:27], s54 offen offset:160
    v_rcp_f32 v54, v54
    v_rcp_f32 v55, v55
    v_mfma_f32_32x32x16_bf16 v[16:31], v[88:91], a[48:51], v[16:31]
    v_rcp_f32 v56, v56
    v_rcp_f32 v57, v57
    v_rcp_f32 v58, v58
    v_mfma_f32_32x32x16_bf16 v[16:31], v[92:95], a[52:55], v[16:31]
    v_rcp_f32 v59, v59
    v_rcp_f32 v60, v60
    v_rcp_f32 v61, v61
    v_rcp_f32 v62, v62
    v_rcp_f32 v63, v63
    v_pk_mul_f32 v[48:49], v[32:33], v[48:49]
    v_pk_mul_f32 v[50:51], v[34:35], v[50:51]
    v_pk_mul_f32 v[52:53], v[36:37], v[52:53]
    v_pk_mul_f32 v[54:55], v[38:39], v[54:55]
    v_pk_mul_f32 v[56:57], v[40:41], v[56:57]
    v_pk_mul_f32 v[58:59], v[42:43], v[58:59]
    v_pk_mul_f32 v[60:61], v[44:45], v[60:61]
    v_pk_mul_f32 v[62:63], v[46:47], v[62:63]
    v_pk_fma_f32 v[118:119], v[48:49], v[48:49], v[118:119]
    v_pk_fma_f32 v[118:119], v[50:51], v[50:51], v[118:119]
    v_pk_fma_f32 v[118:119], v[52:53], v[52:53], v[118:119]
    v_pk_fma_f32 v[118:119], v[54:55], v[54:55], v[118:119]
    v_pk_fma_f32 v[118:119], v[56:57], v[56:57], v[118:119]
    v_pk_fma_f32 v[118:119], v[58:59], v[58:59], v[118:119]
    v_pk_fma_f32 v[118:119], v[60:61], v[60:61], v[118:119]
    v_pk_fma_f32 v[118:119], v[62:63], v[62:63], v[118:119]
    v_pk_fma_f32 v[48:49], v[16:17], v[16:17], s[52:53]
    v_pk_fma_f32 v[50:51], v[18:19], v[18:19], s[52:53]
    v_pk_fma_f32 v[52:53], v[20:21], v[20:21], s[52:53]
    v_pk_fma_f32 v[54:55], v[22:23], v[22:23], s[52:53]
    v_pk_fma_f32 v[56:57], v[24:25], v[24:25], s[52:53]
    v_pk_fma_f32 v[58:59], v[26:27], v[26:27], s[52:53]
    v_pk_fma_f32 v[60:61], v[28:29], v[28:29], s[52:53]
    v_pk_fma_f32 v[62:63], v[30:31], v[30:31], s[52:53]
    v_pk_mul_f32 v[48:49], v[48:49], v[16:17] neg_lo:[1,0] neg_hi:[1,0]
    v_pk_mul_f32 v[50:51], v[50:51], v[18:19] neg_lo:[1,0] neg_hi:[1,0]
    v_pk_mul_f32 v[52:53], v[52:53], v[20:21] neg_lo:[1,0] neg_hi:[1,0]
    v_pk_mul_f32 v[54:55], v[54:55], v[22:23] neg_lo:[1,0] neg_hi:[1,0]
    v_pk_mul_f32 v[56:57], v[56:57], v[24:25] neg_lo:[1,0] neg_hi:[1,0]
    v_pk_mul_f32 v[58:59], v[58:59], v[26:27] neg_lo:[1,0] neg_hi:[1,0]
    v_pk_mul_f32 v[60:61], v[60:61], v[28:29] neg_lo:[1,0] neg_hi:[1,0]
    v_pk_mul_f32 v[62:63], v[62:63], v[30:31] neg_lo:[1,0] neg_hi:[1,0]
    v_lshlrev_b32 v124, 4, v0
    v_add_u32 v124, 161664, v124
    v_cmp_gt_u32 vcc, 48, v0
    s_nop 4
    s_and_saveexec_b64 s[64:65], vcc
    s_waitcnt vmcnt(10)
    ds_write_b128 v124, v[132:135]
    s_mov_b64 exec, s[64:65]
    v_mov_b32 v125, 1
    s_waitcnt lgkmcnt(0)
    s_barrier
    s_and_b32 s67, s2, 3
    s_mul_i32 s67, s67, 64
    s_cmp_eq_u32 s57, 0
    s_cselect_b32 s67, s67, 256
    v_mov_b32 v135, 1
    v_mfma_f32_32x32x16_bf16 v[32:47], v[72:75], a[56:59], 0
    v_exp_f32 v48, v48
    v_exp_f32 v49, v49
    v_exp_f32 v50, v50
    v_mfma_f32_32x32x16_bf16 v[32:47], v[76:79], a[60:63], v[32:47]
    v_exp_f32 v51, v51
    v_exp_f32 v52, v52
    v_exp_f32 v53, v53
    v_exp_f32 v54, v54
    v_exp_f32 v55, v55
    v_exp_f32 v56, v56
    v_exp_f32 v57, v57
    v_exp_f32 v58, v58
    v_exp_f32 v59, v59
    v_exp_f32 v60, v60
    v_exp_f32 v61, v61
    v_exp_f32 v62, v62
    v_exp_f32_e64 v63, v63
    v_pk_add_f32 v[48:49], v[48:49], 1.0 op_sel_hi:[1,0]
    v_pk_add_f32 v[50:51], v[50:51], 1.0 op_sel_hi:[1,0]
    v_pk_add_f32 v[52:53], v[52:53], 1.0 op_sel_hi:[1,0]
    v_pk_add_f32 v[54:55], v[54:55], 1.0 op_sel_hi:[1,0]
    v_pk_add_f32 v[56:57], v[56:57], 1.0 op_sel_hi:[1,0]
    v_pk_add_f32 v[58:59], v[58:59], 1.0 op_sel_hi:[1,0]
    v_pk_add_f32 v[60:61], v[60:61], 1.0 op_sel_hi:[1,0]
    v_pk_add_f32 v[62:63], v[62:63], 1.0 op_sel_hi:[1,0]
    v_mfma_f32_32x32x16_bf16 v[32:47], v[80:83], a[64:67], v[32:47]
    v_rcp_f32 v48, v48
    v_rcp_f32 v49, v49
    v_rcp_f32 v50, v50
    v_mfma_f32_32x32x16_bf16 v[32:47], v[84:87], a[68:71], v[32:47]
    v_rcp_f32 v51, v51
    v_rcp_f32 v52, v52
    v_rcp_f32 v53, v53
    v_mfma_f32_32x32x16_bf16 v[32:47], v[88:91], a[72:75], v[32:47]
    v_rcp_f32 v54, v54
    v_rcp_f32 v55, v55
    v_rcp_f32 v56, v56
    v_mfma_f32_32x32x16_bf16 v[32:47], v[92:95], a[76:79], v[32:47]
    v_rcp_f32 v57, v57
    v_rcp_f32 v58, v58
    v_rcp_f32 v59, v59
    v_rcp_f32 v60, v60
    v_rcp_f32 v61, v61
    v_rcp_f32 v62, v62
    v_rcp_f32 v63, v63
    v_pk_mul_f32 v[48:49], v[16:17], v[48:49]
    v_pk_mul_f32 v[50:51], v[18:19], v[50:51]
    v_pk_mul_f32 v[52:53], v[20:21], v[52:53]
    v_pk_mul_f32 v[54:55], v[22:23], v[54:55]
    v_pk_mul_f32 v[56:57], v[24:25], v[56:57]
    v_pk_mul_f32 v[58:59], v[26:27], v[58:59]
    v_pk_mul_f32 v[60:61], v[28:29], v[60:61]
    v_pk_mul_f32 v[62:63], v[30:31], v[62:63]
    v_pk_fma_f32 v[96:97], v[48:49], v[48:49], v[96:97]
    v_pk_fma_f32 v[96:97], v[50:51], v[50:51], v[96:97]
    v_pk_fma_f32 v[96:97], v[52:53], v[52:53], v[96:97]
    v_pk_fma_f32 v[96:97], v[54:55], v[54:55], v[96:97]
    v_pk_fma_f32 v[96:97], v[56:57], v[56:57], v[96:97]
    v_pk_fma_f32 v[96:97], v[58:59], v[58:59], v[96:97]
    v_pk_fma_f32 v[96:97], v[60:61], v[60:61], v[96:97]
    v_pk_fma_f32 v[96:97], v[62:63], v[62:63], v[96:97]
    v_pk_fma_f32 v[48:49], v[32:33], v[32:33], s[52:53]
    v_pk_fma_f32 v[50:51], v[34:35], v[34:35], s[52:53]
    v_pk_fma_f32 v[52:53], v[36:37], v[36:37], s[52:53]
    v_pk_fma_f32 v[54:55], v[38:39], v[38:39], s[52:53]
    v_pk_fma_f32 v[56:57], v[40:41], v[40:41], s[52:53]
    v_pk_fma_f32 v[58:59], v[42:43], v[42:43], s[52:53]
    v_pk_fma_f32 v[60:61], v[44:45], v[44:45], s[52:53]
    v_pk_fma_f32 v[62:63], v[46:47], v[46:47], s[52:53]
    v_pk_mul_f32 v[48:49], v[48:49], v[32:33] neg_lo:[1,0] neg_hi:[1,0]
    v_pk_mul_f32 v[50:51], v[50:51], v[34:35] neg_lo:[1,0] neg_hi:[1,0]
    v_pk_mul_f32 v[52:53], v[52:53], v[36:37] neg_lo:[1,0] neg_hi:[1,0]
    v_pk_mul_f32 v[54:55], v[54:55], v[38:39] neg_lo:[1,0] neg_hi:[1,0]
    v_pk_mul_f32 v[56:57], v[56:57], v[40:41] neg_lo:[1,0] neg_hi:[1,0]
    v_pk_mul_f32 v[58:59], v[58:59], v[42:43] neg_lo:[1,0] neg_hi:[1,0]
    v_pk_mul_f32 v[60:61], v[60:61], v[44:45] neg_lo:[1,0] neg_hi:[1,0]
    v_pk_mul_f32 v[62:63], v[62:63], v[46:47] neg_lo:[1,0] neg_hi:[1,0]
    v_mfma_f32_32x32x16_bf16 v[16:31], v[72:75], a[80:83], 0
    v_exp_f32 v48, v48
    v_exp_f32 v49, v49
    v_exp_f32 v50, v50
    v_mfma_f32_32x32x16_bf16 v[16:31], v[76:79], a[84:87], v[16:31]
    v_exp_f32 v51, v51
    v_exp_f32 v52, v52
    v_exp_f32 v53, v53
    v_exp_f32 v54, v54
    v_exp_f32 v55, v55
    v_exp_f32 v56, v56
    v_exp_f32 v57, v57
    v_exp_f32 v58, v58
    v_exp_f32 v59, v59
    v_exp_f32 v60, v60
    v_exp_f32 v61, v61
    v_exp_f32 v62, v62
    v_exp_f32 v63, v63
    v_pk_add_f32 v[48:49], v[48:49], 1.0 op_sel_hi:[1,0]
    v_pk_add_f32 v[50:51], v[50:51], 1.0 op_sel_hi:[1,0]
    v_pk_add_f32 v[52:53], v[52:53], 1.0 op_sel_hi:[1,0]
    v_pk_add_f32 v[54:55], v[54:55], 1.0 op_sel_hi:[1,0]
    v_pk_add_f32 v[56:57], v[56:57], 1.0 op_sel_hi:[1,0]
    v_pk_add_f32 v[58:59], v[58:59], 1.0 op_sel_hi:[1,0]
    v_pk_add_f32 v[60:61], v[60:61], 1.0 op_sel_hi:[1,0]
    v_pk_add_f32 v[62:63], v[62:63], 1.0 op_sel_hi:[1,0]
    v_mfma_f32_32x32x16_bf16 v[16:31], v[80:83], a[88:91], v[16:31]
    v_rcp_f32 v48, v48
    v_rcp_f32 v49, v49
    v_rcp_f32 v50, v50
    v_mfma_f32_32x32x16_bf16 v[16:31], v[84:87], a[92:95], v[16:31]
    v_rcp_f32 v51, v51
    v_rcp_f32 v52, v52
    v_rcp_f32 v53, v53
    v_mfma_f32_32x32x16_bf16 v[16:31], v[88:91], a[96:99], v[16:31]
    v_rcp_f32 v54, v54
    v_rcp_f32 v55, v55
    v_rcp_f32 v56, v56
    v_mfma_f32_32x32x16_bf16 v[16:31], v[92:95], a[100:103], v[16:31]
    v_rcp_f32 v57, v57
    v_rcp_f32 v58, v58
    v_rcp_f32 v59, v59
    v_rcp_f32 v60, v60
    v_rcp_f32 v61, v61
    v_rcp_f32 v62, v62
    v_rcp_f32 v63, v63
    v_pk_mul_f32 v[48:49], v[32:33], v[48:49]
    v_pk_mul_f32 v[50:51], v[34:35], v[50:51]
    v_pk_mul_f32 v[52:53], v[36:37], v[52:53]
    v_pk_mul_f32 v[54:55], v[38:39], v[54:55]
    v_pk_mul_f32 v[56:57], v[40:41], v[56:57]
    v_pk_mul_f32 v[58:59], v[42:43], v[58:59]
    v_pk_mul_f32 v[60:61], v[44:45], v[60:61]
    v_pk_mul_f32 v[62:63], v[46:47], v[62:63]
    v_pk_fma_f32 v[98:99], v[48:49], v[48:49], v[98:99]
    v_pk_fma_f32 v[98:99], v[50:51], v[50:51], v[98:99]
    v_pk_fma_f32 v[98:99], v[52:53], v[52:53], v[98:99]
    v_pk_fma_f32 v[98:99], v[54:55], v[54:55], v[98:99]
    v_pk_fma_f32 v[98:99], v[56:57], v[56:57], v[98:99]
    v_pk_fma_f32 v[98:99], v[58:59], v[58:59], v[98:99]
    v_pk_fma_f32 v[98:99], v[60:61], v[60:61], v[98:99]
    v_pk_fma_f32 v[98:99], v[62:63], v[62:63], v[98:99]
    v_pk_fma_f32 v[48:49], v[16:17], v[16:17], s[52:53]
    v_pk_fma_f32 v[50:51], v[18:19], v[18:19], s[52:53]
    v_pk_fma_f32 v[52:53], v[20:21], v[20:21], s[52:53]
    v_pk_fma_f32 v[54:55], v[22:23], v[22:23], s[52:53]
    v_pk_fma_f32 v[56:57], v[24:25], v[24:25], s[52:53]
    v_pk_fma_f32 v[58:59], v[26:27], v[26:27], s[52:53]
    v_pk_fma_f32 v[60:61], v[28:29], v[28:29], s[52:53]
    v_pk_fma_f32 v[62:63], v[30:31], v[30:31], s[52:53]
    v_pk_mul_f32 v[48:49], v[48:49], v[16:17] neg_lo:[1,0] neg_hi:[1,0]
    v_pk_mul_f32 v[50:51], v[50:51], v[18:19] neg_lo:[1,0] neg_hi:[1,0]
    v_pk_mul_f32 v[52:53], v[52:53], v[20:21] neg_lo:[1,0] neg_hi:[1,0]
    v_pk_mul_f32 v[54:55], v[54:55], v[22:23] neg_lo:[1,0] neg_hi:[1,0]
    v_pk_mul_f32 v[56:57], v[56:57], v[24:25] neg_lo:[1,0] neg_hi:[1,0]
    v_pk_mul_f32 v[58:59], v[58:59], v[26:27] neg_lo:[1,0] neg_hi:[1,0]
    v_pk_mul_f32 v[60:61], v[60:61], v[28:29] neg_lo:[1,0] neg_hi:[1,0]
    v_pk_mul_f32 v[62:63], v[62:63], v[30:31] neg_lo:[1,0] neg_hi:[1,0]
    v_mfma_f32_32x32x16_bf16 v[32:47], v[72:75], a[104:107], 0
    v_exp_f32 v48, v48
    v_exp_f32 v49, v49
    v_exp_f32 v50, v50
    v_mfma_f32_32x32x16_bf16 v[32:47], v[76:79], a[108:111], v[32:47]
    v_exp_f32 v51, v51
    v_exp_f32 v52, v52
    v_exp_f32 v53, v53
    v_exp_f32 v54, v54
    v_exp_f32 v55, v55
    v_exp_f32 v56, v56
    v_exp_f32 v57, v57
    v_exp_f32 v58, v58
    v_exp_f32 v59, v59
    v_exp_f32 v60, v60
    v_exp_f32 v61, v61
    v_exp_f32 v62, v62
    v_exp_f32 v63, v63
    v_pk_add_f32 v[48:49], v[48:49], 1.0 op_sel_hi:[1,0]
    v_pk_add_f32 v[50:51], v[50:51], 1.0 op_sel_hi:[1,0]
    v_pk_add_f32 v[52:53], v[52:53], 1.0 op_sel_hi:[1,0]
    v_pk_add_f32 v[54:55], v[54:55], 1.0 op_sel_hi:[1,0]
    v_pk_add_f32 v[56:57], v[56:57], 1.0 op_sel_hi:[1,0]
    v_pk_add_f32 v[58:59], v[58:59], 1.0 op_sel_hi:[1,0]
    v_pk_add_f32 v[60:61], v[60:61], 1.0 op_sel_hi:[1,0]
    v_pk_add_f32 v[62:63], v[62:63], 1.0 op_sel_hi:[1,0]
    v_mfma_f32_32x32x16_bf16 v[32:47], v[80:83], a[112:115], v[32:47]
    v_rcp_f32 v48, v48
    v_rcp_f32 v49, v49
    v_rcp_f32 v50, v50
    v_mfma_f32_32x32x16_bf16 v[32:47], v[84:87], a[116:119], v[32:47]
    v_rcp_f32 v51, v51
    v_rcp_f32 v52, v52
    v_rcp_f32 v53, v53
    v_mfma_f32_32x32x16_bf16 v[32:47], v[88:91], a[120:123], v[32:47]
    v_rcp_f32 v54, v54
    v_rcp_f32 v55, v55
    v_rcp_f32 v56, v56
    v_mfma_f32_32x32x16_bf16 v[32:47], v[92:95], a[124:127], v[32:47]
    v_rcp_f32 v57, v57
    v_rcp_f32 v58, v58
    v_rcp_f32 v59, v59
    v_rcp_f32 v60, v60
    v_rcp_f32 v61, v61
    v_rcp_f32 v62, v62
    v_rcp_f32 v63, v63
    v_pk_mul_f32 v[48:49], v[16:17], v[48:49]
    v_pk_mul_f32 v[50:51], v[18:19], v[50:51]
    v_pk_mul_f32 v[52:53], v[20:21], v[52:53]
    v_pk_mul_f32 v[54:55], v[22:23], v[54:55]
    v_pk_mul_f32 v[56:57], v[24:25], v[56:57]
    v_pk_mul_f32 v[58:59], v[26:27], v[58:59]
    v_pk_mul_f32 v[60:61], v[28:29], v[60:61]
    v_pk_mul_f32 v[62:63], v[30:31], v[62:63]
    v_pk_fma_f32 v[100:101], v[48:49], v[48:49], v[100:101]
    v_pk_fma_f32 v[100:101], v[50:51], v[50:51], v[100:101]
    v_pk_fma_f32 v[100:101], v[52:53], v[52:53], v[100:101]
    v_pk_fma_f32 v[100:101], v[54:55], v[54:55], v[100:101]
    v_pk_fma_f32 v[100:101], v[56:57], v[56:57], v[100:101]
    v_pk_fma_f32 v[100:101], v[58:59], v[58:59], v[100:101]
    v_pk_fma_f32 v[100:101], v[60:61], v[60:61], v[100:101]
    v_pk_fma_f32 v[100:101], v[62:63], v[62:63], v[100:101]
    v_pk_fma_f32 v[48:49], v[32:33], v[32:33], s[52:53]
    v_pk_fma_f32 v[50:51], v[34:35], v[34:35], s[52:53]
    v_pk_fma_f32 v[52:53], v[36:37], v[36:37], s[52:53]
    v_pk_fma_f32 v[54:55], v[38:39], v[38:39], s[52:53]
    v_pk_fma_f32 v[56:57], v[40:41], v[40:41], s[52:53]
    v_pk_fma_f32 v[58:59], v[42:43], v[42:43], s[52:53]
    v_pk_fma_f32 v[60:61], v[44:45], v[44:45], s[52:53]
    v_pk_fma_f32 v[62:63], v[46:47], v[46:47], s[52:53]
    v_pk_mul_f32 v[48:49], v[48:49], v[32:33] neg_lo:[1,0] neg_hi:[1,0]
    v_pk_mul_f32 v[50:51], v[50:51], v[34:35] neg_lo:[1,0] neg_hi:[1,0]
    v_pk_mul_f32 v[52:53], v[52:53], v[36:37] neg_lo:[1,0] neg_hi:[1,0]
    v_pk_mul_f32 v[54:55], v[54:55], v[38:39] neg_lo:[1,0] neg_hi:[1,0]
    v_pk_mul_f32 v[56:57], v[56:57], v[40:41] neg_lo:[1,0] neg_hi:[1,0]
    v_pk_mul_f32 v[58:59], v[58:59], v[42:43] neg_lo:[1,0] neg_hi:[1,0]
    v_pk_mul_f32 v[60:61], v[60:61], v[44:45] neg_lo:[1,0] neg_hi:[1,0]
    v_pk_mul_f32 v[62:63], v[62:63], v[46:47] neg_lo:[1,0] neg_hi:[1,0]
    v_mfma_f32_32x32x16_bf16 v[16:31], v[72:75], a[128:131], 0
    v_exp_f32 v48, v48
    v_exp_f32 v49, v49
    v_exp_f32 v50, v50
    v_mfma_f32_32x32x16_bf16 v[16:31], v[76:79], a[132:135], v[16:31]
    v_exp_f32 v51, v51
    v_exp_f32 v52, v52
    v_exp_f32 v53, v53
    v_exp_f32 v54, v54
    v_exp_f32 v55, v55
    v_exp_f32 v56, v56
    v_exp_f32 v57, v57
    v_exp_f32 v58, v58
    v_exp_f32 v59, v59
    v_exp_f32 v60, v60
    v_exp_f32 v61, v61
    v_exp_f32 v62, v62
    v_exp_f32 v63, v63
    v_pk_add_f32 v[48:49], v[48:49], 1.0 op_sel_hi:[1,0]
    v_pk_add_f32 v[50:51], v[50:51], 1.0 op_sel_hi:[1,0]
    v_pk_add_f32 v[52:53], v[52:53], 1.0 op_sel_hi:[1,0]
    v_pk_add_f32 v[54:55], v[54:55], 1.0 op_sel_hi:[1,0]
    v_pk_add_f32 v[56:57], v[56:57], 1.0 op_sel_hi:[1,0]
    v_pk_add_f32 v[58:59], v[58:59], 1.0 op_sel_hi:[1,0]
    v_pk_add_f32 v[60:61], v[60:61], 1.0 op_sel_hi:[1,0]
    v_pk_add_f32 v[62:63], v[62:63], 1.0 op_sel_hi:[1,0]
    v_mfma_f32_32x32x16_bf16 v[16:31], v[80:83], a[136:139], v[16:31]
    v_rcp_f32 v48, v48
    v_rcp_f32 v49, v49
    v_rcp_f32 v50, v50
    v_mfma_f32_32x32x16_bf16 v[16:31], v[84:87], a[140:143], v[16:31]
    v_rcp_f32 v51, v51
    v_rcp_f32 v52, v52
    v_rcp_f32 v53, v53
    v_mfma_f32_32x32x16_bf16 v[16:31], v[88:91], a[144:147], v[16:31]
    v_rcp_f32 v54, v54
    v_rcp_f32 v55, v55
    v_rcp_f32 v56, v56
    v_mfma_f32_32x32x16_bf16 v[16:31], v[92:95], a[148:151], v[16:31]
    v_rcp_f32 v57, v57
    v_rcp_f32 v58, v58
    v_rcp_f32 v59, v59
    v_rcp_f32 v60, v60
    v_rcp_f32 v61, v61
    v_rcp_f32 v62, v62
    v_rcp_f32 v63, v63
    v_pk_mul_f32 v[48:49], v[32:33], v[48:49]
    v_pk_mul_f32 v[50:51], v[34:35], v[50:51]
    v_pk_mul_f32 v[52:53], v[36:37], v[52:53]
    v_pk_mul_f32 v[54:55], v[38:39], v[54:55]
    v_pk_mul_f32 v[56:57], v[40:41], v[56:57]
    v_pk_mul_f32 v[58:59], v[42:43], v[58:59]
    v_pk_mul_f32 v[60:61], v[44:45], v[60:61]
    v_pk_mul_f32 v[62:63], v[46:47], v[62:63]
    v_pk_fma_f32 v[102:103], v[48:49], v[48:49], v[102:103]
    v_pk_fma_f32 v[102:103], v[50:51], v[50:51], v[102:103]
    v_pk_fma_f32 v[102:103], v[52:53], v[52:53], v[102:103]
    v_pk_fma_f32 v[102:103], v[54:55], v[54:55], v[102:103]
    v_pk_fma_f32 v[102:103], v[56:57], v[56:57], v[102:103]
    v_pk_fma_f32 v[102:103], v[58:59], v[58:59], v[102:103]
    v_pk_fma_f32 v[102:103], v[60:61], v[60:61], v[102:103]
    v_pk_fma_f32 v[102:103], v[62:63], v[62:63], v[102:103]
    v_pk_fma_f32 v[48:49], v[16:17], v[16:17], s[52:53]
    v_pk_fma_f32 v[50:51], v[18:19], v[18:19], s[52:53]
    v_pk_fma_f32 v[52:53], v[20:21], v[20:21], s[52:53]
    v_pk_fma_f32 v[54:55], v[22:23], v[22:23], s[52:53]
    v_pk_fma_f32 v[56:57], v[24:25], v[24:25], s[52:53]
    v_pk_fma_f32 v[58:59], v[26:27], v[26:27], s[52:53]
    v_pk_fma_f32 v[60:61], v[28:29], v[28:29], s[52:53]
    v_pk_fma_f32 v[62:63], v[30:31], v[30:31], s[52:53]
    v_pk_mul_f32 v[48:49], v[48:49], v[16:17] neg_lo:[1,0] neg_hi:[1,0]
    v_pk_mul_f32 v[50:51], v[50:51], v[18:19] neg_lo:[1,0] neg_hi:[1,0]
    v_pk_mul_f32 v[52:53], v[52:53], v[20:21] neg_lo:[1,0] neg_hi:[1,0]
    v_pk_mul_f32 v[54:55], v[54:55], v[22:23] neg_lo:[1,0] neg_hi:[1,0]
    v_pk_mul_f32 v[56:57], v[56:57], v[24:25] neg_lo:[1,0] neg_hi:[1,0]
    v_pk_mul_f32 v[58:59], v[58:59], v[26:27] neg_lo:[1,0] neg_hi:[1,0]
    v_pk_mul_f32 v[60:61], v[60:61], v[28:29] neg_lo:[1,0] neg_hi:[1,0]
    v_pk_mul_f32 v[62:63], v[62:63], v[30:31] neg_lo:[1,0] neg_hi:[1,0]
    v_mfma_f32_32x32x16_bf16 v[32:47], v[72:75], a[152:155], 0
    v_exp_f32 v48, v48
    v_exp_f32 v49, v49
    v_exp_f32 v50, v50
    v_mfma_f32_32x32x16_bf16 v[32:47], v[76:79], a[156:159], v[32:47]
    v_exp_f32 v51, v51
    v_exp_f32 v52, v52
    v_exp_f32 v53, v53
    v_exp_f32 v54, v54
    v_exp_f32 v55, v55
    v_exp_f32 v56, v56
    v_exp_f32 v57, v57
    v_exp_f32 v58, v58
    v_exp_f32 v59, v59
    v_exp_f32 v60, v60
    v_exp_f32 v61, v61
    v_exp_f32 v62, v62
    v_exp_f32 v63, v63
    v_pk_add_f32 v[48:49], v[48:49], 1.0 op_sel_hi:[1,0]
    v_pk_add_f32 v[50:51], v[50:51], 1.0 op_sel_hi:[1,0]
    v_pk_add_f32 v[52:53], v[52:53], 1.0 op_sel_hi:[1,0]
    v_pk_add_f32 v[54:55], v[54:55], 1.0 op_sel_hi:[1,0]
    v_pk_add_f32 v[56:57], v[56:57], 1.0 op_sel_hi:[1,0]
    v_pk_add_f32 v[58:59], v[58:59], 1.0 op_sel_hi:[1,0]
    v_pk_add_f32 v[60:61], v[60:61], 1.0 op_sel_hi:[1,0]
    v_pk_add_f32 v[62:63], v[62:63], 1.0 op_sel_hi:[1,0]
    v_mfma_f32_32x32x16_bf16 v[32:47], v[80:83], a[160:163], v[32:47]
    v_rcp_f32 v48, v48
    v_rcp_f32 v49, v49
    v_rcp_f32 v50, v50
    v_mfma_f32_32x32x16_bf16 v[32:47], v[84:87], a[164:167], v[32:47]
    v_rcp_f32 v51, v51
    v_rcp_f32 v52, v52
    v_rcp_f32 v53, v53
    v_mfma_f32_32x32x16_bf16 v[32:47], v[88:91], a[168:171], v[32:47]
    v_rcp_f32 v54, v54
    v_rcp_f32 v55, v55
    v_rcp_f32 v56, v56
    v_mfma_f32_32x32x16_bf16 v[32:47], v[92:95], a[172:175], v[32:47]
    v_rcp_f32 v57, v57
    v_rcp_f32 v58, v58
    v_rcp_f32 v59, v59
    v_rcp_f32 v60, v60
    v_rcp_f32 v61, v61
    v_rcp_f32 v62, v62
    v_rcp_f32 v63, v63
    v_pk_mul_f32 v[48:49], v[16:17], v[48:49]
    v_pk_mul_f32 v[50:51], v[18:19], v[50:51]
    v_pk_mul_f32 v[52:53], v[20:21], v[52:53]
    v_pk_mul_f32 v[54:55], v[22:23], v[54:55]
    v_pk_mul_f32 v[56:57], v[24:25], v[56:57]
    v_pk_mul_f32 v[58:59], v[26:27], v[58:59]
    v_pk_mul_f32 v[60:61], v[28:29], v[60:61]
    v_pk_mul_f32 v[62:63], v[30:31], v[62:63]
    v_pk_fma_f32 v[104:105], v[48:49], v[48:49], v[104:105]
    v_pk_fma_f32 v[104:105], v[50:51], v[50:51], v[104:105]
    v_pk_fma_f32 v[104:105], v[52:53], v[52:53], v[104:105]
    v_pk_fma_f32 v[104:105], v[54:55], v[54:55], v[104:105]
    v_pk_fma_f32 v[104:105], v[56:57], v[56:57], v[104:105]
    v_pk_fma_f32 v[104:105], v[58:59], v[58:59], v[104:105]
    v_pk_fma_f32 v[104:105], v[60:61], v[60:61], v[104:105]
    v_pk_fma_f32 v[104:105], v[62:63], v[62:63], v[104:105]
    v_pk_fma_f32 v[48:49], v[32:33], v[32:33], s[52:53]
    v_pk_fma_f32 v[50:51], v[34:35], v[34:35], s[52:53]
    v_pk_fma_f32 v[52:53], v[36:37], v[36:37], s[52:53]
    v_pk_fma_f32 v[54:55], v[38:39], v[38:39], s[52:53]
    v_pk_fma_f32 v[56:57], v[40:41], v[40:41], s[52:53]
    v_pk_fma_f32 v[58:59], v[42:43], v[42:43], s[52:53]
    v_pk_fma_f32 v[60:61], v[44:45], v[44:45], s[52:53]
    v_pk_fma_f32 v[62:63], v[46:47], v[46:47], s[52:53]
    v_pk_mul_f32 v[48:49], v[48:49], v[32:33] neg_lo:[1,0] neg_hi:[1,0]
    v_pk_mul_f32 v[50:51], v[50:51], v[34:35] neg_lo:[1,0] neg_hi:[1,0]
    v_pk_mul_f32 v[52:53], v[52:53], v[36:37] neg_lo:[1,0] neg_hi:[1,0]
    v_pk_mul_f32 v[54:55], v[54:55], v[38:39] neg_lo:[1,0] neg_hi:[1,0]
    v_pk_mul_f32 v[56:57], v[56:57], v[40:41] neg_lo:[1,0] neg_hi:[1,0]
    v_pk_mul_f32 v[58:59], v[58:59], v[42:43] neg_lo:[1,0] neg_hi:[1,0]
    v_pk_mul_f32 v[60:61], v[60:61], v[44:45] neg_lo:[1,0] neg_hi:[1,0]
    v_pk_mul_f32 v[62:63], v[62:63], v[46:47] neg_lo:[1,0] neg_hi:[1,0]
L_pf3:
    v_mfma_f32_32x32x16_bf16 v[16:31], v[72:75], a[176:179], 0
    s_mov_b32 s63, L_pf3-L_pc+12288
    buffer_load_dword v6, v7, s[68:71], s63 offen
    v_exp_f32 v48, v48
    v_exp_f32 v49, v49
    v_exp_f32 v50, v50
    v_mfma_f32_32x32x16_bf16 v[16:31], v[76:79], a[180:183], v[16:31]
    v_exp_f32 v51, v51
    v_exp_f32 v52, v52
    v_exp_f32 v53, v53
    v_exp_f32 v54, v54
    v_exp_f32 v55, v55
    v_exp_f32 v56, v56
    v_exp_f32 v57, v57
    v_exp_f32 v58, v58
    v_exp_f32 v59, v59
    v_exp_f32 v60, v60
    v_exp_f32 v61, v61
    v_exp_f32 v62, v62
    v_exp_f32 v63, v63
    v_pk_add_f32 v[48:49], v[48:49], 1.0 op_sel_hi:[1,0]
    v_pk_add_f32 v[50:51], v[50:51], 1.0 op_sel_hi:[1,0]
    v_pk_add_f32 v[52:53], v[52:53], 1.0 op_sel_hi:[1,0]
    v_pk_add_f32 v[54:55], v[54:55], 1.0 op_sel_hi:[1,0]
    v_pk_add_f32 v[56:57], v[56:57], 1.0 op_sel_hi:[1,0]
    v_pk_add_f32 v[58:59], v[58:59], 1.0 op_sel_hi:[1,0]
    v_pk_add_f32 v[60:61], v[60:61], 1.0 op_sel_hi:[1,0]
    v_pk_add_f32 v[62:63], v[62:63], 1.0 op_sel_hi:[1,0]
    v_mfma_f32_32x32x16_bf16 v[16:31], v[80:83], a[184:187], v[16:31]
    v_rcp_f32 v48, v48
    v_rcp_f32 v49, v49
    v_rcp_f32 v50, v50
    v_mfma_f32_32x32x16_bf16 v[16:31], v[84:87], a[188:191], v[16:31]
    v_rcp_f32 v51, v51
    v_rcp_f32 v52, v52
    v_rcp_f32 v53, v53
    v_mfma_f32_32x32x16_bf16 v[16:31], v[88:91], a[192:195], v[16:31]
    v_rcp_f32 v54, v54
    v_rcp_f32 v55, v55
    v_rcp_f32 v56, v56
    v_mfma_f32_32x32x16_bf16 v[16:31], v[92:95], a[196:199], v[16:31]
    v_rcp_f32 v57, v57
    v_rcp_f32 v58, v58
    v_rcp_f32 v59, v59
    v_rcp_f32 v60, v60
    v_rcp_f32 v61, v61
    v_rcp_f32 v62, v62
    v_rcp_f32 v63, v63
    v_pk_mul_f32 v[48:49], v[32:33], v[48:49]
    v_pk_mul_f32 v[50:51], v[34:35], v[50:51]
    v_pk_mul_f32 v[52:53], v[36:37], v[52:53]
    v_pk_mul_f32 v[54:55], v[38:39], v[54:55]
    v_pk_mul_f32 v[56:57], v[40:41], v[56:57]
    v_pk_mul_f32 v[58:59], v[42:43], v[58:59]
    v_pk_mul_f32 v[60:61], v[44:45], v[60:61]
    v_pk_mul_f32 v[62:63], v[46:47], v[62:63]
    v_pk_fma_f32 v[106:107], v[48:49], v[48:49], v[106:107]
    v_pk_fma_f32 v[106:107], v[50:51], v[50:51], v[106:107]
    v_pk_fma_f32 v[106:107], v[52:53], v[52:53], v[106:107]
    v_pk_fma_f32 v[106:107], v[54:55], v[54:55], v[106:107]
    v_pk_fma_f32 v[106:107], v[56:57], v[56:57], v[106:107]
    v_pk_fma_f32 v[106:107], v[58:59], v[58:59], v[106:107]
    v_pk_fma_f32 v[106:107], v[60:61], v[60:61], v[106:107]
    v_pk_fma_f32 v[106:107], v[62:63], v[62:63], v[106:107]
    v_pk_fma_f32 v[48:49], v[16:17], v[16:17], s[52:53]
    v_pk_fma_f32 v[50:51], v[18:19], v[18:19], s[52:53]
    v_pk_fma_f32 v[52:53], v[20:21], v[20:21], s[52:53]
    v_pk_fma_f32 v[54:55], v[22:23], v[22:23], s[52:53]
    v_pk_fma_f32 v[56:57], v[24:25], v[24:25], s[52:53]
    v_pk_fma_f32 v[58:59], v[26:27], v[26:27], s[52:53]
    v_pk_fma_f32 v[60:61], v[28:29], v[28:29], s[52:53]
    v_pk_fma_f32 v[62:63], v[30:31], v[30:31], s[52:53]
    v_pk_mul_f32 v[48:49], v[48:49], v[16:17] neg_lo:[1,0] neg_hi:[1,0]
    v_pk_mul_f32 v[50:51], v[50:51], v[18:19] neg_lo:[1,0] neg_hi:[1,0]
    v_pk_mul_f32 v[52:53], v[52:53], v[20:21] neg_lo:[1,0] neg_hi:[1,0]
    v_pk_mul_f32 v[54:55], v[54:55], v[22:23] neg_lo:[1,0] neg_hi:[1,0]
    v_pk_mul_f32 v[56:57], v[56:57], v[24:25] neg_lo:[1,0] neg_hi:[1,0]
    v_pk_mul_f32 v[58:59], v[58:59], v[26:27] neg_lo:[1,0] neg_hi:[1,0]
    v_pk_mul_f32 v[60:61], v[60:61], v[28:29] neg_lo:[1,0] neg_hi:[1,0]
    v_pk_mul_f32 v[62:63], v[62:63], v[30:31] neg_lo:[1,0] neg_hi:[1,0]
    v_mfma_f32_32x32x16_bf16 v[32:47], v[72:75], a[200:203], 0
    v_exp_f32 v48, v48
    v_exp_f32 v49, v49
    v_exp_f32 v50, v50
    v_mfma_f32_32x32x16_bf16 v[32:47], v[76:79], a[204:207], v[32:47]
    v_exp_f32 v51, v51
    v_exp_f32 v52, v52
    v_exp_f32 v53, v53
    v_exp_f32 v54, v54
    v_exp_f32 v55, v55
    v_exp_f32 v56, v56
    v_exp_f32 v57, v57
    v_exp_f32 v58, v58
    v_exp_f32 v59, v59
    v_exp_f32 v60, v60
    v_exp_f32 v61, v61
    v_exp_f32 v62, v62
    v_exp_f32 v63, v63
    v_pk_add_f32 v[48:49], v[48:49], 1.0 op_sel_hi:[1,0]
    v_pk_add_f32 v[50:51], v[50:51], 1.0 op_sel_hi:[1,0]
    v_pk_add_f32 v[52:53], v[52:53], 1.0 op_sel_hi:[1,0]
    v_pk_add_f32 v[54:55], v[54:55], 1.0 op_sel_hi:[1,0]
    v_pk_add_f32 v[56:57], v[56:57], 1.0 op_sel_hi:[1,0]
    v_pk_add_f32 v[58:59], v[58:59], 1.0 op_sel_hi:[1,0]
    v_pk_add_f32 v[60:61], v[60:61], 1.0 op_sel_hi:[1,0]
    v_pk_add_f32 v[62:63], v[62:63], 1.0 op_sel_hi:[1,0]
    v_mfma_f32_32x32x16_bf16 v[32:47], v[80:83], a[208:211], v[32:47]
    v_rcp_f32 v48, v48
    v_rcp_f32 v49, v49
    v_rcp_f32 v50, v50
    v_mfma_f32_32x32x16_bf16 v[32:47], v[84:87], a[212:215], v[32:47]
    v_rcp_f32 v51, v51
    v_rcp_f32 v52, v52
    v_rcp_f32 v53, v53
    v_mfma_f32_32x32x16_bf16 v[32:47], v[88:91], a[216:219], v[32:47]
    v_rcp_f32 v54, v54
    v_rcp_f32 v55, v55
    v_rcp_f32 v56, v56
    v_mfma_f32_32x32x16_bf16 v[32:47], v[92:95], a[220:223], v[32:47]
    v_rcp_f32 v57, v57
    v_rcp_f32 v58, v58
    v_rcp_f32 v59, v59
    v_rcp_f32 v60, v60
    v_rcp_f32 v61, v61
    v_rcp_f32 v62, v62
    v_rcp_f32 v63, v63
    v_pk_mul_f32 v[48:49], v[16:17], v[48:49]
    v_pk_mul_f32 v[50:51], v[18:19], v[50:51]
    v_pk_mul_f32 v[52:53], v[20:21], v[52:53]
    v_pk_mul_f32 v[54:55], v[22:23], v[54:55]
    v_pk_mul_f32 v[56:57], v[24:25], v[56:57]
    v_pk_mul_f32 v[58:59], v[26:27], v[58:59]
    v_pk_mul_f32 v[60:61], v[28:29], v[60:61]
    v_pk_mul_f32 v[62:63], v[30:31], v[62:63]
    v_pk_fma_f32 v[108:109], v[48:49], v[48:49], v[108:109]
    v_pk_fma_f32 v[108:109], v[50:51], v[50:51], v[108:109]
    v_pk_fma_f32 v[108:109], v[52:53], v[52:53], v[108:109]
    v_pk_fma_f32 v[108:109], v[54:55], v[54:55], v[108:109]
    v_pk_fma_f32 v[108:109], v[56:57], v[56:57], v[108:109]
    v_pk_fma_f32 v[108:109], v[58:59], v[58:59], v[108:109]
    v_pk_fma_f32 v[108:109], v[60:61], v[60:61], v[108:109]
    v_pk_fma_f32 v[108:109], v[62:63], v[62:63], v[108:109]
    v_pk_fma_f32 v[48:49], v[32:33], v[32:33], s[52:53]
    v_pk_fma_f32 v[50:51], v[34:35], v[34:35], s[52:53]
    v_pk_fma_f32 v[52:53], v[36:37], v[36:37], s[52:53]
    v_pk_fma_f32 v[54:55], v[38:39], v[38:39], s[52:53]
    v_pk_fma_f32 v[56:57], v[40:41], v[40:41], s[52:53]
    v_pk_fma_f32 v[58:59], v[42:43], v[42:43], s[52:53]
    v_pk_fma_f32 v[60:61], v[44:45], v[44:45], s[52:53]
    v_pk_fma_f32 v[62:63], v[46:47], v[46:47], s[52:53]
    v_pk_mul_f32 v[48:49], v[48:49], v[32:33] neg_lo:[1,0] neg_hi:[1,0]
    v_pk_mul_f32 v[50:51], v[50:51], v[34:35] neg_lo:[1,0] neg_hi:[1,0]
    v_pk_mul_f32 v[52:53], v[52:53], v[36:37] neg_lo:[1,0] neg_hi:[1,0]
    v_pk_mul_f32 v[54:55], v[54:55], v[38:39] neg_lo:[1,0] neg_hi:[1,0]
    v_pk_mul_f32 v[56:57], v[56:57], v[40:41] neg_lo:[1,0] neg_hi:[1,0]
    v_pk_mul_f32 v[58:59], v[58:59], v[42:43] neg_lo:[1,0] neg_hi:[1,0]
    v_pk_mul_f32 v[60:61], v[60:61], v[44:45] neg_lo:[1,0] neg_hi:[1,0]
    v_pk_mul_f32 v[62:63], v[62:63], v[46:47] neg_lo:[1,0] neg_hi:[1,0]
    v_mfma_f32_32x32x16_bf16 v[16:31], v[72:75], v[160:163], 0
    v_exp_f32 v48, v48
    v_exp_f32 v49, v49
    v_exp_f32 v50, v50
    v_mfma_f32_32x32x16_bf16 v[16:31], v[76:79], v[164:167], v[16:31]
    v_exp_f32 v51, v51
    v_exp_f32 v52, v52
    v_exp_f32 v53, v53
    v_exp_f32 v54, v54
    v_exp_f32 v55, v55
    v_exp_f32 v56, v56
    v_exp_f32 v57, v57
    v_exp_f32 v58, v58
    v_exp_f32 v59, v59
    v_exp_f32 v60, v60
    v_exp_f32 v61, v61
    v_exp_f32 v62, v62
    v_exp_f32 v63, v63
    v_pk_add_f32 v[48:49], v[48:49], 1.0 op_sel_hi:[1,0]
    v_pk_add_f32 v[50:51], v[50:51], 1.0 op_sel_hi:[1,0]
    v_pk_add_f32 v[52:53], v[52:53], 1.0 op_sel_hi:[1,0]
    v_pk_add_f32 v[54:55], v[54:55], 1.0 op_sel_hi:[1,0]
    v_pk_add_f32 v[56:57], v[56:57], 1.0 op_sel_hi:[1,0]
    v_pk_add_f32 v[58:59], v[58:59], 1.0 op_sel_hi:[1,0]
    v_pk_add_f32 v[60:61], v[60:61], 1.0 op_sel_hi:[1,0]
    v_pk_add_f32 v[62:63], v[62:63], 1.0 op_sel_hi:[1,0]
    v_mfma_f32_32x32x16_bf16 v[16:31], v[80:83], v[168:171], v[16:31]
    s_waitcnt vmcnt(1)
    s_mul_i32 s59, s57, 18432
    s_add_u32 s59, s59, 0
    s_add_u32 m0, s59, 73728
    s_nop 0
    buffer_load_dwordx4 v2, s[36:39], s59 offen lds
    s_mov_b64 exec, 1
    buffer_atomic_add v135, off, s[48:51], s67
    s_mov_b64 exec, -1
    ds_read_b128 v[120:123], v4 offset:16384
    v_mfma_f32_32x32x16_bf16 v[16:31], v[84:87], v[172:175], v[16:31]
    ds_read_b128 v[124:127], v4 offset:17408
    ds_read_b128 v[128:131], v4 offset:18432
    ds_read_b128 v[132:135], v4 offset:19456
    v_rcp_f32 v48, v48
    v_rcp_f32 v49, v49
    v_mfma_f32_32x32x16_bf16 v[16:31], v[88:91], v[176:179], v[16:31]
    ds_read_b128 v[136:139], v4 offset:20480
    ds_read_b128 v[140:143], v4 offset:21504
    v_rcp_f32 v50, v50
    v_rcp_f32 v51, v51
    v_mfma_f32_32x32x16_bf16 v[16:31], v[92:95], v[180:183], v[16:31]
    s_waitcnt lgkmcnt(0)
    v_rcp_f32 v52, v52
    v_rcp_f32 v53, v53
    v_rcp_f32 v54, v54
    v_rcp_f32 v55, v55
    v_rcp_f32 v56, v56
    v_rcp_f32 v57, v57
    v_rcp_f32 v58, v58
    v_rcp_f32 v59, v59
    v_rcp_f32 v60, v60
    v_rcp_f32 v61, v61
    v_rcp_f32 v62, v62
    v_rcp_f32 v63, v63
    v_pk_mul_f32 v[48:49], v[32:33], v[48:49]
    v_pk_mul_f32 v[50:51], v[34:35], v[50:51]
    v_pk_mul_f32 v[52:53], v[36:37], v[52:53]
    v_pk_mul_f32 v[54:55], v[38:39], v[54:55]
    v_pk_mul_f32 v[56:57], v[40:41], v[56:57]
    v_pk_mul_f32 v[58:59], v[42:43], v[58:59]
    v_pk_mul_f32 v[60:61], v[44:45], v[60:61]
    v_pk_mul_f32 v[62:63], v[46:47], v[62:63]
    v_pk_fma_f32 v[110:111], v[48:49], v[48:49], v[110:111]
    v_pk_fma_f32 v[110:111], v[50:51], v[50:51], v[110:111]
    v_pk_fma_f32 v[110:111], v[52:53], v[52:53], v[110:111]
    v_pk_fma_f32 v[110:111], v[54:55], v[54:55], v[110:111]
    v_pk_fma_f32 v[110:111], v[56:57], v[56:57], v[110:111]
    v_pk_fma_f32 v[110:111], v[58:59], v[58:59], v[110:111]
    v_pk_fma_f32 v[110:111], v[60:61], v[60:61], v[110:111]
    v_pk_fma_f32 v[110:111], v[62:63], v[62:63], v[110:111]
    v_pk_fma_f32 v[48:49], v[16:17], v[16:17], s[52:53]
    v_pk_fma_f32 v[50:51], v[18:19], v[18:19], s[52:53]
    v_pk_fma_f32 v[52:53], v[20:21], v[20:21], s[52:53]
    v_pk_fma_f32 v[54:55], v[22:23], v[22:23], s[52:53]
    v_pk_fma_f32 v[56:57], v[24:25], v[24:25], s[52:53]
    v_pk_fma_f32 v[58:59], v[26:27], v[26:27], s[52:53]
    v_pk_fma_f32 v[60:61], v[28:29], v[28:29], s[52:53]
    v_pk_fma_f32 v[62:63], v[30:31], v[30:31], s[52:53]
    v_pk_mul_f32 v[48:49], v[48:49], v[16:17] neg_lo:[1,0] neg_hi:[1,0]
    v_pk_mul_f32 v[50:51], v[50:51], v[18:19] neg_lo:[1,0] neg_hi:[1,0]
    v_pk_mul_f32 v[52:53], v[52:53], v[20:21] neg_lo:[1,0] neg_hi:[1,0]
    v_pk_mul_f32 v[54:55], v[54:55], v[22:23] neg_lo:[1,0] neg_hi:[1,0]
    v_pk_mul_f32 v[56:57], v[56:57], v[24:25] neg_lo:[1,0] neg_hi:[1,0]
    v_pk_mul_f32 v[58:59], v[58:59], v[26:27] neg_lo:[1,0] neg_hi:[1,0]
    v_pk_mul_f32 v[60:61], v[60:61], v[28:29] neg_lo:[1,0] neg_hi:[1,0]
    v_pk_mul_f32 v[62:63], v[62:63], v[30:31] neg_lo:[1,0] neg_hi:[1,0]
    v_mfma_f32_32x32x16_bf16 v[32:47], v[72:75], v[184:187], 0
    v_exp_f32 v48, v48
    v_exp_f32 v49, v49
    v_exp_f32 v50, v50
    v_mfma_f32_32x32x16_bf16 v[32:47], v[76:79], v[188:191], v[32:47]
    v_exp_f32 v51, v51
    v_exp_f32 v52, v52
    v_exp_f32 v53, v53
    v_mfma_f32_32x32x16_bf16 v[144:159], v[120:123], a[224:227], 0
    v_exp_f32 v54, v54
    v_exp_f32 v55, v55
    v_exp_f32 v56, v56
    v_mfma_f32_32x32x16_bf16 v[144:159], v[124:127], a[228:231], v[144:159]
    v_exp_f32 v57, v57
    v_exp_f32 v58, v58
    v_exp_f32 v59, v59
    v_exp_f32 v60, v60
    v_exp_f32 v61, v61
    v_exp_f32 v62, v62
    v_exp_f32 v63, v63
    v_pk_add_f32 v[48:49], v[48:49], 1.0 op_sel_hi:[1,0]
    v_pk_add_f32 v[50:51], v[50:51], 1.0 op_sel_hi:[1,0]
    v_pk_add_f32 v[52:53], v[52:53], 1.0 op_sel_hi:[1,0]
    v_pk_add_f32 v[54:55], v[54:55], 1.0 op_sel_hi:[1,0]
    v_pk_add_f32 v[56:57], v[56:57], 1.0 op_sel_hi:[1,0]
    v_pk_add_f32 v[58:59], v[58:59], 1.0 op_sel_hi:[1,0]
    v_pk_add_f32 v[60:61], v[60:61], 1.0 op_sel_hi:[1,0]
    v_pk_add_f32 v[62:63], v[62:63], 1.0 op_sel_hi:[1,0]
    v_pk_mul_f32 v[10:11], v[144:145], v[144:145]
    v_pk_add_f32 v[8:9], v[144:145], v[146:147]
    v_pk_fma_f32 v[10:11], v[146:147], v[146:147], v[10:11]
    v_pk_add_f32 v[8:9], v[8:9], v[148:149]
    v_pk_fma_f32 v[10:11], v[148:149], v[148:149], v[10:11]
    v_pk_add_f32 v[8:9], v[8:9], v[150:151]
    v_pk_fma_f32 v[10:11], v[150:151], v[150:151], v[10:11]
    v_pk_add_f32 v[8:9], v[8:9], v[152:153]
    v_pk_fma_f32 v[10:11], v[152:153], v[152:153], v[10:11]
    v_pk_add_f32 v[8:9], v[8:9], v[154:155]
    v_pk_fma_f32 v[10:11], v[154:155], v[154:155], v[10:11]
    v_pk_add_f32 v[8:9], v[8:9], v[156:157]
    v_pk_fma_f32 v[10:11], v[156:157], v[156:157], v[10:11]
    v_pk_add_f32 v[8:9], v[8:9], v[158:159]
    v_pk_fma_f32 v[10:11], v[158:159], v[158:159], v[10:11]
    v_mfma_f32_32x32x16_bf16 v[32:47], v[80:83], v[192:195], v[32:47]
    s_mul_i32 s59, s57, 18432
    s_add_u32 s59, s59, 1024
    s_add_u32 m0, s59, 73728
    s_nop 0
    buffer_load_dwordx4 v2, s[36:39], s59 offen lds
    v_rcp_f32 v48, v48
    v_mfma_f32_32x32x16_bf16 v[32:47], v[84:87], v[196:199], v[32:47]
    v_rcp_f32 v49, v49
    v_rcp_f32 v50, v50
    v_rcp_f32 v51, v51
    v_mfma_f32_32x32x16_bf16 v[32:47], v[88:91], v[200:203], v[32:47]
    v_rcp_f32 v52, v52
    v_rcp_f32 v53, v53
    v_rcp_f32 v54, v54
    v_mfma_f32_32x32x16_bf16 v[32:47], v[92:95], v[204:207], v[32:47]
    v_rcp_f32 v55, v55
    v_rcp_f32 v56, v56
    v_rcp_f32 v57, v57
    v_rcp_f32 v58, v58
    v_rcp_f32 v59, v59
    v_rcp_f32 v60, v60
    v_rcp_f32 v61, v61
    v_rcp_f32 v62, v62
    v_rcp_f32_e64 v63, v63
    v_pk_mul_f32 v[48:49], v[16:17], v[48:49]
    v_pk_mul_f32 v[50:51], v[18:19], v[50:51]
    v_pk_mul_f32 v[52:53], v[20:21], v[52:53]
    v_pk_mul_f32 v[54:55], v[22:23], v[54:55]
    v_pk_mul_f32 v[56:57], v[24:25], v[56:57]
    v_pk_mul_f32 v[58:59], v[26:27], v[58:59]
    v_pk_mul_f32 v[60:61], v[28:29], v[60:61]
    v_pk_mul_f32 v[62:63], v[30:31], v[62:63]
    v_pk_fma_f32 v[112:113], v[48:49], v[48:49], v[112:113]
    v_pk_fma_f32 v[112:113], v[50:51], v[50:51], v[112:113]
    v_pk_fma_f32 v[112:113], v[52:53], v[52:53], v[112:113]
    v_pk_fma_f32 v[112:113], v[54:55], v[54:55], v[112:113]
    v_pk_fma_f32 v[112:113], v[56:57], v[56:57], v[112:113]
    v_pk_fma_f32 v[112:113], v[58:59], v[58:59], v[112:113]
    v_pk_fma_f32 v[112:113], v[60:61], v[60:61], v[112:113]
    v_pk_fma_f32 v[112:113], v[62:63], v[62:63], v[112:113]
    v_pk_fma_f32 v[48:49], v[32:33], v[32:33], s[52:53]
    v_pk_fma_f32 v[50:51], v[34:35], v[34:35], s[52:53]
    v_pk_fma_f32 v[52:53], v[36:37], v[36:37], s[52:53]
    v_pk_fma_f32 v[54:55], v[38:39], v[38:39], s[52:53]
    v_pk_fma_f32 v[56:57], v[40:41], v[40:41], s[52:53]
    v_pk_fma_f32 v[58:59], v[42:43], v[42:43], s[52:53]
    v_pk_fma_f32 v[60:61], v[44:45], v[44:45], s[52:53]
    v_pk_fma_f32 v[62:63], v[46:47], v[46:47], s[52:53]
    v_pk_mul_f32 v[48:49], v[48:49], v[32:33] neg_lo:[1,0] neg_hi:[1,0]
    v_pk_mul_f32 v[50:51], v[50:51], v[34:35] neg_lo:[1,0] neg_hi:[1,0]
    v_pk_mul_f32 v[52:53], v[52:53], v[36:37] neg_lo:[1,0] neg_hi:[1,0]
    v_pk_mul_f32 v[54:55], v[54:55], v[38:39] neg_lo:[1,0] neg_hi:[1,0]
    v_pk_mul_f32 v[56:57], v[56:57], v[40:41] neg_lo:[1,0] neg_hi:[1,0]
    v_pk_mul_f32 v[58:59], v[58:59], v[42:43] neg_lo:[1,0] neg_hi:[1,0]
    v_pk_mul_f32 v[60:61], v[60:61], v[44:45] neg_lo:[1,0] neg_hi:[1,0]
    v_pk_mul_f32 v[62:63], v[62:63], v[46:47] neg_lo:[1,0] neg_hi:[1,0]
    v_mfma_f32_32x32x16_bf16 v[16:31], v[72:75], v[208:211], 0
    v_exp_f32 v48, v48
    v_exp_f32 v49, v49
    v_exp_f32 v50, v50
    v_mfma_f32_32x32x16_bf16 v[16:31], v[76:79], v[212:215], v[16:31]
    v_exp_f32 v51, v51
    v_exp_f32 v52, v52
    v_exp_f32 v53, v53
    v_mfma_f32_32x32x16_bf16 v[144:159], v[128:131], a[232:235], 0
    v_exp_f32 v54, v54
    v_exp_f32 v55, v55
    v_exp_f32 v56, v56
    v_mfma_f32_32x32x16_bf16 v[144:159], v[132:135], a[236:239], v[144:159]
    v_exp_f32 v57, v57
    v_exp_f32 v58, v58
    v_exp_f32 v59, v59
    v_exp_f32 v60, v60
    v_exp_f32 v61, v61
    v_exp_f32 v62, v62
    v_exp_f32 v63, v63
    v_pk_add_f32 v[48:49], v[48:49], 1.0 op_sel_hi:[1,0]
    v_pk_add_f32 v[50:51], v[50:51], 1.0 op_sel_hi:[1,0]
    v_pk_add_f32 v[52:53], v[52:53], 1.0 op_sel_hi:[1,0]
    v_pk_add_f32 v[54:55], v[54:55], 1.0 op_sel_hi:[1,0]
    v_pk_add_f32 v[56:57], v[56:57], 1.0 op_sel_hi:[1,0]
    v_pk_add_f32 v[58:59], v[58:59], 1.0 op_sel_hi:[1,0]
    v_pk_add_f32 v[60:61], v[60:61], 1.0 op_sel_hi:[1,0]
    v_pk_add_f32 v[62:63], v[62:63], 1.0 op_sel_hi:[1,0]
    v_pk_add_f32 v[8:9], v[8:9], v[144:145]
    v_pk_fma_f32 v[10:11], v[144:145], v[144:145], v[10:11]
    v_pk_add_f32 v[8:9], v[8:9], v[146:147]
    v_pk_fma_f32 v[10:11], v[146:147], v[146:147], v[10:11]
    v_pk_add_f32 v[8:9], v[8:9], v[148:149]
    v_pk_fma_f32 v[10:11], v[148:149], v[148:149], v[10:11]
    v_pk_add_f32 v[8:9], v[8:9], v[150:151]
    v_pk_fma_f32 v[10:11], v[150:151], v[150:151], v[10:11]
    v_pk_add_f32 v[8:9], v[8:9], v[152:153]
    v_pk_fma_f32 v[10:11], v[152:153], v[152:153], v[10:11]
    v_pk_add_f32 v[8:9], v[8:9], v[154:155]
    v_pk_fma_f32 v[10:11], v[154:155], v[154:155], v[10:11]
    v_pk_add_f32 v[8:9], v[8:9], v[156:157]
    v_pk_fma_f32 v[10:11], v[156:157], v[156:157], v[10:11]
    v_pk_add_f32 v[8:9], v[8:9], v[158:159]
    v_pk_fma_f32 v[10:11], v[158:159], v[158:159], v[10:11]
    v_mfma_f32_32x32x16_bf16 v[16:31], v[80:83], v[216:219], v[16:31]
    s_mul_i32 s59, s57, 18432
    s_add_u32 s59, s59, 2048
    s_add_u32 m0, s59, 73728
    s_nop 0
    buffer_load_dwordx4 v2, s[36:39], s59 offen lds
    v_rcp_f32 v48, v48
    v_mfma_f32_32x32x16_bf16 v[16:31], v[84:87], v[220:223], v[16:31]
    v_rcp_f32 v49, v49
    v_rcp_f32 v50, v50
    v_rcp_f32 v51, v51
    v_mfma_f32_32x32x16_bf16 v[16:31], v[88:91], v[224:227], v[16:31]
    v_rcp_f32 v52, v52
    v_rcp_f32 v53, v53
    v_rcp_f32 v54, v54
    v_mfma_f32_32x32x16_bf16 v[16:31], v[92:95], v[228:231], v[16:31]
    v_rcp_f32 v55, v55
    v_rcp_f32 v56, v56
    v_rcp_f32 v57, v57
    v_rcp_f32 v58, v58
    v_rcp_f32 v59, v59
    v_rcp_f32 v60, v60
    v_rcp_f32 v61, v61
    v_rcp_f32 v62, v62
    v_rcp_f32_e64 v63, v63
    v_pk_mul_f32 v[48:49], v[32:33], v[48:49]
    v_pk_mul_f32 v[50:51], v[34:35], v[50:51]
    v_pk_mul_f32 v[52:53], v[36:37], v[52:53]
    v_pk_mul_f32 v[54:55], v[38:39], v[54:55]
    v_pk_mul_f32 v[56:57], v[40:41], v[56:57]
    v_pk_mul_f32 v[58:59], v[42:43], v[58:59]
    v_pk_mul_f32 v[60:61], v[44:45], v[60:61]
    v_pk_mul_f32 v[62:63], v[46:47], v[62:63]
    v_pk_fma_f32 v[114:115], v[48:49], v[48:49], v[114:115]
    v_pk_fma_f32 v[114:115], v[50:51], v[50:51], v[114:115]
    v_pk_fma_f32 v[114:115], v[52:53], v[52:53], v[114:115]
    v_pk_fma_f32 v[114:115], v[54:55], v[54:55], v[114:115]
    v_pk_fma_f32 v[114:115], v[56:57], v[56:57], v[114:115]
    v_pk_fma_f32 v[114:115], v[58:59], v[58:59], v[114:115]
    v_pk_fma_f32 v[114:115], v[60:61], v[60:61], v[114:115]
    v_pk_fma_f32 v[114:115], v[62:63], v[62:63], v[114:115]
    v_pk_fma_f32 v[48:49], v[16:17], v[16:17], s[52:53]
    v_pk_fma_f32 v[50:51], v[18:19], v[18:19], s[52:53]
    v_pk_fma_f32 v[52:53], v[20:21], v[20:21], s[52:53]
    v_pk_fma_f32 v[54:55], v[22:23], v[22:23], s[52:53]
    v_pk_fma_f32 v[56:57], v[24:25], v[24:25], s[52:53]
    v_pk_fma_f32 v[58:59], v[26:27], v[26:27], s[52:53]
    v_pk_fma_f32 v[60:61], v[28:29], v[28:29], s[52:53]
    v_pk_fma_f32 v[62:63], v[30:31], v[30:31], s[52:53]
    v_pk_mul_f32 v[48:49], v[48:49], v[16:17] neg_lo:[1,0] neg_hi:[1,0]
    v_pk_mul_f32 v[50:51], v[50:51], v[18:19] neg_lo:[1,0] neg_hi:[1,0]
    v_pk_mul_f32 v[52:53], v[52:53], v[20:21] neg_lo:[1,0] neg_hi:[1,0]
    v_pk_mul_f32 v[54:55], v[54:55], v[22:23] neg_lo:[1,0] neg_hi:[1,0]
    v_pk_mul_f32 v[56:57], v[56:57], v[24:25] neg_lo:[1,0] neg_hi:[1,0]
    v_pk_mul_f32 v[58:59], v[58:59], v[26:27] neg_lo:[1,0] neg_hi:[1,0]
    v_pk_mul_f32 v[60:61], v[60:61], v[28:29] neg_lo:[1,0] neg_hi:[1,0]
    v_pk_mul_f32 v[62:63], v[62:63], v[30:31] neg_lo:[1,0] neg_hi:[1,0]
    v_mfma_f32_32x32x16_bf16 v[32:47], v[72:75], v[232:235], 0
    s_mul_i32 s59, s57, 18432
    s_add_u32 s59, s59, 3072
    s_add_u32 m0, s59, 73728
    s_nop 0
    buffer_load_dwordx4 v2, s[36:39], s59 offen lds
    v_exp_f32 v48, v48
    v_mfma_f32_32x32x16_bf16 v[32:47], v[76:79], v[236:239], v[32:47]
    v_exp_f32 v49, v49
    v_exp_f32 v50, v50
    v_exp_f32 v51, v51
    v_mfma_f32_32x32x16_bf16 v[32:47], v[80:83], v[240:243], v[32:47]
    v_exp_f32 v52, v52
    v_exp_f32 v53, v53
    v_exp_f32 v54, v54
    v_mfma_f32_32x32x16_bf16 v[32:47], v[84:87], v[244:247], v[32:47]
    v_exp_f32 v55, v55
    v_exp_f32 v56, v56
    v_exp_f32 v57, v57
    v_mfma_f32_32x32x16_bf16 v[144:159], v[136:139], a[240:243], 0
    v_exp_f32 v58, v58
    v_exp_f32 v59, v59
    v_exp_f32 v60, v60
    v_mfma_f32_32x32x16_bf16 v[144:159], v[140:143], a[244:247], v[144:159]
    v_exp_f32 v61, v61
    v_exp_f32 v62, v62
    v_exp_f32_e64 v63, v63
    v_pk_add_f32 v[48:49], v[48:49], 1.0 op_sel_hi:[1,0]
    v_pk_add_f32 v[50:51], v[50:51], 1.0 op_sel_hi:[1,0]
    v_pk_add_f32 v[52:53], v[52:53], 1.0 op_sel_hi:[1,0]
    v_pk_add_f32 v[54:55], v[54:55], 1.0 op_sel_hi:[1,0]
    v_pk_add_f32 v[56:57], v[56:57], 1.0 op_sel_hi:[1,0]
    v_pk_add_f32 v[58:59], v[58:59], 1.0 op_sel_hi:[1,0]
    v_pk_add_f32 v[60:61], v[60:61], 1.0 op_sel_hi:[1,0]
    v_pk_add_f32 v[62:63], v[62:63], 1.0 op_sel_hi:[1,0]
    v_pk_add_f32 v[8:9], v[8:9], v[144:145]
    v_pk_fma_f32 v[10:11], v[144:145], v[144:145], v[10:11]
    v_pk_add_f32 v[8:9], v[8:9], v[146:147]
    v_pk_fma_f32 v[10:11], v[146:147], v[146:147], v[10:11]
    v_pk_add_f32 v[8:9], v[8:9], v[148:149]
    v_pk_fma_f32 v[10:11], v[148:149], v[148:149], v[10:11]
    v_pk_add_f32 v[8:9], v[8:9], v[150:151]
    v_pk_fma_f32 v[10:11], v[150:151], v[150:151], v[10:11]
    v_pk_add_f32 v[8:9], v[8:9], v[152:153]
    v_pk_fma_f32 v[10:11], v[152:153], v[152:153], v[10:11]
    v_pk_add_f32 v[8:9], v[8:9], v[154:155]
    v_pk_fma_f32 v[10:11], v[154:155], v[154:155], v[10:11]
    v_pk_add_f32 v[8:9], v[8:9], v[156:157]
    v_pk_fma_f32 v[10:11], v[156:157], v[156:157], v[10:11]
    v_pk_add_f32 v[8:9], v[8:9], v[158:159]
    v_pk_fma_f32 v[10:11], v[158:159], v[158:159], v[10:11]
    v_mfma_f32_32x32x16_bf16 v[32:47], v[88:91], v[248:251], v[32:47]
    s_mul_i32 s59, s57, 18432
    s_add_u32 s59, s59, 4096
    s_add_u32 m0, s59, 73728
    s_nop 0
    buffer_load_dwordx4 v2, s[36:39], s59 offen lds
    v_rcp_f32 v48, v48
    v_mfma_f32_32x32x16_bf16 v[32:47], v[92:95], v[252:255], v[32:47]
    v_rcp_f32 v49, v49
    v_rcp_f32 v50, v50
    v_rcp_f32 v51, v51
    v_mfma_f32_32x32x16_bf16 v[144:159], v[120:123], a[224:227], 0
    v_rcp_f32 v52, v52
    v_rcp_f32 v53, v53
    v_rcp_f32 v54, v54
    v_mfma_f32_32x32x16_bf16 v[144:159], v[124:127], a[228:231], v[144:159]
    v_add_f32 v8, v8, v9
    v_add_f32 v10, v10, v11
    s_nop 1
    v_permlane32_swap_b32 v8, v10
    v_add_f32 v8, v8, v10
    v_mov_b32 v10, v8
    s_nop 1
    v_permlane32_swap_b32 v8, v10
    v_rcp_f32 v55, v55
    v_mul_f32 v8, 0x3c2aaaab, v8
    v_rcp_f32 v56, v56
    v_rcp_f32 v57, v57
    v_mul_f32 v10, 0x3c2aaaab, v10
    v_rcp_f32 v58, v58
    v_fma_f32 v10, -v8, v8, v10
    v_rcp_f32 v59, v59
    v_max_f32 v10, 0, v10
    v_rcp_f32 v60, v60
    v_add_f32 v10, 0x3727c5ac, v10
    v_rcp_f32 v61, v61
    v_rsq_f32 v10, v10
    v_rcp_f32 v62, v62
    v_mul_f32 v12, 0x3eeff558, v10
    v_rcp_f32_e64 v63, v63
    v_mul_f32_e64 v13, -v8, v12
    v_pk_mul_f32 v[48:49], v[16:17], v[48:49]
    v_pk_mul_f32 v[50:51], v[18:19], v[50:51]
    v_pk_mul_f32 v[52:53], v[20:21], v[52:53]
    v_pk_mul_f32 v[54:55], v[22:23], v[54:55]
    v_pk_mul_f32 v[56:57], v[24:25], v[56:57]
    v_pk_mul_f32 v[58:59], v[26:27], v[58:59]
    v_pk_mul_f32 v[60:61], v[28:29], v[60:61]
    v_pk_mul_f32 v[62:63], v[30:31], v[62:63]
    v_pk_fma_f32 v[116:117], v[48:49], v[48:49], v[116:117]
    v_pk_fma_f32 v[116:117], v[50:51], v[50:51], v[116:117]
    v_pk_fma_f32 v[116:117], v[52:53], v[52:53], v[116:117]
    v_pk_fma_f32 v[116:117], v[54:55], v[54:55], v[116:117]
    v_pk_fma_f32 v[116:117], v[56:57], v[56:57], v[116:117]
    v_pk_fma_f32 v[116:117], v[58:59], v[58:59], v[116:117]
    v_pk_fma_f32 v[116:117], v[60:61], v[60:61], v[116:117]
    v_pk_fma_f32 v[116:117], v[62:63], v[62:63], v[116:117]
    v_pk_fma_f32 v[144:145], v[144:145], v[12:13], v[12:13] op_sel:[0,0,1] op_sel_hi:[1,0,1]
    v_pk_fma_f32 v[146:147], v[146:147], v[12:13], v[12:13] op_sel:[0,0,1] op_sel_hi:[1,0,1]
    v_pk_fma_f32 v[148:149], v[148:149], v[12:13], v[12:13] op_sel:[0,0,1] op_sel_hi:[1,0,1]
    v_pk_fma_f32 v[150:151], v[150:151], v[12:13], v[12:13] op_sel:[0,0,1] op_sel_hi:[1,0,1]
    v_pk_fma_f32 v[152:153], v[152:153], v[12:13], v[12:13] op_sel:[0,0,1] op_sel_hi:[1,0,1]
    v_pk_fma_f32 v[154:155], v[154:155], v[12:13], v[12:13] op_sel:[0,0,1] op_sel_hi:[1,0,1]
    v_pk_fma_f32 v[156:157], v[156:157], v[12:13], v[12:13] op_sel:[0,0,1] op_sel_hi:[1,0,1]
    v_pk_fma_f32 v[158:159], v[158:159], v[12:13], v[12:13] op_sel:[0,0,1] op_sel_hi:[1,0,1]
    v_cvt_pk_bf16_f32 v72, v144, v145
    v_cvt_pk_bf16_f32 v73, v146, v147
    v_cvt_pk_bf16_f32 v74, v148, v149
    v_cvt_pk_bf16_f32 v75, v150, v151
    v_cvt_pk_bf16_f32 v76, v152, v153
    v_cvt_pk_bf16_f32 v77, v154, v155
    v_cvt_pk_bf16_f32 v78, v156, v157
    v_cvt_pk_bf16_f32 v79, v158, v159
    v_pk_fma_f32 v[48:49], v[32:33], v[32:33], s[52:53]
    v_pk_fma_f32 v[50:51], v[34:35], v[34:35], s[52:53]
    v_pk_fma_f32 v[52:53], v[36:37], v[36:37], s[52:53]
    v_pk_fma_f32 v[54:55], v[38:39], v[38:39], s[52:53]
    v_pk_fma_f32 v[56:57], v[40:41], v[40:41], s[52:53]
    v_pk_fma_f32 v[58:59], v[42:43], v[42:43], s[52:53]
    v_pk_fma_f32 v[60:61], v[44:45], v[44:45], s[52:53]
    v_pk_fma_f32 v[62:63], v[46:47], v[46:47], s[52:53]
    v_pk_mul_f32 v[48:49], v[48:49], v[32:33] neg_lo:[1,0] neg_hi:[1,0]
    v_pk_mul_f32 v[50:51], v[50:51], v[34:35] neg_lo:[1,0] neg_hi:[1,0]
    v_pk_mul_f32 v[52:53], v[52:53], v[36:37] neg_lo:[1,0] neg_hi:[1,0]
    v_pk_mul_f32 v[54:55], v[54:55], v[38:39] neg_lo:[1,0] neg_hi:[1,0]
    v_pk_mul_f32 v[56:57], v[56:57], v[40:41] neg_lo:[1,0] neg_hi:[1,0]
    v_pk_mul_f32 v[58:59], v[58:59], v[42:43] neg_lo:[1,0] neg_hi:[1,0]
    v_pk_mul_f32 v[60:61], v[60:61], v[44:45] neg_lo:[1,0] neg_hi:[1,0]
    v_pk_mul_f32 v[62:63], v[62:63], v[46:47] neg_lo:[1,0] neg_hi:[1,0]
    v_mfma_f32_32x32x16_bf16 v[144:159], v[128:131], a[232:235], 0
    v_exp_f32 v48, v48
    v_exp_f32 v49, v49
    v_exp_f32 v50, v50
    v_mfma_f32_32x32x16_bf16 v[144:159], v[132:135], a[236:239], v[144:159]
    v_exp_f32 v51, v51
    v_exp_f32 v52, v52
    v_exp_f32 v53, v53
    v_mfma_f32_32x32x16_bf16 v[16:31], v[136:139], a[240:243], 0
    v_exp_f32 v54, v54
    v_exp_f32 v55, v55
    v_exp_f32 v56, v56
    v_mfma_f32_32x32x16_bf16 v[16:31], v[140:143], a[244:247], v[16:31]
    v_exp_f32 v57, v57
    v_exp_f32 v58, v58
    v_exp_f32 v59, v59
    v_exp_f32 v60, v60
    v_exp_f32 v61, v61
    v_exp_f32 v62, v62
    v_exp_f32 v63, v63
    v_pk_add_f32 v[48:49], v[48:49], 1.0 op_sel_hi:[1,0]
    v_pk_add_f32 v[50:51], v[50:51], 1.0 op_sel_hi:[1,0]
    v_pk_add_f32 v[52:53], v[52:53], 1.0 op_sel_hi:[1,0]
    v_pk_add_f32 v[54:55], v[54:55], 1.0 op_sel_hi:[1,0]
    v_pk_add_f32 v[56:57], v[56:57], 1.0 op_sel_hi:[1,0]
    v_pk_add_f32 v[58:59], v[58:59], 1.0 op_sel_hi:[1,0]
    v_pk_add_f32 v[60:61], v[60:61], 1.0 op_sel_hi:[1,0]
    v_pk_add_f32 v[62:63], v[62:63], 1.0 op_sel_hi:[1,0]
    v_pk_fma_f32 v[144:145], v[144:145], v[12:13], v[12:13] op_sel:[0,0,1] op_sel_hi:[1,0,1]
    v_pk_fma_f32 v[146:147], v[146:147], v[12:13], v[12:13] op_sel:[0,0,1] op_sel_hi:[1,0,1]
    v_pk_fma_f32 v[148:149], v[148:149], v[12:13], v[12:13] op_sel:[0,0,1] op_sel_hi:[1,0,1]
    v_pk_fma_f32 v[150:151], v[150:151], v[12:13], v[12:13] op_sel:[0,0,1] op_sel_hi:[1,0,1]
    v_pk_fma_f32 v[152:153], v[152:153], v[12:13], v[12:13] op_sel:[0,0,1] op_sel_hi:[1,0,1]
    v_pk_fma_f32 v[154:155], v[154:155], v[12:13], v[12:13] op_sel:[0,0,1] op_sel_hi:[1,0,1]
    v_pk_fma_f32 v[156:157], v[156:157], v[12:13], v[12:13] op_sel:[0,0,1] op_sel_hi:[1,0,1]
    v_pk_fma_f32 v[158:159], v[158:159], v[12:13], v[12:13] op_sel:[0,0,1] op_sel_hi:[1,0,1]
    v_cvt_pk_bf16_f32 v80, v144, v145
    v_cvt_pk_bf16_f32 v81, v146, v147
    v_cvt_pk_bf16_f32 v82, v148, v149
    v_cvt_pk_bf16_f32 v83, v150, v151
    v_cvt_pk_bf16_f32 v84, v152, v153
    v_cvt_pk_bf16_f32 v85, v154, v155
    v_cvt_pk_bf16_f32 v86, v156, v157
    v_cvt_pk_bf16_f32 v87, v158, v159
    v_pk_fma_f32 v[16:17], v[16:17], v[12:13], v[12:13] op_sel:[0,0,1] op_sel_hi:[1,0,1]
    v_pk_fma_f32 v[18:19], v[18:19], v[12:13], v[12:13] op_sel:[0,0,1] op_sel_hi:[1,0,1]
    v_pk_fma_f32 v[20:21], v[20:21], v[12:13], v[12:13] op_sel:[0,0,1] op_sel_hi:[1,0,1]
    v_pk_fma_f32 v[22:23], v[22:23], v[12:13], v[12:13] op_sel:[0,0,1] op_sel_hi:[1,0,1]
    v_pk_fma_f32 v[24:25], v[24:25], v[12:13], v[12:13] op_sel:[0,0,1] op_sel_hi:[1,0,1]
    v_pk_fma_f32 v[26:27], v[26:27], v[12:13], v[12:13] op_sel:[0,0,1] op_sel_hi:[1,0,1]
    v_pk_fma_f32 v[28:29], v[28:29], v[12:13], v[12:13] op_sel:[0,0,1] op_sel_hi:[1,0,1]
    v_pk_fma_f32 v[30:31], v[30:31], v[12:13], v[12:13] op_sel:[0,0,1] op_sel_hi:[1,0,1]
    v_cvt_pk_bf16_f32 v88, v16, v17
    v_cvt_pk_bf16_f32 v89, v18, v19
    v_cvt_pk_bf16_f32 v90, v20, v21
    v_cvt_pk_bf16_f32 v91, v22, v23
    v_cvt_pk_bf16_f32 v92, v24, v25
    v_cvt_pk_bf16_f32 v93, v26, v27
    v_cvt_pk_bf16_f32 v94, v28, v29
    v_cvt_pk_bf16_f32 v95, v30, v31
    v_mfma_f32_32x32x16_bf16 v[16:31], v[72:75], a[32:35], 0
    buffer_store_dwordx4 v[12:15], v2, s[44:47], s58 offen offset:2048 sc1
    s_add_u32 s54, s56, 73728
    v_rcp_f32 v48, v48
    v_rcp_f32 v49, v49
    v_mfma_f32_32x32x16_bf16 v[16:31], v[76:79], a[36:39], v[16:31]
    buffer_load_dwordx4 a[224:227], v1, s[24:27], s54 offen offset:0
    buffer_load_dwordx4 a[228:231], v1, s[24:27], s54 offen offset:32
    v_rcp_f32 v50, v50
    v_rcp_f32 v51, v51
    v_mfma_f32_32x32x16_bf16 v[16:31], v[80:83], a[40:43], v[16:31]
    buffer_load_dwordx4 a[232:235], v1, s[24:27], s54 offen offset:64
    buffer_load_dwordx4 a[236:239], v1, s[24:27], s54 offen offset:96
    v_rcp_f32 v52, v52
    v_rcp_f32 v53, v53
    v_mfma_f32_32x32x16_bf16 v[16:31], v[84:87], a[44:47], v[16:31]
    buffer_load_dwordx4 a[240:243], v1, s[24:27], s54 offen offset:128
    buffer_load_dwordx4 a[244:247], v1, s[24:27], s54 offen offset:160
    v_rcp_f32 v54, v54
    v_rcp_f32 v55, v55
    v_mfma_f32_32x32x16_bf16 v[16:31], v[88:91], a[48:51], v[16:31]
    v_rcp_f32 v56, v56
    v_rcp_f32 v57, v57
    v_rcp_f32 v58, v58
    v_mfma_f32_32x32x16_bf16 v[16:31], v[92:95], a[52:55], v[16:31]
    v_rcp_f32 v59, v59
    v_rcp_f32 v60, v60
    v_rcp_f32 v61, v61
    v_rcp_f32 v62, v62
    v_rcp_f32 v63, v63
    v_pk_mul_f32 v[48:49], v[32:33], v[48:49]
    v_pk_mul_f32 v[50:51], v[34:35], v[50:51]
    v_pk_mul_f32 v[52:53], v[36:37], v[52:53]
    v_pk_mul_f32 v[54:55], v[38:39], v[54:55]
    v_pk_mul_f32 v[56:57], v[40:41], v[56:57]
    v_pk_mul_f32 v[58:59], v[42:43], v[58:59]
    v_pk_mul_f32 v[60:61], v[44:45], v[60:61]
    v_pk_mul_f32 v[62:63], v[46:47], v[62:63]
    v_pk_fma_f32 v[118:119], v[48:49], v[48:49], v[118:119]
    v_pk_fma_f32 v[118:119], v[50:51], v[50:51], v[118:119]
    v_pk_fma_f32 v[118:119], v[52:53], v[52:53], v[118:119]
    v_pk_fma_f32 v[118:119], v[54:55], v[54:55], v[118:119]
    v_pk_fma_f32 v[118:119], v[56:57], v[56:57], v[118:119]
    v_pk_fma_f32 v[118:119], v[58:59], v[58:59], v[118:119]
    v_pk_fma_f32 v[118:119], v[60:61], v[60:61], v[118:119]
    v_pk_fma_f32 v[118:119], v[62:63], v[62:63], v[118:119]
    v_pk_fma_f32 v[48:49], v[16:17], v[16:17], s[52:53]
    v_pk_fma_f32 v[50:51], v[18:19], v[18:19], s[52:53]
    v_pk_fma_f32 v[52:53], v[20:21], v[20:21], s[52:53]
    v_pk_fma_f32 v[54:55], v[22:23], v[22:23], s[52:53]
    v_pk_fma_f32 v[56:57], v[24:25], v[24:25], s[52:53]
    v_pk_fma_f32 v[58:59], v[26:27], v[26:27], s[52:53]
    v_pk_fma_f32 v[60:61], v[28:29], v[28:29], s[52:53]
    v_pk_fma_f32 v[62:63], v[30:31], v[30:31], s[52:53]
    v_pk_mul_f32 v[48:49], v[48:49], v[16:17] neg_lo:[1,0] neg_hi:[1,0]
    v_pk_mul_f32 v[50:51], v[50:51], v[18:19] neg_lo:[1,0] neg_hi:[1,0]
    v_pk_mul_f32 v[52:53], v[52:53], v[20:21] neg_lo:[1,0] neg_hi:[1,0]
    v_pk_mul_f32 v[54:55], v[54:55], v[22:23] neg_lo:[1,0] neg_hi:[1,0]
    v_pk_mul_f32 v[56:57], v[56:57], v[24:25] neg_lo:[1,0] neg_hi:[1,0]
    v_pk_mul_f32 v[58:59], v[58:59], v[26:27] neg_lo:[1,0] neg_hi:[1,0]
    v_pk_mul_f32 v[60:61], v[60:61], v[28:29] neg_lo:[1,0] neg_hi:[1,0]
    v_pk_mul_f32 v[62:63], v[62:63], v[30:31] neg_lo:[1,0] neg_hi:[1,0]
    v_mfma_f32_32x32x16_bf16 v[32:47], v[72:75], a[56:59], 0
    v_exp_f32 v48, v48
    v_exp_f32 v49, v49
    v_exp_f32 v50, v50
    v_mfma_f32_32x32x16_bf16 v[32:47], v[76:79], a[60:63], v[32:47]
    v_exp_f32 v51, v51
    v_exp_f32 v52, v52
    v_exp_f32 v53, v53
    v_exp_f32 v54, v54
    v_exp_f32 v55, v55
    v_exp_f32 v56, v56
    v_exp_f32 v57, v57
    v_exp_f32 v58, v58
    v_exp_f32 v59, v59
    v_exp_f32 v60, v60
    v_exp_f32 v61, v61
    v_exp_f32 v62, v62
    v_exp_f32 v63, v63
    v_pk_add_f32 v[48:49], v[48:49], 1.0 op_sel_hi:[1,0]
    v_pk_add_f32 v[50:51], v[50:51], 1.0 op_sel_hi:[1,0]
    v_pk_add_f32 v[52:53], v[52:53], 1.0 op_sel_hi:[1,0]
    v_pk_add_f32 v[54:55], v[54:55], 1.0 op_sel_hi:[1,0]
    v_pk_add_f32 v[56:57], v[56:57], 1.0 op_sel_hi:[1,0]
    v_pk_add_f32 v[58:59], v[58:59], 1.0 op_sel_hi:[1,0]
    v_pk_add_f32 v[60:61], v[60:61], 1.0 op_sel_hi:[1,0]
    v_pk_add_f32 v[62:63], v[62:63], 1.0 op_sel_hi:[1,0]
    v_mfma_f32_32x32x16_bf16 v[32:47], v[80:83], a[64:67], v[32:47]
    v_rcp_f32 v48, v48
    v_rcp_f32 v49, v49
    v_rcp_f32 v50, v50
    v_mfma_f32_32x32x16_bf16 v[32:47], v[84:87], a[68:71], v[32:47]
    v_rcp_f32 v51, v51
    v_rcp_f32 v52, v52
    v_rcp_f32 v53, v53
    v_mfma_f32_32x32x16_bf16 v[32:47], v[88:91], a[72:75], v[32:47]
    v_rcp_f32 v54, v54
    v_rcp_f32 v55, v55
    v_rcp_f32 v56, v56
    v_mfma_f32_32x32x16_bf16 v[32:47], v[92:95], a[76:79], v[32:47]
    v_rcp_f32 v57, v57
    v_rcp_f32 v58, v58
    v_rcp_f32 v59, v59
    v_rcp_f32 v60, v60
    v_rcp_f32 v61, v61
    v_rcp_f32 v62, v62
    v_rcp_f32 v63, v63
    v_pk_mul_f32 v[48:49], v[16:17], v[48:49]
    v_pk_mul_f32 v[50:51], v[18:19], v[50:51]
    v_pk_mul_f32 v[52:53], v[20:21], v[52:53]
    v_pk_mul_f32 v[54:55], v[22:23], v[54:55]
    v_pk_mul_f32 v[56:57], v[24:25], v[56:57]
    v_pk_mul_f32 v[58:59], v[26:27], v[58:59]
    v_pk_mul_f32 v[60:61], v[28:29], v[60:61]
    v_pk_mul_f32 v[62:63], v[30:31], v[62:63]
    v_pk_fma_f32 v[96:97], v[48:49], v[48:49], v[96:97]
    v_pk_fma_f32 v[96:97], v[50:51], v[50:51], v[96:97]
    v_pk_fma_f32 v[96:97], v[52:53], v[52:53], v[96:97]
    v_pk_fma_f32 v[96:97], v[54:55], v[54:55], v[96:97]
    v_pk_fma_f32 v[96:97], v[56:57], v[56:57], v[96:97]
    v_pk_fma_f32 v[96:97], v[58:59], v[58:59], v[96:97]
    v_pk_fma_f32 v[96:97], v[60:61], v[60:61], v[96:97]
    v_pk_fma_f32 v[96:97], v[62:63], v[62:63], v[96:97]
    v_pk_fma_f32 v[48:49], v[32:33], v[32:33], s[52:53]
    v_pk_fma_f32 v[50:51], v[34:35], v[34:35], s[52:53]
    v_pk_fma_f32 v[52:53], v[36:37], v[36:37], s[52:53]
    v_pk_fma_f32 v[54:55], v[38:39], v[38:39], s[52:53]
    v_pk_fma_f32 v[56:57], v[40:41], v[40:41], s[52:53]
    v_pk_fma_f32 v[58:59], v[42:43], v[42:43], s[52:53]
    v_pk_fma_f32 v[60:61], v[44:45], v[44:45], s[52:53]
    v_pk_fma_f32 v[62:63], v[46:47], v[46:47], s[52:53]
    v_pk_mul_f32 v[48:49], v[48:49], v[32:33] neg_lo:[1,0] neg_hi:[1,0]
    v_pk_mul_f32 v[50:51], v[50:51], v[34:35] neg_lo:[1,0] neg_hi:[1,0]
    v_pk_mul_f32 v[52:53], v[52:53], v[36:37] neg_lo:[1,0] neg_hi:[1,0]
    v_pk_mul_f32 v[54:55], v[54:55], v[38:39] neg_lo:[1,0] neg_hi:[1,0]
    v_pk_mul_f32 v[56:57], v[56:57], v[40:41] neg_lo:[1,0] neg_hi:[1,0]
    v_pk_mul_f32 v[58:59], v[58:59], v[42:43] neg_lo:[1,0] neg_hi:[1,0]
    v_pk_mul_f32 v[60:61], v[60:61], v[44:45] neg_lo:[1,0] neg_hi:[1,0]
    v_pk_mul_f32 v[62:63], v[62:63], v[46:47] neg_lo:[1,0] neg_hi:[1,0]
L_pf4:
    v_mfma_f32_32x32x16_bf16 v[16:31], v[72:75], a[80:83], 0
    s_mov_b32 s63, L_pf4-L_pc+12288
    buffer_load_dword v6, v7, s[68:71], s63 offen
    v_exp_f32 v48, v48
    v_exp_f32 v49, v49
    v_exp_f32 v50, v50
    v_mfma_f32_32x32x16_bf16 v[16:31], v[76:79], a[84:87], v[16:31]
    v_exp_f32 v51, v51
    v_exp_f32 v52, v52
    v_exp_f32 v53, v53
    v_exp_f32 v54, v54
    v_exp_f32 v55, v55
    v_exp_f32 v56, v56
    v_exp_f32 v57, v57
    v_exp_f32 v58, v58
    v_exp_f32 v59, v59
    v_exp_f32 v60, v60
    v_exp_f32 v61, v61
    v_exp_f32 v62, v62
    v_exp_f32 v63, v63
    v_pk_add_f32 v[48:49], v[48:49], 1.0 op_sel_hi:[1,0]
    v_pk_add_f32 v[50:51], v[50:51], 1.0 op_sel_hi:[1,0]
    v_pk_add_f32 v[52:53], v[52:53], 1.0 op_sel_hi:[1,0]
    v_pk_add_f32 v[54:55], v[54:55], 1.0 op_sel_hi:[1,0]
    v_pk_add_f32 v[56:57], v[56:57], 1.0 op_sel_hi:[1,0]
    v_pk_add_f32 v[58:59], v[58:59], 1.0 op_sel_hi:[1,0]
    v_pk_add_f32 v[60:61], v[60:61], 1.0 op_sel_hi:[1,0]
    v_pk_add_f32 v[62:63], v[62:63], 1.0 op_sel_hi:[1,0]
    v_mfma_f32_32x32x16_bf16 v[16:31], v[80:83], a[88:91], v[16:31]
    v_rcp_f32 v48, v48
    v_rcp_f32 v49, v49
    v_rcp_f32 v50, v50
    v_mfma_f32_32x32x16_bf16 v[16:31], v[84:87], a[92:95], v[16:31]
    v_rcp_f32 v51, v51
    v_rcp_f32 v52, v52
    v_rcp_f32 v53, v53
    v_mfma_f32_32x32x16_bf16 v[16:31], v[88:91], a[96:99], v[16:31]
    v_rcp_f32 v54, v54
    v_rcp_f32 v55, v55
    v_rcp_f32 v56, v56
    v_mfma_f32_32x32x16_bf16 v[16:31], v[92:95], a[100:103], v[16:31]
    v_rcp_f32 v57, v57
    v_rcp_f32 v58, v58
    v_rcp_f32 v59, v59
    v_rcp_f32 v60, v60
    v_rcp_f32 v61, v61
    v_rcp_f32 v62, v62
    v_rcp_f32 v63, v63
    v_pk_mul_f32 v[48:49], v[32:33], v[48:49]
    v_pk_mul_f32 v[50:51], v[34:35], v[50:51]
    v_pk_mul_f32 v[52:53], v[36:37], v[52:53]
    v_pk_mul_f32 v[54:55], v[38:39], v[54:55]
    v_pk_mul_f32 v[56:57], v[40:41], v[56:57]
    v_pk_mul_f32 v[58:59], v[42:43], v[58:59]
    v_pk_mul_f32 v[60:61], v[44:45], v[60:61]
    v_pk_mul_f32 v[62:63], v[46:47], v[62:63]
    v_pk_fma_f32 v[98:99], v[48:49], v[48:49], v[98:99]
    v_pk_fma_f32 v[98:99], v[50:51], v[50:51], v[98:99]
    v_pk_fma_f32 v[98:99], v[52:53], v[52:53], v[98:99]
    v_pk_fma_f32 v[98:99], v[54:55], v[54:55], v[98:99]
    v_pk_fma_f32 v[98:99], v[56:57], v[56:57], v[98:99]
    v_pk_fma_f32 v[98:99], v[58:59], v[58:59], v[98:99]
    v_pk_fma_f32 v[98:99], v[60:61], v[60:61], v[98:99]
    v_pk_fma_f32 v[98:99], v[62:63], v[62:63], v[98:99]
    v_pk_fma_f32 v[48:49], v[16:17], v[16:17], s[52:53]
    v_pk_fma_f32 v[50:51], v[18:19], v[18:19], s[52:53]
    v_pk_fma_f32 v[52:53], v[20:21], v[20:21], s[52:53]
    v_pk_fma_f32 v[54:55], v[22:23], v[22:23], s[52:53]
    v_pk_fma_f32 v[56:57], v[24:25], v[24:25], s[52:53]
    v_pk_fma_f32 v[58:59], v[26:27], v[26:27], s[52:53]
    v_pk_fma_f32 v[60:61], v[28:29], v[28:29], s[52:53]
    v_pk_fma_f32 v[62:63], v[30:31], v[30:31], s[52:53]
    v_pk_mul_f32 v[48:49], v[48:49], v[16:17] neg_lo:[1,0] neg_hi:[1,0]
    v_pk_mul_f32 v[50:51], v[50:51], v[18:19] neg_lo:[1,0] neg_hi:[1,0]
    v_pk_mul_f32 v[52:53], v[52:53], v[20:21] neg_lo:[1,0] neg_hi:[1,0]
    v_pk_mul_f32 v[54:55], v[54:55], v[22:23] neg_lo:[1,0] neg_hi:[1,0]
    v_pk_mul_f32 v[56:57], v[56:57], v[24:25] neg_lo:[1,0] neg_hi:[1,0]
    v_pk_mul_f32 v[58:59], v[58:59], v[26:27] neg_lo:[1,0] neg_hi:[1,0]
    v_pk_mul_f32 v[60:61], v[60:61], v[28:29] neg_lo:[1,0] neg_hi:[1,0]
    v_pk_mul_f32 v[62:63], v[62:63], v[30:31] neg_lo:[1,0] neg_hi:[1,0]
    v_mfma_f32_32x32x16_bf16 v[32:47], v[72:75], a[104:107], 0
    v_exp_f32 v48, v48
    v_exp_f32 v49, v49
    v_exp_f32 v50, v50
    v_mfma_f32_32x32x16_bf16 v[32:47], v[76:79], a[108:111], v[32:47]
    v_exp_f32 v51, v51
    v_exp_f32 v52, v52
    v_exp_f32 v53, v53
    v_exp_f32 v54, v54
    v_exp_f32 v55, v55
    v_exp_f32 v56, v56
    v_exp_f32 v57, v57
    v_exp_f32 v58, v58
    v_exp_f32 v59, v59
    v_exp_f32 v60, v60
    v_exp_f32 v61, v61
    v_exp_f32 v62, v62
    v_exp_f32 v63, v63
    v_pk_add_f32 v[48:49], v[48:49], 1.0 op_sel_hi:[1,0]
    v_pk_add_f32 v[50:51], v[50:51], 1.0 op_sel_hi:[1,0]
    v_pk_add_f32 v[52:53], v[52:53], 1.0 op_sel_hi:[1,0]
    v_pk_add_f32 v[54:55], v[54:55], 1.0 op_sel_hi:[1,0]
    v_pk_add_f32 v[56:57], v[56:57], 1.0 op_sel_hi:[1,0]
    v_pk_add_f32 v[58:59], v[58:59], 1.0 op_sel_hi:[1,0]
    v_pk_add_f32 v[60:61], v[60:61], 1.0 op_sel_hi:[1,0]
    v_pk_add_f32 v[62:63], v[62:63], 1.0 op_sel_hi:[1,0]
    v_mfma_f32_32x32x16_bf16 v[32:47], v[80:83], a[112:115], v[32:47]
    v_rcp_f32 v48, v48
    v_rcp_f32 v49, v49
    v_rcp_f32 v50, v50
    v_mfma_f32_32x32x16_bf16 v[32:47], v[84:87], a[116:119], v[32:47]
    v_rcp_f32 v51, v51
    v_rcp_f32 v52, v52
    v_rcp_f32 v53, v53
    v_mfma_f32_32x32x16_bf16 v[32:47], v[88:91], a[120:123], v[32:47]
    v_rcp_f32 v54, v54
    v_rcp_f32 v55, v55
    v_rcp_f32 v56, v56
    v_mfma_f32_32x32x16_bf16 v[32:47], v[92:95], a[124:127], v[32:47]
    v_rcp_f32 v57, v57
    v_rcp_f32 v58, v58
    v_rcp_f32 v59, v59
    v_rcp_f32 v60, v60
    v_rcp_f32 v61, v61
    v_rcp_f32 v62, v62
    v_rcp_f32 v63, v63
    v_pk_mul_f32 v[48:49], v[16:17], v[48:49]
    v_pk_mul_f32 v[50:51], v[18:19], v[50:51]
    v_pk_mul_f32 v[52:53], v[20:21], v[52:53]
    v_pk_mul_f32 v[54:55], v[22:23], v[54:55]
    v_pk_mul_f32 v[56:57], v[24:25], v[56:57]
    v_pk_mul_f32 v[58:59], v[26:27], v[58:59]
    v_pk_mul_f32 v[60:61], v[28:29], v[60:61]
    v_pk_mul_f32 v[62:63], v[30:31], v[62:63]
    v_pk_fma_f32 v[100:101], v[48:49], v[48:49], v[100:101]
    v_pk_fma_f32 v[100:101], v[50:51], v[50:51], v[100:101]
    v_pk_fma_f32 v[100:101], v[52:53], v[52:53], v[100:101]
    v_pk_fma_f32 v[100:101], v[54:55], v[54:55], v[100:101]
    v_pk_fma_f32 v[100:101], v[56:57], v[56:57], v[100:101]
    v_pk_fma_f32 v[100:101], v[58:59], v[58:59], v[100:101]
    v_pk_fma_f32 v[100:101], v[60:61], v[60:61], v[100:101]
    v_pk_fma_f32 v[100:101], v[62:63], v[62:63], v[100:101]
    v_pk_fma_f32 v[48:49], v[32:33], v[32:33], s[52:53]
    v_pk_fma_f32 v[50:51], v[34:35], v[34:35], s[52:53]
    v_pk_fma_f32 v[52:53], v[36:37], v[36:37], s[52:53]
    v_pk_fma_f32 v[54:55], v[38:39], v[38:39], s[52:53]
    v_pk_fma_f32 v[56:57], v[40:41], v[40:41], s[52:53]
    v_pk_fma_f32 v[58:59], v[42:43], v[42:43], s[52:53]
    v_pk_fma_f32 v[60:61], v[44:45], v[44:45], s[52:53]
    v_pk_fma_f32 v[62:63], v[46:47], v[46:47], s[52:53]
    v_pk_mul_f32 v[48:49], v[48:49], v[32:33] neg_lo:[1,0] neg_hi:[1,0]
    v_pk_mul_f32 v[50:51], v[50:51], v[34:35] neg_lo:[1,0] neg_hi:[1,0]
    v_pk_mul_f32 v[52:53], v[52:53], v[36:37] neg_lo:[1,0] neg_hi:[1,0]
    v_pk_mul_f32 v[54:55], v[54:55], v[38:39] neg_lo:[1,0] neg_hi:[1,0]
    v_pk_mul_f32 v[56:57], v[56:57], v[40:41] neg_lo:[1,0] neg_hi:[1,0]
    v_pk_mul_f32 v[58:59], v[58:59], v[42:43] neg_lo:[1,0] neg_hi:[1,0]
    v_pk_mul_f32 v[60:61], v[60:61], v[44:45] neg_lo:[1,0] neg_hi:[1,0]
    v_pk_mul_f32 v[62:63], v[62:63], v[46:47] neg_lo:[1,0] neg_hi:[1,0]
    v_mfma_f32_32x32x16_bf16 v[16:31], v[72:75], a[128:131], 0
    v_exp_f32 v48, v48
    v_exp_f32 v49, v49
    v_exp_f32 v50, v50
    v_mfma_f32_32x32x16_bf16 v[16:31], v[76:79], a[132:135], v[16:31]
    v_exp_f32 v51, v51
    v_exp_f32 v52, v52
    v_exp_f32 v53, v53
    v_exp_f32 v54, v54
    v_exp_f32 v55, v55
    v_exp_f32 v56, v56
    v_exp_f32 v57, v57
    v_exp_f32 v58, v58
    v_exp_f32 v59, v59
    v_exp_f32 v60, v60
    v_exp_f32 v61, v61
    v_exp_f32 v62, v62
    v_exp_f32 v63, v63
    v_pk_add_f32 v[48:49], v[48:49], 1.0 op_sel_hi:[1,0]
    v_pk_add_f32 v[50:51], v[50:51], 1.0 op_sel_hi:[1,0]
    v_pk_add_f32 v[52:53], v[52:53], 1.0 op_sel_hi:[1,0]
    v_pk_add_f32 v[54:55], v[54:55], 1.0 op_sel_hi:[1,0]
    v_pk_add_f32 v[56:57], v[56:57], 1.0 op_sel_hi:[1,0]
    v_pk_add_f32 v[58:59], v[58:59], 1.0 op_sel_hi:[1,0]
    v_pk_add_f32 v[60:61], v[60:61], 1.0 op_sel_hi:[1,0]
    v_pk_add_f32 v[62:63], v[62:63], 1.0 op_sel_hi:[1,0]
    v_mfma_f32_32x32x16_bf16 v[16:31], v[80:83], a[136:139], v[16:31]
    v_rcp_f32 v48, v48
    v_rcp_f32 v49, v49
    v_rcp_f32 v50, v50
    v_mfma_f32_32x32x16_bf16 v[16:31], v[84:87], a[140:143], v[16:31]
    v_rcp_f32 v51, v51
    v_rcp_f32 v52, v52
    v_rcp_f32 v53, v53
    v_mfma_f32_32x32x16_bf16 v[16:31], v[88:91], a[144:147], v[16:31]
    v_rcp_f32 v54, v54
    v_rcp_f32 v55, v55
    v_rcp_f32 v56, v56
    v_mfma_f32_32x32x16_bf16 v[16:31], v[92:95], a[148:151], v[16:31]
    v_rcp_f32 v57, v57
    v_rcp_f32 v58, v58
    v_rcp_f32 v59, v59
    v_rcp_f32 v60, v60
    v_rcp_f32 v61, v61
    v_rcp_f32 v62, v62
    v_rcp_f32 v63, v63
    v_pk_mul_f32 v[48:49], v[32:33], v[48:49]
    v_pk_mul_f32 v[50:51], v[34:35], v[50:51]
    v_pk_mul_f32 v[52:53], v[36:37], v[52:53]
    v_pk_mul_f32 v[54:55], v[38:39], v[54:55]
    v_pk_mul_f32 v[56:57], v[40:41], v[56:57]
    v_pk_mul_f32 v[58:59], v[42:43], v[58:59]
    v_pk_mul_f32 v[60:61], v[44:45], v[60:61]
    v_pk_mul_f32 v[62:63], v[46:47], v[62:63]
    v_pk_fma_f32 v[102:103], v[48:49], v[48:49], v[102:103]
    v_pk_fma_f32 v[102:103], v[50:51], v[50:51], v[102:103]
    v_pk_fma_f32 v[102:103], v[52:53], v[52:53], v[102:103]
    v_pk_fma_f32 v[102:103], v[54:55], v[54:55], v[102:103]
    v_pk_fma_f32 v[102:103], v[56:57], v[56:57], v[102:103]
    v_pk_fma_f32 v[102:103], v[58:59], v[58:59], v[102:103]
    v_pk_fma_f32 v[102:103], v[60:61], v[60:61], v[102:103]
    v_pk_fma_f32 v[102:103], v[62:63], v[62:63], v[102:103]
    v_pk_fma_f32 v[48:49], v[16:17], v[16:17], s[52:53]
    v_pk_fma_f32 v[50:51], v[18:19], v[18:19], s[52:53]
    v_pk_fma_f32 v[52:53], v[20:21], v[20:21], s[52:53]
    v_pk_fma_f32 v[54:55], v[22:23], v[22:23], s[52:53]
    v_pk_fma_f32 v[56:57], v[24:25], v[24:25], s[52:53]
    v_pk_fma_f32 v[58:59], v[26:27], v[26:27], s[52:53]
    v_pk_fma_f32 v[60:61], v[28:29], v[28:29], s[52:53]
    v_pk_fma_f32 v[62:63], v[30:31], v[30:31], s[52:53]
    v_pk_mul_f32 v[48:49], v[48:49], v[16:17] neg_lo:[1,0] neg_hi:[1,0]
    v_pk_mul_f32 v[50:51], v[50:51], v[18:19] neg_lo:[1,0] neg_hi:[1,0]
    v_pk_mul_f32 v[52:53], v[52:53], v[20:21] neg_lo:[1,0] neg_hi:[1,0]
    v_pk_mul_f32 v[54:55], v[54:55], v[22:23] neg_lo:[1,0] neg_hi:[1,0]
    v_pk_mul_f32 v[56:57], v[56:57], v[24:25] neg_lo:[1,0] neg_hi:[1,0]
    v_pk_mul_f32 v[58:59], v[58:59], v[26:27] neg_lo:[1,0] neg_hi:[1,0]
    v_pk_mul_f32 v[60:61], v[60:61], v[28:29] neg_lo:[1,0] neg_hi:[1,0]
    v_pk_mul_f32 v[62:63], v[62:63], v[30:31] neg_lo:[1,0] neg_hi:[1,0]
    v_mfma_f32_32x32x16_bf16 v[32:47], v[72:75], a[152:155], 0
    v_exp_f32 v48, v48
    v_exp_f32 v49, v49
    v_exp_f32 v50, v50
    v_mfma_f32_32x32x16_bf16 v[32:47], v[76:79], a[156:159], v[32:47]
    v_exp_f32 v51, v51
    v_exp_f32 v52, v52
    v_exp_f32 v53, v53
    v_exp_f32 v54, v54
    v_exp_f32 v55, v55
    v_exp_f32 v56, v56
    v_exp_f32 v57, v57
    v_exp_f32 v58, v58
    v_exp_f32 v59, v59
    v_exp_f32 v60, v60
    v_exp_f32 v61, v61
    v_exp_f32 v62, v62
    v_exp_f32 v63, v63
    v_pk_add_f32 v[48:49], v[48:49], 1.0 op_sel_hi:[1,0]
    v_pk_add_f32 v[50:51], v[50:51], 1.0 op_sel_hi:[1,0]
    v_pk_add_f32 v[52:53], v[52:53], 1.0 op_sel_hi:[1,0]
    v_pk_add_f32 v[54:55], v[54:55], 1.0 op_sel_hi:[1,0]
    v_pk_add_f32 v[56:57], v[56:57], 1.0 op_sel_hi:[1,0]
    v_pk_add_f32 v[58:59], v[58:59], 1.0 op_sel_hi:[1,0]
    v_pk_add_f32 v[60:61], v[60:61], 1.0 op_sel_hi:[1,0]
    v_pk_add_f32 v[62:63], v[62:63], 1.0 op_sel_hi:[1,0]
    v_mfma_f32_32x32x16_bf16 v[32:47], v[80:83], a[160:163], v[32:47]
    v_rcp_f32 v48, v48
    v_rcp_f32 v49, v49
    v_rcp_f32 v50, v50
    v_mfma_f32_32x32x16_bf16 v[32:47], v[84:87], a[164:167], v[32:47]
    v_rcp_f32 v51, v51
    v_rcp_f32 v52, v52
    v_rcp_f32 v53, v53
    v_mfma_f32_32x32x16_bf16 v[32:47], v[88:91], a[168:171], v[32:47]
    v_rcp_f32 v54, v54
    v_rcp_f32 v55, v55
    v_rcp_f32 v56, v56
    v_mfma_f32_32x32x16_bf16 v[32:47], v[92:95], a[172:175], v[32:47]
    v_rcp_f32 v57, v57
    v_rcp_f32 v58, v58
    v_rcp_f32 v59, v59
    v_rcp_f32 v60, v60
    v_rcp_f32 v61, v61
    v_rcp_f32 v62, v62
    v_rcp_f32 v63, v63
    v_pk_mul_f32 v[48:49], v[16:17], v[48:49]
    v_pk_mul_f32 v[50:51], v[18:19], v[50:51]
    v_pk_mul_f32 v[52:53], v[20:21], v[52:53]
    v_pk_mul_f32 v[54:55], v[22:23], v[54:55]
    v_pk_mul_f32 v[56:57], v[24:25], v[56:57]
    v_pk_mul_f32 v[58:59], v[26:27], v[58:59]
    v_pk_mul_f32 v[60:61], v[28:29], v[60:61]
    v_pk_mul_f32 v[62:63], v[30:31], v[62:63]
    v_pk_fma_f32 v[104:105], v[48:49], v[48:49], v[104:105]
    v_pk_fma_f32 v[104:105], v[50:51], v[50:51], v[104:105]
    v_pk_fma_f32 v[104:105], v[52:53], v[52:53], v[104:105]
    v_pk_fma_f32 v[104:105], v[54:55], v[54:55], v[104:105]
    v_pk_fma_f32 v[104:105], v[56:57], v[56:57], v[104:105]
    v_pk_fma_f32 v[104:105], v[58:59], v[58:59], v[104:105]
    v_pk_fma_f32 v[104:105], v[60:61], v[60:61], v[104:105]
    v_pk_fma_f32 v[104:105], v[62:63], v[62:63], v[104:105]
    v_pk_fma_f32 v[48:49], v[32:33], v[32:33], s[52:53]
    v_pk_fma_f32 v[50:51], v[34:35], v[34:35], s[52:53]
    v_pk_fma_f32 v[52:53], v[36:37], v[36:37], s[52:53]
    v_pk_fma_f32 v[54:55], v[38:39], v[38:39], s[52:53]
    v_pk_fma_f32 v[56:57], v[40:41], v[40:41], s[52:53]
    v_pk_fma_f32 v[58:59], v[42:43], v[42:43], s[52:53]
    v_pk_fma_f32 v[60:61], v[44:45], v[44:45], s[52:53]
    v_pk_fma_f32 v[62:63], v[46:47], v[46:47], s[52:53]
    v_pk_mul_f32 v[48:49], v[48:49], v[32:33] neg_lo:[1,0] neg_hi:[1,0]
    v_pk_mul_f32 v[50:51], v[50:51], v[34:35] neg_lo:[1,0] neg_hi:[1,0]
    v_pk_mul_f32 v[52:53], v[52:53], v[36:37] neg_lo:[1,0] neg_hi:[1,0]
    v_pk_mul_f32 v[54:55], v[54:55], v[38:39] neg_lo:[1,0] neg_hi:[1,0]
    v_pk_mul_f32 v[56:57], v[56:57], v[40:41] neg_lo:[1,0] neg_hi:[1,0]
    v_pk_mul_f32 v[58:59], v[58:59], v[42:43] neg_lo:[1,0] neg_hi:[1,0]
    v_pk_mul_f32 v[60:61], v[60:61], v[44:45] neg_lo:[1,0] neg_hi:[1,0]
    v_pk_mul_f32 v[62:63], v[62:63], v[46:47] neg_lo:[1,0] neg_hi:[1,0]
    v_mfma_f32_32x32x16_bf16 v[16:31], v[72:75], a[176:179], 0
    v_exp_f32 v48, v48
    v_exp_f32 v49, v49
    v_exp_f32 v50, v50
    v_mfma_f32_32x32x16_bf16 v[16:31], v[76:79], a[180:183], v[16:31]
    v_exp_f32 v51, v51
    v_exp_f32 v52, v52
    v_exp_f32 v53, v53
    v_exp_f32 v54, v54
    v_exp_f32 v55, v55
    v_exp_f32 v56, v56
    v_exp_f32 v57, v57
    v_exp_f32 v58, v58
    v_exp_f32 v59, v59
    v_exp_f32 v60, v60
    v_exp_f32 v61, v61
    v_exp_f32 v62, v62
    v_exp_f32 v63, v63
    v_pk_add_f32 v[48:49], v[48:49], 1.0 op_sel_hi:[1,0]
    v_pk_add_f32 v[50:51], v[50:51], 1.0 op_sel_hi:[1,0]
    v_pk_add_f32 v[52:53], v[52:53], 1.0 op_sel_hi:[1,0]
    v_pk_add_f32 v[54:55], v[54:55], 1.0 op_sel_hi:[1,0]
    v_pk_add_f32 v[56:57], v[56:57], 1.0 op_sel_hi:[1,0]
    v_pk_add_f32 v[58:59], v[58:59], 1.0 op_sel_hi:[1,0]
    v_pk_add_f32 v[60:61], v[60:61], 1.0 op_sel_hi:[1,0]
    v_pk_add_f32 v[62:63], v[62:63], 1.0 op_sel_hi:[1,0]
    v_mfma_f32_32x32x16_bf16 v[16:31], v[80:83], a[184:187], v[16:31]
    v_rcp_f32 v48, v48
    v_rcp_f32 v49, v49
    v_rcp_f32 v50, v50
    v_mfma_f32_32x32x16_bf16 v[16:31], v[84:87], a[188:191], v[16:31]
    v_rcp_f32 v51, v51
    v_rcp_f32 v52, v52
    v_rcp_f32 v53, v53
    v_mfma_f32_32x32x16_bf16 v[16:31], v[88:91], a[192:195], v[16:31]
    v_rcp_f32 v54, v54
    v_rcp_f32 v55, v55
    v_rcp_f32 v56, v56
    v_mfma_f32_32x32x16_bf16 v[16:31], v[92:95], a[196:199], v[16:31]
    v_rcp_f32 v57, v57
    v_rcp_f32 v58, v58
    v_rcp_f32 v59, v59
    v_rcp_f32 v60, v60
    v_rcp_f32 v61, v61
    v_rcp_f32 v62, v62
    v_rcp_f32 v63, v63
    v_pk_mul_f32 v[48:49], v[32:33], v[48:49]
    v_pk_mul_f32 v[50:51], v[34:35], v[50:51]
    v_pk_mul_f32 v[52:53], v[36:37], v[52:53]
    v_pk_mul_f32 v[54:55], v[38:39], v[54:55]
    v_pk_mul_f32 v[56:57], v[40:41], v[56:57]
    v_pk_mul_f32 v[58:59], v[42:43], v[58:59]
    v_pk_mul_f32 v[60:61], v[44:45], v[60:61]
    v_pk_mul_f32 v[62:63], v[46:47], v[62:63]
    v_pk_fma_f32 v[106:107], v[48:49], v[48:49], v[106:107]
    v_pk_fma_f32 v[106:107], v[50:51], v[50:51], v[106:107]
    v_pk_fma_f32 v[106:107], v[52:53], v[52:53], v[106:107]
    v_pk_fma_f32 v[106:107], v[54:55], v[54:55], v[106:107]
    v_pk_fma_f32 v[106:107], v[56:57], v[56:57], v[106:107]
    v_pk_fma_f32 v[106:107], v[58:59], v[58:59], v[106:107]
    v_pk_fma_f32 v[106:107], v[60:61], v[60:61], v[106:107]
    v_pk_fma_f32 v[106:107], v[62:63], v[62:63], v[106:107]
    v_pk_fma_f32 v[48:49], v[16:17], v[16:17], s[52:53]
    v_pk_fma_f32 v[50:51], v[18:19], v[18:19], s[52:53]
    v_pk_fma_f32 v[52:53], v[20:21], v[20:21], s[52:53]
    v_pk_fma_f32 v[54:55], v[22:23], v[22:23], s[52:53]
    v_pk_fma_f32 v[56:57], v[24:25], v[24:25], s[52:53]
    v_pk_fma_f32 v[58:59], v[26:27], v[26:27], s[52:53]
    v_pk_fma_f32 v[60:61], v[28:29], v[28:29], s[52:53]
    v_pk_fma_f32 v[62:63], v[30:31], v[30:31], s[52:53]
    v_pk_mul_f32 v[48:49], v[48:49], v[16:17] neg_lo:[1,0] neg_hi:[1,0]
    v_pk_mul_f32 v[50:51], v[50:51], v[18:19] neg_lo:[1,0] neg_hi:[1,0]
    v_pk_mul_f32 v[52:53], v[52:53], v[20:21] neg_lo:[1,0] neg_hi:[1,0]
    v_pk_mul_f32 v[54:55], v[54:55], v[22:23] neg_lo:[1,0] neg_hi:[1,0]
    v_pk_mul_f32 v[56:57], v[56:57], v[24:25] neg_lo:[1,0] neg_hi:[1,0]
    v_pk_mul_f32 v[58:59], v[58:59], v[26:27] neg_lo:[1,0] neg_hi:[1,0]
    v_pk_mul_f32 v[60:61], v[60:61], v[28:29] neg_lo:[1,0] neg_hi:[1,0]
    v_pk_mul_f32 v[62:63], v[62:63], v[30:31] neg_lo:[1,0] neg_hi:[1,0]
    v_mfma_f32_32x32x16_bf16 v[32:47], v[72:75], a[200:203], 0
    v_exp_f32 v48, v48
    v_exp_f32 v49, v49
    v_exp_f32 v50, v50
    v_mfma_f32_32x32x16_bf16 v[32:47], v[76:79], a[204:207], v[32:47]
    v_exp_f32 v51, v51
    v_exp_f32 v52, v52
    v_exp_f32 v53, v53
    v_exp_f32 v54, v54
    v_exp_f32 v55, v55
    v_exp_f32 v56, v56
    v_exp_f32 v57, v57
    v_exp_f32 v58, v58
    v_exp_f32 v59, v59
    v_exp_f32 v60, v60
    v_exp_f32 v61, v61
    v_exp_f32 v62, v62
    v_exp_f32 v63, v63
    v_pk_add_f32 v[48:49], v[48:49], 1.0 op_sel_hi:[1,0]
    v_pk_add_f32 v[50:51], v[50:51], 1.0 op_sel_hi:[1,0]
    v_pk_add_f32 v[52:53], v[52:53], 1.0 op_sel_hi:[1,0]
    v_pk_add_f32 v[54:55], v[54:55], 1.0 op_sel_hi:[1,0]
    v_pk_add_f32 v[56:57], v[56:57], 1.0 op_sel_hi:[1,0]
    v_pk_add_f32 v[58:59], v[58:59], 1.0 op_sel_hi:[1,0]
    v_pk_add_f32 v[60:61], v[60:61], 1.0 op_sel_hi:[1,0]
    v_pk_add_f32 v[62:63], v[62:63], 1.0 op_sel_hi:[1,0]
    v_mfma_f32_32x32x16_bf16 v[32:47], v[80:83], a[208:211], v[32:47]
    v_rcp_f32 v48, v48
    v_rcp_f32 v49, v49
    v_rcp_f32 v50, v50
    v_mfma_f32_32x32x16_bf16 v[32:47], v[84:87], a[212:215], v[32:47]
    v_rcp_f32 v51, v51
    v_rcp_f32 v52, v52
    v_rcp_f32 v53, v53
    v_mfma_f32_32x32x16_bf16 v[32:47], v[88:91], a[216:219], v[32:47]
    v_rcp_f32 v54, v54
    v_rcp_f32 v55, v55
    v_rcp_f32 v56, v56
    v_mfma_f32_32x32x16_bf16 v[32:47], v[92:95], a[220:223], v[32:47]
    v_rcp_f32 v57, v57
    v_rcp_f32 v58, v58
    v_rcp_f32 v59, v59
    v_rcp_f32 v60, v60
    v_rcp_f32 v61, v61
    v_rcp_f32 v62, v62
    v_rcp_f32 v63, v63
    v_pk_mul_f32 v[48:49], v[16:17], v[48:49]
    v_pk_mul_f32 v[50:51], v[18:19], v[50:51]
    v_pk_mul_f32 v[52:53], v[20:21], v[52:53]
    v_pk_mul_f32 v[54:55], v[22:23], v[54:55]
    v_pk_mul_f32 v[56:57], v[24:25], v[56:57]
    v_pk_mul_f32 v[58:59], v[26:27], v[58:59]
    v_pk_mul_f32 v[60:61], v[28:29], v[60:61]
    v_pk_mul_f32 v[62:63], v[30:31], v[62:63]
    v_pk_fma_f32 v[108:109], v[48:49], v[48:49], v[108:109]
    v_pk_fma_f32 v[108:109], v[50:51], v[50:51], v[108:109]
    v_pk_fma_f32 v[108:109], v[52:53], v[52:53], v[108:109]
    v_pk_fma_f32 v[108:109], v[54:55], v[54:55], v[108:109]
    v_pk_fma_f32 v[108:109], v[56:57], v[56:57], v[108:109]
    v_pk_fma_f32 v[108:109], v[58:59], v[58:59], v[108:109]
    v_pk_fma_f32 v[108:109], v[60:61], v[60:61], v[108:109]
    v_pk_fma_f32 v[108:109], v[62:63], v[62:63], v[108:109]
    v_pk_fma_f32 v[48:49], v[32:33], v[32:33], s[52:53]
    v_pk_fma_f32 v[50:51], v[34:35], v[34:35], s[52:53]
    v_pk_fma_f32 v[52:53], v[36:37], v[36:37], s[52:53]
    v_pk_fma_f32 v[54:55], v[38:39], v[38:39], s[52:53]
    v_pk_fma_f32 v[56:57], v[40:41], v[40:41], s[52:53]
    v_pk_fma_f32 v[58:59], v[42:43], v[42:43], s[52:53]
    v_pk_fma_f32 v[60:61], v[44:45], v[44:45], s[52:53]
    v_pk_fma_f32 v[62:63], v[46:47], v[46:47], s[52:53]
    v_pk_mul_f32 v[48:49], v[48:49], v[32:33] neg_lo:[1,0] neg_hi:[1,0]
    v_pk_mul_f32 v[50:51], v[50:51], v[34:35] neg_lo:[1,0] neg_hi:[1,0]
    v_pk_mul_f32 v[52:53], v[52:53], v[36:37] neg_lo:[1,0] neg_hi:[1,0]
    v_pk_mul_f32 v[54:55], v[54:55], v[38:39] neg_lo:[1,0] neg_hi:[1,0]
    v_pk_mul_f32 v[56:57], v[56:57], v[40:41] neg_lo:[1,0] neg_hi:[1,0]
    v_pk_mul_f32 v[58:59], v[58:59], v[42:43] neg_lo:[1,0] neg_hi:[1,0]
    v_pk_mul_f32 v[60:61], v[60:61], v[44:45] neg_lo:[1,0] neg_hi:[1,0]
    v_pk_mul_f32 v[62:63], v[62:63], v[46:47] neg_lo:[1,0] neg_hi:[1,0]
    v_mfma_f32_32x32x16_bf16 v[16:31], v[72:75], v[160:163], 0
    v_exp_f32 v48, v48
    v_exp_f32 v49, v49
    v_exp_f32 v50, v50
    v_mfma_f32_32x32x16_bf16 v[16:31], v[76:79], v[164:167], v[16:31]
    v_exp_f32 v51, v51
    v_exp_f32 v52, v52
    v_exp_f32 v53, v53
    v_exp_f32 v54, v54
    v_exp_f32 v55, v55
    v_exp_f32 v56, v56
    v_exp_f32 v57, v57
    v_exp_f32 v58, v58
    v_exp_f32 v59, v59
    v_exp_f32 v60, v60
    v_exp_f32 v61, v61
    v_exp_f32 v62, v62
    v_exp_f32 v63, v63
    v_pk_add_f32 v[48:49], v[48:49], 1.0 op_sel_hi:[1,0]
    v_pk_add_f32 v[50:51], v[50:51], 1.0 op_sel_hi:[1,0]
    v_pk_add_f32 v[52:53], v[52:53], 1.0 op_sel_hi:[1,0]
    v_pk_add_f32 v[54:55], v[54:55], 1.0 op_sel_hi:[1,0]
    v_pk_add_f32 v[56:57], v[56:57], 1.0 op_sel_hi:[1,0]
    v_pk_add_f32 v[58:59], v[58:59], 1.0 op_sel_hi:[1,0]
    v_pk_add_f32 v[60:61], v[60:61], 1.0 op_sel_hi:[1,0]
    v_pk_add_f32 v[62:63], v[62:63], 1.0 op_sel_hi:[1,0]
    v_mfma_f32_32x32x16_bf16 v[16:31], v[80:83], v[168:171], v[16:31]
    s_waitcnt vmcnt(1)
    s_mul_i32 s59, s57, 18432
    s_add_u32 s59, s59, 5120
    s_add_u32 m0, s59, 73728
    s_nop 0
    buffer_load_dwordx4 v2, s[36:39], s59 offen lds
    v_rcp_f32 v48, v48
    v_mfma_f32_32x32x16_bf16 v[16:31], v[84:87], v[172:175], v[16:31]
    v_rcp_f32 v49, v49
    v_rcp_f32 v50, v50
    v_rcp_f32 v51, v51
    v_mfma_f32_32x32x16_bf16 v[16:31], v[88:91], v[176:179], v[16:31]
    v_rcp_f32 v52, v52
    v_rcp_f32 v53, v53
    v_rcp_f32 v54, v54
    v_mfma_f32_32x32x16_bf16 v[16:31], v[92:95], v[180:183], v[16:31]
    v_rcp_f32 v55, v55
    v_rcp_f32 v56, v56
    v_rcp_f32 v57, v57
    v_rcp_f32 v58, v58
    v_rcp_f32 v59, v59
    v_rcp_f32 v60, v60
    v_rcp_f32 v61, v61
    v_rcp_f32 v62, v62
    v_rcp_f32 v63, v63
    v_pk_mul_f32 v[48:49], v[32:33], v[48:49]
    v_pk_mul_f32 v[50:51], v[34:35], v[50:51]
    v_pk_mul_f32 v[52:53], v[36:37], v[52:53]
    v_pk_mul_f32 v[54:55], v[38:39], v[54:55]
    v_pk_mul_f32 v[56:57], v[40:41], v[56:57]
    v_pk_mul_f32 v[58:59], v[42:43], v[58:59]
    v_pk_mul_f32 v[60:61], v[44:45], v[60:61]
    v_pk_mul_f32 v[62:63], v[46:47], v[62:63]
    v_pk_fma_f32 v[110:111], v[48:49], v[48:49], v[110:111]
    v_pk_fma_f32 v[110:111], v[50:51], v[50:51], v[110:111]
    v_pk_fma_f32 v[110:111], v[52:53], v[52:53], v[110:111]
    v_pk_fma_f32 v[110:111], v[54:55], v[54:55], v[110:111]
    v_pk_fma_f32 v[110:111], v[56:57], v[56:57], v[110:111]
    v_pk_fma_f32 v[110:111], v[58:59], v[58:59], v[110:111]
    v_pk_fma_f32 v[110:111], v[60:61], v[60:61], v[110:111]
    v_pk_fma_f32 v[110:111], v[62:63], v[62:63], v[110:111]
    v_pk_fma_f32 v[48:49], v[16:17], v[16:17], s[52:53]
    v_pk_fma_f32 v[50:51], v[18:19], v[18:19], s[52:53]
    v_pk_fma_f32 v[52:53], v[20:21], v[20:21], s[52:53]
    v_pk_fma_f32 v[54:55], v[22:23], v[22:23], s[52:53]
    v_pk_fma_f32 v[56:57], v[24:25], v[24:25], s[52:53]
    v_pk_fma_f32 v[58:59], v[26:27], v[26:27], s[52:53]
    v_pk_fma_f32 v[60:61], v[28:29], v[28:29], s[52:53]
    v_pk_fma_f32 v[62:63], v[30:31], v[30:31], s[52:53]
    v_pk_mul_f32 v[48:49], v[48:49], v[16:17] neg_lo:[1,0] neg_hi:[1,0]
    v_pk_mul_f32 v[50:51], v[50:51], v[18:19] neg_lo:[1,0] neg_hi:[1,0]
    v_pk_mul_f32 v[52:53], v[52:53], v[20:21] neg_lo:[1,0] neg_hi:[1,0]
    v_pk_mul_f32 v[54:55], v[54:55], v[22:23] neg_lo:[1,0] neg_hi:[1,0]
    v_pk_mul_f32 v[56:57], v[56:57], v[24:25] neg_lo:[1,0] neg_hi:[1,0]
    v_pk_mul_f32 v[58:59], v[58:59], v[26:27] neg_lo:[1,0] neg_hi:[1,0]
    v_pk_mul_f32 v[60:61], v[60:61], v[28:29] neg_lo:[1,0] neg_hi:[1,0]
    v_pk_mul_f32 v[62:63], v[62:63], v[30:31] neg_lo:[1,0] neg_hi:[1,0]
    v_mfma_f32_32x32x16_bf16 v[32:47], v[72:75], v[184:187], 0
    v_exp_f32 v48, v48
    v_exp_f32 v49, v49
    v_exp_f32 v50, v50
    v_mfma_f32_32x32x16_bf16 v[32:47], v[76:79], v[188:191], v[32:47]
    v_exp_f32 v51, v51
    v_exp_f32 v52, v52
    v_exp_f32 v53, v53
    v_mfma_f32_32x32x16_bf16 v[144:159], v[120:123], a[224:227], 0
    v_exp_f32 v54, v54
    v_exp_f32 v55, v55
    v_exp_f32 v56, v56
    v_mfma_f32_32x32x16_bf16 v[144:159], v[124:127], a[228:231], v[144:159]
    v_exp_f32 v57, v57
    v_exp_f32 v58, v58
    v_exp_f32 v59, v59
    v_exp_f32 v60, v60
    v_exp_f32 v61, v61
    v_exp_f32 v62, v62
    v_exp_f32 v63, v63
    v_pk_add_f32 v[48:49], v[48:49], 1.0 op_sel_hi:[1,0]
    v_pk_add_f32 v[50:51], v[50:51], 1.0 op_sel_hi:[1,0]
    v_pk_add_f32 v[52:53], v[52:53], 1.0 op_sel_hi:[1,0]
    v_pk_add_f32 v[54:55], v[54:55], 1.0 op_sel_hi:[1,0]
    v_pk_add_f32 v[56:57], v[56:57], 1.0 op_sel_hi:[1,0]
    v_pk_add_f32 v[58:59], v[58:59], 1.0 op_sel_hi:[1,0]
    v_pk_add_f32 v[60:61], v[60:61], 1.0 op_sel_hi:[1,0]
    v_pk_add_f32 v[62:63], v[62:63], 1.0 op_sel_hi:[1,0]
    v_pk_mul_f32 v[10:11], v[144:145], v[144:145]
    v_pk_add_f32 v[8:9], v[144:145], v[146:147]
    v_pk_fma_f32 v[10:11], v[146:147], v[146:147], v[10:11]
    v_pk_add_f32 v[8:9], v[8:9], v[148:149]
    v_pk_fma_f32 v[10:11], v[148:149], v[148:149], v[10:11]
    v_pk_add_f32 v[8:9], v[8:9], v[150:151]
    v_pk_fma_f32 v[10:11], v[150:151], v[150:151], v[10:11]
    v_pk_add_f32 v[8:9], v[8:9], v[152:153]
    v_pk_fma_f32 v[10:11], v[152:153], v[152:153], v[10:11]
    v_pk_add_f32 v[8:9], v[8:9], v[154:155]
    v_pk_fma_f32 v[10:11], v[154:155], v[154:155], v[10:11]
    v_pk_add_f32 v[8:9], v[8:9], v[156:157]
    v_pk_fma_f32 v[10:11], v[156:157], v[156:157], v[10:11]
    v_pk_add_f32 v[8:9], v[8:9], v[158:159]
    v_pk_fma_f32 v[10:11], v[158:159], v[158:159], v[10:11]
    v_mfma_f32_32x32x16_bf16 v[32:47], v[80:83], v[192:195], v[32:47]
    s_mul_i32 s59, s57, 18432
    s_add_u32 s59, s59, 6144
    s_add_u32 m0, s59, 73728
    s_nop 0
    buffer_load_dwordx4 v2, s[36:39], s59 offen lds
    v_rcp_f32 v48, v48
    v_mfma_f32_32x32x16_bf16 v[32:47], v[84:87], v[196:199], v[32:47]
    v_rcp_f32 v49, v49
    v_rcp_f32 v50, v50
    v_rcp_f32 v51, v51
    v_mfma_f32_32x32x16_bf16 v[32:47], v[88:91], v[200:203], v[32:47]
    v_rcp_f32 v52, v52
    v_rcp_f32 v53, v53
    v_rcp_f32 v54, v54
    v_mfma_f32_32x32x16_bf16 v[32:47], v[92:95], v[204:207], v[32:47]
    v_rcp_f32 v55, v55
    v_rcp_f32 v56, v56
    v_rcp_f32 v57, v57
    v_rcp_f32 v58, v58
    v_rcp_f32 v59, v59
    v_rcp_f32 v60, v60
    v_rcp_f32 v61, v61
    v_rcp_f32 v62, v62
    v_rcp_f32_e64 v63, v63
    v_pk_mul_f32 v[48:49], v[16:17], v[48:49]
    v_pk_mul_f32 v[50:51], v[18:19], v[50:51]
    v_pk_mul_f32 v[52:53], v[20:21], v[52:53]
    v_pk_mul_f32 v[54:55], v[22:23], v[54:55]
    v_pk_mul_f32 v[56:57], v[24:25], v[56:57]
    v_pk_mul_f32 v[58:59], v[26:27], v[58:59]
    v_pk_mul_f32 v[60:61], v[28:29], v[60:61]
    v_pk_mul_f32 v[62:63], v[30:31], v[62:63]
    v_pk_fma_f32 v[112:113], v[48:49], v[48:49], v[112:113]
    v_pk_fma_f32 v[112:113], v[50:51], v[50:51], v[112:113]
    v_pk_fma_f32 v[112:113], v[52:53], v[52:53], v[112:113]
    v_pk_fma_f32 v[112:113], v[54:55], v[54:55], v[112:113]
    v_pk_fma_f32 v[112:113], v[56:57], v[56:57], v[112:113]
    v_pk_fma_f32 v[112:113], v[58:59], v[58:59], v[112:113]
    v_pk_fma_f32 v[112:113], v[60:61], v[60:61], v[112:113]
    v_pk_fma_f32 v[112:113], v[62:63], v[62:63], v[112:113]
    v_pk_fma_f32 v[48:49], v[32:33], v[32:33], s[52:53]
    v_pk_fma_f32 v[50:51], v[34:35], v[34:35], s[52:53]
    v_pk_fma_f32 v[52:53], v[36:37], v[36:37], s[52:53]
    v_pk_fma_f32 v[54:55], v[38:39], v[38:39], s[52:53]
    v_pk_fma_f32 v[56:57], v[40:41], v[40:41], s[52:53]
    v_pk_fma_f32 v[58:59], v[42:43], v[42:43], s[52:53]
    v_pk_fma_f32 v[60:61], v[44:45], v[44:45], s[52:53]
    v_pk_fma_f32 v[62:63], v[46:47], v[46:47], s[52:53]
    v_pk_mul_f32 v[48:49], v[48:49], v[32:33] neg_lo:[1,0] neg_hi:[1,0]
    v_pk_mul_f32 v[50:51], v[50:51], v[34:35] neg_lo:[1,0] neg_hi:[1,0]
    v_pk_mul_f32 v[52:53], v[52:53], v[36:37] neg_lo:[1,0] neg_hi:[1,0]
    v_pk_mul_f32 v[54:55], v[54:55], v[38:39] neg_lo:[1,0] neg_hi:[1,0]
    v_pk_mul_f32 v[56:57], v[56:57], v[40:41] neg_lo:[1,0] neg_hi:[1,0]
    v_pk_mul_f32 v[58:59], v[58:59], v[42:43] neg_lo:[1,0] neg_hi:[1,0]
    v_pk_mul_f32 v[60:61], v[60:61], v[44:45] neg_lo:[1,0] neg_hi:[1,0]
    v_pk_mul_f32 v[62:63], v[62:63], v[46:47] neg_lo:[1,0] neg_hi:[1,0]
L_pf5:
    v_mfma_f32_32x32x16_bf16 v[16:31], v[72:75], v[208:211], 0
    s_mov_b32 s63, L_pf5-L_pc+12288
    buffer_load_dword v6, v7, s[68:71], s63 offen
    v_exp_f32 v48, v48
    v_exp_f32 v49, v49
    v_exp_f32 v50, v50
    v_mfma_f32_32x32x16_bf16 v[16:31], v[76:79], v[212:215], v[16:31]
    v_exp_f32 v51, v51
    v_exp_f32 v52, v52
    v_exp_f32 v53, v53
    v_mfma_f32_32x32x16_bf16 v[144:159], v[128:131], a[232:235], 0
    v_exp_f32 v54, v54
    v_exp_f32 v55, v55
    v_exp_f32 v56, v56
    v_mfma_f32_32x32x16_bf16 v[144:159], v[132:135], a[236:239], v[144:159]
    v_exp_f32 v57, v57
    v_exp_f32 v58, v58
    v_exp_f32 v59, v59
    v_exp_f32 v60, v60
    v_exp_f32 v61, v61
    v_exp_f32 v62, v62
    v_exp_f32 v63, v63
    v_pk_add_f32 v[48:49], v[48:49], 1.0 op_sel_hi:[1,0]
    v_pk_add_f32 v[50:51], v[50:51], 1.0 op_sel_hi:[1,0]
    v_pk_add_f32 v[52:53], v[52:53], 1.0 op_sel_hi:[1,0]
    v_pk_add_f32 v[54:55], v[54:55], 1.0 op_sel_hi:[1,0]
    v_pk_add_f32 v[56:57], v[56:57], 1.0 op_sel_hi:[1,0]
    v_pk_add_f32 v[58:59], v[58:59], 1.0 op_sel_hi:[1,0]
    v_pk_add_f32 v[60:61], v[60:61], 1.0 op_sel_hi:[1,0]
    v_pk_add_f32 v[62:63], v[62:63], 1.0 op_sel_hi:[1,0]
    v_pk_add_f32 v[8:9], v[8:9], v[144:145]
    v_pk_fma_f32 v[10:11], v[144:145], v[144:145], v[10:11]
    v_pk_add_f32 v[8:9], v[8:9], v[146:147]
    v_pk_fma_f32 v[10:11], v[146:147], v[146:147], v[10:11]
    v_pk_add_f32 v[8:9], v[8:9], v[148:149]
    v_pk_fma_f32 v[10:11], v[148:149], v[148:149], v[10:11]
    v_pk_add_f32 v[8:9], v[8:9], v[150:151]
    v_pk_fma_f32 v[10:11], v[150:151], v[150:151], v[10:11]
    v_pk_add_f32 v[8:9], v[8:9], v[152:153]
    v_pk_fma_f32 v[10:11], v[152:153], v[152:153], v[10:11]
    v_pk_add_f32 v[8:9], v[8:9], v[154:155]
    v_pk_fma_f32 v[10:11], v[154:155], v[154:155], v[10:11]
    v_pk_add_f32 v[8:9], v[8:9], v[156:157]
    v_pk_fma_f32 v[10:11], v[156:157], v[156:157], v[10:11]
    v_pk_add_f32 v[8:9], v[8:9], v[158:159]
    v_pk_fma_f32 v[10:11], v[158:159], v[158:159], v[10:11]
    v_mfma_f32_32x32x16_bf16 v[16:31], v[80:83], v[216:219], v[16:31]
    s_mul_i32 s59, s57, 18432
    s_add_u32 s59, s59, 7168
    s_add_u32 m0, s59, 73728
    s_nop 0
    buffer_load_dwordx4 v2, s[36:39], s59 offen lds
    v_rcp_f32 v48, v48
    v_mfma_f32_32x32x16_bf16 v[16:31], v[84:87], v[220:223], v[16:31]
    v_rcp_f32 v49, v49
    v_rcp_f32 v50, v50
    v_rcp_f32 v51, v51
    v_mfma_f32_32x32x16_bf16 v[16:31], v[88:91], v[224:227], v[16:31]
    v_rcp_f32 v52, v52
    v_rcp_f32 v53, v53
    v_rcp_f32 v54, v54
    v_mfma_f32_32x32x16_bf16 v[16:31], v[92:95], v[228:231], v[16:31]
    v_rcp_f32 v55, v55
    v_rcp_f32 v56, v56
    v_rcp_f32 v57, v57
    v_rcp_f32 v58, v58
    v_rcp_f32 v59, v59
    v_rcp_f32 v60, v60
    v_rcp_f32 v61, v61
    v_rcp_f32 v62, v62
    v_rcp_f32_e64 v63, v63
    v_pk_mul_f32 v[48:49], v[32:33], v[48:49]
    v_pk_mul_f32 v[50:51], v[34:35], v[50:51]
    v_pk_mul_f32 v[52:53], v[36:37], v[52:53]
    v_pk_mul_f32 v[54:55], v[38:39], v[54:55]
    v_pk_mul_f32 v[56:57], v[40:41], v[56:57]
    v_pk_mul_f32 v[58:59], v[42:43], v[58:59]
    v_pk_mul_f32 v[60:61], v[44:45], v[60:61]
    v_pk_mul_f32 v[62:63], v[46:47], v[62:63]
    v_pk_fma_f32 v[114:115], v[48:49], v[48:49], v[114:115]
    v_pk_fma_f32 v[114:115], v[50:51], v[50:51], v[114:115]
    v_pk_fma_f32 v[114:115], v[52:53], v[52:53], v[114:115]
    v_pk_fma_f32 v[114:115], v[54:55], v[54:55], v[114:115]
    v_pk_fma_f32 v[114:115], v[56:57], v[56:57], v[114:115]
    v_pk_fma_f32 v[114:115], v[58:59], v[58:59], v[114:115]
    v_pk_fma_f32 v[114:115], v[60:61], v[60:61], v[114:115]
    v_pk_fma_f32 v[114:115], v[62:63], v[62:63], v[114:115]
    v_pk_fma_f32 v[48:49], v[16:17], v[16:17], s[52:53]
    v_pk_fma_f32 v[50:51], v[18:19], v[18:19], s[52:53]
    v_pk_fma_f32 v[52:53], v[20:21], v[20:21], s[52:53]
    v_pk_fma_f32 v[54:55], v[22:23], v[22:23], s[52:53]
    v_pk_fma_f32 v[56:57], v[24:25], v[24:25], s[52:53]
    v_pk_fma_f32 v[58:59], v[26:27], v[26:27], s[52:53]
    v_pk_fma_f32 v[60:61], v[28:29], v[28:29], s[52:53]
    v_pk_fma_f32 v[62:63], v[30:31], v[30:31], s[52:53]
    v_pk_mul_f32 v[48:49], v[48:49], v[16:17] neg_lo:[1,0] neg_hi:[1,0]
    v_pk_mul_f32 v[50:51], v[50:51], v[18:19] neg_lo:[1,0] neg_hi:[1,0]
    v_pk_mul_f32 v[52:53], v[52:53], v[20:21] neg_lo:[1,0] neg_hi:[1,0]
    v_pk_mul_f32 v[54:55], v[54:55], v[22:23] neg_lo:[1,0] neg_hi:[1,0]
    v_pk_mul_f32 v[56:57], v[56:57], v[24:25] neg_lo:[1,0] neg_hi:[1,0]
    v_pk_mul_f32 v[58:59], v[58:59], v[26:27] neg_lo:[1,0] neg_hi:[1,0]
    v_pk_mul_f32 v[60:61], v[60:61], v[28:29] neg_lo:[1,0] neg_hi:[1,0]
    v_pk_mul_f32 v[62:63], v[62:63], v[30:31] neg_lo:[1,0] neg_hi:[1,0]
    v_mfma_f32_32x32x16_bf16 v[32:47], v[72:75], v[232:235], 0
    s_mul_i32 s59, s57, 18432
    s_add_u32 s59, s59, 8192
    s_add_u32 m0, s59, 73728
    s_nop 0
    buffer_load_dwordx4 v2, s[36:39], s59 offen lds
    v_exp_f32 v48, v48
    v_mfma_f32_32x32x16_bf16 v[32:47], v[76:79], v[236:239], v[32:47]
    v_exp_f32 v49, v49
    v_exp_f32 v50, v50
    v_exp_f32 v51, v51
    v_mfma_f32_32x32x16_bf16 v[32:47], v[80:83], v[240:243], v[32:47]
    v_exp_f32 v52, v52
    v_exp_f32 v53, v53
    v_exp_f32 v54, v54
    v_mfma_f32_32x32x16_bf16 v[32:47], v[84:87], v[244:247], v[32:47]
    v_exp_f32 v55, v55
    v_exp_f32 v56, v56
    v_exp_f32 v57, v57
    v_mfma_f32_32x32x16_bf16 v[144:159], v[136:139], a[240:243], 0
    v_exp_f32 v58, v58
    v_exp_f32 v59, v59
    v_exp_f32 v60, v60
    v_mfma_f32_32x32x16_bf16 v[144:159], v[140:143], a[244:247], v[144:159]
    v_exp_f32 v61, v61
    v_exp_f32 v62, v62
    v_exp_f32_e64 v63, v63
    v_pk_add_f32 v[48:49], v[48:49], 1.0 op_sel_hi:[1,0]
    v_pk_add_f32 v[50:51], v[50:51], 1.0 op_sel_hi:[1,0]
    v_pk_add_f32 v[52:53], v[52:53], 1.0 op_sel_hi:[1,0]
    v_pk_add_f32 v[54:55], v[54:55], 1.0 op_sel_hi:[1,0]
    v_pk_add_f32 v[56:57], v[56:57], 1.0 op_sel_hi:[1,0]
    v_pk_add_f32 v[58:59], v[58:59], 1.0 op_sel_hi:[1,0]
    v_pk_add_f32 v[60:61], v[60:61], 1.0 op_sel_hi:[1,0]
    v_pk_add_f32 v[62:63], v[62:63], 1.0 op_sel_hi:[1,0]
    v_pk_add_f32 v[8:9], v[8:9], v[144:145]
    v_pk_fma_f32 v[10:11], v[144:145], v[144:145], v[10:11]
    v_pk_add_f32 v[8:9], v[8:9], v[146:147]
    v_pk_fma_f32 v[10:11], v[146:147], v[146:147], v[10:11]
    v_pk_add_f32 v[8:9], v[8:9], v[148:149]
    v_pk_fma_f32 v[10:11], v[148:149], v[148:149], v[10:11]
    v_pk_add_f32 v[8:9], v[8:9], v[150:151]
    v_pk_fma_f32 v[10:11], v[150:151], v[150:151], v[10:11]
    v_pk_add_f32 v[8:9], v[8:9], v[152:153]
    v_pk_fma_f32 v[10:11], v[152:153], v[152:153], v[10:11]
    v_pk_add_f32 v[8:9], v[8:9], v[154:155]
    v_pk_fma_f32 v[10:11], v[154:155], v[154:155], v[10:11]
    v_pk_add_f32 v[8:9], v[8:9], v[156:157]
    v_pk_fma_f32 v[10:11], v[156:157], v[156:157], v[10:11]
    v_pk_add_f32 v[8:9], v[8:9], v[158:159]
    v_pk_fma_f32 v[10:11], v[158:159], v[158:159], v[10:11]
    v_mfma_f32_32x32x16_bf16 v[32:47], v[88:91], v[248:251], v[32:47]
    s_mul_i32 s59, s57, 18432
    s_add_u32 s59, s59, 9216
    s_add_u32 m0, s59, 73728
    s_nop 0
    buffer_load_dwordx4 v2, s[36:39], s59 offen lds
    v_rcp_f32 v48, v48
    v_mfma_f32_32x32x16_bf16 v[32:47], v[92:95], v[252:255], v[32:47]
    v_rcp_f32 v49, v49
    v_rcp_f32 v50, v50
    v_rcp_f32 v51, v51
    v_mfma_f32_32x32x16_bf16 v[144:159], v[120:123], a[224:227], 0
    v_rcp_f32 v52, v52
    v_rcp_f32 v53, v53
    v_rcp_f32 v54, v54
    v_mfma_f32_32x32x16_bf16 v[144:159], v[124:127], a[228:231], v[144:159]
    v_add_f32 v8, v8, v9
    v_add_f32 v10, v10, v11
    s_nop 1
    v_permlane32_swap_b32 v8, v10
    v_add_f32 v8, v8, v10
    v_mov_b32 v10, v8
    s_nop 1
    v_permlane32_swap_b32 v8, v10
    v_rcp_f32 v55, v55
    v_mul_f32 v8, 0x3c2aaaab, v8
    v_rcp_f32 v56, v56
    v_rcp_f32 v57, v57
    v_mul_f32 v10, 0x3c2aaaab, v10
    v_rcp_f32 v58, v58
    v_fma_f32 v10, -v8, v8, v10
    v_rcp_f32 v59, v59
    v_max_f32 v10, 0, v10
    v_rcp_f32 v60, v60
    v_add_f32 v10, 0x3727c5ac, v10
    v_rcp_f32 v61, v61
    v_rsq_f32 v10, v10
    v_rcp_f32 v62, v62
    v_mul_f32 v12, 0x3eeff558, v10
    v_rcp_f32_e64 v63, v63
    v_mul_f32_e64 v13, -v8, v12
    v_pk_mul_f32 v[48:49], v[16:17], v[48:49]
    v_pk_mul_f32 v[50:51], v[18:19], v[50:51]
    v_pk_mul_f32 v[52:53], v[20:21], v[52:53]
    v_pk_mul_f32 v[54:55], v[22:23], v[54:55]
    v_pk_mul_f32 v[56:57], v[24:25], v[56:57]
    v_pk_mul_f32 v[58:59], v[26:27], v[58:59]
    v_pk_mul_f32 v[60:61], v[28:29], v[60:61]
    v_pk_mul_f32 v[62:63], v[30:31], v[62:63]
    v_pk_fma_f32 v[116:117], v[48:49], v[48:49], v[116:117]
    v_pk_fma_f32 v[116:117], v[50:51], v[50:51], v[116:117]
    v_pk_fma_f32 v[116:117], v[52:53], v[52:53], v[116:117]
    v_pk_fma_f32 v[116:117], v[54:55], v[54:55], v[116:117]
    v_pk_fma_f32 v[116:117], v[56:57], v[56:57], v[116:117]
    v_pk_fma_f32 v[116:117], v[58:59], v[58:59], v[116:117]
    v_pk_fma_f32 v[116:117], v[60:61], v[60:61], v[116:117]
    v_pk_fma_f32 v[116:117], v[62:63], v[62:63], v[116:117]
    v_pk_fma_f32 v[144:145], v[144:145], v[12:13], v[12:13] op_sel:[0,0,1] op_sel_hi:[1,0,1]
    v_pk_fma_f32 v[146:147], v[146:147], v[12:13], v[12:13] op_sel:[0,0,1] op_sel_hi:[1,0,1]
    v_pk_fma_f32 v[148:149], v[148:149], v[12:13], v[12:13] op_sel:[0,0,1] op_sel_hi:[1,0,1]
    v_pk_fma_f32 v[150:151], v[150:151], v[12:13], v[12:13] op_sel:[0,0,1] op_sel_hi:[1,0,1]
    v_pk_fma_f32 v[152:153], v[152:153], v[12:13], v[12:13] op_sel:[0,0,1] op_sel_hi:[1,0,1]
    v_pk_fma_f32 v[154:155], v[154:155], v[12:13], v[12:13] op_sel:[0,0,1] op_sel_hi:[1,0,1]
    v_pk_fma_f32 v[156:157], v[156:157], v[12:13], v[12:13] op_sel:[0,0,1] op_sel_hi:[1,0,1]
    v_pk_fma_f32 v[158:159], v[158:159], v[12:13], v[12:13] op_sel:[0,0,1] op_sel_hi:[1,0,1]
    v_cvt_pk_bf16_f32 v72, v144, v145
    v_cvt_pk_bf16_f32 v73, v146, v147
    v_cvt_pk_bf16_f32 v74, v148, v149
    v_cvt_pk_bf16_f32 v75, v150, v151
    v_cvt_pk_bf16_f32 v76, v152, v153
    v_cvt_pk_bf16_f32 v77, v154, v155
    v_cvt_pk_bf16_f32 v78, v156, v157
    v_cvt_pk_bf16_f32 v79, v158, v159
    v_pk_fma_f32 v[48:49], v[32:33], v[32:33], s[52:53]
    v_pk_fma_f32 v[50:51], v[34:35], v[34:35], s[52:53]
    v_pk_fma_f32 v[52:53], v[36:37], v[36:37], s[52:53]
    v_pk_fma_f32 v[54:55], v[38:39], v[38:39], s[52:53]
    v_pk_fma_f32 v[56:57], v[40:41], v[40:41], s[52:53]
    v_pk_fma_f32 v[58:59], v[42:43], v[42:43], s[52:53]
    v_pk_fma_f32 v[60:61], v[44:45], v[44:45], s[52:53]
    v_pk_fma_f32 v[62:63], v[46:47], v[46:47], s[52:53]
    v_pk_mul_f32 v[48:49], v[48:49], v[32:33] neg_lo:[1,0] neg_hi:[1,0]
    v_pk_mul_f32 v[50:51], v[50:51], v[34:35] neg_lo:[1,0] neg_hi:[1,0]
    v_pk_mul_f32 v[52:53], v[52:53], v[36:37] neg_lo:[1,0] neg_hi:[1,0]
    v_pk_mul_f32 v[54:55], v[54:55], v[38:39] neg_lo:[1,0] neg_hi:[1,0]
    v_pk_mul_f32 v[56:57], v[56:57], v[40:41] neg_lo:[1,0] neg_hi:[1,0]
    v_pk_mul_f32 v[58:59], v[58:59], v[42:43] neg_lo:[1,0] neg_hi:[1,0]
    v_pk_mul_f32 v[60:61], v[60:61], v[44:45] neg_lo:[1,0] neg_hi:[1,0]
    v_pk_mul_f32 v[62:63], v[62:63], v[46:47] neg_lo:[1,0] neg_hi:[1,0]
    v_mfma_f32_32x32x16_bf16 v[144:159], v[128:131], a[232:235], 0
    v_exp_f32 v48, v48
    v_exp_f32 v49, v49
    v_exp_f32 v50, v50
    v_mfma_f32_32x32x16_bf16 v[144:159], v[132:135], a[236:239], v[144:159]
    v_exp_f32 v51, v51
    v_exp_f32 v52, v52
    v_exp_f32 v53, v53
    v_mfma_f32_32x32x16_bf16 v[16:31], v[136:139], a[240:243], 0
    v_exp_f32 v54, v54
    v_exp_f32 v55, v55
    v_exp_f32 v56, v56
    v_mfma_f32_32x32x16_bf16 v[16:31], v[140:143], a[244:247], v[16:31]
    v_exp_f32 v57, v57
    v_exp_f32 v58, v58
    v_exp_f32 v59, v59
    v_exp_f32 v60, v60
    v_exp_f32 v61, v61
    v_exp_f32 v62, v62
    v_exp_f32 v63, v63
    v_pk_add_f32 v[48:49], v[48:49], 1.0 op_sel_hi:[1,0]
    v_pk_add_f32 v[50:51], v[50:51], 1.0 op_sel_hi:[1,0]
    v_pk_add_f32 v[52:53], v[52:53], 1.0 op_sel_hi:[1,0]
    v_pk_add_f32 v[54:55], v[54:55], 1.0 op_sel_hi:[1,0]
    v_pk_add_f32 v[56:57], v[56:57], 1.0 op_sel_hi:[1,0]
    v_pk_add_f32 v[58:59], v[58:59], 1.0 op_sel_hi:[1,0]
    v_pk_add_f32 v[60:61], v[60:61], 1.0 op_sel_hi:[1,0]
    v_pk_add_f32 v[62:63], v[62:63], 1.0 op_sel_hi:[1,0]
    v_pk_fma_f32 v[144:145], v[144:145], v[12:13], v[12:13] op_sel:[0,0,1] op_sel_hi:[1,0,1]
    v_pk_fma_f32 v[146:147], v[146:147], v[12:13], v[12:13] op_sel:[0,0,1] op_sel_hi:[1,0,1]
    v_pk_fma_f32 v[148:149], v[148:149], v[12:13], v[12:13] op_sel:[0,0,1] op_sel_hi:[1,0,1]
    v_pk_fma_f32 v[150:151], v[150:151], v[12:13], v[12:13] op_sel:[0,0,1] op_sel_hi:[1,0,1]
    v_pk_fma_f32 v[152:153], v[152:153], v[12:13], v[12:13] op_sel:[0,0,1] op_sel_hi:[1,0,1]
    v_pk_fma_f32 v[154:155], v[154:155], v[12:13], v[12:13] op_sel:[0,0,1] op_sel_hi:[1,0,1]
    v_pk_fma_f32 v[156:157], v[156:157], v[12:13], v[12:13] op_sel:[0,0,1] op_sel_hi:[1,0,1]
    v_pk_fma_f32 v[158:159], v[158:159], v[12:13], v[12:13] op_sel:[0,0,1] op_sel_hi:[1,0,1]
    v_cvt_pk_bf16_f32 v80, v144, v145
    v_cvt_pk_bf16_f32 v81, v146, v147
    v_cvt_pk_bf16_f32 v82, v148, v149
    v_cvt_pk_bf16_f32 v83, v150, v151
    v_cvt_pk_bf16_f32 v84, v152, v153
    v_cvt_pk_bf16_f32 v85, v154, v155
    v_cvt_pk_bf16_f32 v86, v156, v157
    v_cvt_pk_bf16_f32 v87, v158, v159
    v_pk_fma_f32 v[16:17], v[16:17], v[12:13], v[12:13] op_sel:[0,0,1] op_sel_hi:[1,0,1]
    v_pk_fma_f32 v[18:19], v[18:19], v[12:13], v[12:13] op_sel:[0,0,1] op_sel_hi:[1,0,1]
    v_pk_fma_f32 v[20:21], v[20:21], v[12:13], v[12:13] op_sel:[0,0,1] op_sel_hi:[1,0,1]
    v_pk_fma_f32 v[22:23], v[22:23], v[12:13], v[12:13] op_sel:[0,0,1] op_sel_hi:[1,0,1]
    v_pk_fma_f32 v[24:25], v[24:25], v[12:13], v[12:13] op_sel:[0,0,1] op_sel_hi:[1,0,1]
    v_pk_fma_f32 v[26:27], v[26:27], v[12:13], v[12:13] op_sel:[0,0,1] op_sel_hi:[1,0,1]
    v_pk_fma_f32 v[28:29], v[28:29], v[12:13], v[12:13] op_sel:[0,0,1] op_sel_hi:[1,0,1]
    v_pk_fma_f32 v[30:31], v[30:31], v[12:13], v[12:13] op_sel:[0,0,1] op_sel_hi:[1,0,1]
    v_cvt_pk_bf16_f32 v88, v16, v17
    v_cvt_pk_bf16_f32 v89, v18, v19
    v_cvt_pk_bf16_f32 v90, v20, v21
    v_cvt_pk_bf16_f32 v91, v22, v23
    v_cvt_pk_bf16_f32 v92, v24, v25
    v_cvt_pk_bf16_f32 v93, v26, v27
    v_cvt_pk_bf16_f32 v94, v28, v29
    v_cvt_pk_bf16_f32 v95, v30, v31
    v_mfma_f32_32x32x16_bf16 v[16:31], v[72:75], a[32:35], 0
    buffer_store_dwordx4 v[12:15], v2, s[44:47], s58 offen offset:3072 sc1
    s_add_u32 s54, s56, 98304
    v_rcp_f32 v48, v48
    v_rcp_f32 v49, v49
    v_mfma_f32_32x32x16_bf16 v[16:31], v[76:79], a[36:39], v[16:31]
    buffer_load_dwordx4 a[224:227], v1, s[24:27], s54 offen offset:0
    buffer_load_dwordx4 a[228:231], v1, s[24:27], s54 offen offset:32
    v_rcp_f32 v50, v50
    v_rcp_f32 v51, v51
    v_mfma_f32_32x32x16_bf16 v[16:31], v[80:83], a[40:43], v[16:31]
    buffer_load_dwordx4 a[232:235], v1, s[24:27], s54 offen offset:64
    buffer_load_dwordx4 a[236:239], v1, s[24:27], s54 offen offset:96
    v_rcp_f32 v52, v52
    v_rcp_f32 v53, v53
    v_mfma_f32_32x32x16_bf16 v[16:31], v[84:87], a[44:47], v[16:31]
    buffer_load_dwordx4 a[240:243], v1, s[24:27], s54 offen offset:128
    buffer_load_dwordx4 a[244:247], v1, s[24:27], s54 offen offset:160
    v_rcp_f32 v54, v54
    v_rcp_f32 v55, v55
    v_mfma_f32_32x32x16_bf16 v[16:31], v[88:91], a[48:51], v[16:31]
    v_rcp_f32 v56, v56
    v_rcp_f32 v57, v57
    v_rcp_f32 v58, v58
    v_mfma_f32_32x32x16_bf16 v[16:31], v[92:95], a[52:55], v[16:31]
    v_rcp_f32 v59, v59
    v_rcp_f32 v60, v60
    v_rcp_f32 v61, v61
    v_rcp_f32 v62, v62
    v_rcp_f32 v63, v63
    v_pk_mul_f32 v[48:49], v[32:33], v[48:49]
    v_pk_mul_f32 v[50:51], v[34:35], v[50:51]
    v_pk_mul_f32 v[52:53], v[36:37], v[52:53]
    v_pk_mul_f32 v[54:55], v[38:39], v[54:55]
    v_pk_mul_f32 v[56:57], v[40:41], v[56:57]
    v_pk_mul_f32 v[58:59], v[42:43], v[58:59]
    v_pk_mul_f32 v[60:61], v[44:45], v[60:61]
    v_pk_mul_f32 v[62:63], v[46:47], v[62:63]
    v_pk_fma_f32 v[118:119], v[48:49], v[48:49], v[118:119]
    v_pk_fma_f32 v[118:119], v[50:51], v[50:51], v[118:119]
    v_pk_fma_f32 v[118:119], v[52:53], v[52:53], v[118:119]
    v_pk_fma_f32 v[118:119], v[54:55], v[54:55], v[118:119]
    v_pk_fma_f32 v[118:119], v[56:57], v[56:57], v[118:119]
    v_pk_fma_f32 v[118:119], v[58:59], v[58:59], v[118:119]
    v_pk_fma_f32 v[118:119], v[60:61], v[60:61], v[118:119]
    v_pk_fma_f32 v[118:119], v[62:63], v[62:63], v[118:119]
    v_pk_fma_f32 v[48:49], v[16:17], v[16:17], s[52:53]
    v_pk_fma_f32 v[50:51], v[18:19], v[18:19], s[52:53]
    v_pk_fma_f32 v[52:53], v[20:21], v[20:21], s[52:53]
    v_pk_fma_f32 v[54:55], v[22:23], v[22:23], s[52:53]
    v_pk_fma_f32 v[56:57], v[24:25], v[24:25], s[52:53]
    v_pk_fma_f32 v[58:59], v[26:27], v[26:27], s[52:53]
    v_pk_fma_f32 v[60:61], v[28:29], v[28:29], s[52:53]
    v_pk_fma_f32 v[62:63], v[30:31], v[30:31], s[52:53]
    v_pk_mul_f32 v[48:49], v[48:49], v[16:17] neg_lo:[1,0] neg_hi:[1,0]
    v_pk_mul_f32 v[50:51], v[50:51], v[18:19] neg_lo:[1,0] neg_hi:[1,0]
    v_pk_mul_f32 v[52:53], v[52:53], v[20:21] neg_lo:[1,0] neg_hi:[1,0]
    v_pk_mul_f32 v[54:55], v[54:55], v[22:23] neg_lo:[1,0] neg_hi:[1,0]
    v_pk_mul_f32 v[56:57], v[56:57], v[24:25] neg_lo:[1,0] neg_hi:[1,0]
    v_pk_mul_f32 v[58:59], v[58:59], v[26:27] neg_lo:[1,0] neg_hi:[1,0]
    v_pk_mul_f32 v[60:61], v[60:61], v[28:29] neg_lo:[1,0] neg_hi:[1,0]
    v_pk_mul_f32 v[62:63], v[62:63], v[30:31] neg_lo:[1,0] neg_hi:[1,0]
    v_mfma_f32_32x32x16_bf16 v[32:47], v[72:75], a[56:59], 0
    v_exp_f32 v48, v48
    v_exp_f32 v49, v49
    v_exp_f32 v50, v50
    v_mfma_f32_32x32x16_bf16 v[32:47], v[76:79], a[60:63], v[32:47]
    v_exp_f32 v51, v51
    v_exp_f32 v52, v52
    v_exp_f32 v53, v53
    v_exp_f32 v54, v54
    v_exp_f32 v55, v55
    v_exp_f32 v56, v56
    v_exp_f32 v57, v57
    v_exp_f32 v58, v58
    v_exp_f32 v59, v59
    v_exp_f32 v60, v60
    v_exp_f32 v61, v61
    v_exp_f32 v62, v62
    v_exp_f32 v63, v63
    v_pk_add_f32 v[48:49], v[48:49], 1.0 op_sel_hi:[1,0]
    v_pk_add_f32 v[50:51], v[50:51], 1.0 op_sel_hi:[1,0]
    v_pk_add_f32 v[52:53], v[52:53], 1.0 op_sel_hi:[1,0]
    v_pk_add_f32 v[54:55], v[54:55], 1.0 op_sel_hi:[1,0]
    v_pk_add_f32 v[56:57], v[56:57], 1.0 op_sel_hi:[1,0]
    v_pk_add_f32 v[58:59], v[58:59], 1.0 op_sel_hi:[1,0]
    v_pk_add_f32 v[60:61], v[60:61], 1.0 op_sel_hi:[1,0]
    v_pk_add_f32 v[62:63], v[62:63], 1.0 op_sel_hi:[1,0]
    v_mfma_f32_32x32x16_bf16 v[32:47], v[80:83], a[64:67], v[32:47]
    v_rcp_f32 v48, v48
    v_rcp_f32 v49, v49
    v_rcp_f32 v50, v50
    v_mfma_f32_32x32x16_bf16 v[32:47], v[84:87], a[68:71], v[32:47]
    v_rcp_f32 v51, v51
    v_rcp_f32 v52, v52
    v_rcp_f32 v53, v53
    v_mfma_f32_32x32x16_bf16 v[32:47], v[88:91], a[72:75], v[32:47]
    v_rcp_f32 v54, v54
    v_rcp_f32 v55, v55
    v_rcp_f32 v56, v56
    v_mfma_f32_32x32x16_bf16 v[32:47], v[92:95], a[76:79], v[32:47]
    v_rcp_f32 v57, v57
    v_rcp_f32 v58, v58
    v_rcp_f32 v59, v59
    v_rcp_f32 v60, v60
    v_rcp_f32 v61, v61
    v_rcp_f32 v62, v62
    v_rcp_f32 v63, v63
    v_pk_mul_f32 v[48:49], v[16:17], v[48:49]
    v_pk_mul_f32 v[50:51], v[18:19], v[50:51]
    v_pk_mul_f32 v[52:53], v[20:21], v[52:53]
    v_pk_mul_f32 v[54:55], v[22:23], v[54:55]
    v_pk_mul_f32 v[56:57], v[24:25], v[56:57]
    v_pk_mul_f32 v[58:59], v[26:27], v[58:59]
    v_pk_mul_f32 v[60:61], v[28:29], v[60:61]
    v_pk_mul_f32 v[62:63], v[30:31], v[62:63]
    v_pk_fma_f32 v[96:97], v[48:49], v[48:49], v[96:97]
    v_pk_fma_f32 v[96:97], v[50:51], v[50:51], v[96:97]
    v_pk_fma_f32 v[96:97], v[52:53], v[52:53], v[96:97]
    v_pk_fma_f32 v[96:97], v[54:55], v[54:55], v[96:97]
    v_pk_fma_f32 v[96:97], v[56:57], v[56:57], v[96:97]
    v_pk_fma_f32 v[96:97], v[58:59], v[58:59], v[96:97]
    v_pk_fma_f32 v[96:97], v[60:61], v[60:61], v[96:97]
    v_pk_fma_f32 v[96:97], v[62:63], v[62:63], v[96:97]
    v_pk_fma_f32 v[48:49], v[32:33], v[32:33], s[52:53]
    v_pk_fma_f32 v[50:51], v[34:35], v[34:35], s[52:53]
    v_pk_fma_f32 v[52:53], v[36:37], v[36:37], s[52:53]
    v_pk_fma_f32 v[54:55], v[38:39], v[38:39], s[52:53]
    v_pk_fma_f32 v[56:57], v[40:41], v[40:41], s[52:53]
    v_pk_fma_f32 v[58:59], v[42:43], v[42:43], s[52:53]
    v_pk_fma_f32 v[60:61], v[44:45], v[44:45], s[52:53]
    v_pk_fma_f32 v[62:63], v[46:47], v[46:47], s[52:53]
    v_pk_mul_f32 v[48:49], v[48:49], v[32:33] neg_lo:[1,0] neg_hi:[1,0]
    v_pk_mul_f32 v[50:51], v[50:51], v[34:35] neg_lo:[1,0] neg_hi:[1,0]
    v_pk_mul_f32 v[52:53], v[52:53], v[36:37] neg_lo:[1,0] neg_hi:[1,0]
    v_pk_mul_f32 v[54:55], v[54:55], v[38:39] neg_lo:[1,0] neg_hi:[1,0]
    v_pk_mul_f32 v[56:57], v[56:57], v[40:41] neg_lo:[1,0] neg_hi:[1,0]
    v_pk_mul_f32 v[58:59], v[58:59], v[42:43] neg_lo:[1,0] neg_hi:[1,0]
    v_pk_mul_f32 v[60:61], v[60:61], v[44:45] neg_lo:[1,0] neg_hi:[1,0]
    v_pk_mul_f32 v[62:63], v[62:63], v[46:47] neg_lo:[1,0] neg_hi:[1,0]
    v_mfma_f32_32x32x16_bf16 v[16:31], v[72:75], a[80:83], 0
    v_exp_f32 v48, v48
    v_exp_f32 v49, v49
    v_exp_f32 v50, v50
    v_mfma_f32_32x32x16_bf16 v[16:31], v[76:79], a[84:87], v[16:31]
    v_exp_f32 v51, v51
    v_exp_f32 v52, v52
    v_exp_f32 v53, v53
    v_exp_f32 v54, v54
    v_exp_f32 v55, v55
    v_exp_f32 v56, v56
    v_exp_f32 v57, v57
    v_exp_f32 v58, v58
    v_exp_f32 v59, v59
    v_exp_f32 v60, v60
    v_exp_f32 v61, v61
    v_exp_f32 v62, v62
    v_exp_f32 v63, v63
    v_pk_add_f32 v[48:49], v[48:49], 1.0 op_sel_hi:[1,0]
    v_pk_add_f32 v[50:51], v[50:51], 1.0 op_sel_hi:[1,0]
    v_pk_add_f32 v[52:53], v[52:53], 1.0 op_sel_hi:[1,0]
    v_pk_add_f32 v[54:55], v[54:55], 1.0 op_sel_hi:[1,0]
    v_pk_add_f32 v[56:57], v[56:57], 1.0 op_sel_hi:[1,0]
    v_pk_add_f32 v[58:59], v[58:59], 1.0 op_sel_hi:[1,0]
    v_pk_add_f32 v[60:61], v[60:61], 1.0 op_sel_hi:[1,0]
    v_pk_add_f32 v[62:63], v[62:63], 1.0 op_sel_hi:[1,0]
    v_mfma_f32_32x32x16_bf16 v[16:31], v[80:83], a[88:91], v[16:31]
    v_rcp_f32 v48, v48
    v_rcp_f32 v49, v49
    v_rcp_f32 v50, v50
    v_mfma_f32_32x32x16_bf16 v[16:31], v[84:87], a[92:95], v[16:31]
    v_rcp_f32 v51, v51
    v_rcp_f32 v52, v52
    v_rcp_f32 v53, v53
    v_mfma_f32_32x32x16_bf16 v[16:31], v[88:91], a[96:99], v[16:31]
    v_rcp_f32 v54, v54
    v_rcp_f32 v55, v55
    v_rcp_f32 v56, v56
    v_mfma_f32_32x32x16_bf16 v[16:31], v[92:95], a[100:103], v[16:31]
    v_rcp_f32 v57, v57
    v_rcp_f32 v58, v58
    v_rcp_f32 v59, v59
    v_rcp_f32 v60, v60
    v_rcp_f32 v61, v61
    v_rcp_f32 v62, v62
    v_rcp_f32 v63, v63
    v_pk_mul_f32 v[48:49], v[32:33], v[48:49]
    v_pk_mul_f32 v[50:51], v[34:35], v[50:51]
    v_pk_mul_f32 v[52:53], v[36:37], v[52:53]
    v_pk_mul_f32 v[54:55], v[38:39], v[54:55]
    v_pk_mul_f32 v[56:57], v[40:41], v[56:57]
    v_pk_mul_f32 v[58:59], v[42:43], v[58:59]
    v_pk_mul_f32 v[60:61], v[44:45], v[60:61]
    v_pk_mul_f32 v[62:63], v[46:47], v[62:63]
    v_pk_fma_f32 v[98:99], v[48:49], v[48:49], v[98:99]
    v_pk_fma_f32 v[98:99], v[50:51], v[50:51], v[98:99]
    v_pk_fma_f32 v[98:99], v[52:53], v[52:53], v[98:99]
    v_pk_fma_f32 v[98:99], v[54:55], v[54:55], v[98:99]
    v_pk_fma_f32 v[98:99], v[56:57], v[56:57], v[98:99]
    v_pk_fma_f32 v[98:99], v[58:59], v[58:59], v[98:99]
    v_pk_fma_f32 v[98:99], v[60:61], v[60:61], v[98:99]
    v_pk_fma_f32 v[98:99], v[62:63], v[62:63], v[98:99]
    v_pk_fma_f32 v[48:49], v[16:17], v[16:17], s[52:53]
    v_pk_fma_f32 v[50:51], v[18:19], v[18:19], s[52:53]
    v_pk_fma_f32 v[52:53], v[20:21], v[20:21], s[52:53]
    v_pk_fma_f32 v[54:55], v[22:23], v[22:23], s[52:53]
    v_pk_fma_f32 v[56:57], v[24:25], v[24:25], s[52:53]
    v_pk_fma_f32 v[58:59], v[26:27], v[26:27], s[52:53]
    v_pk_fma_f32 v[60:61], v[28:29], v[28:29], s[52:53]
    v_pk_fma_f32 v[62:63], v[30:31], v[30:31], s[52:53]
    v_pk_mul_f32 v[48:49], v[48:49], v[16:17] neg_lo:[1,0] neg_hi:[1,0]
    v_pk_mul_f32 v[50:51], v[50:51], v[18:19] neg_lo:[1,0] neg_hi:[1,0]
    v_pk_mul_f32 v[52:53], v[52:53], v[20:21] neg_lo:[1,0] neg_hi:[1,0]
    v_pk_mul_f32 v[54:55], v[54:55], v[22:23] neg_lo:[1,0] neg_hi:[1,0]
    v_pk_mul_f32 v[56:57], v[56:57], v[24:25] neg_lo:[1,0] neg_hi:[1,0]
    v_pk_mul_f32 v[58:59], v[58:59], v[26:27] neg_lo:[1,0] neg_hi:[1,0]
    v_pk_mul_f32 v[60:61], v[60:61], v[28:29] neg_lo:[1,0] neg_hi:[1,0]
    v_pk_mul_f32 v[62:63], v[62:63], v[30:31] neg_lo:[1,0] neg_hi:[1,0]
    v_mfma_f32_32x32x16_bf16 v[32:47], v[72:75], a[104:107], 0
    v_exp_f32 v48, v48
    v_exp_f32 v49, v49
    v_exp_f32 v50, v50
    v_mfma_f32_32x32x16_bf16 v[32:47], v[76:79], a[108:111], v[32:47]
    v_exp_f32 v51, v51
    v_exp_f32 v52, v52
    v_exp_f32 v53, v53
    v_exp_f32 v54, v54
    v_exp_f32 v55, v55
    v_exp_f32 v56, v56
    v_exp_f32 v57, v57
    v_exp_f32 v58, v58
    v_exp_f32 v59, v59
    v_exp_f32 v60, v60
    v_exp_f32 v61, v61
    v_exp_f32 v62, v62
    v_exp_f32 v63, v63
    v_pk_add_f32 v[48:49], v[48:49], 1.0 op_sel_hi:[1,0]
    v_pk_add_f32 v[50:51], v[50:51], 1.0 op_sel_hi:[1,0]
    v_pk_add_f32 v[52:53], v[52:53], 1.0 op_sel_hi:[1,0]
    v_pk_add_f32 v[54:55], v[54:55], 1.0 op_sel_hi:[1,0]
    v_pk_add_f32 v[56:57], v[56:57], 1.0 op_sel_hi:[1,0]
    v_pk_add_f32 v[58:59], v[58:59], 1.0 op_sel_hi:[1,0]
    v_pk_add_f32 v[60:61], v[60:61], 1.0 op_sel_hi:[1,0]
    v_pk_add_f32 v[62:63], v[62:63], 1.0 op_sel_hi:[1,0]
    v_mfma_f32_32x32x16_bf16 v[32:47], v[80:83], a[112:115], v[32:47]
    v_rcp_f32 v48, v48
    v_rcp_f32 v49, v49
    v_rcp_f32 v50, v50
    v_mfma_f32_32x32x16_bf16 v[32:47], v[84:87], a[116:119], v[32:47]
    v_rcp_f32 v51, v51
    v_rcp_f32 v52, v52
    v_rcp_f32 v53, v53
    v_mfma_f32_32x32x16_bf16 v[32:47], v[88:91], a[120:123], v[32:47]
    v_rcp_f32 v54, v54
    v_rcp_f32 v55, v55
    v_rcp_f32 v56, v56
    v_mfma_f32_32x32x16_bf16 v[32:47], v[92:95], a[124:127], v[32:47]
    v_rcp_f32 v57, v57
    v_rcp_f32 v58, v58
    v_rcp_f32 v59, v59
    v_rcp_f32 v60, v60
    v_rcp_f32 v61, v61
    v_rcp_f32 v62, v62
    v_rcp_f32 v63, v63
    v_pk_mul_f32 v[48:49], v[16:17], v[48:49]
    v_pk_mul_f32 v[50:51], v[18:19], v[50:51]
    v_pk_mul_f32 v[52:53], v[20:21], v[52:53]
    v_pk_mul_f32 v[54:55], v[22:23], v[54:55]
    v_pk_mul_f32 v[56:57], v[24:25], v[56:57]
    v_pk_mul_f32 v[58:59], v[26:27], v[58:59]
    v_pk_mul_f32 v[60:61], v[28:29], v[60:61]
    v_pk_mul_f32 v[62:63], v[30:31], v[62:63]
    v_pk_fma_f32 v[100:101], v[48:49], v[48:49], v[100:101]
    v_pk_fma_f32 v[100:101], v[50:51], v[50:51], v[100:101]
    v_pk_fma_f32 v[100:101], v[52:53], v[52:53], v[100:101]
    v_pk_fma_f32 v[100:101], v[54:55], v[54:55], v[100:101]
    v_pk_fma_f32 v[100:101], v[56:57], v[56:57], v[100:101]
    v_pk_fma_f32 v[100:101], v[58:59], v[58:59], v[100:101]
    v_pk_fma_f32 v[100:101], v[60:61], v[60:61], v[100:101]
    v_pk_fma_f32 v[100:101], v[62:63], v[62:63], v[100:101]
    v_pk_fma_f32 v[48:49], v[32:33], v[32:33], s[52:53]
    v_pk_fma_f32 v[50:51], v[34:35], v[34:35], s[52:53]
    v_pk_fma_f32 v[52:53], v[36:37], v[36:37], s[52:53]
    v_pk_fma_f32 v[54:55], v[38:39], v[38:39], s[52:53]
    v_pk_fma_f32 v[56:57], v[40:41], v[40:41], s[52:53]
    v_pk_fma_f32 v[58:59], v[42:43], v[42:43], s[52:53]
    v_pk_fma_f32 v[60:61], v[44:45], v[44:45], s[52:53]
    v_pk_fma_f32 v[62:63], v[46:47], v[46:47], s[52:53]
    v_pk_mul_f32 v[48:49], v[48:49], v[32:33] neg_lo:[1,0] neg_hi:[1,0]
    v_pk_mul_f32 v[50:51], v[50:51], v[34:35] neg_lo:[1,0] neg_hi:[1,0]
    v_pk_mul_f32 v[52:53], v[52:53], v[36:37] neg_lo:[1,0] neg_hi:[1,0]
    v_pk_mul_f32 v[54:55], v[54:55], v[38:39] neg_lo:[1,0] neg_hi:[1,0]
    v_pk_mul_f32 v[56:57], v[56:57], v[40:41] neg_lo:[1,0] neg_hi:[1,0]
    v_pk_mul_f32 v[58:59], v[58:59], v[42:43] neg_lo:[1,0] neg_hi:[1,0]
    v_pk_mul_f32 v[60:61], v[60:61], v[44:45] neg_lo:[1,0] neg_hi:[1,0]
    v_pk_mul_f32 v[62:63], v[62:63], v[46:47] neg_lo:[1,0] neg_hi:[1,0]
    v_mfma_f32_32x32x16_bf16 v[16:31], v[72:75], a[128:131], 0
    v_exp_f32 v48, v48
    v_exp_f32 v49, v49
    v_exp_f32 v50, v50
    v_mfma_f32_32x32x16_bf16 v[16:31], v[76:79], a[132:135], v[16:31]
    v_exp_f32 v51, v51
    v_exp_f32 v52, v52
    v_exp_f32 v53, v53
    v_exp_f32 v54, v54
    v_exp_f32 v55, v55
    v_exp_f32 v56, v56
    v_exp_f32 v57, v57
    v_exp_f32 v58, v58
    v_exp_f32 v59, v59
    v_exp_f32 v60, v60
    v_exp_f32 v61, v61
    v_exp_f32 v62, v62
    v_exp_f32 v63, v63
    v_pk_add_f32 v[48:49], v[48:49], 1.0 op_sel_hi:[1,0]
    v_pk_add_f32 v[50:51], v[50:51], 1.0 op_sel_hi:[1,0]
    v_pk_add_f32 v[52:53], v[52:53], 1.0 op_sel_hi:[1,0]
    v_pk_add_f32 v[54:55], v[54:55], 1.0 op_sel_hi:[1,0]
    v_pk_add_f32 v[56:57], v[56:57], 1.0 op_sel_hi:[1,0]
    v_pk_add_f32 v[58:59], v[58:59], 1.0 op_sel_hi:[1,0]
    v_pk_add_f32 v[60:61], v[60:61], 1.0 op_sel_hi:[1,0]
    v_pk_add_f32 v[62:63], v[62:63], 1.0 op_sel_hi:[1,0]
    v_mfma_f32_32x32x16_bf16 v[16:31], v[80:83], a[136:139], v[16:31]
    v_rcp_f32 v48, v48
    v_rcp_f32 v49, v49
    v_rcp_f32 v50, v50
    v_mfma_f32_32x32x16_bf16 v[16:31], v[84:87], a[140:143], v[16:31]
    v_rcp_f32 v51, v51
    v_rcp_f32 v52, v52
    v_rcp_f32 v53, v53
    v_mfma_f32_32x32x16_bf16 v[16:31], v[88:91], a[144:147], v[16:31]
    v_rcp_f32 v54, v54
    v_rcp_f32 v55, v55
    v_rcp_f32 v56, v56
    v_mfma_f32_32x32x16_bf16 v[16:31], v[92:95], a[148:151], v[16:31]
    v_rcp_f32 v57, v57
    v_rcp_f32 v58, v58
    v_rcp_f32 v59, v59
    v_rcp_f32 v60, v60
    v_rcp_f32 v61, v61
    v_rcp_f32 v62, v62
    v_rcp_f32 v63, v63
    v_pk_mul_f32 v[48:49], v[32:33], v[48:49]
    v_pk_mul_f32 v[50:51], v[34:35], v[50:51]
    v_pk_mul_f32 v[52:53], v[36:37], v[52:53]
    v_pk_mul_f32 v[54:55], v[38:39], v[54:55]
    v_pk_mul_f32 v[56:57], v[40:41], v[56:57]
    v_pk_mul_f32 v[58:59], v[42:43], v[58:59]
    v_pk_mul_f32 v[60:61], v[44:45], v[60:61]
    v_pk_mul_f32 v[62:63], v[46:47], v[62:63]
    v_pk_fma_f32 v[102:103], v[48:49], v[48:49], v[102:103]
    v_pk_fma_f32 v[102:103], v[50:51], v[50:51], v[102:103]
    v_pk_fma_f32 v[102:103], v[52:53], v[52:53], v[102:103]
    v_pk_fma_f32 v[102:103], v[54:55], v[54:55], v[102:103]
    v_pk_fma_f32 v[102:103], v[56:57], v[56:57], v[102:103]
    v_pk_fma_f32 v[102:103], v[58:59], v[58:59], v[102:103]
    v_pk_fma_f32 v[102:103], v[60:61], v[60:61], v[102:103]
    v_pk_fma_f32 v[102:103], v[62:63], v[62:63], v[102:103]
    v_pk_fma_f32 v[48:49], v[16:17], v[16:17], s[52:53]
    v_pk_fma_f32 v[50:51], v[18:19], v[18:19], s[52:53]
    v_pk_fma_f32 v[52:53], v[20:21], v[20:21], s[52:53]
    v_pk_fma_f32 v[54:55], v[22:23], v[22:23], s[52:53]
    v_pk_fma_f32 v[56:57], v[24:25], v[24:25], s[52:53]
    v_pk_fma_f32 v[58:59], v[26:27], v[26:27], s[52:53]
    v_pk_fma_f32 v[60:61], v[28:29], v[28:29], s[52:53]
    v_pk_fma_f32 v[62:63], v[30:31], v[30:31], s[52:53]
    v_pk_mul_f32 v[48:49], v[48:49], v[16:17] neg_lo:[1,0] neg_hi:[1,0]
    v_pk_mul_f32 v[50:51], v[50:51], v[18:19] neg_lo:[1,0] neg_hi:[1,0]
    v_pk_mul_f32 v[52:53], v[52:53], v[20:21] neg_lo:[1,0] neg_hi:[1,0]
    v_pk_mul_f32 v[54:55], v[54:55], v[22:23] neg_lo:[1,0] neg_hi:[1,0]
    v_pk_mul_f32 v[56:57], v[56:57], v[24:25] neg_lo:[1,0] neg_hi:[1,0]
    v_pk_mul_f32 v[58:59], v[58:59], v[26:27] neg_lo:[1,0] neg_hi:[1,0]
    v_pk_mul_f32 v[60:61], v[60:61], v[28:29] neg_lo:[1,0] neg_hi:[1,0]
    v_pk_mul_f32 v[62:63], v[62:63], v[30:31] neg_lo:[1,0] neg_hi:[1,0]
    v_mfma_f32_32x32x16_bf16 v[32:47], v[72:75], a[152:155], 0
    v_exp_f32 v48, v48
    v_exp_f32 v49, v49
    v_exp_f32 v50, v50
    v_mfma_f32_32x32x16_bf16 v[32:47], v[76:79], a[156:159], v[32:47]
    v_exp_f32 v51, v51
    v_exp_f32 v52, v52
    v_exp_f32 v53, v53
    v_exp_f32 v54, v54
    v_exp_f32 v55, v55
    v_exp_f32 v56, v56
    v_exp_f32 v57, v57
    v_exp_f32 v58, v58
    v_exp_f32 v59, v59
    v_exp_f32 v60, v60
    v_exp_f32 v61, v61
    v_exp_f32 v62, v62
    v_exp_f32 v63, v63
    v_pk_add_f32 v[48:49], v[48:49], 1.0 op_sel_hi:[1,0]
    v_pk_add_f32 v[50:51], v[50:51], 1.0 op_sel_hi:[1,0]
    v_pk_add_f32 v[52:53], v[52:53], 1.0 op_sel_hi:[1,0]
    v_pk_add_f32 v[54:55], v[54:55], 1.0 op_sel_hi:[1,0]
    v_pk_add_f32 v[56:57], v[56:57], 1.0 op_sel_hi:[1,0]
    v_pk_add_f32 v[58:59], v[58:59], 1.0 op_sel_hi:[1,0]
    v_pk_add_f32 v[60:61], v[60:61], 1.0 op_sel_hi:[1,0]
    v_pk_add_f32 v[62:63], v[62:63], 1.0 op_sel_hi:[1,0]
    v_mfma_f32_32x32x16_bf16 v[32:47], v[80:83], a[160:163], v[32:47]
    v_rcp_f32 v48, v48
    v_rcp_f32 v49, v49
    v_rcp_f32 v50, v50
    v_mfma_f32_32x32x16_bf16 v[32:47], v[84:87], a[164:167], v[32:47]
    v_rcp_f32 v51, v51
    v_rcp_f32 v52, v52
    v_rcp_f32 v53, v53
    v_mfma_f32_32x32x16_bf16 v[32:47], v[88:91], a[168:171], v[32:47]
    v_rcp_f32 v54, v54
    v_rcp_f32 v55, v55
    v_rcp_f32 v56, v56
    v_mfma_f32_32x32x16_bf16 v[32:47], v[92:95], a[172:175], v[32:47]
    v_rcp_f32 v57, v57
    v_rcp_f32 v58, v58
    v_rcp_f32 v59, v59
    v_rcp_f32 v60, v60
    v_rcp_f32 v61, v61
    v_rcp_f32 v62, v62
    v_rcp_f32 v63, v63
    v_pk_mul_f32 v[48:49], v[16:17], v[48:49]
    v_pk_mul_f32 v[50:51], v[18:19], v[50:51]
    v_pk_mul_f32 v[52:53], v[20:21], v[52:53]
    v_pk_mul_f32 v[54:55], v[22:23], v[54:55]
    v_pk_mul_f32 v[56:57], v[24:25], v[56:57]
    v_pk_mul_f32 v[58:59], v[26:27], v[58:59]
    v_pk_mul_f32 v[60:61], v[28:29], v[60:61]
    v_pk_mul_f32 v[62:63], v[30:31], v[62:63]
    v_pk_fma_f32 v[104:105], v[48:49], v[48:49], v[104:105]
    v_pk_fma_f32 v[104:105], v[50:51], v[50:51], v[104:105]
    v_pk_fma_f32 v[104:105], v[52:53], v[52:53], v[104:105]
    v_pk_fma_f32 v[104:105], v[54:55], v[54:55], v[104:105]
    v_pk_fma_f32 v[104:105], v[56:57], v[56:57], v[104:105]
    v_pk_fma_f32 v[104:105], v[58:59], v[58:59], v[104:105]
    v_pk_fma_f32 v[104:105], v[60:61], v[60:61], v[104:105]
    v_pk_fma_f32 v[104:105], v[62:63], v[62:63], v[104:105]
    v_pk_fma_f32 v[48:49], v[32:33], v[32:33], s[52:53]
    v_pk_fma_f32 v[50:51], v[34:35], v[34:35], s[52:53]
    v_pk_fma_f32 v[52:53], v[36:37], v[36:37], s[52:53]
    v_pk_fma_f32 v[54:55], v[38:39], v[38:39], s[52:53]
    v_pk_fma_f32 v[56:57], v[40:41], v[40:41], s[52:53]
    v_pk_fma_f32 v[58:59], v[42:43], v[42:43], s[52:53]
    v_pk_fma_f32 v[60:61], v[44:45], v[44:45], s[52:53]
    v_pk_fma_f32 v[62:63], v[46:47], v[46:47], s[52:53]
    v_pk_mul_f32 v[48:49], v[48:49], v[32:33] neg_lo:[1,0] neg_hi:[1,0]
    v_pk_mul_f32 v[50:51], v[50:51], v[34:35] neg_lo:[1,0] neg_hi:[1,0]
    v_pk_mul_f32 v[52:53], v[52:53], v[36:37] neg_lo:[1,0] neg_hi:[1,0]
    v_pk_mul_f32 v[54:55], v[54:55], v[38:39] neg_lo:[1,0] neg_hi:[1,0]
    v_pk_mul_f32 v[56:57], v[56:57], v[40:41] neg_lo:[1,0] neg_hi:[1,0]
    v_pk_mul_f32 v[58:59], v[58:59], v[42:43] neg_lo:[1,0] neg_hi:[1,0]
    v_pk_mul_f32 v[60:61], v[60:61], v[44:45] neg_lo:[1,0] neg_hi:[1,0]
    v_pk_mul_f32 v[62:63], v[62:63], v[46:47] neg_lo:[1,0] neg_hi:[1,0]
L_pf6:
    v_mfma_f32_32x32x16_bf16 v[16:31], v[72:75], a[176:179], 0
    s_mov_b32 s63, L_pf6-L_pc+12288
    buffer_load_dword v6, v7, s[68:71], s63 offen
    v_exp_f32 v48, v48
    v_exp_f32 v49, v49
    v_exp_f32 v50, v50
    v_mfma_f32_32x32x16_bf16 v[16:31], v[76:79], a[180:183], v[16:31]
    v_exp_f32 v51, v51
    v_exp_f32 v52, v52
    v_exp_f32 v53, v53
    v_exp_f32 v54, v54
    v_exp_f32 v55, v55
    v_exp_f32 v56, v56
    v_exp_f32 v57, v57
    v_exp_f32 v58, v58
    v_exp_f32 v59, v59
    v_exp_f32 v60, v60
    v_exp_f32 v61, v61
    v_exp_f32 v62, v62
    v_exp_f32 v63, v63
    v_pk_add_f32 v[48:49], v[48:49], 1.0 op_sel_hi:[1,0]
    v_pk_add_f32 v[50:51], v[50:51], 1.0 op_sel_hi:[1,0]
    v_pk_add_f32 v[52:53], v[52:53], 1.0 op_sel_hi:[1,0]
    v_pk_add_f32 v[54:55], v[54:55], 1.0 op_sel_hi:[1,0]
    v_pk_add_f32 v[56:57], v[56:57], 1.0 op_sel_hi:[1,0]
    v_pk_add_f32 v[58:59], v[58:59], 1.0 op_sel_hi:[1,0]
    v_pk_add_f32 v[60:61], v[60:61], 1.0 op_sel_hi:[1,0]
    v_pk_add_f32 v[62:63], v[62:63], 1.0 op_sel_hi:[1,0]
    v_mfma_f32_32x32x16_bf16 v[16:31], v[80:83], a[184:187], v[16:31]
    v_rcp_f32 v48, v48
    v_rcp_f32 v49, v49
    v_rcp_f32 v50, v50
    v_mfma_f32_32x32x16_bf16 v[16:31], v[84:87], a[188:191], v[16:31]
    v_rcp_f32 v51, v51
    v_rcp_f32 v52, v52
    v_rcp_f32 v53, v53
    v_mfma_f32_32x32x16_bf16 v[16:31], v[88:91], a[192:195], v[16:31]
    v_rcp_f32 v54, v54
    v_rcp_f32 v55, v55
    v_rcp_f32 v56, v56
    v_mfma_f32_32x32x16_bf16 v[16:31], v[92:95], a[196:199], v[16:31]
    v_rcp_f32 v57, v57
    v_rcp_f32 v58, v58
    v_rcp_f32 v59, v59
    v_rcp_f32 v60, v60
    v_rcp_f32 v61, v61
    v_rcp_f32 v62, v62
    v_rcp_f32 v63, v63
    v_pk_mul_f32 v[48:49], v[32:33], v[48:49]
    v_pk_mul_f32 v[50:51], v[34:35], v[50:51]
    v_pk_mul_f32 v[52:53], v[36:37], v[52:53]
    v_pk_mul_f32 v[54:55], v[38:39], v[54:55]
    v_pk_mul_f32 v[56:57], v[40:41], v[56:57]
    v_pk_mul_f32 v[58:59], v[42:43], v[58:59]
    v_pk_mul_f32 v[60:61], v[44:45], v[60:61]
    v_pk_mul_f32 v[62:63], v[46:47], v[62:63]
    v_pk_fma_f32 v[106:107], v[48:49], v[48:49], v[106:107]
    v_pk_fma_f32 v[106:107], v[50:51], v[50:51], v[106:107]
    v_pk_fma_f32 v[106:107], v[52:53], v[52:53], v[106:107]
    v_pk_fma_f32 v[106:107], v[54:55], v[54:55], v[106:107]
    v_pk_fma_f32 v[106:107], v[56:57], v[56:57], v[106:107]
    v_pk_fma_f32 v[106:107], v[58:59], v[58:59], v[106:107]
    v_pk_fma_f32 v[106:107], v[60:61], v[60:61], v[106:107]
    v_pk_fma_f32 v[106:107], v[62:63], v[62:63], v[106:107]
    v_pk_fma_f32 v[48:49], v[16:17], v[16:17], s[52:53]
    v_pk_fma_f32 v[50:51], v[18:19], v[18:19], s[52:53]
    v_pk_fma_f32 v[52:53], v[20:21], v[20:21], s[52:53]
    v_pk_fma_f32 v[54:55], v[22:23], v[22:23], s[52:53]
    v_pk_fma_f32 v[56:57], v[24:25], v[24:25], s[52:53]
    v_pk_fma_f32 v[58:59], v[26:27], v[26:27], s[52:53]
    v_pk_fma_f32 v[60:61], v[28:29], v[28:29], s[52:53]
    v_pk_fma_f32 v[62:63], v[30:31], v[30:31], s[52:53]
    v_pk_mul_f32 v[48:49], v[48:49], v[16:17] neg_lo:[1,0] neg_hi:[1,0]
    v_pk_mul_f32 v[50:51], v[50:51], v[18:19] neg_lo:[1,0] neg_hi:[1,0]
    v_pk_mul_f32 v[52:53], v[52:53], v[20:21] neg_lo:[1,0] neg_hi:[1,0]
    v_pk_mul_f32 v[54:55], v[54:55], v[22:23] neg_lo:[1,0] neg_hi:[1,0]
    v_pk_mul_f32 v[56:57], v[56:57], v[24:25] neg_lo:[1,0] neg_hi:[1,0]
    v_pk_mul_f32 v[58:59], v[58:59], v[26:27] neg_lo:[1,0] neg_hi:[1,0]
    v_pk_mul_f32 v[60:61], v[60:61], v[28:29] neg_lo:[1,0] neg_hi:[1,0]
    v_pk_mul_f32 v[62:63], v[62:63], v[30:31] neg_lo:[1,0] neg_hi:[1,0]
    v_mfma_f32_32x32x16_bf16 v[32:47], v[72:75], a[200:203], 0
    v_exp_f32 v48, v48
    v_exp_f32 v49, v49
    v_exp_f32 v50, v50
    v_mfma_f32_32x32x16_bf16 v[32:47], v[76:79], a[204:207], v[32:47]
    v_exp_f32 v51, v51
    v_exp_f32 v52, v52
    v_exp_f32 v53, v53
    v_exp_f32 v54, v54
    v_exp_f32 v55, v55
    v_exp_f32 v56, v56
    v_exp_f32 v57, v57
    v_exp_f32 v58, v58
    v_exp_f32 v59, v59
    v_exp_f32 v60, v60
    v_exp_f32 v61, v61
    v_exp_f32 v62, v62
    v_exp_f32 v63, v63
    v_pk_add_f32 v[48:49], v[48:49], 1.0 op_sel_hi:[1,0]
    v_pk_add_f32 v[50:51], v[50:51], 1.0 op_sel_hi:[1,0]
    v_pk_add_f32 v[52:53], v[52:53], 1.0 op_sel_hi:[1,0]
    v_pk_add_f32 v[54:55], v[54:55], 1.0 op_sel_hi:[1,0]
    v_pk_add_f32 v[56:57], v[56:57], 1.0 op_sel_hi:[1,0]
    v_pk_add_f32 v[58:59], v[58:59], 1.0 op_sel_hi:[1,0]
    v_pk_add_f32 v[60:61], v[60:61], 1.0 op_sel_hi:[1,0]
    v_pk_add_f32 v[62:63], v[62:63], 1.0 op_sel_hi:[1,0]
    v_mfma_f32_32x32x16_bf16 v[32:47], v[80:83], a[208:211], v[32:47]
    v_rcp_f32 v48, v48
    v_rcp_f32 v49, v49
    v_rcp_f32 v50, v50
    v_mfma_f32_32x32x16_bf16 v[32:47], v[84:87], a[212:215], v[32:47]
    v_rcp_f32 v51, v51
    v_rcp_f32 v52, v52
    v_rcp_f32 v53, v53
    v_mfma_f32_32x32x16_bf16 v[32:47], v[88:91], a[216:219], v[32:47]
    v_rcp_f32 v54, v54
    v_rcp_f32 v55, v55
    v_rcp_f32 v56, v56
    v_mfma_f32_32x32x16_bf16 v[32:47], v[92:95], a[220:223], v[32:47]
    v_rcp_f32 v57, v57
    v_rcp_f32 v58, v58
    v_rcp_f32 v59, v59
    v_rcp_f32 v60, v60
    v_rcp_f32 v61, v61
    v_rcp_f32 v62, v62
    v_rcp_f32 v63, v63
    v_pk_mul_f32 v[48:49], v[16:17], v[48:49]
    v_pk_mul_f32 v[50:51], v[18:19], v[50:51]
    v_pk_mul_f32 v[52:53], v[20:21], v[52:53]
    v_pk_mul_f32 v[54:55], v[22:23], v[54:55]
    v_pk_mul_f32 v[56:57], v[24:25], v[56:57]
    v_pk_mul_f32 v[58:59], v[26:27], v[58:59]
    v_pk_mul_f32 v[60:61], v[28:29], v[60:61]
    v_pk_mul_f32 v[62:63], v[30:31], v[62:63]
    v_pk_fma_f32 v[108:109], v[48:49], v[48:49], v[108:109]
    v_pk_fma_f32 v[108:109], v[50:51], v[50:51], v[108:109]
    v_pk_fma_f32 v[108:109], v[52:53], v[52:53], v[108:109]
    v_pk_fma_f32 v[108:109], v[54:55], v[54:55], v[108:109]
    v_pk_fma_f32 v[108:109], v[56:57], v[56:57], v[108:109]
    v_pk_fma_f32 v[108:109], v[58:59], v[58:59], v[108:109]
    v_pk_fma_f32 v[108:109], v[60:61], v[60:61], v[108:109]
    v_pk_fma_f32 v[108:109], v[62:63], v[62:63], v[108:109]
    v_pk_fma_f32 v[48:49], v[32:33], v[32:33], s[52:53]
    v_pk_fma_f32 v[50:51], v[34:35], v[34:35], s[52:53]
    v_pk_fma_f32 v[52:53], v[36:37], v[36:37], s[52:53]
    v_pk_fma_f32 v[54:55], v[38:39], v[38:39], s[52:53]
    v_pk_fma_f32 v[56:57], v[40:41], v[40:41], s[52:53]
    v_pk_fma_f32 v[58:59], v[42:43], v[42:43], s[52:53]
    v_pk_fma_f32 v[60:61], v[44:45], v[44:45], s[52:53]
    v_pk_fma_f32 v[62:63], v[46:47], v[46:47], s[52:53]
    v_pk_mul_f32 v[48:49], v[48:49], v[32:33] neg_lo:[1,0] neg_hi:[1,0]
    v_pk_mul_f32 v[50:51], v[50:51], v[34:35] neg_lo:[1,0] neg_hi:[1,0]
    v_pk_mul_f32 v[52:53], v[52:53], v[36:37] neg_lo:[1,0] neg_hi:[1,0]
    v_pk_mul_f32 v[54:55], v[54:55], v[38:39] neg_lo:[1,0] neg_hi:[1,0]
    v_pk_mul_f32 v[56:57], v[56:57], v[40:41] neg_lo:[1,0] neg_hi:[1,0]
    v_pk_mul_f32 v[58:59], v[58:59], v[42:43] neg_lo:[1,0] neg_hi:[1,0]
    v_pk_mul_f32 v[60:61], v[60:61], v[44:45] neg_lo:[1,0] neg_hi:[1,0]
    v_pk_mul_f32 v[62:63], v[62:63], v[46:47] neg_lo:[1,0] neg_hi:[1,0]
    v_mfma_f32_32x32x16_bf16 v[16:31], v[72:75], v[160:163], 0
    v_exp_f32 v48, v48
    v_exp_f32 v49, v49
    v_exp_f32 v50, v50
    v_mfma_f32_32x32x16_bf16 v[16:31], v[76:79], v[164:167], v[16:31]
    v_exp_f32 v51, v51
    v_exp_f32 v52, v52
    v_exp_f32 v53, v53
    v_exp_f32 v54, v54
    v_exp_f32 v55, v55
    v_exp_f32 v56, v56
    v_exp_f32 v57, v57
    v_exp_f32 v58, v58
    v_exp_f32 v59, v59
    v_exp_f32 v60, v60
    v_exp_f32 v61, v61
    v_exp_f32 v62, v62
    v_exp_f32 v63, v63
    v_pk_add_f32 v[48:49], v[48:49], 1.0 op_sel_hi:[1,0]
    v_pk_add_f32 v[50:51], v[50:51], 1.0 op_sel_hi:[1,0]
    v_pk_add_f32 v[52:53], v[52:53], 1.0 op_sel_hi:[1,0]
    v_pk_add_f32 v[54:55], v[54:55], 1.0 op_sel_hi:[1,0]
    v_pk_add_f32 v[56:57], v[56:57], 1.0 op_sel_hi:[1,0]
    v_pk_add_f32 v[58:59], v[58:59], 1.0 op_sel_hi:[1,0]
    v_pk_add_f32 v[60:61], v[60:61], 1.0 op_sel_hi:[1,0]
    v_pk_add_f32 v[62:63], v[62:63], 1.0 op_sel_hi:[1,0]
    v_mfma_f32_32x32x16_bf16 v[16:31], v[80:83], v[168:171], v[16:31]
    s_waitcnt vmcnt(1)
    s_mul_i32 s59, s57, 18432
    s_add_u32 s59, s59, 10240
    s_add_u32 m0, s59, 73728
    s_nop 0
    buffer_load_dwordx4 v2, s[36:39], s59 offen lds
    v_rcp_f32 v48, v48
    v_mfma_f32_32x32x16_bf16 v[16:31], v[84:87], v[172:175], v[16:31]
    v_rcp_f32 v49, v49
    v_rcp_f32 v50, v50
    v_rcp_f32 v51, v51
    v_mfma_f32_32x32x16_bf16 v[16:31], v[88:91], v[176:179], v[16:31]
    v_rcp_f32 v52, v52
    v_rcp_f32 v53, v53
    v_rcp_f32 v54, v54
    v_mfma_f32_32x32x16_bf16 v[16:31], v[92:95], v[180:183], v[16:31]
    v_rcp_f32 v55, v55
    v_rcp_f32 v56, v56
    v_rcp_f32 v57, v57
    v_rcp_f32 v58, v58
    v_rcp_f32 v59, v59
    v_rcp_f32 v60, v60
    v_rcp_f32 v61, v61
    v_rcp_f32 v62, v62
    v_rcp_f32 v63, v63
    v_pk_mul_f32 v[48:49], v[32:33], v[48:49]
    v_pk_mul_f32 v[50:51], v[34:35], v[50:51]
    v_pk_mul_f32 v[52:53], v[36:37], v[52:53]
    v_pk_mul_f32 v[54:55], v[38:39], v[54:55]
    v_pk_mul_f32 v[56:57], v[40:41], v[56:57]
    v_pk_mul_f32 v[58:59], v[42:43], v[58:59]
    v_pk_mul_f32 v[60:61], v[44:45], v[60:61]
    v_pk_mul_f32 v[62:63], v[46:47], v[62:63]
    v_pk_fma_f32 v[110:111], v[48:49], v[48:49], v[110:111]
    v_pk_fma_f32 v[110:111], v[50:51], v[50:51], v[110:111]
    v_pk_fma_f32 v[110:111], v[52:53], v[52:53], v[110:111]
    v_pk_fma_f32 v[110:111], v[54:55], v[54:55], v[110:111]
    v_pk_fma_f32 v[110:111], v[56:57], v[56:57], v[110:111]
    v_pk_fma_f32 v[110:111], v[58:59], v[58:59], v[110:111]
    v_pk_fma_f32 v[110:111], v[60:61], v[60:61], v[110:111]
    v_pk_fma_f32 v[110:111], v[62:63], v[62:63], v[110:111]
    v_pk_fma_f32 v[48:49], v[16:17], v[16:17], s[52:53]
    v_pk_fma_f32 v[50:51], v[18:19], v[18:19], s[52:53]
    v_pk_fma_f32 v[52:53], v[20:21], v[20:21], s[52:53]
    v_pk_fma_f32 v[54:55], v[22:23], v[22:23], s[52:53]
    v_pk_fma_f32 v[56:57], v[24:25], v[24:25], s[52:53]
    v_pk_fma_f32 v[58:59], v[26:27], v[26:27], s[52:53]
    v_pk_fma_f32 v[60:61], v[28:29], v[28:29], s[52:53]
    v_pk_fma_f32 v[62:63], v[30:31], v[30:31], s[52:53]
    v_pk_mul_f32 v[48:49], v[48:49], v[16:17] neg_lo:[1,0] neg_hi:[1,0]
    v_pk_mul_f32 v[50:51], v[50:51], v[18:19] neg_lo:[1,0] neg_hi:[1,0]
    v_pk_mul_f32 v[52:53], v[52:53], v[20:21] neg_lo:[1,0] neg_hi:[1,0]
    v_pk_mul_f32 v[54:55], v[54:55], v[22:23] neg_lo:[1,0] neg_hi:[1,0]
    v_pk_mul_f32 v[56:57], v[56:57], v[24:25] neg_lo:[1,0] neg_hi:[1,0]
    v_pk_mul_f32 v[58:59], v[58:59], v[26:27] neg_lo:[1,0] neg_hi:[1,0]
    v_pk_mul_f32 v[60:61], v[60:61], v[28:29] neg_lo:[1,0] neg_hi:[1,0]
    v_pk_mul_f32 v[62:63], v[62:63], v[30:31] neg_lo:[1,0] neg_hi:[1,0]
    v_mfma_f32_32x32x16_bf16 v[32:47], v[72:75], v[184:187], 0
    v_exp_f32 v48, v48
    v_exp_f32 v49, v49
    v_exp_f32 v50, v50
    v_mfma_f32_32x32x16_bf16 v[32:47], v[76:79], v[188:191], v[32:47]
    v_exp_f32 v51, v51
    v_exp_f32 v52, v52
    v_exp_f32 v53, v53
    v_mfma_f32_32x32x16_bf16 v[144:159], v[120:123], a[224:227], 0
    v_exp_f32 v54, v54
    v_exp_f32 v55, v55
    v_exp_f32 v56, v56
    v_mfma_f32_32x32x16_bf16 v[144:159], v[124:127], a[228:231], v[144:159]
    v_exp_f32 v57, v57
    v_exp_f32 v58, v58
    v_exp_f32 v59, v59
    v_exp_f32 v60, v60
    v_exp_f32 v61, v61
    v_exp_f32 v62, v62
    v_exp_f32 v63, v63
    v_pk_add_f32 v[48:49], v[48:49], 1.0 op_sel_hi:[1,0]
    v_pk_add_f32 v[50:51], v[50:51], 1.0 op_sel_hi:[1,0]
    v_pk_add_f32 v[52:53], v[52:53], 1.0 op_sel_hi:[1,0]
    v_pk_add_f32 v[54:55], v[54:55], 1.0 op_sel_hi:[1,0]
    v_pk_add_f32 v[56:57], v[56:57], 1.0 op_sel_hi:[1,0]
    v_pk_add_f32 v[58:59], v[58:59], 1.0 op_sel_hi:[1,0]
    v_pk_add_f32 v[60:61], v[60:61], 1.0 op_sel_hi:[1,0]
    v_pk_add_f32 v[62:63], v[62:63], 1.0 op_sel_hi:[1,0]
    v_pk_mul_f32 v[10:11], v[144:145], v[144:145]
    v_pk_add_f32 v[8:9], v[144:145], v[146:147]
    v_pk_fma_f32 v[10:11], v[146:147], v[146:147], v[10:11]
    v_pk_add_f32 v[8:9], v[8:9], v[148:149]
    v_pk_fma_f32 v[10:11], v[148:149], v[148:149], v[10:11]
    v_pk_add_f32 v[8:9], v[8:9], v[150:151]
    v_pk_fma_f32 v[10:11], v[150:151], v[150:151], v[10:11]
    v_pk_add_f32 v[8:9], v[8:9], v[152:153]
    v_pk_fma_f32 v[10:11], v[152:153], v[152:153], v[10:11]
    v_pk_add_f32 v[8:9], v[8:9], v[154:155]
    v_pk_fma_f32 v[10:11], v[154:155], v[154:155], v[10:11]
    v_pk_add_f32 v[8:9], v[8:9], v[156:157]
    v_pk_fma_f32 v[10:11], v[156:157], v[156:157], v[10:11]
    v_pk_add_f32 v[8:9], v[8:9], v[158:159]
    v_pk_fma_f32 v[10:11], v[158:159], v[158:159], v[10:11]
    v_mfma_f32_32x32x16_bf16 v[32:47], v[80:83], v[192:195], v[32:47]
    s_mul_i32 s59, s57, 18432
    s_add_u32 s59, s59, 11264
    s_add_u32 m0, s59, 73728
    s_nop 0
    buffer_load_dwordx4 v2, s[36:39], s59 offen lds
    v_rcp_f32 v48, v48
    v_mfma_f32_32x32x16_bf16 v[32:47], v[84:87], v[196:199], v[32:47]
    v_rcp_f32 v49, v49
    v_rcp_f32 v50, v50
    v_rcp_f32 v51, v51
    v_mfma_f32_32x32x16_bf16 v[32:47], v[88:91], v[200:203], v[32:47]
    v_rcp_f32 v52, v52
    v_rcp_f32 v53, v53
    v_rcp_f32 v54, v54
    v_mfma_f32_32x32x16_bf16 v[32:47], v[92:95], v[204:207], v[32:47]
    v_rcp_f32 v55, v55
    v_rcp_f32 v56, v56
    v_rcp_f32 v57, v57
    v_rcp_f32 v58, v58
    v_rcp_f32 v59, v59
    v_rcp_f32 v60, v60
    v_rcp_f32 v61, v61
    v_rcp_f32 v62, v62
    v_rcp_f32_e64 v63, v63
    v_pk_mul_f32 v[48:49], v[16:17], v[48:49]
    v_pk_mul_f32 v[50:51], v[18:19], v[50:51]
    v_pk_mul_f32 v[52:53], v[20:21], v[52:53]
    v_pk_mul_f32 v[54:55], v[22:23], v[54:55]
    v_pk_mul_f32 v[56:57], v[24:25], v[56:57]
    v_pk_mul_f32 v[58:59], v[26:27], v[58:59]
    v_pk_mul_f32 v[60:61], v[28:29], v[60:61]
    v_pk_mul_f32 v[62:63], v[30:31], v[62:63]
    v_pk_fma_f32 v[112:113], v[48:49], v[48:49], v[112:113]
    v_pk_fma_f32 v[112:113], v[50:51], v[50:51], v[112:113]
    v_pk_fma_f32 v[112:113], v[52:53], v[52:53], v[112:113]
    v_pk_fma_f32 v[112:113], v[54:55], v[54:55], v[112:113]
    v_pk_fma_f32 v[112:113], v[56:57], v[56:57], v[112:113]
    v_pk_fma_f32 v[112:113], v[58:59], v[58:59], v[112:113]
    v_pk_fma_f32 v[112:113], v[60:61], v[60:61], v[112:113]
    v_pk_fma_f32 v[112:113], v[62:63], v[62:63], v[112:113]
    v_pk_fma_f32 v[48:49], v[32:33], v[32:33], s[52:53]
    v_pk_fma_f32 v[50:51], v[34:35], v[34:35], s[52:53]
    v_pk_fma_f32 v[52:53], v[36:37], v[36:37], s[52:53]
    v_pk_fma_f32 v[54:55], v[38:39], v[38:39], s[52:53]
    v_pk_fma_f32 v[56:57], v[40:41], v[40:41], s[52:53]
    v_pk_fma_f32 v[58:59], v[42:43], v[42:43], s[52:53]
    v_pk_fma_f32 v[60:61], v[44:45], v[44:45], s[52:53]
    v_pk_fma_f32 v[62:63], v[46:47], v[46:47], s[52:53]
    v_pk_mul_f32 v[48:49], v[48:49], v[32:33] neg_lo:[1,0] neg_hi:[1,0]
    v_pk_mul_f32 v[50:51], v[50:51], v[34:35] neg_lo:[1,0] neg_hi:[1,0]
    v_pk_mul_f32 v[52:53], v[52:53], v[36:37] neg_lo:[1,0] neg_hi:[1,0]
    v_pk_mul_f32 v[54:55], v[54:55], v[38:39] neg_lo:[1,0] neg_hi:[1,0]
    v_pk_mul_f32 v[56:57], v[56:57], v[40:41] neg_lo:[1,0] neg_hi:[1,0]
    v_pk_mul_f32 v[58:59], v[58:59], v[42:43] neg_lo:[1,0] neg_hi:[1,0]
    v_pk_mul_f32 v[60:61], v[60:61], v[44:45] neg_lo:[1,0] neg_hi:[1,0]
    v_pk_mul_f32 v[62:63], v[62:63], v[46:47] neg_lo:[1,0] neg_hi:[1,0]
    v_mfma_f32_32x32x16_bf16 v[16:31], v[72:75], v[208:211], 0
    v_exp_f32 v48, v48
    v_exp_f32 v49, v49
    v_exp_f32 v50, v50
    v_mfma_f32_32x32x16_bf16 v[16:31], v[76:79], v[212:215], v[16:31]
    v_exp_f32 v51, v51
    v_exp_f32 v52, v52
    v_exp_f32 v53, v53
    v_mfma_f32_32x32x16_bf16 v[144:159], v[128:131], a[232:235], 0
    v_exp_f32 v54, v54
    v_exp_f32 v55, v55
    v_exp_f32 v56, v56
    v_mfma_f32_32x32x16_bf16 v[144:159], v[132:135], a[236:239], v[144:159]
    v_exp_f32 v57, v57
    v_exp_f32 v58, v58
    v_exp_f32 v59, v59
    v_exp_f32 v60, v60
    v_exp_f32 v61, v61
    v_exp_f32 v62, v62
    v_exp_f32 v63, v63
    v_pk_add_f32 v[48:49], v[48:49], 1.0 op_sel_hi:[1,0]
    v_pk_add_f32 v[50:51], v[50:51], 1.0 op_sel_hi:[1,0]
    v_pk_add_f32 v[52:53], v[52:53], 1.0 op_sel_hi:[1,0]
    v_pk_add_f32 v[54:55], v[54:55], 1.0 op_sel_hi:[1,0]
    v_pk_add_f32 v[56:57], v[56:57], 1.0 op_sel_hi:[1,0]
    v_pk_add_f32 v[58:59], v[58:59], 1.0 op_sel_hi:[1,0]
    v_pk_add_f32 v[60:61], v[60:61], 1.0 op_sel_hi:[1,0]
    v_pk_add_f32 v[62:63], v[62:63], 1.0 op_sel_hi:[1,0]
    v_pk_add_f32 v[8:9], v[8:9], v[144:145]
    v_pk_fma_f32 v[10:11], v[144:145], v[144:145], v[10:11]
    v_pk_add_f32 v[8:9], v[8:9], v[146:147]
    v_pk_fma_f32 v[10:11], v[146:147], v[146:147], v[10:11]
    v_pk_add_f32 v[8:9], v[8:9], v[148:149]
    v_pk_fma_f32 v[10:11], v[148:149], v[148:149], v[10:11]
    v_pk_add_f32 v[8:9], v[8:9], v[150:151]
    v_pk_fma_f32 v[10:11], v[150:151], v[150:151], v[10:11]
    v_pk_add_f32 v[8:9], v[8:9], v[152:153]
    v_pk_fma_f32 v[10:11], v[152:153], v[152:153], v[10:11]
    v_pk_add_f32 v[8:9], v[8:9], v[154:155]
    v_pk_fma_f32 v[10:11], v[154:155], v[154:155], v[10:11]
    v_pk_add_f32 v[8:9], v[8:9], v[156:157]
    v_pk_fma_f32 v[10:11], v[156:157], v[156:157], v[10:11]
    v_pk_add_f32 v[8:9], v[8:9], v[158:159]
    v_pk_fma_f32 v[10:11], v[158:159], v[158:159], v[10:11]
    v_mfma_f32_32x32x16_bf16 v[16:31], v[80:83], v[216:219], v[16:31]
    s_mul_i32 s59, s57, 18432
    s_add_u32 s59, s59, 12288
    s_add_u32 m0, s59, 73728
    s_nop 0
    buffer_load_dwordx4 v2, s[36:39], s59 offen lds
    v_rcp_f32 v48, v48
    v_mfma_f32_32x32x16_bf16 v[16:31], v[84:87], v[220:223], v[16:31]
    v_rcp_f32 v49, v49
    v_rcp_f32 v50, v50
    v_rcp_f32 v51, v51
    v_mfma_f32_32x32x16_bf16 v[16:31], v[88:91], v[224:227], v[16:31]
    v_rcp_f32 v52, v52
    v_rcp_f32 v53, v53
    v_rcp_f32 v54, v54
    v_mfma_f32_32x32x16_bf16 v[16:31], v[92:95], v[228:231], v[16:31]
    v_rcp_f32 v55, v55
    v_rcp_f32 v56, v56
    v_rcp_f32 v57, v57
    v_rcp_f32 v58, v58
    v_rcp_f32 v59, v59
    v_rcp_f32 v60, v60
    v_rcp_f32 v61, v61
    v_rcp_f32 v62, v62
    v_rcp_f32_e64 v63, v63
    v_pk_mul_f32 v[48:49], v[32:33], v[48:49]
    v_pk_mul_f32 v[50:51], v[34:35], v[50:51]
    v_pk_mul_f32 v[52:53], v[36:37], v[52:53]
    v_pk_mul_f32 v[54:55], v[38:39], v[54:55]
    v_pk_mul_f32 v[56:57], v[40:41], v[56:57]
    v_pk_mul_f32 v[58:59], v[42:43], v[58:59]
    v_pk_mul_f32 v[60:61], v[44:45], v[60:61]
    v_pk_mul_f32 v[62:63], v[46:47], v[62:63]
    v_pk_fma_f32 v[114:115], v[48:49], v[48:49], v[114:115]
    v_pk_fma_f32 v[114:115], v[50:51], v[50:51], v[114:115]
    v_pk_fma_f32 v[114:115], v[52:53], v[52:53], v[114:115]
    v_pk_fma_f32 v[114:115], v[54:55], v[54:55], v[114:115]
    v_pk_fma_f32 v[114:115], v[56:57], v[56:57], v[114:115]
    v_pk_fma_f32 v[114:115], v[58:59], v[58:59], v[114:115]
    v_pk_fma_f32 v[114:115], v[60:61], v[60:61], v[114:115]
    v_pk_fma_f32 v[114:115], v[62:63], v[62:63], v[114:115]
    v_pk_fma_f32 v[48:49], v[16:17], v[16:17], s[52:53]
    v_pk_fma_f32 v[50:51], v[18:19], v[18:19], s[52:53]
    v_pk_fma_f32 v[52:53], v[20:21], v[20:21], s[52:53]
    v_pk_fma_f32 v[54:55], v[22:23], v[22:23], s[52:53]
    v_pk_fma_f32 v[56:57], v[24:25], v[24:25], s[52:53]
    v_pk_fma_f32 v[58:59], v[26:27], v[26:27], s[52:53]
    v_pk_fma_f32 v[60:61], v[28:29], v[28:29], s[52:53]
    v_pk_fma_f32 v[62:63], v[30:31], v[30:31], s[52:53]
    v_pk_mul_f32 v[48:49], v[48:49], v[16:17] neg_lo:[1,0] neg_hi:[1,0]
    v_pk_mul_f32 v[50:51], v[50:51], v[18:19] neg_lo:[1,0] neg_hi:[1,0]
    v_pk_mul_f32 v[52:53], v[52:53], v[20:21] neg_lo:[1,0] neg_hi:[1,0]
    v_pk_mul_f32 v[54:55], v[54:55], v[22:23] neg_lo:[1,0] neg_hi:[1,0]
    v_pk_mul_f32 v[56:57], v[56:57], v[24:25] neg_lo:[1,0] neg_hi:[1,0]
    v_pk_mul_f32 v[58:59], v[58:59], v[26:27] neg_lo:[1,0] neg_hi:[1,0]
    v_pk_mul_f32 v[60:61], v[60:61], v[28:29] neg_lo:[1,0] neg_hi:[1,0]
    v_pk_mul_f32 v[62:63], v[62:63], v[30:31] neg_lo:[1,0] neg_hi:[1,0]
    v_mfma_f32_32x32x16_bf16 v[32:47], v[72:75], v[232:235], 0
    s_mul_i32 s59, s57, 18432
    s_add_u32 s59, s59, 13312
    s_add_u32 m0, s59, 73728
    s_nop 0
    buffer_load_dwordx4 v2, s[36:39], s59 offen lds
    v_exp_f32 v48, v48
    v_mfma_f32_32x32x16_bf16 v[32:47], v[76:79], v[236:239], v[32:47]
    v_exp_f32 v49, v49
    v_exp_f32 v50, v50
    v_exp_f32 v51, v51
    v_mfma_f32_32x32x16_bf16 v[32:47], v[80:83], v[240:243], v[32:47]
    v_exp_f32 v52, v52
    v_exp_f32 v53, v53
    v_exp_f32 v54, v54
    v_mfma_f32_32x32x16_bf16 v[32:47], v[84:87], v[244:247], v[32:47]
    v_exp_f32 v55, v55
    v_exp_f32 v56, v56
    v_exp_f32 v57, v57
    v_mfma_f32_32x32x16_bf16 v[144:159], v[136:139], a[240:243], 0
    v_exp_f32 v58, v58
    v_exp_f32 v59, v59
    v_exp_f32 v60, v60
    v_mfma_f32_32x32x16_bf16 v[144:159], v[140:143], a[244:247], v[144:159]
    v_exp_f32 v61, v61
    v_exp_f32 v62, v62
    v_exp_f32_e64 v63, v63
    v_pk_add_f32 v[48:49], v[48:49], 1.0 op_sel_hi:[1,0]
    v_pk_add_f32 v[50:51], v[50:51], 1.0 op_sel_hi:[1,0]
    v_pk_add_f32 v[52:53], v[52:53], 1.0 op_sel_hi:[1,0]
    v_pk_add_f32 v[54:55], v[54:55], 1.0 op_sel_hi:[1,0]
    v_pk_add_f32 v[56:57], v[56:57], 1.0 op_sel_hi:[1,0]
    v_pk_add_f32 v[58:59], v[58:59], 1.0 op_sel_hi:[1,0]
    v_pk_add_f32 v[60:61], v[60:61], 1.0 op_sel_hi:[1,0]
    v_pk_add_f32 v[62:63], v[62:63], 1.0 op_sel_hi:[1,0]
    v_pk_add_f32 v[8:9], v[8:9], v[144:145]
    v_pk_fma_f32 v[10:11], v[144:145], v[144:145], v[10:11]
    v_pk_add_f32 v[8:9], v[8:9], v[146:147]
    v_pk_fma_f32 v[10:11], v[146:147], v[146:147], v[10:11]
    v_pk_add_f32 v[8:9], v[8:9], v[148:149]
    v_pk_fma_f32 v[10:11], v[148:149], v[148:149], v[10:11]
    v_pk_add_f32 v[8:9], v[8:9], v[150:151]
    v_pk_fma_f32 v[10:11], v[150:151], v[150:151], v[10:11]
    v_pk_add_f32 v[8:9], v[8:9], v[152:153]
    v_pk_fma_f32 v[10:11], v[152:153], v[152:153], v[10:11]
    v_pk_add_f32 v[8:9], v[8:9], v[154:155]
    v_pk_fma_f32 v[10:11], v[154:155], v[154:155], v[10:11]
    v_pk_add_f32 v[8:9], v[8:9], v[156:157]
    v_pk_fma_f32 v[10:11], v[156:157], v[156:157], v[10:11]
    v_pk_add_f32 v[8:9], v[8:9], v[158:159]
    v_pk_fma_f32 v[10:11], v[158:159], v[158:159], v[10:11]
    v_mfma_f32_32x32x16_bf16 v[32:47], v[88:91], v[248:251], v[32:47]
    s_mul_i32 s59, s57, 18432
    s_add_u32 s59, s59, 14336
    s_add_u32 m0, s59, 73728
    s_nop 0
    buffer_load_dwordx4 v2, s[36:39], s59 offen lds
    v_rcp_f32 v48, v48
    v_mfma_f32_32x32x16_bf16 v[32:47], v[92:95], v[252:255], v[32:47]
    v_rcp_f32 v49, v49
    v_rcp_f32 v50, v50
    v_rcp_f32 v51, v51
    v_mfma_f32_32x32x16_bf16 v[144:159], v[120:123], a[224:227], 0
    v_rcp_f32 v52, v52
    v_rcp_f32 v53, v53
    v_rcp_f32 v54, v54
    v_mfma_f32_32x32x16_bf16 v[144:159], v[124:127], a[228:231], v[144:159]
    v_add_f32 v8, v8, v9
    v_add_f32 v10, v10, v11
    s_nop 1
    v_permlane32_swap_b32 v8, v10
    v_add_f32 v8, v8, v10
    v_mov_b32 v10, v8
    s_nop 1
    v_permlane32_swap_b32 v8, v10
    v_rcp_f32 v55, v55
    v_mul_f32 v8, 0x3c2aaaab, v8
    v_rcp_f32 v56, v56
    v_rcp_f32 v57, v57
    v_mul_f32 v10, 0x3c2aaaab, v10
    v_rcp_f32 v58, v58
    v_fma_f32 v10, -v8, v8, v10
    v_rcp_f32 v59, v59
    v_max_f32 v10, 0, v10
    v_rcp_f32 v60, v60
    v_add_f32 v10, 0x3727c5ac, v10
    v_rcp_f32 v61, v61
    v_rsq_f32 v10, v10
    v_rcp_f32 v62, v62
    v_mul_f32 v12, 0x3eeff558, v10
    v_rcp_f32_e64 v63, v63
    v_mul_f32_e64 v13, -v8, v12
    v_pk_mul_f32 v[48:49], v[16:17], v[48:49]
    v_pk_mul_f32 v[50:51], v[18:19], v[50:51]
    v_pk_mul_f32 v[52:53], v[20:21], v[52:53]
    v_pk_mul_f32 v[54:55], v[22:23], v[54:55]
    v_pk_mul_f32 v[56:57], v[24:25], v[56:57]
    v_pk_mul_f32 v[58:59], v[26:27], v[58:59]
    v_pk_mul_f32 v[60:61], v[28:29], v[60:61]
    v_pk_mul_f32 v[62:63], v[30:31], v[62:63]
    v_pk_fma_f32 v[116:117], v[48:49], v[48:49], v[116:117]
    v_pk_fma_f32 v[116:117], v[50:51], v[50:51], v[116:117]
    v_pk_fma_f32 v[116:117], v[52:53], v[52:53], v[116:117]
    v_pk_fma_f32 v[116:117], v[54:55], v[54:55], v[116:117]
    v_pk_fma_f32 v[116:117], v[56:57], v[56:57], v[116:117]
    v_pk_fma_f32 v[116:117], v[58:59], v[58:59], v[116:117]
    v_pk_fma_f32 v[116:117], v[60:61], v[60:61], v[116:117]
    v_pk_fma_f32 v[116:117], v[62:63], v[62:63], v[116:117]
    v_pk_fma_f32 v[144:145], v[144:145], v[12:13], v[12:13] op_sel:[0,0,1] op_sel_hi:[1,0,1]
    v_pk_fma_f32 v[146:147], v[146:147], v[12:13], v[12:13] op_sel:[0,0,1] op_sel_hi:[1,0,1]
    v_pk_fma_f32 v[148:149], v[148:149], v[12:13], v[12:13] op_sel:[0,0,1] op_sel_hi:[1,0,1]
    v_pk_fma_f32 v[150:151], v[150:151], v[12:13], v[12:13] op_sel:[0,0,1] op_sel_hi:[1,0,1]
    v_pk_fma_f32 v[152:153], v[152:153], v[12:13], v[12:13] op_sel:[0,0,1] op_sel_hi:[1,0,1]
    v_pk_fma_f32 v[154:155], v[154:155], v[12:13], v[12:13] op_sel:[0,0,1] op_sel_hi:[1,0,1]
    v_pk_fma_f32 v[156:157], v[156:157], v[12:13], v[12:13] op_sel:[0,0,1] op_sel_hi:[1,0,1]
    v_pk_fma_f32 v[158:159], v[158:159], v[12:13], v[12:13] op_sel:[0,0,1] op_sel_hi:[1,0,1]
    v_cvt_pk_bf16_f32 v72, v144, v145
    v_cvt_pk_bf16_f32 v73, v146, v147
    v_cvt_pk_bf16_f32 v74, v148, v149
    v_cvt_pk_bf16_f32 v75, v150, v151
    v_cvt_pk_bf16_f32 v76, v152, v153
    v_cvt_pk_bf16_f32 v77, v154, v155
    v_cvt_pk_bf16_f32 v78, v156, v157
    v_cvt_pk_bf16_f32 v79, v158, v159
    v_pk_fma_f32 v[48:49], v[32:33], v[32:33], s[52:53]
    v_pk_fma_f32 v[50:51], v[34:35], v[34:35], s[52:53]
    v_pk_fma_f32 v[52:53], v[36:37], v[36:37], s[52:53]
    v_pk_fma_f32 v[54:55], v[38:39], v[38:39], s[52:53]
    v_pk_fma_f32 v[56:57], v[40:41], v[40:41], s[52:53]
    v_pk_fma_f32 v[58:59], v[42:43], v[42:43], s[52:53]
    v_pk_fma_f32 v[60:61], v[44:45], v[44:45], s[52:53]
    v_pk_fma_f32 v[62:63], v[46:47], v[46:47], s[52:53]
    v_pk_mul_f32 v[48:49], v[48:49], v[32:33] neg_lo:[1,0] neg_hi:[1,0]
    v_pk_mul_f32 v[50:51], v[50:51], v[34:35] neg_lo:[1,0] neg_hi:[1,0]
    v_pk_mul_f32 v[52:53], v[52:53], v[36:37] neg_lo:[1,0] neg_hi:[1,0]
    v_pk_mul_f32 v[54:55], v[54:55], v[38:39] neg_lo:[1,0] neg_hi:[1,0]
    v_pk_mul_f32 v[56:57], v[56:57], v[40:41] neg_lo:[1,0] neg_hi:[1,0]
    v_pk_mul_f32 v[58:59], v[58:59], v[42:43] neg_lo:[1,0] neg_hi:[1,0]
    v_pk_mul_f32 v[60:61], v[60:61], v[44:45] neg_lo:[1,0] neg_hi:[1,0]
    v_pk_mul_f32 v[62:63], v[62:63], v[46:47] neg_lo:[1,0] neg_hi:[1,0]
    v_mfma_f32_32x32x16_bf16 v[144:159], v[128:131], a[232:235], 0
    v_exp_f32 v48, v48
    v_exp_f32 v49, v49
    v_exp_f32 v50, v50
    v_mfma_f32_32x32x16_bf16 v[144:159], v[132:135], a[236:239], v[144:159]
    v_exp_f32 v51, v51
    v_exp_f32 v52, v52
    v_exp_f32 v53, v53
    v_mfma_f32_32x32x16_bf16 v[16:31], v[136:139], a[240:243], 0
    v_exp_f32 v54, v54
    v_exp_f32 v55, v55
    v_exp_f32 v56, v56
    v_mfma_f32_32x32x16_bf16 v[16:31], v[140:143], a[244:247], v[16:31]
    v_exp_f32 v57, v57
    v_exp_f32 v58, v58
    v_exp_f32 v59, v59
    v_exp_f32 v60, v60
    v_exp_f32 v61, v61
    v_exp_f32 v62, v62
    v_exp_f32 v63, v63
    v_pk_add_f32 v[48:49], v[48:49], 1.0 op_sel_hi:[1,0]
    v_pk_add_f32 v[50:51], v[50:51], 1.0 op_sel_hi:[1,0]
    v_pk_add_f32 v[52:53], v[52:53], 1.0 op_sel_hi:[1,0]
    v_pk_add_f32 v[54:55], v[54:55], 1.0 op_sel_hi:[1,0]
    v_pk_add_f32 v[56:57], v[56:57], 1.0 op_sel_hi:[1,0]
    v_pk_add_f32 v[58:59], v[58:59], 1.0 op_sel_hi:[1,0]
    v_pk_add_f32 v[60:61], v[60:61], 1.0 op_sel_hi:[1,0]
    v_pk_add_f32 v[62:63], v[62:63], 1.0 op_sel_hi:[1,0]
    v_pk_fma_f32 v[144:145], v[144:145], v[12:13], v[12:13] op_sel:[0,0,1] op_sel_hi:[1,0,1]
    v_pk_fma_f32 v[146:147], v[146:147], v[12:13], v[12:13] op_sel:[0,0,1] op_sel_hi:[1,0,1]
    v_pk_fma_f32 v[148:149], v[148:149], v[12:13], v[12:13] op_sel:[0,0,1] op_sel_hi:[1,0,1]
    v_pk_fma_f32 v[150:151], v[150:151], v[12:13], v[12:13] op_sel:[0,0,1] op_sel_hi:[1,0,1]
    v_pk_fma_f32 v[152:153], v[152:153], v[12:13], v[12:13] op_sel:[0,0,1] op_sel_hi:[1,0,1]
    v_pk_fma_f32 v[154:155], v[154:155], v[12:13], v[12:13] op_sel:[0,0,1] op_sel_hi:[1,0,1]
    v_pk_fma_f32 v[156:157], v[156:157], v[12:13], v[12:13] op_sel:[0,0,1] op_sel_hi:[1,0,1]
    v_pk_fma_f32 v[158:159], v[158:159], v[12:13], v[12:13] op_sel:[0,0,1] op_sel_hi:[1,0,1]
    v_cvt_pk_bf16_f32 v80, v144, v145
    v_cvt_pk_bf16_f32 v81, v146, v147
    v_cvt_pk_bf16_f32 v82, v148, v149
    v_cvt_pk_bf16_f32 v83, v150, v151
    v_cvt_pk_bf16_f32 v84, v152, v153
    v_cvt_pk_bf16_f32 v85, v154, v155
    v_cvt_pk_bf16_f32 v86, v156, v157
    v_cvt_pk_bf16_f32 v87, v158, v159
    v_pk_fma_f32 v[16:17], v[16:17], v[12:13], v[12:13] op_sel:[0,0,1] op_sel_hi:[1,0,1]
    v_pk_fma_f32 v[18:19], v[18:19], v[12:13], v[12:13] op_sel:[0,0,1] op_sel_hi:[1,0,1]
    v_pk_fma_f32 v[20:21], v[20:21], v[12:13], v[12:13] op_sel:[0,0,1] op_sel_hi:[1,0,1]
    v_pk_fma_f32 v[22:23], v[22:23], v[12:13], v[12:13] op_sel:[0,0,1] op_sel_hi:[1,0,1]
    v_pk_fma_f32 v[24:25], v[24:25], v[12:13], v[12:13] op_sel:[0,0,1] op_sel_hi:[1,0,1]
    v_pk_fma_f32 v[26:27], v[26:27], v[12:13], v[12:13] op_sel:[0,0,1] op_sel_hi:[1,0,1]
    v_pk_fma_f32 v[28:29], v[28:29], v[12:13], v[12:13] op_sel:[0,0,1] op_sel_hi:[1,0,1]
    v_pk_fma_f32 v[30:31], v[30:31], v[12:13], v[12:13] op_sel:[0,0,1] op_sel_hi:[1,0,1]
    v_cvt_pk_bf16_f32 v88, v16, v17
    v_cvt_pk_bf16_f32 v89, v18, v19
    v_cvt_pk_bf16_f32 v90, v20, v21
    v_cvt_pk_bf16_f32 v91, v22, v23
    v_cvt_pk_bf16_f32 v92, v24, v25
    v_cvt_pk_bf16_f32 v93, v26, v27
    v_cvt_pk_bf16_f32 v94, v28, v29
    v_cvt_pk_bf16_f32 v95, v30, v31
    v_mfma_f32_32x32x16_bf16 v[16:31], a[32:35], v[72:75], 0
    s_add_u32 s54, s56, 122880
    buffer_load_dwordx4 a[224:227], v1, s[24:27], s54 offen offset:0
    buffer_load_dwordx4 a[228:231], v1, s[24:27], s54 offen offset:32
    v_rcp_f32 v48, v48
    v_rcp_f32 v49, v49
    v_mfma_f32_32x32x16_bf16 v[16:31], a[36:39], v[76:79], v[16:31]
    buffer_load_dwordx4 a[232:235], v1, s[24:27], s54 offen offset:64
    buffer_load_dwordx4 a[236:239], v1, s[24:27], s54 offen offset:96
    v_rcp_f32 v50, v50
    v_rcp_f32 v51, v51
    v_mfma_f32_32x32x16_bf16 v[16:31], a[40:43], v[80:83], v[16:31]
    buffer_load_dwordx4 a[240:243], v1, s[24:27], s54 offen offset:128
    buffer_load_dwordx4 a[244:247], v1, s[24:27], s54 offen offset:160
    v_rcp_f32 v52, v52
    v_rcp_f32 v53, v53
    v_mfma_f32_32x32x16_bf16 v[16:31], a[44:47], v[84:87], v[16:31]
    v_rcp_f32 v54, v54
    v_rcp_f32 v55, v55
    v_rcp_f32 v56, v56
    v_mfma_f32_32x32x16_bf16 v[16:31], a[48:51], v[88:91], v[16:31]
    v_rcp_f32 v57, v57
    v_rcp_f32 v58, v58
    v_rcp_f32 v59, v59
    v_mfma_f32_32x32x16_bf16 v[16:31], a[52:55], v[92:95], v[16:31]
    v_rcp_f32 v60, v60
    v_rcp_f32 v61, v61
    v_rcp_f32 v62, v62
    v_rcp_f32 v63, v63
    v_pk_mul_f32 v[48:49], v[32:33], v[48:49]
    v_pk_mul_f32 v[50:51], v[34:35], v[50:51]
    v_pk_mul_f32 v[52:53], v[36:37], v[52:53]
    v_pk_mul_f32 v[54:55], v[38:39], v[54:55]
    v_pk_mul_f32 v[56:57], v[40:41], v[56:57]
    v_pk_mul_f32 v[58:59], v[42:43], v[58:59]
    v_pk_mul_f32 v[60:61], v[44:45], v[60:61]
    v_pk_mul_f32 v[62:63], v[46:47], v[62:63]
    v_pk_fma_f32 v[118:119], v[48:49], v[48:49], v[118:119]
    v_pk_fma_f32 v[118:119], v[50:51], v[50:51], v[118:119]
    v_pk_fma_f32 v[118:119], v[52:53], v[52:53], v[118:119]
    v_pk_fma_f32 v[118:119], v[54:55], v[54:55], v[118:119]
    v_pk_fma_f32 v[118:119], v[56:57], v[56:57], v[118:119]
    v_pk_fma_f32 v[118:119], v[58:59], v[58:59], v[118:119]
    v_pk_fma_f32 v[118:119], v[60:61], v[60:61], v[118:119]
    v_pk_fma_f32 v[118:119], v[62:63], v[62:63], v[118:119]
    v_pk_fma_f32 v[48:49], v[16:17], v[16:17], s[52:53]
    v_pk_fma_f32 v[50:51], v[18:19], v[18:19], s[52:53]
    v_pk_fma_f32 v[52:53], v[20:21], v[20:21], s[52:53]
    v_pk_fma_f32 v[54:55], v[22:23], v[22:23], s[52:53]
    v_pk_fma_f32 v[56:57], v[24:25], v[24:25], s[52:53]
    v_pk_fma_f32 v[58:59], v[26:27], v[26:27], s[52:53]
    v_pk_fma_f32 v[60:61], v[28:29], v[28:29], s[52:53]
    v_pk_fma_f32 v[62:63], v[30:31], v[30:31], s[52:53]
    v_pk_mul_f32 v[48:49], v[48:49], v[16:17] neg_lo:[1,0] neg_hi:[1,0]
    v_pk_mul_f32 v[50:51], v[50:51], v[18:19] neg_lo:[1,0] neg_hi:[1,0]
    v_pk_mul_f32 v[52:53], v[52:53], v[20:21] neg_lo:[1,0] neg_hi:[1,0]
    v_pk_mul_f32 v[54:55], v[54:55], v[22:23] neg_lo:[1,0] neg_hi:[1,0]
    v_pk_mul_f32 v[56:57], v[56:57], v[24:25] neg_lo:[1,0] neg_hi:[1,0]
    v_pk_mul_f32 v[58:59], v[58:59], v[26:27] neg_lo:[1,0] neg_hi:[1,0]
    v_pk_mul_f32 v[60:61], v[60:61], v[28:29] neg_lo:[1,0] neg_hi:[1,0]
    v_pk_mul_f32 v[62:63], v[62:63], v[30:31] neg_lo:[1,0] neg_hi:[1,0]
    v_mfma_f32_32x32x16_bf16 v[32:47], a[56:59], v[72:75], 0
    v_exp_f32 v48, v48
    v_exp_f32 v49, v49
    v_exp_f32 v50, v50
    v_mfma_f32_32x32x16_bf16 v[32:47], a[60:63], v[76:79], v[32:47]
    v_exp_f32 v51, v51
    v_exp_f32 v52, v52
    v_exp_f32 v53, v53
    v_exp_f32 v54, v54
    v_exp_f32 v55, v55
    v_exp_f32 v56, v56
    v_exp_f32 v57, v57
    v_exp_f32 v58, v58
    v_exp_f32 v59, v59
    v_exp_f32 v60, v60
    v_exp_f32 v61, v61
    v_exp_f32 v62, v62
    v_exp_f32 v63, v63
    v_pk_add_f32 v[48:49], v[48:49], 1.0 op_sel_hi:[1,0]
    v_pk_add_f32 v[50:51], v[50:51], 1.0 op_sel_hi:[1,0]
    v_pk_add_f32 v[52:53], v[52:53], 1.0 op_sel_hi:[1,0]
    v_pk_add_f32 v[54:55], v[54:55], 1.0 op_sel_hi:[1,0]
    v_pk_add_f32 v[56:57], v[56:57], 1.0 op_sel_hi:[1,0]
    v_pk_add_f32 v[58:59], v[58:59], 1.0 op_sel_hi:[1,0]
    v_pk_add_f32 v[60:61], v[60:61], 1.0 op_sel_hi:[1,0]
    v_pk_add_f32 v[62:63], v[62:63], 1.0 op_sel_hi:[1,0]
    v_mfma_f32_32x32x16_bf16 v[32:47], a[64:67], v[80:83], v[32:47]
    v_rcp_f32 v48, v48
    v_rcp_f32 v49, v49
    v_rcp_f32 v50, v50
    v_mfma_f32_32x32x16_bf16 v[32:47], a[68:71], v[84:87], v[32:47]
    v_rcp_f32 v51, v51
    v_rcp_f32 v52, v52
    v_rcp_f32 v53, v53
    v_mfma_f32_32x32x16_bf16 v[32:47], a[72:75], v[88:91], v[32:47]
    v_rcp_f32 v54, v54
    v_rcp_f32 v55, v55
    v_rcp_f32 v56, v56
    v_mfma_f32_32x32x16_bf16 v[32:47], a[76:79], v[92:95], v[32:47]
    v_rcp_f32 v57, v57
    v_rcp_f32 v58, v58
    v_rcp_f32 v59, v59
    v_rcp_f32 v60, v60
    v_rcp_f32 v61, v61
    v_rcp_f32 v62, v62
    v_rcp_f32 v63, v63
    v_pk_mul_f32 v[16:17], v[16:17], v[48:49]
    v_pk_mul_f32 v[18:19], v[18:19], v[50:51]
    v_pk_mul_f32 v[20:21], v[20:21], v[52:53]
    v_pk_mul_f32 v[22:23], v[22:23], v[54:55]
    v_pk_mul_f32 v[24:25], v[24:25], v[56:57]
    v_pk_mul_f32 v[26:27], v[26:27], v[58:59]
    v_pk_mul_f32 v[28:29], v[28:29], v[60:61]
    v_pk_mul_f32 v[30:31], v[30:31], v[62:63]
    v_pk_fma_f32 v[48:49], v[32:33], v[32:33], s[52:53]
    v_pk_fma_f32 v[50:51], v[34:35], v[34:35], s[52:53]
    v_pk_fma_f32 v[52:53], v[36:37], v[36:37], s[52:53]
    v_pk_fma_f32 v[54:55], v[38:39], v[38:39], s[52:53]
    v_pk_fma_f32 v[56:57], v[40:41], v[40:41], s[52:53]
    v_pk_fma_f32 v[58:59], v[42:43], v[42:43], s[52:53]
    v_pk_fma_f32 v[60:61], v[44:45], v[44:45], s[52:53]
    v_pk_fma_f32 v[62:63], v[46:47], v[46:47], s[52:53]
    v_pk_mul_f32 v[48:49], v[48:49], v[32:33] neg_lo:[1,0] neg_hi:[1,0]
    v_pk_mul_f32 v[50:51], v[50:51], v[34:35] neg_lo:[1,0] neg_hi:[1,0]
    v_pk_mul_f32 v[52:53], v[52:53], v[36:37] neg_lo:[1,0] neg_hi:[1,0]
    v_pk_mul_f32 v[54:55], v[54:55], v[38:39] neg_lo:[1,0] neg_hi:[1,0]
    v_pk_mul_f32 v[56:57], v[56:57], v[40:41] neg_lo:[1,0] neg_hi:[1,0]
    v_pk_mul_f32 v[58:59], v[58:59], v[42:43] neg_lo:[1,0] neg_hi:[1,0]
    v_pk_mul_f32 v[60:61], v[60:61], v[44:45] neg_lo:[1,0] neg_hi:[1,0]
    v_pk_mul_f32 v[62:63], v[62:63], v[46:47] neg_lo:[1,0] neg_hi:[1,0]
L_pf7:
    v_cvt_pk_bf16_f32 v64, v16, v17
    v_cvt_pk_bf16_f32 v65, v18, v19
    v_cvt_pk_bf16_f32 v66, v20, v21
    v_cvt_pk_bf16_f32 v67, v22, v23
    v_cvt_pk_bf16_f32 v68, v24, v25
    v_cvt_pk_bf16_f32 v69, v26, v27
    v_cvt_pk_bf16_f32 v70, v28, v29
    v_cvt_pk_bf16_f32 v71, v30, v31
    v_mfma_f32_32x32x16_bf16 v[144:159], v[64:67], a[24:27], 0
    s_mov_b32 s63, L_pf7-L_pc+12288
    buffer_load_dword v6, v7, s[68:71], s63 offen
    v_exp_f32 v48, v48
    v_exp_f32 v49, v49
    v_accvgpr_write_b32 a32, v64
    v_mfma_f32_32x32x16_bf16 v[144:159], v[68:71], a[28:31], v[144:159]
    v_exp_f32 v50, v50
    v_exp_f32 v51, v51
    v_exp_f32 v52, v52
    v_mfma_f32_32x32x16_bf16 v[16:31], a[80:83], v[72:75], 0
    v_exp_f32 v53, v53
    v_exp_f32 v54, v54
    v_exp_f32 v55, v55
    v_mfma_f32_32x32x16_bf16 v[16:31], a[84:87], v[76:79], v[16:31]
    v_exp_f32 v56, v56
    v_exp_f32 v57, v57
    v_exp_f32 v58, v58
    v_exp_f32 v59, v59
    v_exp_f32 v60, v60
    v_exp_f32 v61, v61
    v_exp_f32 v62, v62
    v_exp_f32 v63, v63
    v_accvgpr_write_b32 a33, v65
    v_accvgpr_write_b32 a34, v66
    v_accvgpr_write_b32 a35, v67
    v_accvgpr_write_b32 a36, v68
    v_accvgpr_write_b32 a37, v69
    v_accvgpr_write_b32 a38, v70
    v_accvgpr_write_b32 a39, v71
    v_pk_add_f32 v[48:49], v[48:49], 1.0 op_sel_hi:[1,0]
    v_pk_add_f32 v[50:51], v[50:51], 1.0 op_sel_hi:[1,0]
    v_pk_add_f32 v[52:53], v[52:53], 1.0 op_sel_hi:[1,0]
    v_pk_add_f32 v[54:55], v[54:55], 1.0 op_sel_hi:[1,0]
    v_pk_add_f32 v[56:57], v[56:57], 1.0 op_sel_hi:[1,0]
    v_pk_add_f32 v[58:59], v[58:59], 1.0 op_sel_hi:[1,0]
    v_pk_add_f32 v[60:61], v[60:61], 1.0 op_sel_hi:[1,0]
    v_pk_add_f32 v[62:63], v[62:63], 1.0 op_sel_hi:[1,0]
    v_pk_fma_f32 v[96:97], v[144:145], v[144:145], v[96:97]
    v_pk_fma_f32 v[96:97], v[146:147], v[146:147], v[96:97]
    v_pk_fma_f32 v[96:97], v[148:149], v[148:149], v[96:97]
    v_pk_fma_f32 v[96:97], v[150:151], v[150:151], v[96:97]
    v_pk_fma_f32 v[96:97], v[152:153], v[152:153], v[96:97]
    v_pk_fma_f32 v[96:97], v[154:155], v[154:155], v[96:97]
    v_pk_fma_f32 v[96:97], v[156:157], v[156:157], v[96:97]
    v_pk_fma_f32 v[96:97], v[158:159], v[158:159], v[96:97]
    v_mfma_f32_32x32x16_bf16 v[16:31], a[88:91], v[80:83], v[16:31]
    v_rcp_f32 v48, v48
    v_rcp_f32 v49, v49
    v_rcp_f32 v50, v50
    v_mfma_f32_32x32x16_bf16 v[16:31], a[92:95], v[84:87], v[16:31]
    v_rcp_f32 v51, v51
    v_rcp_f32 v52, v52
    v_rcp_f32 v53, v53
    v_mfma_f32_32x32x16_bf16 v[16:31], a[96:99], v[88:91], v[16:31]
    v_rcp_f32 v54, v54
    v_rcp_f32 v55, v55
    v_rcp_f32 v56, v56
    v_mfma_f32_32x32x16_bf16 v[16:31], a[100:103], v[92:95], v[16:31]
    v_rcp_f32 v57, v57
    v_rcp_f32 v58, v58
    v_rcp_f32 v59, v59
    v_rcp_f32 v60, v60
    v_rcp_f32 v61, v61
    v_rcp_f32 v62, v62
    v_rcp_f32 v63, v63
    v_pk_mul_f32 v[32:33], v[32:33], v[48:49]
    v_pk_mul_f32 v[34:35], v[34:35], v[50:51]
    v_pk_mul_f32 v[36:37], v[36:37], v[52:53]
    v_pk_mul_f32 v[38:39], v[38:39], v[54:55]
    v_pk_mul_f32 v[40:41], v[40:41], v[56:57]
    v_pk_mul_f32 v[42:43], v[42:43], v[58:59]
    v_pk_mul_f32 v[44:45], v[44:45], v[60:61]
    v_pk_mul_f32 v[46:47], v[46:47], v[62:63]
    v_pk_fma_f32 v[48:49], v[16:17], v[16:17], s[52:53]
    v_pk_fma_f32 v[50:51], v[18:19], v[18:19], s[52:53]
    v_pk_fma_f32 v[52:53], v[20:21], v[20:21], s[52:53]
    v_pk_fma_f32 v[54:55], v[22:23], v[22:23], s[52:53]
    v_pk_fma_f32 v[56:57], v[24:25], v[24:25], s[52:53]
    v_pk_fma_f32 v[58:59], v[26:27], v[26:27], s[52:53]
    v_pk_fma_f32 v[60:61], v[28:29], v[28:29], s[52:53]
    v_pk_fma_f32 v[62:63], v[30:31], v[30:31], s[52:53]
    v_pk_mul_f32 v[48:49], v[48:49], v[16:17] neg_lo:[1,0] neg_hi:[1,0]
    v_pk_mul_f32 v[50:51], v[50:51], v[18:19] neg_lo:[1,0] neg_hi:[1,0]
    v_pk_mul_f32 v[52:53], v[52:53], v[20:21] neg_lo:[1,0] neg_hi:[1,0]
    v_pk_mul_f32 v[54:55], v[54:55], v[22:23] neg_lo:[1,0] neg_hi:[1,0]
    v_pk_mul_f32 v[56:57], v[56:57], v[24:25] neg_lo:[1,0] neg_hi:[1,0]
    v_pk_mul_f32 v[58:59], v[58:59], v[26:27] neg_lo:[1,0] neg_hi:[1,0]
    v_pk_mul_f32 v[60:61], v[60:61], v[28:29] neg_lo:[1,0] neg_hi:[1,0]
    v_pk_mul_f32 v[62:63], v[62:63], v[30:31] neg_lo:[1,0] neg_hi:[1,0]
    v_cvt_pk_bf16_f32 v64, v32, v33
    v_cvt_pk_bf16_f32 v65, v34, v35
    v_cvt_pk_bf16_f32 v66, v36, v37
    v_cvt_pk_bf16_f32 v67, v38, v39
    v_cvt_pk_bf16_f32 v68, v40, v41
    v_cvt_pk_bf16_f32 v69, v42, v43
    v_cvt_pk_bf16_f32 v70, v44, v45
    v_cvt_pk_bf16_f32 v71, v46, v47
    v_mfma_f32_32x32x16_bf16 v[144:159], v[64:67], a[24:27], 0
    v_exp_f32 v48, v48
    v_exp_f32 v49, v49
    v_exp_f32 v50, v50
    v_mfma_f32_32x32x16_bf16 v[144:159], v[68:71], a[28:31], v[144:159]
    v_exp_f32 v51, v51
    v_exp_f32 v52, v52
    v_exp_f32 v53, v53
    v_mfma_f32_32x32x16_bf16 v[32:47], a[104:107], v[72:75], 0
    v_exp_f32 v54, v54
    v_exp_f32 v55, v55
    v_exp_f32 v56, v56
    v_mfma_f32_32x32x16_bf16 v[32:47], a[108:111], v[76:79], v[32:47]
    v_exp_f32 v57, v57
    v_exp_f32 v58, v58
    v_exp_f32 v59, v59
    v_exp_f32 v60, v60
    v_exp_f32 v61, v61
    v_exp_f32 v62, v62
    v_exp_f32 v63, v63
    v_accvgpr_write_b32 a40, v64
    v_accvgpr_write_b32 a41, v65
    v_accvgpr_write_b32 a42, v66
    v_accvgpr_write_b32 a43, v67
    v_accvgpr_write_b32 a44, v68
    v_accvgpr_write_b32 a45, v69
    v_accvgpr_write_b32 a46, v70
    v_accvgpr_write_b32 a47, v71
    v_pk_add_f32 v[48:49], v[48:49], 1.0 op_sel_hi:[1,0]
    v_pk_add_f32 v[50:51], v[50:51], 1.0 op_sel_hi:[1,0]
    v_pk_add_f32 v[52:53], v[52:53], 1.0 op_sel_hi:[1,0]
    v_pk_add_f32 v[54:55], v[54:55], 1.0 op_sel_hi:[1,0]
    v_pk_add_f32 v[56:57], v[56:57], 1.0 op_sel_hi:[1,0]
    v_pk_add_f32 v[58:59], v[58:59], 1.0 op_sel_hi:[1,0]
    v_pk_add_f32 v[60:61], v[60:61], 1.0 op_sel_hi:[1,0]
    v_pk_add_f32 v[62:63], v[62:63], 1.0 op_sel_hi:[1,0]
    v_pk_fma_f32 v[98:99], v[144:145], v[144:145], v[98:99]
    v_pk_fma_f32 v[98:99], v[146:147], v[146:147], v[98:99]
    v_pk_fma_f32 v[98:99], v[148:149], v[148:149], v[98:99]
    v_pk_fma_f32 v[98:99], v[150:151], v[150:151], v[98:99]
    v_pk_fma_f32 v[98:99], v[152:153], v[152:153], v[98:99]
    v_pk_fma_f32 v[98:99], v[154:155], v[154:155], v[98:99]
    v_pk_fma_f32 v[98:99], v[156:157], v[156:157], v[98:99]
    v_pk_fma_f32 v[98:99], v[158:159], v[158:159], v[98:99]
    v_mfma_f32_32x32x16_bf16 v[32:47], a[112:115], v[80:83], v[32:47]
    v_rcp_f32 v48, v48
    v_rcp_f32 v49, v49
    v_rcp_f32 v50, v50
    v_mfma_f32_32x32x16_bf16 v[32:47], a[116:119], v[84:87], v[32:47]
    v_rcp_f32 v51, v51
    v_rcp_f32 v52, v52
    v_rcp_f32 v53, v53
    v_mfma_f32_32x32x16_bf16 v[32:47], a[120:123], v[88:91], v[32:47]
    v_rcp_f32 v54, v54
    v_rcp_f32 v55, v55
    v_rcp_f32 v56, v56
    v_mfma_f32_32x32x16_bf16 v[32:47], a[124:127], v[92:95], v[32:47]
    v_rcp_f32 v57, v57
    v_rcp_f32 v58, v58
    v_rcp_f32 v59, v59
    v_rcp_f32 v60, v60
    v_rcp_f32 v61, v61
    v_rcp_f32 v62, v62
    v_rcp_f32 v63, v63
    v_pk_mul_f32 v[16:17], v[16:17], v[48:49]
    v_pk_mul_f32 v[18:19], v[18:19], v[50:51]
    v_pk_mul_f32 v[20:21], v[20:21], v[52:53]
    v_pk_mul_f32 v[22:23], v[22:23], v[54:55]
    v_pk_mul_f32 v[24:25], v[24:25], v[56:57]
    v_pk_mul_f32 v[26:27], v[26:27], v[58:59]
    v_pk_mul_f32 v[28:29], v[28:29], v[60:61]
    v_pk_mul_f32 v[30:31], v[30:31], v[62:63]
    v_pk_fma_f32 v[48:49], v[32:33], v[32:33], s[52:53]
    v_pk_fma_f32 v[50:51], v[34:35], v[34:35], s[52:53]
    v_pk_fma_f32 v[52:53], v[36:37], v[36:37], s[52:53]
    v_pk_fma_f32 v[54:55], v[38:39], v[38:39], s[52:53]
    v_pk_fma_f32 v[56:57], v[40:41], v[40:41], s[52:53]
    v_pk_fma_f32 v[58:59], v[42:43], v[42:43], s[52:53]
    v_pk_fma_f32 v[60:61], v[44:45], v[44:45], s[52:53]
    v_pk_fma_f32 v[62:63], v[46:47], v[46:47], s[52:53]
    v_pk_mul_f32 v[48:49], v[48:49], v[32:33] neg_lo:[1,0] neg_hi:[1,0]
    v_pk_mul_f32 v[50:51], v[50:51], v[34:35] neg_lo:[1,0] neg_hi:[1,0]
    v_pk_mul_f32 v[52:53], v[52:53], v[36:37] neg_lo:[1,0] neg_hi:[1,0]
    v_pk_mul_f32 v[54:55], v[54:55], v[38:39] neg_lo:[1,0] neg_hi:[1,0]
    v_pk_mul_f32 v[56:57], v[56:57], v[40:41] neg_lo:[1,0] neg_hi:[1,0]
    v_pk_mul_f32 v[58:59], v[58:59], v[42:43] neg_lo:[1,0] neg_hi:[1,0]
    v_pk_mul_f32 v[60:61], v[60:61], v[44:45] neg_lo:[1,0] neg_hi:[1,0]
    v_pk_mul_f32 v[62:63], v[62:63], v[46:47] neg_lo:[1,0] neg_hi:[1,0]
    v_cvt_pk_bf16_f32 v64, v16, v17
    v_cvt_pk_bf16_f32 v65, v18, v19
    v_cvt_pk_bf16_f32 v66, v20, v21
    v_cvt_pk_bf16_f32 v67, v22, v23
    v_cvt_pk_bf16_f32 v68, v24, v25
    v_cvt_pk_bf16_f32 v69, v26, v27
    v_cvt_pk_bf16_f32 v70, v28, v29
    v_cvt_pk_bf16_f32 v71, v30, v31
    v_mfma_f32_32x32x16_bf16 v[144:159], v[64:67], a[24:27], 0
    v_exp_f32 v48, v48
    v_exp_f32 v49, v49
    v_exp_f32 v50, v50
    v_mfma_f32_32x32x16_bf16 v[144:159], v[68:71], a[28:31], v[144:159]
    v_exp_f32 v51, v51
    v_exp_f32 v52, v52
    v_exp_f32 v53, v53
    v_mfma_f32_32x32x16_bf16 v[16:31], a[128:131], v[72:75], 0
    v_exp_f32 v54, v54
    v_exp_f32 v55, v55
    v_exp_f32 v56, v56
    v_mfma_f32_32x32x16_bf16 v[16:31], a[132:135], v[76:79], v[16:31]
    v_exp_f32 v57, v57
    v_exp_f32 v58, v58
    v_exp_f32 v59, v59
    v_exp_f32 v60, v60
    v_exp_f32 v61, v61
    v_exp_f32 v62, v62
    v_exp_f32 v63, v63
    v_accvgpr_write_b32 a48, v64
    v_accvgpr_write_b32 a49, v65
    v_accvgpr_write_b32 a50, v66
    v_accvgpr_write_b32 a51, v67
    v_accvgpr_write_b32 a52, v68
    v_accvgpr_write_b32 a53, v69
    v_accvgpr_write_b32 a54, v70
    v_accvgpr_write_b32 a55, v71
    v_pk_add_f32 v[48:49], v[48:49], 1.0 op_sel_hi:[1,0]
    v_pk_add_f32 v[50:51], v[50:51], 1.0 op_sel_hi:[1,0]
    v_pk_add_f32 v[52:53], v[52:53], 1.0 op_sel_hi:[1,0]
    v_pk_add_f32 v[54:55], v[54:55], 1.0 op_sel_hi:[1,0]
    v_pk_add_f32 v[56:57], v[56:57], 1.0 op_sel_hi:[1,0]
    v_pk_add_f32 v[58:59], v[58:59], 1.0 op_sel_hi:[1,0]
    v_pk_add_f32 v[60:61], v[60:61], 1.0 op_sel_hi:[1,0]
    v_pk_add_f32 v[62:63], v[62:63], 1.0 op_sel_hi:[1,0]
    v_pk_fma_f32 v[100:101], v[144:145], v[144:145], v[100:101]
    v_pk_fma_f32 v[100:101], v[146:147], v[146:147], v[100:101]
    v_pk_fma_f32 v[100:101], v[148:149], v[148:149], v[100:101]
    v_pk_fma_f32 v[100:101], v[150:151], v[150:151], v[100:101]
    v_pk_fma_f32 v[100:101], v[152:153], v[152:153], v[100:101]
    v_pk_fma_f32 v[100:101], v[154:155], v[154:155], v[100:101]
    v_pk_fma_f32 v[100:101], v[156:157], v[156:157], v[100:101]
    v_pk_fma_f32 v[100:101], v[158:159], v[158:159], v[100:101]
    v_mfma_f32_32x32x16_bf16 v[16:31], a[136:139], v[80:83], v[16:31]
    v_rcp_f32 v48, v48
    v_rcp_f32 v49, v49
    v_rcp_f32 v50, v50
    v_mfma_f32_32x32x16_bf16 v[16:31], a[140:143], v[84:87], v[16:31]
    v_rcp_f32 v51, v51
    v_rcp_f32 v52, v52
    v_rcp_f32 v53, v53
    v_mfma_f32_32x32x16_bf16 v[16:31], a[144:147], v[88:91], v[16:31]
    v_rcp_f32 v54, v54
    v_rcp_f32 v55, v55
    v_rcp_f32 v56, v56
    v_mfma_f32_32x32x16_bf16 v[16:31], a[148:151], v[92:95], v[16:31]
    v_rcp_f32 v57, v57
    v_rcp_f32 v58, v58
    v_rcp_f32 v59, v59
    v_rcp_f32 v60, v60
    v_rcp_f32 v61, v61
    v_rcp_f32 v62, v62
    v_rcp_f32 v63, v63
    v_pk_mul_f32 v[32:33], v[32:33], v[48:49]
    v_pk_mul_f32 v[34:35], v[34:35], v[50:51]
    v_pk_mul_f32 v[36:37], v[36:37], v[52:53]
    v_pk_mul_f32 v[38:39], v[38:39], v[54:55]
    v_pk_mul_f32 v[40:41], v[40:41], v[56:57]
    v_pk_mul_f32 v[42:43], v[42:43], v[58:59]
    v_pk_mul_f32 v[44:45], v[44:45], v[60:61]
    v_pk_mul_f32 v[46:47], v[46:47], v[62:63]
    v_pk_fma_f32 v[48:49], v[16:17], v[16:17], s[52:53]
    v_pk_fma_f32 v[50:51], v[18:19], v[18:19], s[52:53]
    v_pk_fma_f32 v[52:53], v[20:21], v[20:21], s[52:53]
    v_pk_fma_f32 v[54:55], v[22:23], v[22:23], s[52:53]
    v_pk_fma_f32 v[56:57], v[24:25], v[24:25], s[52:53]
    v_pk_fma_f32 v[58:59], v[26:27], v[26:27], s[52:53]
    v_pk_fma_f32 v[60:61], v[28:29], v[28:29], s[52:53]
    v_pk_fma_f32 v[62:63], v[30:31], v[30:31], s[52:53]
    v_pk_mul_f32 v[48:49], v[48:49], v[16:17] neg_lo:[1,0] neg_hi:[1,0]
    v_pk_mul_f32 v[50:51], v[50:51], v[18:19] neg_lo:[1,0] neg_hi:[1,0]
    v_pk_mul_f32 v[52:53], v[52:53], v[20:21] neg_lo:[1,0] neg_hi:[1,0]
    v_pk_mul_f32 v[54:55], v[54:55], v[22:23] neg_lo:[1,0] neg_hi:[1,0]
    v_pk_mul_f32 v[56:57], v[56:57], v[24:25] neg_lo:[1,0] neg_hi:[1,0]
    v_pk_mul_f32 v[58:59], v[58:59], v[26:27] neg_lo:[1,0] neg_hi:[1,0]
    v_pk_mul_f32 v[60:61], v[60:61], v[28:29] neg_lo:[1,0] neg_hi:[1,0]
    v_pk_mul_f32 v[62:63], v[62:63], v[30:31] neg_lo:[1,0] neg_hi:[1,0]
    v_cvt_pk_bf16_f32 v64, v32, v33
    v_cvt_pk_bf16_f32 v65, v34, v35
    v_cvt_pk_bf16_f32 v66, v36, v37
    v_cvt_pk_bf16_f32 v67, v38, v39
    v_cvt_pk_bf16_f32 v68, v40, v41
    v_cvt_pk_bf16_f32 v69, v42, v43
    v_cvt_pk_bf16_f32 v70, v44, v45
    v_cvt_pk_bf16_f32 v71, v46, v47
    v_mfma_f32_32x32x16_bf16 v[144:159], v[64:67], a[24:27], 0
    v_exp_f32 v48, v48
    v_exp_f32 v49, v49
    v_exp_f32 v50, v50
    v_mfma_f32_32x32x16_bf16 v[144:159], v[68:71], a[28:31], v[144:159]
    v_exp_f32 v51, v51
    v_exp_f32 v52, v52
    v_exp_f32 v53, v53
    v_mfma_f32_32x32x16_bf16 v[32:47], a[152:155], v[72:75], 0
    v_exp_f32 v54, v54
    v_exp_f32 v55, v55
    v_exp_f32 v56, v56
    v_mfma_f32_32x32x16_bf16 v[32:47], a[156:159], v[76:79], v[32:47]
    v_exp_f32 v57, v57
    v_exp_f32 v58, v58
    v_exp_f32 v59, v59
    v_exp_f32 v60, v60
    v_exp_f32 v61, v61
    v_exp_f32 v62, v62
    v_exp_f32 v63, v63
    v_accvgpr_write_b32 a56, v64
    v_accvgpr_write_b32 a57, v65
    v_accvgpr_write_b32 a58, v66
    v_accvgpr_write_b32 a59, v67
    v_accvgpr_write_b32 a60, v68
    v_accvgpr_write_b32 a61, v69
    v_accvgpr_write_b32 a62, v70
    v_accvgpr_write_b32 a63, v71
    v_pk_add_f32 v[48:49], v[48:49], 1.0 op_sel_hi:[1,0]
    v_pk_add_f32 v[50:51], v[50:51], 1.0 op_sel_hi:[1,0]
    v_pk_add_f32 v[52:53], v[52:53], 1.0 op_sel_hi:[1,0]
    v_pk_add_f32 v[54:55], v[54:55], 1.0 op_sel_hi:[1,0]
    v_pk_add_f32 v[56:57], v[56:57], 1.0 op_sel_hi:[1,0]
    v_pk_add_f32 v[58:59], v[58:59], 1.0 op_sel_hi:[1,0]
    v_pk_add_f32 v[60:61], v[60:61], 1.0 op_sel_hi:[1,0]
    v_pk_add_f32 v[62:63], v[62:63], 1.0 op_sel_hi:[1,0]
    v_pk_fma_f32 v[102:103], v[144:145], v[144:145], v[102:103]
    v_pk_fma_f32 v[102:103], v[146:147], v[146:147], v[102:103]
    v_pk_fma_f32 v[102:103], v[148:149], v[148:149], v[102:103]
    v_pk_fma_f32 v[102:103], v[150:151], v[150:151], v[102:103]
    v_pk_fma_f32 v[102:103], v[152:153], v[152:153], v[102:103]
    v_pk_fma_f32 v[102:103], v[154:155], v[154:155], v[102:103]
    v_pk_fma_f32 v[102:103], v[156:157], v[156:157], v[102:103]
    v_pk_fma_f32 v[102:103], v[158:159], v[158:159], v[102:103]
    v_mfma_f32_32x32x16_bf16 v[32:47], a[160:163], v[80:83], v[32:47]
    v_rcp_f32 v48, v48
    v_rcp_f32 v49, v49
    v_rcp_f32 v50, v50
    v_mfma_f32_32x32x16_bf16 v[32:47], a[164:167], v[84:87], v[32:47]
    v_rcp_f32 v51, v51
    v_rcp_f32 v52, v52
    v_rcp_f32 v53, v53
    v_mfma_f32_32x32x16_bf16 v[32:47], a[168:171], v[88:91], v[32:47]
    v_rcp_f32 v54, v54
    v_rcp_f32 v55, v55
    v_rcp_f32 v56, v56
    v_mfma_f32_32x32x16_bf16 v[32:47], a[172:175], v[92:95], v[32:47]
    v_rcp_f32 v57, v57
    v_rcp_f32 v58, v58
    v_rcp_f32 v59, v59
    v_rcp_f32 v60, v60
    v_rcp_f32 v61, v61
    v_rcp_f32 v62, v62
    v_rcp_f32 v63, v63
    v_pk_mul_f32 v[16:17], v[16:17], v[48:49]
    v_pk_mul_f32 v[18:19], v[18:19], v[50:51]
    v_pk_mul_f32 v[20:21], v[20:21], v[52:53]
    v_pk_mul_f32 v[22:23], v[22:23], v[54:55]
    v_pk_mul_f32 v[24:25], v[24:25], v[56:57]
    v_pk_mul_f32 v[26:27], v[26:27], v[58:59]
    v_pk_mul_f32 v[28:29], v[28:29], v[60:61]
    v_pk_mul_f32 v[30:31], v[30:31], v[62:63]
    v_pk_fma_f32 v[48:49], v[32:33], v[32:33], s[52:53]
    v_pk_fma_f32 v[50:51], v[34:35], v[34:35], s[52:53]
    v_pk_fma_f32 v[52:53], v[36:37], v[36:37], s[52:53]
    v_pk_fma_f32 v[54:55], v[38:39], v[38:39], s[52:53]
    v_pk_fma_f32 v[56:57], v[40:41], v[40:41], s[52:53]
    v_pk_fma_f32 v[58:59], v[42:43], v[42:43], s[52:53]
    v_pk_fma_f32 v[60:61], v[44:45], v[44:45], s[52:53]
    v_pk_fma_f32 v[62:63], v[46:47], v[46:47], s[52:53]
    v_pk_mul_f32 v[48:49], v[48:49], v[32:33] neg_lo:[1,0] neg_hi:[1,0]
    v_pk_mul_f32 v[50:51], v[50:51], v[34:35] neg_lo:[1,0] neg_hi:[1,0]
    v_pk_mul_f32 v[52:53], v[52:53], v[36:37] neg_lo:[1,0] neg_hi:[1,0]
    v_pk_mul_f32 v[54:55], v[54:55], v[38:39] neg_lo:[1,0] neg_hi:[1,0]
    v_pk_mul_f32 v[56:57], v[56:57], v[40:41] neg_lo:[1,0] neg_hi:[1,0]
    v_pk_mul_f32 v[58:59], v[58:59], v[42:43] neg_lo:[1,0] neg_hi:[1,0]
    v_pk_mul_f32 v[60:61], v[60:61], v[44:45] neg_lo:[1,0] neg_hi:[1,0]
    v_pk_mul_f32 v[62:63], v[62:63], v[46:47] neg_lo:[1,0] neg_hi:[1,0]
    v_cvt_pk_bf16_f32 v64, v16, v17
    v_cvt_pk_bf16_f32 v65, v18, v19
    v_cvt_pk_bf16_f32 v66, v20, v21
    v_cvt_pk_bf16_f32 v67, v22, v23
    v_cvt_pk_bf16_f32 v68, v24, v25
    v_cvt_pk_bf16_f32 v69, v26, v27
    v_cvt_pk_bf16_f32 v70, v28, v29
    v_cvt_pk_bf16_f32 v71, v30, v31
    v_mfma_f32_32x32x16_bf16 v[144:159], v[64:67], a[24:27], 0
    v_exp_f32 v48, v48
    v_exp_f32 v49, v49
    v_exp_f32 v50, v50
    v_mfma_f32_32x32x16_bf16 v[144:159], v[68:71], a[28:31], v[144:159]
    v_exp_f32 v51, v51
    v_exp_f32 v52, v52
    v_exp_f32 v53, v53
    v_mfma_f32_32x32x16_bf16 v[16:31], a[176:179], v[72:75], 0
    v_exp_f32 v54, v54
    v_exp_f32 v55, v55
    v_exp_f32 v56, v56
    v_mfma_f32_32x32x16_bf16 v[16:31], a[180:183], v[76:79], v[16:31]
    v_exp_f32 v57, v57
    v_exp_f32 v58, v58
    v_exp_f32 v59, v59
    v_exp_f32 v60, v60
    v_exp_f32 v61, v61
    v_exp_f32 v62, v62
    v_exp_f32 v63, v63
    v_accvgpr_write_b32 a64, v64
    v_accvgpr_write_b32 a65, v65
    v_accvgpr_write_b32 a66, v66
    v_accvgpr_write_b32 a67, v67
    v_accvgpr_write_b32 a68, v68
    v_accvgpr_write_b32 a69, v69
    v_accvgpr_write_b32 a70, v70
    v_accvgpr_write_b32 a71, v71
    v_pk_add_f32 v[48:49], v[48:49], 1.0 op_sel_hi:[1,0]
    v_pk_add_f32 v[50:51], v[50:51], 1.0 op_sel_hi:[1,0]
    v_pk_add_f32 v[52:53], v[52:53], 1.0 op_sel_hi:[1,0]
    v_pk_add_f32 v[54:55], v[54:55], 1.0 op_sel_hi:[1,0]
    v_pk_add_f32 v[56:57], v[56:57], 1.0 op_sel_hi:[1,0]
    v_pk_add_f32 v[58:59], v[58:59], 1.0 op_sel_hi:[1,0]
    v_pk_add_f32 v[60:61], v[60:61], 1.0 op_sel_hi:[1,0]
    v_pk_add_f32 v[62:63], v[62:63], 1.0 op_sel_hi:[1,0]
    v_pk_fma_f32 v[104:105], v[144:145], v[144:145], v[104:105]
    v_pk_fma_f32 v[104:105], v[146:147], v[146:147], v[104:105]
    v_pk_fma_f32 v[104:105], v[148:149], v[148:149], v[104:105]
    v_pk_fma_f32 v[104:105], v[150:151], v[150:151], v[104:105]
    v_pk_fma_f32 v[104:105], v[152:153], v[152:153], v[104:105]
    v_pk_fma_f32 v[104:105], v[154:155], v[154:155], v[104:105]
    v_pk_fma_f32 v[104:105], v[156:157], v[156:157], v[104:105]
    v_pk_fma_f32 v[104:105], v[158:159], v[158:159], v[104:105]
    v_mfma_f32_32x32x16_bf16 v[16:31], a[184:187], v[80:83], v[16:31]
    v_rcp_f32 v48, v48
    v_rcp_f32 v49, v49
    v_rcp_f32 v50, v50
    v_mfma_f32_32x32x16_bf16 v[16:31], a[188:191], v[84:87], v[16:31]
    v_rcp_f32 v51, v51
    v_rcp_f32 v52, v52
    v_rcp_f32 v53, v53
    v_mfma_f32_32x32x16_bf16 v[16:31], a[192:195], v[88:91], v[16:31]
    v_rcp_f32 v54, v54
    v_rcp_f32 v55, v55
    v_rcp_f32 v56, v56
    v_mfma_f32_32x32x16_bf16 v[16:31], a[196:199], v[92:95], v[16:31]
    v_rcp_f32 v57, v57
    v_rcp_f32 v58, v58
    v_rcp_f32 v59, v59
    v_rcp_f32 v60, v60
    v_rcp_f32 v61, v61
    v_rcp_f32 v62, v62
    v_rcp_f32 v63, v63
    v_pk_mul_f32 v[32:33], v[32:33], v[48:49]
    v_pk_mul_f32 v[34:35], v[34:35], v[50:51]
    v_pk_mul_f32 v[36:37], v[36:37], v[52:53]
    v_pk_mul_f32 v[38:39], v[38:39], v[54:55]
    v_pk_mul_f32 v[40:41], v[40:41], v[56:57]
    v_pk_mul_f32 v[42:43], v[42:43], v[58:59]
    v_pk_mul_f32 v[44:45], v[44:45], v[60:61]
    v_pk_mul_f32 v[46:47], v[46:47], v[62:63]
    v_pk_fma_f32 v[48:49], v[16:17], v[16:17], s[52:53]
    v_pk_fma_f32 v[50:51], v[18:19], v[18:19], s[52:53]
    v_pk_fma_f32 v[52:53], v[20:21], v[20:21], s[52:53]
    v_pk_fma_f32 v[54:55], v[22:23], v[22:23], s[52:53]
    v_pk_fma_f32 v[56:57], v[24:25], v[24:25], s[52:53]
    v_pk_fma_f32 v[58:59], v[26:27], v[26:27], s[52:53]
    v_pk_fma_f32 v[60:61], v[28:29], v[28:29], s[52:53]
    v_pk_fma_f32 v[62:63], v[30:31], v[30:31], s[52:53]
    v_pk_mul_f32 v[48:49], v[48:49], v[16:17] neg_lo:[1,0] neg_hi:[1,0]
    v_pk_mul_f32 v[50:51], v[50:51], v[18:19] neg_lo:[1,0] neg_hi:[1,0]
    v_pk_mul_f32 v[52:53], v[52:53], v[20:21] neg_lo:[1,0] neg_hi:[1,0]
    v_pk_mul_f32 v[54:55], v[54:55], v[22:23] neg_lo:[1,0] neg_hi:[1,0]
    v_pk_mul_f32 v[56:57], v[56:57], v[24:25] neg_lo:[1,0] neg_hi:[1,0]
    v_pk_mul_f32 v[58:59], v[58:59], v[26:27] neg_lo:[1,0] neg_hi:[1,0]
    v_pk_mul_f32 v[60:61], v[60:61], v[28:29] neg_lo:[1,0] neg_hi:[1,0]
    v_pk_mul_f32 v[62:63], v[62:63], v[30:31] neg_lo:[1,0] neg_hi:[1,0]
    v_cvt_pk_bf16_f32 v64, v32, v33
    v_cvt_pk_bf16_f32 v65, v34, v35
    v_cvt_pk_bf16_f32 v66, v36, v37
    v_cvt_pk_bf16_f32 v67, v38, v39
    v_cvt_pk_bf16_f32 v68, v40, v41
    v_cvt_pk_bf16_f32 v69, v42, v43
    v_cvt_pk_bf16_f32 v70, v44, v45
    v_cvt_pk_bf16_f32 v71, v46, v47
    v_mfma_f32_32x32x16_bf16 v[144:159], v[64:67], a[24:27], 0
    v_exp_f32 v48, v48
    v_exp_f32 v49, v49
    v_exp_f32 v50, v50
    v_mfma_f32_32x32x16_bf16 v[144:159], v[68:71], a[28:31], v[144:159]
    v_exp_f32 v51, v51
    v_exp_f32 v52, v52
    v_exp_f32 v53, v53
    v_mfma_f32_32x32x16_bf16 v[32:47], a[200:203], v[72:75], 0
    v_exp_f32 v54, v54
    v_exp_f32 v55, v55
    v_exp_f32 v56, v56
    v_mfma_f32_32x32x16_bf16 v[32:47], a[204:207], v[76:79], v[32:47]
    v_exp_f32 v57, v57
    v_exp_f32 v58, v58
    v_exp_f32 v59, v59
    v_exp_f32 v60, v60
    v_exp_f32 v61, v61
    v_exp_f32 v62, v62
    v_exp_f32 v63, v63
    v_accvgpr_write_b32 a72, v64
    v_accvgpr_write_b32 a73, v65
    v_accvgpr_write_b32 a74, v66
    v_accvgpr_write_b32 a75, v67
    v_accvgpr_write_b32 a76, v68
    v_accvgpr_write_b32 a77, v69
    v_accvgpr_write_b32 a78, v70
    v_accvgpr_write_b32 a79, v71
    v_pk_add_f32 v[48:49], v[48:49], 1.0 op_sel_hi:[1,0]
    v_pk_add_f32 v[50:51], v[50:51], 1.0 op_sel_hi:[1,0]
    v_pk_add_f32 v[52:53], v[52:53], 1.0 op_sel_hi:[1,0]
    v_pk_add_f32 v[54:55], v[54:55], 1.0 op_sel_hi:[1,0]
    v_pk_add_f32 v[56:57], v[56:57], 1.0 op_sel_hi:[1,0]
    v_pk_add_f32 v[58:59], v[58:59], 1.0 op_sel_hi:[1,0]
    v_pk_add_f32 v[60:61], v[60:61], 1.0 op_sel_hi:[1,0]
    v_pk_add_f32 v[62:63], v[62:63], 1.0 op_sel_hi:[1,0]
    v_pk_fma_f32 v[106:107], v[144:145], v[144:145], v[106:107]
    v_pk_fma_f32 v[106:107], v[146:147], v[146:147], v[106:107]
    v_pk_fma_f32 v[106:107], v[148:149], v[148:149], v[106:107]
    v_pk_fma_f32 v[106:107], v[150:151], v[150:151], v[106:107]
    v_pk_fma_f32 v[106:107], v[152:153], v[152:153], v[106:107]
    v_pk_fma_f32 v[106:107], v[154:155], v[154:155], v[106:107]
    v_pk_fma_f32 v[106:107], v[156:157], v[156:157], v[106:107]
    v_pk_fma_f32 v[106:107], v[158:159], v[158:159], v[106:107]
    v_mfma_f32_32x32x16_bf16 v[32:47], a[208:211], v[80:83], v[32:47]
    v_rcp_f32 v48, v48
    v_rcp_f32 v49, v49
    v_rcp_f32 v50, v50
    v_mfma_f32_32x32x16_bf16 v[32:47], a[212:215], v[84:87], v[32:47]
    v_rcp_f32 v51, v51
    v_rcp_f32 v52, v52
    v_rcp_f32 v53, v53
    v_mfma_f32_32x32x16_bf16 v[32:47], a[216:219], v[88:91], v[32:47]
    v_rcp_f32 v54, v54
    v_rcp_f32 v55, v55
    v_rcp_f32 v56, v56
    v_mfma_f32_32x32x16_bf16 v[32:47], a[220:223], v[92:95], v[32:47]
    v_rcp_f32 v57, v57
    v_rcp_f32 v58, v58
    v_rcp_f32 v59, v59
    v_rcp_f32 v60, v60
    v_rcp_f32 v61, v61
    v_rcp_f32 v62, v62
    v_rcp_f32 v63, v63
    v_pk_mul_f32 v[16:17], v[16:17], v[48:49]
    v_pk_mul_f32 v[18:19], v[18:19], v[50:51]
    v_pk_mul_f32 v[20:21], v[20:21], v[52:53]
    v_pk_mul_f32 v[22:23], v[22:23], v[54:55]
    v_pk_mul_f32 v[24:25], v[24:25], v[56:57]
    v_pk_mul_f32 v[26:27], v[26:27], v[58:59]
    v_pk_mul_f32 v[28:29], v[28:29], v[60:61]
    v_pk_mul_f32 v[30:31], v[30:31], v[62:63]
    v_pk_fma_f32 v[48:49], v[32:33], v[32:33], s[52:53]
    v_pk_fma_f32 v[50:51], v[34:35], v[34:35], s[52:53]
    v_pk_fma_f32 v[52:53], v[36:37], v[36:37], s[52:53]
    v_pk_fma_f32 v[54:55], v[38:39], v[38:39], s[52:53]
    v_pk_fma_f32 v[56:57], v[40:41], v[40:41], s[52:53]
    v_pk_fma_f32 v[58:59], v[42:43], v[42:43], s[52:53]
    v_pk_fma_f32 v[60:61], v[44:45], v[44:45], s[52:53]
    v_pk_fma_f32 v[62:63], v[46:47], v[46:47], s[52:53]
    v_pk_mul_f32 v[48:49], v[48:49], v[32:33] neg_lo:[1,0] neg_hi:[1,0]
    v_pk_mul_f32 v[50:51], v[50:51], v[34:35] neg_lo:[1,0] neg_hi:[1,0]
    v_pk_mul_f32 v[52:53], v[52:53], v[36:37] neg_lo:[1,0] neg_hi:[1,0]
    v_pk_mul_f32 v[54:55], v[54:55], v[38:39] neg_lo:[1,0] neg_hi:[1,0]
    v_pk_mul_f32 v[56:57], v[56:57], v[40:41] neg_lo:[1,0] neg_hi:[1,0]
    v_pk_mul_f32 v[58:59], v[58:59], v[42:43] neg_lo:[1,0] neg_hi:[1,0]
    v_pk_mul_f32 v[60:61], v[60:61], v[44:45] neg_lo:[1,0] neg_hi:[1,0]
    v_pk_mul_f32 v[62:63], v[62:63], v[46:47] neg_lo:[1,0] neg_hi:[1,0]
    v_cvt_pk_bf16_f32 v64, v16, v17
    v_cvt_pk_bf16_f32 v65, v18, v19
    v_cvt_pk_bf16_f32 v66, v20, v21
    v_cvt_pk_bf16_f32 v67, v22, v23
    v_cvt_pk_bf16_f32 v68, v24, v25
    v_cvt_pk_bf16_f32 v69, v26, v27
    v_cvt_pk_bf16_f32 v70, v28, v29
    v_cvt_pk_bf16_f32 v71, v30, v31
    v_mfma_f32_32x32x16_bf16 v[144:159], v[64:67], a[24:27], 0
    v_exp_f32 v48, v48
    v_exp_f32 v49, v49
    v_exp_f32 v50, v50
    v_mfma_f32_32x32x16_bf16 v[144:159], v[68:71], a[28:31], v[144:159]
    v_exp_f32 v51, v51
    v_exp_f32 v52, v52
    v_exp_f32 v53, v53
    v_mfma_f32_32x32x16_bf16 v[16:31], v[160:163], v[72:75], 0
    v_exp_f32 v54, v54
    v_exp_f32 v55, v55
    v_exp_f32 v56, v56
    v_mfma_f32_32x32x16_bf16 v[16:31], v[164:167], v[76:79], v[16:31]
    v_exp_f32 v57, v57
    v_exp_f32 v58, v58
    v_exp_f32 v59, v59
    v_exp_f32 v60, v60
    v_exp_f32 v61, v61
    v_exp_f32 v62, v62
    v_exp_f32 v63, v63
    v_accvgpr_write_b32 a80, v64
    v_accvgpr_write_b32 a81, v65
    v_accvgpr_write_b32 a82, v66
    v_accvgpr_write_b32 a83, v67
    v_accvgpr_write_b32 a84, v68
    v_accvgpr_write_b32 a85, v69
    v_accvgpr_write_b32 a86, v70
    v_accvgpr_write_b32 a87, v71
    v_pk_add_f32 v[48:49], v[48:49], 1.0 op_sel_hi:[1,0]
    v_pk_add_f32 v[50:51], v[50:51], 1.0 op_sel_hi:[1,0]
    v_pk_add_f32 v[52:53], v[52:53], 1.0 op_sel_hi:[1,0]
    v_pk_add_f32 v[54:55], v[54:55], 1.0 op_sel_hi:[1,0]
    v_pk_add_f32 v[56:57], v[56:57], 1.0 op_sel_hi:[1,0]
    v_pk_add_f32 v[58:59], v[58:59], 1.0 op_sel_hi:[1,0]
    v_pk_add_f32 v[60:61], v[60:61], 1.0 op_sel_hi:[1,0]
    v_pk_add_f32 v[62:63], v[62:63], 1.0 op_sel_hi:[1,0]
    v_pk_fma_f32 v[108:109], v[144:145], v[144:145], v[108:109]
    v_pk_fma_f32 v[108:109], v[146:147], v[146:147], v[108:109]
    v_pk_fma_f32 v[108:109], v[148:149], v[148:149], v[108:109]
    v_pk_fma_f32 v[108:109], v[150:151], v[150:151], v[108:109]
    v_pk_fma_f32 v[108:109], v[152:153], v[152:153], v[108:109]
    v_pk_fma_f32 v[108:109], v[154:155], v[154:155], v[108:109]
    v_pk_fma_f32 v[108:109], v[156:157], v[156:157], v[108:109]
    v_pk_fma_f32 v[108:109], v[158:159], v[158:159], v[108:109]
    v_mfma_f32_32x32x16_bf16 v[16:31], v[168:171], v[80:83], v[16:31]
    s_waitcnt vmcnt(1)
    s_mul_i32 s59, s57, 18432
    s_add_u32 s59, s59, 15360
    s_add_u32 m0, s59, 73728
    s_nop 0
    buffer_load_dwordx4 v2, s[36:39], s59 offen lds
    v_rcp_f32 v48, v48
    v_mfma_f32_32x32x16_bf16 v[16:31], v[172:175], v[84:87], v[16:31]
    v_rcp_f32 v49, v49
    v_rcp_f32 v50, v50
    v_rcp_f32 v51, v51
    v_mfma_f32_32x32x16_bf16 v[16:31], v[176:179], v[88:91], v[16:31]
    v_rcp_f32 v52, v52
    v_rcp_f32 v53, v53
    v_rcp_f32 v54, v54
    v_mfma_f32_32x32x16_bf16 v[16:31], v[180:183], v[92:95], v[16:31]
    v_rcp_f32 v55, v55
    v_rcp_f32 v56, v56
    v_rcp_f32 v57, v57
    v_rcp_f32 v58, v58
    v_rcp_f32 v59, v59
    v_rcp_f32 v60, v60
    v_rcp_f32 v61, v61
    v_rcp_f32 v62, v62
    v_rcp_f32 v63, v63
    v_pk_mul_f32 v[32:33], v[32:33], v[48:49]
    v_pk_mul_f32 v[34:35], v[34:35], v[50:51]
    v_pk_mul_f32 v[36:37], v[36:37], v[52:53]
    v_pk_mul_f32 v[38:39], v[38:39], v[54:55]
    v_pk_mul_f32 v[40:41], v[40:41], v[56:57]
    v_pk_mul_f32 v[42:43], v[42:43], v[58:59]
    v_pk_mul_f32 v[44:45], v[44:45], v[60:61]
    v_pk_mul_f32 v[46:47], v[46:47], v[62:63]
    v_pk_fma_f32 v[48:49], v[16:17], v[16:17], s[52:53]
    v_pk_fma_f32 v[50:51], v[18:19], v[18:19], s[52:53]
    v_pk_fma_f32 v[52:53], v[20:21], v[20:21], s[52:53]
    v_pk_fma_f32 v[54:55], v[22:23], v[22:23], s[52:53]
    v_pk_fma_f32 v[56:57], v[24:25], v[24:25], s[52:53]
    v_pk_fma_f32 v[58:59], v[26:27], v[26:27], s[52:53]
    v_pk_fma_f32 v[60:61], v[28:29], v[28:29], s[52:53]
    v_pk_fma_f32 v[62:63], v[30:31], v[30:31], s[52:53]
    v_pk_mul_f32 v[48:49], v[48:49], v[16:17] neg_lo:[1,0] neg_hi:[1,0]
    v_pk_mul_f32 v[50:51], v[50:51], v[18:19] neg_lo:[1,0] neg_hi:[1,0]
    v_pk_mul_f32 v[52:53], v[52:53], v[20:21] neg_lo:[1,0] neg_hi:[1,0]
    v_pk_mul_f32 v[54:55], v[54:55], v[22:23] neg_lo:[1,0] neg_hi:[1,0]
    v_pk_mul_f32 v[56:57], v[56:57], v[24:25] neg_lo:[1,0] neg_hi:[1,0]
    v_pk_mul_f32 v[58:59], v[58:59], v[26:27] neg_lo:[1,0] neg_hi:[1,0]
    v_pk_mul_f32 v[60:61], v[60:61], v[28:29] neg_lo:[1,0] neg_hi:[1,0]
    v_pk_mul_f32 v[62:63], v[62:63], v[30:31] neg_lo:[1,0] neg_hi:[1,0]
    v_cvt_pk_bf16_f32 v64, v32, v33
    v_cvt_pk_bf16_f32 v65, v34, v35
    v_cvt_pk_bf16_f32 v66, v36, v37
    v_cvt_pk_bf16_f32 v67, v38, v39
    v_cvt_pk_bf16_f32 v68, v40, v41
    v_cvt_pk_bf16_f32 v69, v42, v43
    v_cvt_pk_bf16_f32 v70, v44, v45
    v_cvt_pk_bf16_f32 v71, v46, v47
    v_mfma_f32_32x32x16_bf16 v[32:47], v[64:67], a[24:27], 0
    v_exp_f32 v48, v48
    v_exp_f32 v49, v49
    v_exp_f32 v50, v50
    v_mfma_f32_32x32x16_bf16 v[32:47], v[68:71], a[28:31], v[32:47]
    v_exp_f32 v51, v51
    v_exp_f32 v52, v52
    v_exp_f32 v53, v53
    v_mfma_f32_32x32x16_bf16 v[144:159], v[120:123], a[224:227], 0
    v_exp_f32 v54, v54
    v_exp_f32 v55, v55
    v_exp_f32 v56, v56
    v_mfma_f32_32x32x16_bf16 v[144:159], v[124:127], a[228:231], v[144:159]
    v_exp_f32 v57, v57
    v_exp_f32 v58, v58
    v_exp_f32 v59, v59
    v_exp_f32 v60, v60
    v_exp_f32 v61, v61
    v_exp_f32 v62, v62
    v_exp_f32 v63, v63
    v_pk_add_f32 v[48:49], v[48:49], 1.0 op_sel_hi:[1,0]
    v_pk_add_f32 v[50:51], v[50:51], 1.0 op_sel_hi:[1,0]
    v_pk_add_f32 v[52:53], v[52:53], 1.0 op_sel_hi:[1,0]
    v_pk_add_f32 v[54:55], v[54:55], 1.0 op_sel_hi:[1,0]
    v_pk_add_f32 v[56:57], v[56:57], 1.0 op_sel_hi:[1,0]
    v_pk_add_f32 v[58:59], v[58:59], 1.0 op_sel_hi:[1,0]
    v_pk_add_f32 v[60:61], v[60:61], 1.0 op_sel_hi:[1,0]
    v_pk_add_f32 v[62:63], v[62:63], 1.0 op_sel_hi:[1,0]
    v_pk_fma_f32 v[110:111], v[32:33], v[32:33], v[110:111]
    v_pk_fma_f32 v[110:111], v[34:35], v[34:35], v[110:111]
    v_pk_fma_f32 v[110:111], v[36:37], v[36:37], v[110:111]
    v_pk_fma_f32 v[110:111], v[38:39], v[38:39], v[110:111]
    v_pk_fma_f32 v[110:111], v[40:41], v[40:41], v[110:111]
    v_pk_fma_f32 v[110:111], v[42:43], v[42:43], v[110:111]
    v_pk_fma_f32 v[110:111], v[44:45], v[44:45], v[110:111]
    v_pk_fma_f32 v[110:111], v[46:47], v[46:47], v[110:111]
    v_pk_mul_f32 v[10:11], v[144:145], v[144:145]
    v_pk_add_f32 v[8:9], v[144:145], v[146:147]
    v_pk_fma_f32 v[10:11], v[146:147], v[146:147], v[10:11]
    v_pk_add_f32 v[8:9], v[8:9], v[148:149]
    v_pk_fma_f32 v[10:11], v[148:149], v[148:149], v[10:11]
    v_pk_add_f32 v[8:9], v[8:9], v[150:151]
    v_pk_fma_f32 v[10:11], v[150:151], v[150:151], v[10:11]
    v_pk_add_f32 v[8:9], v[8:9], v[152:153]
    v_pk_fma_f32 v[10:11], v[152:153], v[152:153], v[10:11]
    v_pk_add_f32 v[8:9], v[8:9], v[154:155]
    v_pk_fma_f32 v[10:11], v[154:155], v[154:155], v[10:11]
    v_pk_add_f32 v[8:9], v[8:9], v[156:157]
    v_pk_fma_f32 v[10:11], v[156:157], v[156:157], v[10:11]
    v_pk_add_f32 v[8:9], v[8:9], v[158:159]
    v_pk_fma_f32 v[10:11], v[158:159], v[158:159], v[10:11]
    v_mfma_f32_32x32x16_bf16 v[32:47], v[184:187], v[72:75], 0
    s_mul_i32 s59, s57, 18432
    s_add_u32 s59, s59, 16384
    s_add_u32 m0, s59, 73728
    s_nop 0
    buffer_load_dwordx4 v2, s[36:39], s59 offen lds
    v_rcp_f32 v48, v48
    v_mfma_f32_32x32x16_bf16 v[32:47], v[188:191], v[76:79], v[32:47]
    v_rcp_f32 v49, v49
    v_rcp_f32 v50, v50
    v_rcp_f32 v51, v51
    v_mfma_f32_32x32x16_bf16 v[32:47], v[192:195], v[80:83], v[32:47]
    v_rcp_f32 v52, v52
    v_rcp_f32 v53, v53
    v_rcp_f32 v54, v54
    v_mfma_f32_32x32x16_bf16 v[32:47], v[196:199], v[84:87], v[32:47]
    v_rcp_f32 v55, v55
    v_rcp_f32 v56, v56
    v_rcp_f32 v57, v57
    v_mfma_f32_32x32x16_bf16 v[32:47], v[200:203], v[88:91], v[32:47]
    v_rcp_f32 v58, v58
    v_rcp_f32 v59, v59
    v_rcp_f32 v60, v60
    v_mfma_f32_32x32x16_bf16 v[32:47], v[204:207], v[92:95], v[32:47]
    v_rcp_f32 v61, v61
    v_rcp_f32 v62, v62
    v_rcp_f32_e64 v63, v63
    v_accvgpr_write_b32 a88, v64
    v_accvgpr_write_b32 a89, v65
    v_accvgpr_write_b32 a90, v66
    v_accvgpr_write_b32 a91, v67
    v_accvgpr_write_b32 a92, v68
    v_accvgpr_write_b32 a93, v69
    v_accvgpr_write_b32 a94, v70
    v_accvgpr_write_b32 a95, v71
    v_pk_mul_f32 v[16:17], v[16:17], v[48:49]
    v_pk_mul_f32 v[18:19], v[18:19], v[50:51]
    v_pk_mul_f32 v[20:21], v[20:21], v[52:53]
    v_pk_mul_f32 v[22:23], v[22:23], v[54:55]
    v_pk_mul_f32 v[24:25], v[24:25], v[56:57]
    v_pk_mul_f32 v[26:27], v[26:27], v[58:59]
    v_pk_mul_f32 v[28:29], v[28:29], v[60:61]
    v_pk_mul_f32 v[30:31], v[30:31], v[62:63]
    v_pk_fma_f32 v[48:49], v[32:33], v[32:33], s[52:53]
    v_pk_fma_f32 v[50:51], v[34:35], v[34:35], s[52:53]
    v_pk_fma_f32 v[52:53], v[36:37], v[36:37], s[52:53]
    v_pk_fma_f32 v[54:55], v[38:39], v[38:39], s[52:53]
    v_pk_fma_f32 v[56:57], v[40:41], v[40:41], s[52:53]
    v_pk_fma_f32 v[58:59], v[42:43], v[42:43], s[52:53]
    v_pk_fma_f32 v[60:61], v[44:45], v[44:45], s[52:53]
    v_pk_fma_f32 v[62:63], v[46:47], v[46:47], s[52:53]
    v_pk_mul_f32 v[48:49], v[48:49], v[32:33] neg_lo:[1,0] neg_hi:[1,0]
    v_pk_mul_f32 v[50:51], v[50:51], v[34:35] neg_lo:[1,0] neg_hi:[1,0]
    v_pk_mul_f32 v[52:53], v[52:53], v[36:37] neg_lo:[1,0] neg_hi:[1,0]
    v_pk_mul_f32 v[54:55], v[54:55], v[38:39] neg_lo:[1,0] neg_hi:[1,0]
    v_pk_mul_f32 v[56:57], v[56:57], v[40:41] neg_lo:[1,0] neg_hi:[1,0]
    v_pk_mul_f32 v[58:59], v[58:59], v[42:43] neg_lo:[1,0] neg_hi:[1,0]
    v_pk_mul_f32 v[60:61], v[60:61], v[44:45] neg_lo:[1,0] neg_hi:[1,0]
    v_pk_mul_f32 v[62:63], v[62:63], v[46:47] neg_lo:[1,0] neg_hi:[1,0]
L_pf8:
    v_cvt_pk_bf16_f32 v64, v16, v17
    v_cvt_pk_bf16_f32 v65, v18, v19
    v_cvt_pk_bf16_f32 v66, v20, v21
    v_cvt_pk_bf16_f32 v67, v22, v23
    v_cvt_pk_bf16_f32 v68, v24, v25
    v_cvt_pk_bf16_f32 v69, v26, v27
    v_cvt_pk_bf16_f32 v70, v28, v29
    v_cvt_pk_bf16_f32 v71, v30, v31
    v_mfma_f32_32x32x16_bf16 v[16:31], v[64:67], a[24:27], 0
    s_mov_b32 s63, L_pf8-L_pc+12288
    buffer_load_dword v6, v7, s[68:71], s63 offen
    v_exp_f32 v48, v48
    v_exp_f32 v49, v49
    v_exp_f32 v50, v50
    v_mfma_f32_32x32x16_bf16 v[16:31], v[68:71], a[28:31], v[16:31]
    v_exp_f32 v51, v51
    v_exp_f32 v52, v52
    v_exp_f32 v53, v53
    v_mfma_f32_32x32x16_bf16 v[144:159], v[128:131], a[232:235], 0
    v_exp_f32 v54, v54
    v_exp_f32 v55, v55
    v_exp_f32 v56, v56
    v_mfma_f32_32x32x16_bf16 v[144:159], v[132:135], a[236:239], v[144:159]
    v_exp_f32 v57, v57
    v_exp_f32 v58, v58
    v_exp_f32 v59, v59
    v_exp_f32 v60, v60
    v_exp_f32 v61, v61
    v_exp_f32 v62, v62
    v_exp_f32 v63, v63
    v_pk_add_f32 v[48:49], v[48:49], 1.0 op_sel_hi:[1,0]
    v_pk_add_f32 v[50:51], v[50:51], 1.0 op_sel_hi:[1,0]
    v_pk_add_f32 v[52:53], v[52:53], 1.0 op_sel_hi:[1,0]
    v_pk_add_f32 v[54:55], v[54:55], 1.0 op_sel_hi:[1,0]
    v_pk_add_f32 v[56:57], v[56:57], 1.0 op_sel_hi:[1,0]
    v_pk_add_f32 v[58:59], v[58:59], 1.0 op_sel_hi:[1,0]
    v_pk_add_f32 v[60:61], v[60:61], 1.0 op_sel_hi:[1,0]
    v_pk_add_f32 v[62:63], v[62:63], 1.0 op_sel_hi:[1,0]
    v_pk_fma_f32 v[112:113], v[16:17], v[16:17], v[112:113]
    v_pk_fma_f32 v[112:113], v[18:19], v[18:19], v[112:113]
    v_pk_fma_f32 v[112:113], v[20:21], v[20:21], v[112:113]
    v_pk_fma_f32 v[112:113], v[22:23], v[22:23], v[112:113]
    v_pk_fma_f32 v[112:113], v[24:25], v[24:25], v[112:113]
    v_pk_fma_f32 v[112:113], v[26:27], v[26:27], v[112:113]
    v_pk_fma_f32 v[112:113], v[28:29], v[28:29], v[112:113]
    v_pk_fma_f32 v[112:113], v[30:31], v[30:31], v[112:113]
    v_pk_add_f32 v[8:9], v[8:9], v[144:145]
    v_pk_fma_f32 v[10:11], v[144:145], v[144:145], v[10:11]
    v_pk_add_f32 v[8:9], v[8:9], v[146:147]
    v_pk_fma_f32 v[10:11], v[146:147], v[146:147], v[10:11]
    v_pk_add_f32 v[8:9], v[8:9], v[148:149]
    v_pk_fma_f32 v[10:11], v[148:149], v[148:149], v[10:11]
    v_pk_add_f32 v[8:9], v[8:9], v[150:151]
    v_pk_fma_f32 v[10:11], v[150:151], v[150:151], v[10:11]
    v_pk_add_f32 v[8:9], v[8:9], v[152:153]
    v_pk_fma_f32 v[10:11], v[152:153], v[152:153], v[10:11]
    v_pk_add_f32 v[8:9], v[8:9], v[154:155]
    v_pk_fma_f32 v[10:11], v[154:155], v[154:155], v[10:11]
    v_pk_add_f32 v[8:9], v[8:9], v[156:157]
    v_pk_fma_f32 v[10:11], v[156:157], v[156:157], v[10:11]
    v_pk_add_f32 v[8:9], v[8:9], v[158:159]
    v_pk_fma_f32 v[10:11], v[158:159], v[158:159], v[10:11]
    v_mfma_f32_32x32x16_bf16 v[16:31], v[208:211], v[72:75], 0
    s_mul_i32 s59, s57, 18432
    s_add_u32 s59, s59, 17408
    s_add_u32 m0, s59, 73728
    s_nop 0
    buffer_load_dwordx4 v2, s[36:39], s59 offen lds
    v_rcp_f32 v48, v48
    v_mfma_f32_32x32x16_bf16 v[16:31], v[212:215], v[76:79], v[16:31]
    v_rcp_f32 v49, v49
    v_rcp_f32 v50, v50
    v_rcp_f32 v51, v51
    v_mfma_f32_32x32x16_bf16 v[16:31], v[216:219], v[80:83], v[16:31]
    v_rcp_f32 v52, v52
    v_rcp_f32 v53, v53
    v_rcp_f32 v54, v54
    v_mfma_f32_32x32x16_bf16 v[16:31], v[220:223], v[84:87], v[16:31]
    v_rcp_f32 v55, v55
    v_rcp_f32 v56, v56
    v_rcp_f32 v57, v57
    v_mfma_f32_32x32x16_bf16 v[16:31], v[224:227], v[88:91], v[16:31]
    v_rcp_f32 v58, v58
    v_rcp_f32 v59, v59
    v_rcp_f32 v60, v60
    v_mfma_f32_32x32x16_bf16 v[16:31], v[228:231], v[92:95], v[16:31]
    v_rcp_f32 v61, v61
    v_rcp_f32 v62, v62
    v_rcp_f32_e64 v63, v63
    v_accvgpr_write_b32 a96, v64
    v_accvgpr_write_b32 a97, v65
    v_accvgpr_write_b32 a98, v66
    v_accvgpr_write_b32 a99, v67
    v_accvgpr_write_b32 a100, v68
    v_accvgpr_write_b32 a101, v69
    v_accvgpr_write_b32 a102, v70
    v_accvgpr_write_b32 a103, v71
    v_pk_mul_f32 v[32:33], v[32:33], v[48:49]
    v_pk_mul_f32 v[34:35], v[34:35], v[50:51]
    v_pk_mul_f32 v[36:37], v[36:37], v[52:53]
    v_pk_mul_f32 v[38:39], v[38:39], v[54:55]
    v_pk_mul_f32 v[40:41], v[40:41], v[56:57]
    v_pk_mul_f32 v[42:43], v[42:43], v[58:59]
    v_pk_mul_f32 v[44:45], v[44:45], v[60:61]
    v_pk_mul_f32 v[46:47], v[46:47], v[62:63]
    v_pk_fma_f32 v[48:49], v[16:17], v[16:17], s[52:53]
    v_pk_fma_f32 v[50:51], v[18:19], v[18:19], s[52:53]
    v_pk_fma_f32 v[52:53], v[20:21], v[20:21], s[52:53]
    v_pk_fma_f32 v[54:55], v[22:23], v[22:23], s[52:53]
    v_pk_fma_f32 v[56:57], v[24:25], v[24:25], s[52:53]
    v_pk_fma_f32 v[58:59], v[26:27], v[26:27], s[52:53]
    v_pk_fma_f32 v[60:61], v[28:29], v[28:29], s[52:53]
    v_pk_fma_f32 v[62:63], v[30:31], v[30:31], s[52:53]
    v_pk_mul_f32 v[48:49], v[48:49], v[16:17] neg_lo:[1,0] neg_hi:[1,0]
    v_pk_mul_f32 v[50:51], v[50:51], v[18:19] neg_lo:[1,0] neg_hi:[1,0]
    v_pk_mul_f32 v[52:53], v[52:53], v[20:21] neg_lo:[1,0] neg_hi:[1,0]
    v_pk_mul_f32 v[54:55], v[54:55], v[22:23] neg_lo:[1,0] neg_hi:[1,0]
    v_pk_mul_f32 v[56:57], v[56:57], v[24:25] neg_lo:[1,0] neg_hi:[1,0]
    v_pk_mul_f32 v[58:59], v[58:59], v[26:27] neg_lo:[1,0] neg_hi:[1,0]
    v_pk_mul_f32 v[60:61], v[60:61], v[28:29] neg_lo:[1,0] neg_hi:[1,0]
    v_pk_mul_f32 v[62:63], v[62:63], v[30:31] neg_lo:[1,0] neg_hi:[1,0]
    v_cvt_pk_bf16_f32 v64, v32, v33
    v_cvt_pk_bf16_f32 v65, v34, v35
    v_cvt_pk_bf16_f32 v66, v36, v37
    v_cvt_pk_bf16_f32 v67, v38, v39
    v_cvt_pk_bf16_f32 v68, v40, v41
    v_cvt_pk_bf16_f32 v69, v42, v43
    v_cvt_pk_bf16_f32 v70, v44, v45
    v_cvt_pk_bf16_f32 v71, v46, v47
    v_mfma_f32_32x32x16_bf16 v[32:47], v[64:67], a[24:27], 0
    v_exp_f32 v48, v48
    v_exp_f32 v49, v49
    v_exp_f32 v50, v50
    v_mfma_f32_32x32x16_bf16 v[32:47], v[68:71], a[28:31], v[32:47]
    v_exp_f32 v51, v51
    v_exp_f32 v52, v52
    v_exp_f32 v53, v53
    v_mfma_f32_32x32x16_bf16 v[144:159], v[136:139], a[240:243], 0
    v_exp_f32 v54, v54
    v_exp_f32 v55, v55
    v_exp_f32 v56, v56
    v_mfma_f32_32x32x16_bf16 v[144:159], v[140:143], a[244:247], v[144:159]
    v_exp_f32 v57, v57
    v_exp_f32 v58, v58
    v_exp_f32 v59, v59
    v_exp_f32 v60, v60
    v_exp_f32 v61, v61
    v_exp_f32 v62, v62
    v_exp_f32 v63, v63
    v_pk_add_f32 v[48:49], v[48:49], 1.0 op_sel_hi:[1,0]
    v_pk_add_f32 v[50:51], v[50:51], 1.0 op_sel_hi:[1,0]
    v_pk_add_f32 v[52:53], v[52:53], 1.0 op_sel_hi:[1,0]
    v_pk_add_f32 v[54:55], v[54:55], 1.0 op_sel_hi:[1,0]
    v_pk_add_f32 v[56:57], v[56:57], 1.0 op_sel_hi:[1,0]
    v_pk_add_f32 v[58:59], v[58:59], 1.0 op_sel_hi:[1,0]
    v_pk_add_f32 v[60:61], v[60:61], 1.0 op_sel_hi:[1,0]
    v_pk_add_f32 v[62:63], v[62:63], 1.0 op_sel_hi:[1,0]
    v_pk_fma_f32 v[114:115], v[32:33], v[32:33], v[114:115]
    v_pk_fma_f32 v[114:115], v[34:35], v[34:35], v[114:115]
    v_pk_fma_f32 v[114:115], v[36:37], v[36:37], v[114:115]
    v_pk_fma_f32 v[114:115], v[38:39], v[38:39], v[114:115]
    v_pk_fma_f32 v[114:115], v[40:41], v[40:41], v[114:115]
    v_pk_fma_f32 v[114:115], v[42:43], v[42:43], v[114:115]
    v_pk_fma_f32 v[114:115], v[44:45], v[44:45], v[114:115]
    v_pk_fma_f32 v[114:115], v[46:47], v[46:47], v[114:115]
    v_pk_add_f32 v[8:9], v[8:9], v[144:145]
    v_pk_fma_f32 v[10:11], v[144:145], v[144:145], v[10:11]
    v_pk_add_f32 v[8:9], v[8:9], v[146:147]
    v_pk_fma_f32 v[10:11], v[146:147], v[146:147], v[10:11]
    v_pk_add_f32 v[8:9], v[8:9], v[148:149]
    v_pk_fma_f32 v[10:11], v[148:149], v[148:149], v[10:11]
    v_pk_add_f32 v[8:9], v[8:9], v[150:151]
    v_pk_fma_f32 v[10:11], v[150:151], v[150:151], v[10:11]
    v_pk_add_f32 v[8:9], v[8:9], v[152:153]
    v_pk_fma_f32 v[10:11], v[152:153], v[152:153], v[10:11]
    v_pk_add_f32 v[8:9], v[8:9], v[154:155]
    v_pk_fma_f32 v[10:11], v[154:155], v[154:155], v[10:11]
    v_pk_add_f32 v[8:9], v[8:9], v[156:157]
    v_pk_fma_f32 v[10:11], v[156:157], v[156:157], v[10:11]
    v_pk_add_f32 v[8:9], v[8:9], v[158:159]
    v_pk_fma_f32 v[10:11], v[158:159], v[158:159], v[10:11]
    v_mfma_f32_32x32x16_bf16 v[32:47], v[232:235], v[72:75], 0
    v_rcp_f32 v48, v48
    v_rcp_f32 v49, v49
    v_rcp_f32 v50, v50
    v_mfma_f32_32x32x16_bf16 v[32:47], v[236:239], v[76:79], v[32:47]
    v_rcp_f32 v51, v51
    v_rcp_f32 v52, v52
    v_rcp_f32 v53, v53
    v_mfma_f32_32x32x16_bf16 v[32:47], v[240:243], v[80:83], v[32:47]
    v_rcp_f32 v54, v54
    v_rcp_f32 v55, v55
    v_rcp_f32 v56, v56
    v_mfma_f32_32x32x16_bf16 v[32:47], v[244:247], v[84:87], v[32:47]
    v_rcp_f32 v57, v57
    v_rcp_f32 v58, v58
    v_rcp_f32 v59, v59
    v_mfma_f32_32x32x16_bf16 v[32:47], v[248:251], v[88:91], v[32:47]
    v_rcp_f32 v60, v60
    v_rcp_f32 v61, v61
    v_rcp_f32 v62, v62
    v_mfma_f32_32x32x16_bf16 v[32:47], v[252:255], v[92:95], v[32:47]
    v_rcp_f32 v63, v63
    v_add_f32 v8, v8, v9
    v_add_f32 v10, v10, v11
    s_nop 1
    v_permlane32_swap_b32 v8, v10
    v_add_f32 v8, v8, v10
    v_mfma_f32_32x32x16_bf16 v[144:159], v[120:123], a[224:227], 0
    v_mov_b32 v10, v8
    s_nop 1
    v_permlane32_swap_b32 v8, v10
    v_mul_f32 v8, 0x3c2aaaab, v8
    v_mul_f32 v10, 0x3c2aaaab, v10
    v_fma_f32 v10, -v8, v8, v10
    v_max_f32 v10, 0, v10
    v_mfma_f32_32x32x16_bf16 v[144:159], v[124:127], a[228:231], v[144:159]
    v_add_f32 v10, 0x3727c5ac, v10
    v_rsq_f32_e64 v10, v10
    s_nop 0
    v_mul_f32 v12, 0x3eeff558, v10
    v_mul_f32_e64 v13, -v8, v12
    v_accvgpr_write_b32 a104, v64
    v_accvgpr_write_b32 a105, v65
    v_accvgpr_write_b32 a106, v66
    v_accvgpr_write_b32 a107, v67
    v_accvgpr_write_b32 a108, v68
    v_accvgpr_write_b32 a109, v69
    v_accvgpr_write_b32 a110, v70
    v_accvgpr_write_b32 a111, v71
    v_pk_mul_f32 v[16:17], v[16:17], v[48:49]
    v_pk_mul_f32 v[18:19], v[18:19], v[50:51]
    v_pk_mul_f32 v[20:21], v[20:21], v[52:53]
    v_pk_mul_f32 v[22:23], v[22:23], v[54:55]
    v_pk_mul_f32 v[24:25], v[24:25], v[56:57]
    v_pk_mul_f32 v[26:27], v[26:27], v[58:59]
    v_pk_mul_f32 v[28:29], v[28:29], v[60:61]
    v_pk_mul_f32 v[30:31], v[30:31], v[62:63]
    v_pk_fma_f32 v[144:145], v[144:145], v[12:13], v[12:13] op_sel:[0,0,1] op_sel_hi:[1,0,1]
    v_pk_fma_f32 v[146:147], v[146:147], v[12:13], v[12:13] op_sel:[0,0,1] op_sel_hi:[1,0,1]
    v_pk_fma_f32 v[148:149], v[148:149], v[12:13], v[12:13] op_sel:[0,0,1] op_sel_hi:[1,0,1]
    v_pk_fma_f32 v[150:151], v[150:151], v[12:13], v[12:13] op_sel:[0,0,1] op_sel_hi:[1,0,1]
    v_pk_fma_f32 v[152:153], v[152:153], v[12:13], v[12:13] op_sel:[0,0,1] op_sel_hi:[1,0,1]
    v_pk_fma_f32 v[154:155], v[154:155], v[12:13], v[12:13] op_sel:[0,0,1] op_sel_hi:[1,0,1]
    v_pk_fma_f32 v[156:157], v[156:157], v[12:13], v[12:13] op_sel:[0,0,1] op_sel_hi:[1,0,1]
    v_pk_fma_f32 v[158:159], v[158:159], v[12:13], v[12:13] op_sel:[0,0,1] op_sel_hi:[1,0,1]
    v_cvt_pk_bf16_f32 v72, v144, v145
    v_cvt_pk_bf16_f32 v73, v146, v147
    v_cvt_pk_bf16_f32 v74, v148, v149
    v_cvt_pk_bf16_f32 v75, v150, v151
    v_cvt_pk_bf16_f32 v76, v152, v153
    v_cvt_pk_bf16_f32 v77, v154, v155
    v_cvt_pk_bf16_f32 v78, v156, v157
    v_cvt_pk_bf16_f32 v79, v158, v159
    v_pk_fma_f32 v[48:49], v[32:33], v[32:33], s[52:53]
    v_pk_fma_f32 v[50:51], v[34:35], v[34:35], s[52:53]
    v_pk_fma_f32 v[52:53], v[36:37], v[36:37], s[52:53]
    v_pk_fma_f32 v[54:55], v[38:39], v[38:39], s[52:53]
    v_pk_fma_f32 v[56:57], v[40:41], v[40:41], s[52:53]
    v_pk_fma_f32 v[58:59], v[42:43], v[42:43], s[52:53]
    v_pk_fma_f32 v[60:61], v[44:45], v[44:45], s[52:53]
    v_pk_fma_f32 v[62:63], v[46:47], v[46:47], s[52:53]
    v_pk_mul_f32 v[48:49], v[48:49], v[32:33] neg_lo:[1,0] neg_hi:[1,0]
    v_pk_mul_f32 v[50:51], v[50:51], v[34:35] neg_lo:[1,0] neg_hi:[1,0]
    v_pk_mul_f32 v[52:53], v[52:53], v[36:37] neg_lo:[1,0] neg_hi:[1,0]
    v_pk_mul_f32 v[54:55], v[54:55], v[38:39] neg_lo:[1,0] neg_hi:[1,0]
    v_pk_mul_f32 v[56:57], v[56:57], v[40:41] neg_lo:[1,0] neg_hi:[1,0]
    v_pk_mul_f32 v[58:59], v[58:59], v[42:43] neg_lo:[1,0] neg_hi:[1,0]
    v_pk_mul_f32 v[60:61], v[60:61], v[44:45] neg_lo:[1,0] neg_hi:[1,0]
    v_pk_mul_f32 v[62:63], v[62:63], v[46:47] neg_lo:[1,0] neg_hi:[1,0]
    v_cvt_pk_bf16_f32 v64, v16, v17
    v_cvt_pk_bf16_f32 v65, v18, v19
    v_cvt_pk_bf16_f32 v66, v20, v21
    v_cvt_pk_bf16_f32 v67, v22, v23
    v_cvt_pk_bf16_f32 v68, v24, v25
    v_cvt_pk_bf16_f32 v69, v26, v27
    v_cvt_pk_bf16_f32 v70, v28, v29
    v_cvt_pk_bf16_f32 v71, v30, v31
    v_mfma_f32_32x32x16_bf16 v[16:31], v[64:67], a[24:27], 0
    v_exp_f32 v48, v48
    v_exp_f32 v49, v49
    v_exp_f32 v50, v50
    v_mfma_f32_32x32x16_bf16 v[16:31], v[68:71], a[28:31], v[16:31]
    v_exp_f32 v51, v51
    v_exp_f32 v52, v52
    v_exp_f32 v53, v53
    v_mfma_f32_32x32x16_bf16 v[144:159], v[128:131], a[232:235], 0
    v_exp_f32 v54, v54
    v_exp_f32 v55, v55
    v_exp_f32 v56, v56
    v_mfma_f32_32x32x16_bf16 v[144:159], v[132:135], a[236:239], v[144:159]
    v_exp_f32 v57, v57
    v_pk_fma_f32 v[116:117], v[16:17], v[16:17], v[116:117]
    v_pk_fma_f32 v[116:117], v[18:19], v[18:19], v[116:117]
    v_pk_fma_f32 v[116:117], v[20:21], v[20:21], v[116:117]
    v_pk_fma_f32 v[116:117], v[22:23], v[22:23], v[116:117]
    v_pk_fma_f32 v[116:117], v[24:25], v[24:25], v[116:117]
    v_pk_fma_f32 v[116:117], v[26:27], v[26:27], v[116:117]
    v_pk_fma_f32 v[116:117], v[28:29], v[28:29], v[116:117]
    v_pk_fma_f32 v[116:117], v[30:31], v[30:31], v[116:117]
    v_pk_fma_f32 v[144:145], v[144:145], v[12:13], v[12:13] op_sel:[0,0,1] op_sel_hi:[1,0,1]
    v_pk_fma_f32 v[146:147], v[146:147], v[12:13], v[12:13] op_sel:[0,0,1] op_sel_hi:[1,0,1]
    v_pk_fma_f32 v[148:149], v[148:149], v[12:13], v[12:13] op_sel:[0,0,1] op_sel_hi:[1,0,1]
    v_pk_fma_f32 v[150:151], v[150:151], v[12:13], v[12:13] op_sel:[0,0,1] op_sel_hi:[1,0,1]
    v_pk_fma_f32 v[152:153], v[152:153], v[12:13], v[12:13] op_sel:[0,0,1] op_sel_hi:[1,0,1]
    v_pk_fma_f32 v[154:155], v[154:155], v[12:13], v[12:13] op_sel:[0,0,1] op_sel_hi:[1,0,1]
    v_pk_fma_f32 v[156:157], v[156:157], v[12:13], v[12:13] op_sel:[0,0,1] op_sel_hi:[1,0,1]
    v_pk_fma_f32 v[158:159], v[158:159], v[12:13], v[12:13] op_sel:[0,0,1] op_sel_hi:[1,0,1]
    v_cvt_pk_bf16_f32 v80, v144, v145
    v_cvt_pk_bf16_f32 v81, v146, v147
    v_cvt_pk_bf16_f32 v82, v148, v149
    v_cvt_pk_bf16_f32 v83, v150, v151
    v_cvt_pk_bf16_f32 v84, v152, v153
    v_cvt_pk_bf16_f32 v85, v154, v155
    v_cvt_pk_bf16_f32 v86, v156, v157
    v_cvt_pk_bf16_f32 v87, v158, v159
    v_mfma_f32_32x32x16_bf16 v[144:159], v[136:139], a[240:243], 0
    v_exp_f32 v58, v58
    v_exp_f32 v59, v59
    v_exp_f32 v60, v60
    v_mfma_f32_32x32x16_bf16 v[144:159], v[140:143], a[244:247], v[144:159]
    v_exp_f32 v61, v61
    v_exp_f32 v62, v62
    v_exp_f32 v63, v63
    v_pk_add_f32 v[48:49], v[48:49], 1.0 op_sel_hi:[1,0]
    v_pk_add_f32 v[50:51], v[50:51], 1.0 op_sel_hi:[1,0]
    v_pk_add_f32 v[52:53], v[52:53], 1.0 op_sel_hi:[1,0]
    v_pk_add_f32 v[54:55], v[54:55], 1.0 op_sel_hi:[1,0]
    v_pk_add_f32 v[56:57], v[56:57], 1.0 op_sel_hi:[1,0]
    v_pk_add_f32 v[58:59], v[58:59], 1.0 op_sel_hi:[1,0]
    v_pk_add_f32 v[60:61], v[60:61], 1.0 op_sel_hi:[1,0]
    v_pk_add_f32 v[62:63], v[62:63], 1.0 op_sel_hi:[1,0]
    v_pk_fma_f32 v[144:145], v[144:145], v[12:13], v[12:13] op_sel:[0,0,1] op_sel_hi:[1,0,1]
    v_pk_fma_f32 v[146:147], v[146:147], v[12:13], v[12:13] op_sel:[0,0,1] op_sel_hi:[1,0,1]
    v_pk_fma_f32 v[148:149], v[148:149], v[12:13], v[12:13] op_sel:[0,0,1] op_sel_hi:[1,0,1]
    v_pk_fma_f32 v[150:151], v[150:151], v[12:13], v[12:13] op_sel:[0,0,1] op_sel_hi:[1,0,1]
    v_pk_fma_f32 v[152:153], v[152:153], v[12:13], v[12:13] op_sel:[0,0,1] op_sel_hi:[1,0,1]
    v_pk_fma_f32 v[154:155], v[154:155], v[12:13], v[12:13] op_sel:[0,0,1] op_sel_hi:[1,0,1]
    v_pk_fma_f32 v[156:157], v[156:157], v[12:13], v[12:13] op_sel:[0,0,1] op_sel_hi:[1,0,1]
    v_pk_fma_f32 v[158:159], v[158:159], v[12:13], v[12:13] op_sel:[0,0,1] op_sel_hi:[1,0,1]
    v_cvt_pk_bf16_f32 v88, v144, v145
    v_cvt_pk_bf16_f32 v89, v146, v147
    v_cvt_pk_bf16_f32 v90, v148, v149
    v_cvt_pk_bf16_f32 v91, v150, v151
    v_cvt_pk_bf16_f32 v92, v152, v153
    v_cvt_pk_bf16_f32 v93, v154, v155
    v_cvt_pk_bf16_f32 v94, v156, v157
    v_cvt_pk_bf16_f32 v95, v158, v159
    v_mfma_f32_32x32x16_bf16 v[16:31], a[128:131], v[72:75], 0
    s_add_u32 s54, s56, 147456
    buffer_load_dwordx4 a[224:227], v1, s[24:27], s54 offen offset:0
    buffer_load_dwordx4 a[228:231], v1, s[24:27], s54 offen offset:32
    v_rcp_f32 v48, v48
    v_rcp_f32 v49, v49
    v_mfma_f32_32x32x16_bf16 v[16:31], a[132:135], v[76:79], v[16:31]
    buffer_load_dwordx4 a[232:235], v1, s[24:27], s54 offen offset:64
    buffer_load_dwordx4 a[236:239], v1, s[24:27], s54 offen offset:96
    v_rcp_f32 v50, v50
    v_rcp_f32 v51, v51
    v_mfma_f32_32x32x16_bf16 v[16:31], a[136:139], v[80:83], v[16:31]
    buffer_load_dwordx4 a[240:243], v1, s[24:27], s54 offen offset:128
    buffer_load_dwordx4 a[244:247], v1, s[24:27], s54 offen offset:160
    v_rcp_f32 v52, v52
    v_rcp_f32 v53, v53
    v_mfma_f32_32x32x16_bf16 v[16:31], a[140:143], v[84:87], v[16:31]
    v_rcp_f32 v54, v54
    v_rcp_f32 v55, v55
    v_rcp_f32 v56, v56
    v_mfma_f32_32x32x16_bf16 v[16:31], a[144:147], v[88:91], v[16:31]
    v_rcp_f32 v57, v57
    v_rcp_f32 v58, v58
    v_rcp_f32 v59, v59
    v_mfma_f32_32x32x16_bf16 v[16:31], a[148:151], v[92:95], v[16:31]
    v_rcp_f32 v60, v60
    v_rcp_f32 v61, v61
    v_rcp_f32 v62, v62
    v_rcp_f32 v63, v63
    v_accvgpr_write_b32 a112, v64
    v_accvgpr_write_b32 a113, v65
    v_accvgpr_write_b32 a114, v66
    v_accvgpr_write_b32 a115, v67
    v_accvgpr_write_b32 a116, v68
    v_accvgpr_write_b32 a117, v69
    v_accvgpr_write_b32 a118, v70
    v_accvgpr_write_b32 a119, v71
    v_pk_mul_f32 v[32:33], v[32:33], v[48:49]
    v_pk_mul_f32 v[34:35], v[34:35], v[50:51]
    v_pk_mul_f32 v[36:37], v[36:37], v[52:53]
    v_pk_mul_f32 v[38:39], v[38:39], v[54:55]
    v_pk_mul_f32 v[40:41], v[40:41], v[56:57]
    v_pk_mul_f32 v[42:43], v[42:43], v[58:59]
    v_pk_mul_f32 v[44:45], v[44:45], v[60:61]
    v_pk_mul_f32 v[46:47], v[46:47], v[62:63]
    v_pk_fma_f32 v[48:49], v[16:17], v[16:17], s[52:53]
    v_pk_fma_f32 v[50:51], v[18:19], v[18:19], s[52:53]
    v_pk_fma_f32 v[52:53], v[20:21], v[20:21], s[52:53]
    v_pk_fma_f32 v[54:55], v[22:23], v[22:23], s[52:53]
    v_pk_fma_f32 v[56:57], v[24:25], v[24:25], s[52:53]
    v_pk_fma_f32 v[58:59], v[26:27], v[26:27], s[52:53]
    v_pk_fma_f32 v[60:61], v[28:29], v[28:29], s[52:53]
    v_pk_fma_f32 v[62:63], v[30:31], v[30:31], s[52:53]
    v_pk_mul_f32 v[48:49], v[48:49], v[16:17] neg_lo:[1,0] neg_hi:[1,0]
    v_pk_mul_f32 v[50:51], v[50:51], v[18:19] neg_lo:[1,0] neg_hi:[1,0]
    v_pk_mul_f32 v[52:53], v[52:53], v[20:21] neg_lo:[1,0] neg_hi:[1,0]
    v_pk_mul_f32 v[54:55], v[54:55], v[22:23] neg_lo:[1,0] neg_hi:[1,0]
    v_pk_mul_f32 v[56:57], v[56:57], v[24:25] neg_lo:[1,0] neg_hi:[1,0]
    v_pk_mul_f32 v[58:59], v[58:59], v[26:27] neg_lo:[1,0] neg_hi:[1,0]
    v_pk_mul_f32 v[60:61], v[60:61], v[28:29] neg_lo:[1,0] neg_hi:[1,0]
    v_pk_mul_f32 v[62:63], v[62:63], v[30:31] neg_lo:[1,0] neg_hi:[1,0]
    v_cvt_pk_bf16_f32 v64, v32, v33
    v_cvt_pk_bf16_f32 v65, v34, v35
    v_cvt_pk_bf16_f32 v66, v36, v37
    v_cvt_pk_bf16_f32 v67, v38, v39
    v_cvt_pk_bf16_f32 v68, v40, v41
    v_cvt_pk_bf16_f32 v69, v42, v43
    v_cvt_pk_bf16_f32 v70, v44, v45
    v_cvt_pk_bf16_f32 v71, v46, v47
    v_mfma_f32_32x32x16_bf16 v[144:159], v[64:67], a[24:27], 0
    v_exp_f32 v48, v48
    v_exp_f32 v49, v49
    v_exp_f32 v50, v50
    v_mfma_f32_32x32x16_bf16 v[144:159], v[68:71], a[28:31], v[144:159]
    v_exp_f32 v51, v51
    v_exp_f32 v52, v52
    v_exp_f32 v53, v53
    v_mfma_f32_32x32x16_bf16 v[32:47], a[152:155], v[72:75], 0
    v_exp_f32 v54, v54
    v_exp_f32 v55, v55
    v_exp_f32 v56, v56
    v_mfma_f32_32x32x16_bf16 v[32:47], a[156:159], v[76:79], v[32:47]
    v_exp_f32 v57, v57
    v_exp_f32 v58, v58
    v_exp_f32 v59, v59
    v_exp_f32 v60, v60
    v_exp_f32 v61, v61
    v_exp_f32 v62, v62
    v_exp_f32 v63, v63
    v_accvgpr_write_b32 a120, v64
    v_accvgpr_write_b32 a121, v65
    v_accvgpr_write_b32 a122, v66
    v_accvgpr_write_b32 a123, v67
    v_accvgpr_write_b32 a124, v68
    v_accvgpr_write_b32 a125, v69
    v_accvgpr_write_b32 a126, v70
    v_accvgpr_write_b32 a127, v71
    v_pk_add_f32 v[48:49], v[48:49], 1.0 op_sel_hi:[1,0]
    v_pk_add_f32 v[50:51], v[50:51], 1.0 op_sel_hi:[1,0]
    v_pk_add_f32 v[52:53], v[52:53], 1.0 op_sel_hi:[1,0]
    v_pk_add_f32 v[54:55], v[54:55], 1.0 op_sel_hi:[1,0]
    v_pk_add_f32 v[56:57], v[56:57], 1.0 op_sel_hi:[1,0]
    v_pk_add_f32 v[58:59], v[58:59], 1.0 op_sel_hi:[1,0]
    v_pk_add_f32 v[60:61], v[60:61], 1.0 op_sel_hi:[1,0]
    v_pk_add_f32 v[62:63], v[62:63], 1.0 op_sel_hi:[1,0]
    v_pk_fma_f32 v[118:119], v[144:145], v[144:145], v[118:119]
    v_pk_fma_f32 v[118:119], v[146:147], v[146:147], v[118:119]
    v_pk_fma_f32 v[118:119], v[148:149], v[148:149], v[118:119]
    v_pk_fma_f32 v[118:119], v[150:151], v[150:151], v[118:119]
    v_pk_fma_f32 v[118:119], v[152:153], v[152:153], v[118:119]
    v_pk_fma_f32 v[118:119], v[154:155], v[154:155], v[118:119]
    v_pk_fma_f32 v[118:119], v[156:157], v[156:157], v[118:119]
    v_pk_fma_f32 v[118:119], v[158:159], v[158:159], v[118:119]
    v_mfma_f32_32x32x16_bf16 v[32:47], a[160:163], v[80:83], v[32:47]
    v_rcp_f32 v48, v48
    v_rcp_f32 v49, v49
    v_rcp_f32 v50, v50
    v_mfma_f32_32x32x16_bf16 v[32:47], a[164:167], v[84:87], v[32:47]
    v_rcp_f32 v51, v51
    v_rcp_f32 v52, v52
    v_rcp_f32 v53, v53
    v_mfma_f32_32x32x16_bf16 v[32:47], a[168:171], v[88:91], v[32:47]
    v_rcp_f32 v54, v54
    v_rcp_f32 v55, v55
    v_rcp_f32 v56, v56
    v_mfma_f32_32x32x16_bf16 v[32:47], a[172:175], v[92:95], v[32:47]
    v_rcp_f32 v57, v57
    v_rcp_f32 v58, v58
    v_rcp_f32 v59, v59
    v_rcp_f32 v60, v60
    v_rcp_f32 v61, v61
    v_rcp_f32 v62, v62
    v_rcp_f32 v63, v63
    v_pk_mul_f32 v[16:17], v[16:17], v[48:49]
    v_pk_mul_f32 v[18:19], v[18:19], v[50:51]
    v_pk_mul_f32 v[20:21], v[20:21], v[52:53]
    v_pk_mul_f32 v[22:23], v[22:23], v[54:55]
    v_pk_mul_f32 v[24:25], v[24:25], v[56:57]
    v_pk_mul_f32 v[26:27], v[26:27], v[58:59]
    v_pk_mul_f32 v[28:29], v[28:29], v[60:61]
    v_pk_mul_f32 v[30:31], v[30:31], v[62:63]
    v_pk_fma_f32 v[48:49], v[32:33], v[32:33], s[52:53]
    v_pk_fma_f32 v[50:51], v[34:35], v[34:35], s[52:53]
    v_pk_fma_f32 v[52:53], v[36:37], v[36:37], s[52:53]
    v_pk_fma_f32 v[54:55], v[38:39], v[38:39], s[52:53]
    v_pk_fma_f32 v[56:57], v[40:41], v[40:41], s[52:53]
    v_pk_fma_f32 v[58:59], v[42:43], v[42:43], s[52:53]
    v_pk_fma_f32 v[60:61], v[44:45], v[44:45], s[52:53]
    v_pk_fma_f32 v[62:63], v[46:47], v[46:47], s[52:53]
    v_pk_mul_f32 v[48:49], v[48:49], v[32:33] neg_lo:[1,0] neg_hi:[1,0]
    v_pk_mul_f32 v[50:51], v[50:51], v[34:35] neg_lo:[1,0] neg_hi:[1,0]
    v_pk_mul_f32 v[52:53], v[52:53], v[36:37] neg_lo:[1,0] neg_hi:[1,0]
    v_pk_mul_f32 v[54:55], v[54:55], v[38:39] neg_lo:[1,0] neg_hi:[1,0]
    v_pk_mul_f32 v[56:57], v[56:57], v[40:41] neg_lo:[1,0] neg_hi:[1,0]
    v_pk_mul_f32 v[58:59], v[58:59], v[42:43] neg_lo:[1,0] neg_hi:[1,0]
    v_pk_mul_f32 v[60:61], v[60:61], v[44:45] neg_lo:[1,0] neg_hi:[1,0]
    v_pk_mul_f32 v[62:63], v[62:63], v[46:47] neg_lo:[1,0] neg_hi:[1,0]
    v_cvt_pk_bf16_f32 v64, v16, v17
    v_cvt_pk_bf16_f32 v65, v18, v19
    v_cvt_pk_bf16_f32 v66, v20, v21
    v_cvt_pk_bf16_f32 v67, v22, v23
    v_cvt_pk_bf16_f32 v68, v24, v25
    v_cvt_pk_bf16_f32 v69, v26, v27
    v_cvt_pk_bf16_f32 v70, v28, v29
    v_cvt_pk_bf16_f32 v71, v30, v31
    v_mfma_f32_32x32x16_bf16 v[144:159], v[64:67], a[24:27], 0
    v_exp_f32 v48, v48
    v_exp_f32 v49, v49
    v_exp_f32 v50, v50
    v_mfma_f32_32x32x16_bf16 v[144:159], v[68:71], a[28:31], v[144:159]
    v_exp_f32 v51, v51
    v_exp_f32 v52, v52
    v_exp_f32 v53, v53
    v_mfma_f32_32x32x16_bf16 v[16:31], a[176:179], v[72:75], 0
    v_exp_f32 v54, v54
    v_exp_f32 v55, v55
    v_exp_f32 v56, v56
    v_mfma_f32_32x32x16_bf16 v[16:31], a[180:183], v[76:79], v[16:31]
    v_exp_f32 v57, v57
    v_exp_f32 v58, v58
    v_exp_f32 v59, v59
    v_exp_f32 v60, v60
    v_exp_f32 v61, v61
    v_exp_f32 v62, v62
    v_exp_f32 v63, v63
    v_accvgpr_write_b32 a128, v64
    v_accvgpr_write_b32 a129, v65
    v_accvgpr_write_b32 a130, v66
    v_accvgpr_write_b32 a131, v67
    v_accvgpr_write_b32 a132, v68
    v_accvgpr_write_b32 a133, v69
    v_accvgpr_write_b32 a134, v70
    v_accvgpr_write_b32 a135, v71
    v_pk_add_f32 v[48:49], v[48:49], 1.0 op_sel_hi:[1,0]
    v_pk_add_f32 v[50:51], v[50:51], 1.0 op_sel_hi:[1,0]
    v_pk_add_f32 v[52:53], v[52:53], 1.0 op_sel_hi:[1,0]
    v_pk_add_f32 v[54:55], v[54:55], 1.0 op_sel_hi:[1,0]
    v_pk_add_f32 v[56:57], v[56:57], 1.0 op_sel_hi:[1,0]
    v_pk_add_f32 v[58:59], v[58:59], 1.0 op_sel_hi:[1,0]
    v_pk_add_f32 v[60:61], v[60:61], 1.0 op_sel_hi:[1,0]
    v_pk_add_f32 v[62:63], v[62:63], 1.0 op_sel_hi:[1,0]
    v_pk_fma_f32 v[104:105], v[144:145], v[144:145], v[104:105]
    v_pk_fma_f32 v[104:105], v[146:147], v[146:147], v[104:105]
    v_pk_fma_f32 v[104:105], v[148:149], v[148:149], v[104:105]
    v_pk_fma_f32 v[104:105], v[150:151], v[150:151], v[104:105]
    v_pk_fma_f32 v[104:105], v[152:153], v[152:153], v[104:105]
    v_pk_fma_f32 v[104:105], v[154:155], v[154:155], v[104:105]
    v_pk_fma_f32 v[104:105], v[156:157], v[156:157], v[104:105]
    v_pk_fma_f32 v[104:105], v[158:159], v[158:159], v[104:105]
    v_mfma_f32_32x32x16_bf16 v[16:31], a[184:187], v[80:83], v[16:31]
    v_rcp_f32 v48, v48
    v_rcp_f32 v49, v49
    v_rcp_f32 v50, v50
    v_mfma_f32_32x32x16_bf16 v[16:31], a[188:191], v[84:87], v[16:31]
    v_rcp_f32 v51, v51
    v_rcp_f32 v52, v52
    v_rcp_f32 v53, v53
    v_mfma_f32_32x32x16_bf16 v[16:31], a[192:195], v[88:91], v[16:31]
    v_rcp_f32 v54, v54
    v_rcp_f32 v55, v55
    v_rcp_f32 v56, v56
    v_mfma_f32_32x32x16_bf16 v[16:31], a[196:199], v[92:95], v[16:31]
    v_rcp_f32 v57, v57
    v_rcp_f32 v58, v58
    v_rcp_f32 v59, v59
    v_rcp_f32 v60, v60
    v_rcp_f32 v61, v61
    v_rcp_f32 v62, v62
    v_rcp_f32 v63, v63
    v_pk_mul_f32 v[32:33], v[32:33], v[48:49]
    v_pk_mul_f32 v[34:35], v[34:35], v[50:51]
    v_pk_mul_f32 v[36:37], v[36:37], v[52:53]
    v_pk_mul_f32 v[38:39], v[38:39], v[54:55]
    v_pk_mul_f32 v[40:41], v[40:41], v[56:57]
    v_pk_mul_f32 v[42:43], v[42:43], v[58:59]
    v_pk_mul_f32 v[44:45], v[44:45], v[60:61]
    v_pk_mul_f32 v[46:47], v[46:47], v[62:63]
    v_pk_fma_f32 v[48:49], v[16:17], v[16:17], s[52:53]
    v_pk_fma_f32 v[50:51], v[18:19], v[18:19], s[52:53]
    v_pk_fma_f32 v[52:53], v[20:21], v[20:21], s[52:53]
    v_pk_fma_f32 v[54:55], v[22:23], v[22:23], s[52:53]
    v_pk_fma_f32 v[56:57], v[24:25], v[24:25], s[52:53]
    v_pk_fma_f32 v[58:59], v[26:27], v[26:27], s[52:53]
    v_pk_fma_f32 v[60:61], v[28:29], v[28:29], s[52:53]
    v_pk_fma_f32 v[62:63], v[30:31], v[30:31], s[52:53]
    v_pk_mul_f32 v[48:49], v[48:49], v[16:17] neg_lo:[1,0] neg_hi:[1,0]
    v_pk_mul_f32 v[50:51], v[50:51], v[18:19] neg_lo:[1,0] neg_hi:[1,0]
    v_pk_mul_f32 v[52:53], v[52:53], v[20:21] neg_lo:[1,0] neg_hi:[1,0]
    v_pk_mul_f32 v[54:55], v[54:55], v[22:23] neg_lo:[1,0] neg_hi:[1,0]
    v_pk_mul_f32 v[56:57], v[56:57], v[24:25] neg_lo:[1,0] neg_hi:[1,0]
    v_pk_mul_f32 v[58:59], v[58:59], v[26:27] neg_lo:[1,0] neg_hi:[1,0]
    v_pk_mul_f32 v[60:61], v[60:61], v[28:29] neg_lo:[1,0] neg_hi:[1,0]
    v_pk_mul_f32 v[62:63], v[62:63], v[30:31] neg_lo:[1,0] neg_hi:[1,0]
    v_cvt_pk_bf16_f32 v64, v32, v33
    v_cvt_pk_bf16_f32 v65, v34, v35
    v_cvt_pk_bf16_f32 v66, v36, v37
    v_cvt_pk_bf16_f32 v67, v38, v39
    v_cvt_pk_bf16_f32 v68, v40, v41
    v_cvt_pk_bf16_f32 v69, v42, v43
    v_cvt_pk_bf16_f32 v70, v44, v45
    v_cvt_pk_bf16_f32 v71, v46, v47
    v_mfma_f32_32x32x16_bf16 v[144:159], v[64:67], a[24:27], 0
    v_exp_f32 v48, v48
    v_exp_f32 v49, v49
    v_exp_f32 v50, v50
    v_mfma_f32_32x32x16_bf16 v[144:159], v[68:71], a[28:31], v[144:159]
    v_exp_f32 v51, v51
    v_exp_f32 v52, v52
    v_exp_f32 v53, v53
    v_mfma_f32_32x32x16_bf16 v[32:47], a[200:203], v[72:75], 0
    v_exp_f32 v54, v54
    v_exp_f32 v55, v55
    v_exp_f32 v56, v56
    v_mfma_f32_32x32x16_bf16 v[32:47], a[204:207], v[76:79], v[32:47]
    v_exp_f32 v57, v57
    v_exp_f32 v58, v58
    v_exp_f32 v59, v59
    v_exp_f32 v60, v60
    v_exp_f32 v61, v61
    v_exp_f32 v62, v62
    v_exp_f32 v63, v63
    v_accvgpr_write_b32 a136, v64
    v_accvgpr_write_b32 a137, v65
    v_accvgpr_write_b32 a138, v66
    v_accvgpr_write_b32 a139, v67
    v_accvgpr_write_b32 a140, v68
    v_accvgpr_write_b32 a141, v69
    v_accvgpr_write_b32 a142, v70
    v_accvgpr_write_b32 a143, v71
    v_pk_add_f32 v[48:49], v[48:49], 1.0 op_sel_hi:[1,0]
    v_pk_add_f32 v[50:51], v[50:51], 1.0 op_sel_hi:[1,0]
    v_pk_add_f32 v[52:53], v[52:53], 1.0 op_sel_hi:[1,0]
    v_pk_add_f32 v[54:55], v[54:55], 1.0 op_sel_hi:[1,0]
    v_pk_add_f32 v[56:57], v[56:57], 1.0 op_sel_hi:[1,0]
    v_pk_add_f32 v[58:59], v[58:59], 1.0 op_sel_hi:[1,0]
    v_pk_add_f32 v[60:61], v[60:61], 1.0 op_sel_hi:[1,0]
    v_pk_add_f32 v[62:63], v[62:63], 1.0 op_sel_hi:[1,0]
    v_pk_fma_f32 v[106:107], v[144:145], v[144:145], v[106:107]
    v_pk_fma_f32 v[106:107], v[146:147], v[146:147], v[106:107]
    v_pk_fma_f32 v[106:107], v[148:149], v[148:149], v[106:107]
    v_pk_fma_f32 v[106:107], v[150:151], v[150:151], v[106:107]
    v_pk_fma_f32 v[106:107], v[152:153], v[152:153], v[106:107]
    v_pk_fma_f32 v[106:107], v[154:155], v[154:155], v[106:107]
    v_pk_fma_f32 v[106:107], v[156:157], v[156:157], v[106:107]
    v_pk_fma_f32 v[106:107], v[158:159], v[158:159], v[106:107]
    v_mfma_f32_32x32x16_bf16 v[32:47], a[208:211], v[80:83], v[32:47]
    v_rcp_f32 v48, v48
    v_rcp_f32 v49, v49
    v_rcp_f32 v50, v50
    v_mfma_f32_32x32x16_bf16 v[32:47], a[212:215], v[84:87], v[32:47]
    v_rcp_f32 v51, v51
    v_rcp_f32 v52, v52
    v_rcp_f32 v53, v53
    v_mfma_f32_32x32x16_bf16 v[32:47], a[216:219], v[88:91], v[32:47]
    v_rcp_f32 v54, v54
    v_rcp_f32 v55, v55
    v_rcp_f32 v56, v56
    v_mfma_f32_32x32x16_bf16 v[32:47], a[220:223], v[92:95], v[32:47]
    v_rcp_f32 v57, v57
    v_rcp_f32 v58, v58
    v_rcp_f32 v59, v59
    v_rcp_f32 v60, v60
    v_rcp_f32 v61, v61
    v_rcp_f32 v62, v62
    v_rcp_f32 v63, v63
    v_pk_mul_f32 v[16:17], v[16:17], v[48:49]
    v_pk_mul_f32 v[18:19], v[18:19], v[50:51]
    v_pk_mul_f32 v[20:21], v[20:21], v[52:53]
    v_pk_mul_f32 v[22:23], v[22:23], v[54:55]
    v_pk_mul_f32 v[24:25], v[24:25], v[56:57]
    v_pk_mul_f32 v[26:27], v[26:27], v[58:59]
    v_pk_mul_f32 v[28:29], v[28:29], v[60:61]
    v_pk_mul_f32 v[30:31], v[30:31], v[62:63]
    v_pk_fma_f32 v[48:49], v[32:33], v[32:33], s[52:53]
    v_pk_fma_f32 v[50:51], v[34:35], v[34:35], s[52:53]
    v_pk_fma_f32 v[52:53], v[36:37], v[36:37], s[52:53]
    v_pk_fma_f32 v[54:55], v[38:39], v[38:39], s[52:53]
    v_pk_fma_f32 v[56:57], v[40:41], v[40:41], s[52:53]
    v_pk_fma_f32 v[58:59], v[42:43], v[42:43], s[52:53]
    v_pk_fma_f32 v[60:61], v[44:45], v[44:45], s[52:53]
    v_pk_fma_f32 v[62:63], v[46:47], v[46:47], s[52:53]
    v_pk_mul_f32 v[48:49], v[48:49], v[32:33] neg_lo:[1,0] neg_hi:[1,0]
    v_pk_mul_f32 v[50:51], v[50:51], v[34:35] neg_lo:[1,0] neg_hi:[1,0]
    v_pk_mul_f32 v[52:53], v[52:53], v[36:37] neg_lo:[1,0] neg_hi:[1,0]
    v_pk_mul_f32 v[54:55], v[54:55], v[38:39] neg_lo:[1,0] neg_hi:[1,0]
    v_pk_mul_f32 v[56:57], v[56:57], v[40:41] neg_lo:[1,0] neg_hi:[1,0]
    v_pk_mul_f32 v[58:59], v[58:59], v[42:43] neg_lo:[1,0] neg_hi:[1,0]
    v_pk_mul_f32 v[60:61], v[60:61], v[44:45] neg_lo:[1,0] neg_hi:[1,0]
    v_pk_mul_f32 v[62:63], v[62:63], v[46:47] neg_lo:[1,0] neg_hi:[1,0]
    v_cvt_pk_bf16_f32 v64, v16, v17
    v_cvt_pk_bf16_f32 v65, v18, v19
    v_cvt_pk_bf16_f32 v66, v20, v21
    v_cvt_pk_bf16_f32 v67, v22, v23
    v_cvt_pk_bf16_f32 v68, v24, v25
    v_cvt_pk_bf16_f32 v69, v26, v27
    v_cvt_pk_bf16_f32 v70, v28, v29
    v_cvt_pk_bf16_f32 v71, v30, v31
    v_mfma_f32_32x32x16_bf16 v[144:159], v[64:67], a[24:27], 0
    v_exp_f32 v48, v48
    v_exp_f32 v49, v49
    v_exp_f32 v50, v50
    v_mfma_f32_32x32x16_bf16 v[144:159], v[68:71], a[28:31], v[144:159]
    v_exp_f32 v51, v51
    v_exp_f32 v52, v52
    v_exp_f32 v53, v53
    v_mfma_f32_32x32x16_bf16 v[16:31], v[160:163], v[72:75], 0
    v_exp_f32 v54, v54
    v_exp_f32 v55, v55
    v_exp_f32 v56, v56
    v_mfma_f32_32x32x16_bf16 v[16:31], v[164:167], v[76:79], v[16:31]
    v_exp_f32 v57, v57
    v_exp_f32 v58, v58
    v_exp_f32 v59, v59
    v_exp_f32 v60, v60
    v_exp_f32 v61, v61
    v_exp_f32 v62, v62
    v_exp_f32 v63, v63
    v_accvgpr_write_b32 a144, v64
    v_accvgpr_write_b32 a145, v65
    v_accvgpr_write_b32 a146, v66
    v_accvgpr_write_b32 a147, v67
    v_accvgpr_write_b32 a148, v68
    v_accvgpr_write_b32 a149, v69
    v_accvgpr_write_b32 a150, v70
    v_accvgpr_write_b32 a151, v71
    v_pk_add_f32 v[48:49], v[48:49], 1.0 op_sel_hi:[1,0]
    v_pk_add_f32 v[50:51], v[50:51], 1.0 op_sel_hi:[1,0]
    v_pk_add_f32 v[52:53], v[52:53], 1.0 op_sel_hi:[1,0]
    v_pk_add_f32 v[54:55], v[54:55], 1.0 op_sel_hi:[1,0]
    v_pk_add_f32 v[56:57], v[56:57], 1.0 op_sel_hi:[1,0]
    v_pk_add_f32 v[58:59], v[58:59], 1.0 op_sel_hi:[1,0]
    v_pk_add_f32 v[60:61], v[60:61], 1.0 op_sel_hi:[1,0]
    v_pk_add_f32 v[62:63], v[62:63], 1.0 op_sel_hi:[1,0]
    v_pk_fma_f32 v[108:109], v[144:145], v[144:145], v[108:109]
    v_pk_fma_f32 v[108:109], v[146:147], v[146:147], v[108:109]
    v_pk_fma_f32 v[108:109], v[148:149], v[148:149], v[108:109]
    v_pk_fma_f32 v[108:109], v[150:151], v[150:151], v[108:109]
    v_pk_fma_f32 v[108:109], v[152:153], v[152:153], v[108:109]
    v_pk_fma_f32 v[108:109], v[154:155], v[154:155], v[108:109]
    v_pk_fma_f32 v[108:109], v[156:157], v[156:157], v[108:109]
    v_pk_fma_f32 v[108:109], v[158:159], v[158:159], v[108:109]
    v_mfma_f32_32x32x16_bf16 v[16:31], v[168:171], v[80:83], v[16:31]
    v_rcp_f32 v48, v48
    v_rcp_f32 v49, v49
    v_rcp_f32 v50, v50
    v_mfma_f32_32x32x16_bf16 v[16:31], v[172:175], v[84:87], v[16:31]
    v_rcp_f32 v51, v51
    v_rcp_f32 v52, v52
    v_rcp_f32 v53, v53
    v_mfma_f32_32x32x16_bf16 v[16:31], v[176:179], v[88:91], v[16:31]
    v_rcp_f32 v54, v54
    v_rcp_f32 v55, v55
    v_rcp_f32 v56, v56
    v_mfma_f32_32x32x16_bf16 v[16:31], v[180:183], v[92:95], v[16:31]
    v_rcp_f32 v57, v57
    v_rcp_f32 v58, v58
    v_rcp_f32 v59, v59
    v_rcp_f32 v60, v60
    v_rcp_f32 v61, v61
    v_rcp_f32 v62, v62
    v_rcp_f32 v63, v63
    v_pk_mul_f32 v[32:33], v[32:33], v[48:49]
    v_pk_mul_f32 v[34:35], v[34:35], v[50:51]
    v_pk_mul_f32 v[36:37], v[36:37], v[52:53]
    v_pk_mul_f32 v[38:39], v[38:39], v[54:55]
    v_pk_mul_f32 v[40:41], v[40:41], v[56:57]
    v_pk_mul_f32 v[42:43], v[42:43], v[58:59]
    v_pk_mul_f32 v[44:45], v[44:45], v[60:61]
    v_pk_mul_f32 v[46:47], v[46:47], v[62:63]
    v_pk_fma_f32 v[48:49], v[16:17], v[16:17], s[52:53]
    v_pk_fma_f32 v[50:51], v[18:19], v[18:19], s[52:53]
    v_pk_fma_f32 v[52:53], v[20:21], v[20:21], s[52:53]
    v_pk_fma_f32 v[54:55], v[22:23], v[22:23], s[52:53]
    v_pk_fma_f32 v[56:57], v[24:25], v[24:25], s[52:53]
    v_pk_fma_f32 v[58:59], v[26:27], v[26:27], s[52:53]
    v_pk_fma_f32 v[60:61], v[28:29], v[28:29], s[52:53]
    v_pk_fma_f32 v[62:63], v[30:31], v[30:31], s[52:53]
    v_pk_mul_f32 v[48:49], v[48:49], v[16:17] neg_lo:[1,0] neg_hi:[1,0]
    v_pk_mul_f32 v[50:51], v[50:51], v[18:19] neg_lo:[1,0] neg_hi:[1,0]
    v_pk_mul_f32 v[52:53], v[52:53], v[20:21] neg_lo:[1,0] neg_hi:[1,0]
    v_pk_mul_f32 v[54:55], v[54:55], v[22:23] neg_lo:[1,0] neg_hi:[1,0]
    v_pk_mul_f32 v[56:57], v[56:57], v[24:25] neg_lo:[1,0] neg_hi:[1,0]
    v_pk_mul_f32 v[58:59], v[58:59], v[26:27] neg_lo:[1,0] neg_hi:[1,0]
    v_pk_mul_f32 v[60:61], v[60:61], v[28:29] neg_lo:[1,0] neg_hi:[1,0]
    v_pk_mul_f32 v[62:63], v[62:63], v[30:31] neg_lo:[1,0] neg_hi:[1,0]
    v_cvt_pk_bf16_f32 v64, v32, v33
    v_cvt_pk_bf16_f32 v65, v34, v35
    v_cvt_pk_bf16_f32 v66, v36, v37
    v_cvt_pk_bf16_f32 v67, v38, v39
    v_cvt_pk_bf16_f32 v68, v40, v41
    v_cvt_pk_bf16_f32 v69, v42, v43
    v_cvt_pk_bf16_f32 v70, v44, v45
    v_cvt_pk_bf16_f32 v71, v46, v47
    v_mfma_f32_32x32x16_bf16 v[144:159], v[64:67], a[24:27], 0
    v_exp_f32 v48, v48
    v_exp_f32 v49, v49
    v_exp_f32 v50, v50
    v_mfma_f32_32x32x16_bf16 v[144:159], v[68:71], a[28:31], v[144:159]
    v_exp_f32 v51, v51
    v_exp_f32 v52, v52
    v_exp_f32 v53, v53
    v_mfma_f32_32x32x16_bf16 v[32:47], v[184:187], v[72:75], 0
    v_exp_f32 v54, v54
    v_exp_f32 v55, v55
    v_exp_f32 v56, v56
    v_mfma_f32_32x32x16_bf16 v[32:47], v[188:191], v[76:79], v[32:47]
    v_exp_f32 v57, v57
    v_exp_f32 v58, v58
    v_exp_f32 v59, v59
    v_exp_f32 v60, v60
    v_exp_f32 v61, v61
    v_exp_f32 v62, v62
    v_exp_f32 v63, v63
    v_accvgpr_write_b32 a152, v64
    v_accvgpr_write_b32 a153, v65
    v_accvgpr_write_b32 a154, v66
    v_accvgpr_write_b32 a155, v67
    v_accvgpr_write_b32 a156, v68
    v_accvgpr_write_b32 a157, v69
    v_accvgpr_write_b32 a158, v70
    v_accvgpr_write_b32 a159, v71
    v_pk_add_f32 v[48:49], v[48:49], 1.0 op_sel_hi:[1,0]
    v_pk_add_f32 v[50:51], v[50:51], 1.0 op_sel_hi:[1,0]
    v_pk_add_f32 v[52:53], v[52:53], 1.0 op_sel_hi:[1,0]
    v_pk_add_f32 v[54:55], v[54:55], 1.0 op_sel_hi:[1,0]
    v_pk_add_f32 v[56:57], v[56:57], 1.0 op_sel_hi:[1,0]
    v_pk_add_f32 v[58:59], v[58:59], 1.0 op_sel_hi:[1,0]
    v_pk_add_f32 v[60:61], v[60:61], 1.0 op_sel_hi:[1,0]
    v_pk_add_f32 v[62:63], v[62:63], 1.0 op_sel_hi:[1,0]
    v_pk_fma_f32 v[110:111], v[144:145], v[144:145], v[110:111]
    v_pk_fma_f32 v[110:111], v[146:147], v[146:147], v[110:111]
    v_pk_fma_f32 v[110:111], v[148:149], v[148:149], v[110:111]
    v_pk_fma_f32 v[110:111], v[150:151], v[150:151], v[110:111]
    v_pk_fma_f32 v[110:111], v[152:153], v[152:153], v[110:111]
    v_pk_fma_f32 v[110:111], v[154:155], v[154:155], v[110:111]
    v_pk_fma_f32 v[110:111], v[156:157], v[156:157], v[110:111]
    v_pk_fma_f32 v[110:111], v[158:159], v[158:159], v[110:111]
L_pf9:
    v_mfma_f32_32x32x16_bf16 v[32:47], v[192:195], v[80:83], v[32:47]
    s_mov_b32 s63, L_pf9-L_pc+12288
    buffer_load_dword v6, v7, s[68:71], s63 offen
    v_rcp_f32 v48, v48
    v_rcp_f32 v49, v49
    v_rcp_f32 v50, v50
    v_mfma_f32_32x32x16_bf16 v[32:47], v[196:199], v[84:87], v[32:47]
    v_rcp_f32 v51, v51
    v_rcp_f32 v52, v52
    v_rcp_f32 v53, v53
    v_mfma_f32_32x32x16_bf16 v[32:47], v[200:203], v[88:91], v[32:47]
    v_rcp_f32 v54, v54
    v_rcp_f32 v55, v55
    v_rcp_f32 v56, v56
    v_mfma_f32_32x32x16_bf16 v[32:47], v[204:207], v[92:95], v[32:47]
    v_rcp_f32 v57, v57
    v_rcp_f32 v58, v58
    v_rcp_f32 v59, v59
    v_rcp_f32 v60, v60
    v_rcp_f32 v61, v61
    v_rcp_f32 v62, v62
    v_rcp_f32 v63, v63
    v_pk_mul_f32 v[16:17], v[16:17], v[48:49]
    v_pk_mul_f32 v[18:19], v[18:19], v[50:51]
    v_pk_mul_f32 v[20:21], v[20:21], v[52:53]
    v_pk_mul_f32 v[22:23], v[22:23], v[54:55]
    v_pk_mul_f32 v[24:25], v[24:25], v[56:57]
    v_pk_mul_f32 v[26:27], v[26:27], v[58:59]
    v_pk_mul_f32 v[28:29], v[28:29], v[60:61]
    v_pk_mul_f32 v[30:31], v[30:31], v[62:63]
    v_pk_fma_f32 v[48:49], v[32:33], v[32:33], s[52:53]
    v_pk_fma_f32 v[50:51], v[34:35], v[34:35], s[52:53]
    v_pk_fma_f32 v[52:53], v[36:37], v[36:37], s[52:53]
    v_pk_fma_f32 v[54:55], v[38:39], v[38:39], s[52:53]
    v_pk_fma_f32 v[56:57], v[40:41], v[40:41], s[52:53]
    v_pk_fma_f32 v[58:59], v[42:43], v[42:43], s[52:53]
    v_pk_fma_f32 v[60:61], v[44:45], v[44:45], s[52:53]
    v_pk_fma_f32 v[62:63], v[46:47], v[46:47], s[52:53]
    v_pk_mul_f32 v[48:49], v[48:49], v[32:33] neg_lo:[1,0] neg_hi:[1,0]
    v_pk_mul_f32 v[50:51], v[50:51], v[34:35] neg_lo:[1,0] neg_hi:[1,0]
    v_pk_mul_f32 v[52:53], v[52:53], v[36:37] neg_lo:[1,0] neg_hi:[1,0]
    v_pk_mul_f32 v[54:55], v[54:55], v[38:39] neg_lo:[1,0] neg_hi:[1,0]
    v_pk_mul_f32 v[56:57], v[56:57], v[40:41] neg_lo:[1,0] neg_hi:[1,0]
    v_pk_mul_f32 v[58:59], v[58:59], v[42:43] neg_lo:[1,0] neg_hi:[1,0]
    v_pk_mul_f32 v[60:61], v[60:61], v[44:45] neg_lo:[1,0] neg_hi:[1,0]
    v_pk_mul_f32 v[62:63], v[62:63], v[46:47] neg_lo:[1,0] neg_hi:[1,0]
    v_cvt_pk_bf16_f32 v64, v16, v17
    v_cvt_pk_bf16_f32 v65, v18, v19
    v_cvt_pk_bf16_f32 v66, v20, v21
    v_cvt_pk_bf16_f32 v67, v22, v23
    v_cvt_pk_bf16_f32 v68, v24, v25
    v_cvt_pk_bf16_f32 v69, v26, v27
    v_cvt_pk_bf16_f32 v70, v28, v29
    v_cvt_pk_bf16_f32 v71, v30, v31
    v_mfma_f32_32x32x16_bf16 v[144:159], v[64:67], a[24:27], 0
    v_exp_f32 v48, v48
    v_exp_f32 v49, v49
    v_exp_f32 v50, v50
    v_mfma_f32_32x32x16_bf16 v[144:159], v[68:71], a[28:31], v[144:159]
    v_exp_f32 v51, v51
    v_exp_f32 v52, v52
    v_exp_f32 v53, v53
    v_mfma_f32_32x32x16_bf16 v[16:31], v[208:211], v[72:75], 0
    v_exp_f32 v54, v54
    v_exp_f32 v55, v55
    v_exp_f32 v56, v56
    v_mfma_f32_32x32x16_bf16 v[16:31], v[212:215], v[76:79], v[16:31]
    v_exp_f32 v57, v57
    v_exp_f32 v58, v58
    v_exp_f32 v59, v59
    v_exp_f32 v60, v60
    v_exp_f32 v61, v61
    v_exp_f32 v62, v62
    v_exp_f32 v63, v63
    v_accvgpr_write_b32 a160, v64
    v_accvgpr_write_b32 a161, v65
    v_accvgpr_write_b32 a162, v66
    v_accvgpr_write_b32 a163, v67
    v_accvgpr_write_b32 a164, v68
    v_accvgpr_write_b32 a165, v69
    v_accvgpr_write_b32 a166, v70
    v_accvgpr_write_b32 a167, v71
    v_pk_add_f32 v[48:49], v[48:49], 1.0 op_sel_hi:[1,0]
    v_pk_add_f32 v[50:51], v[50:51], 1.0 op_sel_hi:[1,0]
    v_pk_add_f32 v[52:53], v[52:53], 1.0 op_sel_hi:[1,0]
    v_pk_add_f32 v[54:55], v[54:55], 1.0 op_sel_hi:[1,0]
    v_pk_add_f32 v[56:57], v[56:57], 1.0 op_sel_hi:[1,0]
    v_pk_add_f32 v[58:59], v[58:59], 1.0 op_sel_hi:[1,0]
    v_pk_add_f32 v[60:61], v[60:61], 1.0 op_sel_hi:[1,0]
    v_pk_add_f32 v[62:63], v[62:63], 1.0 op_sel_hi:[1,0]
    v_pk_fma_f32 v[112:113], v[144:145], v[144:145], v[112:113]
    v_pk_fma_f32 v[112:113], v[146:147], v[146:147], v[112:113]
    v_pk_fma_f32 v[112:113], v[148:149], v[148:149], v[112:113]
    v_pk_fma_f32 v[112:113], v[150:151], v[150:151], v[112:113]
    v_pk_fma_f32 v[112:113], v[152:153], v[152:153], v[112:113]
    v_pk_fma_f32 v[112:113], v[154:155], v[154:155], v[112:113]
    v_pk_fma_f32 v[112:113], v[156:157], v[156:157], v[112:113]
    v_pk_fma_f32 v[112:113], v[158:159], v[158:159], v[112:113]
    v_mfma_f32_32x32x16_bf16 v[16:31], v[216:219], v[80:83], v[16:31]
    v_rcp_f32 v48, v48
    v_rcp_f32 v49, v49
    v_rcp_f32 v50, v50
    v_mfma_f32_32x32x16_bf16 v[16:31], v[220:223], v[84:87], v[16:31]
    v_rcp_f32 v51, v51
    v_rcp_f32 v52, v52
    v_rcp_f32 v53, v53
    v_mfma_f32_32x32x16_bf16 v[16:31], v[224:227], v[88:91], v[16:31]
    v_rcp_f32 v54, v54
    v_rcp_f32 v55, v55
    v_rcp_f32 v56, v56
    v_mfma_f32_32x32x16_bf16 v[16:31], v[228:231], v[92:95], v[16:31]
    v_rcp_f32 v57, v57
    v_rcp_f32 v58, v58
    v_rcp_f32 v59, v59
    v_rcp_f32 v60, v60
    v_rcp_f32 v61, v61
    v_rcp_f32 v62, v62
    v_rcp_f32 v63, v63
    v_pk_mul_f32 v[32:33], v[32:33], v[48:49]
    v_pk_mul_f32 v[34:35], v[34:35], v[50:51]
    v_pk_mul_f32 v[36:37], v[36:37], v[52:53]
    v_pk_mul_f32 v[38:39], v[38:39], v[54:55]
    v_pk_mul_f32 v[40:41], v[40:41], v[56:57]
    v_pk_mul_f32 v[42:43], v[42:43], v[58:59]
    v_pk_mul_f32 v[44:45], v[44:45], v[60:61]
    v_pk_mul_f32 v[46:47], v[46:47], v[62:63]
    v_pk_fma_f32 v[48:49], v[16:17], v[16:17], s[52:53]
    v_pk_fma_f32 v[50:51], v[18:19], v[18:19], s[52:53]
    v_pk_fma_f32 v[52:53], v[20:21], v[20:21], s[52:53]
    v_pk_fma_f32 v[54:55], v[22:23], v[22:23], s[52:53]
    v_pk_fma_f32 v[56:57], v[24:25], v[24:25], s[52:53]
    v_pk_fma_f32 v[58:59], v[26:27], v[26:27], s[52:53]
    v_pk_fma_f32 v[60:61], v[28:29], v[28:29], s[52:53]
    v_pk_fma_f32 v[62:63], v[30:31], v[30:31], s[52:53]
    v_pk_mul_f32 v[48:49], v[48:49], v[16:17] neg_lo:[1,0] neg_hi:[1,0]
    v_pk_mul_f32 v[50:51], v[50:51], v[18:19] neg_lo:[1,0] neg_hi:[1,0]
    v_pk_mul_f32 v[52:53], v[52:53], v[20:21] neg_lo:[1,0] neg_hi:[1,0]
    v_pk_mul_f32 v[54:55], v[54:55], v[22:23] neg_lo:[1,0] neg_hi:[1,0]
    v_pk_mul_f32 v[56:57], v[56:57], v[24:25] neg_lo:[1,0] neg_hi:[1,0]
    v_pk_mul_f32 v[58:59], v[58:59], v[26:27] neg_lo:[1,0] neg_hi:[1,0]
    v_pk_mul_f32 v[60:61], v[60:61], v[28:29] neg_lo:[1,0] neg_hi:[1,0]
    v_pk_mul_f32 v[62:63], v[62:63], v[30:31] neg_lo:[1,0] neg_hi:[1,0]
    v_cvt_pk_bf16_f32 v64, v32, v33
    v_cvt_pk_bf16_f32 v65, v34, v35
    v_cvt_pk_bf16_f32 v66, v36, v37
    v_cvt_pk_bf16_f32 v67, v38, v39
    v_cvt_pk_bf16_f32 v68, v40, v41
    v_cvt_pk_bf16_f32 v69, v42, v43
    v_cvt_pk_bf16_f32 v70, v44, v45
    v_cvt_pk_bf16_f32 v71, v46, v47
    v_mfma_f32_32x32x16_bf16 v[144:159], v[64:67], a[24:27], 0
    v_exp_f32 v48, v48
    v_exp_f32 v49, v49
    v_exp_f32 v50, v50
    v_mfma_f32_32x32x16_bf16 v[144:159], v[68:71], a[28:31], v[144:159]
    v_exp_f32 v51, v51
    v_exp_f32 v52, v52
    v_exp_f32 v53, v53
    v_mfma_f32_32x32x16_bf16 v[32:47], v[232:235], v[72:75], 0
    v_exp_f32 v54, v54
    v_exp_f32 v55, v55
    v_exp_f32 v56, v56
    v_mfma_f32_32x32x16_bf16 v[32:47], v[236:239], v[76:79], v[32:47]
    v_exp_f32 v57, v57
    v_exp_f32 v58, v58
    v_exp_f32 v59, v59
    v_exp_f32 v60, v60
    v_exp_f32 v61, v61
    v_exp_f32 v62, v62
    v_exp_f32 v63, v63
    v_accvgpr_write_b32 a168, v64
    v_accvgpr_write_b32 a169, v65
    v_accvgpr_write_b32 a170, v66
    v_accvgpr_write_b32 a171, v67
    v_accvgpr_write_b32 a172, v68
    v_accvgpr_write_b32 a173, v69
    v_accvgpr_write_b32 a174, v70
    v_accvgpr_write_b32 a175, v71
    v_pk_add_f32 v[48:49], v[48:49], 1.0 op_sel_hi:[1,0]
    v_pk_add_f32 v[50:51], v[50:51], 1.0 op_sel_hi:[1,0]
    v_pk_add_f32 v[52:53], v[52:53], 1.0 op_sel_hi:[1,0]
    v_pk_add_f32 v[54:55], v[54:55], 1.0 op_sel_hi:[1,0]
    v_pk_add_f32 v[56:57], v[56:57], 1.0 op_sel_hi:[1,0]
    v_pk_add_f32 v[58:59], v[58:59], 1.0 op_sel_hi:[1,0]
    v_pk_add_f32 v[60:61], v[60:61], 1.0 op_sel_hi:[1,0]
    v_pk_add_f32 v[62:63], v[62:63], 1.0 op_sel_hi:[1,0]
    v_pk_fma_f32 v[114:115], v[144:145], v[144:145], v[114:115]
    v_pk_fma_f32 v[114:115], v[146:147], v[146:147], v[114:115]
    v_pk_fma_f32 v[114:115], v[148:149], v[148:149], v[114:115]
    v_pk_fma_f32 v[114:115], v[150:151], v[150:151], v[114:115]
    v_pk_fma_f32 v[114:115], v[152:153], v[152:153], v[114:115]
    v_pk_fma_f32 v[114:115], v[154:155], v[154:155], v[114:115]
    v_pk_fma_f32 v[114:115], v[156:157], v[156:157], v[114:115]
    v_pk_fma_f32 v[114:115], v[158:159], v[158:159], v[114:115]
    v_mfma_f32_32x32x16_bf16 v[32:47], v[240:243], v[80:83], v[32:47]
    v_rcp_f32 v48, v48
    v_rcp_f32 v49, v49
    v_rcp_f32 v50, v50
    v_mfma_f32_32x32x16_bf16 v[32:47], v[244:247], v[84:87], v[32:47]
    v_rcp_f32 v51, v51
    v_rcp_f32 v52, v52
    v_rcp_f32 v53, v53
    v_mfma_f32_32x32x16_bf16 v[32:47], v[248:251], v[88:91], v[32:47]
    v_rcp_f32 v54, v54
    v_rcp_f32 v55, v55
    v_rcp_f32 v56, v56
    v_mfma_f32_32x32x16_bf16 v[32:47], v[252:255], v[92:95], v[32:47]
    v_rcp_f32 v57, v57
    v_rcp_f32 v58, v58
    v_rcp_f32 v59, v59
    v_rcp_f32 v60, v60
    v_rcp_f32 v61, v61
    v_rcp_f32 v62, v62
    v_rcp_f32 v63, v63
    v_pk_mul_f32 v[16:17], v[16:17], v[48:49]
    v_pk_mul_f32 v[18:19], v[18:19], v[50:51]
    v_pk_mul_f32 v[20:21], v[20:21], v[52:53]
    v_pk_mul_f32 v[22:23], v[22:23], v[54:55]
    v_pk_mul_f32 v[24:25], v[24:25], v[56:57]
    v_pk_mul_f32 v[26:27], v[26:27], v[58:59]
    v_pk_mul_f32 v[28:29], v[28:29], v[60:61]
    v_pk_mul_f32 v[30:31], v[30:31], v[62:63]
    v_pk_fma_f32 v[48:49], v[32:33], v[32:33], s[52:53]
    v_pk_fma_f32 v[50:51], v[34:35], v[34:35], s[52:53]
    v_pk_fma_f32 v[52:53], v[36:37], v[36:37], s[52:53]
    v_pk_fma_f32 v[54:55], v[38:39], v[38:39], s[52:53]
    v_pk_fma_f32 v[56:57], v[40:41], v[40:41], s[52:53]
    v_pk_fma_f32 v[58:59], v[42:43], v[42:43], s[52:53]
    v_pk_fma_f32 v[60:61], v[44:45], v[44:45], s[52:53]
    v_pk_fma_f32 v[62:63], v[46:47], v[46:47], s[52:53]
    v_pk_mul_f32 v[48:49], v[48:49], v[32:33] neg_lo:[1,0] neg_hi:[1,0]
    v_pk_mul_f32 v[50:51], v[50:51], v[34:35] neg_lo:[1,0] neg_hi:[1,0]
    v_pk_mul_f32 v[52:53], v[52:53], v[36:37] neg_lo:[1,0] neg_hi:[1,0]
    v_pk_mul_f32 v[54:55], v[54:55], v[38:39] neg_lo:[1,0] neg_hi:[1,0]
    v_pk_mul_f32 v[56:57], v[56:57], v[40:41] neg_lo:[1,0] neg_hi:[1,0]
    v_pk_mul_f32 v[58:59], v[58:59], v[42:43] neg_lo:[1,0] neg_hi:[1,0]
    v_pk_mul_f32 v[60:61], v[60:61], v[44:45] neg_lo:[1,0] neg_hi:[1,0]
    v_pk_mul_f32 v[62:63], v[62:63], v[46:47] neg_lo:[1,0] neg_hi:[1,0]
    v_cvt_pk_bf16_f32 v64, v16, v17
    v_cvt_pk_bf16_f32 v65, v18, v19
    v_cvt_pk_bf16_f32 v66, v20, v21
    v_cvt_pk_bf16_f32 v67, v22, v23
    v_cvt_pk_bf16_f32 v68, v24, v25
    v_cvt_pk_bf16_f32 v69, v26, v27
    v_cvt_pk_bf16_f32 v70, v28, v29
    v_cvt_pk_bf16_f32 v71, v30, v31
    v_mfma_f32_32x32x16_bf16 v[144:159], v[64:67], a[24:27], 0
    v_exp_f32 v48, v48
    v_exp_f32 v49, v49
    v_exp_f32 v50, v50
    v_mfma_f32_32x32x16_bf16 v[144:159], v[68:71], a[28:31], v[144:159]
    v_exp_f32 v51, v51
    v_exp_f32 v52, v52
    v_exp_f32 v53, v53
    v_mfma_f32_32x32x16_bf16 v[16:31], a[0:3], v[72:75], 0
    ds_read_b128 a[20:23], v2 offset:5120
    ds_read_b128 a[0:3], v2 offset:6144
    v_exp_f32 v54, v54
    v_exp_f32 v55, v55
    v_mfma_f32_32x32x16_bf16 v[16:31], a[4:7], v[76:79], v[16:31]
    v_exp_f32 v56, v56
    v_exp_f32 v57, v57
    v_exp_f32 v58, v58
    v_exp_f32 v59, v59
    v_exp_f32 v60, v60
    v_exp_f32 v61, v61
    v_exp_f32 v62, v62
    v_exp_f32 v63, v63
    v_accvgpr_write_b32 a176, v64
    v_accvgpr_write_b32 a177, v65
    v_accvgpr_write_b32 a178, v66
    v_accvgpr_write_b32 a179, v67
    v_accvgpr_write_b32 a180, v68
    v_accvgpr_write_b32 a181, v69
    v_accvgpr_write_b32 a182, v70
    v_accvgpr_write_b32 a183, v71
    v_pk_add_f32 v[48:49], v[48:49], 1.0 op_sel_hi:[1,0]
    v_pk_add_f32 v[50:51], v[50:51], 1.0 op_sel_hi:[1,0]
    v_pk_add_f32 v[52:53], v[52:53], 1.0 op_sel_hi:[1,0]
    v_pk_add_f32 v[54:55], v[54:55], 1.0 op_sel_hi:[1,0]
    v_pk_add_f32 v[56:57], v[56:57], 1.0 op_sel_hi:[1,0]
    v_pk_add_f32 v[58:59], v[58:59], 1.0 op_sel_hi:[1,0]
    v_pk_add_f32 v[60:61], v[60:61], 1.0 op_sel_hi:[1,0]
    v_pk_add_f32 v[62:63], v[62:63], 1.0 op_sel_hi:[1,0]
    v_pk_fma_f32 v[116:117], v[144:145], v[144:145], v[116:117]
    v_pk_fma_f32 v[116:117], v[146:147], v[146:147], v[116:117]
    v_pk_fma_f32 v[116:117], v[148:149], v[148:149], v[116:117]
    v_pk_fma_f32 v[116:117], v[150:151], v[150:151], v[116:117]
    v_pk_fma_f32 v[116:117], v[152:153], v[152:153], v[116:117]
    v_pk_fma_f32 v[116:117], v[154:155], v[154:155], v[116:117]
    v_pk_fma_f32 v[116:117], v[156:157], v[156:157], v[116:117]
    v_pk_fma_f32 v[116:117], v[158:159], v[158:159], v[116:117]
    v_mfma_f32_32x32x16_bf16 v[16:31], a[8:11], v[80:83], v[16:31]
    ds_read_b128 a[4:7], v2 offset:7168
    ds_read_b128 a[8:11], v2 offset:8192
    v_rcp_f32 v48, v48
    v_rcp_f32 v49, v49
    v_mfma_f32_32x32x16_bf16 v[16:31], a[12:15], v[84:87], v[16:31]
    s_waitcnt vmcnt(1)
    v_rcp_f32 v50, v50
    v_rcp_f32 v51, v51
    v_rcp_f32 v52, v52
    v_mfma_f32_32x32x16_bf16 v[16:31], a[16:19], v[88:91], v[16:31]
    s_waitcnt lgkmcnt(3)
    ds_read_b128 a[12:15], v2 offset:9216
    ds_read_b128 a[16:19], v2 offset:10240
    v_rcp_f32 v53, v53
    v_rcp_f32 v54, v54
    v_mfma_f32_32x32x16_bf16 v[16:31], a[20:23], v[92:95], v[16:31]
    s_waitcnt lgkmcnt(4)
    v_rcp_f32 v55, v55
    v_rcp_f32 v56, v56
    v_rcp_f32 v57, v57
    v_rcp_f32 v58, v58
    v_rcp_f32 v59, v59
    v_rcp_f32 v60, v60
    v_rcp_f32 v61, v61
    v_rcp_f32 v62, v62
    v_rcp_f32_e64 v63, v63
    v_pk_mul_f32 v[32:33], v[32:33], v[48:49]
    v_pk_mul_f32 v[34:35], v[34:35], v[50:51]
    v_pk_mul_f32 v[36:37], v[36:37], v[52:53]
    v_pk_mul_f32 v[38:39], v[38:39], v[54:55]
    v_pk_mul_f32 v[40:41], v[40:41], v[56:57]
    v_pk_mul_f32 v[42:43], v[42:43], v[58:59]
    v_pk_mul_f32 v[44:45], v[44:45], v[60:61]
    v_pk_mul_f32 v[46:47], v[46:47], v[62:63]
    v_pk_fma_f32 v[48:49], v[16:17], v[16:17], s[52:53]
    v_pk_fma_f32 v[50:51], v[18:19], v[18:19], s[52:53]
    v_pk_fma_f32 v[52:53], v[20:21], v[20:21], s[52:53]
    v_pk_fma_f32 v[54:55], v[22:23], v[22:23], s[52:53]
    v_pk_fma_f32 v[56:57], v[24:25], v[24:25], s[52:53]
    v_pk_fma_f32 v[58:59], v[26:27], v[26:27], s[52:53]
    v_pk_fma_f32 v[60:61], v[28:29], v[28:29], s[52:53]
    v_pk_fma_f32 v[62:63], v[30:31], v[30:31], s[52:53]
    v_pk_mul_f32 v[48:49], v[48:49], v[16:17] neg_lo:[1,0] neg_hi:[1,0]
    v_pk_mul_f32 v[50:51], v[50:51], v[18:19] neg_lo:[1,0] neg_hi:[1,0]
    v_pk_mul_f32 v[52:53], v[52:53], v[20:21] neg_lo:[1,0] neg_hi:[1,0]
    v_pk_mul_f32 v[54:55], v[54:55], v[22:23] neg_lo:[1,0] neg_hi:[1,0]
    v_pk_mul_f32 v[56:57], v[56:57], v[24:25] neg_lo:[1,0] neg_hi:[1,0]
    v_pk_mul_f32 v[58:59], v[58:59], v[26:27] neg_lo:[1,0] neg_hi:[1,0]
    v_pk_mul_f32 v[60:61], v[60:61], v[28:29] neg_lo:[1,0] neg_hi:[1,0]
    v_pk_mul_f32 v[62:63], v[62:63], v[30:31] neg_lo:[1,0] neg_hi:[1,0]
    v_cvt_pk_bf16_f32 v64, v32, v33
    v_cvt_pk_bf16_f32 v65, v34, v35
    v_cvt_pk_bf16_f32 v66, v36, v37
    v_cvt_pk_bf16_f32 v67, v38, v39
    v_cvt_pk_bf16_f32 v68, v40, v41
    v_cvt_pk_bf16_f32 v69, v42, v43
    v_cvt_pk_bf16_f32 v70, v44, v45
    v_cvt_pk_bf16_f32 v71, v46, v47
    v_mfma_f32_32x32x16_bf16 v[32:47], v[64:67], a[24:27], 0
    v_exp_f32 v48, v48
    v_exp_f32 v49, v49
    v_exp_f32 v50, v50
    v_mfma_f32_32x32x16_bf16 v[32:47], v[68:71], a[28:31], v[32:47]
    v_exp_f32 v51, v51
    v_exp_f32 v52, v52
    v_exp_f32 v53, v53
    v_mfma_f32_32x32x16_bf16 v[144:159], v[120:123], a[224:227], 0
    v_exp_f32 v54, v54
    v_exp_f32 v55, v55
    v_exp_f32 v56, v56
    v_mfma_f32_32x32x16_bf16 v[144:159], v[124:127], a[228:231], v[144:159]
    v_exp_f32 v57, v57
    v_exp_f32 v58, v58
    v_exp_f32 v59, v59
    v_exp_f32 v60, v60
    v_exp_f32 v61, v61
    v_exp_f32 v62, v62
    v_exp_f32 v63, v63
    v_pk_add_f32 v[48:49], v[48:49], 1.0 op_sel_hi:[1,0]
    v_pk_add_f32 v[50:51], v[50:51], 1.0 op_sel_hi:[1,0]
    v_pk_add_f32 v[52:53], v[52:53], 1.0 op_sel_hi:[1,0]
    v_pk_add_f32 v[54:55], v[54:55], 1.0 op_sel_hi:[1,0]
    v_pk_add_f32 v[56:57], v[56:57], 1.0 op_sel_hi:[1,0]
    v_pk_add_f32 v[58:59], v[58:59], 1.0 op_sel_hi:[1,0]
    v_pk_add_f32 v[60:61], v[60:61], 1.0 op_sel_hi:[1,0]
    v_pk_add_f32 v[62:63], v[62:63], 1.0 op_sel_hi:[1,0]
    v_pk_fma_f32 v[118:119], v[32:33], v[32:33], v[118:119]
    v_pk_fma_f32 v[118:119], v[34:35], v[34:35], v[118:119]
    v_pk_fma_f32 v[118:119], v[36:37], v[36:37], v[118:119]
    v_pk_fma_f32 v[118:119], v[38:39], v[38:39], v[118:119]
    v_pk_fma_f32 v[118:119], v[40:41], v[40:41], v[118:119]
    v_pk_fma_f32 v[118:119], v[42:43], v[42:43], v[118:119]
    v_pk_fma_f32 v[118:119], v[44:45], v[44:45], v[118:119]
    v_pk_fma_f32 v[118:119], v[46:47], v[46:47], v[118:119]
    v_pk_mul_f32 v[10:11], v[144:145], v[144:145]
    v_pk_add_f32 v[8:9], v[144:145], v[146:147]
    v_pk_fma_f32 v[10:11], v[146:147], v[146:147], v[10:11]
    v_pk_add_f32 v[8:9], v[8:9], v[148:149]
    v_pk_fma_f32 v[10:11], v[148:149], v[148:149], v[10:11]
    v_pk_add_f32 v[8:9], v[8:9], v[150:151]
    v_pk_fma_f32 v[10:11], v[150:151], v[150:151], v[10:11]
    v_pk_add_f32 v[8:9], v[8:9], v[152:153]
    v_pk_fma_f32 v[10:11], v[152:153], v[152:153], v[10:11]
    v_pk_add_f32 v[8:9], v[8:9], v[154:155]
    v_pk_fma_f32 v[10:11], v[154:155], v[154:155], v[10:11]
    v_pk_add_f32 v[8:9], v[8:9], v[156:157]
    v_pk_fma_f32 v[10:11], v[156:157], v[156:157], v[10:11]
    v_pk_add_f32 v[8:9], v[8:9], v[158:159]
    v_pk_fma_f32 v[10:11], v[158:159], v[158:159], v[10:11]
    v_mfma_f32_32x32x16_bf16 v[32:47], a[0:3], v[72:75], 0
    s_waitcnt lgkmcnt(3)
    ds_read_b128 a[20:23], v2 offset:11264
    ds_read_b128 a[0:3], v2 offset:12288
    v_rcp_f32 v48, v48
    v_rcp_f32 v49, v49
    v_mfma_f32_32x32x16_bf16 v[32:47], a[4:7], v[76:79], v[32:47]
    s_waitcnt lgkmcnt(4)
    v_rcp_f32 v50, v50
    v_rcp_f32 v51, v51
    v_rcp_f32 v52, v52
    v_mfma_f32_32x32x16_bf16 v[32:47], a[8:11], v[80:83], v[32:47]
    s_waitcnt lgkmcnt(3)
    ds_read_b128 a[4:7], v2 offset:13312
    ds_read_b128 a[8:11], v2 offset:14336
    v_rcp_f32 v53, v53
    v_rcp_f32 v54, v54
    v_mfma_f32_32x32x16_bf16 v[32:47], a[12:15], v[84:87], v[32:47]
    s_waitcnt lgkmcnt(4)
    v_rcp_f32 v55, v55
    v_rcp_f32 v56, v56
    v_rcp_f32 v57, v57
    v_mfma_f32_32x32x16_bf16 v[32:47], a[16:19], v[88:91], v[32:47]
    s_waitcnt lgkmcnt(3)
    ds_read_b128 a[12:15], v2 offset:15360
    ds_read_b128 a[16:19], v2 offset:16384
    v_rcp_f32 v58, v58
    v_rcp_f32 v59, v59
    v_mfma_f32_32x32x16_bf16 v[32:47], a[20:23], v[92:95], v[32:47]
    s_waitcnt lgkmcnt(4)
    v_rcp_f32 v60, v60
    v_rcp_f32 v61, v61
    v_rcp_f32 v62, v62
    v_rcp_f32 v63, v63
    v_accvgpr_write_b32 a184, v64
    v_accvgpr_write_b32 a185, v65
    v_accvgpr_write_b32 a186, v66
    v_accvgpr_write_b32 a187, v67
    v_accvgpr_write_b32 a188, v68
    v_accvgpr_write_b32 a189, v69
    v_accvgpr_write_b32 a190, v70
    v_accvgpr_write_b32 a191, v71
    v_pk_mul_f32 v[16:17], v[16:17], v[48:49]
    v_pk_mul_f32 v[18:19], v[18:19], v[50:51]
    v_pk_mul_f32 v[20:21], v[20:21], v[52:53]
    v_pk_mul_f32 v[22:23], v[22:23], v[54:55]
    v_pk_mul_f32 v[24:25], v[24:25], v[56:57]
    v_pk_mul_f32 v[26:27], v[26:27], v[58:59]
    v_pk_mul_f32 v[28:29], v[28:29], v[60:61]
    v_pk_mul_f32 v[30:31], v[30:31], v[62:63]
    v_pk_fma_f32 v[48:49], v[32:33], v[32:33], s[52:53]
    v_pk_fma_f32 v[50:51], v[34:35], v[34:35], s[52:53]
    v_pk_fma_f32 v[52:53], v[36:37], v[36:37], s[52:53]
    v_pk_fma_f32 v[54:55], v[38:39], v[38:39], s[52:53]
    v_pk_fma_f32 v[56:57], v[40:41], v[40:41], s[52:53]
    v_pk_fma_f32 v[58:59], v[42:43], v[42:43], s[52:53]
    v_pk_fma_f32 v[60:61], v[44:45], v[44:45], s[52:53]
    v_pk_fma_f32 v[62:63], v[46:47], v[46:47], s[52:53]
    v_pk_mul_f32 v[48:49], v[48:49], v[32:33] neg_lo:[1,0] neg_hi:[1,0]
    v_pk_mul_f32 v[50:51], v[50:51], v[34:35] neg_lo:[1,0] neg_hi:[1,0]
    v_pk_mul_f32 v[52:53], v[52:53], v[36:37] neg_lo:[1,0] neg_hi:[1,0]
    v_pk_mul_f32 v[54:55], v[54:55], v[38:39] neg_lo:[1,0] neg_hi:[1,0]
    v_pk_mul_f32 v[56:57], v[56:57], v[40:41] neg_lo:[1,0] neg_hi:[1,0]
    v_pk_mul_f32 v[58:59], v[58:59], v[42:43] neg_lo:[1,0] neg_hi:[1,0]
    v_pk_mul_f32 v[60:61], v[60:61], v[44:45] neg_lo:[1,0] neg_hi:[1,0]
    v_pk_mul_f32 v[62:63], v[62:63], v[46:47] neg_lo:[1,0] neg_hi:[1,0]
    v_cvt_pk_bf16_f32 v64, v16, v17
    v_cvt_pk_bf16_f32 v65, v18, v19
    v_cvt_pk_bf16_f32 v66, v20, v21
    v_cvt_pk_bf16_f32 v67, v22, v23
    v_cvt_pk_bf16_f32 v68, v24, v25
    v_cvt_pk_bf16_f32 v69, v26, v27
    v_cvt_pk_bf16_f32 v70, v28, v29
    v_cvt_pk_bf16_f32 v71, v30, v31
    v_mfma_f32_32x32x16_bf16 v[16:31], v[64:67], a[24:27], 0
    v_exp_f32 v48, v48
    v_exp_f32 v49, v49
    v_exp_f32 v50, v50
    v_mfma_f32_32x32x16_bf16 v[16:31], v[68:71], a[28:31], v[16:31]
    v_exp_f32 v51, v51
    v_exp_f32 v52, v52
    v_exp_f32 v53, v53
    v_mfma_f32_32x32x16_bf16 v[144:159], v[128:131], a[232:235], 0
    v_exp_f32 v54, v54
    v_exp_f32 v55, v55
    v_exp_f32 v56, v56
    v_mfma_f32_32x32x16_bf16 v[144:159], v[132:135], a[236:239], v[144:159]
    v_exp_f32 v57, v57
    v_exp_f32 v58, v58
    v_exp_f32 v59, v59
    v_exp_f32 v60, v60
    v_exp_f32 v61, v61
    v_exp_f32 v62, v62
    v_exp_f32 v63, v63
    v_pk_add_f32 v[48:49], v[48:49], 1.0 op_sel_hi:[1,0]
    v_pk_add_f32 v[50:51], v[50:51], 1.0 op_sel_hi:[1,0]
    v_pk_add_f32 v[52:53], v[52:53], 1.0 op_sel_hi:[1,0]
    v_pk_add_f32 v[54:55], v[54:55], 1.0 op_sel_hi:[1,0]
    v_pk_add_f32 v[56:57], v[56:57], 1.0 op_sel_hi:[1,0]
    v_pk_add_f32 v[58:59], v[58:59], 1.0 op_sel_hi:[1,0]
    v_pk_add_f32 v[60:61], v[60:61], 1.0 op_sel_hi:[1,0]
    v_pk_add_f32 v[62:63], v[62:63], 1.0 op_sel_hi:[1,0]
    v_pk_fma_f32 v[96:97], v[16:17], v[16:17], v[96:97]
    v_pk_fma_f32 v[96:97], v[18:19], v[18:19], v[96:97]
    v_pk_fma_f32 v[96:97], v[20:21], v[20:21], v[96:97]
    v_pk_fma_f32 v[96:97], v[22:23], v[22:23], v[96:97]
    v_pk_fma_f32 v[96:97], v[24:25], v[24:25], v[96:97]
    v_pk_fma_f32 v[96:97], v[26:27], v[26:27], v[96:97]
    v_pk_fma_f32 v[96:97], v[28:29], v[28:29], v[96:97]
    v_pk_fma_f32 v[96:97], v[30:31], v[30:31], v[96:97]
    v_pk_add_f32 v[8:9], v[8:9], v[144:145]
    v_pk_fma_f32 v[10:11], v[144:145], v[144:145], v[10:11]
    v_pk_add_f32 v[8:9], v[8:9], v[146:147]
    v_pk_fma_f32 v[10:11], v[146:147], v[146:147], v[10:11]
    v_pk_add_f32 v[8:9], v[8:9], v[148:149]
    v_pk_fma_f32 v[10:11], v[148:149], v[148:149], v[10:11]
    v_pk_add_f32 v[8:9], v[8:9], v[150:151]
    v_pk_fma_f32 v[10:11], v[150:151], v[150:151], v[10:11]
    v_pk_add_f32 v[8:9], v[8:9], v[152:153]
    v_pk_fma_f32 v[10:11], v[152:153], v[152:153], v[10:11]
    v_pk_add_f32 v[8:9], v[8:9], v[154:155]
    v_pk_fma_f32 v[10:11], v[154:155], v[154:155], v[10:11]
    v_pk_add_f32 v[8:9], v[8:9], v[156:157]
    v_pk_fma_f32 v[10:11], v[156:157], v[156:157], v[10:11]
    v_pk_add_f32 v[8:9], v[8:9], v[158:159]
    v_pk_fma_f32 v[10:11], v[158:159], v[158:159], v[10:11]
    v_mfma_f32_32x32x16_bf16 v[16:31], a[0:3], v[72:75], 0
    s_waitcnt lgkmcnt(3)
    ds_read_b128 a[20:23], v2 offset:17408
    ds_read_b128 a[0:3], v2 offset:18432
    v_rcp_f32 v48, v48
    v_rcp_f32 v49, v49
    v_mfma_f32_32x32x16_bf16 v[16:31], a[4:7], v[76:79], v[16:31]
    s_waitcnt lgkmcnt(4)
    v_rcp_f32 v50, v50
    v_rcp_f32 v51, v51
    v_rcp_f32 v52, v52
    v_mfma_f32_32x32x16_bf16 v[16:31], a[8:11], v[80:83], v[16:31]
    s_waitcnt lgkmcnt(3)
    ds_read_b128 a[4:7], v2 offset:19456
    ds_read_b128 a[8:11], v2 offset:20480
    v_rcp_f32 v53, v53
    v_rcp_f32 v54, v54
    v_mfma_f32_32x32x16_bf16 v[16:31], a[12:15], v[84:87], v[16:31]
    s_waitcnt lgkmcnt(4)
    v_rcp_f32 v55, v55
    v_rcp_f32 v56, v56
    v_rcp_f32 v57, v57
    v_mfma_f32_32x32x16_bf16 v[16:31], a[16:19], v[88:91], v[16:31]
    s_waitcnt lgkmcnt(3)
    ds_read_b128 a[12:15], v2 offset:21504
    ds_read_b128 a[16:19], v2 offset:22528
    v_rcp_f32 v58, v58
    v_rcp_f32 v59, v59
    v_mfma_f32_32x32x16_bf16 v[16:31], a[20:23], v[92:95], v[16:31]
    s_waitcnt lgkmcnt(4)
    v_rcp_f32 v60, v60
    v_rcp_f32 v61, v61
    v_rcp_f32 v62, v62
    v_rcp_f32 v63, v63
    v_accvgpr_write_b32 a192, v64
    v_accvgpr_write_b32 a193, v65
    v_accvgpr_write_b32 a194, v66
    v_accvgpr_write_b32 a195, v67
    v_accvgpr_write_b32 a196, v68
    v_accvgpr_write_b32 a197, v69
    v_accvgpr_write_b32 a198, v70
    v_accvgpr_write_b32 a199, v71
    v_pk_mul_f32 v[32:33], v[32:33], v[48:49]
    v_pk_mul_f32 v[34:35], v[34:35], v[50:51]
    v_pk_mul_f32 v[36:37], v[36:37], v[52:53]
    v_pk_mul_f32 v[38:39], v[38:39], v[54:55]
    v_pk_mul_f32 v[40:41], v[40:41], v[56:57]
    v_pk_mul_f32 v[42:43], v[42:43], v[58:59]
    v_pk_mul_f32 v[44:45], v[44:45], v[60:61]
    v_pk_mul_f32 v[46:47], v[46:47], v[62:63]
    v_pk_fma_f32 v[48:49], v[16:17], v[16:17], s[52:53]
    v_pk_fma_f32 v[50:51], v[18:19], v[18:19], s[52:53]
    v_pk_fma_f32 v[52:53], v[20:21], v[20:21], s[52:53]
    v_pk_fma_f32 v[54:55], v[22:23], v[22:23], s[52:53]
    v_pk_fma_f32 v[56:57], v[24:25], v[24:25], s[52:53]
    v_pk_fma_f32 v[58:59], v[26:27], v[26:27], s[52:53]
    v_pk_fma_f32 v[60:61], v[28:29], v[28:29], s[52:53]
    v_pk_fma_f32 v[62:63], v[30:31], v[30:31], s[52:53]
    v_pk_mul_f32 v[48:49], v[48:49], v[16:17] neg_lo:[1,0] neg_hi:[1,0]
    v_pk_mul_f32 v[50:51], v[50:51], v[18:19] neg_lo:[1,0] neg_hi:[1,0]
    v_pk_mul_f32 v[52:53], v[52:53], v[20:21] neg_lo:[1,0] neg_hi:[1,0]
    v_pk_mul_f32 v[54:55], v[54:55], v[22:23] neg_lo:[1,0] neg_hi:[1,0]
    v_pk_mul_f32 v[56:57], v[56:57], v[24:25] neg_lo:[1,0] neg_hi:[1,0]
    v_pk_mul_f32 v[58:59], v[58:59], v[26:27] neg_lo:[1,0] neg_hi:[1,0]
    v_pk_mul_f32 v[60:61], v[60:61], v[28:29] neg_lo:[1,0] neg_hi:[1,0]
    v_pk_mul_f32 v[62:63], v[62:63], v[30:31] neg_lo:[1,0] neg_hi:[1,0]
    v_cvt_pk_bf16_f32 v64, v32, v33
    v_cvt_pk_bf16_f32 v65, v34, v35
    v_cvt_pk_bf16_f32 v66, v36, v37
    v_cvt_pk_bf16_f32 v67, v38, v39
    v_cvt_pk_bf16_f32 v68, v40, v41
    v_cvt_pk_bf16_f32 v69, v42, v43
    v_cvt_pk_bf16_f32 v70, v44, v45
    v_cvt_pk_bf16_f32 v71, v46, v47
    v_mfma_f32_32x32x16_bf16 v[32:47], v[64:67], a[24:27], 0
    v_exp_f32 v48, v48
    v_exp_f32 v49, v49
    v_exp_f32 v50, v50
    v_mfma_f32_32x32x16_bf16 v[32:47], v[68:71], a[28:31], v[32:47]
    v_exp_f32 v51, v51
    v_exp_f32 v52, v52
    v_exp_f32 v53, v53
    v_mfma_f32_32x32x16_bf16 v[144:159], v[136:139], a[240:243], 0
    v_exp_f32 v54, v54
    v_exp_f32 v55, v55
    v_exp_f32 v56, v56
    v_mfma_f32_32x32x16_bf16 v[144:159], v[140:143], a[244:247], v[144:159]
    v_exp_f32 v57, v57
    v_exp_f32 v58, v58
    v_exp_f32 v59, v59
    v_exp_f32 v60, v60
    v_exp_f32 v61, v61
    v_exp_f32 v62, v62
    v_exp_f32 v63, v63
    v_pk_add_f32 v[48:49], v[48:49], 1.0 op_sel_hi:[1,0]
    v_pk_add_f32 v[50:51], v[50:51], 1.0 op_sel_hi:[1,0]
    v_pk_add_f32 v[52:53], v[52:53], 1.0 op_sel_hi:[1,0]
    v_pk_add_f32 v[54:55], v[54:55], 1.0 op_sel_hi:[1,0]
    v_pk_add_f32 v[56:57], v[56:57], 1.0 op_sel_hi:[1,0]
    v_pk_add_f32 v[58:59], v[58:59], 1.0 op_sel_hi:[1,0]
    v_pk_add_f32 v[60:61], v[60:61], 1.0 op_sel_hi:[1,0]
    v_pk_add_f32 v[62:63], v[62:63], 1.0 op_sel_hi:[1,0]
    v_pk_fma_f32 v[98:99], v[32:33], v[32:33], v[98:99]
    v_pk_fma_f32 v[98:99], v[34:35], v[34:35], v[98:99]
    v_pk_fma_f32 v[98:99], v[36:37], v[36:37], v[98:99]
    v_pk_fma_f32 v[98:99], v[38:39], v[38:39], v[98:99]
    v_pk_fma_f32 v[98:99], v[40:41], v[40:41], v[98:99]
    v_pk_fma_f32 v[98:99], v[42:43], v[42:43], v[98:99]
    v_pk_fma_f32 v[98:99], v[44:45], v[44:45], v[98:99]
    v_pk_fma_f32 v[98:99], v[46:47], v[46:47], v[98:99]
    v_pk_add_f32 v[8:9], v[8:9], v[144:145]
    v_pk_fma_f32 v[10:11], v[144:145], v[144:145], v[10:11]
    v_pk_add_f32 v[8:9], v[8:9], v[146:147]
    v_pk_fma_f32 v[10:11], v[146:147], v[146:147], v[10:11]
    v_pk_add_f32 v[8:9], v[8:9], v[148:149]
    v_pk_fma_f32 v[10:11], v[148:149], v[148:149], v[10:11]
    v_pk_add_f32 v[8:9], v[8:9], v[150:151]
    v_pk_fma_f32 v[10:11], v[150:151], v[150:151], v[10:11]
    v_pk_add_f32 v[8:9], v[8:9], v[152:153]
    v_pk_fma_f32 v[10:11], v[152:153], v[152:153], v[10:11]
    v_pk_add_f32 v[8:9], v[8:9], v[154:155]
    v_pk_fma_f32 v[10:11], v[154:155], v[154:155], v[10:11]
    v_pk_add_f32 v[8:9], v[8:9], v[156:157]
    v_pk_fma_f32 v[10:11], v[156:157], v[156:157], v[10:11]
    v_pk_add_f32 v[8:9], v[8:9], v[158:159]
    v_pk_fma_f32 v[10:11], v[158:159], v[158:159], v[10:11]
    v_mfma_f32_32x32x16_bf16 v[32:47], a[0:3], v[72:75], 0
    s_waitcnt lgkmcnt(3)
    ds_read_b128 a[20:23], v2 offset:23552
    ds_read_b128 a[0:3], v2 offset:0
    v_rcp_f32 v48, v48
    v_rcp_f32 v49, v49
    v_mfma_f32_32x32x16_bf16 v[32:47], a[4:7], v[76:79], v[32:47]
    s_waitcnt lgkmcnt(4)
    v_rcp_f32 v50, v50
    v_rcp_f32 v51, v51
    v_rcp_f32 v52, v52
    v_mfma_f32_32x32x16_bf16 v[32:47], a[8:11], v[80:83], v[32:47]
    s_waitcnt lgkmcnt(3)
    ds_read_b128 a[4:7], v2 offset:1024
    ds_read_b128 a[8:11], v2 offset:2048
    v_rcp_f32 v53, v53
    v_rcp_f32 v54, v54
    v_mfma_f32_32x32x16_bf16 v[32:47], a[12:15], v[84:87], v[32:47]
    s_waitcnt lgkmcnt(4)
    v_rcp_f32 v55, v55
    v_rcp_f32 v56, v56
    v_rcp_f32 v57, v57
    v_mfma_f32_32x32x16_bf16 v[32:47], a[16:19], v[88:91], v[32:47]
    s_waitcnt lgkmcnt(3)
    ds_read_b128 a[12:15], v2 offset:3072
    ds_read_b128 a[16:19], v2 offset:4096
    v_rcp_f32 v58, v58
    v_rcp_f32 v59, v59
    v_mfma_f32_32x32x16_bf16 v[32:47], a[20:23], v[92:95], v[32:47]
    s_waitcnt lgkmcnt(4)
    v_rcp_f32 v60, v60
    v_rcp_f32 v61, v61
    v_rcp_f32 v62, v62
    v_mfma_f32_32x32x16_bf16 v[144:159], v[120:123], a[224:227], 0
    v_rcp_f32 v63, v63
    v_add_f32 v8, v8, v9
    v_add_f32 v10, v10, v11
    s_nop 1
    v_permlane32_swap_b32 v8, v10
    v_add_f32 v8, v8, v10
    v_mfma_f32_32x32x16_bf16 v[144:159], v[124:127], a[228:231], v[144:159]
    v_mov_b32 v10, v8
    s_nop 1
    v_permlane32_swap_b32 v8, v10
    v_mul_f32 v8, 0x3c2aaaab, v8
    v_mul_f32 v10, 0x3c2aaaab, v10
    v_fma_f32 v10, -v8, v8, v10
    v_max_f32 v10, 0, v10
    v_add_f32 v10, 0x3727c5ac, v10
    v_rsq_f32_e64 v10, v10
    s_nop 0
    v_mul_f32 v12, 0x3eeff558, v10
    v_mul_f32_e64 v13, -v8, v12
    v_accvgpr_write_b32 a200, v64
    v_accvgpr_write_b32 a201, v65
    v_accvgpr_write_b32 a202, v66
    v_accvgpr_write_b32 a203, v67
    v_accvgpr_write_b32 a204, v68
    v_accvgpr_write_b32 a205, v69
    v_accvgpr_write_b32 a206, v70
    v_accvgpr_write_b32 a207, v71
    v_pk_mul_f32 v[16:17], v[16:17], v[48:49]
    v_pk_mul_f32 v[18:19], v[18:19], v[50:51]
    v_pk_mul_f32 v[20:21], v[20:21], v[52:53]
    v_pk_mul_f32 v[22:23], v[22:23], v[54:55]
    v_pk_mul_f32 v[24:25], v[24:25], v[56:57]
    v_pk_mul_f32 v[26:27], v[26:27], v[58:59]
    v_pk_mul_f32 v[28:29], v[28:29], v[60:61]
    v_pk_mul_f32 v[30:31], v[30:31], v[62:63]
    v_pk_fma_f32 v[144:145], v[144:145], v[12:13], v[12:13] op_sel:[0,0,1] op_sel_hi:[1,0,1]
    v_pk_fma_f32 v[146:147], v[146:147], v[12:13], v[12:13] op_sel:[0,0,1] op_sel_hi:[1,0,1]
    v_pk_fma_f32 v[148:149], v[148:149], v[12:13], v[12:13] op_sel:[0,0,1] op_sel_hi:[1,0,1]
    v_pk_fma_f32 v[150:151], v[150:151], v[12:13], v[12:13] op_sel:[0,0,1] op_sel_hi:[1,0,1]
    v_pk_fma_f32 v[152:153], v[152:153], v[12:13], v[12:13] op_sel:[0,0,1] op_sel_hi:[1,0,1]
    v_pk_fma_f32 v[154:155], v[154:155], v[12:13], v[12:13] op_sel:[0,0,1] op_sel_hi:[1,0,1]
    v_pk_fma_f32 v[156:157], v[156:157], v[12:13], v[12:13] op_sel:[0,0,1] op_sel_hi:[1,0,1]
    v_pk_fma_f32 v[158:159], v[158:159], v[12:13], v[12:13] op_sel:[0,0,1] op_sel_hi:[1,0,1]
    v_cvt_pk_bf16_f32 v72, v144, v145
    v_cvt_pk_bf16_f32 v73, v146, v147
    v_cvt_pk_bf16_f32 v74, v148, v149
    v_cvt_pk_bf16_f32 v75, v150, v151
    v_cvt_pk_bf16_f32 v76, v152, v153
    v_cvt_pk_bf16_f32 v77, v154, v155
    v_cvt_pk_bf16_f32 v78, v156, v157
    v_cvt_pk_bf16_f32 v79, v158, v159
    v_pk_fma_f32 v[48:49], v[32:33], v[32:33], s[52:53]
    v_pk_fma_f32 v[50:51], v[34:35], v[34:35], s[52:53]
    v_pk_fma_f32 v[52:53], v[36:37], v[36:37], s[52:53]
    v_pk_fma_f32 v[54:55], v[38:39], v[38:39], s[52:53]
    v_pk_fma_f32 v[56:57], v[40:41], v[40:41], s[52:53]
    v_pk_fma_f32 v[58:59], v[42:43], v[42:43], s[52:53]
    v_pk_fma_f32 v[60:61], v[44:45], v[44:45], s[52:53]
    v_pk_fma_f32 v[62:63], v[46:47], v[46:47], s[52:53]
    v_pk_mul_f32 v[48:49], v[48:49], v[32:33] neg_lo:[1,0] neg_hi:[1,0]
    v_pk_mul_f32 v[50:51], v[50:51], v[34:35] neg_lo:[1,0] neg_hi:[1,0]
    v_pk_mul_f32 v[52:53], v[52:53], v[36:37] neg_lo:[1,0] neg_hi:[1,0]
    v_pk_mul_f32 v[54:55], v[54:55], v[38:39] neg_lo:[1,0] neg_hi:[1,0]
    v_pk_mul_f32 v[56:57], v[56:57], v[40:41] neg_lo:[1,0] neg_hi:[1,0]
    v_pk_mul_f32 v[58:59], v[58:59], v[42:43] neg_lo:[1,0] neg_hi:[1,0]
    v_pk_mul_f32 v[60:61], v[60:61], v[44:45] neg_lo:[1,0] neg_hi:[1,0]
    v_pk_mul_f32 v[62:63], v[62:63], v[46:47] neg_lo:[1,0] neg_hi:[1,0]
    v_cvt_pk_bf16_f32 v64, v16, v17
    v_cvt_pk_bf16_f32 v65, v18, v19
    v_cvt_pk_bf16_f32 v66, v20, v21
    v_cvt_pk_bf16_f32 v67, v22, v23
    v_cvt_pk_bf16_f32 v68, v24, v25
    v_cvt_pk_bf16_f32 v69, v26, v27
    v_cvt_pk_bf16_f32 v70, v28, v29
    v_cvt_pk_bf16_f32 v71, v30, v31
    v_mfma_f32_32x32x16_bf16 v[16:31], v[64:67], a[24:27], 0
    v_exp_f32 v48, v48
    v_exp_f32 v49, v49
    v_exp_f32 v50, v50
    v_mfma_f32_32x32x16_bf16 v[16:31], v[68:71], a[28:31], v[16:31]
    v_exp_f32 v51, v51
    v_exp_f32 v52, v52
    v_exp_f32 v53, v53
    v_mfma_f32_32x32x16_bf16 v[144:159], v[128:131], a[232:235], 0
    v_exp_f32 v54, v54
    v_exp_f32 v55, v55
    v_exp_f32 v56, v56
    v_mfma_f32_32x32x16_bf16 v[144:159], v[132:135], a[236:239], v[144:159]
    v_exp_f32 v57, v57
    v_pk_fma_f32 v[100:101], v[16:17], v[16:17], v[100:101]
    v_pk_fma_f32 v[100:101], v[18:19], v[18:19], v[100:101]
    v_pk_fma_f32 v[100:101], v[20:21], v[20:21], v[100:101]
    v_pk_fma_f32 v[100:101], v[22:23], v[22:23], v[100:101]
    v_pk_fma_f32 v[100:101], v[24:25], v[24:25], v[100:101]
    v_pk_fma_f32 v[100:101], v[26:27], v[26:27], v[100:101]
    v_pk_fma_f32 v[100:101], v[28:29], v[28:29], v[100:101]
    v_pk_fma_f32 v[100:101], v[30:31], v[30:31], v[100:101]
    v_pk_fma_f32 v[144:145], v[144:145], v[12:13], v[12:13] op_sel:[0,0,1] op_sel_hi:[1,0,1]
    v_pk_fma_f32 v[146:147], v[146:147], v[12:13], v[12:13] op_sel:[0,0,1] op_sel_hi:[1,0,1]
    v_pk_fma_f32 v[148:149], v[148:149], v[12:13], v[12:13] op_sel:[0,0,1] op_sel_hi:[1,0,1]
    v_pk_fma_f32 v[150:151], v[150:151], v[12:13], v[12:13] op_sel:[0,0,1] op_sel_hi:[1,0,1]
    v_pk_fma_f32 v[152:153], v[152:153], v[12:13], v[12:13] op_sel:[0,0,1] op_sel_hi:[1,0,1]
    v_pk_fma_f32 v[154:155], v[154:155], v[12:13], v[12:13] op_sel:[0,0,1] op_sel_hi:[1,0,1]
    v_pk_fma_f32 v[156:157], v[156:157], v[12:13], v[12:13] op_sel:[0,0,1] op_sel_hi:[1,0,1]
    v_pk_fma_f32 v[158:159], v[158:159], v[12:13], v[12:13] op_sel:[0,0,1] op_sel_hi:[1,0,1]
    v_cvt_pk_bf16_f32 v80, v144, v145
    v_cvt_pk_bf16_f32 v81, v146, v147
    v_cvt_pk_bf16_f32 v82, v148, v149
    v_cvt_pk_bf16_f32 v83, v150, v151
    v_cvt_pk_bf16_f32 v84, v152, v153
    v_cvt_pk_bf16_f32 v85, v154, v155
    v_cvt_pk_bf16_f32 v86, v156, v157
    v_cvt_pk_bf16_f32 v87, v158, v159
    v_mfma_f32_32x32x16_bf16 v[144:159], v[136:139], a[240:243], 0
    v_exp_f32 v58, v58
    v_exp_f32 v59, v59
    v_exp_f32 v60, v60
    v_mfma_f32_32x32x16_bf16 v[144:159], v[140:143], a[244:247], v[144:159]
    v_exp_f32 v61, v61
    v_exp_f32 v62, v62
    v_exp_f32 v63, v63
    v_pk_add_f32 v[48:49], v[48:49], 1.0 op_sel_hi:[1,0]
    v_pk_add_f32 v[50:51], v[50:51], 1.0 op_sel_hi:[1,0]
    v_pk_add_f32 v[52:53], v[52:53], 1.0 op_sel_hi:[1,0]
    v_pk_add_f32 v[54:55], v[54:55], 1.0 op_sel_hi:[1,0]
    v_pk_add_f32 v[56:57], v[56:57], 1.0 op_sel_hi:[1,0]
    v_pk_add_f32 v[58:59], v[58:59], 1.0 op_sel_hi:[1,0]
    v_pk_add_f32 v[60:61], v[60:61], 1.0 op_sel_hi:[1,0]
    v_pk_add_f32 v[62:63], v[62:63], 1.0 op_sel_hi:[1,0]
    v_pk_fma_f32 v[144:145], v[144:145], v[12:13], v[12:13] op_sel:[0,0,1] op_sel_hi:[1,0,1]
    v_pk_fma_f32 v[146:147], v[146:147], v[12:13], v[12:13] op_sel:[0,0,1] op_sel_hi:[1,0,1]
    v_pk_fma_f32 v[148:149], v[148:149], v[12:13], v[12:13] op_sel:[0,0,1] op_sel_hi:[1,0,1]
    v_pk_fma_f32 v[150:151], v[150:151], v[12:13], v[12:13] op_sel:[0,0,1] op_sel_hi:[1,0,1]
    v_pk_fma_f32 v[152:153], v[152:153], v[12:13], v[12:13] op_sel:[0,0,1] op_sel_hi:[1,0,1]
    v_pk_fma_f32 v[154:155], v[154:155], v[12:13], v[12:13] op_sel:[0,0,1] op_sel_hi:[1,0,1]
    v_pk_fma_f32 v[156:157], v[156:157], v[12:13], v[12:13] op_sel:[0,0,1] op_sel_hi:[1,0,1]
    v_pk_fma_f32 v[158:159], v[158:159], v[12:13], v[12:13] op_sel:[0,0,1] op_sel_hi:[1,0,1]
    v_cvt_pk_bf16_f32 v88, v144, v145
    v_cvt_pk_bf16_f32 v89, v146, v147
    v_cvt_pk_bf16_f32 v90, v148, v149
    v_cvt_pk_bf16_f32 v91, v150, v151
    v_cvt_pk_bf16_f32 v92, v152, v153
    v_cvt_pk_bf16_f32 v93, v154, v155
    v_cvt_pk_bf16_f32 v94, v156, v157
    v_cvt_pk_bf16_f32 v95, v158, v159
    v_mfma_f32_32x32x16_bf16 v[16:31], v[160:163], v[72:75], 0
    s_add_u32 s54, s56, 172032
    buffer_load_dwordx4 a[224:227], v1, s[24:27], s54 offen offset:0
    buffer_load_dwordx4 a[228:231], v1, s[24:27], s54 offen offset:32
    v_rcp_f32 v48, v48
    v_rcp_f32 v49, v49
    v_mfma_f32_32x32x16_bf16 v[16:31], v[164:167], v[76:79], v[16:31]
    buffer_load_dwordx4 a[232:235], v1, s[24:27], s54 offen offset:64
    buffer_load_dwordx4 a[236:239], v1, s[24:27], s54 offen offset:96
    v_rcp_f32 v50, v50
    v_rcp_f32 v51, v51
    v_mfma_f32_32x32x16_bf16 v[16:31], v[168:171], v[80:83], v[16:31]
    buffer_load_dwordx4 a[240:243], v1, s[24:27], s54 offen offset:128
    buffer_load_dwordx4 a[244:247], v1, s[24:27], s54 offen offset:160
    v_rcp_f32 v52, v52
    v_rcp_f32 v53, v53
    v_mfma_f32_32x32x16_bf16 v[16:31], v[172:175], v[84:87], v[16:31]
    v_rcp_f32 v54, v54
    v_rcp_f32 v55, v55
    v_rcp_f32 v56, v56
    v_mfma_f32_32x32x16_bf16 v[16:31], v[176:179], v[88:91], v[16:31]
    v_rcp_f32 v57, v57
    v_rcp_f32 v58, v58
    v_rcp_f32 v59, v59
    v_mfma_f32_32x32x16_bf16 v[16:31], v[180:183], v[92:95], v[16:31]
    v_rcp_f32 v60, v60
    v_rcp_f32 v61, v61
    v_rcp_f32 v62, v62
    v_rcp_f32 v63, v63
    v_accvgpr_write_b32 a208, v64
    v_accvgpr_write_b32 a209, v65
    v_accvgpr_write_b32 a210, v66
    v_accvgpr_write_b32 a211, v67
    v_accvgpr_write_b32 a212, v68
    v_accvgpr_write_b32 a213, v69
    v_accvgpr_write_b32 a214, v70
    v_accvgpr_write_b32 a215, v71
    v_pk_mul_f32 v[32:33], v[32:33], v[48:49]
    v_pk_mul_f32 v[34:35], v[34:35], v[50:51]
    v_pk_mul_f32 v[36:37], v[36:37], v[52:53]
    v_pk_mul_f32 v[38:39], v[38:39], v[54:55]
    v_pk_mul_f32 v[40:41], v[40:41], v[56:57]
    v_pk_mul_f32 v[42:43], v[42:43], v[58:59]
    v_pk_mul_f32 v[44:45], v[44:45], v[60:61]
    v_pk_mul_f32 v[46:47], v[46:47], v[62:63]
    v_pk_fma_f32 v[48:49], v[16:17], v[16:17], s[52:53]
    v_pk_fma_f32 v[50:51], v[18:19], v[18:19], s[52:53]
    v_pk_fma_f32 v[52:53], v[20:21], v[20:21], s[52:53]
    v_pk_fma_f32 v[54:55], v[22:23], v[22:23], s[52:53]
    v_pk_fma_f32 v[56:57], v[24:25], v[24:25], s[52:53]
    v_pk_fma_f32 v[58:59], v[26:27], v[26:27], s[52:53]
    v_pk_fma_f32 v[60:61], v[28:29], v[28:29], s[52:53]
    v_pk_fma_f32 v[62:63], v[30:31], v[30:31], s[52:53]
    v_pk_mul_f32 v[48:49], v[48:49], v[16:17] neg_lo:[1,0] neg_hi:[1,0]
    v_pk_mul_f32 v[50:51], v[50:51], v[18:19] neg_lo:[1,0] neg_hi:[1,0]
    v_pk_mul_f32 v[52:53], v[52:53], v[20:21] neg_lo:[1,0] neg_hi:[1,0]
    v_pk_mul_f32 v[54:55], v[54:55], v[22:23] neg_lo:[1,0] neg_hi:[1,0]
    v_pk_mul_f32 v[56:57], v[56:57], v[24:25] neg_lo:[1,0] neg_hi:[1,0]
    v_pk_mul_f32 v[58:59], v[58:59], v[26:27] neg_lo:[1,0] neg_hi:[1,0]
    v_pk_mul_f32 v[60:61], v[60:61], v[28:29] neg_lo:[1,0] neg_hi:[1,0]
    v_pk_mul_f32 v[62:63], v[62:63], v[30:31] neg_lo:[1,0] neg_hi:[1,0]
L_pf10:
    v_cvt_pk_bf16_f32 v64, v32, v33
    v_cvt_pk_bf16_f32 v65, v34, v35
    v_cvt_pk_bf16_f32 v66, v36, v37
    v_cvt_pk_bf16_f32 v67, v38, v39
    v_cvt_pk_bf16_f32 v68, v40, v41
    v_cvt_pk_bf16_f32 v69, v42, v43
    v_cvt_pk_bf16_f32 v70, v44, v45
    v_cvt_pk_bf16_f32 v71, v46, v47
    v_mfma_f32_32x32x16_bf16 v[144:159], v[64:67], a[24:27], 0
    s_mov_b32 s63, L_pf10-L_pc+12288
    buffer_load_dword v6, v7, s[68:71], s63 offen
    v_exp_f32 v48, v48
    v_exp_f32 v49, v49
    v_accvgpr_write_b32 a216, v64
    v_mfma_f32_32x32x16_bf16 v[144:159], v[68:71], a[28:31], v[144:159]
    v_exp_f32 v50, v50
    v_exp_f32 v51, v51
    v_exp_f32 v52, v52
    v_mfma_f32_32x32x16_bf16 v[32:47], v[184:187], v[72:75], 0
    v_exp_f32 v53, v53
    v_exp_f32 v54, v54
    v_exp_f32 v55, v55
    v_mfma_f32_32x32x16_bf16 v[32:47], v[188:191], v[76:79], v[32:47]
    v_exp_f32 v56, v56
    v_exp_f32 v57, v57
    v_exp_f32 v58, v58
    v_exp_f32 v59, v59
    v_exp_f32 v60, v60
    v_exp_f32 v61, v61
    v_exp_f32 v62, v62
    v_exp_f32 v63, v63
    v_accvgpr_write_b32 a217, v65
    v_accvgpr_write_b32 a218, v66
    v_accvgpr_write_b32 a219, v67
    v_accvgpr_write_b32 a220, v68
    v_accvgpr_write_b32 a221, v69
    v_accvgpr_write_b32 a222, v70
    v_accvgpr_write_b32 a223, v71
    v_pk_add_f32 v[48:49], v[48:49], 1.0 op_sel_hi:[1,0]
    v_pk_add_f32 v[50:51], v[50:51], 1.0 op_sel_hi:[1,0]
    v_pk_add_f32 v[52:53], v[52:53], 1.0 op_sel_hi:[1,0]
    v_pk_add_f32 v[54:55], v[54:55], 1.0 op_sel_hi:[1,0]
    v_pk_add_f32 v[56:57], v[56:57], 1.0 op_sel_hi:[1,0]
    v_pk_add_f32 v[58:59], v[58:59], 1.0 op_sel_hi:[1,0]
    v_pk_add_f32 v[60:61], v[60:61], 1.0 op_sel_hi:[1,0]
    v_pk_add_f32 v[62:63], v[62:63], 1.0 op_sel_hi:[1,0]
    v_pk_fma_f32 v[102:103], v[144:145], v[144:145], v[102:103]
    v_pk_fma_f32 v[102:103], v[146:147], v[146:147], v[102:103]
    v_pk_fma_f32 v[102:103], v[148:149], v[148:149], v[102:103]
    v_pk_fma_f32 v[102:103], v[150:151], v[150:151], v[102:103]
    v_pk_fma_f32 v[102:103], v[152:153], v[152:153], v[102:103]
    v_pk_fma_f32 v[102:103], v[154:155], v[154:155], v[102:103]
    v_pk_fma_f32 v[102:103], v[156:157], v[156:157], v[102:103]
    v_pk_fma_f32 v[102:103], v[158:159], v[158:159], v[102:103]
    v_mfma_f32_32x32x16_bf16 v[32:47], v[192:195], v[80:83], v[32:47]
    v_rcp_f32 v48, v48
    v_rcp_f32 v49, v49
    v_rcp_f32 v50, v50
    v_mfma_f32_32x32x16_bf16 v[32:47], v[196:199], v[84:87], v[32:47]
    v_rcp_f32 v51, v51
    v_rcp_f32 v52, v52
    v_rcp_f32 v53, v53
    v_mfma_f32_32x32x16_bf16 v[32:47], v[200:203], v[88:91], v[32:47]
    v_rcp_f32 v54, v54
    v_rcp_f32 v55, v55
    v_rcp_f32 v56, v56
    v_mfma_f32_32x32x16_bf16 v[32:47], v[204:207], v[92:95], v[32:47]
    v_rcp_f32 v57, v57
    v_rcp_f32 v58, v58
    v_rcp_f32 v59, v59
    v_rcp_f32 v60, v60
    v_rcp_f32 v61, v61
    v_rcp_f32 v62, v62
    v_rcp_f32 v63, v63
    v_pk_mul_f32 v[16:17], v[16:17], v[48:49]
    v_pk_mul_f32 v[18:19], v[18:19], v[50:51]
    v_pk_mul_f32 v[20:21], v[20:21], v[52:53]
    v_pk_mul_f32 v[22:23], v[22:23], v[54:55]
    v_pk_mul_f32 v[24:25], v[24:25], v[56:57]
    v_pk_mul_f32 v[26:27], v[26:27], v[58:59]
    v_pk_mul_f32 v[28:29], v[28:29], v[60:61]
    v_pk_mul_f32 v[30:31], v[30:31], v[62:63]
    v_pk_fma_f32 v[48:49], v[32:33], v[32:33], s[52:53]
    v_pk_fma_f32 v[50:51], v[34:35], v[34:35], s[52:53]
    v_pk_fma_f32 v[52:53], v[36:37], v[36:37], s[52:53]
    v_pk_fma_f32 v[54:55], v[38:39], v[38:39], s[52:53]
    v_pk_fma_f32 v[56:57], v[40:41], v[40:41], s[52:53]
    v_pk_fma_f32 v[58:59], v[42:43], v[42:43], s[52:53]
    v_pk_fma_f32 v[60:61], v[44:45], v[44:45], s[52:53]
    v_pk_fma_f32 v[62:63], v[46:47], v[46:47], s[52:53]
    v_pk_mul_f32 v[48:49], v[48:49], v[32:33] neg_lo:[1,0] neg_hi:[1,0]
    v_pk_mul_f32 v[50:51], v[50:51], v[34:35] neg_lo:[1,0] neg_hi:[1,0]
    v_pk_mul_f32 v[52:53], v[52:53], v[36:37] neg_lo:[1,0] neg_hi:[1,0]
    v_pk_mul_f32 v[54:55], v[54:55], v[38:39] neg_lo:[1,0] neg_hi:[1,0]
    v_pk_mul_f32 v[56:57], v[56:57], v[40:41] neg_lo:[1,0] neg_hi:[1,0]
    v_pk_mul_f32 v[58:59], v[58:59], v[42:43] neg_lo:[1,0] neg_hi:[1,0]
    v_pk_mul_f32 v[60:61], v[60:61], v[44:45] neg_lo:[1,0] neg_hi:[1,0]
    v_pk_mul_f32 v[62:63], v[62:63], v[46:47] neg_lo:[1,0] neg_hi:[1,0]
    v_cvt_pk_bf16_f32 v160, v16, v17
    v_cvt_pk_bf16_f32 v161, v18, v19
    v_cvt_pk_bf16_f32 v162, v20, v21
    v_cvt_pk_bf16_f32 v163, v22, v23
    v_cvt_pk_bf16_f32 v164, v24, v25
    v_cvt_pk_bf16_f32 v165, v26, v27
    v_cvt_pk_bf16_f32 v166, v28, v29
    v_cvt_pk_bf16_f32 v167, v30, v31
    v_mfma_f32_32x32x16_bf16 v[144:159], v[160:163], a[24:27], 0
    v_exp_f32 v48, v48
    v_exp_f32 v49, v49
    v_exp_f32 v50, v50
    v_mfma_f32_32x32x16_bf16 v[144:159], v[164:167], a[28:31], v[144:159]
    v_exp_f32 v51, v51
    v_exp_f32 v52, v52
    v_exp_f32 v53, v53
    v_mfma_f32_32x32x16_bf16 v[16:31], v[208:211], v[72:75], 0
    v_exp_f32 v54, v54
    v_exp_f32 v55, v55
    v_exp_f32 v56, v56
    v_mfma_f32_32x32x16_bf16 v[16:31], v[212:215], v[76:79], v[16:31]
    v_exp_f32 v57, v57
    v_exp_f32 v58, v58
    v_exp_f32 v59, v59
    v_exp_f32 v60, v60
    v_exp_f32 v61, v61
    v_exp_f32 v62, v62
    v_exp_f32 v63, v63
    v_pk_add_f32 v[48:49], v[48:49], 1.0 op_sel_hi:[1,0]
    v_pk_add_f32 v[50:51], v[50:51], 1.0 op_sel_hi:[1,0]
    v_pk_add_f32 v[52:53], v[52:53], 1.0 op_sel_hi:[1,0]
    v_pk_add_f32 v[54:55], v[54:55], 1.0 op_sel_hi:[1,0]
    v_pk_add_f32 v[56:57], v[56:57], 1.0 op_sel_hi:[1,0]
    v_pk_add_f32 v[58:59], v[58:59], 1.0 op_sel_hi:[1,0]
    v_pk_add_f32 v[60:61], v[60:61], 1.0 op_sel_hi:[1,0]
    v_pk_add_f32 v[62:63], v[62:63], 1.0 op_sel_hi:[1,0]
    v_pk_fma_f32 v[112:113], v[144:145], v[144:145], v[112:113]
    v_pk_fma_f32 v[112:113], v[146:147], v[146:147], v[112:113]
    v_pk_fma_f32 v[112:113], v[148:149], v[148:149], v[112:113]
    v_pk_fma_f32 v[112:113], v[150:151], v[150:151], v[112:113]
    v_pk_fma_f32 v[112:113], v[152:153], v[152:153], v[112:113]
    v_pk_fma_f32 v[112:113], v[154:155], v[154:155], v[112:113]
    v_pk_fma_f32 v[112:113], v[156:157], v[156:157], v[112:113]
    v_pk_fma_f32 v[112:113], v[158:159], v[158:159], v[112:113]
    v_mfma_f32_32x32x16_bf16 v[16:31], v[216:219], v[80:83], v[16:31]
    v_rcp_f32 v48, v48
    v_rcp_f32 v49, v49
    v_rcp_f32 v50, v50
    v_mfma_f32_32x32x16_bf16 v[16:31], v[220:223], v[84:87], v[16:31]
    v_rcp_f32 v51, v51
    v_rcp_f32 v52, v52
    v_rcp_f32 v53, v53
    v_mfma_f32_32x32x16_bf16 v[16:31], v[224:227], v[88:91], v[16:31]
    v_rcp_f32 v54, v54
    v_rcp_f32 v55, v55
    v_rcp_f32 v56, v56
    v_mfma_f32_32x32x16_bf16 v[16:31], v[228:231], v[92:95], v[16:31]
    v_rcp_f32 v57, v57
    v_rcp_f32 v58, v58
    v_rcp_f32 v59, v59
    v_rcp_f32 v60, v60
    v_rcp_f32 v61, v61
    v_rcp_f32 v62, v62
    v_rcp_f32 v63, v63
    v_pk_mul_f32 v[32:33], v[32:33], v[48:49]
    v_pk_mul_f32 v[34:35], v[34:35], v[50:51]
    v_pk_mul_f32 v[36:37], v[36:37], v[52:53]
    v_pk_mul_f32 v[38:39], v[38:39], v[54:55]
    v_pk_mul_f32 v[40:41], v[40:41], v[56:57]
    v_pk_mul_f32 v[42:43], v[42:43], v[58:59]
    v_pk_mul_f32 v[44:45], v[44:45], v[60:61]
    v_pk_mul_f32 v[46:47], v[46:47], v[62:63]
    v_pk_fma_f32 v[48:49], v[16:17], v[16:17], s[52:53]
    v_pk_fma_f32 v[50:51], v[18:19], v[18:19], s[52:53]
    v_pk_fma_f32 v[52:53], v[20:21], v[20:21], s[52:53]
    v_pk_fma_f32 v[54:55], v[22:23], v[22:23], s[52:53]
    v_pk_fma_f32 v[56:57], v[24:25], v[24:25], s[52:53]
    v_pk_fma_f32 v[58:59], v[26:27], v[26:27], s[52:53]
    v_pk_fma_f32 v[60:61], v[28:29], v[28:29], s[52:53]
    v_pk_fma_f32 v[62:63], v[30:31], v[30:31], s[52:53]
    v_pk_mul_f32 v[48:49], v[48:49], v[16:17] neg_lo:[1,0] neg_hi:[1,0]
    v_pk_mul_f32 v[50:51], v[50:51], v[18:19] neg_lo:[1,0] neg_hi:[1,0]
    v_pk_mul_f32 v[52:53], v[52:53], v[20:21] neg_lo:[1,0] neg_hi:[1,0]
    v_pk_mul_f32 v[54:55], v[54:55], v[22:23] neg_lo:[1,0] neg_hi:[1,0]
    v_pk_mul_f32 v[56:57], v[56:57], v[24:25] neg_lo:[1,0] neg_hi:[1,0]
    v_pk_mul_f32 v[58:59], v[58:59], v[26:27] neg_lo:[1,0] neg_hi:[1,0]
    v_pk_mul_f32 v[60:61], v[60:61], v[28:29] neg_lo:[1,0] neg_hi:[1,0]
    v_pk_mul_f32 v[62:63], v[62:63], v[30:31] neg_lo:[1,0] neg_hi:[1,0]
    v_cvt_pk_bf16_f32 v168, v32, v33
    v_cvt_pk_bf16_f32 v169, v34, v35
    v_cvt_pk_bf16_f32 v170, v36, v37
    v_cvt_pk_bf16_f32 v171, v38, v39
    v_cvt_pk_bf16_f32 v172, v40, v41
    v_cvt_pk_bf16_f32 v173, v42, v43
    v_cvt_pk_bf16_f32 v174, v44, v45
    v_cvt_pk_bf16_f32 v175, v46, v47
    v_mfma_f32_32x32x16_bf16 v[144:159], v[168:171], a[24:27], 0
    v_exp_f32 v48, v48
    v_exp_f32 v49, v49
    v_exp_f32 v50, v50
    v_mfma_f32_32x32x16_bf16 v[144:159], v[172:175], a[28:31], v[144:159]
    v_exp_f32 v51, v51
    v_exp_f32 v52, v52
    v_exp_f32 v53, v53
    v_mfma_f32_32x32x16_bf16 v[32:47], v[232:235], v[72:75], 0
    v_exp_f32 v54, v54
    v_exp_f32 v55, v55
    v_exp_f32 v56, v56
    v_mfma_f32_32x32x16_bf16 v[32:47], v[236:239], v[76:79], v[32:47]
    v_exp_f32 v57, v57
    v_exp_f32 v58, v58
    v_exp_f32 v59, v59
    v_exp_f32 v60, v60
    v_exp_f32 v61, v61
    v_exp_f32 v62, v62
    v_exp_f32 v63, v63
    v_pk_add_f32 v[48:49], v[48:49], 1.0 op_sel_hi:[1,0]
    v_pk_add_f32 v[50:51], v[50:51], 1.0 op_sel_hi:[1,0]
    v_pk_add_f32 v[52:53], v[52:53], 1.0 op_sel_hi:[1,0]
    v_pk_add_f32 v[54:55], v[54:55], 1.0 op_sel_hi:[1,0]
    v_pk_add_f32 v[56:57], v[56:57], 1.0 op_sel_hi:[1,0]
    v_pk_add_f32 v[58:59], v[58:59], 1.0 op_sel_hi:[1,0]
    v_pk_add_f32 v[60:61], v[60:61], 1.0 op_sel_hi:[1,0]
    v_pk_add_f32 v[62:63], v[62:63], 1.0 op_sel_hi:[1,0]
    v_pk_fma_f32 v[114:115], v[144:145], v[144:145], v[114:115]
    v_pk_fma_f32 v[114:115], v[146:147], v[146:147], v[114:115]
    v_pk_fma_f32 v[114:115], v[148:149], v[148:149], v[114:115]
    v_pk_fma_f32 v[114:115], v[150:151], v[150:151], v[114:115]
    v_pk_fma_f32 v[114:115], v[152:153], v[152:153], v[114:115]
    v_pk_fma_f32 v[114:115], v[154:155], v[154:155], v[114:115]
    v_pk_fma_f32 v[114:115], v[156:157], v[156:157], v[114:115]
    v_pk_fma_f32 v[114:115], v[158:159], v[158:159], v[114:115]
    v_mfma_f32_32x32x16_bf16 v[32:47], v[240:243], v[80:83], v[32:47]
    v_rcp_f32 v48, v48
    v_rcp_f32 v49, v49
    v_rcp_f32 v50, v50
    v_mfma_f32_32x32x16_bf16 v[32:47], v[244:247], v[84:87], v[32:47]
    v_rcp_f32 v51, v51
    v_rcp_f32 v52, v52
    v_rcp_f32 v53, v53
    v_mfma_f32_32x32x16_bf16 v[32:47], v[248:251], v[88:91], v[32:47]
    v_rcp_f32 v54, v54
    v_rcp_f32 v55, v55
    v_rcp_f32 v56, v56
    v_mfma_f32_32x32x16_bf16 v[32:47], v[252:255], v[92:95], v[32:47]
    v_rcp_f32 v57, v57
    v_rcp_f32 v58, v58
    v_rcp_f32 v59, v59
    v_rcp_f32 v60, v60
    v_rcp_f32 v61, v61
    v_rcp_f32 v62, v62
    v_rcp_f32 v63, v63
    v_pk_mul_f32 v[16:17], v[16:17], v[48:49]
    v_pk_mul_f32 v[18:19], v[18:19], v[50:51]
    v_pk_mul_f32 v[20:21], v[20:21], v[52:53]
    v_pk_mul_f32 v[22:23], v[22:23], v[54:55]
    v_pk_mul_f32 v[24:25], v[24:25], v[56:57]
    v_pk_mul_f32 v[26:27], v[26:27], v[58:59]
    v_pk_mul_f32 v[28:29], v[28:29], v[60:61]
    v_pk_mul_f32 v[30:31], v[30:31], v[62:63]
    v_pk_fma_f32 v[48:49], v[32:33], v[32:33], s[52:53]
    v_pk_fma_f32 v[50:51], v[34:35], v[34:35], s[52:53]
    v_pk_fma_f32 v[52:53], v[36:37], v[36:37], s[52:53]
    v_pk_fma_f32 v[54:55], v[38:39], v[38:39], s[52:53]
    v_pk_fma_f32 v[56:57], v[40:41], v[40:41], s[52:53]
    v_pk_fma_f32 v[58:59], v[42:43], v[42:43], s[52:53]
    v_pk_fma_f32 v[60:61], v[44:45], v[44:45], s[52:53]
    v_pk_fma_f32 v[62:63], v[46:47], v[46:47], s[52:53]
    v_pk_mul_f32 v[48:49], v[48:49], v[32:33] neg_lo:[1,0] neg_hi:[1,0]
    v_pk_mul_f32 v[50:51], v[50:51], v[34:35] neg_lo:[1,0] neg_hi:[1,0]
    v_pk_mul_f32 v[52:53], v[52:53], v[36:37] neg_lo:[1,0] neg_hi:[1,0]
    v_pk_mul_f32 v[54:55], v[54:55], v[38:39] neg_lo:[1,0] neg_hi:[1,0]
    v_pk_mul_f32 v[56:57], v[56:57], v[40:41] neg_lo:[1,0] neg_hi:[1,0]
    v_pk_mul_f32 v[58:59], v[58:59], v[42:43] neg_lo:[1,0] neg_hi:[1,0]
    v_pk_mul_f32 v[60:61], v[60:61], v[44:45] neg_lo:[1,0] neg_hi:[1,0]
    v_pk_mul_f32 v[62:63], v[62:63], v[46:47] neg_lo:[1,0] neg_hi:[1,0]
    v_cvt_pk_bf16_f32 v176, v16, v17
    v_cvt_pk_bf16_f32 v177, v18, v19
    v_cvt_pk_bf16_f32 v178, v20, v21
    v_cvt_pk_bf16_f32 v179, v22, v23
    v_cvt_pk_bf16_f32 v180, v24, v25
    v_cvt_pk_bf16_f32 v181, v26, v27
    v_cvt_pk_bf16_f32 v182, v28, v29
    v_cvt_pk_bf16_f32 v183, v30, v31
    v_mfma_f32_32x32x16_bf16 v[144:159], v[176:179], a[24:27], 0
    v_exp_f32 v48, v48
    v_exp_f32 v49, v49
    v_exp_f32 v50, v50
    v_mfma_f32_32x32x16_bf16 v[144:159], v[180:183], a[28:31], v[144:159]
    v_exp_f32 v51, v51
    v_exp_f32 v52, v52
    v_exp_f32 v53, v53
    v_mfma_f32_32x32x16_bf16 v[16:31], a[0:3], v[72:75], 0
    s_waitcnt lgkmcnt(3)
    ds_read_b128 a[20:23], v2 offset:5120
    ds_read_b128 a[0:3], v2 offset:6144
    v_exp_f32 v54, v54
    v_exp_f32 v55, v55
    v_mfma_f32_32x32x16_bf16 v[16:31], a[4:7], v[76:79], v[16:31]
    s_waitcnt lgkmcnt(4)
    v_exp_f32 v56, v56
    v_exp_f32 v57, v57
    v_exp_f32 v58, v58
    v_exp_f32 v59, v59
    v_exp_f32 v60, v60
    v_exp_f32 v61, v61
    v_exp_f32 v62, v62
    v_exp_f32 v63, v63
    v_pk_add_f32 v[48:49], v[48:49], 1.0 op_sel_hi:[1,0]
    v_pk_add_f32 v[50:51], v[50:51], 1.0 op_sel_hi:[1,0]
    v_pk_add_f32 v[52:53], v[52:53], 1.0 op_sel_hi:[1,0]
    v_pk_add_f32 v[54:55], v[54:55], 1.0 op_sel_hi:[1,0]
    v_pk_add_f32 v[56:57], v[56:57], 1.0 op_sel_hi:[1,0]
    v_pk_add_f32 v[58:59], v[58:59], 1.0 op_sel_hi:[1,0]
    v_pk_add_f32 v[60:61], v[60:61], 1.0 op_sel_hi:[1,0]
    v_pk_add_f32 v[62:63], v[62:63], 1.0 op_sel_hi:[1,0]
    v_pk_fma_f32 v[116:117], v[144:145], v[144:145], v[116:117]
    v_pk_fma_f32 v[116:117], v[146:147], v[146:147], v[116:117]
    v_pk_fma_f32 v[116:117], v[148:149], v[148:149], v[116:117]
    v_pk_fma_f32 v[116:117], v[150:151], v[150:151], v[116:117]
    v_pk_fma_f32 v[116:117], v[152:153], v[152:153], v[116:117]
    v_pk_fma_f32 v[116:117], v[154:155], v[154:155], v[116:117]
    v_pk_fma_f32 v[116:117], v[156:157], v[156:157], v[116:117]
    v_pk_fma_f32 v[116:117], v[158:159], v[158:159], v[116:117]
    v_mfma_f32_32x32x16_bf16 v[16:31], a[8:11], v[80:83], v[16:31]
    s_waitcnt lgkmcnt(3)
    ds_read_b128 a[4:7], v2 offset:7168
    ds_read_b128 a[8:11], v2 offset:8192
    v_rcp_f32 v48, v48
    v_rcp_f32 v49, v49
    v_mfma_f32_32x32x16_bf16 v[16:31], a[12:15], v[84:87], v[16:31]
    s_waitcnt lgkmcnt(4)
    v_rcp_f32 v50, v50
    v_rcp_f32 v51, v51
    v_rcp_f32 v52, v52
    v_mfma_f32_32x32x16_bf16 v[16:31], a[16:19], v[88:91], v[16:31]
    s_waitcnt lgkmcnt(3)
    ds_read_b128 a[12:15], v2 offset:9216
    ds_read_b128 a[16:19], v2 offset:10240
    v_rcp_f32 v53, v53
    v_rcp_f32 v54, v54
    v_mfma_f32_32x32x16_bf16 v[16:31], a[20:23], v[92:95], v[16:31]
    s_waitcnt lgkmcnt(4)
    v_rcp_f32 v55, v55
    v_rcp_f32 v56, v56
    v_rcp_f32 v57, v57
    v_rcp_f32 v58, v58
    v_rcp_f32 v59, v59
    v_rcp_f32 v60, v60
    v_rcp_f32 v61, v61
    v_rcp_f32 v62, v62
    v_rcp_f32 v63, v63
    v_pk_mul_f32 v[32:33], v[32:33], v[48:49]
    v_pk_mul_f32 v[34:35], v[34:35], v[50:51]
    v_pk_mul_f32 v[36:37], v[36:37], v[52:53]
    v_pk_mul_f32 v[38:39], v[38:39], v[54:55]
    v_pk_mul_f32 v[40:41], v[40:41], v[56:57]
    v_pk_mul_f32 v[42:43], v[42:43], v[58:59]
    v_pk_mul_f32 v[44:45], v[44:45], v[60:61]
    v_pk_mul_f32 v[46:47], v[46:47], v[62:63]
    v_pk_fma_f32 v[48:49], v[16:17], v[16:17], s[52:53]
    v_pk_fma_f32 v[50:51], v[18:19], v[18:19], s[52:53]
    v_pk_fma_f32 v[52:53], v[20:21], v[20:21], s[52:53]
    v_pk_fma_f32 v[54:55], v[22:23], v[22:23], s[52:53]
    v_pk_fma_f32 v[56:57], v[24:25], v[24:25], s[52:53]
    v_pk_fma_f32 v[58:59], v[26:27], v[26:27], s[52:53]
    v_pk_fma_f32 v[60:61], v[28:29], v[28:29], s[52:53]
    v_pk_fma_f32 v[62:63], v[30:31], v[30:31], s[52:53]
    v_pk_mul_f32 v[48:49], v[48:49], v[16:17] neg_lo:[1,0] neg_hi:[1,0]
    v_pk_mul_f32 v[50:51], v[50:51], v[18:19] neg_lo:[1,0] neg_hi:[1,0]
    v_pk_mul_f32 v[52:53], v[52:53], v[20:21] neg_lo:[1,0] neg_hi:[1,0]
    v_pk_mul_f32 v[54:55], v[54:55], v[22:23] neg_lo:[1,0] neg_hi:[1,0]
    v_pk_mul_f32 v[56:57], v[56:57], v[24:25] neg_lo:[1,0] neg_hi:[1,0]
    v_pk_mul_f32 v[58:59], v[58:59], v[26:27] neg_lo:[1,0] neg_hi:[1,0]
    v_pk_mul_f32 v[60:61], v[60:61], v[28:29] neg_lo:[1,0] neg_hi:[1,0]
    v_pk_mul_f32 v[62:63], v[62:63], v[30:31] neg_lo:[1,0] neg_hi:[1,0]
    v_cvt_pk_bf16_f32 v184, v32, v33
    v_cvt_pk_bf16_f32 v185, v34, v35
    v_cvt_pk_bf16_f32 v186, v36, v37
    v_cvt_pk_bf16_f32 v187, v38, v39
    v_cvt_pk_bf16_f32 v188, v40, v41
    v_cvt_pk_bf16_f32 v189, v42, v43
    v_cvt_pk_bf16_f32 v190, v44, v45
    v_cvt_pk_bf16_f32 v191, v46, v47
    v_mfma_f32_32x32x16_bf16 v[144:159], v[184:187], a[24:27], 0
    v_exp_f32 v48, v48
    v_exp_f32 v49, v49
    v_exp_f32 v50, v50
    v_mfma_f32_32x32x16_bf16 v[144:159], v[188:191], a[28:31], v[144:159]
    v_exp_f32 v51, v51
    v_exp_f32 v52, v52
    v_exp_f32 v53, v53
    v_mfma_f32_32x32x16_bf16 v[32:47], a[0:3], v[72:75], 0
    s_waitcnt lgkmcnt(3)
    ds_read_b128 a[20:23], v2 offset:11264
    ds_read_b128 a[0:3], v2 offset:12288
    v_exp_f32 v54, v54
    v_exp_f32 v55, v55
    v_mfma_f32_32x32x16_bf16 v[32:47], a[4:7], v[76:79], v[32:47]
    s_waitcnt lgkmcnt(4)
    v_exp_f32 v56, v56
    v_exp_f32 v57, v57
    v_exp_f32 v58, v58
    v_exp_f32 v59, v59
    v_exp_f32 v60, v60
    v_exp_f32 v61, v61
    v_exp_f32 v62, v62
    v_exp_f32 v63, v63
    v_pk_add_f32 v[48:49], v[48:49], 1.0 op_sel_hi:[1,0]
    v_pk_add_f32 v[50:51], v[50:51], 1.0 op_sel_hi:[1,0]
    v_pk_add_f32 v[52:53], v[52:53], 1.0 op_sel_hi:[1,0]
    v_pk_add_f32 v[54:55], v[54:55], 1.0 op_sel_hi:[1,0]
    v_pk_add_f32 v[56:57], v[56:57], 1.0 op_sel_hi:[1,0]
    v_pk_add_f32 v[58:59], v[58:59], 1.0 op_sel_hi:[1,0]
    v_pk_add_f32 v[60:61], v[60:61], 1.0 op_sel_hi:[1,0]
    v_pk_add_f32 v[62:63], v[62:63], 1.0 op_sel_hi:[1,0]
    v_pk_fma_f32 v[118:119], v[144:145], v[144:145], v[118:119]
    v_pk_fma_f32 v[118:119], v[146:147], v[146:147], v[118:119]
    v_pk_fma_f32 v[118:119], v[148:149], v[148:149], v[118:119]
    v_pk_fma_f32 v[118:119], v[150:151], v[150:151], v[118:119]
    v_pk_fma_f32 v[118:119], v[152:153], v[152:153], v[118:119]
    v_pk_fma_f32 v[118:119], v[154:155], v[154:155], v[118:119]
    v_pk_fma_f32 v[118:119], v[156:157], v[156:157], v[118:119]
    v_pk_fma_f32 v[118:119], v[158:159], v[158:159], v[118:119]
    v_mfma_f32_32x32x16_bf16 v[32:47], a[8:11], v[80:83], v[32:47]
    s_waitcnt lgkmcnt(3)
    ds_read_b128 a[4:7], v2 offset:13312
    ds_read_b128 a[8:11], v2 offset:14336
    v_rcp_f32 v48, v48
    v_rcp_f32 v49, v49
    v_mfma_f32_32x32x16_bf16 v[32:47], a[12:15], v[84:87], v[32:47]
    s_waitcnt lgkmcnt(4)
    v_rcp_f32 v50, v50
    v_rcp_f32 v51, v51
    v_rcp_f32 v52, v52
    v_mfma_f32_32x32x16_bf16 v[32:47], a[16:19], v[88:91], v[32:47]
    s_waitcnt lgkmcnt(3)
    ds_read_b128 a[12:15], v2 offset:15360
    ds_read_b128 a[16:19], v2 offset:16384
    v_rcp_f32 v53, v53
    v_rcp_f32 v54, v54
    v_mfma_f32_32x32x16_bf16 v[32:47], a[20:23], v[92:95], v[32:47]
    s_waitcnt lgkmcnt(4)
    v_rcp_f32 v55, v55
    v_rcp_f32 v56, v56
    v_rcp_f32 v57, v57
    v_rcp_f32 v58, v58
    v_rcp_f32 v59, v59
    v_rcp_f32 v60, v60
    v_rcp_f32 v61, v61
    v_rcp_f32 v62, v62
    v_rcp_f32 v63, v63
    v_pk_mul_f32 v[16:17], v[16:17], v[48:49]
    v_pk_mul_f32 v[18:19], v[18:19], v[50:51]
    v_pk_mul_f32 v[20:21], v[20:21], v[52:53]
    v_pk_mul_f32 v[22:23], v[22:23], v[54:55]
    v_pk_mul_f32 v[24:25], v[24:25], v[56:57]
    v_pk_mul_f32 v[26:27], v[26:27], v[58:59]
    v_pk_mul_f32 v[28:29], v[28:29], v[60:61]
    v_pk_mul_f32 v[30:31], v[30:31], v[62:63]
    v_pk_fma_f32 v[48:49], v[32:33], v[32:33], s[52:53]
    v_pk_fma_f32 v[50:51], v[34:35], v[34:35], s[52:53]
    v_pk_fma_f32 v[52:53], v[36:37], v[36:37], s[52:53]
    v_pk_fma_f32 v[54:55], v[38:39], v[38:39], s[52:53]
    v_pk_fma_f32 v[56:57], v[40:41], v[40:41], s[52:53]
    v_pk_fma_f32 v[58:59], v[42:43], v[42:43], s[52:53]
    v_pk_fma_f32 v[60:61], v[44:45], v[44:45], s[52:53]
    v_pk_fma_f32 v[62:63], v[46:47], v[46:47], s[52:53]
    v_pk_mul_f32 v[48:49], v[48:49], v[32:33] neg_lo:[1,0] neg_hi:[1,0]
    v_pk_mul_f32 v[50:51], v[50:51], v[34:35] neg_lo:[1,0] neg_hi:[1,0]
    v_pk_mul_f32 v[52:53], v[52:53], v[36:37] neg_lo:[1,0] neg_hi:[1,0]
    v_pk_mul_f32 v[54:55], v[54:55], v[38:39] neg_lo:[1,0] neg_hi:[1,0]
    v_pk_mul_f32 v[56:57], v[56:57], v[40:41] neg_lo:[1,0] neg_hi:[1,0]
    v_pk_mul_f32 v[58:59], v[58:59], v[42:43] neg_lo:[1,0] neg_hi:[1,0]
    v_pk_mul_f32 v[60:61], v[60:61], v[44:45] neg_lo:[1,0] neg_hi:[1,0]
    v_pk_mul_f32 v[62:63], v[62:63], v[46:47] neg_lo:[1,0] neg_hi:[1,0]
    v_cvt_pk_bf16_f32 v192, v16, v17
    v_cvt_pk_bf16_f32 v193, v18, v19
    v_cvt_pk_bf16_f32 v194, v20, v21
    v_cvt_pk_bf16_f32 v195, v22, v23
    v_cvt_pk_bf16_f32 v196, v24, v25
    v_cvt_pk_bf16_f32 v197, v26, v27
    v_cvt_pk_bf16_f32 v198, v28, v29
    v_cvt_pk_bf16_f32 v199, v30, v31
    v_mfma_f32_32x32x16_bf16 v[144:159], v[192:195], a[24:27], 0
    v_exp_f32 v48, v48
    v_exp_f32 v49, v49
    v_exp_f32 v50, v50
    v_mfma_f32_32x32x16_bf16 v[144:159], v[196:199], a[28:31], v[144:159]
    v_exp_f32 v51, v51
    v_exp_f32 v52, v52
    v_exp_f32 v53, v53
    v_mfma_f32_32x32x16_bf16 v[16:31], a[0:3], v[72:75], 0
    s_waitcnt lgkmcnt(3)
    ds_read_b128 a[20:23], v2 offset:17408
    ds_read_b128 a[0:3], v2 offset:18432
    v_exp_f32 v54, v54
    v_exp_f32 v55, v55
    v_mfma_f32_32x32x16_bf16 v[16:31], a[4:7], v[76:79], v[16:31]
    s_waitcnt lgkmcnt(4)
    v_exp_f32 v56, v56
    v_exp_f32 v57, v57
    v_exp_f32 v58, v58
    v_exp_f32 v59, v59
    v_exp_f32 v60, v60
    v_exp_f32 v61, v61
    v_exp_f32 v62, v62
    v_exp_f32 v63, v63
    v_pk_add_f32 v[48:49], v[48:49], 1.0 op_sel_hi:[1,0]
    v_pk_add_f32 v[50:51], v[50:51], 1.0 op_sel_hi:[1,0]
    v_pk_add_f32 v[52:53], v[52:53], 1.0 op_sel_hi:[1,0]
    v_pk_add_f32 v[54:55], v[54:55], 1.0 op_sel_hi:[1,0]
    v_pk_add_f32 v[56:57], v[56:57], 1.0 op_sel_hi:[1,0]
    v_pk_add_f32 v[58:59], v[58:59], 1.0 op_sel_hi:[1,0]
    v_pk_add_f32 v[60:61], v[60:61], 1.0 op_sel_hi:[1,0]
    v_pk_add_f32 v[62:63], v[62:63], 1.0 op_sel_hi:[1,0]
    v_pk_fma_f32 v[96:97], v[144:145], v[144:145], v[96:97]
    v_pk_fma_f32 v[96:97], v[146:147], v[146:147], v[96:97]
    v_pk_fma_f32 v[96:97], v[148:149], v[148:149], v[96:97]
    v_pk_fma_f32 v[96:97], v[150:151], v[150:151], v[96:97]
    v_pk_fma_f32 v[96:97], v[152:153], v[152:153], v[96:97]
    v_pk_fma_f32 v[96:97], v[154:155], v[154:155], v[96:97]
    v_pk_fma_f32 v[96:97], v[156:157], v[156:157], v[96:97]
    v_pk_fma_f32 v[96:97], v[158:159], v[158:159], v[96:97]
    v_mfma_f32_32x32x16_bf16 v[16:31], a[8:11], v[80:83], v[16:31]
    s_waitcnt lgkmcnt(3)
    ds_read_b128 a[4:7], v2 offset:19456
    ds_read_b128 a[8:11], v2 offset:20480
    v_rcp_f32 v48, v48
    v_rcp_f32 v49, v49
    v_mfma_f32_32x32x16_bf16 v[16:31], a[12:15], v[84:87], v[16:31]
    s_waitcnt lgkmcnt(4)
    v_rcp_f32 v50, v50
    v_rcp_f32 v51, v51
    v_rcp_f32 v52, v52
    v_mfma_f32_32x32x16_bf16 v[16:31], a[16:19], v[88:91], v[16:31]
    s_waitcnt lgkmcnt(3)
    ds_read_b128 a[12:15], v2 offset:21504
    ds_read_b128 a[16:19], v2 offset:22528
    v_rcp_f32 v53, v53
    v_rcp_f32 v54, v54
    v_mfma_f32_32x32x16_bf16 v[16:31], a[20:23], v[92:95], v[16:31]
    s_waitcnt lgkmcnt(4)
    v_rcp_f32 v55, v55
    v_rcp_f32 v56, v56
    v_rcp_f32 v57, v57
    v_rcp_f32 v58, v58
    v_rcp_f32 v59, v59
    v_rcp_f32 v60, v60
    v_rcp_f32 v61, v61
    v_rcp_f32 v62, v62
    v_rcp_f32 v63, v63
    v_pk_mul_f32 v[32:33], v[32:33], v[48:49]
    v_pk_mul_f32 v[34:35], v[34:35], v[50:51]
    v_pk_mul_f32 v[36:37], v[36:37], v[52:53]
    v_pk_mul_f32 v[38:39], v[38:39], v[54:55]
    v_pk_mul_f32 v[40:41], v[40:41], v[56:57]
    v_pk_mul_f32 v[42:43], v[42:43], v[58:59]
    v_pk_mul_f32 v[44:45], v[44:45], v[60:61]
    v_pk_mul_f32 v[46:47], v[46:47], v[62:63]
    v_pk_fma_f32 v[48:49], v[16:17], v[16:17], s[52:53]
    v_pk_fma_f32 v[50:51], v[18:19], v[18:19], s[52:53]
    v_pk_fma_f32 v[52:53], v[20:21], v[20:21], s[52:53]
    v_pk_fma_f32 v[54:55], v[22:23], v[22:23], s[52:53]
    v_pk_fma_f32 v[56:57], v[24:25], v[24:25], s[52:53]
    v_pk_fma_f32 v[58:59], v[26:27], v[26:27], s[52:53]
    v_pk_fma_f32 v[60:61], v[28:29], v[28:29], s[52:53]
    v_pk_fma_f32 v[62:63], v[30:31], v[30:31], s[52:53]
    v_pk_mul_f32 v[48:49], v[48:49], v[16:17] neg_lo:[1,0] neg_hi:[1,0]
    v_pk_mul_f32 v[50:51], v[50:51], v[18:19] neg_lo:[1,0] neg_hi:[1,0]
    v_pk_mul_f32 v[52:53], v[52:53], v[20:21] neg_lo:[1,0] neg_hi:[1,0]
    v_pk_mul_f32 v[54:55], v[54:55], v[22:23] neg_lo:[1,0] neg_hi:[1,0]
    v_pk_mul_f32 v[56:57], v[56:57], v[24:25] neg_lo:[1,0] neg_hi:[1,0]
    v_pk_mul_f32 v[58:59], v[58:59], v[26:27] neg_lo:[1,0] neg_hi:[1,0]
    v_pk_mul_f32 v[60:61], v[60:61], v[28:29] neg_lo:[1,0] neg_hi:[1,0]
    v_pk_mul_f32 v[62:63], v[62:63], v[30:31] neg_lo:[1,0] neg_hi:[1,0]
    v_cvt_pk_bf16_f32 v200, v32, v33
    v_cvt_pk_bf16_f32 v201, v34, v35
    v_cvt_pk_bf16_f32 v202, v36, v37
    v_cvt_pk_bf16_f32 v203, v38, v39
    v_cvt_pk_bf16_f32 v204, v40, v41
    v_cvt_pk_bf16_f32 v205, v42, v43
    v_cvt_pk_bf16_f32 v206, v44, v45
    v_cvt_pk_bf16_f32 v207, v46, v47
    v_mfma_f32_32x32x16_bf16 v[144:159], v[200:203], a[24:27], 0
    v_exp_f32 v48, v48
    v_exp_f32 v49, v49
    v_exp_f32 v50, v50
    v_mfma_f32_32x32x16_bf16 v[144:159], v[204:207], a[28:31], v[144:159]
    v_exp_f32 v51, v51
    v_exp_f32 v52, v52
    v_exp_f32 v53, v53
    v_mfma_f32_32x32x16_bf16 v[32:47], a[0:3], v[72:75], 0
    s_waitcnt lgkmcnt(3)
    ds_read_b128 a[20:23], v2 offset:23552
    ds_read_b128 a[0:3], v2 offset:24576
    v_exp_f32 v54, v54
    v_exp_f32 v55, v55
    v_mfma_f32_32x32x16_bf16 v[32:47], a[4:7], v[76:79], v[32:47]
    s_waitcnt lgkmcnt(4)
    v_exp_f32 v56, v56
    v_exp_f32 v57, v57
    v_exp_f32 v58, v58
    v_exp_f32 v59, v59
    v_exp_f32 v60, v60
    v_exp_f32 v61, v61
    v_exp_f32 v62, v62
    v_exp_f32 v63, v63
    v_pk_add_f32 v[48:49], v[48:49], 1.0 op_sel_hi:[1,0]
    v_pk_add_f32 v[50:51], v[50:51], 1.0 op_sel_hi:[1,0]
    v_pk_add_f32 v[52:53], v[52:53], 1.0 op_sel_hi:[1,0]
    v_pk_add_f32 v[54:55], v[54:55], 1.0 op_sel_hi:[1,0]
    v_pk_add_f32 v[56:57], v[56:57], 1.0 op_sel_hi:[1,0]
    v_pk_add_f32 v[58:59], v[58:59], 1.0 op_sel_hi:[1,0]
    v_pk_add_f32 v[60:61], v[60:61], 1.0 op_sel_hi:[1,0]
    v_pk_add_f32 v[62:63], v[62:63], 1.0 op_sel_hi:[1,0]
    v_pk_fma_f32 v[98:99], v[144:145], v[144:145], v[98:99]
    v_pk_fma_f32 v[98:99], v[146:147], v[146:147], v[98:99]
    v_pk_fma_f32 v[98:99], v[148:149], v[148:149], v[98:99]
    v_pk_fma_f32 v[98:99], v[150:151], v[150:151], v[98:99]
    v_pk_fma_f32 v[98:99], v[152:153], v[152:153], v[98:99]
    v_pk_fma_f32 v[98:99], v[154:155], v[154:155], v[98:99]
    v_pk_fma_f32 v[98:99], v[156:157], v[156:157], v[98:99]
    v_pk_fma_f32 v[98:99], v[158:159], v[158:159], v[98:99]
    v_mfma_f32_32x32x16_bf16 v[32:47], a[8:11], v[80:83], v[32:47]
    s_waitcnt lgkmcnt(3)
    ds_read_b128 a[4:7], v2 offset:25600
    ds_read_b128 a[8:11], v2 offset:26624
    v_rcp_f32 v48, v48
    v_rcp_f32 v49, v49
    v_mfma_f32_32x32x16_bf16 v[32:47], a[12:15], v[84:87], v[32:47]
    s_waitcnt lgkmcnt(4)
    v_rcp_f32 v50, v50
    v_rcp_f32 v51, v51
    v_rcp_f32 v52, v52
    v_mfma_f32_32x32x16_bf16 v[32:47], a[16:19], v[88:91], v[32:47]
    s_waitcnt lgkmcnt(3)
    ds_read_b128 a[12:15], v2 offset:27648
    ds_read_b128 a[16:19], v2 offset:28672
    v_rcp_f32 v53, v53
    v_rcp_f32 v54, v54
    v_mfma_f32_32x32x16_bf16 v[32:47], a[20:23], v[92:95], v[32:47]
    s_waitcnt lgkmcnt(4)
    v_rcp_f32 v55, v55
    v_rcp_f32 v56, v56
    v_rcp_f32 v57, v57
    v_rcp_f32 v58, v58
    v_rcp_f32 v59, v59
    v_rcp_f32 v60, v60
    v_rcp_f32 v61, v61
    v_rcp_f32 v62, v62
    v_rcp_f32 v63, v63
    v_pk_mul_f32 v[16:17], v[16:17], v[48:49]
    v_pk_mul_f32 v[18:19], v[18:19], v[50:51]
    v_pk_mul_f32 v[20:21], v[20:21], v[52:53]
    v_pk_mul_f32 v[22:23], v[22:23], v[54:55]
    v_pk_mul_f32 v[24:25], v[24:25], v[56:57]
    v_pk_mul_f32 v[26:27], v[26:27], v[58:59]
    v_pk_mul_f32 v[28:29], v[28:29], v[60:61]
    v_pk_mul_f32 v[30:31], v[30:31], v[62:63]
    v_pk_fma_f32 v[48:49], v[32:33], v[32:33], s[52:53]
    v_pk_fma_f32 v[50:51], v[34:35], v[34:35], s[52:53]
    v_pk_fma_f32 v[52:53], v[36:37], v[36:37], s[52:53]
    v_pk_fma_f32 v[54:55], v[38:39], v[38:39], s[52:53]
    v_pk_fma_f32 v[56:57], v[40:41], v[40:41], s[52:53]
    v_pk_fma_f32 v[58:59], v[42:43], v[42:43], s[52:53]
    v_pk_fma_f32 v[60:61], v[44:45], v[44:45], s[52:53]
    v_pk_fma_f32 v[62:63], v[46:47], v[46:47], s[52:53]
    v_pk_mul_f32 v[48:49], v[48:49], v[32:33] neg_lo:[1,0] neg_hi:[1,0]
    v_pk_mul_f32 v[50:51], v[50:51], v[34:35] neg_lo:[1,0] neg_hi:[1,0]
    v_pk_mul_f32 v[52:53], v[52:53], v[36:37] neg_lo:[1,0] neg_hi:[1,0]
    v_pk_mul_f32 v[54:55], v[54:55], v[38:39] neg_lo:[1,0] neg_hi:[1,0]
    v_pk_mul_f32 v[56:57], v[56:57], v[40:41] neg_lo:[1,0] neg_hi:[1,0]
    v_pk_mul_f32 v[58:59], v[58:59], v[42:43] neg_lo:[1,0] neg_hi:[1,0]
    v_pk_mul_f32 v[60:61], v[60:61], v[44:45] neg_lo:[1,0] neg_hi:[1,0]
    v_pk_mul_f32 v[62:63], v[62:63], v[46:47] neg_lo:[1,0] neg_hi:[1,0]
    v_cvt_pk_bf16_f32 v208, v16, v17
    v_cvt_pk_bf16_f32 v209, v18, v19
    v_cvt_pk_bf16_f32 v210, v20, v21
    v_cvt_pk_bf16_f32 v211, v22, v23
    v_cvt_pk_bf16_f32 v212, v24, v25
    v_cvt_pk_bf16_f32 v213, v26, v27
    v_cvt_pk_bf16_f32 v214, v28, v29
    v_cvt_pk_bf16_f32 v215, v30, v31
    v_mfma_f32_32x32x16_bf16 v[144:159], v[208:211], a[24:27], 0
    v_exp_f32 v48, v48
    v_exp_f32 v49, v49
    v_exp_f32 v50, v50
    v_mfma_f32_32x32x16_bf16 v[144:159], v[212:215], a[28:31], v[144:159]
    v_exp_f32 v51, v51
    v_exp_f32 v52, v52
    v_exp_f32 v53, v53
    v_mfma_f32_32x32x16_bf16 v[16:31], a[0:3], v[72:75], 0
    s_waitcnt lgkmcnt(3)
    ds_read_b128 a[20:23], v2 offset:29696
    ds_read_b128 a[0:3], v2 offset:30720
    v_exp_f32 v54, v54
    v_exp_f32 v55, v55
    v_mfma_f32_32x32x16_bf16 v[16:31], a[4:7], v[76:79], v[16:31]
    s_waitcnt lgkmcnt(4)
    v_exp_f32 v56, v56
    v_exp_f32 v57, v57
    v_exp_f32 v58, v58
    v_exp_f32 v59, v59
    v_exp_f32 v60, v60
    v_exp_f32 v61, v61
    v_exp_f32 v62, v62
    v_exp_f32 v63, v63
    v_pk_add_f32 v[48:49], v[48:49], 1.0 op_sel_hi:[1,0]
    v_pk_add_f32 v[50:51], v[50:51], 1.0 op_sel_hi:[1,0]
    v_pk_add_f32 v[52:53], v[52:53], 1.0 op_sel_hi:[1,0]
    v_pk_add_f32 v[54:55], v[54:55], 1.0 op_sel_hi:[1,0]
    v_pk_add_f32 v[56:57], v[56:57], 1.0 op_sel_hi:[1,0]
    v_pk_add_f32 v[58:59], v[58:59], 1.0 op_sel_hi:[1,0]
    v_pk_add_f32 v[60:61], v[60:61], 1.0 op_sel_hi:[1,0]
    v_pk_add_f32 v[62:63], v[62:63], 1.0 op_sel_hi:[1,0]
    v_pk_fma_f32 v[100:101], v[144:145], v[144:145], v[100:101]
    v_pk_fma_f32 v[100:101], v[146:147], v[146:147], v[100:101]
    v_pk_fma_f32 v[100:101], v[148:149], v[148:149], v[100:101]
    v_pk_fma_f32 v[100:101], v[150:151], v[150:151], v[100:101]
    v_pk_fma_f32 v[100:101], v[152:153], v[152:153], v[100:101]
    v_pk_fma_f32 v[100:101], v[154:155], v[154:155], v[100:101]
    v_pk_fma_f32 v[100:101], v[156:157], v[156:157], v[100:101]
    v_pk_fma_f32 v[100:101], v[158:159], v[158:159], v[100:101]
    v_mfma_f32_32x32x16_bf16 v[16:31], a[8:11], v[80:83], v[16:31]
    s_waitcnt lgkmcnt(3)
    ds_read_b128 a[4:7], v2 offset:31744
    ds_read_b128 a[8:11], v2 offset:32768
    v_rcp_f32 v48, v48
    v_rcp_f32 v49, v49
    v_mfma_f32_32x32x16_bf16 v[16:31], a[12:15], v[84:87], v[16:31]
    s_waitcnt lgkmcnt(4)
    s_waitcnt vmcnt(1)
    v_rcp_f32 v50, v50
    v_rcp_f32 v51, v51
    v_rcp_f32 v52, v52
    v_mfma_f32_32x32x16_bf16 v[16:31], a[16:19], v[88:91], v[16:31]
    s_waitcnt lgkmcnt(3)
    ds_read_b128 a[12:15], v2 offset:33792
    ds_read_b128 a[16:19], v2 offset:34816
    v_rcp_f32 v53, v53
    v_rcp_f32 v54, v54
    v_mfma_f32_32x32x16_bf16 v[16:31], a[20:23], v[92:95], v[16:31]
    s_waitcnt lgkmcnt(4)
    v_rcp_f32 v55, v55
    v_rcp_f32 v56, v56
    v_rcp_f32 v57, v57
    v_rcp_f32 v58, v58
    v_rcp_f32 v59, v59
    v_rcp_f32 v60, v60
    v_rcp_f32 v61, v61
    v_rcp_f32 v62, v62
    v_rcp_f32_e64 v63, v63
    v_pk_mul_f32 v[32:33], v[32:33], v[48:49]
    v_pk_mul_f32 v[34:35], v[34:35], v[50:51]
    v_pk_mul_f32 v[36:37], v[36:37], v[52:53]
    v_pk_mul_f32 v[38:39], v[38:39], v[54:55]
    v_pk_mul_f32 v[40:41], v[40:41], v[56:57]
    v_pk_mul_f32 v[42:43], v[42:43], v[58:59]
    v_pk_mul_f32 v[44:45], v[44:45], v[60:61]
    v_pk_mul_f32 v[46:47], v[46:47], v[62:63]
    v_pk_fma_f32 v[48:49], v[16:17], v[16:17], s[52:53]
    v_pk_fma_f32 v[50:51], v[18:19], v[18:19], s[52:53]
    v_pk_fma_f32 v[52:53], v[20:21], v[20:21], s[52:53]
    v_pk_fma_f32 v[54:55], v[22:23], v[22:23], s[52:53]
    v_pk_fma_f32 v[56:57], v[24:25], v[24:25], s[52:53]
    v_pk_fma_f32 v[58:59], v[26:27], v[26:27], s[52:53]
    v_pk_fma_f32 v[60:61], v[28:29], v[28:29], s[52:53]
    v_pk_fma_f32 v[62:63], v[30:31], v[30:31], s[52:53]
    v_pk_mul_f32 v[48:49], v[48:49], v[16:17] neg_lo:[1,0] neg_hi:[1,0]
    v_pk_mul_f32 v[50:51], v[50:51], v[18:19] neg_lo:[1,0] neg_hi:[1,0]
    v_pk_mul_f32 v[52:53], v[52:53], v[20:21] neg_lo:[1,0] neg_hi:[1,0]
    v_pk_mul_f32 v[54:55], v[54:55], v[22:23] neg_lo:[1,0] neg_hi:[1,0]
    v_pk_mul_f32 v[56:57], v[56:57], v[24:25] neg_lo:[1,0] neg_hi:[1,0]
    v_pk_mul_f32 v[58:59], v[58:59], v[26:27] neg_lo:[1,0] neg_hi:[1,0]
    v_pk_mul_f32 v[60:61], v[60:61], v[28:29] neg_lo:[1,0] neg_hi:[1,0]
    v_pk_mul_f32 v[62:63], v[62:63], v[30:31] neg_lo:[1,0] neg_hi:[1,0]
L_pf11:
    v_cvt_pk_bf16_f32 v216, v32, v33
    v_cvt_pk_bf16_f32 v217, v34, v35
    v_cvt_pk_bf16_f32 v218, v36, v37
    v_cvt_pk_bf16_f32 v219, v38, v39
    v_cvt_pk_bf16_f32 v220, v40, v41
    v_cvt_pk_bf16_f32 v221, v42, v43
    v_cvt_pk_bf16_f32 v222, v44, v45
    v_cvt_pk_bf16_f32 v223, v46, v47
    v_mfma_f32_32x32x16_bf16 v[32:47], v[216:219], a[24:27], 0
    s_mov_b32 s63, L_pf11-L_pc+12288
    buffer_load_dword v6, v7, s[68:71], s63 offen
    v_exp_f32 v48, v48
    v_exp_f32 v49, v49
    v_exp_f32 v50, v50
    v_mfma_f32_32x32x16_bf16 v[32:47], v[220:223], a[28:31], v[32:47]
    v_exp_f32 v51, v51
    v_exp_f32 v52, v52
    v_exp_f32 v53, v53
    v_mfma_f32_32x32x16_bf16 v[144:159], v[120:123], a[224:227], 0
    v_exp_f32 v54, v54
    v_exp_f32 v55, v55
    v_exp_f32 v56, v56
    v_mfma_f32_32x32x16_bf16 v[144:159], v[124:127], a[228:231], v[144:159]
    v_exp_f32 v57, v57
    v_exp_f32 v58, v58
    v_exp_f32 v59, v59
    v_exp_f32 v60, v60
    v_exp_f32 v61, v61
    v_exp_f32 v62, v62
    v_exp_f32 v63, v63
    v_pk_add_f32 v[48:49], v[48:49], 1.0 op_sel_hi:[1,0]
    v_pk_add_f32 v[50:51], v[50:51], 1.0 op_sel_hi:[1,0]
    v_pk_add_f32 v[52:53], v[52:53], 1.0 op_sel_hi:[1,0]
    v_pk_add_f32 v[54:55], v[54:55], 1.0 op_sel_hi:[1,0]
    v_pk_add_f32 v[56:57], v[56:57], 1.0 op_sel_hi:[1,0]
    v_pk_add_f32 v[58:59], v[58:59], 1.0 op_sel_hi:[1,0]
    v_pk_add_f32 v[60:61], v[60:61], 1.0 op_sel_hi:[1,0]
    v_pk_add_f32 v[62:63], v[62:63], 1.0 op_sel_hi:[1,0]
    v_pk_fma_f32 v[102:103], v[32:33], v[32:33], v[102:103]
    v_pk_fma_f32 v[102:103], v[34:35], v[34:35], v[102:103]
    v_pk_fma_f32 v[102:103], v[36:37], v[36:37], v[102:103]
    v_pk_fma_f32 v[102:103], v[38:39], v[38:39], v[102:103]
    v_pk_fma_f32 v[102:103], v[40:41], v[40:41], v[102:103]
    v_pk_fma_f32 v[102:103], v[42:43], v[42:43], v[102:103]
    v_pk_fma_f32 v[102:103], v[44:45], v[44:45], v[102:103]
    v_pk_fma_f32 v[102:103], v[46:47], v[46:47], v[102:103]
    v_pk_mul_f32 v[10:11], v[144:145], v[144:145]
    v_pk_add_f32 v[8:9], v[144:145], v[146:147]
    v_pk_fma_f32 v[10:11], v[146:147], v[146:147], v[10:11]
    v_pk_add_f32 v[8:9], v[8:9], v[148:149]
    v_pk_fma_f32 v[10:11], v[148:149], v[148:149], v[10:11]
    v_pk_add_f32 v[8:9], v[8:9], v[150:151]
    v_pk_fma_f32 v[10:11], v[150:151], v[150:151], v[10:11]
    v_pk_add_f32 v[8:9], v[8:9], v[152:153]
    v_pk_fma_f32 v[10:11], v[152:153], v[152:153], v[10:11]
    v_pk_add_f32 v[8:9], v[8:9], v[154:155]
    v_pk_fma_f32 v[10:11], v[154:155], v[154:155], v[10:11]
    v_pk_add_f32 v[8:9], v[8:9], v[156:157]
    v_pk_fma_f32 v[10:11], v[156:157], v[156:157], v[10:11]
    v_pk_add_f32 v[8:9], v[8:9], v[158:159]
    v_pk_fma_f32 v[10:11], v[158:159], v[158:159], v[10:11]
    v_mfma_f32_32x32x16_bf16 v[32:47], a[0:3], v[72:75], 0
    s_waitcnt lgkmcnt(3)
    ds_read_b128 a[20:23], v2 offset:35840
    ds_read_b128 a[0:3], v2 offset:36864
    v_rcp_f32 v48, v48
    v_rcp_f32 v49, v49
    v_mfma_f32_32x32x16_bf16 v[32:47], a[4:7], v[76:79], v[32:47]
    s_waitcnt lgkmcnt(4)
    v_rcp_f32 v50, v50
    v_rcp_f32 v51, v51
    v_rcp_f32 v52, v52
    v_mfma_f32_32x32x16_bf16 v[32:47], a[8:11], v[80:83], v[32:47]
    s_waitcnt lgkmcnt(3)
    ds_read_b128 a[4:7], v2 offset:37888
    ds_read_b128 a[8:11], v2 offset:38912
    v_rcp_f32 v53, v53
    v_rcp_f32 v54, v54
    v_mfma_f32_32x32x16_bf16 v[32:47], a[12:15], v[84:87], v[32:47]
    s_waitcnt lgkmcnt(4)
    v_rcp_f32 v55, v55
    v_rcp_f32 v56, v56
    v_rcp_f32 v57, v57
    v_mfma_f32_32x32x16_bf16 v[32:47], a[16:19], v[88:91], v[32:47]
    s_waitcnt lgkmcnt(3)
    ds_read_b128 a[12:15], v2 offset:39936
    ds_read_b128 a[16:19], v2 offset:40960
    v_rcp_f32 v58, v58
    v_rcp_f32 v59, v59
    v_mfma_f32_32x32x16_bf16 v[32:47], a[20:23], v[92:95], v[32:47]
    s_waitcnt lgkmcnt(4)
    v_rcp_f32 v60, v60
    v_rcp_f32 v61, v61
    v_rcp_f32 v62, v62
    v_rcp_f32 v63, v63
    v_pk_mul_f32 v[16:17], v[16:17], v[48:49]
    v_pk_mul_f32 v[18:19], v[18:19], v[50:51]
    v_pk_mul_f32 v[20:21], v[20:21], v[52:53]
    v_pk_mul_f32 v[22:23], v[22:23], v[54:55]
    v_pk_mul_f32 v[24:25], v[24:25], v[56:57]
    v_pk_mul_f32 v[26:27], v[26:27], v[58:59]
    v_pk_mul_f32 v[28:29], v[28:29], v[60:61]
    v_pk_mul_f32 v[30:31], v[30:31], v[62:63]
    v_pk_fma_f32 v[48:49], v[32:33], v[32:33], s[52:53]
    v_pk_fma_f32 v[50:51], v[34:35], v[34:35], s[52:53]
    v_pk_fma_f32 v[52:53], v[36:37], v[36:37], s[52:53]
    v_pk_fma_f32 v[54:55], v[38:39], v[38:39], s[52:53]
    v_pk_fma_f32 v[56:57], v[40:41], v[40:41], s[52:53]
    v_pk_fma_f32 v[58:59], v[42:43], v[42:43], s[52:53]
    v_pk_fma_f32 v[60:61], v[44:45], v[44:45], s[52:53]
    v_pk_fma_f32 v[62:63], v[46:47], v[46:47], s[52:53]
    v_pk_mul_f32 v[48:49], v[48:49], v[32:33] neg_lo:[1,0] neg_hi:[1,0]
    v_pk_mul_f32 v[50:51], v[50:51], v[34:35] neg_lo:[1,0] neg_hi:[1,0]
    v_pk_mul_f32 v[52:53], v[52:53], v[36:37] neg_lo:[1,0] neg_hi:[1,0]
    v_pk_mul_f32 v[54:55], v[54:55], v[38:39] neg_lo:[1,0] neg_hi:[1,0]
    v_pk_mul_f32 v[56:57], v[56:57], v[40:41] neg_lo:[1,0] neg_hi:[1,0]
    v_pk_mul_f32 v[58:59], v[58:59], v[42:43] neg_lo:[1,0] neg_hi:[1,0]
    v_pk_mul_f32 v[60:61], v[60:61], v[44:45] neg_lo:[1,0] neg_hi:[1,0]
    v_pk_mul_f32 v[62:63], v[62:63], v[46:47] neg_lo:[1,0] neg_hi:[1,0]
    v_cvt_pk_bf16_f32 v224, v16, v17
    v_cvt_pk_bf16_f32 v225, v18, v19
    v_cvt_pk_bf16_f32 v226, v20, v21
    v_cvt_pk_bf16_f32 v227, v22, v23
    v_cvt_pk_bf16_f32 v228, v24, v25
    v_cvt_pk_bf16_f32 v229, v26, v27
    v_cvt_pk_bf16_f32 v230, v28, v29
    v_cvt_pk_bf16_f32 v231, v30, v31
    v_mfma_f32_32x32x16_bf16 v[16:31], v[224:227], a[24:27], 0
    v_exp_f32 v48, v48
    v_exp_f32 v49, v49
    v_exp_f32 v50, v50
    v_mfma_f32_32x32x16_bf16 v[16:31], v[228:231], a[28:31], v[16:31]
    v_exp_f32 v51, v51
    v_exp_f32 v52, v52
    v_exp_f32 v53, v53
    v_mfma_f32_32x32x16_bf16 v[144:159], v[128:131], a[232:235], 0
    v_exp_f32 v54, v54
    v_exp_f32 v55, v55
    v_exp_f32 v56, v56
    v_mfma_f32_32x32x16_bf16 v[144:159], v[132:135], a[236:239], v[144:159]
    v_exp_f32 v57, v57
    v_exp_f32 v58, v58
    v_exp_f32 v59, v59
    v_exp_f32 v60, v60
    v_exp_f32 v61, v61
    v_exp_f32 v62, v62
    v_exp_f32 v63, v63
    v_pk_add_f32 v[48:49], v[48:49], 1.0 op_sel_hi:[1,0]
    v_pk_add_f32 v[50:51], v[50:51], 1.0 op_sel_hi:[1,0]
    v_pk_add_f32 v[52:53], v[52:53], 1.0 op_sel_hi:[1,0]
    v_pk_add_f32 v[54:55], v[54:55], 1.0 op_sel_hi:[1,0]
    v_pk_add_f32 v[56:57], v[56:57], 1.0 op_sel_hi:[1,0]
    v_pk_add_f32 v[58:59], v[58:59], 1.0 op_sel_hi:[1,0]
    v_pk_add_f32 v[60:61], v[60:61], 1.0 op_sel_hi:[1,0]
    v_pk_add_f32 v[62:63], v[62:63], 1.0 op_sel_hi:[1,0]
    v_pk_fma_f32 v[104:105], v[16:17], v[16:17], v[104:105]
    v_pk_fma_f32 v[104:105], v[18:19], v[18:19], v[104:105]
    v_pk_fma_f32 v[104:105], v[20:21], v[20:21], v[104:105]
    v_pk_fma_f32 v[104:105], v[22:23], v[22:23], v[104:105]
    v_pk_fma_f32 v[104:105], v[24:25], v[24:25], v[104:105]
    v_pk_fma_f32 v[104:105], v[26:27], v[26:27], v[104:105]
    v_pk_fma_f32 v[104:105], v[28:29], v[28:29], v[104:105]
    v_pk_fma_f32 v[104:105], v[30:31], v[30:31], v[104:105]
    v_pk_add_f32 v[8:9], v[8:9], v[144:145]
    v_pk_fma_f32 v[10:11], v[144:145], v[144:145], v[10:11]
    v_pk_add_f32 v[8:9], v[8:9], v[146:147]
    v_pk_fma_f32 v[10:11], v[146:147], v[146:147], v[10:11]
    v_pk_add_f32 v[8:9], v[8:9], v[148:149]
    v_pk_fma_f32 v[10:11], v[148:149], v[148:149], v[10:11]
    v_pk_add_f32 v[8:9], v[8:9], v[150:151]
    v_pk_fma_f32 v[10:11], v[150:151], v[150:151], v[10:11]
    v_pk_add_f32 v[8:9], v[8:9], v[152:153]
    v_pk_fma_f32 v[10:11], v[152:153], v[152:153], v[10:11]
    v_pk_add_f32 v[8:9], v[8:9], v[154:155]
    v_pk_fma_f32 v[10:11], v[154:155], v[154:155], v[10:11]
    v_pk_add_f32 v[8:9], v[8:9], v[156:157]
    v_pk_fma_f32 v[10:11], v[156:157], v[156:157], v[10:11]
    v_pk_add_f32 v[8:9], v[8:9], v[158:159]
    v_pk_fma_f32 v[10:11], v[158:159], v[158:159], v[10:11]
    v_mfma_f32_32x32x16_bf16 v[16:31], a[0:3], v[72:75], 0
    s_waitcnt lgkmcnt(3)
    ds_read_b128 a[20:23], v2 offset:41984
    ds_read_b128 a[0:3], v2 offset:43008
    v_rcp_f32 v48, v48
    v_rcp_f32 v49, v49
    v_mfma_f32_32x32x16_bf16 v[16:31], a[4:7], v[76:79], v[16:31]
    s_waitcnt lgkmcnt(4)
    v_rcp_f32 v50, v50
    v_rcp_f32 v51, v51
    v_rcp_f32 v52, v52
    v_mfma_f32_32x32x16_bf16 v[16:31], a[8:11], v[80:83], v[16:31]
    s_waitcnt lgkmcnt(3)
    ds_read_b128 a[4:7], v2 offset:44032
    ds_read_b128 a[8:11], v2 offset:45056
    v_rcp_f32 v53, v53
    v_rcp_f32 v54, v54
    v_mfma_f32_32x32x16_bf16 v[16:31], a[12:15], v[84:87], v[16:31]
    s_waitcnt lgkmcnt(4)
    v_rcp_f32 v55, v55
    v_rcp_f32 v56, v56
    v_rcp_f32 v57, v57
    v_mfma_f32_32x32x16_bf16 v[16:31], a[16:19], v[88:91], v[16:31]
    s_waitcnt lgkmcnt(3)
    ds_read_b128 a[12:15], v2 offset:46080
    ds_read_b128 a[16:19], v2 offset:47104
    v_rcp_f32 v58, v58
    v_rcp_f32 v59, v59
    v_mfma_f32_32x32x16_bf16 v[16:31], a[20:23], v[92:95], v[16:31]
    s_waitcnt lgkmcnt(4)
    v_rcp_f32 v60, v60
    v_rcp_f32 v61, v61
    v_rcp_f32 v62, v62
    v_rcp_f32 v63, v63
    v_pk_mul_f32 v[32:33], v[32:33], v[48:49]
    v_pk_mul_f32 v[34:35], v[34:35], v[50:51]
    v_pk_mul_f32 v[36:37], v[36:37], v[52:53]
    v_pk_mul_f32 v[38:39], v[38:39], v[54:55]
    v_pk_mul_f32 v[40:41], v[40:41], v[56:57]
    v_pk_mul_f32 v[42:43], v[42:43], v[58:59]
    v_pk_mul_f32 v[44:45], v[44:45], v[60:61]
    v_pk_mul_f32 v[46:47], v[46:47], v[62:63]
    v_pk_fma_f32 v[48:49], v[16:17], v[16:17], s[52:53]
    v_pk_fma_f32 v[50:51], v[18:19], v[18:19], s[52:53]
    v_pk_fma_f32 v[52:53], v[20:21], v[20:21], s[52:53]
    v_pk_fma_f32 v[54:55], v[22:23], v[22:23], s[52:53]
    v_pk_fma_f32 v[56:57], v[24:25], v[24:25], s[52:53]
    v_pk_fma_f32 v[58:59], v[26:27], v[26:27], s[52:53]
    v_pk_fma_f32 v[60:61], v[28:29], v[28:29], s[52:53]
    v_pk_fma_f32 v[62:63], v[30:31], v[30:31], s[52:53]
    v_pk_mul_f32 v[48:49], v[48:49], v[16:17] neg_lo:[1,0] neg_hi:[1,0]
    v_pk_mul_f32 v[50:51], v[50:51], v[18:19] neg_lo:[1,0] neg_hi:[1,0]
    v_pk_mul_f32 v[52:53], v[52:53], v[20:21] neg_lo:[1,0] neg_hi:[1,0]
    v_pk_mul_f32 v[54:55], v[54:55], v[22:23] neg_lo:[1,0] neg_hi:[1,0]
    v_pk_mul_f32 v[56:57], v[56:57], v[24:25] neg_lo:[1,0] neg_hi:[1,0]
    v_pk_mul_f32 v[58:59], v[58:59], v[26:27] neg_lo:[1,0] neg_hi:[1,0]
    v_pk_mul_f32 v[60:61], v[60:61], v[28:29] neg_lo:[1,0] neg_hi:[1,0]
    v_pk_mul_f32 v[62:63], v[62:63], v[30:31] neg_lo:[1,0] neg_hi:[1,0]
    v_cvt_pk_bf16_f32 v232, v32, v33
    v_cvt_pk_bf16_f32 v233, v34, v35
    v_cvt_pk_bf16_f32 v234, v36, v37
    v_cvt_pk_bf16_f32 v235, v38, v39
    v_cvt_pk_bf16_f32 v236, v40, v41
    v_cvt_pk_bf16_f32 v237, v42, v43
    v_cvt_pk_bf16_f32 v238, v44, v45
    v_cvt_pk_bf16_f32 v239, v46, v47
    v_mfma_f32_32x32x16_bf16 v[32:47], v[232:235], a[24:27], 0
    v_exp_f32 v48, v48
    v_exp_f32 v49, v49
    v_exp_f32 v50, v50
    v_mfma_f32_32x32x16_bf16 v[32:47], v[236:239], a[28:31], v[32:47]
    v_exp_f32 v51, v51
    v_exp_f32 v52, v52
    v_exp_f32 v53, v53
    v_mfma_f32_32x32x16_bf16 v[144:159], v[136:139], a[240:243], 0
    v_exp_f32 v54, v54
    v_exp_f32 v55, v55
    v_exp_f32 v56, v56
    v_mfma_f32_32x32x16_bf16 v[144:159], v[140:143], a[244:247], v[144:159]
    v_exp_f32 v57, v57
    v_exp_f32 v58, v58
    v_exp_f32 v59, v59
    v_exp_f32 v60, v60
    v_exp_f32 v61, v61
    v_exp_f32 v62, v62
    v_exp_f32 v63, v63
    v_pk_add_f32 v[48:49], v[48:49], 1.0 op_sel_hi:[1,0]
    v_pk_add_f32 v[50:51], v[50:51], 1.0 op_sel_hi:[1,0]
    v_pk_add_f32 v[52:53], v[52:53], 1.0 op_sel_hi:[1,0]
    v_pk_add_f32 v[54:55], v[54:55], 1.0 op_sel_hi:[1,0]
    v_pk_add_f32 v[56:57], v[56:57], 1.0 op_sel_hi:[1,0]
    v_pk_add_f32 v[58:59], v[58:59], 1.0 op_sel_hi:[1,0]
    v_pk_add_f32 v[60:61], v[60:61], 1.0 op_sel_hi:[1,0]
    v_pk_add_f32 v[62:63], v[62:63], 1.0 op_sel_hi:[1,0]
    v_pk_fma_f32 v[106:107], v[32:33], v[32:33], v[106:107]
    v_pk_fma_f32 v[106:107], v[34:35], v[34:35], v[106:107]
    v_pk_fma_f32 v[106:107], v[36:37], v[36:37], v[106:107]
    v_pk_fma_f32 v[106:107], v[38:39], v[38:39], v[106:107]
    v_pk_fma_f32 v[106:107], v[40:41], v[40:41], v[106:107]
    v_pk_fma_f32 v[106:107], v[42:43], v[42:43], v[106:107]
    v_pk_fma_f32 v[106:107], v[44:45], v[44:45], v[106:107]
    v_pk_fma_f32 v[106:107], v[46:47], v[46:47], v[106:107]
    v_pk_add_f32 v[8:9], v[8:9], v[144:145]
    v_pk_fma_f32 v[10:11], v[144:145], v[144:145], v[10:11]
    v_pk_add_f32 v[8:9], v[8:9], v[146:147]
    v_pk_fma_f32 v[10:11], v[146:147], v[146:147], v[10:11]
    v_pk_add_f32 v[8:9], v[8:9], v[148:149]
    v_pk_fma_f32 v[10:11], v[148:149], v[148:149], v[10:11]
    v_pk_add_f32 v[8:9], v[8:9], v[150:151]
    v_pk_fma_f32 v[10:11], v[150:151], v[150:151], v[10:11]
    v_pk_add_f32 v[8:9], v[8:9], v[152:153]
    v_pk_fma_f32 v[10:11], v[152:153], v[152:153], v[10:11]
    v_pk_add_f32 v[8:9], v[8:9], v[154:155]
    v_pk_fma_f32 v[10:11], v[154:155], v[154:155], v[10:11]
    v_pk_add_f32 v[8:9], v[8:9], v[156:157]
    v_pk_fma_f32 v[10:11], v[156:157], v[156:157], v[10:11]
    v_pk_add_f32 v[8:9], v[8:9], v[158:159]
    v_pk_fma_f32 v[10:11], v[158:159], v[158:159], v[10:11]
    v_mfma_f32_32x32x16_bf16 v[32:47], a[0:3], v[72:75], 0
    s_waitcnt lgkmcnt(3)
    ds_read_b128 a[20:23], v2 offset:48128
    ds_read_b128 a[0:3], v2 offset:0
    v_rcp_f32 v48, v48
    v_rcp_f32 v49, v49
    v_mfma_f32_32x32x16_bf16 v[32:47], a[4:7], v[76:79], v[32:47]
    s_waitcnt lgkmcnt(4)
    v_rcp_f32 v50, v50
    v_rcp_f32 v51, v51
    v_rcp_f32 v52, v52
    v_mfma_f32_32x32x16_bf16 v[32:47], a[8:11], v[80:83], v[32:47]
    s_waitcnt lgkmcnt(3)
    ds_read_b128 a[4:7], v2 offset:1024
    ds_read_b128 a[8:11], v2 offset:2048
    v_rcp_f32 v53, v53
    v_rcp_f32 v54, v54
    v_mfma_f32_32x32x16_bf16 v[32:47], a[12:15], v[84:87], v[32:47]
    s_waitcnt lgkmcnt(4)
    v_rcp_f32 v55, v55
    v_rcp_f32 v56, v56
    v_rcp_f32 v57, v57
    v_mfma_f32_32x32x16_bf16 v[32:47], a[16:19], v[88:91], v[32:47]
    s_waitcnt lgkmcnt(3)
    ds_read_b128 a[12:15], v2 offset:3072
    ds_read_b128 a[16:19], v2 offset:4096
    v_rcp_f32 v58, v58
    v_rcp_f32 v59, v59
    v_mfma_f32_32x32x16_bf16 v[32:47], a[20:23], v[92:95], v[32:47]
    s_waitcnt lgkmcnt(4)
    v_rcp_f32 v60, v60
    v_rcp_f32 v61, v61
    v_rcp_f32 v62, v62
    v_mfma_f32_32x32x16_bf16 v[144:159], v[120:123], a[224:227], 0
    v_rcp_f32 v63, v63
    v_add_f32 v8, v8, v9
    v_add_f32 v10, v10, v11
    s_nop 1
    v_permlane32_swap_b32 v8, v10
    v_add_f32 v8, v8, v10
    v_mfma_f32_32x32x16_bf16 v[144:159], v[124:127], a[228:231], v[144:159]
    v_mov_b32 v10, v8
    s_nop 1
    v_permlane32_swap_b32 v8, v10
    v_mul_f32 v8, 0x3c2aaaab, v8
    v_mul_f32 v10, 0x3c2aaaab, v10
    v_fma_f32 v10, -v8, v8, v10
    v_max_f32 v10, 0, v10
    v_add_f32 v10, 0x3727c5ac, v10
    v_rsq_f32_e64 v10, v10
    s_nop 0
    v_mul_f32 v12, 0x3eeff558, v10
    v_mul_f32_e64 v13, -v8, v12
    v_pk_mul_f32 v[16:17], v[16:17], v[48:49]
    v_pk_mul_f32 v[18:19], v[18:19], v[50:51]
    v_pk_mul_f32 v[20:21], v[20:21], v[52:53]
    v_pk_mul_f32 v[22:23], v[22:23], v[54:55]
    v_pk_mul_f32 v[24:25], v[24:25], v[56:57]
    v_pk_mul_f32 v[26:27], v[26:27], v[58:59]
    v_pk_mul_f32 v[28:29], v[28:29], v[60:61]
    v_pk_mul_f32 v[30:31], v[30:31], v[62:63]
    v_pk_fma_f32 v[144:145], v[144:145], v[12:13], v[12:13] op_sel:[0,0,1] op_sel_hi:[1,0,1]
    v_pk_fma_f32 v[146:147], v[146:147], v[12:13], v[12:13] op_sel:[0,0,1] op_sel_hi:[1,0,1]
    v_pk_fma_f32 v[148:149], v[148:149], v[12:13], v[12:13] op_sel:[0,0,1] op_sel_hi:[1,0,1]
    v_pk_fma_f32 v[150:151], v[150:151], v[12:13], v[12:13] op_sel:[0,0,1] op_sel_hi:[1,0,1]
    v_pk_fma_f32 v[152:153], v[152:153], v[12:13], v[12:13] op_sel:[0,0,1] op_sel_hi:[1,0,1]
    v_pk_fma_f32 v[154:155], v[154:155], v[12:13], v[12:13] op_sel:[0,0,1] op_sel_hi:[1,0,1]
    v_pk_fma_f32 v[156:157], v[156:157], v[12:13], v[12:13] op_sel:[0,0,1] op_sel_hi:[1,0,1]
    v_pk_fma_f32 v[158:159], v[158:159], v[12:13], v[12:13] op_sel:[0,0,1] op_sel_hi:[1,0,1]
    v_cvt_pk_bf16_f32 v72, v144, v145
    v_cvt_pk_bf16_f32 v73, v146, v147
    v_cvt_pk_bf16_f32 v74, v148, v149
    v_cvt_pk_bf16_f32 v75, v150, v151
    v_cvt_pk_bf16_f32 v76, v152, v153
    v_cvt_pk_bf16_f32 v77, v154, v155
    v_cvt_pk_bf16_f32 v78, v156, v157
    v_cvt_pk_bf16_f32 v79, v158, v159
    v_pk_fma_f32 v[48:49], v[32:33], v[32:33], s[52:53]
    v_pk_fma_f32 v[50:51], v[34:35], v[34:35], s[52:53]
    v_pk_fma_f32 v[52:53], v[36:37], v[36:37], s[52:53]
    v_pk_fma_f32 v[54:55], v[38:39], v[38:39], s[52:53]
    v_pk_fma_f32 v[56:57], v[40:41], v[40:41], s[52:53]
    v_pk_fma_f32 v[58:59], v[42:43], v[42:43], s[52:53]
    v_pk_fma_f32 v[60:61], v[44:45], v[44:45], s[52:53]
    v_pk_fma_f32 v[62:63], v[46:47], v[46:47], s[52:53]
    v_pk_mul_f32 v[48:49], v[48:49], v[32:33] neg_lo:[1,0] neg_hi:[1,0]
    v_pk_mul_f32 v[50:51], v[50:51], v[34:35] neg_lo:[1,0] neg_hi:[1,0]
    v_pk_mul_f32 v[52:53], v[52:53], v[36:37] neg_lo:[1,0] neg_hi:[1,0]
    v_pk_mul_f32 v[54:55], v[54:55], v[38:39] neg_lo:[1,0] neg_hi:[1,0]
    v_pk_mul_f32 v[56:57], v[56:57], v[40:41] neg_lo:[1,0] neg_hi:[1,0]
    v_pk_mul_f32 v[58:59], v[58:59], v[42:43] neg_lo:[1,0] neg_hi:[1,0]
    v_pk_mul_f32 v[60:61], v[60:61], v[44:45] neg_lo:[1,0] neg_hi:[1,0]
    v_pk_mul_f32 v[62:63], v[62:63], v[46:47] neg_lo:[1,0] neg_hi:[1,0]
    v_cvt_pk_bf16_f32 v240, v16, v17
    v_cvt_pk_bf16_f32 v241, v18, v19
    v_cvt_pk_bf16_f32 v242, v20, v21
    v_cvt_pk_bf16_f32 v243, v22, v23
    v_cvt_pk_bf16_f32 v244, v24, v25
    v_cvt_pk_bf16_f32 v245, v26, v27
    v_cvt_pk_bf16_f32 v246, v28, v29
    v_cvt_pk_bf16_f32 v247, v30, v31
    v_mfma_f32_32x32x16_bf16 v[16:31], v[240:243], a[24:27], 0
    v_exp_f32 v48, v48
    v_exp_f32 v49, v49
    v_exp_f32 v50, v50
    v_mfma_f32_32x32x16_bf16 v[16:31], v[244:247], a[28:31], v[16:31]
    v_exp_f32 v51, v51
    v_exp_f32 v52, v52
    v_exp_f32 v53, v53
    v_mfma_f32_32x32x16_bf16 v[144:159], v[128:131], a[232:235], 0
    v_exp_f32 v54, v54
    v_exp_f32 v55, v55
    v_exp_f32 v56, v56
    v_mfma_f32_32x32x16_bf16 v[144:159], v[132:135], a[236:239], v[144:159]
    v_exp_f32 v57, v57
    v_pk_fma_f32 v[108:109], v[16:17], v[16:17], v[108:109]
    v_pk_fma_f32 v[108:109], v[18:19], v[18:19], v[108:109]
    v_pk_fma_f32 v[108:109], v[20:21], v[20:21], v[108:109]
    v_pk_fma_f32 v[108:109], v[22:23], v[22:23], v[108:109]
    v_pk_fma_f32 v[108:109], v[24:25], v[24:25], v[108:109]
    v_pk_fma_f32 v[108:109], v[26:27], v[26:27], v[108:109]
    v_pk_fma_f32 v[108:109], v[28:29], v[28:29], v[108:109]
    v_pk_fma_f32 v[108:109], v[30:31], v[30:31], v[108:109]
    v_pk_fma_f32 v[144:145], v[144:145], v[12:13], v[12:13] op_sel:[0,0,1] op_sel_hi:[1,0,1]
    v_pk_fma_f32 v[146:147], v[146:147], v[12:13], v[12:13] op_sel:[0,0,1] op_sel_hi:[1,0,1]
    v_pk_fma_f32 v[148:149], v[148:149], v[12:13], v[12:13] op_sel:[0,0,1] op_sel_hi:[1,0,1]
    v_pk_fma_f32 v[150:151], v[150:151], v[12:13], v[12:13] op_sel:[0,0,1] op_sel_hi:[1,0,1]
    v_pk_fma_f32 v[152:153], v[152:153], v[12:13], v[12:13] op_sel:[0,0,1] op_sel_hi:[1,0,1]
    v_pk_fma_f32 v[154:155], v[154:155], v[12:13], v[12:13] op_sel:[0,0,1] op_sel_hi:[1,0,1]
    v_pk_fma_f32 v[156:157], v[156:157], v[12:13], v[12:13] op_sel:[0,0,1] op_sel_hi:[1,0,1]
    v_pk_fma_f32 v[158:159], v[158:159], v[12:13], v[12:13] op_sel:[0,0,1] op_sel_hi:[1,0,1]
    v_cvt_pk_bf16_f32 v80, v144, v145
    v_cvt_pk_bf16_f32 v81, v146, v147
    v_cvt_pk_bf16_f32 v82, v148, v149
    v_cvt_pk_bf16_f32 v83, v150, v151
    v_cvt_pk_bf16_f32 v84, v152, v153
    v_cvt_pk_bf16_f32 v85, v154, v155
    v_cvt_pk_bf16_f32 v86, v156, v157
    v_cvt_pk_bf16_f32 v87, v158, v159
    v_mfma_f32_32x32x16_bf16 v[144:159], v[136:139], a[240:243], 0
    v_exp_f32 v58, v58
    v_exp_f32 v59, v59
    v_exp_f32 v60, v60
    v_mfma_f32_32x32x16_bf16 v[144:159], v[140:143], a[244:247], v[144:159]
    v_exp_f32 v61, v61
    v_exp_f32 v62, v62
    v_exp_f32 v63, v63
    v_pk_add_f32 v[48:49], v[48:49], 1.0 op_sel_hi:[1,0]
    v_pk_add_f32 v[50:51], v[50:51], 1.0 op_sel_hi:[1,0]
    v_pk_add_f32 v[52:53], v[52:53], 1.0 op_sel_hi:[1,0]
    v_pk_add_f32 v[54:55], v[54:55], 1.0 op_sel_hi:[1,0]
    v_pk_add_f32 v[56:57], v[56:57], 1.0 op_sel_hi:[1,0]
    v_pk_add_f32 v[58:59], v[58:59], 1.0 op_sel_hi:[1,0]
    v_pk_add_f32 v[60:61], v[60:61], 1.0 op_sel_hi:[1,0]
    v_pk_add_f32 v[62:63], v[62:63], 1.0 op_sel_hi:[1,0]
    v_pk_fma_f32 v[144:145], v[144:145], v[12:13], v[12:13] op_sel:[0,0,1] op_sel_hi:[1,0,1]
    v_pk_fma_f32 v[146:147], v[146:147], v[12:13], v[12:13] op_sel:[0,0,1] op_sel_hi:[1,0,1]
    v_pk_fma_f32 v[148:149], v[148:149], v[12:13], v[12:13] op_sel:[0,0,1] op_sel_hi:[1,0,1]
    v_pk_fma_f32 v[150:151], v[150:151], v[12:13], v[12:13] op_sel:[0,0,1] op_sel_hi:[1,0,1]
    v_pk_fma_f32 v[152:153], v[152:153], v[12:13], v[12:13] op_sel:[0,0,1] op_sel_hi:[1,0,1]
    v_pk_fma_f32 v[154:155], v[154:155], v[12:13], v[12:13] op_sel:[0,0,1] op_sel_hi:[1,0,1]
    v_pk_fma_f32 v[156:157], v[156:157], v[12:13], v[12:13] op_sel:[0,0,1] op_sel_hi:[1,0,1]
    v_pk_fma_f32 v[158:159], v[158:159], v[12:13], v[12:13] op_sel:[0,0,1] op_sel_hi:[1,0,1]
    v_cvt_pk_bf16_f32 v88, v144, v145
    v_cvt_pk_bf16_f32 v89, v146, v147
    v_cvt_pk_bf16_f32 v90, v148, v149
    v_cvt_pk_bf16_f32 v91, v150, v151
    v_cvt_pk_bf16_f32 v92, v152, v153
    v_cvt_pk_bf16_f32 v93, v154, v155
    v_cvt_pk_bf16_f32 v94, v156, v157
    v_cvt_pk_bf16_f32 v95, v158, v159
    v_mfma_f32_32x32x16_bf16 v[16:31], a[0:3], v[72:75], 0
    s_waitcnt lgkmcnt(3)
    ds_read_b128 a[20:23], v2 offset:5120
    ds_read_b128 a[0:3], v2 offset:18432
    v_rcp_f32 v48, v48
    v_rcp_f32 v49, v49
    v_mfma_f32_32x32x16_bf16 v[16:31], a[4:7], v[76:79], v[16:31]
    s_waitcnt lgkmcnt(4)
    v_rcp_f32 v50, v50
    v_rcp_f32 v51, v51
    v_rcp_f32 v52, v52
    v_mfma_f32_32x32x16_bf16 v[16:31], a[8:11], v[80:83], v[16:31]
    s_waitcnt lgkmcnt(3)
    ds_read_b128 a[4:7], v2 offset:19456
    ds_read_b128 a[8:11], v2 offset:20480
    v_rcp_f32 v53, v53
    v_rcp_f32 v54, v54
    v_mfma_f32_32x32x16_bf16 v[16:31], a[12:15], v[84:87], v[16:31]
    s_waitcnt lgkmcnt(4)
    v_rcp_f32 v55, v55
    v_rcp_f32 v56, v56
    v_rcp_f32 v57, v57
    v_mfma_f32_32x32x16_bf16 v[16:31], a[16:19], v[88:91], v[16:31]
    s_waitcnt lgkmcnt(3)
    ds_read_b128 a[12:15], v2 offset:21504
    ds_read_b128 a[16:19], v2 offset:22528
    v_rcp_f32 v58, v58
    v_rcp_f32 v59, v59
    v_mfma_f32_32x32x16_bf16 v[16:31], a[20:23], v[92:95], v[16:31]
    s_waitcnt lgkmcnt(4)
    v_rcp_f32 v60, v60
    v_rcp_f32 v61, v61
    v_rcp_f32 v62, v62
    v_rcp_f32 v63, v63
    v_pk_mul_f32 v[32:33], v[32:33], v[48:49]
    v_pk_mul_f32 v[34:35], v[34:35], v[50:51]
    v_pk_mul_f32 v[36:37], v[36:37], v[52:53]
    v_pk_mul_f32 v[38:39], v[38:39], v[54:55]
    v_pk_mul_f32 v[40:41], v[40:41], v[56:57]
    v_pk_mul_f32 v[42:43], v[42:43], v[58:59]
    v_pk_mul_f32 v[44:45], v[44:45], v[60:61]
    v_pk_mul_f32 v[46:47], v[46:47], v[62:63]
    v_pk_fma_f32 v[48:49], v[16:17], v[16:17], s[52:53]
    v_pk_fma_f32 v[50:51], v[18:19], v[18:19], s[52:53]
    v_pk_fma_f32 v[52:53], v[20:21], v[20:21], s[52:53]
    v_pk_fma_f32 v[54:55], v[22:23], v[22:23], s[52:53]
    v_pk_fma_f32 v[56:57], v[24:25], v[24:25], s[52:53]
    v_pk_fma_f32 v[58:59], v[26:27], v[26:27], s[52:53]
    v_pk_fma_f32 v[60:61], v[28:29], v[28:29], s[52:53]
    v_pk_fma_f32 v[62:63], v[30:31], v[30:31], s[52:53]
    v_pk_mul_f32 v[48:49], v[48:49], v[16:17] neg_lo:[1,0] neg_hi:[1,0]
    v_pk_mul_f32 v[50:51], v[50:51], v[18:19] neg_lo:[1,0] neg_hi:[1,0]
    v_pk_mul_f32 v[52:53], v[52:53], v[20:21] neg_lo:[1,0] neg_hi:[1,0]
    v_pk_mul_f32 v[54:55], v[54:55], v[22:23] neg_lo:[1,0] neg_hi:[1,0]
    v_pk_mul_f32 v[56:57], v[56:57], v[24:25] neg_lo:[1,0] neg_hi:[1,0]
    v_pk_mul_f32 v[58:59], v[58:59], v[26:27] neg_lo:[1,0] neg_hi:[1,0]
    v_pk_mul_f32 v[60:61], v[60:61], v[28:29] neg_lo:[1,0] neg_hi:[1,0]
    v_pk_mul_f32 v[62:63], v[62:63], v[30:31] neg_lo:[1,0] neg_hi:[1,0]
    v_cvt_pk_bf16_f32 v248, v32, v33
    v_cvt_pk_bf16_f32 v249, v34, v35
    v_cvt_pk_bf16_f32 v250, v36, v37
    v_cvt_pk_bf16_f32 v251, v38, v39
    v_cvt_pk_bf16_f32 v252, v40, v41
    v_cvt_pk_bf16_f32 v253, v42, v43
    v_cvt_pk_bf16_f32 v254, v44, v45
    v_cvt_pk_bf16_f32 v255, v46, v47
    v_mfma_f32_32x32x16_bf16 v[144:159], v[248:251], a[24:27], 0
    v_exp_f32 v48, v48
    v_exp_f32 v49, v49
    v_exp_f32 v50, v50
    v_mfma_f32_32x32x16_bf16 v[144:159], v[252:255], a[28:31], v[144:159]
    v_exp_f32 v51, v51
    v_exp_f32 v52, v52
    v_exp_f32 v53, v53
    v_mfma_f32_32x32x16_bf16 v[32:47], a[0:3], v[72:75], 0
    s_waitcnt lgkmcnt(3)
    ds_read_b128 a[20:23], v2 offset:23552
    ds_read_b128 a[0:3], v2 offset:36864
    v_exp_f32 v54, v54
    v_exp_f32 v55, v55
    v_mfma_f32_32x32x16_bf16 v[32:47], a[4:7], v[76:79], v[32:47]
    s_waitcnt lgkmcnt(4)
    v_exp_f32 v56, v56
    v_exp_f32 v57, v57
    v_exp_f32 v58, v58
    v_exp_f32 v59, v59
    v_exp_f32 v60, v60
    v_exp_f32 v61, v61
    v_exp_f32 v62, v62
    v_exp_f32 v63, v63
    v_pk_add_f32 v[48:49], v[48:49], 1.0 op_sel_hi:[1,0]
    v_pk_add_f32 v[50:51], v[50:51], 1.0 op_sel_hi:[1,0]
    v_pk_add_f32 v[52:53], v[52:53], 1.0 op_sel_hi:[1,0]
    v_pk_add_f32 v[54:55], v[54:55], 1.0 op_sel_hi:[1,0]
    v_pk_add_f32 v[56:57], v[56:57], 1.0 op_sel_hi:[1,0]
    v_pk_add_f32 v[58:59], v[58:59], 1.0 op_sel_hi:[1,0]
    v_pk_add_f32 v[60:61], v[60:61], 1.0 op_sel_hi:[1,0]
    v_pk_add_f32 v[62:63], v[62:63], 1.0 op_sel_hi:[1,0]
    v_pk_fma_f32 v[110:111], v[144:145], v[144:145], v[110:111]
    v_pk_fma_f32 v[110:111], v[146:147], v[146:147], v[110:111]
    v_pk_fma_f32 v[110:111], v[148:149], v[148:149], v[110:111]
    v_pk_fma_f32 v[110:111], v[150:151], v[150:151], v[110:111]
    v_pk_fma_f32 v[110:111], v[152:153], v[152:153], v[110:111]
    v_pk_fma_f32 v[110:111], v[154:155], v[154:155], v[110:111]
    v_pk_fma_f32 v[110:111], v[156:157], v[156:157], v[110:111]
    v_pk_fma_f32 v[110:111], v[158:159], v[158:159], v[110:111]
    v_mfma_f32_32x32x16_bf16 v[32:47], a[8:11], v[80:83], v[32:47]
    s_waitcnt lgkmcnt(3)
    ds_read_b128 a[4:7], v2 offset:37888
    ds_read_b128 a[8:11], v2 offset:38912
    v_rcp_f32 v48, v48
    v_rcp_f32 v49, v49
    v_mfma_f32_32x32x16_bf16 v[32:47], a[12:15], v[84:87], v[32:47]
    s_waitcnt lgkmcnt(4)
    v_rcp_f32 v50, v50
    v_rcp_f32 v51, v51
    v_rcp_f32 v52, v52
    v_mfma_f32_32x32x16_bf16 v[32:47], a[16:19], v[88:91], v[32:47]
    s_waitcnt lgkmcnt(3)
    ds_read_b128 a[12:15], v2 offset:39936
    ds_read_b128 a[16:19], v2 offset:40960
    v_rcp_f32 v53, v53
    v_rcp_f32 v54, v54
    v_mfma_f32_32x32x16_bf16 v[32:47], a[20:23], v[92:95], v[32:47]
    s_waitcnt lgkmcnt(4)
    v_rcp_f32 v55, v55
    v_rcp_f32 v56, v56
    v_rcp_f32 v57, v57
    v_rcp_f32 v58, v58
    v_rcp_f32 v59, v59
    v_rcp_f32 v60, v60
    v_rcp_f32 v61, v61
    v_rcp_f32 v62, v62
    v_rcp_f32 v63, v63
    v_pk_mul_f32 v[16:17], v[16:17], v[48:49]
    v_pk_mul_f32 v[18:19], v[18:19], v[50:51]
    v_pk_mul_f32 v[20:21], v[20:21], v[52:53]
    v_pk_mul_f32 v[22:23], v[22:23], v[54:55]
    v_pk_mul_f32 v[24:25], v[24:25], v[56:57]
    v_pk_mul_f32 v[26:27], v[26:27], v[58:59]
    v_pk_mul_f32 v[28:29], v[28:29], v[60:61]
    v_pk_mul_f32 v[30:31], v[30:31], v[62:63]
    v_pk_fma_f32 v[48:49], v[32:33], v[32:33], s[52:53]
    v_pk_fma_f32 v[50:51], v[34:35], v[34:35], s[52:53]
    v_pk_fma_f32 v[52:53], v[36:37], v[36:37], s[52:53]
    v_pk_fma_f32 v[54:55], v[38:39], v[38:39], s[52:53]
    v_pk_fma_f32 v[56:57], v[40:41], v[40:41], s[52:53]
    v_pk_fma_f32 v[58:59], v[42:43], v[42:43], s[52:53]
    v_pk_fma_f32 v[60:61], v[44:45], v[44:45], s[52:53]
    v_pk_fma_f32 v[62:63], v[46:47], v[46:47], s[52:53]
    v_pk_mul_f32 v[48:49], v[48:49], v[32:33] neg_lo:[1,0] neg_hi:[1,0]
    v_pk_mul_f32 v[50:51], v[50:51], v[34:35] neg_lo:[1,0] neg_hi:[1,0]
    v_pk_mul_f32 v[52:53], v[52:53], v[36:37] neg_lo:[1,0] neg_hi:[1,0]
    v_pk_mul_f32 v[54:55], v[54:55], v[38:39] neg_lo:[1,0] neg_hi:[1,0]
    v_pk_mul_f32 v[56:57], v[56:57], v[40:41] neg_lo:[1,0] neg_hi:[1,0]
    v_pk_mul_f32 v[58:59], v[58:59], v[42:43] neg_lo:[1,0] neg_hi:[1,0]
    v_pk_mul_f32 v[60:61], v[60:61], v[44:45] neg_lo:[1,0] neg_hi:[1,0]
    v_pk_mul_f32 v[62:63], v[62:63], v[46:47] neg_lo:[1,0] neg_hi:[1,0]
    v_cvt_pk_bf16_f32 v64, v16, v17
    v_cvt_pk_bf16_f32 v65, v18, v19
    v_cvt_pk_bf16_f32 v66, v20, v21
    v_cvt_pk_bf16_f32 v67, v22, v23
    v_cvt_pk_bf16_f32 v68, v24, v25
    v_cvt_pk_bf16_f32 v69, v26, v27
    v_cvt_pk_bf16_f32 v70, v28, v29
    v_cvt_pk_bf16_f32 v71, v30, v31
    v_mfma_f32_32x32x16_bf16 v[144:159], v[64:67], a[24:27], 0
    v_exp_f32 v48, v48
    v_exp_f32 v49, v49
    v_exp_f32 v50, v50
    v_mfma_f32_32x32x16_bf16 v[144:159], v[68:71], a[28:31], v[144:159]
    v_exp_f32 v51, v51
    v_exp_f32 v52, v52
    v_exp_f32 v53, v53
    v_mfma_f32_32x32x16_bf16 v[16:31], a[0:3], v[72:75], 0
    s_waitcnt lgkmcnt(3)
    ds_read_b128 a[20:23], v2 offset:41984
    ds_read_b128 a[0:3], v2 offset:30720
    v_exp_f32 v54, v54
    v_exp_f32 v55, v55
    v_mfma_f32_32x32x16_bf16 v[16:31], a[4:7], v[76:79], v[16:31]
    s_waitcnt lgkmcnt(4)
    v_exp_f32 v56, v56
    v_exp_f32 v57, v57
    v_exp_f32 v58, v58
    v_exp_f32 v59, v59
    v_exp_f32 v60, v60
    v_exp_f32 v61, v61
    v_exp_f32 v62, v62
    v_exp_f32 v63, v63
    v_accvgpr_write_b32 a224, v64
    v_accvgpr_write_b32 a225, v65
    v_accvgpr_write_b32 a226, v66
    v_accvgpr_write_b32 a227, v67
    v_accvgpr_write_b32 a228, v68
    v_accvgpr_write_b32 a229, v69
    v_accvgpr_write_b32 a230, v70
    v_accvgpr_write_b32 a231, v71
    v_pk_add_f32 v[48:49], v[48:49], 1.0 op_sel_hi:[1,0]
    v_pk_add_f32 v[50:51], v[50:51], 1.0 op_sel_hi:[1,0]
    v_pk_add_f32 v[52:53], v[52:53], 1.0 op_sel_hi:[1,0]
    v_pk_add_f32 v[54:55], v[54:55], 1.0 op_sel_hi:[1,0]
    v_pk_add_f32 v[56:57], v[56:57], 1.0 op_sel_hi:[1,0]
    v_pk_add_f32 v[58:59], v[58:59], 1.0 op_sel_hi:[1,0]
    v_pk_add_f32 v[60:61], v[60:61], 1.0 op_sel_hi:[1,0]
    v_pk_add_f32 v[62:63], v[62:63], 1.0 op_sel_hi:[1,0]
    v_pk_fma_f32 v[96:97], v[144:145], v[144:145], v[96:97]
    v_pk_fma_f32 v[96:97], v[146:147], v[146:147], v[96:97]
    v_pk_fma_f32 v[96:97], v[148:149], v[148:149], v[96:97]
    v_pk_fma_f32 v[96:97], v[150:151], v[150:151], v[96:97]
    v_pk_fma_f32 v[96:97], v[152:153], v[152:153], v[96:97]
    v_pk_fma_f32 v[96:97], v[154:155], v[154:155], v[96:97]
    v_pk_fma_f32 v[96:97], v[156:157], v[156:157], v[96:97]
    v_pk_fma_f32 v[96:97], v[158:159], v[158:159], v[96:97]
    v_mfma_f32_32x32x16_bf16 v[16:31], a[8:11], v[80:83], v[16:31]
    s_waitcnt lgkmcnt(3)
    ds_read_b128 a[4:7], v2 offset:31744
    ds_read_b128 a[8:11], v2 offset:32768
    v_rcp_f32 v48, v48
    v_rcp_f32 v49, v49
    v_mfma_f32_32x32x16_bf16 v[16:31], a[12:15], v[84:87], v[16:31]
    s_waitcnt lgkmcnt(4)
    v_rcp_f32 v50, v50
    v_rcp_f32 v51, v51
    v_rcp_f32 v52, v52
    v_mfma_f32_32x32x16_bf16 v[16:31], a[16:19], v[88:91], v[16:31]
    s_waitcnt lgkmcnt(3)
    ds_read_b128 a[12:15], v2 offset:33792
    ds_read_b128 a[16:19], v2 offset:34816
    v_rcp_f32 v53, v53
    v_rcp_f32 v54, v54
    v_mfma_f32_32x32x16_bf16 v[16:31], a[20:23], v[92:95], v[16:31]
    s_waitcnt lgkmcnt(4)
    v_rcp_f32 v55, v55
    v_rcp_f32 v56, v56
    v_rcp_f32 v57, v57
    v_rcp_f32 v58, v58
    v_rcp_f32 v59, v59
    v_rcp_f32 v60, v60
    v_rcp_f32 v61, v61
    v_rcp_f32 v62, v62
    v_rcp_f32 v63, v63
    v_pk_mul_f32 v[32:33], v[32:33], v[48:49]
    v_pk_mul_f32 v[34:35], v[34:35], v[50:51]
    v_pk_mul_f32 v[36:37], v[36:37], v[52:53]
    v_pk_mul_f32 v[38:39], v[38:39], v[54:55]
    v_pk_mul_f32 v[40:41], v[40:41], v[56:57]
    v_pk_mul_f32 v[42:43], v[42:43], v[58:59]
    v_pk_mul_f32 v[44:45], v[44:45], v[60:61]
    v_pk_mul_f32 v[46:47], v[46:47], v[62:63]
    v_pk_fma_f32 v[48:49], v[16:17], v[16:17], s[52:53]
    v_pk_fma_f32 v[50:51], v[18:19], v[18:19], s[52:53]
    v_pk_fma_f32 v[52:53], v[20:21], v[20:21], s[52:53]
    v_pk_fma_f32 v[54:55], v[22:23], v[22:23], s[52:53]
    v_pk_fma_f32 v[56:57], v[24:25], v[24:25], s[52:53]
    v_pk_fma_f32 v[58:59], v[26:27], v[26:27], s[52:53]
    v_pk_fma_f32 v[60:61], v[28:29], v[28:29], s[52:53]
    v_pk_fma_f32 v[62:63], v[30:31], v[30:31], s[52:53]
    v_pk_mul_f32 v[48:49], v[48:49], v[16:17] neg_lo:[1,0] neg_hi:[1,0]
    v_pk_mul_f32 v[50:51], v[50:51], v[18:19] neg_lo:[1,0] neg_hi:[1,0]
    v_pk_mul_f32 v[52:53], v[52:53], v[20:21] neg_lo:[1,0] neg_hi:[1,0]
    v_pk_mul_f32 v[54:55], v[54:55], v[22:23] neg_lo:[1,0] neg_hi:[1,0]
    v_pk_mul_f32 v[56:57], v[56:57], v[24:25] neg_lo:[1,0] neg_hi:[1,0]
    v_pk_mul_f32 v[58:59], v[58:59], v[26:27] neg_lo:[1,0] neg_hi:[1,0]
    v_pk_mul_f32 v[60:61], v[60:61], v[28:29] neg_lo:[1,0] neg_hi:[1,0]
    v_pk_mul_f32 v[62:63], v[62:63], v[30:31] neg_lo:[1,0] neg_hi:[1,0]
    v_cvt_pk_bf16_f32 v64, v32, v33
    v_cvt_pk_bf16_f32 v65, v34, v35
    v_cvt_pk_bf16_f32 v66, v36, v37
    v_cvt_pk_bf16_f32 v67, v38, v39
    v_cvt_pk_bf16_f32 v68, v40, v41
    v_cvt_pk_bf16_f32 v69, v42, v43
    v_cvt_pk_bf16_f32 v70, v44, v45
    v_cvt_pk_bf16_f32 v71, v46, v47
    v_mfma_f32_32x32x16_bf16 v[144:159], v[64:67], a[24:27], 0
    v_exp_f32 v48, v48
    v_exp_f32 v49, v49
    v_exp_f32 v50, v50
    v_mfma_f32_32x32x16_bf16 v[144:159], v[68:71], a[28:31], v[144:159]
    v_exp_f32 v51, v51
    v_exp_f32 v52, v52
    v_exp_f32 v53, v53
    v_mfma_f32_32x32x16_bf16 v[32:47], a[0:3], v[72:75], 0
    s_waitcnt lgkmcnt(3)
    ds_read_b128 a[20:23], v2 offset:35840
    ds_read_b128 a[0:3], v2 offset:43008
    v_exp_f32 v54, v54
    v_exp_f32 v55, v55
    v_mfma_f32_32x32x16_bf16 v[32:47], a[4:7], v[76:79], v[32:47]
    s_waitcnt lgkmcnt(4)
    v_exp_f32 v56, v56
    v_exp_f32 v57, v57
    v_exp_f32 v58, v58
    v_exp_f32 v59, v59
    v_exp_f32 v60, v60
    v_exp_f32 v61, v61
    v_exp_f32 v62, v62
    v_exp_f32 v63, v63
    v_accvgpr_write_b32 a232, v64
    v_accvgpr_write_b32 a233, v65
    v_accvgpr_write_b32 a234, v66
    v_accvgpr_write_b32 a235, v67
    v_accvgpr_write_b32 a236, v68
    v_accvgpr_write_b32 a237, v69
    v_accvgpr_write_b32 a238, v70
    v_accvgpr_write_b32 a239, v71
    v_pk_add_f32 v[48:49], v[48:49], 1.0 op_sel_hi:[1,0]
    v_pk_add_f32 v[50:51], v[50:51], 1.0 op_sel_hi:[1,0]
    v_pk_add_f32 v[52:53], v[52:53], 1.0 op_sel_hi:[1,0]
    v_pk_add_f32 v[54:55], v[54:55], 1.0 op_sel_hi:[1,0]
    v_pk_add_f32 v[56:57], v[56:57], 1.0 op_sel_hi:[1,0]
    v_pk_add_f32 v[58:59], v[58:59], 1.0 op_sel_hi:[1,0]
    v_pk_add_f32 v[60:61], v[60:61], 1.0 op_sel_hi:[1,0]
    v_pk_add_f32 v[62:63], v[62:63], 1.0 op_sel_hi:[1,0]
    v_pk_fma_f32 v[102:103], v[144:145], v[144:145], v[102:103]
    v_pk_fma_f32 v[102:103], v[146:147], v[146:147], v[102:103]
    v_pk_fma_f32 v[102:103], v[148:149], v[148:149], v[102:103]
    v_pk_fma_f32 v[102:103], v[150:151], v[150:151], v[102:103]
    v_pk_fma_f32 v[102:103], v[152:153], v[152:153], v[102:103]
    v_pk_fma_f32 v[102:103], v[154:155], v[154:155], v[102:103]
    v_pk_fma_f32 v[102:103], v[156:157], v[156:157], v[102:103]
    v_pk_fma_f32 v[102:103], v[158:159], v[158:159], v[102:103]
    v_mfma_f32_32x32x16_bf16 v[32:47], a[8:11], v[80:83], v[32:47]
    s_waitcnt lgkmcnt(3)
    ds_read_b128 a[4:7], v2 offset:44032
    ds_read_b128 a[8:11], v2 offset:45056
    v_rcp_f32 v48, v48
    v_rcp_f32 v49, v49
    v_mfma_f32_32x32x16_bf16 v[32:47], a[12:15], v[84:87], v[32:47]
    s_waitcnt lgkmcnt(4)
    v_rcp_f32 v50, v50
    v_rcp_f32 v51, v51
    v_rcp_f32 v52, v52
    v_mfma_f32_32x32x16_bf16 v[32:47], a[16:19], v[88:91], v[32:47]
    s_waitcnt lgkmcnt(3)
    ds_read_b128 a[12:15], v2 offset:46080
    ds_read_b128 a[16:19], v2 offset:47104
    v_rcp_f32 v53, v53
    v_rcp_f32 v54, v54
    v_mfma_f32_32x32x16_bf16 v[32:47], a[20:23], v[92:95], v[32:47]
    s_waitcnt lgkmcnt(4)
    v_lshrrev_b32 v10, 4, v2
    v_and_b32 v10, 3, v10
    v_mul_u32_u24 v10, 64, v10
    v_rcp_f32 v55, v55
    v_rcp_f32 v56, v56
    v_rcp_f32 v57, v57
    v_rcp_f32 v58, v58
    v_rcp_f32 v59, v59
    v_rcp_f32 v60, v60
    v_rcp_f32 v61, v61
    v_rcp_f32 v62, v62
    v_rcp_f32_e64 v63, v63
    v_pk_mul_f32 v[16:17], v[16:17], v[48:49]
    v_pk_mul_f32 v[18:19], v[18:19], v[50:51]
    v_pk_mul_f32 v[20:21], v[20:21], v[52:53]
    v_pk_mul_f32 v[22:23], v[22:23], v[54:55]
    v_pk_mul_f32 v[24:25], v[24:25], v[56:57]
    v_pk_mul_f32 v[26:27], v[26:27], v[58:59]
    v_pk_mul_f32 v[28:29], v[28:29], v[60:61]
    v_pk_mul_f32 v[30:31], v[30:31], v[62:63]
    v_pk_fma_f32 v[48:49], v[32:33], v[32:33], s[52:53]
    v_pk_fma_f32 v[50:51], v[34:35], v[34:35], s[52:53]
    v_pk_fma_f32 v[52:53], v[36:37], v[36:37], s[52:53]
    v_pk_fma_f32 v[54:55], v[38:39], v[38:39], s[52:53]
    v_pk_fma_f32 v[56:57], v[40:41], v[40:41], s[52:53]
    v_pk_fma_f32 v[58:59], v[42:43], v[42:43], s[52:53]
    v_pk_fma_f32 v[60:61], v[44:45], v[44:45], s[52:53]
    v_pk_fma_f32 v[62:63], v[46:47], v[46:47], s[52:53]
    v_pk_mul_f32 v[48:49], v[48:49], v[32:33] neg_lo:[1,0] neg_hi:[1,0]
    v_pk_mul_f32 v[50:51], v[50:51], v[34:35] neg_lo:[1,0] neg_hi:[1,0]
    v_pk_mul_f32 v[52:53], v[52:53], v[36:37] neg_lo:[1,0] neg_hi:[1,0]
    v_pk_mul_f32 v[54:55], v[54:55], v[38:39] neg_lo:[1,0] neg_hi:[1,0]
    v_pk_mul_f32 v[56:57], v[56:57], v[40:41] neg_lo:[1,0] neg_hi:[1,0]
    v_pk_mul_f32 v[58:59], v[58:59], v[42:43] neg_lo:[1,0] neg_hi:[1,0]
    v_pk_mul_f32 v[60:61], v[60:61], v[44:45] neg_lo:[1,0] neg_hi:[1,0]
    v_pk_mul_f32 v[62:63], v[62:63], v[46:47] neg_lo:[1,0] neg_hi:[1,0]
    v_cvt_pk_bf16_f32 v64, v16, v17
    v_cvt_pk_bf16_f32 v65, v18, v19
    v_cvt_pk_bf16_f32 v66, v20, v21
    v_cvt_pk_bf16_f32 v67, v22, v23
    v_cvt_pk_bf16_f32 v68, v24, v25
    v_cvt_pk_bf16_f32 v69, v26, v27
    v_cvt_pk_bf16_f32 v70, v28, v29
    v_cvt_pk_bf16_f32 v71, v30, v31
    v_mfma_f32_32x32x16_bf16 v[144:159], v[64:67], a[24:27], 0
    v_exp_f32 v48, v48
    v_exp_f32 v49, v49
    v_exp_f32 v50, v50
    v_mfma_f32_32x32x16_bf16 v[144:159], v[68:71], a[28:31], v[144:159]
    v_exp_f32 v51, v51
    v_exp_f32 v52, v52
    v_exp_f32 v53, v53
    v_mfma_f32_32x32x16_bf16 v[16:31], a[0:3], v[72:75], 0
    s_waitcnt lgkmcnt(3)
    ds_read_b128 a[20:23], v2 offset:48128
    ds_read_b128 a[0:3], v2 offset:61440
    v_exp_f32 v54, v54
    v_exp_f32 v55, v55
    v_mfma_f32_32x32x16_bf16 v[16:31], a[4:7], v[76:79], v[16:31]
    s_waitcnt lgkmcnt(4)
    v_exp_f32 v56, v56
    v_exp_f32 v57, v57
    v_exp_f32 v58, v58
    v_exp_f32 v59, v59
    v_exp_f32 v60, v60
    v_exp_f32 v61, v61
    v_exp_f32 v62, v62
    v_exp_f32 v63, v63
    v_accvgpr_write_b32 a240, v64
    v_accvgpr_write_b32 a241, v65
    v_accvgpr_write_b32 a242, v66
    v_accvgpr_write_b32 a243, v67
    v_accvgpr_write_b32 a244, v68
    v_accvgpr_write_b32 a245, v69
    v_accvgpr_write_b32 a246, v70
    v_accvgpr_write_b32 a247, v71
    v_pk_add_f32 v[48:49], v[48:49], 1.0 op_sel_hi:[1,0]
    v_pk_add_f32 v[50:51], v[50:51], 1.0 op_sel_hi:[1,0]
    v_pk_add_f32 v[52:53], v[52:53], 1.0 op_sel_hi:[1,0]
    v_pk_add_f32 v[54:55], v[54:55], 1.0 op_sel_hi:[1,0]
    v_pk_add_f32 v[56:57], v[56:57], 1.0 op_sel_hi:[1,0]
    v_pk_add_f32 v[58:59], v[58:59], 1.0 op_sel_hi:[1,0]
    v_pk_add_f32 v[60:61], v[60:61], 1.0 op_sel_hi:[1,0]
    v_pk_add_f32 v[62:63], v[62:63], 1.0 op_sel_hi:[1,0]
    v_pk_fma_f32 v[108:109], v[144:145], v[144:145], v[108:109]
    v_pk_fma_f32 v[108:109], v[146:147], v[146:147], v[108:109]
    v_pk_fma_f32 v[108:109], v[148:149], v[148:149], v[108:109]
    v_pk_fma_f32 v[108:109], v[150:151], v[150:151], v[108:109]
    v_pk_fma_f32 v[108:109], v[152:153], v[152:153], v[108:109]
    v_pk_fma_f32 v[108:109], v[154:155], v[154:155], v[108:109]
    v_pk_fma_f32 v[108:109], v[156:157], v[156:157], v[108:109]
    v_pk_fma_f32 v[108:109], v[158:159], v[158:159], v[108:109]
L_pf12:
    v_mfma_f32_32x32x16_bf16 v[16:31], a[8:11], v[80:83], v[16:31]
    s_waitcnt lgkmcnt(3)
    ds_read_b128 a[4:7], v2 offset:62464
    ds_read_b128 a[8:11], v2 offset:63488
    v_rcp_f32 v48, v48
    v_rcp_f32 v49, v49
    v_mfma_f32_32x32x16_bf16 v[16:31], a[12:15], v[84:87], v[16:31]
    s_waitcnt lgkmcnt(4)
    s_mov_b32 s63, L_pf12-L_pc+12288
    buffer_load_dword v6, v7, s[68:71], s63 offen
    v_rcp_f32 v50, v50
    v_rcp_f32 v51, v51
    v_mfma_f32_32x32x16_bf16 v[16:31], a[16:19], v[88:91], v[16:31]
    s_waitcnt lgkmcnt(3)
    ds_read_b128 a[12:15], v2 offset:64512
    ds_read_b128 a[16:19], v3 offset:0
    v_rcp_f32 v52, v52
    v_rcp_f32 v53, v53
    v_mfma_f32_32x32x16_bf16 v[16:31], a[20:23], v[92:95], v[16:31]
    s_waitcnt lgkmcnt(4)
    v_rcp_f32 v54, v54
    v_rcp_f32 v55, v55
    v_rcp_f32 v56, v56
    v_rcp_f32 v57, v57
    v_rcp_f32 v58, v58
    v_rcp_f32 v59, v59
    v_rcp_f32 v60, v60
    v_rcp_f32 v61, v61
    v_rcp_f32 v62, v62
    v_rcp_f32 v63, v63
    v_pk_mul_f32 v[32:33], v[32:33], v[48:49]
    v_pk_mul_f32 v[34:35], v[34:35], v[50:51]
    v_pk_mul_f32 v[36:37], v[36:37], v[52:53]
    v_pk_mul_f32 v[38:39], v[38:39], v[54:55]
    v_pk_mul_f32 v[40:41], v[40:41], v[56:57]
    v_pk_mul_f32 v[42:43], v[42:43], v[58:59]
    v_pk_mul_f32 v[44:45], v[44:45], v[60:61]
    v_pk_mul_f32 v[46:47], v[46:47], v[62:63]
    v_pk_fma_f32 v[48:49], v[16:17], v[16:17], s[52:53]
    v_pk_fma_f32 v[50:51], v[18:19], v[18:19], s[52:53]
    v_pk_fma_f32 v[52:53], v[20:21], v[20:21], s[52:53]
    v_pk_fma_f32 v[54:55], v[22:23], v[22:23], s[52:53]
    v_pk_fma_f32 v[56:57], v[24:25], v[24:25], s[52:53]
    v_pk_fma_f32 v[58:59], v[26:27], v[26:27], s[52:53]
    v_pk_fma_f32 v[60:61], v[28:29], v[28:29], s[52:53]
    v_pk_fma_f32 v[62:63], v[30:31], v[30:31], s[52:53]
    v_pk_mul_f32 v[48:49], v[48:49], v[16:17] neg_lo:[1,0] neg_hi:[1,0]
    v_pk_mul_f32 v[50:51], v[50:51], v[18:19] neg_lo:[1,0] neg_hi:[1,0]
    v_pk_mul_f32 v[52:53], v[52:53], v[20:21] neg_lo:[1,0] neg_hi:[1,0]
    v_pk_mul_f32 v[54:55], v[54:55], v[22:23] neg_lo:[1,0] neg_hi:[1,0]
    v_pk_mul_f32 v[56:57], v[56:57], v[24:25] neg_lo:[1,0] neg_hi:[1,0]
    v_pk_mul_f32 v[58:59], v[58:59], v[26:27] neg_lo:[1,0] neg_hi:[1,0]
    v_pk_mul_f32 v[60:61], v[60:61], v[28:29] neg_lo:[1,0] neg_hi:[1,0]
    v_pk_mul_f32 v[62:63], v[62:63], v[30:31] neg_lo:[1,0] neg_hi:[1,0]
    v_cvt_pk_bf16_f32 v64, v32, v33
    v_cvt_pk_bf16_f32 v65, v34, v35
    v_cvt_pk_bf16_f32 v66, v36, v37
    v_cvt_pk_bf16_f32 v67, v38, v39
    v_cvt_pk_bf16_f32 v68, v40, v41
    v_cvt_pk_bf16_f32 v69, v42, v43
    v_cvt_pk_bf16_f32 v70, v44, v45
    v_cvt_pk_bf16_f32 v71, v46, v47
    v_mfma_f32_32x32x16_bf16 v[144:159], v[64:67], a[24:27], 0
    v_exp_f32 v48, v48
    v_exp_f32 v49, v49
    v_exp_f32 v50, v50
    v_mfma_f32_32x32x16_bf16 v[144:159], v[68:71], a[28:31], v[144:159]
    v_exp_f32 v51, v51
    v_exp_f32 v52, v52
    v_exp_f32 v53, v53
    v_mfma_f32_32x32x16_bf16 v[32:47], a[0:3], v[72:75], 0
    s_waitcnt lgkmcnt(3)
    ds_read_b128 a[20:23], v3 offset:1024
    ds_read_b128 a[0:3], v2 offset:12288
    v_exp_f32 v54, v54
    v_exp_f32 v55, v55
    v_mfma_f32_32x32x16_bf16 v[32:47], a[4:7], v[76:79], v[32:47]
    s_waitcnt lgkmcnt(4)
    v_exp_f32 v56, v56
    v_exp_f32 v57, v57
    v_exp_f32 v58, v58
    v_exp_f32 v59, v59
    v_exp_f32 v60, v60
    v_exp_f32 v61, v61
    v_exp_f32 v62, v62
    v_exp_f32 v63, v63
    v_accvgpr_write_b32 a248, v64
    v_accvgpr_write_b32 a249, v65
    v_accvgpr_write_b32 a250, v66
    v_accvgpr_write_b32 a251, v67
    v_accvgpr_write_b32 a252, v68
    v_accvgpr_write_b32 a253, v69
    v_accvgpr_write_b32 a254, v70
    v_accvgpr_write_b32 a255, v71
    v_pk_add_f32 v[48:49], v[48:49], 1.0 op_sel_hi:[1,0]
    v_pk_add_f32 v[50:51], v[50:51], 1.0 op_sel_hi:[1,0]
    v_pk_add_f32 v[52:53], v[52:53], 1.0 op_sel_hi:[1,0]
    v_pk_add_f32 v[54:55], v[54:55], 1.0 op_sel_hi:[1,0]
    v_pk_add_f32 v[56:57], v[56:57], 1.0 op_sel_hi:[1,0]
    v_pk_add_f32 v[58:59], v[58:59], 1.0 op_sel_hi:[1,0]
    v_pk_add_f32 v[60:61], v[60:61], 1.0 op_sel_hi:[1,0]
    v_pk_add_f32 v[62:63], v[62:63], 1.0 op_sel_hi:[1,0]
    v_pk_fma_f32 v[106:107], v[144:145], v[144:145], v[106:107]
    v_pk_fma_f32 v[106:107], v[146:147], v[146:147], v[106:107]
    v_pk_fma_f32 v[106:107], v[148:149], v[148:149], v[106:107]
    v_pk_fma_f32 v[106:107], v[150:151], v[150:151], v[106:107]
    v_pk_fma_f32 v[106:107], v[152:153], v[152:153], v[106:107]
    v_pk_fma_f32 v[106:107], v[154:155], v[154:155], v[106:107]
    v_pk_fma_f32 v[106:107], v[156:157], v[156:157], v[106:107]
    v_pk_fma_f32 v[106:107], v[158:159], v[158:159], v[106:107]
    v_mfma_f32_32x32x16_bf16 v[32:47], a[8:11], v[80:83], v[32:47]
    s_waitcnt lgkmcnt(3)
    ds_read_b128 a[4:7], v2 offset:13312
    ds_read_b128 a[8:11], v2 offset:14336
    v_rcp_f32 v48, v48
    v_rcp_f32 v49, v49
    v_mfma_f32_32x32x16_bf16 v[32:47], a[12:15], v[84:87], v[32:47]
    s_waitcnt lgkmcnt(4)
    v_rcp_f32 v50, v50
    v_rcp_f32 v51, v51
    v_rcp_f32 v52, v52
    v_mfma_f32_32x32x16_bf16 v[32:47], a[16:19], v[88:91], v[32:47]
    s_waitcnt lgkmcnt(3)
    ds_read_b128 a[12:15], v2 offset:15360
    ds_read_b128 a[16:19], v2 offset:16384
    v_rcp_f32 v53, v53
    v_rcp_f32 v54, v54
    v_mfma_f32_32x32x16_bf16 v[32:47], a[20:23], v[92:95], v[32:47]
    s_waitcnt lgkmcnt(4)
    v_rcp_f32 v55, v55
    v_rcp_f32 v56, v56
    v_rcp_f32 v57, v57
    v_rcp_f32 v58, v58
    v_rcp_f32 v59, v59
    v_rcp_f32 v60, v60
    v_rcp_f32 v61, v61
    v_rcp_f32 v62, v62
    v_rcp_f32 v63, v63
    v_pk_mul_f32 v[16:17], v[16:17], v[48:49]
    v_pk_mul_f32 v[18:19], v[18:19], v[50:51]
    v_pk_mul_f32 v[20:21], v[20:21], v[52:53]
    v_pk_mul_f32 v[22:23], v[22:23], v[54:55]
    v_pk_mul_f32 v[24:25], v[24:25], v[56:57]
    v_pk_mul_f32 v[26:27], v[26:27], v[58:59]
    v_pk_mul_f32 v[28:29], v[28:29], v[60:61]
    v_pk_mul_f32 v[30:31], v[30:31], v[62:63]
    v_pk_fma_f32 v[48:49], v[32:33], v[32:33], s[52:53]
    v_pk_fma_f32 v[50:51], v[34:35], v[34:35], s[52:53]
    v_pk_fma_f32 v[52:53], v[36:37], v[36:37], s[52:53]
    v_pk_fma_f32 v[54:55], v[38:39], v[38:39], s[52:53]
    v_pk_fma_f32 v[56:57], v[40:41], v[40:41], s[52:53]
    v_pk_fma_f32 v[58:59], v[42:43], v[42:43], s[52:53]
    v_pk_fma_f32 v[60:61], v[44:45], v[44:45], s[52:53]
    v_pk_fma_f32 v[62:63], v[46:47], v[46:47], s[52:53]
    v_pk_mul_f32 v[48:49], v[48:49], v[32:33] neg_lo:[1,0] neg_hi:[1,0]
    v_pk_mul_f32 v[50:51], v[50:51], v[34:35] neg_lo:[1,0] neg_hi:[1,0]
    v_pk_mul_f32 v[52:53], v[52:53], v[36:37] neg_lo:[1,0] neg_hi:[1,0]
    v_pk_mul_f32 v[54:55], v[54:55], v[38:39] neg_lo:[1,0] neg_hi:[1,0]
    v_pk_mul_f32 v[56:57], v[56:57], v[40:41] neg_lo:[1,0] neg_hi:[1,0]
    v_pk_mul_f32 v[58:59], v[58:59], v[42:43] neg_lo:[1,0] neg_hi:[1,0]
    v_pk_mul_f32 v[60:61], v[60:61], v[44:45] neg_lo:[1,0] neg_hi:[1,0]
    v_pk_mul_f32 v[62:63], v[62:63], v[46:47] neg_lo:[1,0] neg_hi:[1,0]
    v_cvt_pk_bf16_f32 v120, v16, v17
    v_cvt_pk_bf16_f32 v121, v18, v19
    v_cvt_pk_bf16_f32 v122, v20, v21
    v_cvt_pk_bf16_f32 v123, v22, v23
    v_cvt_pk_bf16_f32 v124, v24, v25
    v_cvt_pk_bf16_f32 v125, v26, v27
    v_cvt_pk_bf16_f32 v126, v28, v29
    v_cvt_pk_bf16_f32 v127, v30, v31
    v_mfma_f32_32x32x16_bf16 v[144:159], v[120:123], a[24:27], 0
    v_exp_f32 v48, v48
    v_exp_f32 v49, v49
    v_exp_f32 v50, v50
    v_mfma_f32_32x32x16_bf16 v[144:159], v[124:127], a[28:31], v[144:159]
    v_exp_f32 v51, v51
    v_exp_f32 v52, v52
    v_exp_f32 v53, v53
    v_mfma_f32_32x32x16_bf16 v[16:31], a[0:3], v[72:75], 0
    s_waitcnt lgkmcnt(3)
    ds_read_b128 a[20:23], v2 offset:17408
    ds_read_b128 a[0:3], v2 offset:49152
    v_exp_f32 v54, v54
    v_exp_f32 v55, v55
    v_mfma_f32_32x32x16_bf16 v[16:31], a[4:7], v[76:79], v[16:31]
    s_waitcnt lgkmcnt(4)
    v_exp_f32 v56, v56
    v_exp_f32 v57, v57
    v_exp_f32 v58, v58
    v_exp_f32 v59, v59
    v_exp_f32 v60, v60
    v_exp_f32 v61, v61
    v_exp_f32 v62, v62
    v_exp_f32 v63, v63
    v_pk_add_f32 v[48:49], v[48:49], 1.0 op_sel_hi:[1,0]
    v_pk_add_f32 v[50:51], v[50:51], 1.0 op_sel_hi:[1,0]
    v_pk_add_f32 v[52:53], v[52:53], 1.0 op_sel_hi:[1,0]
    v_pk_add_f32 v[54:55], v[54:55], 1.0 op_sel_hi:[1,0]
    v_pk_add_f32 v[56:57], v[56:57], 1.0 op_sel_hi:[1,0]
    v_pk_add_f32 v[58:59], v[58:59], 1.0 op_sel_hi:[1,0]
    v_pk_add_f32 v[60:61], v[60:61], 1.0 op_sel_hi:[1,0]
    v_pk_add_f32 v[62:63], v[62:63], 1.0 op_sel_hi:[1,0]
    v_pk_fma_f32 v[110:111], v[144:145], v[144:145], v[110:111]
    v_pk_fma_f32 v[110:111], v[146:147], v[146:147], v[110:111]
    v_pk_fma_f32 v[110:111], v[148:149], v[148:149], v[110:111]
    v_pk_fma_f32 v[110:111], v[150:151], v[150:151], v[110:111]
    v_pk_fma_f32 v[110:111], v[152:153], v[152:153], v[110:111]
    v_pk_fma_f32 v[110:111], v[154:155], v[154:155], v[110:111]
    v_pk_fma_f32 v[110:111], v[156:157], v[156:157], v[110:111]
    v_pk_fma_f32 v[110:111], v[158:159], v[158:159], v[110:111]
    v_mfma_f32_32x32x16_bf16 v[16:31], a[8:11], v[80:83], v[16:31]
    s_waitcnt lgkmcnt(3)
    ds_read_b128 a[4:7], v2 offset:50176
    ds_read_b128 a[8:11], v2 offset:51200
    v_rcp_f32 v48, v48
    v_rcp_f32 v49, v49
    v_mfma_f32_32x32x16_bf16 v[16:31], a[12:15], v[84:87], v[16:31]
    s_waitcnt lgkmcnt(4)
    v_rcp_f32 v50, v50
    v_rcp_f32 v51, v51
    v_rcp_f32 v52, v52
    v_mfma_f32_32x32x16_bf16 v[16:31], a[16:19], v[88:91], v[16:31]
    s_waitcnt lgkmcnt(3)
    ds_read_b128 a[12:15], v2 offset:52224
    ds_read_b128 a[16:19], v2 offset:53248
    v_rcp_f32 v53, v53
    v_rcp_f32 v54, v54
    v_mfma_f32_32x32x16_bf16 v[16:31], a[20:23], v[92:95], v[16:31]
    s_waitcnt lgkmcnt(4)
    v_rcp_f32 v55, v55
    v_rcp_f32 v56, v56
    v_rcp_f32 v57, v57
    v_rcp_f32 v58, v58
    v_rcp_f32 v59, v59
    v_rcp_f32 v60, v60
    v_rcp_f32 v61, v61
    v_rcp_f32 v62, v62
    v_rcp_f32 v63, v63
    v_pk_mul_f32 v[32:33], v[32:33], v[48:49]
    v_pk_mul_f32 v[34:35], v[34:35], v[50:51]
    v_pk_mul_f32 v[36:37], v[36:37], v[52:53]
    v_pk_mul_f32 v[38:39], v[38:39], v[54:55]
    v_pk_mul_f32 v[40:41], v[40:41], v[56:57]
    v_pk_mul_f32 v[42:43], v[42:43], v[58:59]
    v_pk_mul_f32 v[44:45], v[44:45], v[60:61]
    v_pk_mul_f32 v[46:47], v[46:47], v[62:63]
    v_pk_fma_f32 v[48:49], v[16:17], v[16:17], s[52:53]
    v_pk_fma_f32 v[50:51], v[18:19], v[18:19], s[52:53]
    v_pk_fma_f32 v[52:53], v[20:21], v[20:21], s[52:53]
    v_pk_fma_f32 v[54:55], v[22:23], v[22:23], s[52:53]
    v_pk_fma_f32 v[56:57], v[24:25], v[24:25], s[52:53]
    v_pk_fma_f32 v[58:59], v[26:27], v[26:27], s[52:53]
    v_pk_fma_f32 v[60:61], v[28:29], v[28:29], s[52:53]
    v_pk_fma_f32 v[62:63], v[30:31], v[30:31], s[52:53]
    v_pk_mul_f32 v[48:49], v[48:49], v[16:17] neg_lo:[1,0] neg_hi:[1,0]
    v_pk_mul_f32 v[50:51], v[50:51], v[18:19] neg_lo:[1,0] neg_hi:[1,0]
    v_pk_mul_f32 v[52:53], v[52:53], v[20:21] neg_lo:[1,0] neg_hi:[1,0]
    v_pk_mul_f32 v[54:55], v[54:55], v[22:23] neg_lo:[1,0] neg_hi:[1,0]
    v_pk_mul_f32 v[56:57], v[56:57], v[24:25] neg_lo:[1,0] neg_hi:[1,0]
    v_pk_mul_f32 v[58:59], v[58:59], v[26:27] neg_lo:[1,0] neg_hi:[1,0]
    v_pk_mul_f32 v[60:61], v[60:61], v[28:29] neg_lo:[1,0] neg_hi:[1,0]
    v_pk_mul_f32 v[62:63], v[62:63], v[30:31] neg_lo:[1,0] neg_hi:[1,0]
    v_cvt_pk_bf16_f32 v128, v32, v33
    v_cvt_pk_bf16_f32 v129, v34, v35
    v_cvt_pk_bf16_f32 v130, v36, v37
    v_cvt_pk_bf16_f32 v131, v38, v39
    v_cvt_pk_bf16_f32 v132, v40, v41
    v_cvt_pk_bf16_f32 v133, v42, v43
    v_cvt_pk_bf16_f32 v134, v44, v45
    v_cvt_pk_bf16_f32 v135, v46, v47
    v_mfma_f32_32x32x16_bf16 v[144:159], v[128:131], a[24:27], 0
    v_exp_f32 v48, v48
    v_exp_f32 v49, v49
    v_exp_f32 v50, v50
    v_mfma_f32_32x32x16_bf16 v[144:159], v[132:135], a[28:31], v[144:159]
    v_exp_f32 v51, v51
    v_exp_f32 v52, v52
    v_exp_f32 v53, v53
    v_mfma_f32_32x32x16_bf16 v[32:47], a[0:3], v[72:75], 0
    s_waitcnt lgkmcnt(3)
    ds_read_b128 a[20:23], v2 offset:54272
    ds_read_b128 a[0:3], v3 offset:2048
    v_exp_f32 v54, v54
    v_exp_f32 v55, v55
    v_mfma_f32_32x32x16_bf16 v[32:47], a[4:7], v[76:79], v[32:47]
    s_waitcnt lgkmcnt(4)
    v_exp_f32 v56, v56
    v_exp_f32 v57, v57
    v_exp_f32 v58, v58
    v_exp_f32 v59, v59
    v_exp_f32 v60, v60
    v_exp_f32 v61, v61
    v_exp_f32 v62, v62
    v_exp_f32 v63, v63
    v_pk_add_f32 v[48:49], v[48:49], 1.0 op_sel_hi:[1,0]
    v_pk_add_f32 v[50:51], v[50:51], 1.0 op_sel_hi:[1,0]
    v_pk_add_f32 v[52:53], v[52:53], 1.0 op_sel_hi:[1,0]
    v_pk_add_f32 v[54:55], v[54:55], 1.0 op_sel_hi:[1,0]
    v_pk_add_f32 v[56:57], v[56:57], 1.0 op_sel_hi:[1,0]
    v_pk_add_f32 v[58:59], v[58:59], 1.0 op_sel_hi:[1,0]
    v_pk_add_f32 v[60:61], v[60:61], 1.0 op_sel_hi:[1,0]
    v_pk_add_f32 v[62:63], v[62:63], 1.0 op_sel_hi:[1,0]
    v_pk_fma_f32 v[116:117], v[144:145], v[144:145], v[116:117]
    v_pk_fma_f32 v[116:117], v[146:147], v[146:147], v[116:117]
    v_pk_fma_f32 v[116:117], v[148:149], v[148:149], v[116:117]
    v_pk_fma_f32 v[116:117], v[150:151], v[150:151], v[116:117]
    v_pk_fma_f32 v[116:117], v[152:153], v[152:153], v[116:117]
    v_pk_fma_f32 v[116:117], v[154:155], v[154:155], v[116:117]
    v_pk_fma_f32 v[116:117], v[156:157], v[156:157], v[116:117]
    v_pk_fma_f32 v[116:117], v[158:159], v[158:159], v[116:117]
    v_mfma_f32_32x32x16_bf16 v[32:47], a[8:11], v[80:83], v[32:47]
    s_waitcnt lgkmcnt(3)
    ds_read_b128 a[4:7], v3 offset:3072
    ds_read_b128 a[8:11], v3 offset:4096
    v_rcp_f32 v48, v48
    v_rcp_f32 v49, v49
    v_mfma_f32_32x32x16_bf16 v[32:47], a[12:15], v[84:87], v[32:47]
    s_waitcnt lgkmcnt(4)
    v_rcp_f32 v50, v50
    v_rcp_f32 v51, v51
    v_rcp_f32 v52, v52
    v_mfma_f32_32x32x16_bf16 v[32:47], a[16:19], v[88:91], v[32:47]
    s_waitcnt lgkmcnt(3)
    ds_read_b128 a[12:15], v3 offset:5120
    ds_read_b128 a[16:19], v3 offset:6144
    v_rcp_f32 v53, v53
    v_rcp_f32 v54, v54
    v_mfma_f32_32x32x16_bf16 v[32:47], a[20:23], v[92:95], v[32:47]
    s_waitcnt lgkmcnt(4)
    v_rcp_f32 v55, v55
    v_rcp_f32 v56, v56
    v_rcp_f32 v57, v57
    v_rcp_f32 v58, v58
    v_rcp_f32 v59, v59
    v_rcp_f32 v60, v60
    v_rcp_f32 v61, v61
    v_rcp_f32 v62, v62
    v_rcp_f32 v63, v63
    v_pk_mul_f32 v[16:17], v[16:17], v[48:49]
    v_pk_mul_f32 v[18:19], v[18:19], v[50:51]
    v_pk_mul_f32 v[20:21], v[20:21], v[52:53]
    v_pk_mul_f32 v[22:23], v[22:23], v[54:55]
    v_pk_mul_f32 v[24:25], v[24:25], v[56:57]
    v_pk_mul_f32 v[26:27], v[26:27], v[58:59]
    v_pk_mul_f32 v[28:29], v[28:29], v[60:61]
    v_pk_mul_f32 v[30:31], v[30:31], v[62:63]
    v_pk_fma_f32 v[48:49], v[32:33], v[32:33], s[52:53]
    v_pk_fma_f32 v[50:51], v[34:35], v[34:35], s[52:53]
    v_pk_fma_f32 v[52:53], v[36:37], v[36:37], s[52:53]
    v_pk_fma_f32 v[54:55], v[38:39], v[38:39], s[52:53]
    v_pk_fma_f32 v[56:57], v[40:41], v[40:41], s[52:53]
    v_pk_fma_f32 v[58:59], v[42:43], v[42:43], s[52:53]
    v_pk_fma_f32 v[60:61], v[44:45], v[44:45], s[52:53]
    v_pk_fma_f32 v[62:63], v[46:47], v[46:47], s[52:53]
    v_pk_mul_f32 v[48:49], v[48:49], v[32:33] neg_lo:[1,0] neg_hi:[1,0]
    v_pk_mul_f32 v[50:51], v[50:51], v[34:35] neg_lo:[1,0] neg_hi:[1,0]
    v_pk_mul_f32 v[52:53], v[52:53], v[36:37] neg_lo:[1,0] neg_hi:[1,0]
    v_pk_mul_f32 v[54:55], v[54:55], v[38:39] neg_lo:[1,0] neg_hi:[1,0]
    v_pk_mul_f32 v[56:57], v[56:57], v[40:41] neg_lo:[1,0] neg_hi:[1,0]
    v_pk_mul_f32 v[58:59], v[58:59], v[42:43] neg_lo:[1,0] neg_hi:[1,0]
    v_pk_mul_f32 v[60:61], v[60:61], v[44:45] neg_lo:[1,0] neg_hi:[1,0]
    v_pk_mul_f32 v[62:63], v[62:63], v[46:47] neg_lo:[1,0] neg_hi:[1,0]
    v_cvt_pk_bf16_f32 v136, v16, v17
    v_cvt_pk_bf16_f32 v137, v18, v19
    v_cvt_pk_bf16_f32 v138, v20, v21
    v_cvt_pk_bf16_f32 v139, v22, v23
    v_cvt_pk_bf16_f32 v140, v24, v25
    v_cvt_pk_bf16_f32 v141, v26, v27
    v_cvt_pk_bf16_f32 v142, v28, v29
    v_cvt_pk_bf16_f32 v143, v30, v31
    v_mfma_f32_32x32x16_bf16 v[144:159], v[136:139], a[24:27], 0
    v_exp_f32 v48, v48
    v_exp_f32 v49, v49
    v_exp_f32 v50, v50
    v_mfma_f32_32x32x16_bf16 v[144:159], v[140:143], a[28:31], v[144:159]
    v_exp_f32 v51, v51
    v_exp_f32 v52, v52
    v_exp_f32 v53, v53
    v_mfma_f32_32x32x16_bf16 v[16:31], a[0:3], v[72:75], 0
    s_waitcnt lgkmcnt(3)
    ds_read_b128 a[20:23], v3 offset:7168
    ds_read_b128 a[0:3], v2 offset:24576
    v_exp_f32 v54, v54
    v_exp_f32 v55, v55
    v_mfma_f32_32x32x16_bf16 v[16:31], a[4:7], v[76:79], v[16:31]
    s_waitcnt lgkmcnt(4)
    v_exp_f32 v56, v56
    v_exp_f32 v57, v57
    v_exp_f32 v58, v58
    v_exp_f32 v59, v59
    v_exp_f32 v60, v60
    v_exp_f32 v61, v61
    v_exp_f32 v62, v62
    v_exp_f32 v63, v63
    v_pk_add_f32 v[48:49], v[48:49], 1.0 op_sel_hi:[1,0]
    v_pk_add_f32 v[50:51], v[50:51], 1.0 op_sel_hi:[1,0]
    v_pk_add_f32 v[52:53], v[52:53], 1.0 op_sel_hi:[1,0]
    v_pk_add_f32 v[54:55], v[54:55], 1.0 op_sel_hi:[1,0]
    v_pk_add_f32 v[56:57], v[56:57], 1.0 op_sel_hi:[1,0]
    v_pk_add_f32 v[58:59], v[58:59], 1.0 op_sel_hi:[1,0]
    v_pk_add_f32 v[60:61], v[60:61], 1.0 op_sel_hi:[1,0]
    v_pk_add_f32 v[62:63], v[62:63], 1.0 op_sel_hi:[1,0]
    v_pk_fma_f32 v[100:101], v[144:145], v[144:145], v[100:101]
    v_pk_fma_f32 v[100:101], v[146:147], v[146:147], v[100:101]
    v_pk_fma_f32 v[100:101], v[148:149], v[148:149], v[100:101]
    v_pk_fma_f32 v[100:101], v[150:151], v[150:151], v[100:101]
    v_pk_fma_f32 v[100:101], v[152:153], v[152:153], v[100:101]
    v_pk_fma_f32 v[100:101], v[154:155], v[154:155], v[100:101]
    v_pk_fma_f32 v[100:101], v[156:157], v[156:157], v[100:101]
    v_pk_fma_f32 v[100:101], v[158:159], v[158:159], v[100:101]
    v_mfma_f32_32x32x16_bf16 v[16:31], a[8:11], v[80:83], v[16:31]
    s_waitcnt lgkmcnt(3)
    ds_read_b128 a[4:7], v2 offset:25600
    ds_read_b128 a[8:11], v2 offset:26624
    v_rcp_f32 v48, v48
    v_rcp_f32 v49, v49
    v_mfma_f32_32x32x16_bf16 v[16:31], a[12:15], v[84:87], v[16:31]
    s_waitcnt lgkmcnt(4)
    v_rcp_f32 v50, v50
    v_rcp_f32 v51, v51
    v_rcp_f32 v52, v52
    v_mfma_f32_32x32x16_bf16 v[16:31], a[16:19], v[88:91], v[16:31]
    s_waitcnt lgkmcnt(3)
    ds_read_b128 a[12:15], v2 offset:27648
    ds_read_b128 a[16:19], v2 offset:28672
    v_rcp_f32 v53, v53
    v_rcp_f32 v54, v54
    v_mfma_f32_32x32x16_bf16 v[16:31], a[20:23], v[92:95], v[16:31]
    s_waitcnt lgkmcnt(4)
    v_rcp_f32 v55, v55
    v_rcp_f32 v56, v56
    v_rcp_f32 v57, v57
    v_rcp_f32 v58, v58
    v_rcp_f32 v59, v59
    v_rcp_f32 v60, v60
    v_rcp_f32 v61, v61
    v_rcp_f32 v62, v62
    v_rcp_f32 v63, v63
    v_pk_mul_f32 v[32:33], v[32:33], v[48:49]
    v_pk_mul_f32 v[34:35], v[34:35], v[50:51]
    v_pk_mul_f32 v[36:37], v[36:37], v[52:53]
    v_pk_mul_f32 v[38:39], v[38:39], v[54:55]
    v_pk_mul_f32 v[40:41], v[40:41], v[56:57]
    v_pk_mul_f32 v[42:43], v[42:43], v[58:59]
    v_pk_mul_f32 v[44:45], v[44:45], v[60:61]
    v_pk_mul_f32 v[46:47], v[46:47], v[62:63]
    v_pk_fma_f32 v[48:49], v[16:17], v[16:17], s[52:53]
    v_pk_fma_f32 v[50:51], v[18:19], v[18:19], s[52:53]
    v_pk_fma_f32 v[52:53], v[20:21], v[20:21], s[52:53]
    v_pk_fma_f32 v[54:55], v[22:23], v[22:23], s[52:53]
    v_pk_fma_f32 v[56:57], v[24:25], v[24:25], s[52:53]
    v_pk_fma_f32 v[58:59], v[26:27], v[26:27], s[52:53]
    v_pk_fma_f32 v[60:61], v[28:29], v[28:29], s[52:53]
    v_pk_fma_f32 v[62:63], v[30:31], v[30:31], s[52:53]
    v_pk_mul_f32 v[48:49], v[48:49], v[16:17] neg_lo:[1,0] neg_hi:[1,0]
    v_pk_mul_f32 v[50:51], v[50:51], v[18:19] neg_lo:[1,0] neg_hi:[1,0]
    v_pk_mul_f32 v[52:53], v[52:53], v[20:21] neg_lo:[1,0] neg_hi:[1,0]
    v_pk_mul_f32 v[54:55], v[54:55], v[22:23] neg_lo:[1,0] neg_hi:[1,0]
    v_pk_mul_f32 v[56:57], v[56:57], v[24:25] neg_lo:[1,0] neg_hi:[1,0]
    v_pk_mul_f32 v[58:59], v[58:59], v[26:27] neg_lo:[1,0] neg_hi:[1,0]
    v_pk_mul_f32 v[60:61], v[60:61], v[28:29] neg_lo:[1,0] neg_hi:[1,0]
    v_pk_mul_f32 v[62:63], v[62:63], v[30:31] neg_lo:[1,0] neg_hi:[1,0]
    v_cvt_pk_bf16_f32 v144, v32, v33
    v_cvt_pk_bf16_f32 v145, v34, v35
    v_cvt_pk_bf16_f32 v146, v36, v37
    v_cvt_pk_bf16_f32 v147, v38, v39
    v_cvt_pk_bf16_f32 v148, v40, v41
    v_cvt_pk_bf16_f32 v149, v42, v43
    v_cvt_pk_bf16_f32 v150, v44, v45
    v_cvt_pk_bf16_f32 v151, v46, v47
    v_mfma_f32_32x32x16_bf16 v[32:47], v[144:147], a[24:27], 0
    v_exp_f32 v48, v48
    v_exp_f32 v49, v49
    v_exp_f32 v50, v50
    v_mfma_f32_32x32x16_bf16 v[32:47], v[148:151], a[28:31], v[32:47]
    v_exp_f32 v51, v51
    v_exp_f32 v52, v52
    v_exp_f32 v53, v53
    v_exp_f32 v54, v54
    v_exp_f32 v55, v55
    v_exp_f32 v56, v56
    v_exp_f32 v57, v57
    v_exp_f32 v58, v58
    v_exp_f32 v59, v59
    v_exp_f32 v60, v60
    v_exp_f32 v61, v61
    v_exp_f32 v62, v62
    v_exp_f32 v63, v63
    v_pk_add_f32 v[48:49], v[48:49], 1.0 op_sel_hi:[1,0]
    v_pk_add_f32 v[50:51], v[50:51], 1.0 op_sel_hi:[1,0]
    v_pk_add_f32 v[52:53], v[52:53], 1.0 op_sel_hi:[1,0]
    v_pk_add_f32 v[54:55], v[54:55], 1.0 op_sel_hi:[1,0]
    v_pk_add_f32 v[56:57], v[56:57], 1.0 op_sel_hi:[1,0]
    v_pk_add_f32 v[58:59], v[58:59], 1.0 op_sel_hi:[1,0]
    v_pk_add_f32 v[60:61], v[60:61], 1.0 op_sel_hi:[1,0]
    v_pk_add_f32 v[62:63], v[62:63], 1.0 op_sel_hi:[1,0]
    v_pk_fma_f32 v[112:113], v[32:33], v[32:33], v[112:113]
    v_pk_fma_f32 v[112:113], v[34:35], v[34:35], v[112:113]
    v_pk_fma_f32 v[112:113], v[36:37], v[36:37], v[112:113]
    v_pk_fma_f32 v[112:113], v[38:39], v[38:39], v[112:113]
    v_pk_fma_f32 v[112:113], v[40:41], v[40:41], v[112:113]
    v_pk_fma_f32 v[112:113], v[42:43], v[42:43], v[112:113]
    v_pk_fma_f32 v[112:113], v[44:45], v[44:45], v[112:113]
    v_pk_fma_f32 v[112:113], v[46:47], v[46:47], v[112:113]
    v_mfma_f32_32x32x16_bf16 v[32:47], a[0:3], v[72:75], 0
    s_waitcnt lgkmcnt(3)
    ds_read_b128 a[20:23], v2 offset:29696
    ds_read_b128 a[0:3], v2 offset:55296
    v_rcp_f32 v48, v48
    v_rcp_f32 v49, v49
    v_mfma_f32_32x32x16_bf16 v[32:47], a[4:7], v[76:79], v[32:47]
    s_waitcnt lgkmcnt(4)
    v_rcp_f32 v50, v50
    v_rcp_f32 v51, v51
    v_rcp_f32 v52, v52
    v_mfma_f32_32x32x16_bf16 v[32:47], a[8:11], v[80:83], v[32:47]
    s_waitcnt lgkmcnt(3)
    ds_read_b128 a[4:7], v2 offset:56320
    ds_read_b128 a[8:11], v2 offset:57344
    v_rcp_f32 v53, v53
    v_rcp_f32 v54, v54
    v_mfma_f32_32x32x16_bf16 v[32:47], a[12:15], v[84:87], v[32:47]
    s_waitcnt lgkmcnt(4)
    v_rcp_f32 v55, v55
    v_rcp_f32 v56, v56
    v_rcp_f32 v57, v57
    v_mfma_f32_32x32x16_bf16 v[32:47], a[16:19], v[88:91], v[32:47]
    s_waitcnt lgkmcnt(3)
    ds_read_b128 a[12:15], v2 offset:58368
    ds_read_b128 a[16:19], v2 offset:59392
    v_rcp_f32 v58, v58
    v_rcp_f32 v59, v59
    v_mfma_f32_32x32x16_bf16 v[32:47], a[20:23], v[92:95], v[32:47]
    s_waitcnt lgkmcnt(4)
    v_rcp_f32 v60, v60
    v_rcp_f32 v61, v61
    v_rcp_f32 v62, v62
    v_rcp_f32 v63, v63
    v_pk_mul_f32 v[16:17], v[16:17], v[48:49]
    v_pk_mul_f32 v[18:19], v[18:19], v[50:51]
    v_pk_mul_f32 v[20:21], v[20:21], v[52:53]
    v_pk_mul_f32 v[22:23], v[22:23], v[54:55]
    v_pk_mul_f32 v[24:25], v[24:25], v[56:57]
    v_pk_mul_f32 v[26:27], v[26:27], v[58:59]
    v_pk_mul_f32 v[28:29], v[28:29], v[60:61]
    v_pk_mul_f32 v[30:31], v[30:31], v[62:63]
    v_pk_fma_f32 v[48:49], v[32:33], v[32:33], s[52:53]
    v_pk_fma_f32 v[50:51], v[34:35], v[34:35], s[52:53]
    v_pk_fma_f32 v[52:53], v[36:37], v[36:37], s[52:53]
    v_pk_fma_f32 v[54:55], v[38:39], v[38:39], s[52:53]
    v_pk_fma_f32 v[56:57], v[40:41], v[40:41], s[52:53]
    v_pk_fma_f32 v[58:59], v[42:43], v[42:43], s[52:53]
    v_pk_fma_f32 v[60:61], v[44:45], v[44:45], s[52:53]
    v_pk_fma_f32 v[62:63], v[46:47], v[46:47], s[52:53]
    v_pk_mul_f32 v[48:49], v[48:49], v[32:33] neg_lo:[1,0] neg_hi:[1,0]
    v_pk_mul_f32 v[50:51], v[50:51], v[34:35] neg_lo:[1,0] neg_hi:[1,0]
    v_pk_mul_f32 v[52:53], v[52:53], v[36:37] neg_lo:[1,0] neg_hi:[1,0]
    v_pk_mul_f32 v[54:55], v[54:55], v[38:39] neg_lo:[1,0] neg_hi:[1,0]
    v_pk_mul_f32 v[56:57], v[56:57], v[40:41] neg_lo:[1,0] neg_hi:[1,0]
    v_pk_mul_f32 v[58:59], v[58:59], v[42:43] neg_lo:[1,0] neg_hi:[1,0]
    v_pk_mul_f32 v[60:61], v[60:61], v[44:45] neg_lo:[1,0] neg_hi:[1,0]
    v_pk_mul_f32 v[62:63], v[62:63], v[46:47] neg_lo:[1,0] neg_hi:[1,0]
    v_cvt_pk_bf16_f32 v152, v16, v17
    v_cvt_pk_bf16_f32 v153, v18, v19
    v_cvt_pk_bf16_f32 v154, v20, v21
    v_cvt_pk_bf16_f32 v155, v22, v23
    v_cvt_pk_bf16_f32 v156, v24, v25
    v_cvt_pk_bf16_f32 v157, v26, v27
    v_cvt_pk_bf16_f32 v158, v28, v29
    v_cvt_pk_bf16_f32 v159, v30, v31
    v_mfma_f32_32x32x16_bf16 v[16:31], v[152:155], a[24:27], 0
    v_exp_f32 v48, v48
    v_exp_f32 v49, v49
    v_exp_f32 v50, v50
    v_mfma_f32_32x32x16_bf16 v[16:31], v[156:159], a[28:31], v[16:31]
    v_exp_f32 v51, v51
    v_exp_f32 v52, v52
    v_exp_f32 v53, v53
    v_exp_f32 v54, v54
    v_exp_f32 v55, v55
    v_exp_f32 v56, v56
    v_exp_f32 v57, v57
    v_exp_f32 v58, v58
    v_exp_f32 v59, v59
    v_exp_f32 v60, v60
    v_exp_f32 v61, v61
    v_exp_f32 v62, v62
    v_exp_f32 v63, v63
    v_pk_add_f32 v[48:49], v[48:49], 1.0 op_sel_hi:[1,0]
    v_pk_add_f32 v[50:51], v[50:51], 1.0 op_sel_hi:[1,0]
    v_pk_add_f32 v[52:53], v[52:53], 1.0 op_sel_hi:[1,0]
    v_pk_add_f32 v[54:55], v[54:55], 1.0 op_sel_hi:[1,0]
    v_pk_add_f32 v[56:57], v[56:57], 1.0 op_sel_hi:[1,0]
    v_pk_add_f32 v[58:59], v[58:59], 1.0 op_sel_hi:[1,0]
    v_pk_add_f32 v[60:61], v[60:61], 1.0 op_sel_hi:[1,0]
    v_pk_add_f32 v[62:63], v[62:63], 1.0 op_sel_hi:[1,0]
    v_pk_fma_f32 v[118:119], v[16:17], v[16:17], v[118:119]
    v_pk_fma_f32 v[118:119], v[18:19], v[18:19], v[118:119]
    v_pk_fma_f32 v[118:119], v[20:21], v[20:21], v[118:119]
    v_pk_fma_f32 v[118:119], v[22:23], v[22:23], v[118:119]
    v_pk_fma_f32 v[118:119], v[24:25], v[24:25], v[118:119]
    v_pk_fma_f32 v[118:119], v[26:27], v[26:27], v[118:119]
    v_pk_fma_f32 v[118:119], v[28:29], v[28:29], v[118:119]
    v_pk_fma_f32 v[118:119], v[30:31], v[30:31], v[118:119]
    v_mfma_f32_32x32x16_bf16 v[16:31], a[0:3], v[72:75], 0
    s_waitcnt lgkmcnt(3)
    ds_read_b128 a[20:23], v2 offset:60416
    ds_read_b128 a[0:3], v2 offset:6144
    v_rcp_f32 v48, v48
    v_rcp_f32 v49, v49
    v_mfma_f32_32x32x16_bf16 v[16:31], a[4:7], v[76:79], v[16:31]
    s_waitcnt lgkmcnt(4)
    v_rcp_f32 v50, v50
    v_rcp_f32 v51, v51
    v_rcp_f32 v52, v52
    v_mfma_f32_32x32x16_bf16 v[16:31], a[8:11], v[80:83], v[16:31]
    s_waitcnt lgkmcnt(3)
    ds_read_b128 a[4:7], v2 offset:7168
    ds_read_b128 a[8:11], v2 offset:8192
    v_rcp_f32 v53, v53
    v_rcp_f32 v54, v54
    v_mfma_f32_32x32x16_bf16 v[16:31], a[12:15], v[84:87], v[16:31]
    s_waitcnt lgkmcnt(4)
    v_rcp_f32 v55, v55
    v_rcp_f32 v56, v56
    v_rcp_f32 v57, v57
    v_mfma_f32_32x32x16_bf16 v[16:31], a[16:19], v[88:91], v[16:31]
    s_waitcnt lgkmcnt(3)
    ds_read_b128 a[12:15], v2 offset:9216
    ds_read_b128 a[16:19], v2 offset:10240
    v_rcp_f32 v58, v58
    v_rcp_f32 v59, v59
    v_mfma_f32_32x32x16_bf16 v[16:31], a[20:23], v[92:95], v[16:31]
    s_waitcnt lgkmcnt(4)
    v_rcp_f32 v60, v60
    v_rcp_f32 v61, v61
    v_rcp_f32 v62, v62
    v_rcp_f32 v63, v63
    v_pk_mul_f32 v[32:33], v[32:33], v[48:49]
    v_pk_mul_f32 v[34:35], v[34:35], v[50:51]
    v_pk_mul_f32 v[36:37], v[36:37], v[52:53]
    v_pk_mul_f32 v[38:39], v[38:39], v[54:55]
    v_pk_mul_f32 v[40:41], v[40:41], v[56:57]
    v_pk_mul_f32 v[42:43], v[42:43], v[58:59]
    v_pk_mul_f32 v[44:45], v[44:45], v[60:61]
    v_pk_mul_f32 v[46:47], v[46:47], v[62:63]
    v_pk_fma_f32 v[48:49], v[16:17], v[16:17], s[52:53]
    v_pk_fma_f32 v[50:51], v[18:19], v[18:19], s[52:53]
    v_pk_fma_f32 v[52:53], v[20:21], v[20:21], s[52:53]
    v_pk_fma_f32 v[54:55], v[22:23], v[22:23], s[52:53]
    v_pk_fma_f32 v[56:57], v[24:25], v[24:25], s[52:53]
    v_pk_fma_f32 v[58:59], v[26:27], v[26:27], s[52:53]
    v_pk_fma_f32 v[60:61], v[28:29], v[28:29], s[52:53]
    v_pk_fma_f32 v[62:63], v[30:31], v[30:31], s[52:53]
    v_pk_mul_f32 v[48:49], v[48:49], v[16:17] neg_lo:[1,0] neg_hi:[1,0]
    v_pk_mul_f32 v[50:51], v[50:51], v[18:19] neg_lo:[1,0] neg_hi:[1,0]
    v_pk_mul_f32 v[52:53], v[52:53], v[20:21] neg_lo:[1,0] neg_hi:[1,0]
    v_pk_mul_f32 v[54:55], v[54:55], v[22:23] neg_lo:[1,0] neg_hi:[1,0]
    v_pk_mul_f32 v[56:57], v[56:57], v[24:25] neg_lo:[1,0] neg_hi:[1,0]
    v_pk_mul_f32 v[58:59], v[58:59], v[26:27] neg_lo:[1,0] neg_hi:[1,0]
    v_pk_mul_f32 v[60:61], v[60:61], v[28:29] neg_lo:[1,0] neg_hi:[1,0]
    v_pk_mul_f32 v[62:63], v[62:63], v[30:31] neg_lo:[1,0] neg_hi:[1,0]
    v_cvt_pk_bf16_f32 v64, v32, v33
    v_cvt_pk_bf16_f32 v65, v34, v35
    v_cvt_pk_bf16_f32 v66, v36, v37
    v_cvt_pk_bf16_f32 v67, v38, v39
    v_cvt_pk_bf16_f32 v68, v40, v41
    v_cvt_pk_bf16_f32 v69, v42, v43
    v_cvt_pk_bf16_f32 v70, v44, v45
    v_cvt_pk_bf16_f32 v71, v46, v47
    v_mfma_f32_32x32x16_bf16 v[32:47], v[64:67], a[24:27], 0
    v_exp_f32 v48, v48
    v_exp_f32 v49, v49
    v_exp_f32 v50, v50
    v_mfma_f32_32x32x16_bf16 v[32:47], v[68:71], a[28:31], v[32:47]
    v_exp_f32 v51, v51
    v_exp_f32 v52, v52
    v_exp_f32 v53, v53
    v_exp_f32 v54, v54
    v_exp_f32 v55, v55
    v_exp_f32 v56, v56
    v_exp_f32 v57, v57
    v_exp_f32 v58, v58
    v_exp_f32 v59, v59
    v_exp_f32 v60, v60
    v_exp_f32 v61, v61
    v_exp_f32 v62, v62
    v_exp_f32 v63, v63
    v_pk_add_f32 v[48:49], v[48:49], 1.0 op_sel_hi:[1,0]
    v_pk_add_f32 v[50:51], v[50:51], 1.0 op_sel_hi:[1,0]
    v_pk_add_f32 v[52:53], v[52:53], 1.0 op_sel_hi:[1,0]
    v_pk_add_f32 v[54:55], v[54:55], 1.0 op_sel_hi:[1,0]
    v_pk_add_f32 v[56:57], v[56:57], 1.0 op_sel_hi:[1,0]
    v_pk_add_f32 v[58:59], v[58:59], 1.0 op_sel_hi:[1,0]
    v_pk_add_f32 v[60:61], v[60:61], 1.0 op_sel_hi:[1,0]
    v_pk_add_f32 v[62:63], v[62:63], 1.0 op_sel_hi:[1,0]
    v_pk_fma_f32 v[104:105], v[32:33], v[32:33], v[104:105]
    v_pk_fma_f32 v[104:105], v[34:35], v[34:35], v[104:105]
    v_pk_fma_f32 v[104:105], v[36:37], v[36:37], v[104:105]
    v_pk_fma_f32 v[104:105], v[38:39], v[38:39], v[104:105]
    v_pk_fma_f32 v[104:105], v[40:41], v[40:41], v[104:105]
    v_pk_fma_f32 v[104:105], v[42:43], v[42:43], v[104:105]
    v_pk_fma_f32 v[104:105], v[44:45], v[44:45], v[104:105]
    v_pk_fma_f32 v[104:105], v[46:47], v[46:47], v[104:105]
    v_mfma_f32_32x32x16_bf16 v[32:47], a[0:3], v[72:75], 0
    s_waitcnt lgkmcnt(3)
    ds_read_b128 a[20:23], v2 offset:11264
    v_rcp_f32 v48, v48
    v_rcp_f32 v49, v49
    v_rcp_f32 v50, v50
    v_mfma_f32_32x32x16_bf16 v[32:47], a[4:7], v[76:79], v[32:47]
    s_waitcnt lgkmcnt(3)
    s_mov_b32 s63, L_idle-L_pc+8192
    buffer_load_dword v6, v7, s[68:71], s63 offen
    s_mov_b32 s63, L_idle-L_pc+16384
    v_rcp_f32 v51, v51
    v_rcp_f32 v52, v52
    v_mfma_f32_32x32x16_bf16 v[32:47], a[8:11], v[80:83], v[32:47]
    s_waitcnt lgkmcnt(2)
    v_rcp_f32 v53, v53
    v_rcp_f32 v54, v54
    v_rcp_f32 v55, v55
    v_mfma_f32_32x32x16_bf16 v[32:47], a[12:15], v[84:87], v[32:47]
    s_waitcnt lgkmcnt(1)
    buffer_load_dword v6, v7, s[68:71], s63 offen
    v_rcp_f32 v56, v56
    v_rcp_f32 v57, v57
    v_mfma_f32_32x32x16_bf16 v[32:47], a[16:19], v[88:91], v[32:47]
    s_waitcnt lgkmcnt(0)
    v_rcp_f32 v58, v58
    v_rcp_f32 v59, v59
    v_rcp_f32 v60, v60
    v_mfma_f32_32x32x16_bf16 v[32:47], a[20:23], v[92:95], v[32:47]
    buffer_load_dword v6, v10, s[48:51], 0 offen sc1
    v_rcp_f32 v61, v61
    v_rcp_f32 v62, v62
    v_rcp_f32_e64 v63, v63
    v_pk_mul_f32 v[16:17], v[16:17], v[48:49]
    v_pk_mul_f32 v[18:19], v[18:19], v[50:51]
    v_pk_mul_f32 v[20:21], v[20:21], v[52:53]
    v_pk_mul_f32 v[22:23], v[22:23], v[54:55]
    v_pk_mul_f32 v[24:25], v[24:25], v[56:57]
    v_pk_mul_f32 v[26:27], v[26:27], v[58:59]
    v_pk_mul_f32 v[28:29], v[28:29], v[60:61]
    v_pk_mul_f32 v[30:31], v[30:31], v[62:63]
    v_pk_fma_f32 v[48:49], v[32:33], v[32:33], s[52:53]
    v_pk_fma_f32 v[50:51], v[34:35], v[34:35], s[52:53]
    v_pk_fma_f32 v[52:53], v[36:37], v[36:37], s[52:53]
    v_pk_fma_f32 v[54:55], v[38:39], v[38:39], s[52:53]
    v_pk_fma_f32 v[56:57], v[40:41], v[40:41], s[52:53]
    v_pk_fma_f32 v[58:59], v[42:43], v[42:43], s[52:53]
    v_pk_fma_f32 v[60:61], v[44:45], v[44:45], s[52:53]
    v_pk_fma_f32 v[62:63], v[46:47], v[46:47], s[52:53]
    v_pk_mul_f32 v[48:49], v[48:49], v[32:33] neg_lo:[1,0] neg_hi:[1,0]
    v_pk_mul_f32 v[50:51], v[50:51], v[34:35] neg_lo:[1,0] neg_hi:[1,0]
    v_pk_mul_f32 v[52:53], v[52:53], v[36:37] neg_lo:[1,0] neg_hi:[1,0]
    v_pk_mul_f32 v[54:55], v[54:55], v[38:39] neg_lo:[1,0] neg_hi:[1,0]
    v_pk_mul_f32 v[56:57], v[56:57], v[40:41] neg_lo:[1,0] neg_hi:[1,0]
    v_pk_mul_f32 v[58:59], v[58:59], v[42:43] neg_lo:[1,0] neg_hi:[1,0]
    v_pk_mul_f32 v[60:61], v[60:61], v[44:45] neg_lo:[1,0] neg_hi:[1,0]
    v_pk_mul_f32 v[62:63], v[62:63], v[46:47] neg_lo:[1,0] neg_hi:[1,0]
    v_cvt_pk_bf16_f32 v72, v16, v17
    v_cvt_pk_bf16_f32 v73, v18, v19
    v_cvt_pk_bf16_f32 v74, v20, v21
    v_cvt_pk_bf16_f32 v75, v22, v23
    v_cvt_pk_bf16_f32 v76, v24, v25
    v_cvt_pk_bf16_f32 v77, v26, v27
    v_cvt_pk_bf16_f32 v78, v28, v29
    v_cvt_pk_bf16_f32 v79, v30, v31
    v_mfma_f32_32x32x16_bf16 v[16:31], v[72:75], a[24:27], 0
    v_exp_f32 v48, v48
    v_exp_f32 v49, v49
    v_exp_f32 v50, v50
    v_mfma_f32_32x32x16_bf16 v[16:31], v[76:79], a[28:31], v[16:31]
    v_exp_f32 v51, v51
    v_exp_f32 v52, v52
    v_exp_f32 v53, v53
    v_exp_f32 v54, v54
    v_exp_f32 v55, v55
    v_exp_f32 v56, v56
    v_exp_f32 v57, v57
    v_exp_f32 v58, v58
    v_exp_f32 v59, v59
    v_exp_f32 v60, v60
    v_exp_f32 v61, v61
    v_exp_f32 v62, v62
    v_exp_f32 v63, v63
    v_pk_add_f32 v[48:49], v[48:49], 1.0 op_sel_hi:[1,0]
    v_pk_add_f32 v[50:51], v[50:51], 1.0 op_sel_hi:[1,0]
    v_pk_add_f32 v[52:53], v[52:53], 1.0 op_sel_hi:[1,0]
    v_pk_add_f32 v[54:55], v[54:55], 1.0 op_sel_hi:[1,0]
    v_pk_add_f32 v[56:57], v[56:57], 1.0 op_sel_hi:[1,0]
    v_pk_add_f32 v[58:59], v[58:59], 1.0 op_sel_hi:[1,0]
    v_pk_add_f32 v[60:61], v[60:61], 1.0 op_sel_hi:[1,0]
    v_pk_add_f32 v[62:63], v[62:63], 1.0 op_sel_hi:[1,0]
    v_pk_fma_f32 v[114:115], v[16:17], v[16:17], v[114:115]
    v_pk_fma_f32 v[114:115], v[18:19], v[18:19], v[114:115]
    v_pk_fma_f32 v[114:115], v[20:21], v[20:21], v[114:115]
    v_pk_fma_f32 v[114:115], v[22:23], v[22:23], v[114:115]
    v_pk_fma_f32 v[114:115], v[24:25], v[24:25], v[114:115]
    v_pk_fma_f32 v[114:115], v[26:27], v[26:27], v[114:115]
    v_pk_fma_f32 v[114:115], v[28:29], v[28:29], v[114:115]
    v_pk_fma_f32 v[114:115], v[30:31], v[30:31], v[114:115]
    v_rcp_f32 v48, v48
    v_rcp_f32 v49, v49
    v_rcp_f32 v50, v50
    v_rcp_f32 v51, v51
    v_rcp_f32 v52, v52
    v_rcp_f32 v53, v53
    v_rcp_f32 v54, v54
    v_rcp_f32 v55, v55
    v_rcp_f32 v56, v56
    v_rcp_f32 v57, v57
    v_rcp_f32 v58, v58
    v_rcp_f32 v59, v59
    v_rcp_f32 v60, v60
    v_rcp_f32 v61, v61
    v_rcp_f32 v62, v62
    v_rcp_f32 v63, v63
    v_pk_mul_f32 v[32:33], v[32:33], v[48:49]
    v_pk_mul_f32 v[34:35], v[34:35], v[50:51]
    v_pk_mul_f32 v[36:37], v[36:37], v[52:53]
    v_pk_mul_f32 v[38:39], v[38:39], v[54:55]
    v_pk_mul_f32 v[40:41], v[40:41], v[56:57]
    v_pk_mul_f32 v[42:43], v[42:43], v[58:59]
    v_pk_mul_f32 v[44:45], v[44:45], v[60:61]
    v_pk_mul_f32 v[46:47], v[46:47], v[62:63]
    v_cvt_pk_bf16_f32 v80, v32, v33
    v_cvt_pk_bf16_f32 v81, v34, v35
    v_cvt_pk_bf16_f32 v82, v36, v37
    v_cvt_pk_bf16_f32 v83, v38, v39
    v_cvt_pk_bf16_f32 v84, v40, v41
    v_cvt_pk_bf16_f32 v85, v42, v43
    v_cvt_pk_bf16_f32 v86, v44, v45
    v_cvt_pk_bf16_f32 v87, v46, v47
    v_mfma_f32_32x32x16_bf16 v[32:47], v[80:83], a[24:27], 0
    s_nop 0
    v_mfma_f32_32x32x16_bf16 v[32:47], v[84:87], a[28:31], v[32:47]
    s_nop 11
    v_pk_fma_f32 v[98:99], v[32:33], v[32:33], v[98:99]
    v_pk_fma_f32 v[98:99], v[34:35], v[34:35], v[98:99]
    v_pk_fma_f32 v[98:99], v[36:37], v[36:37], v[98:99]
    v_pk_fma_f32 v[98:99], v[38:39], v[38:39], v[98:99]
    v_pk_fma_f32 v[98:99], v[40:41], v[40:41], v[98:99]
    v_pk_fma_f32 v[98:99], v[42:43], v[42:43], v[98:99]
    v_pk_fma_f32 v[98:99], v[44:45], v[44:45], v[98:99]
    v_pk_fma_f32 v[98:99], v[46:47], v[46:47], v[98:99]
    v_add_f32 v96, v96, v97
    v_add_f32 v98, v98, v99
    v_add_f32 v100, v100, v101
    v_add_f32 v102, v102, v103
    v_add_f32 v104, v104, v105
    v_add_f32 v106, v106, v107
    v_add_f32 v108, v108, v109
    v_add_f32 v110, v110, v111
    v_add_f32 v112, v112, v113
    v_add_f32 v114, v114, v115
    v_add_f32 v116, v116, v117
    v_add_f32 v118, v118, v119
    v_permlane32_swap_b32 v96, v98
    v_permlane32_swap_b32 v100, v102
    v_permlane32_swap_b32 v104, v106
    v_permlane32_swap_b32 v108, v110
    v_permlane32_swap_b32 v112, v114
    v_permlane32_swap_b32 v116, v118
    v_add_f32 v96, v96, v98
    v_add_f32 v100, v100, v102
    v_add_f32 v104, v104, v106
    v_add_f32 v108, v108, v110
    v_add_f32 v112, v112, v114
    v_add_f32 v116, v116, v118
    s_mul_i32 s59, s57, 1536
    s_add_u32 s59, s59, 153600
    v_lshrrev_b32 v14, 2, v2
    v_add_u32 v14, s59, v14
    ds_write_b32 v14, v96 offset:0
    ds_write_b32 v14, v100 offset:256
    ds_write_b32 v14, v104 offset:512
    ds_write_b32 v14, v108 offset:768
    ds_write_b32 v14, v112 offset:1024
    ds_write_b32 v14, v116 offset:1280
    s_waitcnt vmcnt(0) lgkmcnt(0)
    s_barrier
    s_cmp_ge_u32 s57, 2
    s_cbranch_scc1 L_role23
    v_lshlrev_b32 v14, 4, v0
    v_add_u32 v14, 153600, v14
    v_cmp_gt_u32 vcc, 96, v0
    s_nop 4
    s_and_saveexec_b64 s[64:65], vcc
    ds_read_b128 v[16:19], v14 offset:0
    ds_read_b128 v[20:23], v14 offset:1536
    ds_read_b128 v[24:27], v14 offset:3072
    ds_read_b128 v[28:31], v14 offset:4608
    s_lshl_b32 s59, s2, 6
    v_lshrrev_b32 v14, 2, v0
    v_lshlrev_b32 v14, 14, v14
    v_and_b32 v15, 3, v0
    v_lshl_or_b32 v14, v15, 4, v14
    s_waitcnt lgkmcnt(2)
    v_add_f32 v16, v16, v20
    s_waitcnt lgkmcnt(0)
    v_add_f32 v24, v24, v28
    v_add_f32 v17, v17, v21
    v_add_f32 v25, v25, v29
    v_add_f32 v18, v18, v22
    v_add_f32 v26, v26, v30
    v_add_f32 v19, v19, v23
    v_add_f32 v27, v27, v31
    v_add_f32 v16, v16, v24
    v_add_f32 v17, v17, v25
    v_add_f32 v18, v18, v26
    v_add_f32_e64 v19, v19, v27
    v_and_b32 v16, 0x7fffffff, v16
    v_and_b32 v17, 0x7fffffff, v17
    v_and_b32 v18, 0x7fffffff, v18
    v_and_b32 v19, 0x7fffffff, v19
    buffer_store_dwordx4 v[16:19], v14, s[44:47], s59 offen sc1
    s_mov_b64 exec, s[64:65]
    s_branch L_idle
L_role23:
    s_cmp_eq_u32 s57, 3
    s_cbranch_scc0 L_idle
    s_cmp_ge_u32 s2, 48
    s_cbranch_scc1 L_idle
L_init3:
    v_cmp_gt_u32 vcc, 64, v6
    s_nop 4
    s_cmp_eq_u64 vcc, 0
    s_cbranch_scc1 L_init3_done
    s_sleep 2
    v_lshrrev_b32 v14, 4, v2
    v_and_b32 v14, 3, v14
    v_mul_u32_u24 v14, 64, v14
    buffer_load_dword v6, v14, s[48:51], 0 offen sc1
    s_waitcnt vmcnt(0)
    s_sub_u32 s66, s66, 1
    s_cbranch_scc0 L_init3
L_init3_done:
    s_lshl_b32 s60, s2, 14
    s_cmp_ge_u32 s2, 24
    s_cselect_b32 s61, 385024, 0
    s_sub_u32 s60, s60, s61
    s_add_u32 s61, s60, 4096
L_poll1:
    buffer_load_dwordx4 v[16:19], v2, s[44:47], s60 offen offset:0 sc1
    buffer_load_dwordx4 v[20:23], v2, s[44:47], s60 offen offset:1024 sc1
    buffer_load_dwordx4 v[24:27], v2, s[44:47], s60 offen offset:2048 sc1
    buffer_load_dwordx4 v[28:31], v2, s[44:47], s60 offen offset:3072 sc1
    buffer_load_dwordx4 v[32:35], v2, s[44:47], s61 offen offset:0 sc1
    buffer_load_dwordx4 v[36:39], v2, s[44:47], s61 offen offset:1024 sc1
    buffer_load_dwordx4 v[40:43], v2, s[44:47], s61 offen offset:2048 sc1
    buffer_load_dwordx4 v[44:47], v2, s[44:47], s61 offen offset:3072 sc1
    s_waitcnt vmcnt(7)
    v_or3_b32 v14, v16, v17, v18
    s_waitcnt vmcnt(6)
    v_or3_b32 v14, v14, v19, v20
    v_or3_b32 v14, v14, v21, v22
    s_waitcnt vmcnt(5)
    v_or3_b32 v14, v14, v23, v24
    v_or3_b32 v14, v14, v25, v26
    s_waitcnt vmcnt(4)
    v_or3_b32 v14, v14, v27, v28
    v_or3_b32 v14, v14, v29, v30
    s_waitcnt vmcnt(3)
    v_or3_b32 v14, v14, v31, v32
    v_or3_b32 v14, v14, v33, v34
    s_waitcnt vmcnt(2)
    v_or3_b32 v14, v14, v35, v36
    v_or3_b32 v14, v14, v37, v38
    s_waitcnt vmcnt(1)
    v_or3_b32 v14, v14, v39, v40
    v_or3_b32 v14, v14, v41, v42
    s_waitcnt vmcnt(0)
    v_or3_b32 v14, v14, v43, v44
    v_or3_b32 v14, v14, v45, v46
    v_or_b32 v14, v14, v47
    v_cmp_gt_i32 vcc, 0, v14
    s_nop 4
    s_and_b64 exec, vcc, vcc
    s_cbranch_scc0 L_poll1_done
    s_sleep 1
    s_sub_u32 s66, s66, 1
    s_cbranch_scc0 L_poll1
L_poll1_done:
    s_mov_b64 exec, -1
    v_add_f32 v16, v16, v32
    v_add_f32 v17, v17, v33
    v_add_f32 v18, v18, v34
    v_add_f32 v19, v19, v35
    v_add_f32 v20, v20, v36
    v_add_f32 v21, v21, v37
    v_add_f32 v22, v22, v38
    v_add_f32 v23, v23, v39
    v_add_f32 v24, v24, v40
    v_add_f32 v25, v25, v41
    v_add_f32 v26, v26, v42
    v_add_f32 v27, v27, v43
    v_add_f32 v28, v28, v44
    v_add_f32 v29, v29, v45
    v_add_f32 v30, v30, v46
    v_add_f32 v31, v31, v47
    v_add_f32 v16, v16, v24
    v_add_f32 v17, v17, v25
    v_add_f32 v18, v18, v26
    v_add_f32 v19, v19, v27
    v_add_f32 v20, v20, v28
    v_add_f32 v21, v21, v29
    v_add_f32 v22, v22, v30
    v_add_f32 v23, v23, v31
    v_add_f32 v16, v16, v20
    v_add_f32 v17, v17, v21
    v_add_f32 v18, v18, v22
    v_add_f32_e64 v19, v19, v23
    v_add_f32_dpp v16, v16, v16 row_ror:4 row_mask:0xf bank_mask:0xf
    v_add_f32_dpp v17, v17, v17 row_ror:4 row_mask:0xf bank_mask:0xf
    v_add_f32_dpp v18, v18, v18 row_ror:4 row_mask:0xf bank_mask:0xf
    v_add_f32_dpp v19, v19, v19 row_ror:4 row_mask:0xf bank_mask:0xf
    v_add_f32_dpp v16, v16, v16 row_ror:8 row_mask:0xf bank_mask:0xf
    v_add_f32_dpp v17, v17, v17 row_ror:8 row_mask:0xf bank_mask:0xf
    v_add_f32_dpp v18, v18, v18 row_ror:8 row_mask:0xf bank_mask:0xf
    v_add_f32_dpp v19, v19, v19 row_ror:8 row_mask:0xf bank_mask:0xf
    v_mov_b32 v20, v16
    v_mov_b32 v21, v17
    v_mov_b32 v22, v18
    v_mov_b32 v23, v19
    v_permlane16_swap_b32 v16, v20
    v_permlane16_swap_b32 v17, v21
    v_permlane16_swap_b32 v18, v22
    v_permlane16_swap_b32 v19, v23
    v_add_f32 v16, v16, v20
    v_add_f32 v17, v17, v21
    v_add_f32 v18, v18, v22
    v_add_f32 v19, v19, v23
    v_mov_b32 v20, v16
    v_mov_b32 v21, v17
    v_mov_b32 v22, v18
    v_mov_b32 v23, v19
    v_permlane32_swap_b32 v16, v20
    v_permlane32_swap_b32 v17, v21
    v_permlane32_swap_b32 v18, v22
    v_permlane32_swap_b32 v19, v23
    v_add_f32 v16, v16, v20
    v_add_f32 v17, v17, v21
    v_add_f32 v18, v18, v22
    v_add_f32 v19, v19, v23
    v_and_b32 v16, 0x7fffffff, v16
    v_and_b32 v17, 0x7fffffff, v17
    v_and_b32 v18, 0x7fffffff, v18
    v_and_b32 v19, 0x7fffffff, v19
    s_lshl_b32 s59, s2, 6
    s_add_u32 s59, s59, 1048576
    v_lshrrev_b32 v14, 6, v2
    v_lshlrev_b32 v14, 12, v14
    v_and_b32 v15, 48, v2
    v_or_b32 v14, v14, v15
    v_cmp_gt_u32 vcc, 512, v2
    s_nop 4
    s_and_saveexec_b64 s[64:65], vcc
    buffer_store_dwordx4 v[16:19], v14, s[44:47], s59 offen sc1
    s_mov_b64 exec, s[64:65]
L_idle:
    v_bfe_u32 v56, v0, 2, 2
    v_bfe_u32 v57, v0, 5, 1
    v_lshl_add_u32 v56, v57, 2, v56
    v_mul_u32_u24 v56, 192, v56
    v_bfe_u32 v14, v0, 4, 1
    v_lshl_add_u32 v56, v14, 5, v56
    v_and_b32 v14, 1, v0
    v_lshl_add_u32 v56, v14, 4, v56
    v_bfe_u32 v14, v0, 1, 1
    v_lshl_add_u32 v56, v14, 3, v56
    s_mul_i32 s59, s57, 18432
    s_add_u32 s60, s59, 73728
    v_add_u32 v8, s60, v56
    v_add_u32 v12, s60, v2
    s_mul_i32 s59, s57, 192
    s_add_u32 s59, s59, 161664
    v_lshl_add_u32 v9, v57, 3, s59
    ds_read_b64_tr_b16 v[32:33], v8 offset:0
    ds_read_b64_tr_b16 v[34:35], v8 offset:1536
    ds_read_b64_tr_b16 v[36:37], v8 offset:64
    ds_read_b64_tr_b16 v[38:39], v8 offset:1600
    ds_read_b64_tr_b16 v[40:41], v8 offset:128
    ds_read_b64_tr_b16 v[42:43], v8 offset:1664
    ds_read_b64_tr_b16 v[44:45], v8 offset:3072
    ds_read_b64_tr_b16 v[46:47], v8 offset:4608
    ds_read_b64_tr_b16 v[48:49], v8 offset:3136
    ds_read_b64_tr_b16 v[50:51], v8 offset:4672
    ds_read_b64_tr_b16 v[52:53], v8 offset:3200
    ds_read_b64_tr_b16 v[54:55], v8 offset:4736
    ds_read_b64_tr_b16 v[96:97], v8 offset:6144
    ds_read_b64_tr_b16 v[98:99], v8 offset:7680
    ds_read_b64_tr_b16 v[100:101], v8 offset:6208
    ds_read_b64_tr_b16 v[102:103], v8 offset:7744
    ds_read_b64_tr_b16 v[104:105], v8 offset:6272
    ds_read_b64_tr_b16 v[106:107], v8 offset:7808
    ds_read_b64_tr_b16 v[108:109], v8 offset:9216
    ds_read_b64_tr_b16 v[110:111], v8 offset:10752
    ds_read_b64_tr_b16 v[112:113], v8 offset:9280
    ds_read_b64_tr_b16 v[114:115], v8 offset:10816
    ds_read_b64_tr_b16 v[116:117], v8 offset:9344
    ds_read_b64_tr_b16 v[118:119], v8 offset:10880
    ds_read_b64_tr_b16 a[0:1], v8 offset:12288
    ds_read_b64_tr_b16 a[2:3], v8 offset:13824
    ds_read_b64_tr_b16 a[4:5], v8 offset:12352
    ds_read_b64_tr_b16 a[6:7], v8 offset:13888
    ds_read_b64_tr_b16 a[8:9], v8 offset:12416
    ds_read_b64_tr_b16 a[10:11], v8 offset:13952
    ds_read_b64_tr_b16 a[12:13], v8 offset:15360
    ds_read_b64_tr_b16 a[14:15], v8 offset:16896
    ds_read_b64_tr_b16 a[16:17], v8 offset:15424
    ds_read_b64_tr_b16 a[18:19], v8 offset:16960
    ds_read_b64_tr_b16 a[20:21], v8 offset:15488
    ds_read_b64_tr_b16 a[22:23], v8 offset:17024
    ds_read2_b64 v[56:59], v9 offset0:0 offset1:2
    ds_read2_b64 v[60:63], v9 offset0:4 offset1:6
    s_waitcnt lgkmcnt(2)
    v_and_b32 v10, 0x13, v0
    v_bfe_u32 v14, v0, 2, 1
    v_lshl_or_b32 v10, v14, 3, v10
    v_bfe_u32 v14, v0, 3, 1
    v_lshl_or_b32 v10, v14, 2, v10
    s_mul_i32 s59, s57, 384
    s_add_u32 s59, s59, 162048
    s_cmp_eq_u32 s57, 0
    s_cselect_b32 s59, 161280, s59
    v_lshl_add_u32 v10, v10, 2, s59
    s_waitcnt lgkmcnt(1)
    v_mfma_f32_32x32x16_bf16 v[16:31], v[56:59], v[32:35], 0
    ds_read2_b64 v[56:59], v9 offset0:8 offset1:10
    ds_write_b128 v12, a[0:3] offset:12288
    s_waitcnt lgkmcnt(2)
    v_mfma_f32_32x32x16_bf16 v[16:31], v[60:63], v[44:47], v[16:31]
    ds_read2_b64 v[60:63], v9 offset0:12 offset1:14
    ds_write_b128 v12, a[4:7] offset:13312
    s_waitcnt lgkmcnt(3)
    v_mfma_f32_32x32x16_bf16 v[16:31], v[56:59], v[96:99], v[16:31]
    ds_read2_b64 v[56:59], v9 offset0:16 offset1:18
    ds_write_b128 v12, a[8:11] offset:14336
    s_waitcnt lgkmcnt(3)
    v_mfma_f32_32x32x16_bf16 v[16:31], v[60:63], v[108:111], v[16:31]
    ds_read2_b64 v[60:63], v9 offset0:20 offset1:22
    ds_write_b128 v12, a[12:15] offset:15360
    s_waitcnt lgkmcnt(3)
    v_mfma_f32_32x32x16_bf16 v[16:31], v[56:59], a[0:3], v[16:31]
    ds_read2_b64 v[56:59], v9 offset0:0 offset1:2
    ds_write_b128 v12, a[16:19] offset:16384
    s_waitcnt lgkmcnt(3)
    v_mfma_f32_32x32x16_bf16 v[16:31], v[60:63], a[12:15], v[16:31]
    ds_read2_b64 v[60:63], v9 offset0:4 offset1:6
    ds_write_b128 v12, a[20:23] offset:17408
    s_nop 9
    ds_write_b32 v10, v16 offset:0
    s_waitcnt lgkmcnt(4)
    v_mfma_f32_32x32x16_bf16 v[16:31], v[56:59], v[36:39], 0
    ds_read2_b64 v[56:59], v9 offset0:8 offset1:10
    ds_write_b128 v12, v[96:99] offset:6144
    s_waitcnt lgkmcnt(4)
    v_mfma_f32_32x32x16_bf16 v[16:31], v[60:63], v[48:51], v[16:31]
    ds_read2_b64 v[60:63], v9 offset0:12 offset1:14
    ds_write_b128 v12, v[100:103] offset:7168
    s_waitcnt lgkmcnt(3)
    v_mfma_f32_32x32x16_bf16 v[16:31], v[56:59], v[100:103], v[16:31]
    ds_read2_b64 v[56:59], v9 offset0:16 offset1:18
    ds_write_b128 v12, v[104:107] offset:8192
    s_waitcnt lgkmcnt(3)
    v_mfma_f32_32x32x16_bf16 v[16:31], v[60:63], v[112:115], v[16:31]
    ds_read2_b64 v[60:63], v9 offset0:20 offset1:22
    ds_write_b128 v12, v[108:111] offset:9216
    s_waitcnt lgkmcnt(3)
    v_mfma_f32_32x32x16_bf16 v[16:31], v[56:59], a[4:7], v[16:31]
    ds_read2_b64 v[56:59], v9 offset0:0 offset1:2
    ds_write_b128 v12, v[112:115] offset:10240
    s_waitcnt lgkmcnt(3)
    v_mfma_f32_32x32x16_bf16 v[16:31], v[60:63], a[16:19], v[16:31]
    ds_read2_b64 v[60:63], v9 offset0:4 offset1:6
    ds_write_b128 v12, v[116:119] offset:11264
    s_nop 9
    ds_write_b32 v10, v16 offset:128
    s_waitcnt lgkmcnt(4)
    v_mfma_f32_32x32x16_bf16 v[16:31], v[56:59], v[40:43], 0
    ds_read2_b64 v[56:59], v9 offset0:8 offset1:10
    ds_write_b128 v12, v[32:35] offset:0
    s_waitcnt lgkmcnt(4)
    v_mfma_f32_32x32x16_bf16 v[16:31], v[60:63], v[52:55], v[16:31]
    ds_read2_b64 v[60:63], v9 offset0:12 offset1:14
    ds_write_b128 v12, v[36:39] offset:1024
    s_waitcnt lgkmcnt(3)
    v_mfma_f32_32x32x16_bf16 v[16:31], v[56:59], v[104:107], v[16:31]
    ds_read2_b64 v[56:59], v9 offset0:16 offset1:18
    ds_write_b128 v12, v[40:43] offset:2048
    s_waitcnt lgkmcnt(3)
    v_mfma_f32_32x32x16_bf16 v[16:31], v[60:63], v[116:119], v[16:31]
    ds_read2_b64 v[60:63], v9 offset0:20 offset1:22
    ds_write_b128 v12, v[44:47] offset:3072
    s_waitcnt lgkmcnt(3)
    v_mfma_f32_32x32x16_bf16 v[16:31], v[56:59], a[8:11], v[16:31]
    ds_write_b128 v12, v[48:51] offset:4096
    s_waitcnt lgkmcnt(2)
    v_mfma_f32_32x32x16_bf16 v[16:31], v[60:63], a[20:23], v[16:31]
    ds_write_b128 v12, v[52:55] offset:5120
    s_nop 10
    ds_write_b32 v10, v16 offset:256
    v_and_b32 v9, 15, v0
    v_mul_u32_u24 v9, 192, v9
    v_bfe_u32 v14, v0, 4, 1
    v_lshl_add_u32 v9, v14, 5, v9
    v_bfe_u32 v14, v0, 5, 1
    v_lshl_add_u32 v9, v14, 4, v9
    s_cmp_lg_u32 s57, 2
    s_cbranch_scc1 L_sdone
    s_mov_b32 s40, s12
    s_mov_b32 s41, s13
    s_mov_b32 s42, 768
    s_mov_b32 s43, 0x20000
    v_mul_u32_u24 v10, 3, v2
    v_lshrrev_b32 v11, 1, v10
    v_lshrrev_b32 v10, 2, v10
    buffer_load_dwordx3 v[28:30], v10, s[40:43], 0 offen
L_init2:
    v_cmp_gt_u32 vcc, 64, v6
    s_nop 4
    s_cmp_eq_u64 vcc, 0
    s_cbranch_scc1 L_init2_done
    s_sleep 2
    v_lshrrev_b32 v14, 4, v2
    v_and_b32 v14, 3, v14
    v_mul_u32_u24 v14, 64, v14
    buffer_load_dword v6, v14, s[48:51], 0 offen sc1
    s_waitcnt vmcnt(0)
    s_sub_u32 s66, s66, 1
    s_cbranch_scc0 L_init2
L_init2_done:
    s_and_b32 s60, s2, 7
    s_lshl_b32 s60, s60, 12
    s_add_u32 s60, s60, 1048576
    s_add_u32 s61, s60, 3072
L_poll2:
    buffer_load_dwordx4 v[16:19], v11, s[44:47], s60 offen offset:0 sc1
    buffer_load_dwordx2 v[20:21], v11, s[44:47], s60 offen offset:16 sc1
    buffer_load_dwordx4 v[22:25], v11, s[44:47], s60 offen offset:1536 sc1
    buffer_load_dwordx2 v[26:27], v11, s[44:47], s60 offen offset:1552 sc1
    s_waitcnt vmcnt(3)
    v_or3_b32 v14, v16, v17, v18
    s_waitcnt vmcnt(2)
    v_or3_b32 v14, v14, v19, v20
    s_waitcnt vmcnt(1)
    v_or3_b32 v14, v14, v21, v22
    v_or3_b32 v14, v14, v23, v24
    s_waitcnt vmcnt(0)
    v_or3_b32 v14, v14, v25, v26
    v_or_b32 v14, v14, v27
    v_cmp_gt_i32 vcc, 0, v14
    s_nop 4
    s_and_b64 exec, vcc, vcc
    s_cbranch_scc0 L_poll2_done
    s_sleep 1
    s_sub_u32 s66, s66, 1
    s_cbranch_scc0 L_poll2
L_poll2_done:
    s_mov_b64 exec, -1
    v_add_f32 v16, v16, v22
    v_add_f32 v17, v17, v23
    v_add_f32 v18, v18, v24
    v_add_f32 v19, v19, v25
    v_add_f32 v20, v20, v26
    v_add_f32_e64 v21, v21, v27
    v_mul_f32 v16, 0x4091afa4, v16
    v_mul_f32 v17, 0x4091afa4, v17
    v_mul_f32 v18, 0x4091afa4, v18
    v_mul_f32 v19, 0x4091afa4, v19
    v_mul_f32 v20, 0x4091afa4, v20
    v_mul_f32 v21, 0x4091afa4, v21
    v_add_f32 v16, 0x358637bd, v16
    v_add_f32 v17, 0x358637bd, v17
    v_add_f32 v18, 0x358637bd, v18
    v_add_f32 v19, 0x358637bd, v19
    v_add_f32 v20, 0x358637bd, v20
    v_add_f32 v21, 0x358637bd, v21
    v_sqrt_f32 v16, v16
    v_sqrt_f32 v17, v17
    v_sqrt_f32 v18, v18
    v_sqrt_f32 v19, v19
    v_sqrt_f32 v20, v20
    v_sqrt_f32 v21, v21
    v_add_f32 v22, v16, v17
    v_add_f32 v23, v18, v19
    v_add_f32 v14, v20, v21
    v_add_f32 v22, v22, v23
    v_add_f32 v22, v22, v14
    s_nop 1
    v_add_f32_dpp v22, v22, v22 row_ror:8 row_mask:0xf bank_mask:0xf
    s_nop 1
    v_add_f32_dpp v22, v22, v22 row_ror:4 row_mask:0xf bank_mask:0xf
    s_nop 1
    v_add_f32_dpp v22, v22, v22 row_ror:2 row_mask:0xf bank_mask:0xf
    s_nop 1
    v_add_f32_dpp v22, v22, v22 row_ror:1 row_mask:0xf bank_mask:0xf
    v_mov_b32 v23, v22
    s_nop 1
    v_permlane16_swap_b32 v22, v23
    v_add_f32 v22, v22, v23
    v_mov_b32 v23, v22
    s_nop 1
    v_permlane32_swap_b32 v22, v23
    v_add_f32 v22, v22, v23
    v_mul_f32 v22, 0x3b2aaaab, v22
    v_add_f32 v22, 0x358637bd, v22
    v_rcp_f32 v22, v22
    v_mov_b32 v23, 0x40088e99
    v_mul_f32 v22, 0x40088e99, v22
    v_lshlrev_b32 v14, 16, v28
    v_mul_f32 v16, v16, v22
    v_fma_f32 v16, v16, v14, v23
    v_and_b32 v14, 0xffff0000, v28
    v_mul_f32 v17, v17, v22
    v_fma_f32 v17, v17, v14, v23
    v_lshlrev_b32 v14, 16, v29
    v_mul_f32 v18, v18, v22
    v_fma_f32 v18, v18, v14, v23
    v_and_b32 v14, 0xffff0000, v29
    v_mul_f32 v19, v19, v22
    v_fma_f32 v19, v19, v14, v23
    v_lshlrev_b32 v14, 16, v30
    v_mul_f32 v20, v20, v22
    v_fma_f32 v20, v20, v14, v23
    v_and_b32 v14, 0xffff0000, v30
    v_mul_f32 v21, v21, v22
    v_fma_f32 v21, v21, v14, v23
    v_add_u32 v11, 159744, v11
    ds_write_b64 v11, v[16:17] offset:0
    ds_write_b64 v11, v[18:19] offset:8
    ds_write_b64 v11, v[20:21] offset:16
L_sdone:
    v_bfe_u32 v10, v0, 5, 1
    v_lshlrev_b32 v10, 4, v10
    s_mul_i32 s59, s57, 384
    s_add_u32 s59, s59, 159744
    v_add_u32 v10, s59, v10
    v_lshrrev_b32 v11, 1, v2
    v_add_u32 v11, 161280, v11
    s_waitcnt lgkmcnt(0)
    s_barrier
    ds_read_b128 v[56:59], v10 offset:0
    ds_read_b128 v[60:63], v10 offset:32
    ds_read_b128 v[24:27], v10 offset:64
    ds_read_b128 v[28:31], v10 offset:96
    s_cmp_lg_u32 s57, 3
    s_cbranch_scc1 L_nofold
    v_cmp_gt_u32 vcc, 768, v2
    s_nop 4
    s_and_saveexec_b64 s[64:65], vcc
    ds_read_b64 v[16:17], v11
    ds_read_b64 v[18:19], v11 offset:1152
    ds_read_b64 v[20:21], v11 offset:1536
    ds_read_b64 v[22:23], v11 offset:1920
    s_waitcnt lgkmcnt(2)
    v_pk_add_f32 v[16:17], v[16:17], v[18:19]
    s_waitcnt lgkmcnt(0)
    v_pk_add_f32 v[20:21], v[20:21], v[22:23]
    v_pk_add_f32 v[16:17], v[16:17], v[20:21]
    ds_write_b64 v11, v[16:17]
    s_mov_b64 exec, s[64:65]
L_nofold:
    v_lshlrev_b32 v16, 16, v32
    v_and_b32 v17, 0xffff0000, v32
    v_lshlrev_b32 v18, 16, v33
    v_and_b32 v19, 0xffff0000, v33
    v_lshlrev_b32 v20, 16, v34
    v_and_b32 v21, 0xffff0000, v34
    v_lshlrev_b32_e64 v22, 16, v35
    v_and_b32 v23, 0xffff0000, v35
    s_waitcnt lgkmcnt(3)
    v_pk_mul_f32 v[16:17], v[16:17], v[56:57]
    v_pk_mul_f32 v[18:19], v[18:19], v[58:59]
    s_waitcnt lgkmcnt(2)
    v_pk_mul_f32 v[20:21], v[20:21], v[60:61]
    v_pk_mul_f32 v[22:23], v[22:23], v[62:63]
    v_cvt_pk_bf16_f32 v32, v16, v17
    v_cvt_pk_bf16_f32 v33, v18, v19
    v_cvt_pk_bf16_f32 v34, v20, v21
    v_cvt_pk_bf16_f32 v35, v22, v23
    ds_write_b128 v12, v[32:35] offset:0
    v_lshlrev_b32 v16, 16, v36
    v_and_b32 v17, 0xffff0000, v36
    v_lshlrev_b32 v18, 16, v37
    v_and_b32 v19, 0xffff0000, v37
    v_lshlrev_b32 v20, 16, v38
    v_and_b32 v21, 0xffff0000, v38
    v_lshlrev_b32 v22, 16, v39
    v_and_b32 v23, 0xffff0000, v39
    v_pk_mul_f32 v[16:17], v[16:17], v[56:57]
    v_pk_mul_f32 v[18:19], v[18:19], v[58:59]
    v_pk_mul_f32 v[20:21], v[20:21], v[60:61]
    v_pk_mul_f32 v[22:23], v[22:23], v[62:63]
    v_cvt_pk_bf16_f32 v36, v16, v17
    v_cvt_pk_bf16_f32 v37, v18, v19
    v_cvt_pk_bf16_f32 v38, v20, v21
    v_cvt_pk_bf16_f32 v39, v22, v23
    ds_write_b128 v12, v[36:39] offset:1024
    v_lshlrev_b32 v16, 16, v40
    v_and_b32 v17, 0xffff0000, v40
    v_lshlrev_b32 v18, 16, v41
    v_and_b32 v19, 0xffff0000, v41
    v_lshlrev_b32 v20, 16, v42
    v_and_b32 v21, 0xffff0000, v42
    v_lshlrev_b32 v22, 16, v43
    v_and_b32 v23, 0xffff0000, v43
    v_pk_mul_f32 v[16:17], v[16:17], v[56:57]
    v_pk_mul_f32 v[18:19], v[18:19], v[58:59]
    v_pk_mul_f32 v[20:21], v[20:21], v[60:61]
    v_pk_mul_f32 v[22:23], v[22:23], v[62:63]
    v_cvt_pk_bf16_f32 v40, v16, v17
    v_cvt_pk_bf16_f32 v41, v18, v19
    v_cvt_pk_bf16_f32 v42, v20, v21
    v_cvt_pk_bf16_f32 v43, v22, v23
    ds_write_b128 v12, v[40:43] offset:2048
    v_lshlrev_b32 v16, 16, v44
    v_and_b32 v17, 0xffff0000, v44
    v_lshlrev_b32 v18, 16, v45
    v_and_b32 v19, 0xffff0000, v45
    v_lshlrev_b32 v20, 16, v46
    v_and_b32 v21, 0xffff0000, v46
    v_lshlrev_b32 v22, 16, v47
    v_and_b32 v23, 0xffff0000, v47
    s_waitcnt lgkmcnt(4)
    v_pk_mul_f32 v[16:17], v[16:17], v[24:25]
    v_pk_mul_f32 v[18:19], v[18:19], v[26:27]
    s_waitcnt lgkmcnt(3)
    v_pk_mul_f32 v[20:21], v[20:21], v[28:29]
    v_pk_mul_f32 v[22:23], v[22:23], v[30:31]
    v_cvt_pk_bf16_f32 v44, v16, v17
    v_cvt_pk_bf16_f32 v45, v18, v19
    v_cvt_pk_bf16_f32 v46, v20, v21
    v_cvt_pk_bf16_f32 v47, v22, v23
    ds_write_b128 v12, v[44:47] offset:3072
    v_lshlrev_b32 v16, 16, v48
    v_and_b32 v17, 0xffff0000, v48
    v_lshlrev_b32 v18, 16, v49
    v_and_b32 v19, 0xffff0000, v49
    v_lshlrev_b32 v20, 16, v50
    v_and_b32 v21, 0xffff0000, v50
    v_lshlrev_b32 v22, 16, v51
    v_and_b32 v23, 0xffff0000, v51
    v_pk_mul_f32 v[16:17], v[16:17], v[24:25]
    v_pk_mul_f32 v[18:19], v[18:19], v[26:27]
    v_pk_mul_f32 v[20:21], v[20:21], v[28:29]
    v_pk_mul_f32 v[22:23], v[22:23], v[30:31]
    v_cvt_pk_bf16_f32 v48, v16, v17
    v_cvt_pk_bf16_f32 v49, v18, v19
    v_cvt_pk_bf16_f32 v50, v20, v21
    v_cvt_pk_bf16_f32 v51, v22, v23
    ds_write_b128 v12, v[48:51] offset:4096
    v_lshlrev_b32 v16, 16, v52
    v_and_b32 v17, 0xffff0000, v52
    v_lshlrev_b32 v18, 16, v53
    v_and_b32 v19, 0xffff0000, v53
    v_lshlrev_b32 v20, 16, v54
    v_and_b32 v21, 0xffff0000, v54
    v_lshlrev_b32 v22, 16, v55
    v_and_b32 v23, 0xffff0000, v55
    v_pk_mul_f32 v[16:17], v[16:17], v[24:25]
    v_pk_mul_f32 v[18:19], v[18:19], v[26:27]
    v_pk_mul_f32 v[20:21], v[20:21], v[28:29]
    v_pk_mul_f32 v[22:23], v[22:23], v[30:31]
    v_cvt_pk_bf16_f32 v52, v16, v17
    v_cvt_pk_bf16_f32 v53, v18, v19
    v_cvt_pk_bf16_f32 v54, v20, v21
    v_cvt_pk_bf16_f32 v55, v22, v23
    ds_write_b128 v12, v[52:55] offset:5120
    s_waitcnt vmcnt(0)
    ds_read_b128 v[112:115], v10 offset:128
    ds_read_b128 v[116:119], v10 offset:160
    ds_read_b128 v[96:99], v12 offset:6144
    ds_read_b128 v[100:103], v12 offset:7168
    s_waitcnt lgkmcnt(4)
    s_barrier
    ds_read_b128 a[0:3], v3 offset:8192
    ds_read_b128 a[4:7], v3 offset:9216
    ds_read_b128 a[8:11], v3 offset:10240
    ds_read_b128 a[12:15], v3 offset:11264
    ds_read_b128 a[16:19], v3 offset:12288
    s_waitcnt lgkmcnt(4)
    v_mfma_f32_32x32x16_bf16 v[16:31], a[0:3], a[224:227], 0
    s_waitcnt lgkmcnt(3)
    ds_read_b128 a[20:23], v3 offset:13312
    ds_read_b128 a[0:3], v3 offset:26624
    v_lshlrev_b32 v104, 16, v96
    v_and_b32 v105, 0xffff0000, v96
    v_lshlrev_b32 v106, 16, v97
    v_and_b32 v107, 0xffff0000, v97
    v_mfma_f32_32x32x16_bf16 v[32:47], a[4:7], a[224:227], 0
    s_waitcnt lgkmcnt(4)
    v_lshlrev_b32 v108, 16, v98
    v_and_b32 v109, 0xffff0000, v98
    v_lshlrev_b32 v110, 16, v99
    v_and_b32 v111, 0xffff0000, v99
    v_mul_f32 v104, v104, v112
    v_mul_f32 v105, v105, v113
    v_mul_f32 v106, v106, v114
    v_mul_f32 v107, v107, v115
    v_mul_f32 v108, v108, v116
    v_mul_f32 v109, v109, v117
    v_mul_f32 v110, v110, v118
    v_mul_f32 v111, v111, v119
    v_cvt_pk_bf16_f32 v104, v104, v105
    v_cvt_pk_bf16_f32 v105, v106, v107
    v_cvt_pk_bf16_f32 v106, v108, v109
    v_cvt_pk_bf16_f32 v107, v110, v111
    v_mfma_f32_32x32x16_bf16 v[48:63], a[8:11], a[224:227], 0
    s_waitcnt lgkmcnt(3)
    ds_read_b128 a[4:7], v3 offset:27648
    ds_read_b128 a[8:11], v3 offset:28672
    ds_read_b128 v[96:99], v12 offset:8192
    ds_write_b128 v12, v[104:107] offset:6144
    v_lshlrev_b32 v104, 16, v100
    v_and_b32 v105, 0xffff0000, v100
    v_mfma_f32_32x32x16_bf16 v[16:31], a[12:15], a[228:231], v[16:31]
    s_waitcnt lgkmcnt(6)
    v_lshlrev_b32 v106, 16, v101
    v_and_b32 v107, 0xffff0000, v101
    v_lshlrev_b32 v108, 16, v102
    v_and_b32 v109, 0xffff0000, v102
    v_lshlrev_b32 v110, 16, v103
    v_and_b32 v111, 0xffff0000, v103
    v_mfma_f32_32x32x16_bf16 v[32:47], a[16:19], a[228:231], v[32:47]
    s_waitcnt lgkmcnt(5)
    ds_read_b128 a[12:15], v3 offset:29696
    ds_read_b128 a[16:19], v3 offset:30720
    v_mul_f32 v104, v104, v112
    v_mul_f32 v105, v105, v113
    v_mul_f32 v106, v106, v114
    v_mul_f32 v107, v107, v115
    v_mul_f32 v108, v108, v116
    v_mul_f32 v109, v109, v117
    v_mul_f32 v110, v110, v118
    v_mul_f32_e64 v111, v111, v119
    v_cvt_pk_bf16_f32 v104, v104, v105
    v_cvt_pk_bf16_f32 v105, v106, v107
    v_cvt_pk_bf16_f32 v106, v108, v109
    v_cvt_pk_bf16_f32 v107, v110, v111
    v_mfma_f32_32x32x16_bf16 v[48:63], a[20:23], a[228:231], v[48:63]
    s_waitcnt lgkmcnt(6)
    ds_read_b128 v[100:103], v12 offset:9216
    ds_write_b128 v12, v[104:107] offset:7168
    v_mfma_f32_32x32x16_bf16 v[16:31], a[0:3], a[232:235], v[16:31]
    s_waitcnt lgkmcnt(7)
    ds_read_b128 a[20:23], v3 offset:31744
    ds_read_b128 a[0:3], v3 offset:45056
    s_waitcnt lgkmcnt(7)
    v_lshlrev_b32 v104, 16, v96
    v_and_b32 v105, 0xffff0000, v96
    v_lshlrev_b32 v106, 16, v97
    v_and_b32 v107, 0xffff0000, v97
    v_mfma_f32_32x32x16_bf16 v[32:47], a[4:7], a[232:235], v[32:47]
    v_lshlrev_b32 v108, 16, v98
    v_and_b32 v109, 0xffff0000, v98
    v_lshlrev_b32 v110, 16, v99
    v_and_b32 v111, 0xffff0000, v99
    v_mul_f32 v104, v104, v112
    v_mul_f32 v105, v105, v113
    v_mul_f32 v106, v106, v114
    v_mul_f32 v107, v107, v115
    v_mul_f32 v108, v108, v116
    v_mul_f32 v109, v109, v117
    v_mul_f32 v110, v110, v118
    v_mul_f32_e64 v111, v111, v119
    v_cvt_pk_bf16_f32 v104, v104, v105
    v_cvt_pk_bf16_f32 v105, v106, v107
    v_cvt_pk_bf16_f32 v106, v108, v109
    v_cvt_pk_bf16_f32 v107, v110, v111
    v_mfma_f32_32x32x16_bf16 v[48:63], a[8:11], a[232:235], v[48:63]
    s_waitcnt lgkmcnt(5)
    ds_read_b128 a[4:7], v3 offset:46080
    ds_read_b128 a[8:11], v3 offset:47104
    ds_read_b128 v[96:99], v12 offset:10240
    ds_read_b128 v[112:115], v10 offset:192
    ds_read_b128 v[116:119], v10 offset:224
    ds_write_b128 v12, v[104:107] offset:8192
    v_mfma_f32_32x32x16_bf16 v[16:31], a[12:15], a[236:239], v[16:31]
    s_waitcnt lgkmcnt(10)
    s_waitcnt lgkmcnt(9)
    v_lshlrev_b32 v104, 16, v100
    v_and_b32 v105, 0xffff0000, v100
    v_lshlrev_b32 v106, 16, v101
    v_and_b32 v107, 0xffff0000, v101
    v_lshlrev_b32 v108, 16, v102
    v_and_b32 v109, 0xffff0000, v102
    v_mfma_f32_32x32x16_bf16 v[32:47], a[16:19], a[236:239], v[32:47]
    s_waitcnt lgkmcnt(7)
    ds_read_b128 a[12:15], v3 offset:48128
    ds_read_b128 a[16:19], v3 offset:49152
    v_lshlrev_b32 v110, 16, v103
    v_and_b32 v111, 0xffff0000, v103
    s_waitcnt lgkmcnt(4)
    v_mul_f32 v104, v104, v112
    v_mul_f32 v105, v105, v113
    v_mul_f32 v106, v106, v114
    v_mul_f32 v107, v107, v115
    s_waitcnt lgkmcnt(3)
    v_mul_f32 v108, v108, v116
    v_mul_f32 v109, v109, v117
    v_mul_f32 v110, v110, v118
    v_mul_f32 v111, v111, v119
    v_cvt_pk_bf16_f32 v104, v104, v105
    v_cvt_pk_bf16_f32 v105, v106, v107
    v_cvt_pk_bf16_f32 v106, v108, v109
    v_cvt_pk_bf16_f32 v107, v110, v111
    v_mfma_f32_32x32x16_bf16 v[48:63], a[20:23], a[236:239], v[48:63]
    ds_read_b128 v[100:103], v12 offset:11264
    ds_write_b128 v12, v[104:107] offset:9216
    v_mfma_f32_32x32x16_bf16 v[16:31], a[0:3], a[240:243], v[16:31]
    ds_read_b128 a[20:23], v3 offset:50176
    ds_read_b128 a[0:3], v3 offset:63488
    v_lshlrev_b32 v104, 16, v96
    v_and_b32 v105, 0xffff0000, v96
    v_lshlrev_b32 v106, 16, v97
    v_and_b32 v107, 0xffff0000, v97
    v_mfma_f32_32x32x16_bf16 v[32:47], a[4:7], a[240:243], v[32:47]
    v_lshlrev_b32 v108, 16, v98
    v_and_b32 v109, 0xffff0000, v98
    v_lshlrev_b32 v110, 16, v99
    v_and_b32 v111, 0xffff0000, v99
    v_mul_f32 v104, v104, v112
    v_mul_f32 v105, v105, v113
    v_mul_f32 v106, v106, v114
    v_mul_f32 v107, v107, v115
    v_mul_f32 v108, v108, v116
    v_mul_f32 v109, v109, v117
    v_mul_f32 v110, v110, v118
    v_mul_f32 v111, v111, v119
    v_cvt_pk_bf16_f32 v104, v104, v105
    v_cvt_pk_bf16_f32 v105, v106, v107
    v_cvt_pk_bf16_f32 v106, v108, v109
    v_cvt_pk_bf16_f32 v107, v110, v111
    v_mfma_f32_32x32x16_bf16 v[48:63], a[8:11], a[240:243], v[48:63]
    s_waitcnt lgkmcnt(5)
    ds_read_b128 a[4:7], v3 offset:64512
    ds_read_b128 a[8:11], v4 offset:0
    ds_write_b128 v12, v[104:107] offset:10240
    s_waitcnt lgkmcnt(6)
    v_lshlrev_b32 v104, 16, v100
    v_and_b32 v105, 0xffff0000, v100
    v_lshlrev_b32 v106, 16, v101
    v_mfma_f32_32x32x16_bf16 v[16:31], a[12:15], a[244:247], v[16:31]
    v_and_b32 v107, 0xffff0000, v101
    v_lshlrev_b32 v108, 16, v102
    v_and_b32 v109, 0xffff0000, v102
    v_lshlrev_b32 v110, 16, v103
    v_and_b32 v111, 0xffff0000, v103
    v_mul_f32 v104, v104, v112
    v_mfma_f32_32x32x16_bf16 v[32:47], a[16:19], a[244:247], v[32:47]
    s_waitcnt lgkmcnt(4)
    ds_read_b128 a[12:15], v4 offset:1024
    ds_read_b128 a[16:19], v4 offset:2048
    v_mul_f32 v105, v105, v113
    v_mul_f32 v106, v106, v114
    v_mul_f32 v107, v107, v115
    v_mul_f32 v108, v108, v116
    v_mul_f32 v109, v109, v117
    v_mul_f32 v110, v110, v118
    v_mul_f32_e64 v111, v111, v119
    v_cvt_pk_bf16_f32 v104, v104, v105
    v_cvt_pk_bf16_f32 v105, v106, v107
    v_cvt_pk_bf16_f32 v106, v108, v109
    v_cvt_pk_bf16_f32 v107, v110, v111
    v_mfma_f32_32x32x16_bf16 v[48:63], a[20:23], a[244:247], v[48:63]
    s_waitcnt lgkmcnt(5)
    ds_read_b128 v[112:115], v10 offset:256
    ds_read_b128 v[116:119], v10 offset:288
    ds_read_b128 v[96:99], v12 offset:12288
    ds_read_b128 v[100:103], v12 offset:13312
    ds_write_b128 v12, v[104:107] offset:11264
    s_waitcnt lgkmcnt(0)
    s_barrier
    v_mfma_f32_32x32x16_bf16 v[16:31], a[0:3], v[72:75], v[16:31]
    ds_read_b128 a[20:23], v4 offset:3072
    ds_read_b128 a[0:3], v3 offset:14336
    v_lshlrev_b32 v104, 16, v96
    v_and_b32 v105, 0xffff0000, v96
    v_lshlrev_b32 v106, 16, v97
    v_and_b32 v107, 0xffff0000, v97
    v_mfma_f32_32x32x16_bf16 v[32:47], a[4:7], v[72:75], v[32:47]
    s_add_u32 s54, s56, 172032
    buffer_load_dwordx4 a[224:227], v1, s[24:27], s54 offen offset:0
    buffer_load_dwordx4 a[228:231], v1, s[24:27], s54 offen offset:32
    v_lshlrev_b32 v108, 16, v98
    v_and_b32 v109, 0xffff0000, v98
    v_lshlrev_b32 v110, 16, v99
    v_and_b32 v111, 0xffff0000, v99
    v_mul_f32 v104, v104, v112
    v_mul_f32 v105, v105, v113
    v_mul_f32 v106, v106, v114
    v_mul_f32 v107, v107, v115
    v_mul_f32 v108, v108, v116
    v_mul_f32 v109, v109, v117
    v_mul_f32 v110, v110, v118
    v_mul_f32_e64 v111, v111, v119
    v_cvt_pk_bf16_f32 v104, v104, v105
    v_cvt_pk_bf16_f32 v105, v106, v107
    v_cvt_pk_bf16_f32 v106, v108, v109
    v_cvt_pk_bf16_f32 v107, v110, v111
    v_mfma_f32_32x32x16_bf16 v[48:63], a[8:11], v[72:75], v[48:63]
    ds_read_b128 a[4:7], v3 offset:15360
    ds_read_b128 a[8:11], v3 offset:16384
    ds_read_b128 v[96:99], v12 offset:14336
    ds_write_b128 v12, v[104:107] offset:12288
    v_lshlrev_b32 v104, 16, v100
    v_and_b32 v105, 0xffff0000, v100
    v_mfma_f32_32x32x16_bf16 v[16:31], a[12:15], v[76:79], v[16:31]
    v_lshlrev_b32 v106, 16, v101
    v_and_b32 v107, 0xffff0000, v101
    v_lshlrev_b32 v108, 16, v102
    v_and_b32 v109, 0xffff0000, v102
    v_lshlrev_b32 v110, 16, v103
    v_and_b32 v111, 0xffff0000, v103
    v_mfma_f32_32x32x16_bf16 v[32:47], a[16:19], v[76:79], v[32:47]
    s_waitcnt lgkmcnt(5)
    ds_read_b128 a[12:15], v3 offset:17408
    ds_read_b128 a[16:19], v3 offset:18432
    v_mul_f32 v104, v104, v112
    v_mul_f32 v105, v105, v113
    v_mul_f32 v106, v106, v114
    v_mul_f32 v107, v107, v115
    v_mul_f32 v108, v108, v116
    v_mul_f32 v109, v109, v117
    v_mul_f32 v110, v110, v118
    v_mul_f32_e64 v111, v111, v119
    v_cvt_pk_bf16_f32 v104, v104, v105
    v_cvt_pk_bf16_f32 v105, v106, v107
    v_cvt_pk_bf16_f32 v106, v108, v109
    v_cvt_pk_bf16_f32 v107, v110, v111
    v_mfma_f32_32x32x16_bf16 v[48:63], a[20:23], v[76:79], v[48:63]
    s_waitcnt lgkmcnt(6)
    ds_read_b128 v[100:103], v12 offset:15360
    ds_write_b128 v12, v[104:107] offset:13312
    v_mfma_f32_32x32x16_bf16 v[16:31], a[0:3], v[80:83], v[16:31]
    s_waitcnt lgkmcnt(7)
    ds_read_b128 a[20:23], v3 offset:19456
    ds_read_b128 a[0:3], v3 offset:32768
    s_waitcnt lgkmcnt(7)
    v_lshlrev_b32 v104, 16, v96
    v_and_b32 v105, 0xffff0000, v96
    v_lshlrev_b32 v106, 16, v97
    v_and_b32 v107, 0xffff0000, v97
    v_mfma_f32_32x32x16_bf16 v[32:47], a[4:7], v[80:83], v[32:47]
    buffer_load_dwordx4 a[232:235], v1, s[24:27], s54 offen offset:64
    buffer_load_dwordx4 a[236:239], v1, s[24:27], s54 offen offset:96
    v_lshlrev_b32 v108, 16, v98
    v_and_b32 v109, 0xffff0000, v98
    v_lshlrev_b32 v110, 16, v99
    v_and_b32 v111, 0xffff0000, v99
    v_mfma_f32_32x32x16_bf16 v[48:63], a[8:11], v[80:83], v[48:63]
    s_waitcnt lgkmcnt(5)
    ds_read_b128 a[4:7], v3 offset:33792
    ds_read_b128 a[8:11], v3 offset:34816
    v_mul_f32 v104, v104, v112
    v_mul_f32 v105, v105, v113
    v_mul_f32 v106, v106, v114
    v_mul_f32 v107, v107, v115
    v_mfma_f32_32x32x16_bf16 v[16:31], a[12:15], v[84:87], v[16:31]
    s_waitcnt lgkmcnt(6)
    buffer_load_dwordx4 a[240:243], v1, s[24:27], s54 offen offset:128
    buffer_load_dwordx4 a[244:247], v1, s[24:27], s54 offen offset:160
    v_mul_f32 v108, v108, v116
    v_mul_f32 v109, v109, v117
    v_mul_f32 v110, v110, v118
    v_mul_f32 v111, v111, v119
    v_mfma_f32_32x32x16_bf16 v[32:47], a[16:19], v[84:87], v[32:47]
    s_waitcnt lgkmcnt(3)
    ds_read_b128 a[12:15], v3 offset:35840
    ds_read_b128 a[16:19], v3 offset:36864
    v_cvt_pk_bf16_f32 v104, v104, v105
    v_cvt_pk_bf16_f32 v105, v106, v107
    v_cvt_pk_bf16_f32 v106, v108, v109
    v_cvt_pk_bf16_f32 v107, v110, v111
    v_mfma_f32_32x32x16_bf16 v[48:63], a[20:23], v[84:87], v[48:63]
    s_waitcnt lgkmcnt(4)
    ds_read_b128 v[96:99], v12 offset:16384
    ds_read_b128 v[112:115], v10 offset:320
    ds_read_b128 v[116:119], v10 offset:352
    ds_write_b128 v12, v[104:107] offset:14336
    v_mfma_f32_32x32x16_bf16 v[16:31], a[0:3], v[64:67], v[16:31]
    s_waitcnt lgkmcnt(7)
    ds_read_b128 a[20:23], v3 offset:37888
    ds_read_b128 a[0:3], v3 offset:51200
    v_lshlrev_b32 v104, 16, v100
    v_and_b32 v105, 0xffff0000, v100
    v_lshlrev_b32 v106, 16, v101
    v_and_b32 v107, 0xffff0000, v101
    v_mfma_f32_32x32x16_bf16 v[32:47], a[4:7], v[64:67], v[32:47]
    s_waitcnt lgkmcnt(8)
    s_add_u32 s54, s56, 73728
    buffer_load_dwordx4 v[72:75], v1, s[24:27], s54 offen offset:0
    buffer_load_dwordx4 v[76:79], v1, s[24:27], s54 offen offset:32
    v_lshlrev_b32 v108, 16, v102
    v_and_b32 v109, 0xffff0000, v102
    v_lshlrev_b32 v110, 16, v103
    v_and_b32 v111, 0xffff0000, v103
    s_waitcnt lgkmcnt(4)
    v_mul_f32 v104, v104, v112
    v_mul_f32 v105, v105, v113
    v_mul_f32 v106, v106, v114
    v_mul_f32 v107, v107, v115
    s_waitcnt lgkmcnt(3)
    v_mul_f32 v108, v108, v116
    v_mul_f32 v109, v109, v117
    v_mul_f32 v110, v110, v118
    v_mul_f32_e64 v111, v111, v119
    v_cvt_pk_bf16_f32 v104, v104, v105
    v_cvt_pk_bf16_f32 v105, v106, v107
    v_cvt_pk_bf16_f32 v106, v108, v109
    v_cvt_pk_bf16_f32 v107, v110, v111
    v_mfma_f32_32x32x16_bf16 v[48:63], a[8:11], v[64:67], v[48:63]
    ds_read_b128 a[4:7], v3 offset:52224
    ds_read_b128 a[8:11], v3 offset:53248
    ds_read_b128 v[100:103], v12 offset:17408
    ds_write_b128 v12, v[104:107] offset:15360
    v_lshlrev_b32 v104, 16, v96
    v_and_b32 v105, 0xffff0000, v96
    v_mfma_f32_32x32x16_bf16 v[16:31], a[12:15], v[68:71], v[16:31]
    v_lshlrev_b32 v106, 16, v97
    v_and_b32 v107, 0xffff0000, v97
    v_lshlrev_b32 v108, 16, v98
    v_and_b32 v109, 0xffff0000, v98
    v_lshlrev_b32 v110, 16, v99
    v_and_b32 v111, 0xffff0000, v99
    v_mfma_f32_32x32x16_bf16 v[32:47], a[16:19], v[68:71], v[32:47]
    s_waitcnt lgkmcnt(5)
    ds_read_b128 a[12:15], v3 offset:54272
    ds_read_b128 a[16:19], v3 offset:55296
    v_mul_f32 v104, v104, v112
    v_mul_f32 v105, v105, v113
    v_mul_f32 v106, v106, v114
    v_mul_f32 v107, v107, v115
    v_mul_f32 v108, v108, v116
    v_mul_f32 v109, v109, v117
    v_mul_f32 v110, v110, v118
    v_mul_f32_e64 v111, v111, v119
    v_cvt_pk_bf16_f32 v104, v104, v105
    v_cvt_pk_bf16_f32 v105, v106, v107
    v_cvt_pk_bf16_f32 v106, v108, v109
    v_cvt_pk_bf16_f32 v107, v110, v111
    v_mfma_f32_32x32x16_bf16 v[48:63], a[20:23], v[68:71], v[48:63]
    s_waitcnt lgkmcnt(6)
    ds_write_b128 v12, v[104:107] offset:16384
    v_mfma_f32_32x32x16_bf16 v[16:31], a[0:3], v[120:123], v[16:31]
    s_waitcnt lgkmcnt(6)
    ds_read_b128 a[20:23], v3 offset:56320
    ds_read_b128 a[0:3], v4 offset:4096
    s_waitcnt lgkmcnt(6)
    v_lshlrev_b32 v104, 16, v100
    v_and_b32 v105, 0xffff0000, v100
    v_lshlrev_b32 v106, 16, v101
    v_and_b32 v107, 0xffff0000, v101
    v_mfma_f32_32x32x16_bf16 v[32:47], a[4:7], v[120:123], v[32:47]
    buffer_load_dwordx4 v[80:83], v1, s[24:27], s54 offen offset:64
    buffer_load_dwordx4 v[84:87], v1, s[24:27], s54 offen offset:96
    v_lshlrev_b32 v108, 16, v102
    v_and_b32 v109, 0xffff0000, v102
    v_lshlrev_b32 v110, 16, v103
    v_and_b32 v111, 0xffff0000, v103
    v_mfma_f32_32x32x16_bf16 v[48:63], a[8:11], v[120:123], v[48:63]
    s_waitcnt lgkmcnt(4)
    ds_read_b128 a[4:7], v4 offset:5120
    ds_read_b128 a[8:11], v4 offset:6144
    v_mul_f32 v104, v104, v112
    v_mul_f32 v105, v105, v113
    v_mul_f32 v106, v106, v114
    v_mul_f32 v107, v107, v115
    v_mfma_f32_32x32x16_bf16 v[16:31], a[12:15], v[124:127], v[16:31]
    s_waitcnt lgkmcnt(5)
    v_mul_f32 v108, v108, v116
    v_mul_f32 v109, v109, v117
    v_mul_f32 v110, v110, v118
    v_mul_f32 v111, v111, v119
    v_cvt_pk_bf16_f32 v104, v104, v105
    v_cvt_pk_bf16_f32 v105, v106, v107
    v_mfma_f32_32x32x16_bf16 v[32:47], a[16:19], v[124:127], v[32:47]
    s_waitcnt lgkmcnt(3)
    ds_read_b128 a[12:15], v4 offset:7168
    ds_read_b128 a[16:19], v4 offset:8192
    v_cvt_pk_bf16_f32 v106, v108, v109
    v_cvt_pk_bf16_f32 v107, v110, v111
    v_mfma_f32_32x32x16_bf16 v[48:63], a[20:23], v[124:127], v[48:63]
    s_waitcnt lgkmcnt(4)
    ds_write_b128 v12, v[104:107] offset:17408
    s_waitcnt lgkmcnt(0)
    s_barrier
    v_mfma_f32_32x32x16_bf16 v[16:31], a[0:3], v[128:131], v[16:31]
    ds_read_b128 a[20:23], v4 offset:9216
    ds_read_b128 a[0:3], v3 offset:20480
    s_waitcnt vmcnt(4)
    v_mfma_f32_32x32x16_bf16 v[32:47], a[4:7], v[128:131], v[32:47]
    buffer_load_dwordx4 v[88:91], v1, s[24:27], s54 offen offset:128
    buffer_load_dwordx4 v[92:95], v1, s[24:27], s54 offen offset:160
    v_mfma_f32_32x32x16_bf16 v[48:63], a[8:11], v[128:131], v[48:63]
    ds_read_b128 a[4:7], v3 offset:21504
    ds_read_b128 a[8:11], v3 offset:22528
    v_mfma_f32_32x32x16_bf16 v[16:31], a[12:15], v[132:135], v[16:31]
    v_mfma_f32_32x32x16_bf16 v[32:47], a[16:19], v[132:135], v[32:47]
    s_waitcnt lgkmcnt(3)
    ds_read_b128 a[12:15], v3 offset:23552
    ds_read_b128 a[16:19], v3 offset:24576
    v_mfma_f32_32x32x16_bf16 v[48:63], a[20:23], v[132:135], v[48:63]
    s_waitcnt lgkmcnt(4)
    v_mfma_f32_32x32x16_bf16 v[16:31], a[24:27], a[224:227], v[16:31]
    buffer_load_dwordx2 v[12:13], v2, s[44:47], s58 offen offset:3072
    v_mfma_f32_32x32x16_bf16 v[16:31], a[28:31], a[228:231], v[16:31]
    v_mfma_f32_32x32x16_bf16 v[32:47], a[24:27], a[232:235], v[32:47]
    v_mfma_f32_32x32x16_bf16 v[32:47], a[28:31], a[236:239], v[32:47]
    v_mfma_f32_32x32x16_bf16 v[48:63], a[24:27], a[240:243], v[48:63]
    v_mfma_f32_32x32x16_bf16 v[48:63], a[28:31], a[244:247], v[48:63]
    v_mfma_f32_32x32x16_bf16 v[16:31], a[0:3], v[136:139], v[16:31]
    s_waitcnt lgkmcnt(3)
    ds_read_b128 a[20:23], v3 offset:25600
    ds_read_b128 a[0:3], v3 offset:38912
    v_mfma_f32_32x32x16_bf16 v[32:47], a[4:7], v[136:139], v[32:47]
    s_waitcnt lgkmcnt(4)
    v_mfma_f32_32x32x16_bf16 v[48:63], a[8:11], v[136:139], v[48:63]
    s_waitcnt lgkmcnt(3)
    ds_read_b128 a[4:7], v3 offset:39936
    ds_read_b128 a[8:11], v3 offset:40960
    v_mfma_f32_32x32x16_bf16 v[16:31], a[12:15], v[140:143], v[16:31]
    s_waitcnt lgkmcnt(4)
    v_mfma_f32_32x32x16_bf16 v[32:47], a[16:19], v[140:143], v[32:47]
    s_waitcnt lgkmcnt(3)
    ds_read_b128 a[12:15], v3 offset:41984
    ds_read_b128 a[16:19], v3 offset:43008
    v_mfma_f32_32x32x16_bf16 v[48:63], a[20:23], v[140:143], v[48:63]
    s_waitcnt lgkmcnt(4)
    v_mfma_f32_32x32x16_bf16 v[16:31], a[0:3], a[248:251], v[16:31]
    s_waitcnt lgkmcnt(3)
    ds_read_b128 a[20:23], v3 offset:44032
    ds_read_b128 a[0:3], v3 offset:57344
    v_mfma_f32_32x32x16_bf16 v[32:47], a[4:7], a[248:251], v[32:47]
    s_waitcnt lgkmcnt(4)
    ds_read_b128 v[104:107], v5 offset:64
    ds_read_b128 v[108:111], v5 offset:80
    v_mfma_f32_32x32x16_bf16 v[48:63], a[8:11], a[248:251], v[48:63]
    s_waitcnt lgkmcnt(5)
    ds_read_b128 a[4:7], v3 offset:58368
    ds_read_b128 a[8:11], v3 offset:59392
    v_mfma_f32_32x32x16_bf16 v[16:31], a[12:15], a[252:255], v[16:31]
    s_waitcnt lgkmcnt(6)
    ds_read_b128 v[96:99], v5 offset:0
    ds_read_b128 v[100:103], v5 offset:16
    s_add_u32 s54, s56, 147456
    v_mfma_f32_32x32x16_bf16 v[32:47], a[16:19], a[252:255], v[32:47]
    s_waitcnt lgkmcnt(7)
    ds_read_b128 a[12:15], v3 offset:60416
    ds_read_b128 a[16:19], v3 offset:61440
    v_mfma_f32_32x32x16_bf16 v[48:63], a[20:23], a[252:255], v[48:63]
    s_waitcnt lgkmcnt(8)
    buffer_load_dwordx4 a[224:227], v1, s[24:27], s54 offen offset:0
    buffer_load_dwordx4 a[228:231], v1, s[24:27], s54 offen offset:32
    v_mfma_f32_32x32x16_bf16 v[16:31], a[0:3], v[144:147], v[16:31]
    s_waitcnt lgkmcnt(5)
    ds_read_b128 a[20:23], v3 offset:62464
    ds_read_b128 a[0:3], v4 offset:10240
    v_mfma_f32_32x32x16_bf16 v[32:47], a[4:7], v[144:147], v[32:47]
    s_waitcnt lgkmcnt(6)
    ds_read_b128 v[120:123], v5 offset:192
    ds_read_b128 v[124:127], v5 offset:208
    v_mfma_f32_32x32x16_bf16 v[48:63], a[8:11], v[144:147], v[48:63]
    s_waitcnt lgkmcnt(5)
    ds_read_b128 a[4:7], v4 offset:11264
    ds_read_b128 a[8:11], v4 offset:12288
    v_mfma_f32_32x32x16_bf16 v[16:31], a[12:15], v[148:151], v[16:31]
    s_waitcnt lgkmcnt(6)
    ds_read_b128 v[112:115], v5 offset:128
    ds_read_b128 v[116:119], v5 offset:144
    v_mfma_f32_32x32x16_bf16 v[32:47], a[16:19], v[148:151], v[32:47]
    s_waitcnt lgkmcnt(7)
    ds_read_b128 a[12:15], v4 offset:13312
    ds_read_b128 a[16:19], v4 offset:14336
    v_mfma_f32_32x32x16_bf16 v[48:63], a[20:23], v[148:151], v[48:63]
    s_waitcnt lgkmcnt(8)
    v_mfma_f32_32x32x16_bf16 v[16:31], a[0:3], v[152:155], v[16:31]
    s_waitcnt lgkmcnt(5)
    ds_read_b128 a[20:23], v4 offset:15360
    ds_read_b128 a[0:3], v3 offset:57344
    v_mfma_f32_32x32x16_bf16 v[32:47], a[4:7], v[152:155], v[32:47]
    s_waitcnt lgkmcnt(6)
    ds_read_b128 v[136:139], v5 offset:320
    ds_read_b128 v[140:143], v5 offset:336
    v_mfma_f32_32x32x16_bf16 v[48:63], a[8:11], v[152:155], v[48:63]
    s_waitcnt lgkmcnt(5)
    ds_read_b128 a[4:7], v3 offset:58368
    ds_read_b128 a[8:11], v3 offset:59392
    v_mfma_f32_32x32x16_bf16 v[16:31], a[12:15], v[156:159], v[16:31]
    s_waitcnt lgkmcnt(6)
    ds_read_b128 v[128:131], v5 offset:256
    ds_read_b128 v[132:135], v5 offset:272
    v_mfma_f32_32x32x16_bf16 v[32:47], a[16:19], v[156:159], v[32:47]
    s_waitcnt lgkmcnt(7)
    ds_read_b128 a[12:15], v3 offset:60416
    ds_read_b128 a[16:19], v3 offset:61440
    v_mfma_f32_32x32x16_bf16 v[48:63], a[20:23], v[156:159], v[48:63]
    s_waitcnt lgkmcnt(8)
    buffer_load_dwordx4 a[232:235], v1, s[24:27], s54 offen offset:64
    buffer_load_dwordx4 a[236:239], v1, s[24:27], s54 offen offset:96
L_pf13:
    v_mfma_f32_32x32x16_bf16 v[96:111], a[0:3], v[160:163], v[96:111]
    s_waitcnt lgkmcnt(5)
    ds_read_b128 a[20:23], v3 offset:62464
    ds_read_b128 a[0:3], v3 offset:63488
    ds_read_b128 v[144:147], v5 offset:0
    ds_read_b128 v[148:151], v5 offset:16
    ds_read_b128 v[152:155], v5 offset:64
    ds_read_b128 v[156:159], v5 offset:80
    v_mfma_f32_32x32x16_bf16 v[112:127], a[4:7], v[160:163], v[112:127]
    s_waitcnt lgkmcnt(10)
    s_mov_b32 s63, L_pf13-L_pc+12288
    buffer_load_dword v6, v7, s[68:71], s63 offen
    s_waitcnt lgkmcnt(8)
    v_mfma_f32_32x32x16_bf16 v[128:143], a[8:11], v[160:163], v[128:143]
    s_waitcnt lgkmcnt(7)
    ds_read_b128 a[4:7], v3 offset:64512
    ds_read_b128 a[8:11], v4 offset:0
    s_waitcnt lgkmcnt(2)
    v_add_f32 v16, v16, v144
    v_add_f32 v17, v17, v145
    v_add_f32 v18, v18, v146
    v_add_f32 v19, v19, v147
    v_mfma_f32_32x32x16_bf16 v[96:111], a[12:15], v[164:167], v[96:111]
    v_add_f32 v20, v20, v148
    v_add_f32 v21, v21, v149
    v_add_f32 v22, v22, v150
    v_add_f32 v23, v23, v151
    v_add_f32 v24, v24, v152
    v_add_f32 v25, v25, v153
    v_mfma_f32_32x32x16_bf16 v[112:127], a[16:19], v[164:167], v[112:127]
    ds_read_b128 a[12:15], v4 offset:1024
    ds_read_b128 a[16:19], v4 offset:2048
    v_add_f32 v26, v26, v154
    v_add_f32 v27, v27, v155
    v_add_f32 v28, v28, v156
    v_add_f32 v29, v29, v157
    v_mfma_f32_32x32x16_bf16 v[128:143], a[20:23], v[164:167], v[128:143]
    v_add_f32 v30, v30, v158
    v_add_f32_e64 v31, v31, v159
    v_cvt_pk_bf16_f32 v16, v16, v17
    v_cvt_pk_bf16_f32 v17, v18, v19
    v_cvt_pk_bf16_f32 v18, v20, v21
    v_cvt_pk_bf16_f32 v19, v22, v23
    v_cvt_pk_bf16_f32 v20, v24, v25
    v_cvt_pk_bf16_f32 v21, v26, v27
    v_cvt_pk_bf16_f32 v22, v28, v29
    v_cvt_pk_bf16_f32 v23, v30, v31
    v_permlane16_swap_b32 v16, v20
    v_permlane16_swap_b32 v17, v21
    v_permlane16_swap_b32 v18, v22
    v_permlane16_swap_b32 v19, v23
    v_mfma_f32_32x32x16_bf16 v[96:111], a[0:3], v[168:171], v[96:111]
    s_waitcnt lgkmcnt(3)
    ds_read_b128 a[20:23], v4 offset:3072
    ds_read_b128 a[0:3], v4 offset:4096
    ds_read_b128 v[144:147], v5 offset:128
    ds_read_b128 v[148:151], v5 offset:144
    ds_read_b128 v[152:155], v5 offset:192
    ds_read_b128 v[156:159], v5 offset:208
    v_mfma_f32_32x32x16_bf16 v[112:127], a[4:7], v[168:171], v[112:127]
    s_waitcnt lgkmcnt(8)
    buffer_load_dwordx4 a[240:243], v1, s[24:27], s54 offen offset:128
    buffer_load_dwordx4 a[244:247], v1, s[24:27], s54 offen offset:160
    v_mfma_f32_32x32x16_bf16 v[128:143], a[8:11], v[168:171], v[128:143]
    s_waitcnt lgkmcnt(7)
    ds_read_b128 a[4:7], v4 offset:5120
    ds_read_b128 a[8:11], v4 offset:6144
    s_waitcnt lgkmcnt(2)
    v_add_f32 v32, v32, v144
    v_add_f32 v33, v33, v145
    v_add_f32 v34, v34, v146
    v_add_f32 v35, v35, v147
    v_mfma_f32_32x32x16_bf16 v[96:111], a[12:15], v[172:175], v[96:111]
    v_add_f32 v36, v36, v148
    v_add_f32 v37, v37, v149
    v_add_f32 v38, v38, v150
    v_add_f32 v39, v39, v151
    v_add_f32 v40, v40, v152
    v_add_f32 v41, v41, v153
    v_mfma_f32_32x32x16_bf16 v[112:127], a[16:19], v[172:175], v[112:127]
    ds_read_b128 a[12:15], v4 offset:7168
    ds_read_b128 a[16:19], v4 offset:8192
    v_add_f32 v42, v42, v154
    v_add_f32 v43, v43, v155
    v_add_f32 v44, v44, v156
    v_add_f32 v45, v45, v157
    v_mfma_f32_32x32x16_bf16 v[128:143], a[20:23], v[172:175], v[128:143]
    v_add_f32 v46, v46, v158
    v_add_f32 v47, v47, v159
    v_cvt_pk_bf16_f32 v32, v32, v33
    v_cvt_pk_bf16_f32 v33, v34, v35
    v_cvt_pk_bf16_f32 v34, v36, v37
    v_cvt_pk_bf16_f32 v35, v38, v39
    v_cvt_pk_bf16_f32 v36, v40, v41
    v_cvt_pk_bf16_f32 v37, v42, v43
    v_cvt_pk_bf16_f32 v38, v44, v45
    v_cvt_pk_bf16_f32 v39, v46, v47
    v_permlane16_swap_b32 v32, v36
    v_permlane16_swap_b32 v33, v37
    v_permlane16_swap_b32 v34, v38
    v_permlane16_swap_b32 v35, v39
    v_mfma_f32_32x32x16_bf16 v[96:111], a[0:3], v[176:179], v[96:111]
    s_waitcnt lgkmcnt(3)
    ds_read_b128 a[20:23], v4 offset:9216
    ds_read_b128 a[0:3], v4 offset:16384
    ds_read_b128 v[144:147], v5 offset:256
    ds_read_b128 v[148:151], v5 offset:272
    ds_read_b128 v[152:155], v5 offset:320
    ds_read_b128 v[156:159], v5 offset:336
    v_mfma_f32_32x32x16_bf16 v[112:127], a[4:7], v[176:179], v[112:127]
    s_waitcnt lgkmcnt(8)
    ds_read_b128 v[168:171], v5 offset:64
    ds_read_b128 v[172:175], v5 offset:80
    v_mfma_f32_32x32x16_bf16 v[128:143], a[8:11], v[176:179], v[128:143]
    s_waitcnt lgkmcnt(9)
    ds_read_b128 a[4:7], v4 offset:17408
    ds_read_b128 a[8:11], v4 offset:10240
    s_waitcnt lgkmcnt(4)
    v_add_f32 v48, v48, v144
    v_add_f32 v49, v49, v145
    v_add_f32 v50, v50, v146
    v_add_f32 v51, v51, v147
    v_mfma_f32_32x32x16_bf16 v[96:111], a[12:15], v[180:183], v[96:111]
    ds_read_b128 v[160:163], v5 offset:0
    ds_read_b128 v[164:167], v5 offset:16
    v_add_f32 v52, v52, v148
    v_add_f32 v53, v53, v149
    v_add_f32 v54, v54, v150
    v_add_f32 v55, v55, v151
    v_mfma_f32_32x32x16_bf16 v[112:127], a[16:19], v[180:183], v[112:127]
    ds_read_b128 a[12:15], v4 offset:11264
    ds_read_b128 a[16:19], v4 offset:12288
    v_add_f32 v56, v56, v152
    v_add_f32 v57, v57, v153
    v_add_f32 v58, v58, v154
    v_add_f32 v59, v59, v155
    v_mfma_f32_32x32x16_bf16 v[128:143], a[20:23], v[180:183], v[128:143]
    v_add_f32 v60, v60, v156
    v_add_f32 v61, v61, v157
    v_add_f32 v62, v62, v158
    v_add_f32 v63, v63, v159
    v_cvt_pk_bf16_f32 v48, v48, v49
    v_cvt_pk_bf16_f32 v49, v50, v51
    v_cvt_pk_bf16_f32 v50, v52, v53
    v_cvt_pk_bf16_f32 v51, v54, v55
    v_cvt_pk_bf16_f32 v52, v56, v57
    v_cvt_pk_bf16_f32 v53, v58, v59
    v_cvt_pk_bf16_f32 v54, v60, v61
    v_cvt_pk_bf16_f32 v55, v62, v63
    v_permlane16_swap_b32 v48, v52
    v_permlane16_swap_b32 v49, v53
    v_permlane16_swap_b32 v50, v54
    v_permlane16_swap_b32 v51, v55
    s_waitcnt vmcnt(7)
    v_mfma_f32_32x32x16_bf16 v[144:159], a[0:3], v[72:75], 0
    s_waitcnt lgkmcnt(5)
    ds_read_b128 a[20:23], v4 offset:13312
    ds_read_b128 a[0:3], v4 offset:14336
    v_mfma_f32_32x32x16_bf16 v[144:159], a[4:7], v[76:79], v[144:159]
    s_waitcnt lgkmcnt(6)
    s_add_u32 s55, s56, 172032
    buffer_store_dwordx4 v[16:19], v9, s[28:31], s55 offen offset:0 sc1
    buffer_store_dwordx4 v[32:35], v9, s[28:31], s55 offen offset:64 sc1
    buffer_store_dwordx4 v[48:51], v9, s[28:31], s55 offen offset:128 sc1
    v_mfma_f32_32x32x16_bf16 v[96:111], a[8:11], v[184:187], v[96:111]
    s_waitcnt lgkmcnt(3)
    ds_read_b128 a[4:7], v4 offset:15360
    ds_read_b128 a[8:11], v3 offset:8192
    v_mfma_f32_32x32x16_bf16 v[112:127], a[12:15], v[184:187], v[112:127]
    s_waitcnt lgkmcnt(4)
    v_mfma_f32_32x32x16_bf16 v[128:143], a[16:19], v[184:187], v[128:143]
    s_waitcnt lgkmcnt(3)
    ds_read_b128 a[12:15], v3 offset:9216
    ds_read_b128 a[16:19], v3 offset:10240
    v_mfma_f32_32x32x16_bf16 v[96:111], a[20:23], v[188:191], v[96:111]
    s_waitcnt lgkmcnt(4)
    v_mfma_f32_32x32x16_bf16 v[112:127], a[0:3], v[188:191], v[112:127]
    s_waitcnt lgkmcnt(3)
    ds_read_b128 a[20:23], v3 offset:11264
    ds_read_b128 a[0:3], v3 offset:12288
    v_mfma_f32_32x32x16_bf16 v[128:143], a[4:7], v[188:191], v[128:143]
    s_waitcnt lgkmcnt(4)
    v_mfma_f32_32x32x16_bf16 v[160:175], a[24:27], v[72:75], v[160:175]
    v_mfma_f32_32x32x16_bf16 v[160:175], a[28:31], v[76:79], v[160:175]
    v_mfma_f32_32x32x16_bf16 v[96:111], a[8:11], v[192:195], v[96:111]
    s_waitcnt lgkmcnt(3)
    ds_read_b128 a[4:7], v3 offset:13312
    ds_read_b128 a[8:11], v4 offset:18432
    v_fma_f32 v144, v144, v12, v13
    v_fma_f32 v145, v145, v12, v13
    v_fma_f32 v146, v146, v12, v13
    v_fma_f32 v147, v147, v12, v13
    v_mfma_f32_32x32x16_bf16 v[112:127], a[12:15], v[192:195], v[112:127]
    s_waitcnt lgkmcnt(4)
    buffer_store_dwordx4 v[20:23], v9, s[28:31], s55 offen offset:3072 sc1
    buffer_store_dwordx4 v[36:39], v9, s[28:31], s55 offen offset:3136 sc1
    buffer_store_dwordx4 v[52:55], v9, s[28:31], s55 offen offset:3200 sc1
    v_fma_f32 v148, v148, v12, v13
    v_fma_f32 v149, v149, v12, v13
    v_fma_f32 v150, v150, v12, v13
    v_mfma_f32_32x32x16_bf16 v[128:143], a[16:19], v[192:195], v[128:143]
    s_waitcnt lgkmcnt(3)
    ds_read_b128 a[12:15], v4 offset:19456
    ds_read_b128 a[16:19], v3 offset:14336
    v_fma_f32 v151, v151, v12, v13
    v_fma_f32 v152, v152, v12, v13
    v_fma_f32 v153, v153, v12, v13
    v_fma_f32 v154, v154, v12, v13
    v_mfma_f32_32x32x16_bf16 v[96:111], a[20:23], v[196:199], v[96:111]
    s_waitcnt lgkmcnt(4)
    ds_read_b128 v[184:187], v5 offset:192
    ds_read_b128 v[188:191], v5 offset:208
    v_fma_f32 v155, v155, v12, v13
    v_fma_f32 v156, v156, v12, v13
    v_fma_f32 v157, v157, v12, v13
    v_fma_f32 v158, v158, v12, v13
    v_mfma_f32_32x32x16_bf16 v[112:127], a[0:3], v[196:199], v[112:127]
    s_waitcnt lgkmcnt(5)
    ds_read_b128 a[20:23], v3 offset:15360
    ds_read_b128 a[0:3], v3 offset:16384
    v_fma_f32 v159, v159, v12, v13
    v_cvt_pk_bf16_f32 v72, v144, v145
    v_cvt_pk_bf16_f32 v73, v146, v147
    v_mfma_f32_32x32x16_bf16 v[128:143], a[4:7], v[196:199], v[128:143]
    s_waitcnt lgkmcnt(6)
    ds_read_b128 v[176:179], v5 offset:128
    ds_read_b128 v[180:183], v5 offset:144
    v_cvt_pk_bf16_f32 v74, v148, v149
    v_cvt_pk_bf16_f32 v75, v150, v151
    v_cvt_pk_bf16_f32 v76, v152, v153
    v_mfma_f32_32x32x16_bf16 v[32:47], a[8:11], v[80:83], 0
    s_waitcnt lgkmcnt(7)
    ds_read_b128 a[4:7], v3 offset:17408
    ds_read_b128 a[8:11], v3 offset:18432
    v_cvt_pk_bf16_f32 v77, v154, v155
    v_cvt_pk_bf16_f32 v78, v156, v157
    v_cvt_pk_bf16_f32 v79, v158, v159
    v_mfma_f32_32x32x16_bf16 v[32:47], a[12:15], v[84:87], v[32:47]
    s_waitcnt lgkmcnt(8)
    s_waitcnt lgkmcnt(2)
    v_mfma_f32_32x32x16_bf16 v[176:191], a[24:27], v[80:83], v[176:191]
    v_mfma_f32_32x32x16_bf16 v[176:191], a[28:31], v[84:87], v[176:191]
    v_mfma_f32_32x32x16_bf16 v[96:111], a[16:19], v[200:203], v[96:111]
    ds_read_b128 a[12:15], v3 offset:19456
    ds_read_b128 a[16:19], v4 offset:20480
    v_fma_f32 v32, v32, v12, v13
    v_fma_f32 v33, v33, v12, v13
    v_fma_f32 v34, v34, v12, v13
    v_fma_f32 v35, v35, v12, v13
    v_mfma_f32_32x32x16_bf16 v[112:127], a[20:23], v[200:203], v[112:127]
    v_fma_f32 v36, v36, v12, v13
    v_fma_f32 v37, v37, v12, v13
    v_fma_f32 v38, v38, v12, v13
    v_fma_f32 v39, v39, v12, v13
    v_fma_f32 v40, v40, v12, v13
    v_fma_f32 v41, v41, v12, v13
    v_mfma_f32_32x32x16_bf16 v[128:143], a[0:3], v[200:203], v[128:143]
    s_waitcnt lgkmcnt(3)
    ds_read_b128 a[20:23], v4 offset:21504
    ds_read_b128 a[0:3], v3 offset:20480
    v_fma_f32 v42, v42, v12, v13
    v_fma_f32 v43, v43, v12, v13
    v_fma_f32 v44, v44, v12, v13
    v_fma_f32 v45, v45, v12, v13
    v_mfma_f32_32x32x16_bf16 v[96:111], a[4:7], v[204:207], v[96:111]
    s_waitcnt lgkmcnt(4)
    v_fma_f32 v46, v46, v12, v13
    v_fma_f32 v47, v47, v12, v13
    v_cvt_pk_bf16_f32 v80, v32, v33
    v_cvt_pk_bf16_f32 v81, v34, v35
    v_cvt_pk_bf16_f32 v82, v36, v37
    v_mfma_f32_32x32x16_bf16 v[112:127], a[8:11], v[204:207], v[112:127]
    s_waitcnt lgkmcnt(3)
    ds_read_b128 a[4:7], v3 offset:21504
    ds_read_b128 a[8:11], v3 offset:22528
    v_cvt_pk_bf16_f32 v83, v38, v39
    v_cvt_pk_bf16_f32 v84, v40, v41
    v_cvt_pk_bf16_f32 v85, v42, v43
    v_mfma_f32_32x32x16_bf16 v[128:143], a[12:15], v[204:207], v[128:143]
    s_waitcnt lgkmcnt(4)
    s_waitcnt vmcnt(6)
    v_cvt_pk_bf16_f32 v86, v44, v45
    v_cvt_pk_bf16_f32 v87, v46, v47
    v_mfma_f32_32x32x16_bf16 v[144:159], a[16:19], v[88:91], 0
    s_waitcnt lgkmcnt(3)
    ds_read_b128 a[12:15], v3 offset:23552
    ds_read_b128 a[16:19], v3 offset:24576
    v_mfma_f32_32x32x16_bf16 v[144:159], a[20:23], v[92:95], v[144:159]
    s_waitcnt lgkmcnt(4)
    ds_read_b128 v[200:203], v5 offset:320
    v_mfma_f32_32x32x16_bf16 v[96:111], a[24:27], a[224:227], v[96:111]
    ds_read_b128 v[204:207], v5 offset:336
    v_mfma_f32_32x32x16_bf16 v[96:111], a[28:31], a[228:231], v[96:111]
    ds_read_b128 v[192:195], v5 offset:256
    v_mfma_f32_32x32x16_bf16 v[112:127], a[24:27], a[232:235], v[112:127]
    ds_read_b128 v[196:199], v5 offset:272
    v_mfma_f32_32x32x16_bf16 v[112:127], a[28:31], a[236:239], v[112:127]
    v_mfma_f32_32x32x16_bf16 v[128:143], a[24:27], a[240:243], v[128:143]
    v_mfma_f32_32x32x16_bf16 v[128:143], a[28:31], a[244:247], v[128:143]
    v_mfma_f32_32x32x16_bf16 v[96:111], a[0:3], v[208:211], v[96:111]
    s_waitcnt lgkmcnt(7)
    ds_read_b128 a[20:23], v3 offset:25600
    ds_read_b128 a[0:3], v3 offset:26624
    v_mfma_f32_32x32x16_bf16 v[112:127], a[4:7], v[208:211], v[112:127]
    s_waitcnt lgkmcnt(8)
    v_mfma_f32_32x32x16_bf16 v[128:143], a[8:11], v[208:211], v[128:143]
    s_waitcnt lgkmcnt(7)
    ds_read_b128 a[4:7], v3 offset:27648
    ds_read_b128 a[8:11], v3 offset:28672
    v_mfma_f32_32x32x16_bf16 v[96:111], a[12:15], v[212:215], v[96:111]
    s_waitcnt lgkmcnt(8)
    v_mfma_f32_32x32x16_bf16 v[112:127], a[16:19], v[212:215], v[112:127]
    s_waitcnt lgkmcnt(3)
    ds_read_b128 a[12:15], v3 offset:29696
    ds_read_b128 a[16:19], v3 offset:30720
    v_mfma_f32_32x32x16_bf16 v[128:143], a[20:23], v[212:215], v[128:143]
    s_waitcnt lgkmcnt(4)
    v_mfma_f32_32x32x16_bf16 v[192:207], a[24:27], v[88:91], v[192:207]
    v_mfma_f32_32x32x16_bf16 v[192:207], a[28:31], v[92:95], v[192:207]
    v_mfma_f32_32x32x16_bf16 v[96:111], a[0:3], v[216:219], v[96:111]
    s_waitcnt lgkmcnt(3)
    ds_read_b128 a[20:23], v3 offset:31744
    ds_read_b128 a[0:3], v2 offset:0
    v_fma_f32 v144, v144, v12, v13
    v_fma_f32 v145, v145, v12, v13
    v_fma_f32 v146, v146, v12, v13
    v_fma_f32 v147, v147, v12, v13
    v_mfma_f32_32x32x16_bf16 v[112:127], a[4:7], v[216:219], v[112:127]
    s_waitcnt lgkmcnt(4)
    v_fma_f32 v148, v148, v12, v13
    v_fma_f32 v149, v149, v12, v13
    v_fma_f32 v150, v150, v12, v13
    v_fma_f32 v151, v151, v12, v13
    v_fma_f32 v152, v152, v12, v13
    v_fma_f32 v153, v153, v12, v13
    v_mfma_f32_32x32x16_bf16 v[128:143], a[8:11], v[216:219], v[128:143]
    s_waitcnt lgkmcnt(3)
    ds_read_b128 a[4:7], v2 offset:1024
    ds_read_b128 a[8:11], v2 offset:2048
    v_fma_f32 v154, v154, v12, v13
    v_fma_f32 v155, v155, v12, v13
    v_fma_f32 v156, v156, v12, v13
    v_fma_f32 v157, v157, v12, v13
    v_mfma_f32_32x32x16_bf16 v[96:111], a[12:15], v[220:223], v[96:111]
    s_waitcnt lgkmcnt(4)
    v_fma_f32 v158, v158, v12, v13
    v_fma_f32 v159, v159, v12, v13
    v_cvt_pk_bf16_f32 v88, v144, v145
    v_cvt_pk_bf16_f32 v89, v146, v147
    v_cvt_pk_bf16_f32 v90, v148, v149
    v_mfma_f32_32x32x16_bf16 v[112:127], a[16:19], v[220:223], v[112:127]
    s_waitcnt lgkmcnt(3)
    ds_read_b128 a[12:15], v2 offset:3072
    ds_read_b128 a[16:19], v2 offset:4096
    v_cvt_pk_bf16_f32 v91, v150, v151
    v_cvt_pk_bf16_f32 v92, v152, v153
    v_cvt_pk_bf16_f32 v93, v154, v155
    v_mfma_f32_32x32x16_bf16 v[128:143], a[20:23], v[220:223], v[128:143]
    s_waitcnt lgkmcnt(4)
    v_cvt_pk_bf16_f32 v94, v156, v157
    v_cvt_pk_bf16_f32 v95, v158, v159
    v_mfma_f32_32x32x16_bf16 v[16:31], a[0:3], v[72:75], 0
    s_waitcnt lgkmcnt(3)
    ds_read_b128 a[20:23], v2 offset:5120
    ds_read_b128 a[0:3], v3 offset:32768
    v_mfma_f32_32x32x16_bf16 v[16:31], a[4:7], v[76:79], v[16:31]
    s_waitcnt lgkmcnt(4)
    v_mfma_f32_32x32x16_bf16 v[16:31], a[8:11], v[80:83], v[16:31]
    s_waitcnt lgkmcnt(3)
    ds_read_b128 a[4:7], v3 offset:33792
    ds_read_b128 a[8:11], v3 offset:34816
    v_mfma_f32_32x32x16_bf16 v[16:31], a[12:15], v[84:87], v[16:31]
    s_waitcnt lgkmcnt(4)
    v_mfma_f32_32x32x16_bf16 v[16:31], a[16:19], v[88:91], v[16:31]
    s_waitcnt lgkmcnt(3)
    ds_read_b128 a[12:15], v3 offset:35840
    ds_read_b128 a[16:19], v3 offset:36864
    v_mfma_f32_32x32x16_bf16 v[16:31], a[20:23], v[92:95], v[16:31]
    s_waitcnt lgkmcnt(4)
    v_mfma_f32_32x32x16_bf16 v[96:111], a[0:3], v[224:227], v[96:111]
    s_waitcnt lgkmcnt(3)
    ds_read_b128 a[20:23], v3 offset:37888
    ds_read_b128 a[0:3], v3 offset:38912
    v_mfma_f32_32x32x16_bf16 v[112:127], a[4:7], v[224:227], v[112:127]
    s_waitcnt lgkmcnt(4)
    v_mfma_f32_32x32x16_bf16 v[128:143], a[8:11], v[224:227], v[128:143]
    s_waitcnt lgkmcnt(3)
    ds_read_b128 a[4:7], v3 offset:39936
    ds_read_b128 a[8:11], v3 offset:40960
    v_mfma_f32_32x32x16_bf16 v[96:111], a[12:15], v[228:231], v[96:111]
    s_waitcnt lgkmcnt(4)
    v_mfma_f32_32x32x16_bf16 v[112:127], a[16:19], v[228:231], v[112:127]
    s_waitcnt lgkmcnt(3)
    ds_read_b128 a[12:15], v3 offset:41984
    ds_read_b128 a[16:19], v3 offset:43008
    v_mfma_f32_32x32x16_bf16 v[128:143], a[20:23], v[228:231], v[128:143]
    s_waitcnt lgkmcnt(4)
    v_mfma_f32_32x32x16_bf16 v[96:111], a[0:3], v[232:235], v[96:111]
    s_waitcnt lgkmcnt(3)
    ds_read_b128 a[20:23], v3 offset:44032
    ds_read_b128 a[0:3], v2 offset:6144
    v_fma_f32 v48, v16, v16, s52
    v_fma_f32 v49, v17, v17, s52
    v_fma_f32 v50, v18, v18, s52
    v_fma_f32 v51, v19, v19, s52
    v_mfma_f32_32x32x16_bf16 v[112:127], a[4:7], v[232:235], v[112:127]
    s_waitcnt lgkmcnt(4)
    v_fma_f32 v52, v20, v20, s52
    v_fma_f32 v53, v21, v21, s52
    v_fma_f32 v54, v22, v22, s52
    v_fma_f32 v55, v23, v23, s52
    v_fma_f32 v56, v24, v24, s52
    v_fma_f32 v57, v25, v25, s52
    v_mfma_f32_32x32x16_bf16 v[128:143], a[8:11], v[232:235], v[128:143]
    s_waitcnt lgkmcnt(3)
    ds_read_b128 a[4:7], v2 offset:7168
    ds_read_b128 a[8:11], v2 offset:8192
    v_fma_f32 v58, v26, v26, s52
    v_fma_f32 v59, v27, v27, s52
    v_fma_f32 v60, v28, v28, s52
    v_fma_f32 v61, v29, v29, s52
    v_mfma_f32_32x32x16_bf16 v[96:111], a[12:15], v[236:239], v[96:111]
    s_waitcnt lgkmcnt(4)
    v_fma_f32 v62, v30, v30, s52
    v_fma_f32 v63, v31, v31, s52
    v_mul_f32_e64 v48, -v48, v16
    v_mul_f32_e64 v49, -v49, v17
    v_mul_f32_e64 v50, -v50, v18
    v_mul_f32_e64 v51, -v51, v19
    v_mfma_f32_32x32x16_bf16 v[112:127], a[16:19], v[236:239], v[112:127]
    s_waitcnt lgkmcnt(3)
    ds_read_b128 a[12:15], v2 offset:9216
    ds_read_b128 a[16:19], v2 offset:10240
    v_mul_f32_e64 v52, -v52, v20
    v_mul_f32_e64 v53, -v53, v21
    v_mul_f32_e64 v54, -v54, v22
    v_mul_f32_e64 v55, -v55, v23
    v_mfma_f32_32x32x16_bf16 v[128:143], a[20:23], v[236:239], v[128:143]
    s_waitcnt lgkmcnt(4)
    v_mul_f32_e64 v56, -v56, v24
    v_mul_f32_e64 v57, -v57, v25
    v_mul_f32_e64 v58, -v58, v26
    v_mul_f32_e64 v59, -v59, v27
    v_mul_f32_e64 v60, -v60, v28
    v_mul_f32_e64 v61, -v61, v29
    v_mul_f32_e64 v62, -v62, v30
    v_mul_f32_e64 v63, -v63, v31
    v_mfma_f32_32x32x16_bf16 v[32:47], a[0:3], v[72:75], 0
    s_waitcnt lgkmcnt(3)
    ds_read_b128 a[20:23], v2 offset:11264
    ds_read_b128 a[0:3], v3 offset:45056
    v_exp_f32 v48, v48
    v_exp_f32 v49, v49
    v_mfma_f32_32x32x16_bf16 v[32:47], a[4:7], v[76:79], v[32:47]
    s_waitcnt lgkmcnt(4)
    v_exp_f32 v50, v50
    v_exp_f32 v51, v51
    v_exp_f32 v52, v52
    v_mfma_f32_32x32x16_bf16 v[32:47], a[8:11], v[80:83], v[32:47]
    s_waitcnt lgkmcnt(3)
    ds_read_b128 a[4:7], v3 offset:46080
    ds_read_b128 a[8:11], v3 offset:47104
    v_exp_f32 v53, v53
    v_exp_f32 v54, v54
    v_mfma_f32_32x32x16_bf16 v[32:47], a[12:15], v[84:87], v[32:47]
    s_waitcnt lgkmcnt(4)
    v_exp_f32 v55, v55
    v_exp_f32 v56, v56
    v_exp_f32 v57, v57
    v_mfma_f32_32x32x16_bf16 v[32:47], a[16:19], v[88:91], v[32:47]
    s_waitcnt lgkmcnt(3)
    ds_read_b128 a[12:15], v3 offset:48128
    ds_read_b128 a[16:19], v3 offset:49152
    v_exp_f32 v58, v58
    v_exp_f32 v59, v59
    v_mfma_f32_32x32x16_bf16 v[32:47], a[20:23], v[92:95], v[32:47]
    s_waitcnt lgkmcnt(4)
    v_exp_f32 v60, v60
    v_exp_f32 v61, v61
    v_exp_f32 v62, v62
    v_mfma_f32_32x32x16_bf16 v[96:111], a[0:3], v[240:243], v[96:111]
    s_waitcnt lgkmcnt(3)
    ds_read_b128 a[20:23], v3 offset:50176
    ds_read_b128 a[0:3], v3 offset:51200
    v_exp_f32 v63, v63
    v_add_f32 v48, 1.0, v48
    v_add_f32 v49, 1.0, v49
    v_mfma_f32_32x32x16_bf16 v[112:127], a[4:7], v[240:243], v[112:127]
    s_waitcnt lgkmcnt(4)
    v_add_f32 v50, 1.0, v50
    v_add_f32 v51, 1.0, v51
    v_add_f32 v52, 1.0, v52
    v_add_f32 v53, 1.0, v53
    v_add_f32 v54, 1.0, v54
    v_add_f32 v55, 1.0, v55
    v_mfma_f32_32x32x16_bf16 v[128:143], a[8:11], v[240:243], v[128:143]
    s_waitcnt lgkmcnt(3)
    ds_read_b128 a[4:7], v3 offset:52224
    ds_read_b128 a[8:11], v3 offset:53248
    v_add_f32 v56, 1.0, v56
    v_add_f32 v57, 1.0, v57
    v_add_f32 v58, 1.0, v58
    v_mfma_f32_32x32x16_bf16 v[96:111], a[12:15], v[244:247], v[96:111]
    s_waitcnt lgkmcnt(4)
    v_add_f32 v59, 1.0, v59
    v_add_f32 v60, 1.0, v60
    v_add_f32 v61, 1.0, v61
    v_add_f32 v62, 1.0, v62
    v_add_f32 v63, 1.0, v63
    v_mfma_f32_32x32x16_bf16 v[112:127], a[16:19], v[244:247], v[112:127]
    s_waitcnt lgkmcnt(3)
    ds_read_b128 a[12:15], v3 offset:54272
    ds_read_b128 a[16:19], v3 offset:55296
    v_mfma_f32_32x32x16_bf16 v[128:143], a[20:23], v[244:247], v[128:143]
    s_waitcnt lgkmcnt(4)
    v_mfma_f32_32x32x16_bf16 v[96:111], a[0:3], v[248:251], v[96:111]
    s_waitcnt lgkmcnt(3)
    ds_read_b128 a[20:23], v3 offset:56320
    ds_read_b128 a[0:3], v2 offset:12288
    v_rcp_f32 v48, v48
    v_rcp_f32 v49, v49
    v_mfma_f32_32x32x16_bf16 v[112:127], a[4:7], v[248:251], v[112:127]
    s_waitcnt lgkmcnt(4)
    v_rcp_f32 v50, v50
    v_rcp_f32 v51, v51
    v_rcp_f32 v52, v52
    v_mfma_f32_32x32x16_bf16 v[128:143], a[8:11], v[248:251], v[128:143]
    s_waitcnt lgkmcnt(3)
    ds_read_b128 a[4:7], v2 offset:13312
    ds_read_b128 a[8:11], v2 offset:14336
    v_rcp_f32 v53, v53
    v_rcp_f32 v54, v54
    v_mfma_f32_32x32x16_bf16 v[96:111], a[12:15], v[252:255], v[96:111]
    s_waitcnt lgkmcnt(4)
    v_rcp_f32 v55, v55
    v_rcp_f32 v56, v56
    v_rcp_f32 v57, v57
    v_mfma_f32_32x32x16_bf16 v[112:127], a[16:19], v[252:255], v[112:127]
    s_waitcnt lgkmcnt(3)
    ds_read_b128 a[12:15], v2 offset:15360
    ds_read_b128 a[16:19], v2 offset:16384
    v_rcp_f32 v58, v58
    v_rcp_f32 v59, v59
    v_mfma_f32_32x32x16_bf16 v[128:143], a[20:23], v[252:255], v[128:143]
    s_waitcnt lgkmcnt(4)
    v_rcp_f32 v60, v60
    v_rcp_f32 v61, v61
    v_rcp_f32 v62, v62
    v_rcp_f32_e64 v63, v63
    v_pk_mul_f32 v[16:17], v[16:17], v[48:49]
    v_pk_mul_f32 v[18:19], v[18:19], v[50:51]
    v_pk_mul_f32 v[20:21], v[20:21], v[52:53]
    v_pk_mul_f32 v[22:23], v[22:23], v[54:55]
    v_pk_mul_f32 v[24:25], v[24:25], v[56:57]
    v_pk_mul_f32 v[26:27], v[26:27], v[58:59]
    v_pk_mul_f32 v[28:29], v[28:29], v[60:61]
    v_pk_mul_f32 v[30:31], v[30:31], v[62:63]
    v_pk_fma_f32 v[48:49], v[32:33], v[32:33], s[52:53]
    v_pk_fma_f32 v[50:51], v[34:35], v[34:35], s[52:53]
    v_pk_fma_f32 v[52:53], v[36:37], v[36:37], s[52:53]
    v_pk_fma_f32 v[54:55], v[38:39], v[38:39], s[52:53]
    v_pk_fma_f32 v[56:57], v[40:41], v[40:41], s[52:53]
    v_pk_fma_f32 v[58:59], v[42:43], v[42:43], s[52:53]
    v_pk_fma_f32 v[60:61], v[44:45], v[44:45], s[52:53]
    v_pk_fma_f32 v[62:63], v[46:47], v[46:47], s[52:53]
    v_pk_mul_f32 v[48:49], v[48:49], v[32:33] neg_lo:[1,0] neg_hi:[1,0]
    v_pk_mul_f32 v[50:51], v[50:51], v[34:35] neg_lo:[1,0] neg_hi:[1,0]
    v_pk_mul_f32 v[52:53], v[52:53], v[36:37] neg_lo:[1,0] neg_hi:[1,0]
    v_pk_mul_f32 v[54:55], v[54:55], v[38:39] neg_lo:[1,0] neg_hi:[1,0]
    v_pk_mul_f32 v[56:57], v[56:57], v[40:41] neg_lo:[1,0] neg_hi:[1,0]
    v_pk_mul_f32 v[58:59], v[58:59], v[42:43] neg_lo:[1,0] neg_hi:[1,0]
    v_pk_mul_f32 v[60:61], v[60:61], v[44:45] neg_lo:[1,0] neg_hi:[1,0]
    v_pk_mul_f32 v[62:63], v[62:63], v[46:47] neg_lo:[1,0] neg_hi:[1,0]
    v_mfma_f32_32x32x16_bf16 v[144:159], a[0:3], v[72:75], 0
    s_waitcnt lgkmcnt(3)
    ds_read_b128 a[20:23], v2 offset:17408
    ds_read_b128 a[0:3], v3 offset:8192
    v_exp_f32 v48, v48
    v_exp_f32 v49, v49
    v_mfma_f32_32x32x16_bf16 v[144:159], a[4:7], v[76:79], v[144:159]
    s_waitcnt lgkmcnt(4)
    v_exp_f32 v50, v50
    v_exp_f32 v51, v51
    v_exp_f32 v52, v52
    v_mfma_f32_32x32x16_bf16 v[144:159], a[8:11], v[80:83], v[144:159]
    s_waitcnt lgkmcnt(3)
    ds_read_b128 a[4:7], v3 offset:9216
    ds_read_b128 a[8:11], v3 offset:10240
    v_exp_f32 v53, v53
    v_exp_f32 v54, v54
    v_mfma_f32_32x32x16_bf16 v[144:159], a[12:15], v[84:87], v[144:159]
    s_waitcnt lgkmcnt(4)
    v_exp_f32 v55, v55
    v_exp_f32 v56, v56
    v_exp_f32 v57, v57
    v_mfma_f32_32x32x16_bf16 v[144:159], a[16:19], v[88:91], v[144:159]
    s_waitcnt lgkmcnt(3)
    ds_read_b128 a[12:15], v3 offset:11264
    ds_read_b128 a[16:19], v3 offset:12288
    v_exp_f32 v58, v58
    v_exp_f32 v59, v59
    v_mfma_f32_32x32x16_bf16 v[144:159], a[20:23], v[92:95], v[144:159]
    s_waitcnt lgkmcnt(4)
    v_cvt_pk_bf16_f32 v64, v16, v17
    v_cvt_pk_bf16_f32 v65, v18, v19
    v_cvt_pk_bf16_f32 v66, v20, v21
    v_cvt_pk_bf16_f32 v67, v22, v23
    v_cvt_pk_bf16_f32 v68, v24, v25
    v_cvt_pk_bf16_f32 v69, v26, v27
    v_cvt_pk_bf16_f32 v70, v28, v29
    v_cvt_pk_bf16_f32 v71, v30, v31
    v_exp_f32 v60, v60
    v_exp_f32 v61, v61
    v_exp_f32 v62, v62
    v_exp_f32 v63, v63
    v_pk_add_f32 v[48:49], v[48:49], 1.0 op_sel_hi:[1,0]
    v_pk_add_f32 v[50:51], v[50:51], 1.0 op_sel_hi:[1,0]
    v_pk_add_f32 v[52:53], v[52:53], 1.0 op_sel_hi:[1,0]
    v_pk_add_f32 v[54:55], v[54:55], 1.0 op_sel_hi:[1,0]
    v_pk_add_f32 v[56:57], v[56:57], 1.0 op_sel_hi:[1,0]
    v_pk_add_f32 v[58:59], v[58:59], 1.0 op_sel_hi:[1,0]
    v_pk_add_f32 v[60:61], v[60:61], 1.0 op_sel_hi:[1,0]
    v_pk_add_f32 v[62:63], v[62:63], 1.0 op_sel_hi:[1,0]
    v_mfma_f32_32x32x16_bf16 v[160:175], a[0:3], v[64:67], v[160:175]
    s_waitcnt lgkmcnt(3)
    ds_read_b128 a[20:23], v3 offset:13312
    ds_read_b128 a[0:3], v2 offset:18432
    v_rcp_f32 v48, v48
    v_rcp_f32 v49, v49
    v_mfma_f32_32x32x16_bf16 v[176:191], a[4:7], v[64:67], v[176:191]
    s_waitcnt lgkmcnt(4)
    v_rcp_f32 v50, v50
    v_rcp_f32 v51, v51
    v_rcp_f32 v52, v52
    v_mfma_f32_32x32x16_bf16 v[192:207], a[8:11], v[64:67], v[192:207]
    s_waitcnt lgkmcnt(3)
    ds_read_b128 a[4:7], v2 offset:19456
    ds_read_b128 a[8:11], v2 offset:20480
    v_rcp_f32 v53, v53
    v_rcp_f32 v54, v54
    v_mfma_f32_32x32x16_bf16 v[160:175], a[12:15], v[68:71], v[160:175]
    s_waitcnt lgkmcnt(4)
    v_rcp_f32 v55, v55
    v_rcp_f32 v56, v56
    v_rcp_f32 v57, v57
    v_mfma_f32_32x32x16_bf16 v[176:191], a[16:19], v[68:71], v[176:191]
    s_waitcnt lgkmcnt(3)
    ds_read_b128 a[12:15], v2 offset:21504
    ds_read_b128 a[16:19], v2 offset:22528
    v_rcp_f32 v58, v58
    v_rcp_f32 v59, v59
    v_mfma_f32_32x32x16_bf16 v[192:207], a[20:23], v[68:71], v[192:207]
    s_waitcnt lgkmcnt(4)
    v_cvt_pk_bf16_f32 v96, v96, v97
    v_cvt_pk_bf16_f32 v97, v98, v99
    v_cvt_pk_bf16_f32 v98, v100, v101
    v_cvt_pk_bf16_f32 v99, v102, v103
    v_cvt_pk_bf16_f32 v100, v104, v105
    v_cvt_pk_bf16_f32 v101, v106, v107
    v_cvt_pk_bf16_f32 v102, v108, v109
    v_cvt_pk_bf16_f32 v103, v110, v111
    v_permlane16_swap_b32 v96, v100
    v_permlane16_swap_b32 v97, v101
    v_permlane16_swap_b32 v98, v102
    v_permlane16_swap_b32 v99, v103
    v_rcp_f32 v60, v60
    v_rcp_f32 v61, v61
    v_rcp_f32 v62, v62
    v_rcp_f32 v63, v63
    v_pk_mul_f32 v[32:33], v[32:33], v[48:49]
    v_pk_mul_f32 v[34:35], v[34:35], v[50:51]
    v_pk_mul_f32 v[36:37], v[36:37], v[52:53]
    v_pk_mul_f32 v[38:39], v[38:39], v[54:55]
    v_pk_mul_f32 v[40:41], v[40:41], v[56:57]
    v_pk_mul_f32 v[42:43], v[42:43], v[58:59]
    v_pk_mul_f32 v[44:45], v[44:45], v[60:61]
    v_pk_mul_f32 v[46:47], v[46:47], v[62:63]
    v_pk_fma_f32 v[48:49], v[144:145], v[144:145], s[52:53]
    v_pk_fma_f32 v[50:51], v[146:147], v[146:147], s[52:53]
    v_pk_fma_f32 v[52:53], v[148:149], v[148:149], s[52:53]
    v_pk_fma_f32 v[54:55], v[150:151], v[150:151], s[52:53]
    v_pk_fma_f32 v[56:57], v[152:153], v[152:153], s[52:53]
    v_pk_fma_f32 v[58:59], v[154:155], v[154:155], s[52:53]
    v_pk_fma_f32 v[60:61], v[156:157], v[156:157], s[52:53]
    v_pk_fma_f32 v[62:63], v[158:159], v[158:159], s[52:53]
    v_pk_mul_f32 v[48:49], v[48:49], v[144:145] neg_lo:[1,0] neg_hi:[1,0]
    v_pk_mul_f32 v[50:51], v[50:51], v[146:147] neg_lo:[1,0] neg_hi:[1,0]
    v_pk_mul_f32 v[52:53], v[52:53], v[148:149] neg_lo:[1,0] neg_hi:[1,0]
    v_pk_mul_f32 v[54:55], v[54:55], v[150:151] neg_lo:[1,0] neg_hi:[1,0]
    v_pk_mul_f32 v[56:57], v[56:57], v[152:153] neg_lo:[1,0] neg_hi:[1,0]
    v_pk_mul_f32 v[58:59], v[58:59], v[154:155] neg_lo:[1,0] neg_hi:[1,0]
    v_pk_mul_f32 v[60:61], v[60:61], v[156:157] neg_lo:[1,0] neg_hi:[1,0]
    v_pk_mul_f32 v[62:63], v[62:63], v[158:159] neg_lo:[1,0] neg_hi:[1,0]
    v_mfma_f32_32x32x16_bf16 v[16:31], a[0:3], v[72:75], 0
    s_waitcnt lgkmcnt(3)
    ds_read_b128 a[20:23], v2 offset:23552
    ds_read_b128 a[0:3], v3 offset:14336
    v_exp_f32 v48, v48
    v_exp_f32 v49, v49
    v_mfma_f32_32x32x16_bf16 v[16:31], a[4:7], v[76:79], v[16:31]
    s_waitcnt lgkmcnt(4)
    s_add_u32 s54, s56, 49152
    buffer_load_dwordx4 v[208:211], v1, s[24:27], s54 offen offset:0
    buffer_load_dwordx4 v[212:215], v1, s[24:27], s54 offen offset:32
    v_exp_f32 v50, v50
    v_cvt_pk_bf16_f32 v112, v112, v113
    v_mfma_f32_32x32x16_bf16 v[16:31], a[8:11], v[80:83], v[16:31]
    s_waitcnt lgkmcnt(3)
    ds_read_b128 a[4:7], v3 offset:15360
    ds_read_b128 a[8:11], v3 offset:16384
    v_exp_f32 v51, v51
    v_exp_f32 v52, v52
    v_mfma_f32_32x32x16_bf16 v[16:31], a[12:15], v[84:87], v[16:31]
    s_waitcnt lgkmcnt(4)
    v_exp_f32 v53, v53
    v_exp_f32 v54, v54
    v_exp_f32 v55, v55
    v_mfma_f32_32x32x16_bf16 v[16:31], a[16:19], v[88:91], v[16:31]
    s_waitcnt lgkmcnt(3)
    ds_read_b128 a[12:15], v3 offset:17408
    ds_read_b128 a[16:19], v3 offset:18432
    v_exp_f32 v56, v56
    v_exp_f32 v57, v57
    v_mfma_f32_32x32x16_bf16 v[16:31], a[20:23], v[92:95], v[16:31]
    s_waitcnt lgkmcnt(4)
    v_cvt_pk_bf16_f32 v113, v114, v115
    v_cvt_pk_bf16_f32 v114, v116, v117
    v_cvt_pk_bf16_f32 v115, v118, v119
    v_cvt_pk_bf16_f32 v116, v120, v121
    v_cvt_pk_bf16_f32 v117, v122, v123
    v_cvt_pk_bf16_f32 v118, v124, v125
    v_cvt_pk_bf16_f32 v119, v126, v127
    v_permlane16_swap_b32 v112, v116
    v_permlane16_swap_b32 v113, v117
    v_permlane16_swap_b32 v114, v118
    v_permlane16_swap_b32 v115, v119
    v_cvt_pk_bf16_f32 v64, v32, v33
    v_cvt_pk_bf16_f32 v65, v34, v35
    v_cvt_pk_bf16_f32 v66, v36, v37
    v_cvt_pk_bf16_f32 v67, v38, v39
    v_cvt_pk_bf16_f32 v68, v40, v41
    v_cvt_pk_bf16_f32 v69, v42, v43
    v_cvt_pk_bf16_f32 v70, v44, v45
    v_cvt_pk_bf16_f32 v71, v46, v47
    v_exp_f32 v58, v58
    v_exp_f32 v59, v59
    v_exp_f32 v60, v60
    v_exp_f32 v61, v61
    v_exp_f32 v62, v62
    v_exp_f32 v63, v63
    v_pk_add_f32 v[48:49], v[48:49], 1.0 op_sel_hi:[1,0]
    v_pk_add_f32 v[50:51], v[50:51], 1.0 op_sel_hi:[1,0]
    v_pk_add_f32 v[52:53], v[52:53], 1.0 op_sel_hi:[1,0]
    v_pk_add_f32 v[54:55], v[54:55], 1.0 op_sel_hi:[1,0]
    v_pk_add_f32 v[56:57], v[56:57], 1.0 op_sel_hi:[1,0]
    v_pk_add_f32 v[58:59], v[58:59], 1.0 op_sel_hi:[1,0]
    v_pk_add_f32 v[60:61], v[60:61], 1.0 op_sel_hi:[1,0]
    v_pk_add_f32 v[62:63], v[62:63], 1.0 op_sel_hi:[1,0]
    v_mfma_f32_32x32x16_bf16 v[160:175], a[0:3], v[64:67], v[160:175]
    s_waitcnt lgkmcnt(3)
    ds_read_b128 a[20:23], v3 offset:19456
    ds_read_b128 a[0:3], v2 offset:24576
    v_rcp_f32 v48, v48
    v_rcp_f32 v49, v49
    v_mfma_f32_32x32x16_bf16 v[176:191], a[4:7], v[64:67], v[176:191]
    s_waitcnt lgkmcnt(4)
    v_rcp_f32 v50, v50
    v_rcp_f32 v51, v51
    v_rcp_f32 v52, v52
    v_mfma_f32_32x32x16_bf16 v[192:207], a[8:11], v[64:67], v[192:207]
    s_waitcnt lgkmcnt(3)
    ds_read_b128 a[4:7], v2 offset:25600
    ds_read_b128 a[8:11], v2 offset:26624
    v_rcp_f32 v53, v53
    v_rcp_f32 v54, v54
    v_mfma_f32_32x32x16_bf16 v[160:175], a[12:15], v[68:71], v[160:175]
    s_waitcnt lgkmcnt(4)
    v_rcp_f32 v55, v55
    v_rcp_f32 v56, v56
    v_rcp_f32 v57, v57
    v_mfma_f32_32x32x16_bf16 v[176:191], a[16:19], v[68:71], v[176:191]
    s_waitcnt lgkmcnt(3)
    ds_read_b128 a[12:15], v2 offset:27648
    ds_read_b128 a[16:19], v2 offset:28672
    v_rcp_f32 v58, v58
    v_rcp_f32 v59, v59
    v_mfma_f32_32x32x16_bf16 v[192:207], a[20:23], v[68:71], v[192:207]
    s_waitcnt lgkmcnt(4)
    v_cvt_pk_bf16_f32 v128, v128, v129
    v_cvt_pk_bf16_f32 v129, v130, v131
    v_cvt_pk_bf16_f32 v130, v132, v133
    v_cvt_pk_bf16_f32 v131, v134, v135
    v_cvt_pk_bf16_f32 v132, v136, v137
    v_cvt_pk_bf16_f32 v133, v138, v139
    v_cvt_pk_bf16_f32 v134, v140, v141
    v_cvt_pk_bf16_f32 v135, v142, v143
    v_permlane16_swap_b32 v128, v132
    v_permlane16_swap_b32 v129, v133
    v_permlane16_swap_b32 v130, v134
    v_permlane16_swap_b32 v131, v135
    v_rcp_f32 v60, v60
    v_rcp_f32 v61, v61
    v_rcp_f32 v62, v62
    v_rcp_f32 v63, v63
    v_pk_mul_f32 v[144:145], v[144:145], v[48:49]
    v_pk_mul_f32 v[146:147], v[146:147], v[50:51]
    v_pk_mul_f32 v[148:149], v[148:149], v[52:53]
    v_pk_mul_f32 v[150:151], v[150:151], v[54:55]
    v_pk_mul_f32 v[152:153], v[152:153], v[56:57]
    v_pk_mul_f32 v[154:155], v[154:155], v[58:59]
    v_pk_mul_f32 v[156:157], v[156:157], v[60:61]
    v_pk_mul_f32 v[158:159], v[158:159], v[62:63]
    v_pk_fma_f32 v[48:49], v[16:17], v[16:17], s[52:53]
    v_pk_fma_f32 v[50:51], v[18:19], v[18:19], s[52:53]
    v_pk_fma_f32 v[52:53], v[20:21], v[20:21], s[52:53]
    v_pk_fma_f32 v[54:55], v[22:23], v[22:23], s[52:53]
    v_pk_fma_f32 v[56:57], v[24:25], v[24:25], s[52:53]
    v_pk_fma_f32 v[58:59], v[26:27], v[26:27], s[52:53]
    v_pk_fma_f32 v[60:61], v[28:29], v[28:29], s[52:53]
    v_pk_fma_f32 v[62:63], v[30:31], v[30:31], s[52:53]
    v_pk_mul_f32 v[48:49], v[48:49], v[16:17] neg_lo:[1,0] neg_hi:[1,0]
    v_pk_mul_f32 v[50:51], v[50:51], v[18:19] neg_lo:[1,0] neg_hi:[1,0]
    v_pk_mul_f32 v[52:53], v[52:53], v[20:21] neg_lo:[1,0] neg_hi:[1,0]
    v_pk_mul_f32 v[54:55], v[54:55], v[22:23] neg_lo:[1,0] neg_hi:[1,0]
    v_pk_mul_f32 v[56:57], v[56:57], v[24:25] neg_lo:[1,0] neg_hi:[1,0]
    v_pk_mul_f32 v[58:59], v[58:59], v[26:27] neg_lo:[1,0] neg_hi:[1,0]
    v_pk_mul_f32 v[60:61], v[60:61], v[28:29] neg_lo:[1,0] neg_hi:[1,0]
    v_pk_mul_f32 v[62:63], v[62:63], v[30:31] neg_lo:[1,0] neg_hi:[1,0]
L_pf14:
    v_mfma_f32_32x32x16_bf16 v[32:47], a[0:3], v[72:75], 0
    s_waitcnt lgkmcnt(3)
    ds_read_b128 a[20:23], v2 offset:29696
    ds_read_b128 a[0:3], v3 offset:20480
    v_exp_f32 v48, v48
    v_exp_f32 v49, v49
    v_mfma_f32_32x32x16_bf16 v[32:47], a[4:7], v[76:79], v[32:47]
    s_waitcnt lgkmcnt(4)
    buffer_load_dwordx4 v[216:219], v1, s[24:27], s54 offen offset:64
    buffer_load_dwordx4 v[220:223], v1, s[24:27], s54 offen offset:96
    s_mov_b32 s63, L_pf14-L_pc+12288
    v_exp_f32 v50, v50
    v_cvt_pk_bf16_f32 v64, v144, v145
    v_mfma_f32_32x32x16_bf16 v[32:47], a[8:11], v[80:83], v[32:47]
    s_waitcnt lgkmcnt(3)
    ds_read_b128 a[4:7], v3 offset:21504
    ds_read_b128 a[8:11], v3 offset:22528
    v_exp_f32 v51, v51
    v_exp_f32 v52, v52
    v_mfma_f32_32x32x16_bf16 v[32:47], a[12:15], v[84:87], v[32:47]
    s_waitcnt lgkmcnt(4)
    buffer_load_dword v6, v7, s[68:71], s63 offen
    v_exp_f32 v53, v53
    v_exp_f32 v54, v54
    v_cvt_pk_bf16_f32 v65, v146, v147
    v_mfma_f32_32x32x16_bf16 v[32:47], a[16:19], v[88:91], v[32:47]
    s_waitcnt lgkmcnt(3)
    ds_read_b128 a[12:15], v3 offset:23552
    ds_read_b128 a[16:19], v3 offset:24576
    v_exp_f32 v55, v55
    v_exp_f32_e64 v56, v56
    v_mfma_f32_32x32x16_bf16 v[32:47], a[20:23], v[92:95], v[32:47]
    s_waitcnt lgkmcnt(4)
    v_cvt_pk_bf16_f32 v66, v148, v149
    v_cvt_pk_bf16_f32 v67, v150, v151
    v_cvt_pk_bf16_f32 v68, v152, v153
    v_cvt_pk_bf16_f32 v69, v154, v155
    v_cvt_pk_bf16_f32 v70, v156, v157
    v_cvt_pk_bf16_f32 v71, v158, v159
    v_exp_f32 v57, v57
    v_exp_f32 v58, v58
    v_exp_f32 v59, v59
    v_exp_f32 v60, v60
    v_exp_f32 v61, v61
    v_exp_f32 v62, v62
    v_exp_f32_e64 v63, v63
    v_pk_add_f32 v[48:49], v[48:49], 1.0 op_sel_hi:[1,0]
    v_pk_add_f32 v[50:51], v[50:51], 1.0 op_sel_hi:[1,0]
    v_pk_add_f32 v[52:53], v[52:53], 1.0 op_sel_hi:[1,0]
    v_pk_add_f32 v[54:55], v[54:55], 1.0 op_sel_hi:[1,0]
    v_pk_add_f32 v[56:57], v[56:57], 1.0 op_sel_hi:[1,0]
    v_pk_add_f32 v[58:59], v[58:59], 1.0 op_sel_hi:[1,0]
    v_pk_add_f32 v[60:61], v[60:61], 1.0 op_sel_hi:[1,0]
    v_pk_add_f32 v[62:63], v[62:63], 1.0 op_sel_hi:[1,0]
    v_mfma_f32_32x32x16_bf16 v[160:175], a[0:3], v[64:67], v[160:175]
    s_waitcnt lgkmcnt(3)
    ds_read_b128 a[20:23], v3 offset:25600
    ds_read_b128 a[0:3], v2 offset:30720
    v_rcp_f32 v48, v48
    v_rcp_f32 v49, v49
    v_mfma_f32_32x32x16_bf16 v[176:191], a[4:7], v[64:67], v[176:191]
    s_waitcnt lgkmcnt(4)
    v_rcp_f32 v50, v50
    v_rcp_f32 v51, v51
    v_rcp_f32 v52, v52
    v_mfma_f32_32x32x16_bf16 v[192:207], a[8:11], v[64:67], v[192:207]
    s_waitcnt lgkmcnt(3)
    ds_read_b128 a[4:7], v2 offset:31744
    ds_read_b128 a[8:11], v2 offset:32768
    v_rcp_f32 v53, v53
    v_rcp_f32 v54, v54
    v_mfma_f32_32x32x16_bf16 v[160:175], a[12:15], v[68:71], v[160:175]
    s_waitcnt lgkmcnt(4)
    v_rcp_f32 v55, v55
    v_rcp_f32 v56, v56
    v_rcp_f32 v57, v57
    v_mfma_f32_32x32x16_bf16 v[176:191], a[16:19], v[68:71], v[176:191]
    s_waitcnt lgkmcnt(3)
    ds_read_b128 a[12:15], v2 offset:33792
    ds_read_b128 a[16:19], v2 offset:34816
    v_rcp_f32 v58, v58
    v_rcp_f32 v59, v59
    v_mfma_f32_32x32x16_bf16 v[192:207], a[20:23], v[68:71], v[192:207]
    s_waitcnt lgkmcnt(4)
    v_rcp_f32 v60, v60
    v_rcp_f32 v61, v61
    v_rcp_f32 v62, v62
    v_rcp_f32 v63, v63
    v_pk_mul_f32 v[16:17], v[16:17], v[48:49]
    v_pk_mul_f32 v[18:19], v[18:19], v[50:51]
    v_pk_mul_f32 v[20:21], v[20:21], v[52:53]
    v_pk_mul_f32 v[22:23], v[22:23], v[54:55]
    v_pk_mul_f32 v[24:25], v[24:25], v[56:57]
    v_pk_mul_f32 v[26:27], v[26:27], v[58:59]
    v_pk_mul_f32 v[28:29], v[28:29], v[60:61]
    v_pk_mul_f32 v[30:31], v[30:31], v[62:63]
    v_pk_fma_f32 v[48:49], v[32:33], v[32:33], s[52:53]
    v_pk_fma_f32 v[50:51], v[34:35], v[34:35], s[52:53]
    v_pk_fma_f32 v[52:53], v[36:37], v[36:37], s[52:53]
    v_pk_fma_f32 v[54:55], v[38:39], v[38:39], s[52:53]
    v_pk_fma_f32 v[56:57], v[40:41], v[40:41], s[52:53]
    v_pk_fma_f32 v[58:59], v[42:43], v[42:43], s[52:53]
    v_pk_fma_f32 v[60:61], v[44:45], v[44:45], s[52:53]
    v_pk_fma_f32 v[62:63], v[46:47], v[46:47], s[52:53]
    v_pk_mul_f32 v[48:49], v[48:49], v[32:33] neg_lo:[1,0] neg_hi:[1,0]
    v_pk_mul_f32 v[50:51], v[50:51], v[34:35] neg_lo:[1,0] neg_hi:[1,0]
    v_pk_mul_f32 v[52:53], v[52:53], v[36:37] neg_lo:[1,0] neg_hi:[1,0]
    v_pk_mul_f32 v[54:55], v[54:55], v[38:39] neg_lo:[1,0] neg_hi:[1,0]
    v_pk_mul_f32 v[56:57], v[56:57], v[40:41] neg_lo:[1,0] neg_hi:[1,0]
    v_pk_mul_f32 v[58:59], v[58:59], v[42:43] neg_lo:[1,0] neg_hi:[1,0]
    v_pk_mul_f32 v[60:61], v[60:61], v[44:45] neg_lo:[1,0] neg_hi:[1,0]
    v_pk_mul_f32 v[62:63], v[62:63], v[46:47] neg_lo:[1,0] neg_hi:[1,0]
    v_mfma_f32_32x32x16_bf16 v[144:159], a[0:3], v[72:75], 0
    s_waitcnt lgkmcnt(3)
    ds_read_b128 a[20:23], v2 offset:35840
    ds_read_b128 a[0:3], v3 offset:26624
    v_exp_f32 v48, v48
    v_exp_f32 v49, v49
    v_mfma_f32_32x32x16_bf16 v[144:159], a[4:7], v[76:79], v[144:159]
    s_waitcnt lgkmcnt(4)
    v_exp_f32 v50, v50
    v_exp_f32 v51, v51
    v_exp_f32 v52, v52
    v_mfma_f32_32x32x16_bf16 v[144:159], a[8:11], v[80:83], v[144:159]
    s_waitcnt lgkmcnt(3)
    ds_read_b128 a[4:7], v3 offset:27648
    ds_read_b128 a[8:11], v3 offset:28672
    v_exp_f32 v53, v53
    v_exp_f32 v54, v54
    v_mfma_f32_32x32x16_bf16 v[144:159], a[12:15], v[84:87], v[144:159]
    s_waitcnt lgkmcnt(4)
    v_exp_f32 v55, v55
    v_exp_f32 v56, v56
    v_exp_f32 v57, v57
    v_mfma_f32_32x32x16_bf16 v[144:159], a[16:19], v[88:91], v[144:159]
    s_waitcnt lgkmcnt(3)
    ds_read_b128 a[12:15], v3 offset:29696
    ds_read_b128 a[16:19], v3 offset:30720
    v_exp_f32 v58, v58
    v_exp_f32 v59, v59
    v_mfma_f32_32x32x16_bf16 v[144:159], a[20:23], v[92:95], v[144:159]
    s_waitcnt lgkmcnt(4)
    v_cvt_pk_bf16_f32 v64, v16, v17
    v_cvt_pk_bf16_f32 v65, v18, v19
    v_cvt_pk_bf16_f32 v66, v20, v21
    v_cvt_pk_bf16_f32 v67, v22, v23
    v_cvt_pk_bf16_f32 v68, v24, v25
    v_cvt_pk_bf16_f32 v69, v26, v27
    v_cvt_pk_bf16_f32 v70, v28, v29
    v_cvt_pk_bf16_f32 v71, v30, v31
    v_exp_f32 v60, v60
    v_exp_f32 v61, v61
    v_exp_f32 v62, v62
    v_exp_f32 v63, v63
    v_pk_add_f32 v[48:49], v[48:49], 1.0 op_sel_hi:[1,0]
    v_pk_add_f32 v[50:51], v[50:51], 1.0 op_sel_hi:[1,0]
    v_pk_add_f32 v[52:53], v[52:53], 1.0 op_sel_hi:[1,0]
    v_pk_add_f32 v[54:55], v[54:55], 1.0 op_sel_hi:[1,0]
    v_pk_add_f32 v[56:57], v[56:57], 1.0 op_sel_hi:[1,0]
    v_pk_add_f32 v[58:59], v[58:59], 1.0 op_sel_hi:[1,0]
    v_pk_add_f32 v[60:61], v[60:61], 1.0 op_sel_hi:[1,0]
    v_pk_add_f32 v[62:63], v[62:63], 1.0 op_sel_hi:[1,0]
    v_mfma_f32_32x32x16_bf16 v[160:175], a[0:3], v[64:67], v[160:175]
    s_waitcnt lgkmcnt(3)
    ds_read_b128 a[20:23], v3 offset:31744
    ds_read_b128 a[0:3], v2 offset:36864
    v_rcp_f32 v48, v48
    v_rcp_f32 v49, v49
    v_mfma_f32_32x32x16_bf16 v[176:191], a[4:7], v[64:67], v[176:191]
    s_waitcnt lgkmcnt(4)
    buffer_load_dwordx4 v[224:227], v1, s[24:27], s54 offen offset:128
    buffer_load_dwordx4 v[228:231], v1, s[24:27], s54 offen offset:160
    v_rcp_f32 v50, v50
    v_rcp_f32 v51, v51
    v_mfma_f32_32x32x16_bf16 v[192:207], a[8:11], v[64:67], v[192:207]
    s_waitcnt lgkmcnt(3)
    ds_read_b128 a[4:7], v2 offset:37888
    ds_read_b128 a[8:11], v2 offset:38912
    v_rcp_f32 v52, v52
    v_rcp_f32 v53, v53
    v_mfma_f32_32x32x16_bf16 v[160:175], a[12:15], v[68:71], v[160:175]
    s_waitcnt lgkmcnt(4)
    v_rcp_f32 v54, v54
    v_rcp_f32 v55, v55
    v_rcp_f32 v56, v56
    v_mfma_f32_32x32x16_bf16 v[176:191], a[16:19], v[68:71], v[176:191]
    s_waitcnt lgkmcnt(3)
    ds_read_b128 a[12:15], v2 offset:39936
    ds_read_b128 a[16:19], v2 offset:40960
    v_rcp_f32 v57, v57
    v_rcp_f32 v58, v58
    v_mfma_f32_32x32x16_bf16 v[192:207], a[20:23], v[68:71], v[192:207]
    s_waitcnt lgkmcnt(4)
    v_rcp_f32 v59, v59
    v_rcp_f32 v60, v60
    v_rcp_f32 v61, v61
    v_rcp_f32 v62, v62
    v_rcp_f32 v63, v63
    v_pk_mul_f32 v[32:33], v[32:33], v[48:49]
    v_pk_mul_f32 v[34:35], v[34:35], v[50:51]
    v_pk_mul_f32 v[36:37], v[36:37], v[52:53]
    v_pk_mul_f32 v[38:39], v[38:39], v[54:55]
    v_pk_mul_f32 v[40:41], v[40:41], v[56:57]
    v_pk_mul_f32 v[42:43], v[42:43], v[58:59]
    v_pk_mul_f32 v[44:45], v[44:45], v[60:61]
    v_pk_mul_f32 v[46:47], v[46:47], v[62:63]
    v_pk_fma_f32 v[48:49], v[144:145], v[144:145], s[52:53]
    v_pk_fma_f32 v[50:51], v[146:147], v[146:147], s[52:53]
    v_pk_fma_f32 v[52:53], v[148:149], v[148:149], s[52:53]
    v_pk_fma_f32 v[54:55], v[150:151], v[150:151], s[52:53]
    v_pk_fma_f32 v[56:57], v[152:153], v[152:153], s[52:53]
    v_pk_fma_f32 v[58:59], v[154:155], v[154:155], s[52:53]
    v_pk_fma_f32 v[60:61], v[156:157], v[156:157], s[52:53]
    v_pk_fma_f32 v[62:63], v[158:159], v[158:159], s[52:53]
    v_pk_mul_f32 v[48:49], v[48:49], v[144:145] neg_lo:[1,0] neg_hi:[1,0]
    v_pk_mul_f32 v[50:51], v[50:51], v[146:147] neg_lo:[1,0] neg_hi:[1,0]
    v_pk_mul_f32 v[52:53], v[52:53], v[148:149] neg_lo:[1,0] neg_hi:[1,0]
    v_pk_mul_f32 v[54:55], v[54:55], v[150:151] neg_lo:[1,0] neg_hi:[1,0]
    v_pk_mul_f32 v[56:57], v[56:57], v[152:153] neg_lo:[1,0] neg_hi:[1,0]
    v_pk_mul_f32 v[58:59], v[58:59], v[154:155] neg_lo:[1,0] neg_hi:[1,0]
    v_pk_mul_f32 v[60:61], v[60:61], v[156:157] neg_lo:[1,0] neg_hi:[1,0]
    v_pk_mul_f32 v[62:63], v[62:63], v[158:159] neg_lo:[1,0] neg_hi:[1,0]
    v_mfma_f32_32x32x16_bf16 v[16:31], a[0:3], v[72:75], 0
    s_waitcnt lgkmcnt(3)
    ds_read_b128 a[20:23], v2 offset:41984
    ds_read_b128 a[0:3], v3 offset:32768
    v_exp_f32 v48, v48
    v_exp_f32 v49, v49
    v_mfma_f32_32x32x16_bf16 v[16:31], a[4:7], v[76:79], v[16:31]
    s_waitcnt lgkmcnt(4)
    s_add_u32 s55, s56, 147456
    buffer_store_dwordx4 v[96:99], v9, s[28:31], s55 offen offset:0 sc1
    buffer_store_dwordx4 v[112:115], v9, s[28:31], s55 offen offset:64 sc1
    buffer_store_dwordx4 v[128:131], v9, s[28:31], s55 offen offset:128 sc1
    v_exp_f32 v50, v50
    v_mfma_f32_32x32x16_bf16 v[16:31], a[8:11], v[80:83], v[16:31]
    s_waitcnt lgkmcnt(3)
    ds_read_b128 a[4:7], v3 offset:33792
    ds_read_b128 a[8:11], v3 offset:34816
    v_exp_f32 v51, v51
    v_exp_f32 v52, v52
    v_mfma_f32_32x32x16_bf16 v[16:31], a[12:15], v[84:87], v[16:31]
    s_waitcnt lgkmcnt(4)
    v_exp_f32 v53, v53
    v_exp_f32 v54, v54
    v_exp_f32 v55, v55
    v_mfma_f32_32x32x16_bf16 v[16:31], a[16:19], v[88:91], v[16:31]
    s_waitcnt lgkmcnt(3)
    ds_read_b128 a[12:15], v3 offset:35840
    ds_read_b128 a[16:19], v3 offset:36864
    v_exp_f32 v56, v56
    v_exp_f32 v57, v57
    v_mfma_f32_32x32x16_bf16 v[16:31], a[20:23], v[92:95], v[16:31]
    s_waitcnt lgkmcnt(4)
    v_cvt_pk_bf16_f32 v64, v32, v33
    v_cvt_pk_bf16_f32 v65, v34, v35
    v_cvt_pk_bf16_f32 v66, v36, v37
    v_cvt_pk_bf16_f32 v67, v38, v39
    v_cvt_pk_bf16_f32 v68, v40, v41
    v_cvt_pk_bf16_f32 v69, v42, v43
    v_cvt_pk_bf16_f32 v70, v44, v45
    v_cvt_pk_bf16_f32 v71, v46, v47
    v_exp_f32 v58, v58
    v_exp_f32 v59, v59
    v_exp_f32 v60, v60
    v_exp_f32 v61, v61
    v_exp_f32 v62, v62
    v_exp_f32 v63, v63
    v_pk_add_f32 v[48:49], v[48:49], 1.0 op_sel_hi:[1,0]
    v_pk_add_f32 v[50:51], v[50:51], 1.0 op_sel_hi:[1,0]
    v_pk_add_f32 v[52:53], v[52:53], 1.0 op_sel_hi:[1,0]
    v_pk_add_f32 v[54:55], v[54:55], 1.0 op_sel_hi:[1,0]
    v_pk_add_f32 v[56:57], v[56:57], 1.0 op_sel_hi:[1,0]
    v_pk_add_f32 v[58:59], v[58:59], 1.0 op_sel_hi:[1,0]
    v_pk_add_f32 v[60:61], v[60:61], 1.0 op_sel_hi:[1,0]
    v_pk_add_f32 v[62:63], v[62:63], 1.0 op_sel_hi:[1,0]
    v_mfma_f32_32x32x16_bf16 v[160:175], a[0:3], v[64:67], v[160:175]
    s_waitcnt lgkmcnt(3)
    ds_read_b128 a[20:23], v3 offset:37888
    ds_read_b128 a[0:3], v2 offset:43008
    v_rcp_f32 v48, v48
    v_rcp_f32 v49, v49
    v_mfma_f32_32x32x16_bf16 v[176:191], a[4:7], v[64:67], v[176:191]
    s_waitcnt lgkmcnt(4)
    v_rcp_f32 v50, v50
    v_rcp_f32 v51, v51
    v_rcp_f32 v52, v52
    v_mfma_f32_32x32x16_bf16 v[192:207], a[8:11], v[64:67], v[192:207]
    s_waitcnt lgkmcnt(3)
    ds_read_b128 a[4:7], v2 offset:44032
    ds_read_b128 a[8:11], v2 offset:45056
    v_rcp_f32 v53, v53
    v_rcp_f32 v54, v54
    v_mfma_f32_32x32x16_bf16 v[160:175], a[12:15], v[68:71], v[160:175]
    s_waitcnt lgkmcnt(4)
    v_rcp_f32 v55, v55
    v_rcp_f32 v56, v56
    v_rcp_f32 v57, v57
    v_mfma_f32_32x32x16_bf16 v[176:191], a[16:19], v[68:71], v[176:191]
    s_waitcnt lgkmcnt(3)
    ds_read_b128 a[12:15], v2 offset:46080
    ds_read_b128 a[16:19], v2 offset:47104
    v_rcp_f32 v58, v58
    v_rcp_f32 v59, v59
    v_mfma_f32_32x32x16_bf16 v[192:207], a[20:23], v[68:71], v[192:207]
    s_waitcnt lgkmcnt(4)
    v_rcp_f32 v60, v60
    v_rcp_f32 v61, v61
    v_rcp_f32 v62, v62
    v_rcp_f32 v63, v63
    v_pk_mul_f32 v[144:145], v[144:145], v[48:49]
    v_pk_mul_f32 v[146:147], v[146:147], v[50:51]
    v_pk_mul_f32 v[148:149], v[148:149], v[52:53]
    v_pk_mul_f32 v[150:151], v[150:151], v[54:55]
    v_pk_mul_f32 v[152:153], v[152:153], v[56:57]
    v_pk_mul_f32 v[154:155], v[154:155], v[58:59]
    v_pk_mul_f32 v[156:157], v[156:157], v[60:61]
    v_pk_mul_f32 v[158:159], v[158:159], v[62:63]
    v_pk_fma_f32 v[48:49], v[16:17], v[16:17], s[52:53]
    v_pk_fma_f32 v[50:51], v[18:19], v[18:19], s[52:53]
    v_pk_fma_f32 v[52:53], v[20:21], v[20:21], s[52:53]
    v_pk_fma_f32 v[54:55], v[22:23], v[22:23], s[52:53]
    v_pk_fma_f32 v[56:57], v[24:25], v[24:25], s[52:53]
    v_pk_fma_f32 v[58:59], v[26:27], v[26:27], s[52:53]
    v_pk_fma_f32 v[60:61], v[28:29], v[28:29], s[52:53]
    v_pk_fma_f32 v[62:63], v[30:31], v[30:31], s[52:53]
    v_pk_mul_f32 v[48:49], v[48:49], v[16:17] neg_lo:[1,0] neg_hi:[1,0]
    v_pk_mul_f32 v[50:51], v[50:51], v[18:19] neg_lo:[1,0] neg_hi:[1,0]
    v_pk_mul_f32 v[52:53], v[52:53], v[20:21] neg_lo:[1,0] neg_hi:[1,0]
    v_pk_mul_f32 v[54:55], v[54:55], v[22:23] neg_lo:[1,0] neg_hi:[1,0]
    v_pk_mul_f32 v[56:57], v[56:57], v[24:25] neg_lo:[1,0] neg_hi:[1,0]
    v_pk_mul_f32 v[58:59], v[58:59], v[26:27] neg_lo:[1,0] neg_hi:[1,0]
    v_pk_mul_f32 v[60:61], v[60:61], v[28:29] neg_lo:[1,0] neg_hi:[1,0]
    v_pk_mul_f32 v[62:63], v[62:63], v[30:31] neg_lo:[1,0] neg_hi:[1,0]
    v_mfma_f32_32x32x16_bf16 v[32:47], a[0:3], v[72:75], 0
    s_waitcnt lgkmcnt(3)
    ds_read_b128 a[20:23], v2 offset:48128
    ds_read_b128 a[0:3], v3 offset:38912
    v_exp_f32 v48, v48
    v_exp_f32 v49, v49
    v_mfma_f32_32x32x16_bf16 v[32:47], a[4:7], v[76:79], v[32:47]
    s_waitcnt lgkmcnt(4)
    v_exp_f32 v50, v50
    v_exp_f32 v51, v51
    v_exp_f32 v52, v52
    v_mfma_f32_32x32x16_bf16 v[32:47], a[8:11], v[80:83], v[32:47]
    s_waitcnt lgkmcnt(3)
    ds_read_b128 a[4:7], v3 offset:39936
    ds_read_b128 a[8:11], v3 offset:40960
    v_exp_f32 v53, v53
    v_exp_f32 v54, v54
    v_mfma_f32_32x32x16_bf16 v[32:47], a[12:15], v[84:87], v[32:47]
    s_waitcnt lgkmcnt(4)
    v_exp_f32 v55, v55
    v_exp_f32 v56, v56
    v_exp_f32 v57, v57
    v_mfma_f32_32x32x16_bf16 v[32:47], a[16:19], v[88:91], v[32:47]
    s_waitcnt lgkmcnt(3)
    ds_read_b128 a[12:15], v3 offset:41984
    ds_read_b128 a[16:19], v3 offset:43008
    v_exp_f32 v58, v58
    v_exp_f32 v59, v59
    v_mfma_f32_32x32x16_bf16 v[32:47], a[20:23], v[92:95], v[32:47]
    s_waitcnt lgkmcnt(4)
    v_cvt_pk_bf16_f32 v64, v144, v145
    v_cvt_pk_bf16_f32 v65, v146, v147
    v_cvt_pk_bf16_f32 v66, v148, v149
    v_cvt_pk_bf16_f32 v67, v150, v151
    v_cvt_pk_bf16_f32 v68, v152, v153
    v_cvt_pk_bf16_f32 v69, v154, v155
    v_cvt_pk_bf16_f32 v70, v156, v157
    v_cvt_pk_bf16_f32 v71, v158, v159
    v_exp_f32 v60, v60
    v_exp_f32 v61, v61
    v_exp_f32 v62, v62
    v_exp_f32 v63, v63
    v_pk_add_f32 v[48:49], v[48:49], 1.0 op_sel_hi:[1,0]
    v_pk_add_f32 v[50:51], v[50:51], 1.0 op_sel_hi:[1,0]
    v_pk_add_f32 v[52:53], v[52:53], 1.0 op_sel_hi:[1,0]
    v_pk_add_f32 v[54:55], v[54:55], 1.0 op_sel_hi:[1,0]
    v_pk_add_f32 v[56:57], v[56:57], 1.0 op_sel_hi:[1,0]
    v_pk_add_f32 v[58:59], v[58:59], 1.0 op_sel_hi:[1,0]
    v_pk_add_f32 v[60:61], v[60:61], 1.0 op_sel_hi:[1,0]
    v_pk_add_f32 v[62:63], v[62:63], 1.0 op_sel_hi:[1,0]
    v_mfma_f32_32x32x16_bf16 v[160:175], a[0:3], v[64:67], v[160:175]
    s_waitcnt lgkmcnt(3)
    ds_read_b128 a[20:23], v3 offset:44032
    ds_read_b128 a[0:3], v2 offset:49152
    v_rcp_f32 v48, v48
    v_rcp_f32 v49, v49
    v_mfma_f32_32x32x16_bf16 v[176:191], a[4:7], v[64:67], v[176:191]
    s_waitcnt lgkmcnt(4)
    s_add_u32 s54, s56, 122880
    buffer_load_dwordx4 v[232:235], v1, s[24:27], s54 offen offset:0
    buffer_load_dwordx4 v[236:239], v1, s[24:27], s54 offen offset:32
    v_rcp_f32 v50, v50
    v_rcp_f32 v51, v51
    v_mfma_f32_32x32x16_bf16 v[192:207], a[8:11], v[64:67], v[192:207]
    s_waitcnt lgkmcnt(3)
    ds_read_b128 a[4:7], v2 offset:50176
    ds_read_b128 a[8:11], v2 offset:51200
    v_rcp_f32 v52, v52
    v_rcp_f32 v53, v53
    v_mfma_f32_32x32x16_bf16 v[160:175], a[12:15], v[68:71], v[160:175]
    s_waitcnt lgkmcnt(4)
    v_rcp_f32 v54, v54
    v_rcp_f32 v55, v55
    v_rcp_f32 v56, v56
    v_mfma_f32_32x32x16_bf16 v[176:191], a[16:19], v[68:71], v[176:191]
    s_waitcnt lgkmcnt(3)
    ds_read_b128 a[12:15], v2 offset:52224
    ds_read_b128 a[16:19], v2 offset:53248
    v_rcp_f32 v57, v57
    v_rcp_f32 v58, v58
    v_mfma_f32_32x32x16_bf16 v[192:207], a[20:23], v[68:71], v[192:207]
    s_waitcnt lgkmcnt(4)
    v_rcp_f32 v59, v59
    v_rcp_f32 v60, v60
    v_rcp_f32 v61, v61
    v_rcp_f32 v62, v62
    v_rcp_f32 v63, v63
    v_pk_mul_f32 v[16:17], v[16:17], v[48:49]
    v_pk_mul_f32 v[18:19], v[18:19], v[50:51]
    v_pk_mul_f32 v[20:21], v[20:21], v[52:53]
    v_pk_mul_f32 v[22:23], v[22:23], v[54:55]
    v_pk_mul_f32 v[24:25], v[24:25], v[56:57]
    v_pk_mul_f32 v[26:27], v[26:27], v[58:59]
    v_pk_mul_f32 v[28:29], v[28:29], v[60:61]
    v_pk_mul_f32 v[30:31], v[30:31], v[62:63]
    v_pk_fma_f32 v[48:49], v[32:33], v[32:33], s[52:53]
    v_pk_fma_f32 v[50:51], v[34:35], v[34:35], s[52:53]
    v_pk_fma_f32 v[52:53], v[36:37], v[36:37], s[52:53]
    v_pk_fma_f32 v[54:55], v[38:39], v[38:39], s[52:53]
    v_pk_fma_f32 v[56:57], v[40:41], v[40:41], s[52:53]
    v_pk_fma_f32 v[58:59], v[42:43], v[42:43], s[52:53]
    v_pk_fma_f32 v[60:61], v[44:45], v[44:45], s[52:53]
    v_pk_fma_f32 v[62:63], v[46:47], v[46:47], s[52:53]
    v_pk_mul_f32 v[48:49], v[48:49], v[32:33] neg_lo:[1,0] neg_hi:[1,0]
    v_pk_mul_f32 v[50:51], v[50:51], v[34:35] neg_lo:[1,0] neg_hi:[1,0]
    v_pk_mul_f32 v[52:53], v[52:53], v[36:37] neg_lo:[1,0] neg_hi:[1,0]
    v_pk_mul_f32 v[54:55], v[54:55], v[38:39] neg_lo:[1,0] neg_hi:[1,0]
    v_pk_mul_f32 v[56:57], v[56:57], v[40:41] neg_lo:[1,0] neg_hi:[1,0]
    v_pk_mul_f32 v[58:59], v[58:59], v[42:43] neg_lo:[1,0] neg_hi:[1,0]
    v_pk_mul_f32 v[60:61], v[60:61], v[44:45] neg_lo:[1,0] neg_hi:[1,0]
    v_pk_mul_f32 v[62:63], v[62:63], v[46:47] neg_lo:[1,0] neg_hi:[1,0]
    v_mfma_f32_32x32x16_bf16 v[144:159], a[0:3], v[72:75], 0
    s_waitcnt lgkmcnt(3)
    ds_read_b128 a[20:23], v2 offset:54272
    ds_read_b128 a[0:3], v3 offset:45056
    v_exp_f32 v48, v48
    v_exp_f32 v49, v49
    v_mfma_f32_32x32x16_bf16 v[144:159], a[4:7], v[76:79], v[144:159]
    s_waitcnt lgkmcnt(4)
    v_exp_f32 v50, v50
    v_exp_f32 v51, v51
    v_exp_f32 v52, v52
    v_mfma_f32_32x32x16_bf16 v[144:159], a[8:11], v[80:83], v[144:159]
    s_waitcnt lgkmcnt(3)
    ds_read_b128 a[4:7], v3 offset:46080
    ds_read_b128 a[8:11], v3 offset:47104
    v_exp_f32 v53, v53
    v_exp_f32 v54, v54
    v_mfma_f32_32x32x16_bf16 v[144:159], a[12:15], v[84:87], v[144:159]
    s_waitcnt lgkmcnt(4)
    v_exp_f32 v55, v55
    v_exp_f32 v56, v56
    v_exp_f32 v57, v57
    v_mfma_f32_32x32x16_bf16 v[144:159], a[16:19], v[88:91], v[144:159]
    s_waitcnt lgkmcnt(3)
    ds_read_b128 a[12:15], v3 offset:48128
    ds_read_b128 a[16:19], v3 offset:49152
    v_exp_f32 v58, v58
    v_exp_f32 v59, v59
    v_mfma_f32_32x32x16_bf16 v[144:159], a[20:23], v[92:95], v[144:159]
    s_waitcnt lgkmcnt(4)
    v_cvt_pk_bf16_f32 v64, v16, v17
    v_cvt_pk_bf16_f32 v65, v18, v19
    v_cvt_pk_bf16_f32 v66, v20, v21
    v_cvt_pk_bf16_f32 v67, v22, v23
    v_cvt_pk_bf16_f32 v68, v24, v25
    v_cvt_pk_bf16_f32 v69, v26, v27
    v_cvt_pk_bf16_f32 v70, v28, v29
    v_cvt_pk_bf16_f32 v71, v30, v31
    v_exp_f32 v60, v60
    v_exp_f32 v61, v61
    v_exp_f32 v62, v62
    v_exp_f32 v63, v63
    v_pk_add_f32 v[48:49], v[48:49], 1.0 op_sel_hi:[1,0]
    v_pk_add_f32 v[50:51], v[50:51], 1.0 op_sel_hi:[1,0]
    v_pk_add_f32 v[52:53], v[52:53], 1.0 op_sel_hi:[1,0]
    v_pk_add_f32 v[54:55], v[54:55], 1.0 op_sel_hi:[1,0]
    v_pk_add_f32 v[56:57], v[56:57], 1.0 op_sel_hi:[1,0]
    v_pk_add_f32 v[58:59], v[58:59], 1.0 op_sel_hi:[1,0]
    v_pk_add_f32 v[60:61], v[60:61], 1.0 op_sel_hi:[1,0]
    v_pk_add_f32 v[62:63], v[62:63], 1.0 op_sel_hi:[1,0]
    v_mfma_f32_32x32x16_bf16 v[160:175], a[0:3], v[64:67], v[160:175]
    s_waitcnt lgkmcnt(3)
    ds_read_b128 a[20:23], v3 offset:50176
    ds_read_b128 a[0:3], v2 offset:55296
    v_rcp_f32 v48, v48
    v_rcp_f32 v49, v49
    v_mfma_f32_32x32x16_bf16 v[176:191], a[4:7], v[64:67], v[176:191]
    s_waitcnt lgkmcnt(4)
    v_rcp_f32 v50, v50
    v_rcp_f32 v51, v51
    v_rcp_f32 v52, v52
    v_mfma_f32_32x32x16_bf16 v[192:207], a[8:11], v[64:67], v[192:207]
    s_waitcnt lgkmcnt(3)
    ds_read_b128 a[4:7], v2 offset:56320
    ds_read_b128 a[8:11], v2 offset:57344
    v_rcp_f32 v53, v53
    v_rcp_f32 v54, v54
    v_mfma_f32_32x32x16_bf16 v[160:175], a[12:15], v[68:71], v[160:175]
    s_waitcnt lgkmcnt(4)
    v_rcp_f32 v55, v55
    v_rcp_f32 v56, v56
    v_rcp_f32 v57, v57
    v_mfma_f32_32x32x16_bf16 v[176:191], a[16:19], v[68:71], v[176:191]
    s_waitcnt lgkmcnt(3)
    ds_read_b128 a[12:15], v2 offset:58368
    ds_read_b128 a[16:19], v2 offset:59392
    v_rcp_f32 v58, v58
    v_rcp_f32 v59, v59
    v_mfma_f32_32x32x16_bf16 v[192:207], a[20:23], v[68:71], v[192:207]
    s_waitcnt lgkmcnt(4)
    v_rcp_f32 v60, v60
    v_rcp_f32 v61, v61
    v_rcp_f32 v62, v62
    v_rcp_f32 v63, v63
    v_pk_mul_f32 v[32:33], v[32:33], v[48:49]
    v_pk_mul_f32 v[34:35], v[34:35], v[50:51]
    v_pk_mul_f32 v[36:37], v[36:37], v[52:53]
    v_pk_mul_f32 v[38:39], v[38:39], v[54:55]
    v_pk_mul_f32 v[40:41], v[40:41], v[56:57]
    v_pk_mul_f32 v[42:43], v[42:43], v[58:59]
    v_pk_mul_f32 v[44:45], v[44:45], v[60:61]
    v_pk_mul_f32 v[46:47], v[46:47], v[62:63]
    v_pk_fma_f32 v[48:49], v[144:145], v[144:145], s[52:53]
    v_pk_fma_f32 v[50:51], v[146:147], v[146:147], s[52:53]
    v_pk_fma_f32 v[52:53], v[148:149], v[148:149], s[52:53]
    v_pk_fma_f32 v[54:55], v[150:151], v[150:151], s[52:53]
    v_pk_fma_f32 v[56:57], v[152:153], v[152:153], s[52:53]
    v_pk_fma_f32 v[58:59], v[154:155], v[154:155], s[52:53]
    v_pk_fma_f32 v[60:61], v[156:157], v[156:157], s[52:53]
    v_pk_fma_f32 v[62:63], v[158:159], v[158:159], s[52:53]
    v_pk_mul_f32 v[48:49], v[48:49], v[144:145] neg_lo:[1,0] neg_hi:[1,0]
    v_pk_mul_f32 v[50:51], v[50:51], v[146:147] neg_lo:[1,0] neg_hi:[1,0]
    v_pk_mul_f32 v[52:53], v[52:53], v[148:149] neg_lo:[1,0] neg_hi:[1,0]
    v_pk_mul_f32 v[54:55], v[54:55], v[150:151] neg_lo:[1,0] neg_hi:[1,0]
    v_pk_mul_f32 v[56:57], v[56:57], v[152:153] neg_lo:[1,0] neg_hi:[1,0]
    v_pk_mul_f32 v[58:59], v[58:59], v[154:155] neg_lo:[1,0] neg_hi:[1,0]
    v_pk_mul_f32 v[60:61], v[60:61], v[156:157] neg_lo:[1,0] neg_hi:[1,0]
    v_pk_mul_f32 v[62:63], v[62:63], v[158:159] neg_lo:[1,0] neg_hi:[1,0]
    v_mfma_f32_32x32x16_bf16 v[16:31], a[0:3], v[72:75], 0
    s_waitcnt lgkmcnt(3)
    ds_read_b128 a[20:23], v2 offset:60416
    ds_read_b128 a[0:3], v3 offset:51200
    v_exp_f32 v48, v48
    v_exp_f32 v49, v49
    v_mfma_f32_32x32x16_bf16 v[16:31], a[4:7], v[76:79], v[16:31]
    s_waitcnt lgkmcnt(4)
    buffer_load_dwordx2 v[12:13], v2, s[44:47], s58 offen offset:2048
    v_exp_f32 v50, v50
    v_exp_f32 v51, v51
    v_cvt_pk_bf16_f32 v64, v32, v33
    v_mfma_f32_32x32x16_bf16 v[16:31], a[8:11], v[80:83], v[16:31]
    s_waitcnt lgkmcnt(3)
    ds_read_b128 a[4:7], v3 offset:52224
    ds_read_b128 a[8:11], v3 offset:53248
    v_exp_f32 v52, v52
    v_exp_f32 v53, v53
    v_mfma_f32_32x32x16_bf16 v[16:31], a[12:15], v[84:87], v[16:31]
    s_waitcnt lgkmcnt(4)
    buffer_load_dwordx4 v[240:243], v1, s[24:27], s54 offen offset:64
    buffer_load_dwordx4 v[244:247], v1, s[24:27], s54 offen offset:96
    v_exp_f32 v54, v54
    v_exp_f32 v55, v55
    v_mfma_f32_32x32x16_bf16 v[16:31], a[16:19], v[88:91], v[16:31]
    s_waitcnt lgkmcnt(3)
    ds_read_b128 a[12:15], v3 offset:54272
    ds_read_b128 a[16:19], v3 offset:55296
    v_exp_f32 v56, v56
    v_exp_f32 v57, v57
    v_mfma_f32_32x32x16_bf16 v[16:31], a[20:23], v[92:95], v[16:31]
    s_waitcnt lgkmcnt(4)
    v_cvt_pk_bf16_f32 v65, v34, v35
    v_cvt_pk_bf16_f32 v66, v36, v37
    v_cvt_pk_bf16_f32 v67, v38, v39
    v_cvt_pk_bf16_f32 v68, v40, v41
    v_cvt_pk_bf16_f32 v69, v42, v43
    v_cvt_pk_bf16_f32 v70, v44, v45
    v_cvt_pk_bf16_f32 v71, v46, v47
    v_exp_f32 v58, v58
    v_exp_f32 v59, v59
    v_exp_f32 v60, v60
    v_exp_f32 v61, v61
    v_exp_f32 v62, v62
    v_exp_f32 v63, v63
    v_pk_add_f32 v[48:49], v[48:49], 1.0 op_sel_hi:[1,0]
    v_pk_add_f32 v[50:51], v[50:51], 1.0 op_sel_hi:[1,0]
    v_pk_add_f32 v[52:53], v[52:53], 1.0 op_sel_hi:[1,0]
    v_pk_add_f32 v[54:55], v[54:55], 1.0 op_sel_hi:[1,0]
    v_pk_add_f32 v[56:57], v[56:57], 1.0 op_sel_hi:[1,0]
    v_pk_add_f32 v[58:59], v[58:59], 1.0 op_sel_hi:[1,0]
    v_pk_add_f32 v[60:61], v[60:61], 1.0 op_sel_hi:[1,0]
    v_pk_add_f32 v[62:63], v[62:63], 1.0 op_sel_hi:[1,0]
    v_mfma_f32_32x32x16_bf16 v[160:175], a[0:3], v[64:67], v[160:175]
    s_waitcnt lgkmcnt(3)
    ds_read_b128 a[20:23], v3 offset:56320
    ds_read_b128 a[0:3], v2 offset:61440
    v_rcp_f32 v48, v48
    v_rcp_f32 v49, v49
    v_mfma_f32_32x32x16_bf16 v[176:191], a[4:7], v[64:67], v[176:191]
    s_waitcnt lgkmcnt(4)
    buffer_store_dwordx4 v[100:103], v9, s[28:31], s55 offen offset:3072 sc1
    buffer_store_dwordx4 v[116:119], v9, s[28:31], s55 offen offset:3136 sc1
    buffer_store_dwordx4 v[132:135], v9, s[28:31], s55 offen offset:3200 sc1
    v_rcp_f32 v50, v50
    v_rcp_f32 v51, v51
    v_mfma_f32_32x32x16_bf16 v[192:207], a[8:11], v[64:67], v[192:207]
    s_waitcnt lgkmcnt(3)
    ds_read_b128 a[4:7], v2 offset:62464
    ds_read_b128 a[8:11], v2 offset:63488
    v_rcp_f32 v52, v52
    v_rcp_f32 v53, v53
    v_mfma_f32_32x32x16_bf16 v[160:175], a[12:15], v[68:71], v[160:175]
    s_waitcnt lgkmcnt(4)
    v_rcp_f32 v54, v54
    v_rcp_f32 v55, v55
    v_rcp_f32 v56, v56
    v_mfma_f32_32x32x16_bf16 v[176:191], a[16:19], v[68:71], v[176:191]
    s_waitcnt lgkmcnt(3)
    ds_read_b128 a[12:15], v2 offset:64512
    ds_read_b128 a[16:19], v3 offset:0
    v_rcp_f32 v57, v57
    v_rcp_f32 v58, v58
    v_mfma_f32_32x32x16_bf16 v[192:207], a[20:23], v[68:71], v[192:207]
    s_waitcnt lgkmcnt(4)
    v_rcp_f32 v59, v59
    v_rcp_f32 v60, v60
    v_rcp_f32 v61, v61
    v_rcp_f32 v62, v62
    v_rcp_f32 v63, v63
    v_pk_mul_f32 v[144:145], v[144:145], v[48:49]
    v_pk_mul_f32 v[146:147], v[146:147], v[50:51]
    v_pk_mul_f32 v[148:149], v[148:149], v[52:53]
    v_pk_mul_f32 v[150:151], v[150:151], v[54:55]
    v_pk_mul_f32 v[152:153], v[152:153], v[56:57]
    v_pk_mul_f32 v[154:155], v[154:155], v[58:59]
    v_pk_mul_f32 v[156:157], v[156:157], v[60:61]
    v_pk_mul_f32 v[158:159], v[158:159], v[62:63]
    v_pk_fma_f32 v[48:49], v[16:17], v[16:17], s[52:53]
    v_pk_fma_f32 v[50:51], v[18:19], v[18:19], s[52:53]
    v_pk_fma_f32 v[52:53], v[20:21], v[20:21], s[52:53]
    v_pk_fma_f32 v[54:55], v[22:23], v[22:23], s[52:53]
    v_pk_fma_f32 v[56:57], v[24:25], v[24:25], s[52:53]
    v_pk_fma_f32 v[58:59], v[26:27], v[26:27], s[52:53]
    v_pk_fma_f32 v[60:61], v[28:29], v[28:29], s[52:53]
    v_pk_fma_f32 v[62:63], v[30:31], v[30:31], s[52:53]
    v_pk_mul_f32 v[48:49], v[48:49], v[16:17] neg_lo:[1,0] neg_hi:[1,0]
    v_pk_mul_f32 v[50:51], v[50:51], v[18:19] neg_lo:[1,0] neg_hi:[1,0]
    v_pk_mul_f32 v[52:53], v[52:53], v[20:21] neg_lo:[1,0] neg_hi:[1,0]
    v_pk_mul_f32 v[54:55], v[54:55], v[22:23] neg_lo:[1,0] neg_hi:[1,0]
    v_pk_mul_f32 v[56:57], v[56:57], v[24:25] neg_lo:[1,0] neg_hi:[1,0]
    v_pk_mul_f32 v[58:59], v[58:59], v[26:27] neg_lo:[1,0] neg_hi:[1,0]
    v_pk_mul_f32 v[60:61], v[60:61], v[28:29] neg_lo:[1,0] neg_hi:[1,0]
    v_pk_mul_f32 v[62:63], v[62:63], v[30:31] neg_lo:[1,0] neg_hi:[1,0]
    v_mfma_f32_32x32x16_bf16 v[32:47], a[0:3], v[72:75], 0
    s_waitcnt lgkmcnt(3)
    ds_read_b128 a[20:23], v3 offset:1024
    ds_read_b128 a[0:3], v3 offset:2048
    v_exp_f32 v48, v48
    v_exp_f32 v49, v49
    v_mfma_f32_32x32x16_bf16 v[32:47], a[4:7], v[76:79], v[32:47]
    s_waitcnt lgkmcnt(4)
    ds_read_b128 a[224:227], v3 offset:57344
    ds_read_b128 a[228:231], v3 offset:58368
    v_exp_f32 v50, v50
    v_exp_f32 v51, v51
    v_mfma_f32_32x32x16_bf16 v[32:47], a[8:11], v[80:83], v[32:47]
    s_waitcnt lgkmcnt(5)
    ds_read_b128 a[4:7], v3 offset:3072
    ds_read_b128 a[8:11], v3 offset:4096
    v_exp_f32 v52, v52
    v_exp_f32 v53, v53
    v_mfma_f32_32x32x16_bf16 v[32:47], a[12:15], v[84:87], v[32:47]
    s_waitcnt lgkmcnt(6)
    ds_read_b128 a[232:235], v3 offset:59392
    ds_read_b128 a[236:239], v3 offset:60416
    v_exp_f32 v54, v54
    v_exp_f32 v55, v55
    v_mfma_f32_32x32x16_bf16 v[32:47], a[16:19], v[88:91], v[32:47]
    s_waitcnt lgkmcnt(7)
    ds_read_b128 a[12:15], v3 offset:5120
    ds_read_b128 a[16:19], v3 offset:6144
    v_exp_f32 v56, v56
    v_exp_f32 v57, v57
    v_mfma_f32_32x32x16_bf16 v[32:47], a[20:23], v[92:95], v[32:47]
    s_waitcnt lgkmcnt(8)
    ds_read_b128 a[240:243], v3 offset:61440
    ds_read_b128 a[244:247], v3 offset:62464
    v_cvt_pk_bf16_f32 v64, v144, v145
    v_cvt_pk_bf16_f32 v65, v146, v147
    v_cvt_pk_bf16_f32 v66, v148, v149
    v_cvt_pk_bf16_f32 v67, v150, v151
    v_exp_f32 v58, v58
    v_exp_f32 v59, v59
    v_exp_f32 v60, v60
    v_exp_f32 v61, v61
    v_exp_f32 v62, v62
    v_exp_f32 v63, v63
    v_pk_add_f32 v[48:49], v[48:49], 1.0 op_sel_hi:[1,0]
    v_pk_add_f32 v[50:51], v[50:51], 1.0 op_sel_hi:[1,0]
    v_pk_add_f32 v[52:53], v[52:53], 1.0 op_sel_hi:[1,0]
    v_pk_add_f32 v[54:55], v[54:55], 1.0 op_sel_hi:[1,0]
    v_pk_add_f32 v[56:57], v[56:57], 1.0 op_sel_hi:[1,0]
    v_pk_add_f32 v[58:59], v[58:59], 1.0 op_sel_hi:[1,0]
    v_pk_add_f32 v[60:61], v[60:61], 1.0 op_sel_hi:[1,0]
    v_pk_add_f32 v[62:63], v[62:63], 1.0 op_sel_hi:[1,0]
    s_waitcnt lgkmcnt(0)
    v_mfma_f32_32x32x16_bf16 v[160:175], a[224:227], v[64:67], v[160:175]
    buffer_load_dwordx4 v[248:251], v1, s[24:27], s54 offen offset:128
    buffer_load_dwordx4 v[252:255], v1, s[24:27], s54 offen offset:160
    v_cvt_pk_bf16_f32 v68, v152, v153
    v_cvt_pk_bf16_f32 v69, v154, v155
    v_cvt_pk_bf16_f32 v70, v156, v157
    v_cvt_pk_bf16_f32 v71, v158, v159
    v_mfma_f32_32x32x16_bf16 v[176:191], a[228:231], v[64:67], v[176:191]
    ds_read_b128 v[104:107], v5 offset:64
    v_rcp_f32 v48, v48
    v_rcp_f32 v49, v49
    v_rcp_f32 v50, v50
    v_mfma_f32_32x32x16_bf16 v[192:207], a[232:235], v[64:67], v[192:207]
    ds_read_b128 v[108:111], v5 offset:80
    v_rcp_f32 v51, v51
    v_rcp_f32 v52, v52
    v_rcp_f32 v53, v53
    v_mfma_f32_32x32x16_bf16 v[160:175], a[236:239], v[68:71], v[160:175]
    ds_read_b128 v[96:99], v5 offset:0
    v_rcp_f32 v54, v54
    v_rcp_f32 v55, v55
    v_rcp_f32 v56, v56
    v_mfma_f32_32x32x16_bf16 v[176:191], a[240:243], v[68:71], v[176:191]
    ds_read_b128 v[100:103], v5 offset:16
    v_rcp_f32 v57, v57
    v_rcp_f32 v58, v58
    v_mfma_f32_32x32x16_bf16 v[192:207], a[244:247], v[68:71], v[192:207]
    v_rcp_f32 v59, v59
    v_rcp_f32 v60, v60
    v_rcp_f32 v61, v61
    v_rcp_f32 v62, v62
    v_rcp_f32_e64 v63, v63
    v_pk_mul_f32 v[16:17], v[16:17], v[48:49]
    v_pk_mul_f32 v[18:19], v[18:19], v[50:51]
    v_pk_mul_f32 v[20:21], v[20:21], v[52:53]
    v_pk_mul_f32 v[22:23], v[22:23], v[54:55]
    v_pk_mul_f32 v[24:25], v[24:25], v[56:57]
    v_pk_mul_f32 v[26:27], v[26:27], v[58:59]
    v_pk_mul_f32 v[28:29], v[28:29], v[60:61]
    v_pk_mul_f32 v[30:31], v[30:31], v[62:63]
    v_pk_fma_f32 v[48:49], v[32:33], v[32:33], s[52:53]
    v_pk_fma_f32 v[50:51], v[34:35], v[34:35], s[52:53]
    v_pk_fma_f32 v[52:53], v[36:37], v[36:37], s[52:53]
    v_pk_fma_f32 v[54:55], v[38:39], v[38:39], s[52:53]
    v_pk_fma_f32 v[56:57], v[40:41], v[40:41], s[52:53]
    v_pk_fma_f32 v[58:59], v[42:43], v[42:43], s[52:53]
    v_pk_fma_f32 v[60:61], v[44:45], v[44:45], s[52:53]
    v_pk_fma_f32 v[62:63], v[46:47], v[46:47], s[52:53]
    v_pk_mul_f32 v[48:49], v[48:49], v[32:33] neg_lo:[1,0] neg_hi:[1,0]
    v_pk_mul_f32 v[50:51], v[50:51], v[34:35] neg_lo:[1,0] neg_hi:[1,0]
    v_pk_mul_f32 v[52:53], v[52:53], v[36:37] neg_lo:[1,0] neg_hi:[1,0]
    v_pk_mul_f32 v[54:55], v[54:55], v[38:39] neg_lo:[1,0] neg_hi:[1,0]
    v_pk_mul_f32 v[56:57], v[56:57], v[40:41] neg_lo:[1,0] neg_hi:[1,0]
    v_pk_mul_f32 v[58:59], v[58:59], v[42:43] neg_lo:[1,0] neg_hi:[1,0]
    v_pk_mul_f32 v[60:61], v[60:61], v[44:45] neg_lo:[1,0] neg_hi:[1,0]
    v_pk_mul_f32 v[62:63], v[62:63], v[46:47] neg_lo:[1,0] neg_hi:[1,0]
    v_mfma_f32_32x32x16_bf16 v[144:159], a[0:3], v[72:75], 0
    ds_read_b128 a[20:23], v3 offset:7168
    ds_read_b128 a[0:3], v3 offset:63488
    v_exp_f32 v48, v48
    v_exp_f32 v49, v49
    v_mfma_f32_32x32x16_bf16 v[144:159], a[4:7], v[76:79], v[144:159]
    ds_read_b128 v[120:123], v5 offset:192
    ds_read_b128 v[124:127], v5 offset:208
    v_exp_f32 v50, v50
    v_exp_f32 v51, v51
    v_mfma_f32_32x32x16_bf16 v[144:159], a[8:11], v[80:83], v[144:159]
    ds_read_b128 a[4:7], v3 offset:64512
    ds_read_b128 a[8:11], v4 offset:0
    v_exp_f32 v52, v52
    v_exp_f32 v53, v53
    v_mfma_f32_32x32x16_bf16 v[144:159], a[12:15], v[84:87], v[144:159]
    ds_read_b128 v[112:115], v5 offset:128
    ds_read_b128 v[116:119], v5 offset:144
    v_exp_f32 v54, v54
    v_exp_f32 v55, v55
    v_mfma_f32_32x32x16_bf16 v[144:159], a[16:19], v[88:91], v[144:159]
    s_waitcnt lgkmcnt(7)
    ds_read_b128 a[12:15], v4 offset:1024
    ds_read_b128 a[16:19], v4 offset:2048
    v_exp_f32 v56, v56
    v_exp_f32 v57, v57
    v_mfma_f32_32x32x16_bf16 v[144:159], a[20:23], v[92:95], v[144:159]
    s_waitcnt lgkmcnt(8)
    v_cvt_pk_bf16_f32 v64, v16, v17
    v_cvt_pk_bf16_f32 v65, v18, v19
    v_cvt_pk_bf16_f32 v66, v20, v21
    v_cvt_pk_bf16_f32 v67, v22, v23
    v_cvt_pk_bf16_f32 v68, v24, v25
    v_cvt_pk_bf16_f32 v69, v26, v27
    v_cvt_pk_bf16_f32 v70, v28, v29
    v_cvt_pk_bf16_f32 v71, v30, v31
    v_exp_f32 v58, v58
    v_exp_f32 v59, v59
    v_exp_f32 v60, v60
    v_exp_f32 v61, v61
    v_exp_f32 v62, v62
    v_exp_f32 v63, v63
    v_pk_add_f32 v[48:49], v[48:49], 1.0 op_sel_hi:[1,0]
    v_pk_add_f32 v[50:51], v[50:51], 1.0 op_sel_hi:[1,0]
    v_pk_add_f32 v[52:53], v[52:53], 1.0 op_sel_hi:[1,0]
    v_pk_add_f32 v[54:55], v[54:55], 1.0 op_sel_hi:[1,0]
    v_pk_add_f32 v[56:57], v[56:57], 1.0 op_sel_hi:[1,0]
    v_pk_add_f32 v[58:59], v[58:59], 1.0 op_sel_hi:[1,0]
    v_pk_add_f32 v[60:61], v[60:61], 1.0 op_sel_hi:[1,0]
    v_pk_add_f32 v[62:63], v[62:63], 1.0 op_sel_hi:[1,0]
    v_mfma_f32_32x32x16_bf16 v[160:175], a[0:3], v[64:67], v[160:175]
    s_waitcnt lgkmcnt(5)
    ds_read_b128 a[20:23], v4 offset:3072
    ds_read_b128 a[0:3], v3 offset:32768
    v_rcp_f32 v48, v48
    v_rcp_f32 v49, v49
    v_mfma_f32_32x32x16_bf16 v[176:191], a[4:7], v[64:67], v[176:191]
    s_waitcnt lgkmcnt(6)
    ds_read_b128 v[136:139], v5 offset:320
    ds_read_b128 v[140:143], v5 offset:336
    v_rcp_f32 v50, v50
    v_rcp_f32 v51, v51
    v_mfma_f32_32x32x16_bf16 v[192:207], a[8:11], v[64:67], v[192:207]
    s_waitcnt lgkmcnt(5)
    ds_read_b128 a[4:7], v3 offset:33792
    ds_read_b128 a[8:11], v3 offset:34816
    v_rcp_f32 v52, v52
    v_rcp_f32 v53, v53
    v_mfma_f32_32x32x16_bf16 v[160:175], a[12:15], v[68:71], v[160:175]
    s_waitcnt lgkmcnt(6)
    ds_read_b128 v[128:131], v5 offset:256
    ds_read_b128 v[132:135], v5 offset:272
    v_rcp_f32 v54, v54
    v_rcp_f32 v55, v55
    v_mfma_f32_32x32x16_bf16 v[176:191], a[16:19], v[68:71], v[176:191]
    s_waitcnt lgkmcnt(7)
    ds_read_b128 a[12:15], v3 offset:35840
    ds_read_b128 a[16:19], v3 offset:36864
    v_rcp_f32 v56, v56
    v_rcp_f32 v57, v57
    v_mfma_f32_32x32x16_bf16 v[192:207], a[20:23], v[68:71], v[192:207]
    s_waitcnt lgkmcnt(8)
    v_rcp_f32 v58, v58
    v_rcp_f32 v59, v59
    v_rcp_f32 v60, v60
    v_rcp_f32 v61, v61
    v_rcp_f32 v62, v62
    v_rcp_f32 v63, v63
    v_pk_mul_f32 v[32:33], v[32:33], v[48:49]
    v_pk_mul_f32 v[34:35], v[34:35], v[50:51]
    v_pk_mul_f32 v[36:37], v[36:37], v[52:53]
    v_pk_mul_f32 v[38:39], v[38:39], v[54:55]
    v_pk_mul_f32 v[40:41], v[40:41], v[56:57]
    v_pk_mul_f32 v[42:43], v[42:43], v[58:59]
    v_pk_mul_f32 v[44:45], v[44:45], v[60:61]
    v_pk_mul_f32 v[46:47], v[46:47], v[62:63]
    v_pk_fma_f32 v[48:49], v[144:145], v[144:145], s[52:53]
    v_pk_fma_f32 v[50:51], v[146:147], v[146:147], s[52:53]
    v_pk_fma_f32 v[52:53], v[148:149], v[148:149], s[52:53]
    v_pk_fma_f32 v[54:55], v[150:151], v[150:151], s[52:53]
    v_pk_fma_f32 v[56:57], v[152:153], v[152:153], s[52:53]
    v_pk_fma_f32 v[58:59], v[154:155], v[154:155], s[52:53]
    v_pk_fma_f32 v[60:61], v[156:157], v[156:157], s[52:53]
    v_pk_fma_f32 v[62:63], v[158:159], v[158:159], s[52:53]
    v_pk_mul_f32 v[48:49], v[48:49], v[144:145] neg_lo:[1,0] neg_hi:[1,0]
    v_pk_mul_f32 v[50:51], v[50:51], v[146:147] neg_lo:[1,0] neg_hi:[1,0]
    v_pk_mul_f32 v[52:53], v[52:53], v[148:149] neg_lo:[1,0] neg_hi:[1,0]
    v_pk_mul_f32 v[54:55], v[54:55], v[150:151] neg_lo:[1,0] neg_hi:[1,0]
    v_pk_mul_f32 v[56:57], v[56:57], v[152:153] neg_lo:[1,0] neg_hi:[1,0]
    v_pk_mul_f32 v[58:59], v[58:59], v[154:155] neg_lo:[1,0] neg_hi:[1,0]
    v_pk_mul_f32 v[60:61], v[60:61], v[156:157] neg_lo:[1,0] neg_hi:[1,0]
    v_pk_mul_f32 v[62:63], v[62:63], v[158:159] neg_lo:[1,0] neg_hi:[1,0]
L_pf15:
    v_mfma_f32_32x32x16_bf16 v[96:111], a[0:3], a[128:131], v[96:111]
    s_waitcnt lgkmcnt(5)
    ds_read_b128 a[20:23], v3 offset:37888
    ds_read_b128 a[0:3], v4 offset:4096
    v_exp_f32 v48, v48
    v_exp_f32 v49, v49
    v_mfma_f32_32x32x16_bf16 v[112:127], a[4:7], a[128:131], v[112:127]
    s_waitcnt lgkmcnt(6)
    s_mov_b32 s63, L_pf15-L_pc+12288
    buffer_load_dword v6, v7, s[68:71], s63 offen
    v_exp_f32 v50, v50
    v_exp_f32 v51, v51
    s_waitcnt lgkmcnt(4)
    v_mfma_f32_32x32x16_bf16 v[128:143], a[8:11], a[128:131], v[128:143]
    s_waitcnt lgkmcnt(3)
    ds_read_b128 a[4:7], v4 offset:5120
    ds_read_b128 a[8:11], v4 offset:6144
    v_exp_f32 v52, v52
    v_exp_f32 v53, v53
    v_mfma_f32_32x32x16_bf16 v[96:111], a[12:15], a[132:135], v[96:111]
    s_waitcnt lgkmcnt(4)
    v_exp_f32 v54, v54
    v_exp_f32 v55, v55
    v_exp_f32 v56, v56
    v_mfma_f32_32x32x16_bf16 v[112:127], a[16:19], a[132:135], v[112:127]
    s_waitcnt lgkmcnt(3)
    ds_read_b128 a[12:15], v4 offset:7168
    ds_read_b128 a[16:19], v4 offset:8192
    v_exp_f32 v57, v57
    v_exp_f32 v58, v58
    v_mfma_f32_32x32x16_bf16 v[128:143], a[20:23], a[132:135], v[128:143]
    s_waitcnt lgkmcnt(4)
    v_cvt_pk_bf16_f32 v64, v32, v33
    v_cvt_pk_bf16_f32 v65, v34, v35
    v_cvt_pk_bf16_f32 v66, v36, v37
    v_cvt_pk_bf16_f32 v67, v38, v39
    v_cvt_pk_bf16_f32 v68, v40, v41
    v_cvt_pk_bf16_f32 v69, v42, v43
    v_cvt_pk_bf16_f32 v70, v44, v45
    v_cvt_pk_bf16_f32 v71, v46, v47
    v_exp_f32 v59, v59
    v_exp_f32 v60, v60
    v_exp_f32 v61, v61
    v_exp_f32 v62, v62
    v_exp_f32_e64 v63, v63
    v_pk_add_f32 v[48:49], v[48:49], 1.0 op_sel_hi:[1,0]
    v_pk_add_f32 v[50:51], v[50:51], 1.0 op_sel_hi:[1,0]
    v_pk_add_f32 v[52:53], v[52:53], 1.0 op_sel_hi:[1,0]
    v_pk_add_f32 v[54:55], v[54:55], 1.0 op_sel_hi:[1,0]
    v_pk_add_f32 v[56:57], v[56:57], 1.0 op_sel_hi:[1,0]
    v_pk_add_f32 v[58:59], v[58:59], 1.0 op_sel_hi:[1,0]
    v_pk_add_f32 v[60:61], v[60:61], 1.0 op_sel_hi:[1,0]
    v_pk_add_f32 v[62:63], v[62:63], 1.0 op_sel_hi:[1,0]
    v_mfma_f32_32x32x16_bf16 v[160:175], a[0:3], v[64:67], v[160:175]
    s_waitcnt lgkmcnt(3)
    ds_read_b128 a[20:23], v4 offset:9216
    ds_read_b128 a[0:3], v3 offset:38912
    v_rcp_f32 v48, v48
    v_rcp_f32 v49, v49
    v_mfma_f32_32x32x16_bf16 v[176:191], a[4:7], v[64:67], v[176:191]
    s_waitcnt lgkmcnt(4)
    v_rcp_f32 v50, v50
    v_rcp_f32 v51, v51
    v_rcp_f32 v52, v52
    v_mfma_f32_32x32x16_bf16 v[192:207], a[8:11], v[64:67], v[192:207]
    s_waitcnt lgkmcnt(3)
    ds_read_b128 a[4:7], v3 offset:39936
    ds_read_b128 a[8:11], v3 offset:40960
    v_rcp_f32 v53, v53
    v_rcp_f32 v54, v54
    v_mfma_f32_32x32x16_bf16 v[160:175], a[12:15], v[68:71], v[160:175]
    s_waitcnt lgkmcnt(4)
    v_rcp_f32 v55, v55
    v_rcp_f32 v56, v56
    v_rcp_f32 v57, v57
    v_mfma_f32_32x32x16_bf16 v[176:191], a[16:19], v[68:71], v[176:191]
    s_waitcnt lgkmcnt(3)
    ds_read_b128 a[12:15], v3 offset:41984
    ds_read_b128 a[16:19], v3 offset:43008
    v_rcp_f32 v58, v58
    v_rcp_f32 v59, v59
    v_mfma_f32_32x32x16_bf16 v[192:207], a[20:23], v[68:71], v[192:207]
    s_waitcnt lgkmcnt(4)
    v_rcp_f32 v60, v60
    v_rcp_f32 v61, v61
    v_rcp_f32 v62, v62
    v_rcp_f32 v63, v63
    v_pk_mul_f32 v[144:145], v[144:145], v[48:49]
    v_pk_mul_f32 v[146:147], v[146:147], v[50:51]
    v_pk_mul_f32 v[148:149], v[148:149], v[52:53]
    v_pk_mul_f32 v[150:151], v[150:151], v[54:55]
    v_pk_mul_f32 v[152:153], v[152:153], v[56:57]
    v_pk_mul_f32 v[154:155], v[154:155], v[58:59]
    v_pk_mul_f32 v[156:157], v[156:157], v[60:61]
    v_pk_mul_f32 v[158:159], v[158:159], v[62:63]
    v_mfma_f32_32x32x16_bf16 v[96:111], a[0:3], a[136:139], v[96:111]
    s_waitcnt lgkmcnt(3)
    ds_read_b128 a[20:23], v3 offset:44032
    ds_read_b128 a[0:3], v4 offset:10240
    v_cvt_pk_bf16_f32 v64, v144, v145
    v_cvt_pk_bf16_f32 v65, v146, v147
    v_cvt_pk_bf16_f32 v66, v148, v149
    v_mfma_f32_32x32x16_bf16 v[112:127], a[4:7], a[136:139], v[112:127]
    s_waitcnt lgkmcnt(4)
    v_cvt_pk_bf16_f32 v67, v150, v151
    v_cvt_pk_bf16_f32 v68, v152, v153
    v_cvt_pk_bf16_f32 v69, v154, v155
    v_cvt_pk_bf16_f32 v70, v156, v157
    v_cvt_pk_bf16_f32 v71, v158, v159
    v_mfma_f32_32x32x16_bf16 v[128:143], a[8:11], a[136:139], v[128:143]
    s_waitcnt lgkmcnt(3)
    ds_read_b128 a[4:7], v4 offset:11264
    ds_read_b128 a[8:11], v4 offset:12288
    v_mfma_f32_32x32x16_bf16 v[96:111], a[12:15], a[140:143], v[96:111]
    s_waitcnt lgkmcnt(4)
    v_mfma_f32_32x32x16_bf16 v[112:127], a[16:19], a[140:143], v[112:127]
    s_waitcnt lgkmcnt(3)
    ds_read_b128 a[12:15], v4 offset:13312
    ds_read_b128 a[16:19], v4 offset:14336
    v_mfma_f32_32x32x16_bf16 v[128:143], a[20:23], a[140:143], v[128:143]
    s_waitcnt lgkmcnt(4)
    v_mfma_f32_32x32x16_bf16 v[160:175], a[0:3], v[64:67], v[160:175]
    s_waitcnt lgkmcnt(3)
    ds_read_b128 a[20:23], v4 offset:15360
    ds_read_b128 a[0:3], v3 offset:45056
    v_mfma_f32_32x32x16_bf16 v[176:191], a[4:7], v[64:67], v[176:191]
    s_waitcnt lgkmcnt(4)
    v_mfma_f32_32x32x16_bf16 v[192:207], a[8:11], v[64:67], v[192:207]
    s_waitcnt lgkmcnt(3)
    ds_read_b128 a[4:7], v3 offset:46080
    ds_read_b128 a[8:11], v3 offset:47104
    v_mfma_f32_32x32x16_bf16 v[160:175], a[12:15], v[68:71], v[160:175]
    s_waitcnt lgkmcnt(4)
    v_mfma_f32_32x32x16_bf16 v[176:191], a[16:19], v[68:71], v[176:191]
    s_waitcnt lgkmcnt(3)
    ds_read_b128 a[12:15], v3 offset:48128
    ds_read_b128 a[16:19], v3 offset:49152
    v_mfma_f32_32x32x16_bf16 v[192:207], a[20:23], v[68:71], v[192:207]
    s_waitcnt lgkmcnt(4)
    v_mfma_f32_32x32x16_bf16 v[96:111], a[0:3], a[144:147], v[96:111]
    s_waitcnt lgkmcnt(3)
    ds_read_b128 a[20:23], v3 offset:50176
    ds_read_b128 a[0:3], v4 offset:16384
    v_mfma_f32_32x32x16_bf16 v[112:127], a[4:7], a[144:147], v[112:127]
    s_waitcnt lgkmcnt(4)
    v_mfma_f32_32x32x16_bf16 v[128:143], a[8:11], a[144:147], v[128:143]
    s_waitcnt lgkmcnt(3)
    ds_read_b128 a[4:7], v4 offset:17408
    ds_read_b128 a[8:11], v3 offset:51200
    v_mfma_f32_32x32x16_bf16 v[96:111], a[12:15], a[148:151], v[96:111]
    s_waitcnt lgkmcnt(4)
    v_mfma_f32_32x32x16_bf16 v[112:127], a[16:19], a[148:151], v[112:127]
    s_waitcnt lgkmcnt(3)
    ds_read_b128 a[12:15], v3 offset:52224
    ds_read_b128 a[16:19], v3 offset:53248
    v_mfma_f32_32x32x16_bf16 v[128:143], a[20:23], a[148:151], v[128:143]
    s_waitcnt lgkmcnt(4)
    s_waitcnt vmcnt(8)
    v_mfma_f32_32x32x16_bf16 v[144:159], a[0:3], v[208:211], 0
    s_waitcnt lgkmcnt(3)
    ds_read_b128 a[20:23], v3 offset:54272
    ds_read_b128 a[0:3], v3 offset:55296
    v_cvt_pk_bf16_f32 v176, v176, v177
    v_cvt_pk_bf16_f32 v177, v178, v179
    v_cvt_pk_bf16_f32 v178, v180, v181
    v_cvt_pk_bf16_f32 v179, v182, v183
    v_mfma_f32_32x32x16_bf16 v[144:159], a[4:7], v[212:215], v[144:159]
    s_waitcnt lgkmcnt(4)
    v_cvt_pk_bf16_f32 v180, v184, v185
    v_cvt_pk_bf16_f32 v181, v186, v187
    v_cvt_pk_bf16_f32 v182, v188, v189
    v_cvt_pk_bf16_f32 v183, v190, v191
    v_permlane16_swap_b32 v176, v180
    v_permlane16_swap_b32 v177, v181
    v_mfma_f32_32x32x16_bf16 v[96:111], a[8:11], a[152:155], v[96:111]
    s_waitcnt lgkmcnt(3)
    ds_read_b128 a[4:7], v3 offset:56320
    ds_read_b128 a[8:11], v4 offset:18432
    v_permlane16_swap_b32 v178, v182
    v_permlane16_swap_b32 v179, v183
    v_cvt_pk_bf16_f32 v160, v160, v161
    v_cvt_pk_bf16_f32 v161, v162, v163
    v_mfma_f32_32x32x16_bf16 v[112:127], a[12:15], a[152:155], v[112:127]
    s_waitcnt lgkmcnt(4)
    v_cvt_pk_bf16_f32 v162, v164, v165
    v_cvt_pk_bf16_f32 v163, v166, v167
    v_cvt_pk_bf16_f32 v164, v168, v169
    v_cvt_pk_bf16_f32 v165, v170, v171
    v_cvt_pk_bf16_f32 v166, v172, v173
    v_mfma_f32_32x32x16_bf16 v[128:143], a[16:19], a[152:155], v[128:143]
    s_waitcnt lgkmcnt(3)
    ds_read_b128 a[12:15], v4 offset:19456
    ds_read_b128 a[16:19], v4 offset:20480
    v_cvt_pk_bf16_f32 v167, v174, v175
    v_permlane16_swap_b32 v160, v164
    v_permlane16_swap_b32 v161, v165
    v_mfma_f32_32x32x16_bf16 v[96:111], a[20:23], a[156:159], v[96:111]
    s_waitcnt lgkmcnt(4)
    v_permlane16_swap_b32 v162, v166
    v_permlane16_swap_b32 v163, v167
    v_mfma_f32_32x32x16_bf16 v[112:127], a[0:3], a[156:159], v[112:127]
    s_waitcnt lgkmcnt(3)
    ds_read_b128 a[20:23], v4 offset:21504
    ds_read_b128 a[0:3], v3 offset:63488
    v_mfma_f32_32x32x16_bf16 v[128:143], a[4:7], a[156:159], v[128:143]
    s_waitcnt lgkmcnt(4)
    v_mfma_f32_32x32x16_bf16 v[96:111], a[224:227], a[160:163], v[96:111]
    v_cvt_pk_bf16_f32 v192, v192, v193
    v_cvt_pk_bf16_f32 v193, v194, v195
    v_cvt_pk_bf16_f32 v194, v196, v197
    v_cvt_pk_bf16_f32 v195, v198, v199
    v_cvt_pk_bf16_f32 v196, v200, v201
    v_cvt_pk_bf16_f32 v197, v202, v203
    v_mfma_f32_32x32x16_bf16 v[112:127], a[228:231], a[160:163], v[112:127]
    v_cvt_pk_bf16_f32 v198, v204, v205
    v_cvt_pk_bf16_f32 v199, v206, v207
    v_permlane16_swap_b32 v192, v196
    v_permlane16_swap_b32 v193, v197
    v_permlane16_swap_b32 v194, v198
    v_permlane16_swap_b32 v195, v199
    v_mfma_f32_32x32x16_bf16 v[128:143], a[232:235], a[160:163], v[128:143]
    v_fma_f32 v144, v144, v12, v13
    v_fma_f32 v145, v145, v12, v13
    v_fma_f32 v146, v146, v12, v13
    v_fma_f32 v147, v147, v12, v13
    v_fma_f32 v148, v148, v12, v13
    v_fma_f32 v149, v149, v12, v13
    v_mfma_f32_32x32x16_bf16 v[96:111], a[236:239], a[164:167], v[96:111]
    v_fma_f32 v150, v150, v12, v13
    v_fma_f32 v151, v151, v12, v13
    v_fma_f32 v152, v152, v12, v13
    v_fma_f32 v153, v153, v12, v13
    v_fma_f32 v154, v154, v12, v13
    v_fma_f32 v155, v155, v12, v13
    v_mfma_f32_32x32x16_bf16 v[112:127], a[240:243], a[164:167], v[112:127]
    v_fma_f32 v156, v156, v12, v13
    v_fma_f32 v157, v157, v12, v13
    v_fma_f32 v158, v158, v12, v13
    v_fma_f32 v159, v159, v12, v13
    v_cvt_pk_bf16_f32 v72, v144, v145
    v_mfma_f32_32x32x16_bf16 v[128:143], a[244:247], a[164:167], v[128:143]
    v_cvt_pk_bf16_f32 v73, v146, v147
    v_cvt_pk_bf16_f32 v74, v148, v149
    v_cvt_pk_bf16_f32 v75, v150, v151
    v_cvt_pk_bf16_f32 v76, v152, v153
    v_cvt_pk_bf16_f32 v77, v154, v155
    v_mfma_f32_32x32x16_bf16 v[32:47], a[8:11], v[216:219], 0
    s_waitcnt lgkmcnt(3)
    ds_read_b128 a[4:7], v3 offset:64512
    ds_read_b128 a[8:11], v4 offset:0
    v_cvt_pk_bf16_f32 v78, v156, v157
    v_cvt_pk_bf16_f32 v79, v158, v159
    v_mfma_f32_32x32x16_bf16 v[32:47], a[12:15], v[220:223], v[32:47]
    s_waitcnt lgkmcnt(4)
    v_mfma_f32_32x32x16_bf16 v[144:159], a[16:19], v[224:227], 0
    s_waitcnt lgkmcnt(3)
    ds_read_b128 a[12:15], v4 offset:1024
    ds_read_b128 a[16:19], v4 offset:2048
    v_mfma_f32_32x32x16_bf16 v[144:159], a[20:23], v[228:231], v[144:159]
    s_waitcnt lgkmcnt(4)
    s_add_u32 s55, s56, 73728
    buffer_store_dwordx4 v[160:163], v9, s[28:31], s55 offen offset:0 sc1
    buffer_store_dwordx4 v[176:179], v9, s[28:31], s55 offen offset:64 sc1
    buffer_store_dwordx4 v[192:195], v9, s[28:31], s55 offen offset:128 sc1
    v_fma_f32 v32, v32, v12, v13
    v_fma_f32 v33, v33, v12, v13
    v_mfma_f32_32x32x16_bf16 v[96:111], a[0:3], a[168:171], v[96:111]
    s_waitcnt lgkmcnt(3)
    ds_read_b128 a[20:23], v4 offset:3072
    ds_read_b128 a[0:3], v4 offset:4096
    v_fma_f32 v34, v34, v12, v13
    v_fma_f32 v35, v35, v12, v13
    v_fma_f32 v36, v36, v12, v13
    v_fma_f32 v37, v37, v12, v13
    v_mfma_f32_32x32x16_bf16 v[112:127], a[4:7], a[168:171], v[112:127]
    s_waitcnt lgkmcnt(4)
    v_fma_f32 v38, v38, v12, v13
    v_fma_f32 v39, v39, v12, v13
    v_fma_f32 v40, v40, v12, v13
    v_fma_f32 v41, v41, v12, v13
    v_fma_f32 v42, v42, v12, v13
    v_fma_f32 v43, v43, v12, v13
    v_mfma_f32_32x32x16_bf16 v[128:143], a[8:11], a[168:171], v[128:143]
    s_waitcnt lgkmcnt(3)
    ds_read_b128 a[4:7], v4 offset:5120
    ds_read_b128 a[8:11], v4 offset:6144
    v_fma_f32 v44, v44, v12, v13
    v_fma_f32 v45, v45, v12, v13
    v_fma_f32 v46, v46, v12, v13
    v_fma_f32 v47, v47, v12, v13
    v_mfma_f32_32x32x16_bf16 v[96:111], a[12:15], a[172:175], v[96:111]
    s_waitcnt lgkmcnt(4)
    v_cvt_pk_bf16_f32 v80, v32, v33
    v_cvt_pk_bf16_f32 v81, v34, v35
    v_cvt_pk_bf16_f32 v82, v36, v37
    v_cvt_pk_bf16_f32 v83, v38, v39
    v_cvt_pk_bf16_f32 v84, v40, v41
    v_mfma_f32_32x32x16_bf16 v[112:127], a[16:19], a[172:175], v[112:127]
    s_waitcnt lgkmcnt(3)
    ds_read_b128 a[12:15], v4 offset:7168
    ds_read_b128 a[16:19], v4 offset:8192
    v_cvt_pk_bf16_f32 v85, v42, v43
    v_cvt_pk_bf16_f32 v86, v44, v45
    v_cvt_pk_bf16_f32 v87, v46, v47
    v_mfma_f32_32x32x16_bf16 v[128:143], a[20:23], a[172:175], v[128:143]
    s_waitcnt lgkmcnt(4)
    s_waitcnt vmcnt(4)
    v_mfma_f32_32x32x16_bf16 v[96:111], a[24:27], v[232:235], v[96:111]
    v_fma_f32 v144, v144, v12, v13
    v_fma_f32 v145, v145, v12, v13
    v_fma_f32 v146, v146, v12, v13
    v_fma_f32 v147, v147, v12, v13
    v_fma_f32 v148, v148, v12, v13
    v_fma_f32 v149, v149, v12, v13
    v_mfma_f32_32x32x16_bf16 v[96:111], a[28:31], v[236:239], v[96:111]
    v_fma_f32 v150, v150, v12, v13
    v_fma_f32 v151, v151, v12, v13
    v_fma_f32 v152, v152, v12, v13
    v_fma_f32 v153, v153, v12, v13
    v_fma_f32 v154, v154, v12, v13
    v_fma_f32 v155, v155, v12, v13
    v_mfma_f32_32x32x16_bf16 v[112:127], a[24:27], v[240:243], v[112:127]
    v_fma_f32 v156, v156, v12, v13
    v_fma_f32 v157, v157, v12, v13
    v_fma_f32 v158, v158, v12, v13
    v_fma_f32 v159, v159, v12, v13
    v_cvt_pk_bf16_f32 v88, v144, v145
    v_mfma_f32_32x32x16_bf16 v[112:127], a[28:31], v[244:247], v[112:127]
    v_cvt_pk_bf16_f32 v89, v146, v147
    v_cvt_pk_bf16_f32 v90, v148, v149
    v_cvt_pk_bf16_f32 v91, v150, v151
    v_cvt_pk_bf16_f32 v92, v152, v153
    v_cvt_pk_bf16_f32 v93, v154, v155
    v_mfma_f32_32x32x16_bf16 v[128:143], a[24:27], v[248:251], v[128:143]
    v_cvt_pk_bf16_f32 v94, v156, v157
    v_cvt_pk_bf16_f32 v95, v158, v159
    v_mfma_f32_32x32x16_bf16 v[128:143], a[28:31], v[252:255], v[128:143]
    v_mfma_f32_32x32x16_bf16 v[96:111], a[0:3], a[176:179], v[96:111]
    s_waitcnt lgkmcnt(3)
    ds_read_b128 a[20:23], v4 offset:9216
    ds_read_b128 a[0:3], v2 offset:0
    v_mfma_f32_32x32x16_bf16 v[112:127], a[4:7], a[176:179], v[112:127]
    s_waitcnt lgkmcnt(4)
    v_mfma_f32_32x32x16_bf16 v[128:143], a[8:11], a[176:179], v[128:143]
    s_waitcnt lgkmcnt(3)
    ds_read_b128 a[4:7], v2 offset:1024
    ds_read_b128 a[8:11], v2 offset:2048
    v_mfma_f32_32x32x16_bf16 v[96:111], a[12:15], a[180:183], v[96:111]
    s_waitcnt lgkmcnt(4)
    v_mfma_f32_32x32x16_bf16 v[112:127], a[16:19], a[180:183], v[112:127]
    s_waitcnt lgkmcnt(3)
    ds_read_b128 a[12:15], v2 offset:3072
    ds_read_b128 a[16:19], v2 offset:4096
    v_mfma_f32_32x32x16_bf16 v[128:143], a[20:23], a[180:183], v[128:143]
    s_waitcnt lgkmcnt(4)
    v_mfma_f32_32x32x16_bf16 v[16:31], a[0:3], v[72:75], 0
    s_waitcnt lgkmcnt(3)
    ds_read_b128 a[20:23], v2 offset:5120
    ds_read_b128 a[0:3], v4 offset:10240
    v_mfma_f32_32x32x16_bf16 v[16:31], a[4:7], v[76:79], v[16:31]
    s_waitcnt lgkmcnt(4)
    buffer_store_dwordx4 v[164:167], v9, s[28:31], s55 offen offset:3072 sc1
    buffer_store_dwordx4 v[180:183], v9, s[28:31], s55 offen offset:3136 sc1
    buffer_store_dwordx4 v[196:199], v9, s[28:31], s55 offen offset:3200 sc1
    v_mfma_f32_32x32x16_bf16 v[16:31], a[8:11], v[80:83], v[16:31]
    s_waitcnt lgkmcnt(3)
    ds_read_b128 a[4:7], v4 offset:11264
    ds_read_b128 a[8:11], v4 offset:12288
    v_mfma_f32_32x32x16_bf16 v[16:31], a[12:15], v[84:87], v[16:31]
    s_waitcnt lgkmcnt(4)
    v_mfma_f32_32x32x16_bf16 v[16:31], a[16:19], v[88:91], v[16:31]
    s_waitcnt lgkmcnt(3)
    ds_read_b128 a[12:15], v4 offset:13312
    ds_read_b128 a[16:19], v4 offset:14336
    v_mfma_f32_32x32x16_bf16 v[16:31], a[20:23], v[92:95], v[16:31]
    s_waitcnt lgkmcnt(4)
    v_mfma_f32_32x32x16_bf16 v[96:111], a[0:3], a[184:187], v[96:111]
    s_waitcnt lgkmcnt(3)
    ds_read_b128 a[20:23], v4 offset:15360
    ds_read_b128 a[0:3], v3 offset:8192
    v_mfma_f32_32x32x16_bf16 v[112:127], a[4:7], a[184:187], v[112:127]
    s_waitcnt lgkmcnt(4)
    v_mfma_f32_32x32x16_bf16 v[128:143], a[8:11], a[184:187], v[128:143]
    s_waitcnt lgkmcnt(3)
    ds_read_b128 a[4:7], v3 offset:9216
    ds_read_b128 a[8:11], v3 offset:10240
    v_mfma_f32_32x32x16_bf16 v[96:111], a[12:15], a[188:191], v[96:111]
    s_waitcnt lgkmcnt(4)
    v_mfma_f32_32x32x16_bf16 v[112:127], a[16:19], a[188:191], v[112:127]
    s_waitcnt lgkmcnt(3)
    ds_read_b128 a[12:15], v3 offset:11264
    ds_read_b128 a[16:19], v3 offset:12288
    v_mfma_f32_32x32x16_bf16 v[128:143], a[20:23], a[188:191], v[128:143]
    s_waitcnt lgkmcnt(4)
    v_mfma_f32_32x32x16_bf16 v[96:111], a[0:3], a[192:195], v[96:111]
    s_waitcnt lgkmcnt(3)
    ds_read_b128 a[20:23], v3 offset:13312
    ds_read_b128 a[0:3], v2 offset:6144
    v_fma_f32 v48, v16, v16, s52
    v_fma_f32 v49, v17, v17, s52
    v_fma_f32 v50, v18, v18, s52
    v_fma_f32 v51, v19, v19, s52
    v_mfma_f32_32x32x16_bf16 v[112:127], a[4:7], a[192:195], v[112:127]
    s_waitcnt lgkmcnt(4)
    ds_read_b128 v[168:171], v5 offset:64
    ds_read_b128 v[172:175], v5 offset:80
    v_fma_f32 v52, v20, v20, s52
    v_fma_f32 v53, v21, v21, s52
    v_fma_f32 v54, v22, v22, s52
    v_fma_f32 v55, v23, v23, s52
    v_mfma_f32_32x32x16_bf16 v[128:143], a[8:11], a[192:195], v[128:143]
    s_waitcnt lgkmcnt(5)
    ds_read_b128 a[4:7], v2 offset:7168
    ds_read_b128 a[8:11], v2 offset:8192
    v_fma_f32 v56, v24, v24, s52
    v_fma_f32 v57, v25, v25, s52
    v_fma_f32 v58, v26, v26, s52
    v_fma_f32 v59, v27, v27, s52
    v_mfma_f32_32x32x16_bf16 v[96:111], a[12:15], a[196:199], v[96:111]
    s_waitcnt lgkmcnt(6)
    ds_read_b128 v[160:163], v5 offset:0
    ds_read_b128 v[164:167], v5 offset:16
    v_fma_f32 v60, v28, v28, s52
    v_fma_f32 v61, v29, v29, s52
    v_fma_f32 v62, v30, v30, s52
    v_fma_f32 v63, v31, v31, s52
    v_mfma_f32_32x32x16_bf16 v[112:127], a[16:19], a[196:199], v[112:127]
    s_waitcnt lgkmcnt(7)
    ds_read_b128 a[12:15], v2 offset:9216
    ds_read_b128 a[16:19], v2 offset:10240
    v_mul_f32_e64 v48, -v48, v16
    v_mul_f32_e64 v49, -v49, v17
    v_mul_f32_e64 v50, -v50, v18
    v_mul_f32_e64 v51, -v51, v19
    v_mfma_f32_32x32x16_bf16 v[128:143], a[20:23], a[196:199], v[128:143]
    s_waitcnt lgkmcnt(8)
    v_mul_f32_e64 v52, -v52, v20
    v_mul_f32_e64 v53, -v53, v21
    v_mul_f32_e64 v54, -v54, v22
    v_mul_f32_e64 v55, -v55, v23
    v_mul_f32_e64 v56, -v56, v24
    v_mul_f32_e64 v57, -v57, v25
    v_mul_f32_e64 v58, -v58, v26
    v_mul_f32_e64 v59, -v59, v27
    v_mul_f32_e64 v60, -v60, v28
    v_mul_f32_e64 v61, -v61, v29
    v_mul_f32_e64 v62, -v62, v30
    v_mul_f32_e64 v63, -v63, v31
    v_mfma_f32_32x32x16_bf16 v[32:47], a[0:3], v[72:75], 0
    s_waitcnt lgkmcnt(5)
    ds_read_b128 a[20:23], v2 offset:11264
    ds_read_b128 a[0:3], v3 offset:14336
    v_exp_f32 v48, v48
    v_exp_f32 v49, v49
    v_mfma_f32_32x32x16_bf16 v[32:47], a[4:7], v[76:79], v[32:47]
    s_waitcnt lgkmcnt(6)
    ds_read_b128 v[184:187], v5 offset:192
    v_exp_f32 v50, v50
    v_exp_f32 v51, v51
    v_add_f32 v48, 1.0, v48
    v_mfma_f32_32x32x16_bf16 v[32:47], a[8:11], v[80:83], v[32:47]
    s_waitcnt lgkmcnt(4)
    ds_read_b128 a[4:7], v3 offset:15360
    ds_read_b128 a[8:11], v3 offset:16384
    v_exp_f32 v52, v52
    v_exp_f32 v53, v53
    v_mfma_f32_32x32x16_bf16 v[32:47], a[12:15], v[84:87], v[32:47]
    s_waitcnt lgkmcnt(5)
    ds_read_b128 v[188:191], v5 offset:208
    v_exp_f32 v54, v54
    v_exp_f32 v55, v55
    v_add_f32 v49, 1.0, v49
    v_mfma_f32_32x32x16_bf16 v[32:47], a[16:19], v[88:91], v[32:47]
    s_waitcnt lgkmcnt(5)
    ds_read_b128 a[12:15], v3 offset:17408
    ds_read_b128 a[16:19], v3 offset:18432
    v_exp_f32 v56, v56
    v_exp_f32 v57, v57
    v_mfma_f32_32x32x16_bf16 v[32:47], a[20:23], v[92:95], v[32:47]
    s_waitcnt lgkmcnt(6)
    ds_read_b128 v[176:179], v5 offset:128
    v_exp_f32 v58, v58
    v_exp_f32 v59, v59
    v_add_f32 v50, 1.0, v50
    v_mfma_f32_32x32x16_bf16 v[96:111], a[0:3], a[200:203], v[96:111]
    s_waitcnt lgkmcnt(5)
    ds_read_b128 a[20:23], v3 offset:19456
    ds_read_b128 a[0:3], v3 offset:20480
    v_exp_f32 v60, v60
    v_exp_f32 v61, v61
    v_mfma_f32_32x32x16_bf16 v[112:127], a[4:7], a[200:203], v[112:127]
    s_waitcnt lgkmcnt(6)
    ds_read_b128 v[180:183], v5 offset:144
    v_exp_f32 v62, v62
    v_exp_f32 v63, v63
    v_add_f32 v51, 1.0, v51
    v_mfma_f32_32x32x16_bf16 v[128:143], a[8:11], a[200:203], v[128:143]
    s_waitcnt lgkmcnt(5)
    ds_read_b128 a[4:7], v3 offset:21504
    ds_read_b128 a[8:11], v3 offset:22528
    v_add_f32 v52, 1.0, v52
    v_add_f32 v53, 1.0, v53
    v_add_f32 v54, 1.0, v54
    v_add_f32 v55, 1.0, v55
    v_mfma_f32_32x32x16_bf16 v[96:111], a[12:15], a[204:207], v[96:111]
    s_waitcnt lgkmcnt(6)
    v_add_f32 v56, 1.0, v56
    v_add_f32 v57, 1.0, v57
    v_add_f32 v58, 1.0, v58
    v_add_f32 v59, 1.0, v59
    v_add_f32 v60, 1.0, v60
    v_mfma_f32_32x32x16_bf16 v[112:127], a[16:19], a[204:207], v[112:127]
    s_waitcnt lgkmcnt(4)
    ds_read_b128 a[12:15], v3 offset:23552
    ds_read_b128 a[16:19], v3 offset:24576
    v_add_f32 v61, 1.0, v61
    v_add_f32 v62, 1.0, v62
    v_add_f32 v63, 1.0, v63
    v_mfma_f32_32x32x16_bf16 v[128:143], a[20:23], a[204:207], v[128:143]
    s_waitcnt lgkmcnt(5)
    v_mfma_f32_32x32x16_bf16 v[96:111], a[0:3], a[208:211], v[96:111]
    s_waitcnt lgkmcnt(3)
    ds_read_b128 a[20:23], v3 offset:25600
    ds_read_b128 a[0:3], v3 offset:26624
    v_rcp_f32 v48, v48
    v_rcp_f32 v49, v49
    v_mfma_f32_32x32x16_bf16 v[112:127], a[4:7], a[208:211], v[112:127]
    s_waitcnt lgkmcnt(4)
    ds_read_b128 v[200:203], v5 offset:320
    v_rcp_f32 v50, v50
    v_rcp_f32 v51, v51
    v_mul_f32 v16, v16, v48
    v_mfma_f32_32x32x16_bf16 v[128:143], a[8:11], a[208:211], v[128:143]
    s_waitcnt lgkmcnt(4)
    ds_read_b128 a[4:7], v3 offset:27648
    ds_read_b128 a[8:11], v3 offset:28672
    v_rcp_f32 v52, v52
    v_rcp_f32 v53, v53
    v_mfma_f32_32x32x16_bf16 v[96:111], a[12:15], a[212:215], v[96:111]
    s_waitcnt lgkmcnt(5)
    ds_read_b128 v[204:207], v5 offset:336
    v_rcp_f32 v54, v54
    v_rcp_f32 v55, v55
    v_mul_f32 v17, v17, v49
    v_mfma_f32_32x32x16_bf16 v[112:127], a[16:19], a[212:215], v[112:127]
    s_waitcnt lgkmcnt(5)
    ds_read_b128 a[12:15], v3 offset:29696
    ds_read_b128 a[16:19], v3 offset:30720
    v_rcp_f32 v56, v56
    v_rcp_f32 v57, v57
    v_mfma_f32_32x32x16_bf16 v[128:143], a[20:23], a[212:215], v[128:143]
    s_waitcnt lgkmcnt(6)
    ds_read_b128 v[192:195], v5 offset:256
    v_rcp_f32 v58, v58
    v_rcp_f32 v59, v59
    v_mul_f32 v18, v18, v50
    v_mfma_f32_32x32x16_bf16 v[96:111], a[0:3], a[216:219], v[96:111]
    s_waitcnt lgkmcnt(5)
    ds_read_b128 a[20:23], v3 offset:31744
    ds_read_b128 a[0:3], v2 offset:12288
    v_rcp_f32 v60, v60
    v_rcp_f32 v61, v61
    v_mfma_f32_32x32x16_bf16 v[112:127], a[4:7], a[216:219], v[112:127]
    s_waitcnt lgkmcnt(6)
    ds_read_b128 v[196:199], v5 offset:272
    v_rcp_f32 v62, v62
    v_rcp_f32 v63, v63
    v_mul_f32 v19, v19, v51
    v_mfma_f32_32x32x16_bf16 v[128:143], a[8:11], a[216:219], v[128:143]
    s_waitcnt lgkmcnt(5)
    ds_read_b128 a[4:7], v2 offset:13312
    ds_read_b128 a[8:11], v2 offset:14336
    v_mul_f32 v20, v20, v52
    v_mul_f32 v21, v21, v53
    v_mul_f32 v22, v22, v54
    v_mul_f32 v23, v23, v55
    v_mfma_f32_32x32x16_bf16 v[96:111], a[12:15], a[220:223], v[96:111]
    s_waitcnt lgkmcnt(6)
    v_mul_f32 v24, v24, v56
    v_mul_f32 v25, v25, v57
    v_mul_f32 v26, v26, v58
    v_mul_f32 v27, v27, v59
    v_mul_f32 v28, v28, v60
    v_mfma_f32_32x32x16_bf16 v[112:127], a[16:19], a[220:223], v[112:127]
    s_waitcnt lgkmcnt(4)
    ds_read_b128 a[12:15], v2 offset:15360
    ds_read_b128 a[16:19], v2 offset:16384
    v_mul_f32 v29, v29, v61
    v_mul_f32 v30, v30, v62
    v_mul_f32 v31, v31, v63
    v_mfma_f32_32x32x16_bf16 v[128:143], a[20:23], a[220:223], v[128:143]
    s_waitcnt lgkmcnt(5)
    v_pk_fma_f32 v[48:49], v[32:33], v[32:33], s[52:53]
    v_pk_fma_f32 v[50:51], v[34:35], v[34:35], s[52:53]
    v_pk_fma_f32 v[52:53], v[36:37], v[36:37], s[52:53]
    v_pk_fma_f32 v[54:55], v[38:39], v[38:39], s[52:53]
    v_pk_fma_f32 v[56:57], v[40:41], v[40:41], s[52:53]
    v_pk_fma_f32 v[58:59], v[42:43], v[42:43], s[52:53]
    v_pk_fma_f32 v[60:61], v[44:45], v[44:45], s[52:53]
    v_pk_fma_f32 v[62:63], v[46:47], v[46:47], s[52:53]
    v_pk_mul_f32 v[48:49], v[48:49], v[32:33] neg_lo:[1,0] neg_hi:[1,0]
    v_pk_mul_f32 v[50:51], v[50:51], v[34:35] neg_lo:[1,0] neg_hi:[1,0]
    v_pk_mul_f32 v[52:53], v[52:53], v[36:37] neg_lo:[1,0] neg_hi:[1,0]
    v_pk_mul_f32 v[54:55], v[54:55], v[38:39] neg_lo:[1,0] neg_hi:[1,0]
    v_pk_mul_f32 v[56:57], v[56:57], v[40:41] neg_lo:[1,0] neg_hi:[1,0]
    v_pk_mul_f32 v[58:59], v[58:59], v[42:43] neg_lo:[1,0] neg_hi:[1,0]
    v_pk_mul_f32 v[60:61], v[60:61], v[44:45] neg_lo:[1,0] neg_hi:[1,0]
    v_pk_mul_f32 v[62:63], v[62:63], v[46:47] neg_lo:[1,0] neg_hi:[1,0]
    v_mfma_f32_32x32x16_bf16 v[144:159], a[0:3], v[72:75], 0
    s_waitcnt lgkmcnt(3)
    ds_read_b128 a[20:23], v2 offset:17408
    ds_read_b128 a[0:3], v2 offset:18432
    v_exp_f32 v48, v48
    v_exp_f32 v49, v49
    v_mfma_f32_32x32x16_bf16 v[144:159], a[4:7], v[76:79], v[144:159]
    s_waitcnt lgkmcnt(4)
    ds_read_b128 a[128:131], v3 offset:8192
    ds_read_b128 a[132:135], v3 offset:9216
    v_exp_f32 v50, v50
    v_exp_f32 v51, v51
    v_mfma_f32_32x32x16_bf16 v[144:159], a[8:11], v[80:83], v[144:159]
    s_waitcnt lgkmcnt(5)
    ds_read_b128 a[4:7], v2 offset:19456
    ds_read_b128 a[8:11], v2 offset:20480
    v_exp_f32 v52, v52
    v_exp_f32 v53, v53
    v_mfma_f32_32x32x16_bf16 v[144:159], a[12:15], v[84:87], v[144:159]
    s_waitcnt lgkmcnt(6)
    ds_read_b128 a[136:139], v3 offset:10240
    ds_read_b128 a[140:143], v3 offset:11264
    v_exp_f32 v54, v54
    v_exp_f32 v55, v55
    v_mfma_f32_32x32x16_bf16 v[144:159], a[16:19], v[88:91], v[144:159]
    s_waitcnt lgkmcnt(7)
    ds_read_b128 a[12:15], v2 offset:21504
    ds_read_b128 a[16:19], v2 offset:22528
    v_exp_f32 v56, v56
    v_exp_f32 v57, v57
    v_mfma_f32_32x32x16_bf16 v[144:159], a[20:23], v[92:95], v[144:159]
    s_waitcnt lgkmcnt(8)
    ds_read_b128 a[144:147], v3 offset:12288
    ds_read_b128 a[148:151], v3 offset:13312
    v_cvt_pk_bf16_f32 v64, v16, v17
    v_cvt_pk_bf16_f32 v65, v18, v19
    v_cvt_pk_bf16_f32 v66, v20, v21
    v_cvt_pk_bf16_f32 v67, v22, v23
    v_cvt_pk_bf16_f32 v68, v24, v25
    v_cvt_pk_bf16_f32 v69, v26, v27
    v_cvt_pk_bf16_f32 v70, v28, v29
    v_cvt_pk_bf16_f32 v71, v30, v31
    v_exp_f32 v58, v58
    v_exp_f32 v59, v59
    v_exp_f32 v60, v60
    v_exp_f32 v61, v61
    v_exp_f32 v62, v62
    v_exp_f32 v63, v63
    v_pk_add_f32 v[48:49], v[48:49], 1.0 op_sel_hi:[1,0]
    v_pk_add_f32 v[50:51], v[50:51], 1.0 op_sel_hi:[1,0]
    v_pk_add_f32 v[52:53], v[52:53], 1.0 op_sel_hi:[1,0]
    v_pk_add_f32 v[54:55], v[54:55], 1.0 op_sel_hi:[1,0]
    v_pk_add_f32 v[56:57], v[56:57], 1.0 op_sel_hi:[1,0]
    v_pk_add_f32 v[58:59], v[58:59], 1.0 op_sel_hi:[1,0]
    v_pk_add_f32 v[60:61], v[60:61], 1.0 op_sel_hi:[1,0]
    v_pk_add_f32 v[62:63], v[62:63], 1.0 op_sel_hi:[1,0]
    s_waitcnt lgkmcnt(0)
    v_mfma_f32_32x32x16_bf16 v[160:175], a[128:131], v[64:67], v[160:175]
    v_rcp_f32 v48, v48
    v_rcp_f32 v49, v49
    v_rcp_f32 v50, v50
    v_mfma_f32_32x32x16_bf16 v[176:191], a[132:135], v[64:67], v[176:191]
    v_rcp_f32 v51, v51
    v_rcp_f32 v52, v52
    v_rcp_f32 v53, v53
    v_mfma_f32_32x32x16_bf16 v[192:207], a[136:139], v[64:67], v[192:207]
    v_rcp_f32 v54, v54
    v_rcp_f32 v55, v55
    v_rcp_f32 v56, v56
    v_mfma_f32_32x32x16_bf16 v[160:175], a[140:143], v[68:71], v[160:175]
    v_rcp_f32 v57, v57
    v_rcp_f32 v58, v58
    v_rcp_f32 v59, v59
    v_mfma_f32_32x32x16_bf16 v[176:191], a[144:147], v[68:71], v[176:191]
    v_rcp_f32 v60, v60
    v_rcp_f32 v61, v61
    v_rcp_f32 v62, v62
    v_mfma_f32_32x32x16_bf16 v[192:207], a[148:151], v[68:71], v[192:207]
    v_cvt_pk_bf16_f32 v96, v96, v97
    v_cvt_pk_bf16_f32 v97, v98, v99
    v_cvt_pk_bf16_f32 v98, v100, v101
    v_cvt_pk_bf16_f32 v99, v102, v103
    v_cvt_pk_bf16_f32 v100, v104, v105
    v_cvt_pk_bf16_f32 v101, v106, v107
    v_cvt_pk_bf16_f32 v102, v108, v109
    v_cvt_pk_bf16_f32 v103, v110, v111
    v_permlane16_swap_b32 v96, v100
    v_permlane16_swap_b32 v97, v101
    v_permlane16_swap_b32 v98, v102
    v_permlane16_swap_b32 v99, v103
    v_rcp_f32_e64 v63, v63
    v_pk_mul_f32 v[32:33], v[32:33], v[48:49]
    v_pk_mul_f32 v[34:35], v[34:35], v[50:51]
    v_pk_mul_f32 v[36:37], v[36:37], v[52:53]
    v_pk_mul_f32 v[38:39], v[38:39], v[54:55]
    v_pk_mul_f32 v[40:41], v[40:41], v[56:57]
    v_pk_mul_f32 v[42:43], v[42:43], v[58:59]
    v_pk_mul_f32 v[44:45], v[44:45], v[60:61]
    v_pk_mul_f32 v[46:47], v[46:47], v[62:63]
    v_pk_fma_f32 v[48:49], v[144:145], v[144:145], s[52:53]
    v_pk_fma_f32 v[50:51], v[146:147], v[146:147], s[52:53]
    v_pk_fma_f32 v[52:53], v[148:149], v[148:149], s[52:53]
    v_pk_fma_f32 v[54:55], v[150:151], v[150:151], s[52:53]
    v_pk_fma_f32 v[56:57], v[152:153], v[152:153], s[52:53]
    v_pk_fma_f32 v[58:59], v[154:155], v[154:155], s[52:53]
    v_pk_fma_f32 v[60:61], v[156:157], v[156:157], s[52:53]
    v_pk_fma_f32 v[62:63], v[158:159], v[158:159], s[52:53]
    v_pk_mul_f32 v[48:49], v[48:49], v[144:145] neg_lo:[1,0] neg_hi:[1,0]
    v_pk_mul_f32 v[50:51], v[50:51], v[146:147] neg_lo:[1,0] neg_hi:[1,0]
    v_pk_mul_f32 v[52:53], v[52:53], v[148:149] neg_lo:[1,0] neg_hi:[1,0]
    v_pk_mul_f32 v[54:55], v[54:55], v[150:151] neg_lo:[1,0] neg_hi:[1,0]
    v_pk_mul_f32 v[56:57], v[56:57], v[152:153] neg_lo:[1,0] neg_hi:[1,0]
    v_pk_mul_f32 v[58:59], v[58:59], v[154:155] neg_lo:[1,0] neg_hi:[1,0]
    v_pk_mul_f32 v[60:61], v[60:61], v[156:157] neg_lo:[1,0] neg_hi:[1,0]
    v_pk_mul_f32 v[62:63], v[62:63], v[158:159] neg_lo:[1,0] neg_hi:[1,0]
    v_mfma_f32_32x32x16_bf16 v[16:31], a[0:3], v[72:75], 0
    ds_read_b128 a[20:23], v2 offset:23552
    ds_read_b128 a[0:3], v2 offset:24576
    v_exp_f32 v48, v48
    v_exp_f32 v49, v49
    v_mfma_f32_32x32x16_bf16 v[16:31], a[4:7], v[76:79], v[16:31]
    ds_read_b128 a[152:155], v3 offset:14336
    ds_read_b128 a[156:159], v3 offset:15360
    ds_read_b128 a[160:163], v3 offset:16384
    ds_read_b128 a[164:167], v3 offset:17408
    v_exp_f32 v50, v50
    v_mfma_f32_32x32x16_bf16 v[16:31], a[8:11], v[80:83], v[16:31]
    ds_read_b128 a[4:7], v2 offset:25600
    ds_read_b128 a[8:11], v2 offset:26624
    v_exp_f32 v51, v51
    v_exp_f32 v52, v52
    v_mfma_f32_32x32x16_bf16 v[16:31], a[12:15], v[84:87], v[16:31]
    ds_read_b128 a[168:171], v3 offset:18432
    ds_read_b128 a[172:175], v3 offset:19456
    s_add_u32 s54, s56, 24576
    buffer_load_dwordx4 v[232:235], v1, s[24:27], s54 offen offset:0
    buffer_load_dwordx4 v[236:239], v1, s[24:27], s54 offen offset:32
    v_cvt_pk_bf16_f32 v112, v112, v113
    v_mfma_f32_32x32x16_bf16 v[16:31], a[16:19], v[88:91], v[16:31]
    s_waitcnt lgkmcnt(9)
    ds_read_b128 a[12:15], v2 offset:27648
    ds_read_b128 a[16:19], v2 offset:28672
    v_exp_f32 v53, v53
    v_exp_f32_e64 v54, v54
    v_mfma_f32_32x32x16_bf16 v[16:31], a[20:23], v[92:95], v[16:31]
    s_waitcnt lgkmcnt(10)
    v_cvt_pk_bf16_f32 v113, v114, v115
    v_cvt_pk_bf16_f32 v114, v116, v117
    v_cvt_pk_bf16_f32 v115, v118, v119
    v_cvt_pk_bf16_f32 v116, v120, v121
    v_cvt_pk_bf16_f32 v117, v122, v123
    v_cvt_pk_bf16_f32 v118, v124, v125
    v_cvt_pk_bf16_f32 v119, v126, v127
    v_permlane16_swap_b32 v112, v116
    v_permlane16_swap_b32 v113, v117
    v_permlane16_swap_b32 v114, v118
    v_permlane16_swap_b32 v115, v119
    v_cvt_pk_bf16_f32 v64, v32, v33
    v_cvt_pk_bf16_f32 v65, v34, v35
    v_cvt_pk_bf16_f32 v66, v36, v37
    v_cvt_pk_bf16_f32 v67, v38, v39
    v_cvt_pk_bf16_f32 v68, v40, v41
    v_cvt_pk_bf16_f32 v69, v42, v43
    v_cvt_pk_bf16_f32 v70, v44, v45
    v_cvt_pk_bf16_f32 v71, v46, v47
    v_exp_f32 v55, v55
    v_exp_f32 v56, v56
    v_exp_f32 v57, v57
    v_exp_f32 v58, v58
    v_exp_f32 v59, v59
    v_exp_f32 v60, v60
    v_exp_f32 v61, v61
    v_exp_f32 v62, v62
    v_exp_f32_e64 v63, v63
    v_pk_add_f32 v[48:49], v[48:49], 1.0 op_sel_hi:[1,0]
    v_pk_add_f32 v[50:51], v[50:51], 1.0 op_sel_hi:[1,0]
    v_pk_add_f32 v[52:53], v[52:53], 1.0 op_sel_hi:[1,0]
    v_pk_add_f32 v[54:55], v[54:55], 1.0 op_sel_hi:[1,0]
    v_pk_add_f32 v[56:57], v[56:57], 1.0 op_sel_hi:[1,0]
    v_pk_add_f32 v[58:59], v[58:59], 1.0 op_sel_hi:[1,0]
    v_pk_add_f32 v[60:61], v[60:61], 1.0 op_sel_hi:[1,0]
    v_pk_add_f32 v[62:63], v[62:63], 1.0 op_sel_hi:[1,0]
    s_waitcnt lgkmcnt(2)
    v_mfma_f32_32x32x16_bf16 v[160:175], a[24:27], v[208:211], v[160:175]
    v_rcp_f32 v48, v48
    v_rcp_f32 v49, v49
    v_rcp_f32 v50, v50
    v_mfma_f32_32x32x16_bf16 v[160:175], a[28:31], v[212:215], v[160:175]
    v_rcp_f32 v51, v51
    v_rcp_f32 v52, v52
    v_rcp_f32 v53, v53
    v_mfma_f32_32x32x16_bf16 v[176:191], a[24:27], v[216:219], v[176:191]
    v_rcp_f32 v54, v54
    v_rcp_f32 v55, v55
    v_rcp_f32 v56, v56
    v_mfma_f32_32x32x16_bf16 v[160:175], a[152:155], v[64:67], v[160:175]
    v_rcp_f32 v57, v57
    v_rcp_f32 v58, v58
    v_rcp_f32 v59, v59
    v_mfma_f32_32x32x16_bf16 v[176:191], a[156:159], v[64:67], v[176:191]
    v_rcp_f32 v60, v60
    v_rcp_f32 v61, v61
    v_rcp_f32 v62, v62
    v_mfma_f32_32x32x16_bf16 v[192:207], a[160:163], v[64:67], v[192:207]
    v_rcp_f32_e64 v63, v63
    v_cvt_pk_bf16_f32 v128, v128, v129
    v_cvt_pk_bf16_f32 v129, v130, v131
    v_cvt_pk_bf16_f32 v130, v132, v133
    v_cvt_pk_bf16_f32 v131, v134, v135
    v_mfma_f32_32x32x16_bf16 v[160:175], a[164:167], v[68:71], v[160:175]
    v_cvt_pk_bf16_f32 v132, v136, v137
    v_cvt_pk_bf16_f32 v133, v138, v139
    v_cvt_pk_bf16_f32 v134, v140, v141
    v_cvt_pk_bf16_f32 v135, v142, v143
    v_permlane16_swap_b32 v128, v132
    v_mfma_f32_32x32x16_bf16 v[176:191], a[168:171], v[68:71], v[176:191]
    v_permlane16_swap_b32 v129, v133
    v_permlane16_swap_b32 v130, v134
    v_permlane16_swap_b32 v131, v135
    v_mfma_f32_32x32x16_bf16 v[192:207], a[172:175], v[68:71], v[192:207]
    v_pk_mul_f32 v[144:145], v[144:145], v[48:49]
    v_pk_mul_f32 v[146:147], v[146:147], v[50:51]
    v_pk_mul_f32 v[148:149], v[148:149], v[52:53]
    v_pk_mul_f32 v[150:151], v[150:151], v[54:55]
    v_pk_mul_f32 v[152:153], v[152:153], v[56:57]
    v_pk_mul_f32 v[154:155], v[154:155], v[58:59]
    v_pk_mul_f32 v[156:157], v[156:157], v[60:61]
    v_pk_mul_f32 v[158:159], v[158:159], v[62:63]
    v_pk_fma_f32 v[48:49], v[16:17], v[16:17], s[52:53]
    v_pk_fma_f32 v[50:51], v[18:19], v[18:19], s[52:53]
    v_pk_fma_f32 v[52:53], v[20:21], v[20:21], s[52:53]
    v_pk_fma_f32 v[54:55], v[22:23], v[22:23], s[52:53]
    v_pk_fma_f32 v[56:57], v[24:25], v[24:25], s[52:53]
    v_pk_fma_f32 v[58:59], v[26:27], v[26:27], s[52:53]
    v_pk_fma_f32 v[60:61], v[28:29], v[28:29], s[52:53]
    v_pk_fma_f32 v[62:63], v[30:31], v[30:31], s[52:53]
    v_pk_mul_f32 v[48:49], v[48:49], v[16:17] neg_lo:[1,0] neg_hi:[1,0]
    v_pk_mul_f32 v[50:51], v[50:51], v[18:19] neg_lo:[1,0] neg_hi:[1,0]
    v_pk_mul_f32 v[52:53], v[52:53], v[20:21] neg_lo:[1,0] neg_hi:[1,0]
    v_pk_mul_f32 v[54:55], v[54:55], v[22:23] neg_lo:[1,0] neg_hi:[1,0]
    v_pk_mul_f32 v[56:57], v[56:57], v[24:25] neg_lo:[1,0] neg_hi:[1,0]
    v_pk_mul_f32 v[58:59], v[58:59], v[26:27] neg_lo:[1,0] neg_hi:[1,0]
    v_pk_mul_f32 v[60:61], v[60:61], v[28:29] neg_lo:[1,0] neg_hi:[1,0]
    v_pk_mul_f32 v[62:63], v[62:63], v[30:31] neg_lo:[1,0] neg_hi:[1,0]
L_pf16:
    v_mfma_f32_32x32x16_bf16 v[32:47], a[0:3], v[72:75], 0
    ds_read_b128 a[20:23], v2 offset:29696
    ds_read_b128 a[0:3], v2 offset:30720
    v_exp_f32 v48, v48
    v_exp_f32 v49, v49
    v_mfma_f32_32x32x16_bf16 v[32:47], a[4:7], v[76:79], v[32:47]
    ds_read_b128 a[176:179], v3 offset:20480
    ds_read_b128 a[180:183], v3 offset:21504
    ds_read_b128 a[184:187], v3 offset:22528
    v_exp_f32 v50, v50
    v_cvt_pk_bf16_f32 v64, v144, v145
    v_mfma_f32_32x32x16_bf16 v[32:47], a[8:11], v[80:83], v[32:47]
    s_waitcnt lgkmcnt(6)
    ds_read_b128 a[4:7], v2 offset:31744
    ds_read_b128 a[8:11], v2 offset:32768
    v_exp_f32 v51, v51
    v_exp_f32 v52, v52
    v_mfma_f32_32x32x16_bf16 v[32:47], a[12:15], v[84:87], v[32:47]
    s_waitcnt lgkmcnt(7)
    ds_read_b128 a[188:191], v3 offset:23552
    ds_read_b128 a[192:195], v3 offset:24576
    ds_read_b128 a[196:199], v3 offset:25600
    v_exp_f32 v53, v53
    v_cvt_pk_bf16_f32 v65, v146, v147
    v_mfma_f32_32x32x16_bf16 v[32:47], a[16:19], v[88:91], v[32:47]
    s_waitcnt lgkmcnt(9)
    ds_read_b128 a[12:15], v2 offset:33792
    ds_read_b128 a[16:19], v2 offset:34816
    v_exp_f32 v54, v54
    v_exp_f32 v55, v55
    v_mfma_f32_32x32x16_bf16 v[32:47], a[20:23], v[92:95], v[32:47]
    s_waitcnt lgkmcnt(10)
    buffer_load_dwordx4 v[240:243], v1, s[24:27], s54 offen offset:64
    buffer_load_dwordx4 v[244:247], v1, s[24:27], s54 offen offset:96
    s_mov_b32 s63, L_pf16-L_pc+12288
    buffer_load_dword v6, v7, s[68:71], s63 offen
    v_cvt_pk_bf16_f32 v66, v148, v149
    v_cvt_pk_bf16_f32 v67, v150, v151
    v_cvt_pk_bf16_f32 v68, v152, v153
    v_cvt_pk_bf16_f32 v69, v154, v155
    v_cvt_pk_bf16_f32 v70, v156, v157
    v_cvt_pk_bf16_f32 v71, v158, v159
    v_exp_f32 v56, v56
    v_exp_f32 v57, v57
    v_exp_f32 v58, v58
    v_exp_f32 v59, v59
    v_exp_f32 v60, v60
    v_exp_f32 v61, v61
    v_exp_f32 v62, v62
    v_exp_f32 v63, v63
    v_pk_add_f32 v[48:49], v[48:49], 1.0 op_sel_hi:[1,0]
    v_pk_add_f32 v[50:51], v[50:51], 1.0 op_sel_hi:[1,0]
    v_pk_add_f32 v[52:53], v[52:53], 1.0 op_sel_hi:[1,0]
    v_pk_add_f32 v[54:55], v[54:55], 1.0 op_sel_hi:[1,0]
    v_pk_add_f32 v[56:57], v[56:57], 1.0 op_sel_hi:[1,0]
    v_pk_add_f32 v[58:59], v[58:59], 1.0 op_sel_hi:[1,0]
    v_pk_add_f32 v[60:61], v[60:61], 1.0 op_sel_hi:[1,0]
    v_pk_add_f32 v[62:63], v[62:63], 1.0 op_sel_hi:[1,0]
    s_waitcnt lgkmcnt(2)
    v_mfma_f32_32x32x16_bf16 v[176:191], a[28:31], v[220:223], v[176:191]
    v_rcp_f32 v48, v48
    v_rcp_f32 v49, v49
    v_rcp_f32 v50, v50
    v_mfma_f32_32x32x16_bf16 v[192:207], a[24:27], v[224:227], v[192:207]
    v_rcp_f32 v51, v51
    v_rcp_f32 v52, v52
    v_rcp_f32 v53, v53
    v_mfma_f32_32x32x16_bf16 v[192:207], a[28:31], v[228:231], v[192:207]
    v_rcp_f32 v54, v54
    v_rcp_f32 v55, v55
    v_rcp_f32 v56, v56
    v_mfma_f32_32x32x16_bf16 v[160:175], a[176:179], v[64:67], v[160:175]
    v_rcp_f32 v57, v57
    v_rcp_f32 v58, v58
    v_rcp_f32 v59, v59
    v_mfma_f32_32x32x16_bf16 v[176:191], a[180:183], v[64:67], v[176:191]
    v_rcp_f32 v60, v60
    v_rcp_f32 v61, v61
    v_rcp_f32 v62, v62
    v_mfma_f32_32x32x16_bf16 v[192:207], a[184:187], v[64:67], v[192:207]
    v_rcp_f32_e64 v63, v63
    v_mfma_f32_32x32x16_bf16 v[160:175], a[188:191], v[68:71], v[160:175]
    v_mfma_f32_32x32x16_bf16 v[176:191], a[192:195], v[68:71], v[176:191]
    v_mfma_f32_32x32x16_bf16 v[192:207], a[196:199], v[68:71], v[192:207]
    v_pk_mul_f32 v[16:17], v[16:17], v[48:49]
    v_pk_mul_f32 v[18:19], v[18:19], v[50:51]
    v_pk_mul_f32 v[20:21], v[20:21], v[52:53]
    v_pk_mul_f32 v[22:23], v[22:23], v[54:55]
    v_pk_mul_f32 v[24:25], v[24:25], v[56:57]
    v_pk_mul_f32 v[26:27], v[26:27], v[58:59]
    v_pk_mul_f32 v[28:29], v[28:29], v[60:61]
    v_pk_mul_f32 v[30:31], v[30:31], v[62:63]
    v_pk_fma_f32 v[48:49], v[32:33], v[32:33], s[52:53]
    v_pk_fma_f32 v[50:51], v[34:35], v[34:35], s[52:53]
    v_pk_fma_f32 v[52:53], v[36:37], v[36:37], s[52:53]
    v_pk_fma_f32 v[54:55], v[38:39], v[38:39], s[52:53]
    v_pk_fma_f32 v[56:57], v[40:41], v[40:41], s[52:53]
    v_pk_fma_f32 v[58:59], v[42:43], v[42:43], s[52:53]
    v_pk_fma_f32 v[60:61], v[44:45], v[44:45], s[52:53]
    v_pk_fma_f32 v[62:63], v[46:47], v[46:47], s[52:53]
    v_pk_mul_f32 v[48:49], v[48:49], v[32:33] neg_lo:[1,0] neg_hi:[1,0]
    v_pk_mul_f32 v[50:51], v[50:51], v[34:35] neg_lo:[1,0] neg_hi:[1,0]
    v_pk_mul_f32 v[52:53], v[52:53], v[36:37] neg_lo:[1,0] neg_hi:[1,0]
    v_pk_mul_f32 v[54:55], v[54:55], v[38:39] neg_lo:[1,0] neg_hi:[1,0]
    v_pk_mul_f32 v[56:57], v[56:57], v[40:41] neg_lo:[1,0] neg_hi:[1,0]
    v_pk_mul_f32 v[58:59], v[58:59], v[42:43] neg_lo:[1,0] neg_hi:[1,0]
    v_pk_mul_f32 v[60:61], v[60:61], v[44:45] neg_lo:[1,0] neg_hi:[1,0]
    v_pk_mul_f32 v[62:63], v[62:63], v[46:47] neg_lo:[1,0] neg_hi:[1,0]
    v_mfma_f32_32x32x16_bf16 v[144:159], a[0:3], v[72:75], 0
    ds_read_b128 a[20:23], v2 offset:35840
    ds_read_b128 a[0:3], v2 offset:36864
    v_exp_f32 v48, v48
    v_exp_f32 v49, v49
    v_mfma_f32_32x32x16_bf16 v[144:159], a[4:7], v[76:79], v[144:159]
    ds_read_b128 a[200:203], v3 offset:26624
    ds_read_b128 a[204:207], v3 offset:27648
    v_exp_f32 v50, v50
    v_exp_f32 v51, v51
    v_mfma_f32_32x32x16_bf16 v[144:159], a[8:11], v[80:83], v[144:159]
    s_waitcnt lgkmcnt(5)
    ds_read_b128 a[4:7], v2 offset:37888
    ds_read_b128 a[8:11], v2 offset:38912
    v_exp_f32 v52, v52
    v_exp_f32 v53, v53
    v_mfma_f32_32x32x16_bf16 v[144:159], a[12:15], v[84:87], v[144:159]
    s_waitcnt lgkmcnt(6)
    ds_read_b128 a[208:211], v3 offset:28672
    ds_read_b128 a[212:215], v3 offset:29696
    v_exp_f32 v54, v54
    v_exp_f32 v55, v55
    v_mfma_f32_32x32x16_bf16 v[144:159], a[16:19], v[88:91], v[144:159]
    s_waitcnt lgkmcnt(7)
    ds_read_b128 a[12:15], v2 offset:39936
    ds_read_b128 a[16:19], v2 offset:40960
    v_exp_f32 v56, v56
    v_exp_f32 v57, v57
    v_mfma_f32_32x32x16_bf16 v[144:159], a[20:23], v[92:95], v[144:159]
    s_waitcnt lgkmcnt(8)
    ds_read_b128 a[216:219], v3 offset:30720
    ds_read_b128 a[220:223], v3 offset:31744
    v_cvt_pk_bf16_f32 v64, v16, v17
    v_cvt_pk_bf16_f32 v65, v18, v19
    v_cvt_pk_bf16_f32 v66, v20, v21
    v_cvt_pk_bf16_f32 v67, v22, v23
    v_exp_f32 v58, v58
    v_exp_f32 v59, v59
    v_exp_f32 v60, v60
    v_exp_f32 v61, v61
    v_exp_f32 v62, v62
    v_exp_f32 v63, v63
    v_pk_add_f32 v[48:49], v[48:49], 1.0 op_sel_hi:[1,0]
    v_pk_add_f32 v[50:51], v[50:51], 1.0 op_sel_hi:[1,0]
    v_pk_add_f32 v[52:53], v[52:53], 1.0 op_sel_hi:[1,0]
    v_pk_add_f32 v[54:55], v[54:55], 1.0 op_sel_hi:[1,0]
    v_pk_add_f32 v[56:57], v[56:57], 1.0 op_sel_hi:[1,0]
    v_pk_add_f32 v[58:59], v[58:59], 1.0 op_sel_hi:[1,0]
    v_pk_add_f32 v[60:61], v[60:61], 1.0 op_sel_hi:[1,0]
    v_pk_add_f32 v[62:63], v[62:63], 1.0 op_sel_hi:[1,0]
    s_waitcnt lgkmcnt(0)
    v_mfma_f32_32x32x16_bf16 v[160:175], a[200:203], v[64:67], v[160:175]
    buffer_load_dwordx4 v[248:251], v1, s[24:27], s54 offen offset:128
    buffer_load_dwordx4 v[252:255], v1, s[24:27], s54 offen offset:160
    v_cvt_pk_bf16_f32 v68, v24, v25
    v_cvt_pk_bf16_f32 v69, v26, v27
    v_cvt_pk_bf16_f32 v70, v28, v29
    v_cvt_pk_bf16_f32 v71, v30, v31
    v_mfma_f32_32x32x16_bf16 v[176:191], a[204:207], v[64:67], v[176:191]
    v_rcp_f32 v48, v48
    v_rcp_f32 v49, v49
    v_rcp_f32 v50, v50
    v_mfma_f32_32x32x16_bf16 v[192:207], a[208:211], v[64:67], v[192:207]
    v_rcp_f32 v51, v51
    v_rcp_f32 v52, v52
    v_rcp_f32 v53, v53
    v_mfma_f32_32x32x16_bf16 v[160:175], a[212:215], v[68:71], v[160:175]
    v_rcp_f32 v54, v54
    v_rcp_f32 v55, v55
    v_rcp_f32 v56, v56
    v_mfma_f32_32x32x16_bf16 v[176:191], a[216:219], v[68:71], v[176:191]
    v_rcp_f32 v57, v57
    v_rcp_f32 v58, v58
    v_rcp_f32 v59, v59
    v_mfma_f32_32x32x16_bf16 v[192:207], a[220:223], v[68:71], v[192:207]
    v_rcp_f32 v60, v60
    v_rcp_f32 v61, v61
    v_rcp_f32 v62, v62
    v_rcp_f32_e64 v63, v63
    v_pk_mul_f32 v[32:33], v[32:33], v[48:49]
    v_pk_mul_f32 v[34:35], v[34:35], v[50:51]
    v_pk_mul_f32 v[36:37], v[36:37], v[52:53]
    v_pk_mul_f32 v[38:39], v[38:39], v[54:55]
    v_pk_mul_f32 v[40:41], v[40:41], v[56:57]
    v_pk_mul_f32 v[42:43], v[42:43], v[58:59]
    v_pk_mul_f32 v[44:45], v[44:45], v[60:61]
    v_pk_mul_f32 v[46:47], v[46:47], v[62:63]
    v_pk_fma_f32 v[48:49], v[144:145], v[144:145], s[52:53]
    v_pk_fma_f32 v[50:51], v[146:147], v[146:147], s[52:53]
    v_pk_fma_f32 v[52:53], v[148:149], v[148:149], s[52:53]
    v_pk_fma_f32 v[54:55], v[150:151], v[150:151], s[52:53]
    v_pk_fma_f32 v[56:57], v[152:153], v[152:153], s[52:53]
    v_pk_fma_f32 v[58:59], v[154:155], v[154:155], s[52:53]
    v_pk_fma_f32 v[60:61], v[156:157], v[156:157], s[52:53]
    v_pk_fma_f32 v[62:63], v[158:159], v[158:159], s[52:53]
    v_pk_mul_f32 v[48:49], v[48:49], v[144:145] neg_lo:[1,0] neg_hi:[1,0]
    v_pk_mul_f32 v[50:51], v[50:51], v[146:147] neg_lo:[1,0] neg_hi:[1,0]
    v_pk_mul_f32 v[52:53], v[52:53], v[148:149] neg_lo:[1,0] neg_hi:[1,0]
    v_pk_mul_f32 v[54:55], v[54:55], v[150:151] neg_lo:[1,0] neg_hi:[1,0]
    v_pk_mul_f32 v[56:57], v[56:57], v[152:153] neg_lo:[1,0] neg_hi:[1,0]
    v_pk_mul_f32 v[58:59], v[58:59], v[154:155] neg_lo:[1,0] neg_hi:[1,0]
    v_pk_mul_f32 v[60:61], v[60:61], v[156:157] neg_lo:[1,0] neg_hi:[1,0]
    v_pk_mul_f32 v[62:63], v[62:63], v[158:159] neg_lo:[1,0] neg_hi:[1,0]
    v_mfma_f32_32x32x16_bf16 v[16:31], a[0:3], v[72:75], 0
    ds_read_b128 a[20:23], v2 offset:41984
    ds_read_b128 a[0:3], v3 offset:32768
    v_exp_f32 v48, v48
    v_exp_f32 v49, v49
    v_mfma_f32_32x32x16_bf16 v[16:31], a[4:7], v[76:79], v[16:31]
    s_add_u32 s55, s56, 122880
    buffer_store_dwordx4 v[96:99], v9, s[28:31], s55 offen offset:0 sc1
    buffer_store_dwordx4 v[112:115], v9, s[28:31], s55 offen offset:64 sc1
    buffer_store_dwordx4 v[128:131], v9, s[28:31], s55 offen offset:128 sc1
    v_exp_f32 v50, v50
    v_mfma_f32_32x32x16_bf16 v[16:31], a[8:11], v[80:83], v[16:31]
    ds_read_b128 a[4:7], v3 offset:33792
    ds_read_b128 a[8:11], v3 offset:34816
    v_exp_f32 v51, v51
    v_exp_f32 v52, v52
    v_mfma_f32_32x32x16_bf16 v[16:31], a[12:15], v[84:87], v[16:31]
    v_exp_f32 v53, v53
    v_exp_f32 v54, v54
    v_exp_f32 v55, v55
    v_mfma_f32_32x32x16_bf16 v[16:31], a[16:19], v[88:91], v[16:31]
    s_waitcnt lgkmcnt(3)
    ds_read_b128 a[12:15], v3 offset:35840
    ds_read_b128 a[16:19], v3 offset:36864
    v_exp_f32 v56, v56
    v_exp_f32 v57, v57
    v_mfma_f32_32x32x16_bf16 v[16:31], a[20:23], v[92:95], v[16:31]
    s_waitcnt lgkmcnt(4)
    v_cvt_pk_bf16_f32 v64, v32, v33
    v_cvt_pk_bf16_f32 v65, v34, v35
    v_cvt_pk_bf16_f32 v66, v36, v37
    v_cvt_pk_bf16_f32 v67, v38, v39
    v_cvt_pk_bf16_f32 v68, v40, v41
    v_cvt_pk_bf16_f32 v69, v42, v43
    v_cvt_pk_bf16_f32 v70, v44, v45
    v_cvt_pk_bf16_f32 v71, v46, v47
    v_exp_f32 v58, v58
    v_exp_f32 v59, v59
    v_exp_f32 v60, v60
    v_exp_f32 v61, v61
    v_exp_f32 v62, v62
    v_exp_f32 v63, v63
    v_pk_add_f32 v[48:49], v[48:49], 1.0 op_sel_hi:[1,0]
    v_pk_add_f32 v[50:51], v[50:51], 1.0 op_sel_hi:[1,0]
    v_pk_add_f32 v[52:53], v[52:53], 1.0 op_sel_hi:[1,0]
    v_pk_add_f32 v[54:55], v[54:55], 1.0 op_sel_hi:[1,0]
    v_pk_add_f32 v[56:57], v[56:57], 1.0 op_sel_hi:[1,0]
    v_pk_add_f32 v[58:59], v[58:59], 1.0 op_sel_hi:[1,0]
    v_pk_add_f32 v[60:61], v[60:61], 1.0 op_sel_hi:[1,0]
    v_pk_add_f32 v[62:63], v[62:63], 1.0 op_sel_hi:[1,0]
    v_mfma_f32_32x32x16_bf16 v[160:175], a[0:3], v[64:67], v[160:175]
    s_waitcnt lgkmcnt(3)
    ds_read_b128 a[20:23], v3 offset:37888
    ds_read_b128 a[0:3], v2 offset:43008
    v_rcp_f32 v48, v48
    v_rcp_f32 v49, v49
    v_mfma_f32_32x32x16_bf16 v[176:191], a[4:7], v[64:67], v[176:191]
    s_waitcnt lgkmcnt(4)
    v_rcp_f32 v50, v50
    v_rcp_f32 v51, v51
    v_rcp_f32 v52, v52
    v_mfma_f32_32x32x16_bf16 v[192:207], a[8:11], v[64:67], v[192:207]
    s_waitcnt lgkmcnt(3)
    ds_read_b128 a[4:7], v2 offset:44032
    ds_read_b128 a[8:11], v2 offset:45056
    v_rcp_f32 v53, v53
    v_rcp_f32 v54, v54
    v_mfma_f32_32x32x16_bf16 v[160:175], a[12:15], v[68:71], v[160:175]
    s_waitcnt lgkmcnt(4)
    v_rcp_f32 v55, v55
    v_rcp_f32 v56, v56
    v_rcp_f32 v57, v57
    v_mfma_f32_32x32x16_bf16 v[176:191], a[16:19], v[68:71], v[176:191]
    s_waitcnt lgkmcnt(3)
    ds_read_b128 a[12:15], v2 offset:46080
    ds_read_b128 a[16:19], v2 offset:47104
    v_rcp_f32 v58, v58
    v_rcp_f32 v59, v59
    v_mfma_f32_32x32x16_bf16 v[192:207], a[20:23], v[68:71], v[192:207]
    s_waitcnt lgkmcnt(4)
    v_rcp_f32 v60, v60
    v_rcp_f32 v61, v61
    v_rcp_f32 v62, v62
    v_rcp_f32 v63, v63
    v_pk_mul_f32 v[144:145], v[144:145], v[48:49]
    v_pk_mul_f32 v[146:147], v[146:147], v[50:51]
    v_pk_mul_f32 v[148:149], v[148:149], v[52:53]
    v_pk_mul_f32 v[150:151], v[150:151], v[54:55]
    v_pk_mul_f32 v[152:153], v[152:153], v[56:57]
    v_pk_mul_f32 v[154:155], v[154:155], v[58:59]
    v_pk_mul_f32 v[156:157], v[156:157], v[60:61]
    v_pk_mul_f32 v[158:159], v[158:159], v[62:63]
    v_pk_fma_f32 v[48:49], v[16:17], v[16:17], s[52:53]
    v_pk_fma_f32 v[50:51], v[18:19], v[18:19], s[52:53]
    v_pk_fma_f32 v[52:53], v[20:21], v[20:21], s[52:53]
    v_pk_fma_f32 v[54:55], v[22:23], v[22:23], s[52:53]
    v_pk_fma_f32 v[56:57], v[24:25], v[24:25], s[52:53]
    v_pk_fma_f32 v[58:59], v[26:27], v[26:27], s[52:53]
    v_pk_fma_f32 v[60:61], v[28:29], v[28:29], s[52:53]
    v_pk_fma_f32 v[62:63], v[30:31], v[30:31], s[52:53]
    v_pk_mul_f32 v[48:49], v[48:49], v[16:17] neg_lo:[1,0] neg_hi:[1,0]
    v_pk_mul_f32 v[50:51], v[50:51], v[18:19] neg_lo:[1,0] neg_hi:[1,0]
    v_pk_mul_f32 v[52:53], v[52:53], v[20:21] neg_lo:[1,0] neg_hi:[1,0]
    v_pk_mul_f32 v[54:55], v[54:55], v[22:23] neg_lo:[1,0] neg_hi:[1,0]
    v_pk_mul_f32 v[56:57], v[56:57], v[24:25] neg_lo:[1,0] neg_hi:[1,0]
    v_pk_mul_f32 v[58:59], v[58:59], v[26:27] neg_lo:[1,0] neg_hi:[1,0]
    v_pk_mul_f32 v[60:61], v[60:61], v[28:29] neg_lo:[1,0] neg_hi:[1,0]
    v_pk_mul_f32 v[62:63], v[62:63], v[30:31] neg_lo:[1,0] neg_hi:[1,0]
    v_mfma_f32_32x32x16_bf16 v[32:47], a[0:3], v[72:75], 0
    s_waitcnt lgkmcnt(3)
    ds_read_b128 a[20:23], v2 offset:48128
    ds_read_b128 a[0:3], v3 offset:38912
    v_exp_f32 v48, v48
    v_exp_f32 v49, v49
    v_mfma_f32_32x32x16_bf16 v[32:47], a[4:7], v[76:79], v[32:47]
    s_waitcnt lgkmcnt(4)
    v_exp_f32 v50, v50
    v_exp_f32 v51, v51
    v_exp_f32 v52, v52
    v_mfma_f32_32x32x16_bf16 v[32:47], a[8:11], v[80:83], v[32:47]
    s_waitcnt lgkmcnt(3)
    ds_read_b128 a[4:7], v3 offset:39936
    ds_read_b128 a[8:11], v3 offset:40960
    v_exp_f32 v53, v53
    v_exp_f32 v54, v54
    v_mfma_f32_32x32x16_bf16 v[32:47], a[12:15], v[84:87], v[32:47]
    s_waitcnt lgkmcnt(4)
    v_exp_f32 v55, v55
    v_exp_f32 v56, v56
    v_exp_f32 v57, v57
    v_mfma_f32_32x32x16_bf16 v[32:47], a[16:19], v[88:91], v[32:47]
    s_waitcnt lgkmcnt(3)
    ds_read_b128 a[12:15], v3 offset:41984
    ds_read_b128 a[16:19], v3 offset:43008
    v_exp_f32 v58, v58
    v_exp_f32 v59, v59
    v_mfma_f32_32x32x16_bf16 v[32:47], a[20:23], v[92:95], v[32:47]
    s_waitcnt lgkmcnt(4)
    v_cvt_pk_bf16_f32 v64, v144, v145
    v_cvt_pk_bf16_f32 v65, v146, v147
    v_cvt_pk_bf16_f32 v66, v148, v149
    v_cvt_pk_bf16_f32 v67, v150, v151
    v_cvt_pk_bf16_f32 v68, v152, v153
    v_cvt_pk_bf16_f32 v69, v154, v155
    v_cvt_pk_bf16_f32 v70, v156, v157
    v_cvt_pk_bf16_f32 v71, v158, v159
    v_exp_f32 v60, v60
    v_exp_f32 v61, v61
    v_exp_f32 v62, v62
    v_exp_f32 v63, v63
    v_pk_add_f32 v[48:49], v[48:49], 1.0 op_sel_hi:[1,0]
    v_pk_add_f32 v[50:51], v[50:51], 1.0 op_sel_hi:[1,0]
    v_pk_add_f32 v[52:53], v[52:53], 1.0 op_sel_hi:[1,0]
    v_pk_add_f32 v[54:55], v[54:55], 1.0 op_sel_hi:[1,0]
    v_pk_add_f32 v[56:57], v[56:57], 1.0 op_sel_hi:[1,0]
    v_pk_add_f32 v[58:59], v[58:59], 1.0 op_sel_hi:[1,0]
    v_pk_add_f32 v[60:61], v[60:61], 1.0 op_sel_hi:[1,0]
    v_pk_add_f32 v[62:63], v[62:63], 1.0 op_sel_hi:[1,0]
    v_mfma_f32_32x32x16_bf16 v[160:175], a[0:3], v[64:67], v[160:175]
    s_waitcnt lgkmcnt(3)
    ds_read_b128 a[20:23], v3 offset:44032
    ds_read_b128 a[0:3], v2 offset:49152
    v_rcp_f32 v48, v48
    v_rcp_f32 v49, v49
    v_mfma_f32_32x32x16_bf16 v[176:191], a[4:7], v[64:67], v[176:191]
    s_waitcnt lgkmcnt(4)
    s_add_u32 s54, s56, 98304
    buffer_load_dwordx4 v[208:211], v1, s[24:27], s54 offen offset:0
    buffer_load_dwordx4 v[212:215], v1, s[24:27], s54 offen offset:32
    v_rcp_f32 v50, v50
    v_rcp_f32 v51, v51
    v_mfma_f32_32x32x16_bf16 v[192:207], a[8:11], v[64:67], v[192:207]
    s_waitcnt lgkmcnt(3)
    ds_read_b128 a[4:7], v2 offset:50176
    ds_read_b128 a[8:11], v2 offset:51200
    v_rcp_f32 v52, v52
    v_rcp_f32 v53, v53
    v_mfma_f32_32x32x16_bf16 v[160:175], a[12:15], v[68:71], v[160:175]
    s_waitcnt lgkmcnt(4)
    v_rcp_f32 v54, v54
    v_rcp_f32 v55, v55
    v_rcp_f32 v56, v56
    v_mfma_f32_32x32x16_bf16 v[176:191], a[16:19], v[68:71], v[176:191]
    s_waitcnt lgkmcnt(3)
    ds_read_b128 a[12:15], v2 offset:52224
    ds_read_b128 a[16:19], v2 offset:53248
    v_rcp_f32 v57, v57
    v_rcp_f32 v58, v58
    v_mfma_f32_32x32x16_bf16 v[192:207], a[20:23], v[68:71], v[192:207]
    s_waitcnt lgkmcnt(4)
    v_rcp_f32 v59, v59
    v_rcp_f32 v60, v60
    v_rcp_f32 v61, v61
    v_rcp_f32 v62, v62
    v_rcp_f32 v63, v63
    v_pk_mul_f32 v[16:17], v[16:17], v[48:49]
    v_pk_mul_f32 v[18:19], v[18:19], v[50:51]
    v_pk_mul_f32 v[20:21], v[20:21], v[52:53]
    v_pk_mul_f32 v[22:23], v[22:23], v[54:55]
    v_pk_mul_f32 v[24:25], v[24:25], v[56:57]
    v_pk_mul_f32 v[26:27], v[26:27], v[58:59]
    v_pk_mul_f32 v[28:29], v[28:29], v[60:61]
    v_pk_mul_f32 v[30:31], v[30:31], v[62:63]
    v_pk_fma_f32 v[48:49], v[32:33], v[32:33], s[52:53]
    v_pk_fma_f32 v[50:51], v[34:35], v[34:35], s[52:53]
    v_pk_fma_f32 v[52:53], v[36:37], v[36:37], s[52:53]
    v_pk_fma_f32 v[54:55], v[38:39], v[38:39], s[52:53]
    v_pk_fma_f32 v[56:57], v[40:41], v[40:41], s[52:53]
    v_pk_fma_f32 v[58:59], v[42:43], v[42:43], s[52:53]
    v_pk_fma_f32 v[60:61], v[44:45], v[44:45], s[52:53]
    v_pk_fma_f32 v[62:63], v[46:47], v[46:47], s[52:53]
    v_pk_mul_f32 v[48:49], v[48:49], v[32:33] neg_lo:[1,0] neg_hi:[1,0]
    v_pk_mul_f32 v[50:51], v[50:51], v[34:35] neg_lo:[1,0] neg_hi:[1,0]
    v_pk_mul_f32 v[52:53], v[52:53], v[36:37] neg_lo:[1,0] neg_hi:[1,0]
    v_pk_mul_f32 v[54:55], v[54:55], v[38:39] neg_lo:[1,0] neg_hi:[1,0]
    v_pk_mul_f32 v[56:57], v[56:57], v[40:41] neg_lo:[1,0] neg_hi:[1,0]
    v_pk_mul_f32 v[58:59], v[58:59], v[42:43] neg_lo:[1,0] neg_hi:[1,0]
    v_pk_mul_f32 v[60:61], v[60:61], v[44:45] neg_lo:[1,0] neg_hi:[1,0]
    v_pk_mul_f32 v[62:63], v[62:63], v[46:47] neg_lo:[1,0] neg_hi:[1,0]
    v_mfma_f32_32x32x16_bf16 v[144:159], a[0:3], v[72:75], 0
    s_waitcnt lgkmcnt(3)
    ds_read_b128 a[20:23], v2 offset:54272
    ds_read_b128 a[0:3], v3 offset:45056
    v_exp_f32 v48, v48
    v_exp_f32 v49, v49
    v_mfma_f32_32x32x16_bf16 v[144:159], a[4:7], v[76:79], v[144:159]
    s_waitcnt lgkmcnt(4)
    v_exp_f32 v50, v50
    v_exp_f32 v51, v51
    v_exp_f32 v52, v52
    v_mfma_f32_32x32x16_bf16 v[144:159], a[8:11], v[80:83], v[144:159]
    s_waitcnt lgkmcnt(3)
    ds_read_b128 a[4:7], v3 offset:46080
    ds_read_b128 a[8:11], v3 offset:47104
    v_exp_f32 v53, v53
    v_exp_f32 v54, v54
    v_mfma_f32_32x32x16_bf16 v[144:159], a[12:15], v[84:87], v[144:159]
    s_waitcnt lgkmcnt(4)
    v_exp_f32 v55, v55
    v_exp_f32 v56, v56
    v_exp_f32 v57, v57
    v_mfma_f32_32x32x16_bf16 v[144:159], a[16:19], v[88:91], v[144:159]
    s_waitcnt lgkmcnt(3)
    ds_read_b128 a[12:15], v3 offset:48128
    ds_read_b128 a[16:19], v3 offset:49152
    v_exp_f32 v58, v58
    v_exp_f32 v59, v59
    v_mfma_f32_32x32x16_bf16 v[144:159], a[20:23], v[92:95], v[144:159]
    s_waitcnt lgkmcnt(4)
    v_cvt_pk_bf16_f32 v64, v16, v17
    v_cvt_pk_bf16_f32 v65, v18, v19
    v_cvt_pk_bf16_f32 v66, v20, v21
    v_cvt_pk_bf16_f32 v67, v22, v23
    v_cvt_pk_bf16_f32 v68, v24, v25
    v_cvt_pk_bf16_f32 v69, v26, v27
    v_cvt_pk_bf16_f32 v70, v28, v29
    v_cvt_pk_bf16_f32 v71, v30, v31
    v_exp_f32 v60, v60
    v_exp_f32 v61, v61
    v_exp_f32 v62, v62
    v_exp_f32 v63, v63
    v_pk_add_f32 v[48:49], v[48:49], 1.0 op_sel_hi:[1,0]
    v_pk_add_f32 v[50:51], v[50:51], 1.0 op_sel_hi:[1,0]
    v_pk_add_f32 v[52:53], v[52:53], 1.0 op_sel_hi:[1,0]
    v_pk_add_f32 v[54:55], v[54:55], 1.0 op_sel_hi:[1,0]
    v_pk_add_f32 v[56:57], v[56:57], 1.0 op_sel_hi:[1,0]
    v_pk_add_f32 v[58:59], v[58:59], 1.0 op_sel_hi:[1,0]
    v_pk_add_f32 v[60:61], v[60:61], 1.0 op_sel_hi:[1,0]
    v_pk_add_f32 v[62:63], v[62:63], 1.0 op_sel_hi:[1,0]
    v_mfma_f32_32x32x16_bf16 v[160:175], a[0:3], v[64:67], v[160:175]
    s_waitcnt lgkmcnt(3)
    ds_read_b128 a[20:23], v3 offset:50176
    ds_read_b128 a[0:3], v2 offset:55296
    v_rcp_f32 v48, v48
    v_rcp_f32 v49, v49
    v_mfma_f32_32x32x16_bf16 v[176:191], a[4:7], v[64:67], v[176:191]
    s_waitcnt lgkmcnt(4)
    v_rcp_f32 v50, v50
    v_rcp_f32 v51, v51
    v_rcp_f32 v52, v52
    v_mfma_f32_32x32x16_bf16 v[192:207], a[8:11], v[64:67], v[192:207]
    s_waitcnt lgkmcnt(3)
    ds_read_b128 a[4:7], v2 offset:56320
    ds_read_b128 a[8:11], v2 offset:57344
    v_rcp_f32 v53, v53
    v_rcp_f32 v54, v54
    v_mfma_f32_32x32x16_bf16 v[160:175], a[12:15], v[68:71], v[160:175]
    s_waitcnt lgkmcnt(4)
    v_rcp_f32 v55, v55
    v_rcp_f32 v56, v56
    v_rcp_f32 v57, v57
    v_mfma_f32_32x32x16_bf16 v[176:191], a[16:19], v[68:71], v[176:191]
    s_waitcnt lgkmcnt(3)
    ds_read_b128 a[12:15], v2 offset:58368
    ds_read_b128 a[16:19], v2 offset:59392
    v_rcp_f32 v58, v58
    v_rcp_f32 v59, v59
    v_mfma_f32_32x32x16_bf16 v[192:207], a[20:23], v[68:71], v[192:207]
    s_waitcnt lgkmcnt(4)
    v_rcp_f32 v60, v60
    v_rcp_f32 v61, v61
    v_rcp_f32 v62, v62
    v_rcp_f32 v63, v63
    v_pk_mul_f32 v[32:33], v[32:33], v[48:49]
    v_pk_mul_f32 v[34:35], v[34:35], v[50:51]
    v_pk_mul_f32 v[36:37], v[36:37], v[52:53]
    v_pk_mul_f32 v[38:39], v[38:39], v[54:55]
    v_pk_mul_f32 v[40:41], v[40:41], v[56:57]
    v_pk_mul_f32 v[42:43], v[42:43], v[58:59]
    v_pk_mul_f32 v[44:45], v[44:45], v[60:61]
    v_pk_mul_f32 v[46:47], v[46:47], v[62:63]
    v_pk_fma_f32 v[48:49], v[144:145], v[144:145], s[52:53]
    v_pk_fma_f32 v[50:51], v[146:147], v[146:147], s[52:53]
    v_pk_fma_f32 v[52:53], v[148:149], v[148:149], s[52:53]
    v_pk_fma_f32 v[54:55], v[150:151], v[150:151], s[52:53]
    v_pk_fma_f32 v[56:57], v[152:153], v[152:153], s[52:53]
    v_pk_fma_f32 v[58:59], v[154:155], v[154:155], s[52:53]
    v_pk_fma_f32 v[60:61], v[156:157], v[156:157], s[52:53]
    v_pk_fma_f32 v[62:63], v[158:159], v[158:159], s[52:53]
    v_pk_mul_f32 v[48:49], v[48:49], v[144:145] neg_lo:[1,0] neg_hi:[1,0]
    v_pk_mul_f32 v[50:51], v[50:51], v[146:147] neg_lo:[1,0] neg_hi:[1,0]
    v_pk_mul_f32 v[52:53], v[52:53], v[148:149] neg_lo:[1,0] neg_hi:[1,0]
    v_pk_mul_f32 v[54:55], v[54:55], v[150:151] neg_lo:[1,0] neg_hi:[1,0]
    v_pk_mul_f32 v[56:57], v[56:57], v[152:153] neg_lo:[1,0] neg_hi:[1,0]
    v_pk_mul_f32 v[58:59], v[58:59], v[154:155] neg_lo:[1,0] neg_hi:[1,0]
    v_pk_mul_f32 v[60:61], v[60:61], v[156:157] neg_lo:[1,0] neg_hi:[1,0]
    v_pk_mul_f32 v[62:63], v[62:63], v[158:159] neg_lo:[1,0] neg_hi:[1,0]
    v_mfma_f32_32x32x16_bf16 v[16:31], a[0:3], v[72:75], 0
    s_waitcnt lgkmcnt(3)
    ds_read_b128 a[20:23], v2 offset:60416
    ds_read_b128 a[0:3], v3 offset:51200
    v_exp_f32 v48, v48
    v_exp_f32 v49, v49
    v_mfma_f32_32x32x16_bf16 v[16:31], a[4:7], v[76:79], v[16:31]
    s_waitcnt lgkmcnt(4)
    buffer_load_dwordx2 v[12:13], v2, s[44:47], s58 offen offset:1024
    v_exp_f32 v50, v50
    v_exp_f32 v51, v51
    v_cvt_pk_bf16_f32 v64, v32, v33
    v_mfma_f32_32x32x16_bf16 v[16:31], a[8:11], v[80:83], v[16:31]
    s_waitcnt lgkmcnt(3)
    ds_read_b128 a[4:7], v3 offset:52224
    ds_read_b128 a[8:11], v3 offset:53248
    v_exp_f32 v52, v52
    v_exp_f32 v53, v53
    v_mfma_f32_32x32x16_bf16 v[16:31], a[12:15], v[84:87], v[16:31]
    s_waitcnt lgkmcnt(4)
    buffer_load_dwordx4 v[216:219], v1, s[24:27], s54 offen offset:64
    buffer_load_dwordx4 v[220:223], v1, s[24:27], s54 offen offset:96
    v_exp_f32 v54, v54
    v_exp_f32 v55, v55
    v_mfma_f32_32x32x16_bf16 v[16:31], a[16:19], v[88:91], v[16:31]
    s_waitcnt lgkmcnt(3)
    ds_read_b128 a[12:15], v3 offset:54272
    ds_read_b128 a[16:19], v3 offset:55296
    v_exp_f32 v56, v56
    v_exp_f32 v57, v57
    v_mfma_f32_32x32x16_bf16 v[16:31], a[20:23], v[92:95], v[16:31]
    s_waitcnt lgkmcnt(4)
    v_cvt_pk_bf16_f32 v65, v34, v35
    v_cvt_pk_bf16_f32 v66, v36, v37
    v_cvt_pk_bf16_f32 v67, v38, v39
    v_cvt_pk_bf16_f32 v68, v40, v41
    v_cvt_pk_bf16_f32 v69, v42, v43
    v_cvt_pk_bf16_f32 v70, v44, v45
    v_cvt_pk_bf16_f32 v71, v46, v47
    v_exp_f32 v58, v58
    v_exp_f32 v59, v59
    v_exp_f32 v60, v60
    v_exp_f32 v61, v61
    v_exp_f32 v62, v62
    v_exp_f32 v63, v63
    v_pk_add_f32 v[48:49], v[48:49], 1.0 op_sel_hi:[1,0]
    v_pk_add_f32 v[50:51], v[50:51], 1.0 op_sel_hi:[1,0]
    v_pk_add_f32 v[52:53], v[52:53], 1.0 op_sel_hi:[1,0]
    v_pk_add_f32 v[54:55], v[54:55], 1.0 op_sel_hi:[1,0]
    v_pk_add_f32 v[56:57], v[56:57], 1.0 op_sel_hi:[1,0]
    v_pk_add_f32 v[58:59], v[58:59], 1.0 op_sel_hi:[1,0]
    v_pk_add_f32 v[60:61], v[60:61], 1.0 op_sel_hi:[1,0]
    v_pk_add_f32 v[62:63], v[62:63], 1.0 op_sel_hi:[1,0]
    v_mfma_f32_32x32x16_bf16 v[160:175], a[0:3], v[64:67], v[160:175]
    s_waitcnt lgkmcnt(3)
    ds_read_b128 a[20:23], v3 offset:56320
    ds_read_b128 a[0:3], v2 offset:61440
    v_rcp_f32 v48, v48
    v_rcp_f32 v49, v49
    v_mfma_f32_32x32x16_bf16 v[176:191], a[4:7], v[64:67], v[176:191]
    s_waitcnt lgkmcnt(4)
    buffer_store_dwordx4 v[100:103], v9, s[28:31], s55 offen offset:3072 sc1
    buffer_store_dwordx4 v[116:119], v9, s[28:31], s55 offen offset:3136 sc1
    buffer_store_dwordx4 v[132:135], v9, s[28:31], s55 offen offset:3200 sc1
    v_rcp_f32 v50, v50
    v_rcp_f32 v51, v51
    v_mfma_f32_32x32x16_bf16 v[192:207], a[8:11], v[64:67], v[192:207]
    s_waitcnt lgkmcnt(3)
    ds_read_b128 a[4:7], v2 offset:62464
    ds_read_b128 a[8:11], v2 offset:63488
    v_rcp_f32 v52, v52
    v_rcp_f32 v53, v53
    v_mfma_f32_32x32x16_bf16 v[160:175], a[12:15], v[68:71], v[160:175]
    s_waitcnt lgkmcnt(4)
    v_rcp_f32 v54, v54
    v_rcp_f32 v55, v55
    v_rcp_f32 v56, v56
    v_mfma_f32_32x32x16_bf16 v[176:191], a[16:19], v[68:71], v[176:191]
    s_waitcnt lgkmcnt(3)
    ds_read_b128 a[12:15], v2 offset:64512
    ds_read_b128 a[16:19], v3 offset:0
    v_rcp_f32 v57, v57
    v_rcp_f32 v58, v58
    v_mfma_f32_32x32x16_bf16 v[192:207], a[20:23], v[68:71], v[192:207]
    s_waitcnt lgkmcnt(4)
    v_rcp_f32 v59, v59
    v_rcp_f32 v60, v60
    v_rcp_f32 v61, v61
    v_rcp_f32 v62, v62
    v_rcp_f32 v63, v63
    v_pk_mul_f32 v[144:145], v[144:145], v[48:49]
    v_pk_mul_f32 v[146:147], v[146:147], v[50:51]
    v_pk_mul_f32 v[148:149], v[148:149], v[52:53]
    v_pk_mul_f32 v[150:151], v[150:151], v[54:55]
    v_pk_mul_f32 v[152:153], v[152:153], v[56:57]
    v_pk_mul_f32 v[154:155], v[154:155], v[58:59]
    v_pk_mul_f32 v[156:157], v[156:157], v[60:61]
    v_pk_mul_f32 v[158:159], v[158:159], v[62:63]
    v_pk_fma_f32 v[48:49], v[16:17], v[16:17], s[52:53]
    v_pk_fma_f32 v[50:51], v[18:19], v[18:19], s[52:53]
    v_pk_fma_f32 v[52:53], v[20:21], v[20:21], s[52:53]
    v_pk_fma_f32 v[54:55], v[22:23], v[22:23], s[52:53]
    v_pk_fma_f32 v[56:57], v[24:25], v[24:25], s[52:53]
    v_pk_fma_f32 v[58:59], v[26:27], v[26:27], s[52:53]
    v_pk_fma_f32 v[60:61], v[28:29], v[28:29], s[52:53]
    v_pk_fma_f32 v[62:63], v[30:31], v[30:31], s[52:53]
    v_pk_mul_f32 v[48:49], v[48:49], v[16:17] neg_lo:[1,0] neg_hi:[1,0]
    v_pk_mul_f32 v[50:51], v[50:51], v[18:19] neg_lo:[1,0] neg_hi:[1,0]
    v_pk_mul_f32 v[52:53], v[52:53], v[20:21] neg_lo:[1,0] neg_hi:[1,0]
    v_pk_mul_f32 v[54:55], v[54:55], v[22:23] neg_lo:[1,0] neg_hi:[1,0]
    v_pk_mul_f32 v[56:57], v[56:57], v[24:25] neg_lo:[1,0] neg_hi:[1,0]
    v_pk_mul_f32 v[58:59], v[58:59], v[26:27] neg_lo:[1,0] neg_hi:[1,0]
    v_pk_mul_f32 v[60:61], v[60:61], v[28:29] neg_lo:[1,0] neg_hi:[1,0]
    v_pk_mul_f32 v[62:63], v[62:63], v[30:31] neg_lo:[1,0] neg_hi:[1,0]
    v_mfma_f32_32x32x16_bf16 v[32:47], a[0:3], v[72:75], 0
    s_waitcnt lgkmcnt(3)
    ds_read_b128 a[20:23], v3 offset:1024
    ds_read_b128 a[0:3], v3 offset:2048
    v_exp_f32 v48, v48
    v_exp_f32 v49, v49
    v_mfma_f32_32x32x16_bf16 v[32:47], a[4:7], v[76:79], v[32:47]
    s_waitcnt lgkmcnt(4)
    v_exp_f32 v50, v50
    v_exp_f32 v51, v51
    v_exp_f32 v52, v52
    v_mfma_f32_32x32x16_bf16 v[32:47], a[8:11], v[80:83], v[32:47]
    s_waitcnt lgkmcnt(3)
    ds_read_b128 a[4:7], v3 offset:3072
    ds_read_b128 a[8:11], v3 offset:4096
    v_exp_f32 v53, v53
    v_exp_f32 v54, v54
    v_mfma_f32_32x32x16_bf16 v[32:47], a[12:15], v[84:87], v[32:47]
    s_waitcnt lgkmcnt(4)
    v_exp_f32 v55, v55
    v_exp_f32 v56, v56
    v_exp_f32 v57, v57
    v_mfma_f32_32x32x16_bf16 v[32:47], a[16:19], v[88:91], v[32:47]
    s_waitcnt lgkmcnt(3)
    ds_read_b128 a[12:15], v3 offset:5120
    ds_read_b128 a[16:19], v3 offset:6144
    v_exp_f32 v58, v58
    v_exp_f32 v59, v59
    v_mfma_f32_32x32x16_bf16 v[32:47], a[20:23], v[92:95], v[32:47]
    s_waitcnt lgkmcnt(4)
    v_cvt_pk_bf16_f32 v64, v144, v145
    v_cvt_pk_bf16_f32 v65, v146, v147
    v_cvt_pk_bf16_f32 v66, v148, v149
    v_cvt_pk_bf16_f32 v67, v150, v151
    v_exp_f32 v60, v60
    v_exp_f32 v61, v61
    v_exp_f32 v62, v62
    v_exp_f32 v63, v63
    v_pk_add_f32 v[48:49], v[48:49], 1.0 op_sel_hi:[1,0]
    v_pk_add_f32 v[50:51], v[50:51], 1.0 op_sel_hi:[1,0]
    v_pk_add_f32 v[52:53], v[52:53], 1.0 op_sel_hi:[1,0]
    v_pk_add_f32 v[54:55], v[54:55], 1.0 op_sel_hi:[1,0]
    v_pk_add_f32 v[56:57], v[56:57], 1.0 op_sel_hi:[1,0]
    v_pk_add_f32 v[58:59], v[58:59], 1.0 op_sel_hi:[1,0]
    v_pk_add_f32 v[60:61], v[60:61], 1.0 op_sel_hi:[1,0]
    v_pk_add_f32 v[62:63], v[62:63], 1.0 op_sel_hi:[1,0]
    v_mfma_f32_32x32x16_bf16 v[160:175], a[224:227], v[64:67], v[160:175]
    buffer_load_dwordx4 v[224:227], v1, s[24:27], s54 offen offset:128
    buffer_load_dwordx4 v[228:231], v1, s[24:27], s54 offen offset:160
    v_cvt_pk_bf16_f32 v68, v152, v153
    v_cvt_pk_bf16_f32 v69, v154, v155
    v_cvt_pk_bf16_f32 v70, v156, v157
    v_cvt_pk_bf16_f32 v71, v158, v159
    v_mfma_f32_32x32x16_bf16 v[176:191], a[228:231], v[64:67], v[176:191]
    ds_read_b128 v[104:107], v5 offset:64
    v_rcp_f32 v48, v48
    v_rcp_f32 v49, v49
    v_rcp_f32 v50, v50
    v_mfma_f32_32x32x16_bf16 v[192:207], a[232:235], v[64:67], v[192:207]
    ds_read_b128 v[108:111], v5 offset:80
    v_rcp_f32 v51, v51
    v_rcp_f32 v52, v52
    v_rcp_f32 v53, v53
    v_mfma_f32_32x32x16_bf16 v[160:175], a[236:239], v[68:71], v[160:175]
    ds_read_b128 v[96:99], v5 offset:0
    v_rcp_f32 v54, v54
    v_rcp_f32 v55, v55
    v_rcp_f32 v56, v56
    v_mfma_f32_32x32x16_bf16 v[176:191], a[240:243], v[68:71], v[176:191]
    ds_read_b128 v[100:103], v5 offset:16
    v_rcp_f32 v57, v57
    v_rcp_f32 v58, v58
    v_mfma_f32_32x32x16_bf16 v[192:207], a[244:247], v[68:71], v[192:207]
    v_rcp_f32 v59, v59
    v_rcp_f32 v60, v60
    v_rcp_f32 v61, v61
    v_rcp_f32 v62, v62
    v_rcp_f32 v63, v63
    v_pk_mul_f32 v[16:17], v[16:17], v[48:49]
    v_pk_mul_f32 v[18:19], v[18:19], v[50:51]
    v_pk_mul_f32 v[20:21], v[20:21], v[52:53]
    v_pk_mul_f32 v[22:23], v[22:23], v[54:55]
    v_pk_mul_f32 v[24:25], v[24:25], v[56:57]
    v_pk_mul_f32 v[26:27], v[26:27], v[58:59]
    v_pk_mul_f32 v[28:29], v[28:29], v[60:61]
    v_pk_mul_f32 v[30:31], v[30:31], v[62:63]
    v_pk_fma_f32 v[48:49], v[32:33], v[32:33], s[52:53]
    v_pk_fma_f32 v[50:51], v[34:35], v[34:35], s[52:53]
    v_pk_fma_f32 v[52:53], v[36:37], v[36:37], s[52:53]
    v_pk_fma_f32 v[54:55], v[38:39], v[38:39], s[52:53]
    v_pk_fma_f32 v[56:57], v[40:41], v[40:41], s[52:53]
    v_pk_fma_f32 v[58:59], v[42:43], v[42:43], s[52:53]
    v_pk_fma_f32 v[60:61], v[44:45], v[44:45], s[52:53]
    v_pk_fma_f32 v[62:63], v[46:47], v[46:47], s[52:53]
    v_pk_mul_f32 v[48:49], v[48:49], v[32:33] neg_lo:[1,0] neg_hi:[1,0]
    v_pk_mul_f32 v[50:51], v[50:51], v[34:35] neg_lo:[1,0] neg_hi:[1,0]
    v_pk_mul_f32 v[52:53], v[52:53], v[36:37] neg_lo:[1,0] neg_hi:[1,0]
    v_pk_mul_f32 v[54:55], v[54:55], v[38:39] neg_lo:[1,0] neg_hi:[1,0]
    v_pk_mul_f32 v[56:57], v[56:57], v[40:41] neg_lo:[1,0] neg_hi:[1,0]
    v_pk_mul_f32 v[58:59], v[58:59], v[42:43] neg_lo:[1,0] neg_hi:[1,0]
    v_pk_mul_f32 v[60:61], v[60:61], v[44:45] neg_lo:[1,0] neg_hi:[1,0]
    v_pk_mul_f32 v[62:63], v[62:63], v[46:47] neg_lo:[1,0] neg_hi:[1,0]
    v_mfma_f32_32x32x16_bf16 v[144:159], a[0:3], v[72:75], 0
    s_waitcnt lgkmcnt(7)
    ds_read_b128 a[20:23], v3 offset:7168
    ds_read_b128 a[0:3], v3 offset:63488
    v_exp_f32 v48, v48
    v_exp_f32 v49, v49
    v_mfma_f32_32x32x16_bf16 v[144:159], a[4:7], v[76:79], v[144:159]
    s_waitcnt lgkmcnt(8)
    ds_read_b128 v[120:123], v5 offset:192
    ds_read_b128 v[124:127], v5 offset:208
    v_exp_f32 v50, v50
    v_exp_f32 v51, v51
    v_mfma_f32_32x32x16_bf16 v[144:159], a[8:11], v[80:83], v[144:159]
    s_waitcnt lgkmcnt(9)
    ds_read_b128 a[4:7], v3 offset:64512
    ds_read_b128 a[8:11], v4 offset:0
    v_exp_f32 v52, v52
    v_exp_f32 v53, v53
    v_mfma_f32_32x32x16_bf16 v[144:159], a[12:15], v[84:87], v[144:159]
    s_waitcnt lgkmcnt(10)
    ds_read_b128 v[112:115], v5 offset:128
    ds_read_b128 v[116:119], v5 offset:144
    v_exp_f32 v54, v54
    v_exp_f32 v55, v55
    v_mfma_f32_32x32x16_bf16 v[144:159], a[16:19], v[88:91], v[144:159]
    s_waitcnt lgkmcnt(7)
    ds_read_b128 a[12:15], v4 offset:1024
    ds_read_b128 a[16:19], v4 offset:2048
    v_exp_f32 v56, v56
    v_exp_f32 v57, v57
    v_mfma_f32_32x32x16_bf16 v[144:159], a[20:23], v[92:95], v[144:159]
    s_waitcnt lgkmcnt(8)
    v_cvt_pk_bf16_f32 v64, v16, v17
    v_cvt_pk_bf16_f32 v65, v18, v19
    v_cvt_pk_bf16_f32 v66, v20, v21
    v_cvt_pk_bf16_f32 v67, v22, v23
    v_cvt_pk_bf16_f32 v68, v24, v25
    v_cvt_pk_bf16_f32 v69, v26, v27
    v_cvt_pk_bf16_f32 v70, v28, v29
    v_cvt_pk_bf16_f32 v71, v30, v31
    v_exp_f32 v58, v58
    v_exp_f32 v59, v59
    v_exp_f32 v60, v60
    v_exp_f32 v61, v61
    v_exp_f32 v62, v62
    v_exp_f32 v63, v63
    v_pk_add_f32 v[48:49], v[48:49], 1.0 op_sel_hi:[1,0]
    v_pk_add_f32 v[50:51], v[50:51], 1.0 op_sel_hi:[1,0]
    v_pk_add_f32 v[52:53], v[52:53], 1.0 op_sel_hi:[1,0]
    v_pk_add_f32 v[54:55], v[54:55], 1.0 op_sel_hi:[1,0]
    v_pk_add_f32 v[56:57], v[56:57], 1.0 op_sel_hi:[1,0]
    v_pk_add_f32 v[58:59], v[58:59], 1.0 op_sel_hi:[1,0]
    v_pk_add_f32 v[60:61], v[60:61], 1.0 op_sel_hi:[1,0]
    v_pk_add_f32 v[62:63], v[62:63], 1.0 op_sel_hi:[1,0]
    v_mfma_f32_32x32x16_bf16 v[160:175], a[0:3], v[64:67], v[160:175]
    s_waitcnt lgkmcnt(5)
    ds_read_b128 a[20:23], v4 offset:3072
    ds_read_b128 a[0:3], v4 offset:4096
    v_rcp_f32 v48, v48
    v_rcp_f32 v49, v49
    v_mfma_f32_32x32x16_bf16 v[176:191], a[4:7], v[64:67], v[176:191]
    s_waitcnt lgkmcnt(6)
    ds_read_b128 v[136:139], v5 offset:320
    ds_read_b128 v[140:143], v5 offset:336
    v_rcp_f32 v50, v50
    v_rcp_f32 v51, v51
    v_mfma_f32_32x32x16_bf16 v[192:207], a[8:11], v[64:67], v[192:207]
    s_waitcnt lgkmcnt(5)
    ds_read_b128 a[4:7], v4 offset:5120
    ds_read_b128 a[8:11], v4 offset:6144
    v_rcp_f32 v52, v52
    v_rcp_f32 v53, v53
    v_mfma_f32_32x32x16_bf16 v[160:175], a[12:15], v[68:71], v[160:175]
    s_waitcnt lgkmcnt(6)
    ds_read_b128 v[128:131], v5 offset:256
    ds_read_b128 v[132:135], v5 offset:272
    v_rcp_f32 v54, v54
    v_rcp_f32 v55, v55
    v_mfma_f32_32x32x16_bf16 v[176:191], a[16:19], v[68:71], v[176:191]
    s_waitcnt lgkmcnt(7)
    ds_read_b128 a[12:15], v4 offset:7168
    ds_read_b128 a[16:19], v4 offset:8192
    v_rcp_f32 v56, v56
    v_rcp_f32 v57, v57
    v_mfma_f32_32x32x16_bf16 v[192:207], a[20:23], v[68:71], v[192:207]
    s_waitcnt lgkmcnt(8)
    v_rcp_f32 v58, v58
    v_rcp_f32 v59, v59
    v_rcp_f32 v60, v60
    v_rcp_f32 v61, v61
    v_rcp_f32 v62, v62
    v_rcp_f32 v63, v63
    v_pk_mul_f32 v[32:33], v[32:33], v[48:49]
    v_pk_mul_f32 v[34:35], v[34:35], v[50:51]
    v_pk_mul_f32 v[36:37], v[36:37], v[52:53]
    v_pk_mul_f32 v[38:39], v[38:39], v[54:55]
    v_pk_mul_f32 v[40:41], v[40:41], v[56:57]
    v_pk_mul_f32 v[42:43], v[42:43], v[58:59]
    v_pk_mul_f32 v[44:45], v[44:45], v[60:61]
    v_pk_mul_f32 v[46:47], v[46:47], v[62:63]
    v_pk_fma_f32 v[48:49], v[144:145], v[144:145], s[52:53]
    v_pk_fma_f32 v[50:51], v[146:147], v[146:147], s[52:53]
    v_pk_fma_f32 v[52:53], v[148:149], v[148:149], s[52:53]
    v_pk_fma_f32 v[54:55], v[150:151], v[150:151], s[52:53]
    v_pk_fma_f32 v[56:57], v[152:153], v[152:153], s[52:53]
    v_pk_fma_f32 v[58:59], v[154:155], v[154:155], s[52:53]
    v_pk_fma_f32 v[60:61], v[156:157], v[156:157], s[52:53]
    v_pk_fma_f32 v[62:63], v[158:159], v[158:159], s[52:53]
    v_pk_mul_f32 v[48:49], v[48:49], v[144:145] neg_lo:[1,0] neg_hi:[1,0]
    v_pk_mul_f32 v[50:51], v[50:51], v[146:147] neg_lo:[1,0] neg_hi:[1,0]
    v_pk_mul_f32 v[52:53], v[52:53], v[148:149] neg_lo:[1,0] neg_hi:[1,0]
    v_pk_mul_f32 v[54:55], v[54:55], v[150:151] neg_lo:[1,0] neg_hi:[1,0]
    v_pk_mul_f32 v[56:57], v[56:57], v[152:153] neg_lo:[1,0] neg_hi:[1,0]
    v_pk_mul_f32 v[58:59], v[58:59], v[154:155] neg_lo:[1,0] neg_hi:[1,0]
    v_pk_mul_f32 v[60:61], v[60:61], v[156:157] neg_lo:[1,0] neg_hi:[1,0]
    v_pk_mul_f32 v[62:63], v[62:63], v[158:159] neg_lo:[1,0] neg_hi:[1,0]
L_pf17:
    v_mfma_f32_32x32x16_bf16 v[96:111], a[128:131], a[32:35], v[96:111]
    s_mov_b32 s63, L_pf17-L_pc+12288
    buffer_load_dword v6, v7, s[68:71], s63 offen
    v_exp_f32 v48, v48
    v_exp_f32 v49, v49
    v_cvt_pk_bf16_f32 v64, v32, v33
    v_mfma_f32_32x32x16_bf16 v[112:127], a[132:135], a[32:35], v[112:127]
    v_exp_f32 v50, v50
    v_exp_f32 v51, v51
    v_exp_f32 v52, v52
    s_waitcnt lgkmcnt(2)
    v_mfma_f32_32x32x16_bf16 v[128:143], a[136:139], a[32:35], v[128:143]
    v_exp_f32 v53, v53
    v_exp_f32 v54, v54
    v_exp_f32 v55, v55
    v_mfma_f32_32x32x16_bf16 v[96:111], a[140:143], a[36:39], v[96:111]
    v_exp_f32 v56, v56
    v_exp_f32 v57, v57
    v_exp_f32 v58, v58
    v_mfma_f32_32x32x16_bf16 v[112:127], a[144:147], a[36:39], v[112:127]
    v_exp_f32 v59, v59
    v_exp_f32 v60, v60
    v_exp_f32_e64 v61, v61
    v_mfma_f32_32x32x16_bf16 v[128:143], a[148:151], a[36:39], v[128:143]
    v_cvt_pk_bf16_f32 v65, v34, v35
    v_cvt_pk_bf16_f32 v66, v36, v37
    v_cvt_pk_bf16_f32 v67, v38, v39
    v_cvt_pk_bf16_f32 v68, v40, v41
    v_cvt_pk_bf16_f32 v69, v42, v43
    v_cvt_pk_bf16_f32 v70, v44, v45
    v_cvt_pk_bf16_f32 v71, v46, v47
    v_exp_f32 v62, v62
    v_exp_f32 v63, v63
    v_pk_add_f32 v[48:49], v[48:49], 1.0 op_sel_hi:[1,0]
    v_pk_add_f32 v[50:51], v[50:51], 1.0 op_sel_hi:[1,0]
    v_pk_add_f32 v[52:53], v[52:53], 1.0 op_sel_hi:[1,0]
    v_pk_add_f32 v[54:55], v[54:55], 1.0 op_sel_hi:[1,0]
    v_pk_add_f32 v[56:57], v[56:57], 1.0 op_sel_hi:[1,0]
    v_pk_add_f32 v[58:59], v[58:59], 1.0 op_sel_hi:[1,0]
    v_pk_add_f32 v[60:61], v[60:61], 1.0 op_sel_hi:[1,0]
    v_pk_add_f32 v[62:63], v[62:63], 1.0 op_sel_hi:[1,0]
    v_mfma_f32_32x32x16_bf16 v[160:175], a[0:3], v[64:67], v[160:175]
    ds_read_b128 a[20:23], v4 offset:9216
    ds_read_b128 a[0:3], v4 offset:10240
    v_rcp_f32 v48, v48
    v_rcp_f32 v49, v49
    v_mfma_f32_32x32x16_bf16 v[176:191], a[4:7], v[64:67], v[176:191]
    v_rcp_f32 v50, v50
    v_rcp_f32 v51, v51
    v_rcp_f32 v52, v52
    v_mfma_f32_32x32x16_bf16 v[192:207], a[8:11], v[64:67], v[192:207]
    s_waitcnt lgkmcnt(3)
    ds_read_b128 a[4:7], v4 offset:11264
    ds_read_b128 a[8:11], v4 offset:12288
    v_rcp_f32 v53, v53
    v_rcp_f32 v54, v54
    v_mfma_f32_32x32x16_bf16 v[160:175], a[12:15], v[68:71], v[160:175]
    s_waitcnt lgkmcnt(4)
    v_rcp_f32 v55, v55
    v_rcp_f32 v56, v56
    v_rcp_f32 v57, v57
    v_mfma_f32_32x32x16_bf16 v[176:191], a[16:19], v[68:71], v[176:191]
    s_waitcnt lgkmcnt(3)
    ds_read_b128 a[12:15], v4 offset:13312
    ds_read_b128 a[16:19], v4 offset:14336
    v_rcp_f32 v58, v58
    v_rcp_f32 v59, v59
    v_mfma_f32_32x32x16_bf16 v[192:207], a[20:23], v[68:71], v[192:207]
    s_waitcnt lgkmcnt(4)
    v_rcp_f32 v60, v60
    v_rcp_f32 v61, v61
    v_rcp_f32 v62, v62
    v_rcp_f32 v63, v63
    v_pk_mul_f32 v[144:145], v[144:145], v[48:49]
    v_pk_mul_f32 v[146:147], v[146:147], v[50:51]
    v_pk_mul_f32 v[148:149], v[148:149], v[52:53]
    v_pk_mul_f32 v[150:151], v[150:151], v[54:55]
    v_pk_mul_f32 v[152:153], v[152:153], v[56:57]
    v_pk_mul_f32 v[154:155], v[154:155], v[58:59]
    v_pk_mul_f32 v[156:157], v[156:157], v[60:61]
    v_pk_mul_f32 v[158:159], v[158:159], v[62:63]
    v_mfma_f32_32x32x16_bf16 v[96:111], a[152:155], a[40:43], v[96:111]
    v_cvt_pk_bf16_f32 v64, v144, v145
    v_cvt_pk_bf16_f32 v65, v146, v147
    v_cvt_pk_bf16_f32 v66, v148, v149
    v_cvt_pk_bf16_f32 v67, v150, v151
    v_cvt_pk_bf16_f32 v68, v152, v153
    v_mfma_f32_32x32x16_bf16 v[112:127], a[156:159], a[40:43], v[112:127]
    v_cvt_pk_bf16_f32 v69, v154, v155
    v_cvt_pk_bf16_f32 v70, v156, v157
    v_cvt_pk_bf16_f32 v71, v158, v159
    v_mfma_f32_32x32x16_bf16 v[128:143], a[160:163], a[40:43], v[128:143]
    v_mfma_f32_32x32x16_bf16 v[96:111], a[164:167], a[44:47], v[96:111]
    v_mfma_f32_32x32x16_bf16 v[112:127], a[168:171], a[44:47], v[112:127]
    v_mfma_f32_32x32x16_bf16 v[128:143], a[172:175], a[44:47], v[128:143]
    v_mfma_f32_32x32x16_bf16 v[160:175], a[0:3], v[64:67], v[160:175]
    s_waitcnt lgkmcnt(3)
    ds_read_b128 a[20:23], v4 offset:15360
    ds_read_b128 a[0:3], v4 offset:16384
    v_mfma_f32_32x32x16_bf16 v[176:191], a[4:7], v[64:67], v[176:191]
    s_waitcnt lgkmcnt(4)
    v_mfma_f32_32x32x16_bf16 v[192:207], a[8:11], v[64:67], v[192:207]
    s_waitcnt lgkmcnt(3)
    ds_read_b128 a[4:7], v4 offset:17408
    ds_read_b128 a[8:11], v3 offset:32768
    v_mfma_f32_32x32x16_bf16 v[160:175], a[12:15], v[68:71], v[160:175]
    s_waitcnt lgkmcnt(4)
    v_mfma_f32_32x32x16_bf16 v[176:191], a[16:19], v[68:71], v[176:191]
    s_waitcnt lgkmcnt(3)
    ds_read_b128 a[12:15], v3 offset:33792
    ds_read_b128 a[16:19], v3 offset:34816
    v_mfma_f32_32x32x16_bf16 v[192:207], a[20:23], v[68:71], v[192:207]
    s_waitcnt lgkmcnt(4)
    v_mfma_f32_32x32x16_bf16 v[96:111], a[176:179], a[48:51], v[96:111]
    v_mfma_f32_32x32x16_bf16 v[112:127], a[180:183], a[48:51], v[112:127]
    v_mfma_f32_32x32x16_bf16 v[128:143], a[184:187], a[48:51], v[128:143]
    v_mfma_f32_32x32x16_bf16 v[96:111], a[188:191], a[52:55], v[96:111]
    v_mfma_f32_32x32x16_bf16 v[112:127], a[192:195], a[52:55], v[112:127]
    v_mfma_f32_32x32x16_bf16 v[128:143], a[196:199], a[52:55], v[128:143]
    s_waitcnt vmcnt(8)
    v_mfma_f32_32x32x16_bf16 v[144:159], a[0:3], v[232:235], 0
    s_waitcnt lgkmcnt(3)
    ds_read_b128 a[20:23], v3 offset:35840
    ds_read_b128 a[0:3], v3 offset:36864
    v_cvt_pk_bf16_f32 v176, v176, v177
    v_cvt_pk_bf16_f32 v177, v178, v179
    v_cvt_pk_bf16_f32 v178, v180, v181
    v_cvt_pk_bf16_f32 v179, v182, v183
    v_mfma_f32_32x32x16_bf16 v[144:159], a[4:7], v[236:239], v[144:159]
    s_waitcnt lgkmcnt(4)
    v_cvt_pk_bf16_f32 v180, v184, v185
    v_cvt_pk_bf16_f32 v181, v186, v187
    v_cvt_pk_bf16_f32 v182, v188, v189
    v_cvt_pk_bf16_f32 v183, v190, v191
    v_permlane16_swap_b32 v176, v180
    v_permlane16_swap_b32 v177, v181
    v_mfma_f32_32x32x16_bf16 v[96:111], a[200:203], a[56:59], v[96:111]
    v_permlane16_swap_b32 v178, v182
    v_permlane16_swap_b32 v179, v183
    v_cvt_pk_bf16_f32 v160, v160, v161
    v_cvt_pk_bf16_f32 v161, v162, v163
    v_cvt_pk_bf16_f32 v162, v164, v165
    v_cvt_pk_bf16_f32 v163, v166, v167
    v_mfma_f32_32x32x16_bf16 v[112:127], a[204:207], a[56:59], v[112:127]
    v_cvt_pk_bf16_f32 v164, v168, v169
    v_cvt_pk_bf16_f32 v165, v170, v171
    v_cvt_pk_bf16_f32 v166, v172, v173
    v_cvt_pk_bf16_f32 v167, v174, v175
    v_permlane16_swap_b32 v160, v164
    v_mfma_f32_32x32x16_bf16 v[128:143], a[208:211], a[56:59], v[128:143]
    v_permlane16_swap_b32 v161, v165
    v_permlane16_swap_b32 v162, v166
    v_permlane16_swap_b32 v163, v167
    v_mfma_f32_32x32x16_bf16 v[96:111], a[212:215], a[60:63], v[96:111]
    v_mfma_f32_32x32x16_bf16 v[112:127], a[216:219], a[60:63], v[112:127]
    v_mfma_f32_32x32x16_bf16 v[128:143], a[220:223], a[60:63], v[128:143]
    v_mfma_f32_32x32x16_bf16 v[96:111], a[8:11], a[64:67], v[96:111]
    s_waitcnt lgkmcnt(3)
    ds_read_b128 a[4:7], v3 offset:37888
    ds_read_b128 a[8:11], v4 offset:18432
    v_cvt_pk_bf16_f32 v192, v192, v193
    v_cvt_pk_bf16_f32 v193, v194, v195
    v_cvt_pk_bf16_f32 v194, v196, v197
    v_cvt_pk_bf16_f32 v195, v198, v199
    v_mfma_f32_32x32x16_bf16 v[112:127], a[12:15], a[64:67], v[112:127]
    s_waitcnt lgkmcnt(4)
    v_cvt_pk_bf16_f32 v196, v200, v201
    v_cvt_pk_bf16_f32 v197, v202, v203
    v_cvt_pk_bf16_f32 v198, v204, v205
    v_cvt_pk_bf16_f32 v199, v206, v207
    v_permlane16_swap_b32 v192, v196
    v_permlane16_swap_b32 v193, v197
    v_mfma_f32_32x32x16_bf16 v[128:143], a[16:19], a[64:67], v[128:143]
    s_waitcnt lgkmcnt(3)
    ds_read_b128 a[12:15], v4 offset:19456
    ds_read_b128 a[16:19], v4 offset:20480
    v_permlane16_swap_b32 v194, v198
    v_permlane16_swap_b32 v195, v199
    v_fma_f32 v144, v144, v12, v13
    v_fma_f32 v145, v145, v12, v13
    v_mfma_f32_32x32x16_bf16 v[96:111], a[20:23], a[68:71], v[96:111]
    s_waitcnt lgkmcnt(4)
    v_fma_f32 v146, v146, v12, v13
    v_fma_f32 v147, v147, v12, v13
    v_fma_f32 v148, v148, v12, v13
    v_fma_f32 v149, v149, v12, v13
    v_fma_f32 v150, v150, v12, v13
    v_fma_f32 v151, v151, v12, v13
    v_mfma_f32_32x32x16_bf16 v[112:127], a[0:3], a[68:71], v[112:127]
    s_waitcnt lgkmcnt(3)
    ds_read_b128 a[20:23], v4 offset:21504
    ds_read_b128 a[0:3], v3 offset:38912
    v_fma_f32 v152, v152, v12, v13
    v_fma_f32 v153, v153, v12, v13
    v_fma_f32 v154, v154, v12, v13
    v_fma_f32 v155, v155, v12, v13
    v_mfma_f32_32x32x16_bf16 v[128:143], a[4:7], a[68:71], v[128:143]
    s_waitcnt lgkmcnt(4)
    v_fma_f32 v156, v156, v12, v13
    v_fma_f32 v157, v157, v12, v13
    v_fma_f32 v158, v158, v12, v13
    v_fma_f32 v159, v159, v12, v13
    v_cvt_pk_bf16_f32 v72, v144, v145
    v_mfma_f32_32x32x16_bf16 v[32:47], a[8:11], v[240:243], 0
    s_waitcnt lgkmcnt(3)
    ds_read_b128 a[4:7], v3 offset:39936
    ds_read_b128 a[8:11], v3 offset:40960
    v_cvt_pk_bf16_f32 v73, v146, v147
    v_cvt_pk_bf16_f32 v74, v148, v149
    v_cvt_pk_bf16_f32 v75, v150, v151
    v_mfma_f32_32x32x16_bf16 v[32:47], a[12:15], v[244:247], v[32:47]
    s_waitcnt lgkmcnt(4)
    v_cvt_pk_bf16_f32 v76, v152, v153
    v_cvt_pk_bf16_f32 v77, v154, v155
    v_cvt_pk_bf16_f32 v78, v156, v157
    v_cvt_pk_bf16_f32 v79, v158, v159
    v_mfma_f32_32x32x16_bf16 v[144:159], a[16:19], v[248:251], 0
    s_waitcnt lgkmcnt(3)
    ds_read_b128 a[12:15], v3 offset:41984
    ds_read_b128 a[16:19], v3 offset:43008
    v_mfma_f32_32x32x16_bf16 v[144:159], a[20:23], v[252:255], v[144:159]
    s_waitcnt lgkmcnt(4)
    s_add_u32 s55, s56, 49152
    buffer_store_dwordx4 v[160:163], v9, s[28:31], s55 offen offset:0 sc1
    buffer_store_dwordx4 v[176:179], v9, s[28:31], s55 offen offset:64 sc1
    buffer_store_dwordx4 v[192:195], v9, s[28:31], s55 offen offset:128 sc1
    v_fma_f32 v32, v32, v12, v13
    v_fma_f32 v33, v33, v12, v13
    v_mfma_f32_32x32x16_bf16 v[96:111], a[0:3], a[72:75], v[96:111]
    s_waitcnt lgkmcnt(3)
    ds_read_b128 a[20:23], v3 offset:44032
    ds_read_b128 a[0:3], v3 offset:45056
    v_fma_f32 v34, v34, v12, v13
    v_fma_f32 v35, v35, v12, v13
    v_fma_f32 v36, v36, v12, v13
    v_fma_f32 v37, v37, v12, v13
    v_mfma_f32_32x32x16_bf16 v[112:127], a[4:7], a[72:75], v[112:127]
    s_waitcnt lgkmcnt(4)
    v_fma_f32 v38, v38, v12, v13
    v_fma_f32 v39, v39, v12, v13
    v_fma_f32 v40, v40, v12, v13
    v_fma_f32 v41, v41, v12, v13
    v_fma_f32 v42, v42, v12, v13
    v_fma_f32 v43, v43, v12, v13
    v_mfma_f32_32x32x16_bf16 v[128:143], a[8:11], a[72:75], v[128:143]
    s_waitcnt lgkmcnt(3)
    ds_read_b128 a[4:7], v3 offset:46080
    ds_read_b128 a[8:11], v3 offset:47104
    v_fma_f32 v44, v44, v12, v13
    v_fma_f32 v45, v45, v12, v13
    v_fma_f32 v46, v46, v12, v13
    v_fma_f32 v47, v47, v12, v13
    v_mfma_f32_32x32x16_bf16 v[96:111], a[12:15], a[76:79], v[96:111]
    s_waitcnt lgkmcnt(4)
    v_cvt_pk_bf16_f32 v80, v32, v33
    v_cvt_pk_bf16_f32 v81, v34, v35
    v_cvt_pk_bf16_f32 v82, v36, v37
    v_cvt_pk_bf16_f32 v83, v38, v39
    v_cvt_pk_bf16_f32 v84, v40, v41
    v_mfma_f32_32x32x16_bf16 v[112:127], a[16:19], a[76:79], v[112:127]
    s_waitcnt lgkmcnt(3)
    ds_read_b128 a[12:15], v3 offset:48128
    ds_read_b128 a[16:19], v3 offset:49152
    v_cvt_pk_bf16_f32 v85, v42, v43
    v_cvt_pk_bf16_f32 v86, v44, v45
    v_cvt_pk_bf16_f32 v87, v46, v47
    v_mfma_f32_32x32x16_bf16 v[128:143], a[20:23], a[76:79], v[128:143]
    s_waitcnt lgkmcnt(4)
    s_waitcnt vmcnt(4)
    v_mfma_f32_32x32x16_bf16 v[96:111], a[24:27], v[208:211], v[96:111]
    v_fma_f32 v144, v144, v12, v13
    v_fma_f32 v145, v145, v12, v13
    v_fma_f32 v146, v146, v12, v13
    v_fma_f32 v147, v147, v12, v13
    v_fma_f32 v148, v148, v12, v13
    v_fma_f32 v149, v149, v12, v13
    v_mfma_f32_32x32x16_bf16 v[96:111], a[28:31], v[212:215], v[96:111]
    v_fma_f32 v150, v150, v12, v13
    v_fma_f32 v151, v151, v12, v13
    v_fma_f32 v152, v152, v12, v13
    v_fma_f32 v153, v153, v12, v13
    v_fma_f32 v154, v154, v12, v13
    v_fma_f32 v155, v155, v12, v13
    v_mfma_f32_32x32x16_bf16 v[112:127], a[24:27], v[216:219], v[112:127]
    v_fma_f32 v156, v156, v12, v13
    v_fma_f32 v157, v157, v12, v13
    v_fma_f32 v158, v158, v12, v13
    v_fma_f32 v159, v159, v12, v13
    v_cvt_pk_bf16_f32 v88, v144, v145
    v_mfma_f32_32x32x16_bf16 v[112:127], a[28:31], v[220:223], v[112:127]
    v_cvt_pk_bf16_f32 v89, v146, v147
    v_cvt_pk_bf16_f32 v90, v148, v149
    v_cvt_pk_bf16_f32 v91, v150, v151
    v_cvt_pk_bf16_f32 v92, v152, v153
    v_cvt_pk_bf16_f32 v93, v154, v155
    v_mfma_f32_32x32x16_bf16 v[128:143], a[24:27], v[224:227], v[128:143]
    v_cvt_pk_bf16_f32 v94, v156, v157
    v_cvt_pk_bf16_f32 v95, v158, v159
    v_mfma_f32_32x32x16_bf16 v[128:143], a[28:31], v[228:231], v[128:143]
    v_mfma_f32_32x32x16_bf16 v[96:111], a[0:3], a[80:83], v[96:111]
    s_waitcnt lgkmcnt(3)
    ds_read_b128 a[20:23], v3 offset:50176
    ds_read_b128 a[0:3], v2 offset:0
    v_mfma_f32_32x32x16_bf16 v[112:127], a[4:7], a[80:83], v[112:127]
    s_waitcnt lgkmcnt(4)
    v_mfma_f32_32x32x16_bf16 v[128:143], a[8:11], a[80:83], v[128:143]
    s_waitcnt lgkmcnt(3)
    ds_read_b128 a[4:7], v2 offset:1024
    ds_read_b128 a[8:11], v2 offset:2048
    v_mfma_f32_32x32x16_bf16 v[96:111], a[12:15], a[84:87], v[96:111]
    s_waitcnt lgkmcnt(4)
    v_mfma_f32_32x32x16_bf16 v[112:127], a[16:19], a[84:87], v[112:127]
    s_waitcnt lgkmcnt(3)
    ds_read_b128 a[12:15], v2 offset:3072
    ds_read_b128 a[16:19], v2 offset:4096
    v_mfma_f32_32x32x16_bf16 v[128:143], a[20:23], a[84:87], v[128:143]
    s_waitcnt lgkmcnt(4)
    v_mfma_f32_32x32x16_bf16 v[16:31], a[0:3], v[72:75], 0
    s_waitcnt lgkmcnt(3)
    ds_read_b128 a[20:23], v2 offset:5120
    ds_read_b128 a[0:3], v3 offset:51200
    v_mfma_f32_32x32x16_bf16 v[16:31], a[4:7], v[76:79], v[16:31]
    s_waitcnt lgkmcnt(4)
    buffer_store_dwordx4 v[164:167], v9, s[28:31], s55 offen offset:3072 sc1
    buffer_store_dwordx4 v[180:183], v9, s[28:31], s55 offen offset:3136 sc1
    buffer_store_dwordx4 v[196:199], v9, s[28:31], s55 offen offset:3200 sc1
    v_mfma_f32_32x32x16_bf16 v[16:31], a[8:11], v[80:83], v[16:31]
    s_waitcnt lgkmcnt(3)
    ds_read_b128 a[4:7], v3 offset:52224
    ds_read_b128 a[8:11], v3 offset:53248
    v_mfma_f32_32x32x16_bf16 v[16:31], a[12:15], v[84:87], v[16:31]
    s_waitcnt lgkmcnt(4)
    v_mfma_f32_32x32x16_bf16 v[16:31], a[16:19], v[88:91], v[16:31]
    s_waitcnt lgkmcnt(3)
    ds_read_b128 a[12:15], v3 offset:54272
    ds_read_b128 a[16:19], v3 offset:55296
    v_mfma_f32_32x32x16_bf16 v[16:31], a[20:23], v[92:95], v[16:31]
    s_waitcnt lgkmcnt(4)
    v_mfma_f32_32x32x16_bf16 v[96:111], a[0:3], a[88:91], v[96:111]
    s_waitcnt lgkmcnt(3)
    ds_read_b128 a[20:23], v3 offset:56320
    ds_read_b128 a[0:3], v2 offset:6144
    v_mfma_f32_32x32x16_bf16 v[112:127], a[4:7], a[88:91], v[112:127]
    s_waitcnt lgkmcnt(4)
    v_mfma_f32_32x32x16_bf16 v[128:143], a[8:11], a[88:91], v[128:143]
    s_waitcnt lgkmcnt(3)
    ds_read_b128 a[4:7], v2 offset:7168
    ds_read_b128 a[8:11], v2 offset:8192
    v_mfma_f32_32x32x16_bf16 v[96:111], a[12:15], a[92:95], v[96:111]
    s_waitcnt lgkmcnt(4)
    v_mfma_f32_32x32x16_bf16 v[112:127], a[16:19], a[92:95], v[112:127]
    s_waitcnt lgkmcnt(3)
    ds_read_b128 a[12:15], v2 offset:9216
    ds_read_b128 a[16:19], v2 offset:10240
    v_mfma_f32_32x32x16_bf16 v[128:143], a[20:23], a[92:95], v[128:143]
    s_waitcnt lgkmcnt(4)
    v_mfma_f32_32x32x16_bf16 v[96:111], a[224:227], a[96:99], v[96:111]
    ds_read_b128 v[168:171], v5 offset:64
    v_fma_f32 v48, v16, v16, s52
    v_fma_f32 v49, v17, v17, s52
    v_fma_f32 v50, v18, v18, s52
    v_fma_f32 v51, v19, v19, s52
    v_fma_f32 v52, v20, v20, s52
    v_mfma_f32_32x32x16_bf16 v[112:127], a[228:231], a[96:99], v[112:127]
    ds_read_b128 v[172:175], v5 offset:80
    v_fma_f32 v53, v21, v21, s52
    v_fma_f32 v54, v22, v22, s52
    v_fma_f32 v55, v23, v23, s52
    v_fma_f32 v56, v24, v24, s52
    v_fma_f32 v57, v25, v25, s52
    v_mfma_f32_32x32x16_bf16 v[128:143], a[232:235], a[96:99], v[128:143]
    ds_read_b128 v[160:163], v5 offset:0
    v_fma_f32 v58, v26, v26, s52
    v_fma_f32 v59, v27, v27, s52
    v_fma_f32 v60, v28, v28, s52
    v_fma_f32 v61, v29, v29, s52
    v_fma_f32 v62, v30, v30, s52
    v_mfma_f32_32x32x16_bf16 v[96:111], a[236:239], a[100:103], v[96:111]
    ds_read_b128 v[164:167], v5 offset:16
    v_fma_f32 v63, v31, v31, s52
    v_mul_f32_e64 v48, -v48, v16
    v_mul_f32_e64 v49, -v49, v17
    v_mul_f32_e64 v50, -v50, v18
    v_mul_f32_e64 v51, -v51, v19
    v_mfma_f32_32x32x16_bf16 v[112:127], a[240:243], a[100:103], v[112:127]
    v_mul_f32_e64 v52, -v52, v20
    v_mul_f32_e64 v53, -v53, v21
    v_mul_f32_e64 v54, -v54, v22
    v_mul_f32_e64 v55, -v55, v23
    v_mul_f32_e64 v56, -v56, v24
    v_mfma_f32_32x32x16_bf16 v[128:143], a[244:247], a[100:103], v[128:143]
    v_mul_f32_e64 v57, -v57, v25
    v_mul_f32_e64 v58, -v58, v26
    v_mul_f32_e64 v59, -v59, v27
    v_mul_f32_e64 v60, -v60, v28
    v_mul_f32_e64 v61, -v61, v29
    v_mul_f32_e64 v62, -v62, v30
    v_mul_f32_e64 v63, -v63, v31
    v_mfma_f32_32x32x16_bf16 v[32:47], a[0:3], v[72:75], 0
    s_waitcnt lgkmcnt(7)
    ds_read_b128 a[20:23], v2 offset:11264
    ds_read_b128 a[0:3], v3 offset:63488
    v_exp_f32 v48, v48
    v_exp_f32 v49, v49
    v_mfma_f32_32x32x16_bf16 v[32:47], a[4:7], v[76:79], v[32:47]
    s_waitcnt lgkmcnt(8)
    ds_read_b128 v[184:187], v5 offset:192
    v_exp_f32 v50, v50
    v_exp_f32 v51, v51
    v_add_f32 v48, 1.0, v48
    v_mfma_f32_32x32x16_bf16 v[32:47], a[8:11], v[80:83], v[32:47]
    s_waitcnt lgkmcnt(8)
    ds_read_b128 a[4:7], v3 offset:64512
    ds_read_b128 a[8:11], v4 offset:0
    v_exp_f32 v52, v52
    v_exp_f32 v53, v53
    v_mfma_f32_32x32x16_bf16 v[32:47], a[12:15], v[84:87], v[32:47]
    s_waitcnt lgkmcnt(9)
    ds_read_b128 v[188:191], v5 offset:208
    v_exp_f32 v54, v54
    v_exp_f32 v55, v55
    v_add_f32 v49, 1.0, v49
    v_mfma_f32_32x32x16_bf16 v[32:47], a[16:19], v[88:91], v[32:47]
    s_waitcnt lgkmcnt(5)
    ds_read_b128 a[12:15], v4 offset:1024
    ds_read_b128 a[16:19], v4 offset:2048
    v_exp_f32 v56, v56
    v_exp_f32 v57, v57
    v_mfma_f32_32x32x16_bf16 v[32:47], a[20:23], v[92:95], v[32:47]
    s_waitcnt lgkmcnt(6)
    ds_read_b128 v[176:179], v5 offset:128
    v_exp_f32 v58, v58
    v_exp_f32 v59, v59
    v_add_f32 v50, 1.0, v50
    v_mfma_f32_32x32x16_bf16 v[96:111], a[0:3], a[104:107], v[96:111]
    s_waitcnt lgkmcnt(5)
    ds_read_b128 a[20:23], v4 offset:3072
    ds_read_b128 a[0:3], v4 offset:4096
    v_exp_f32 v60, v60
    v_exp_f32 v61, v61
    v_mfma_f32_32x32x16_bf16 v[112:127], a[4:7], a[104:107], v[112:127]
    s_waitcnt lgkmcnt(6)
    ds_read_b128 v[180:183], v5 offset:144
    v_exp_f32 v62, v62
    v_exp_f32 v63, v63
    v_add_f32 v51, 1.0, v51
    v_mfma_f32_32x32x16_bf16 v[128:143], a[8:11], a[104:107], v[128:143]
    s_waitcnt lgkmcnt(5)
    ds_read_b128 a[4:7], v4 offset:5120
    ds_read_b128 a[8:11], v4 offset:6144
    v_add_f32 v52, 1.0, v52
    v_add_f32 v53, 1.0, v53
    v_add_f32 v54, 1.0, v54
    v_add_f32 v55, 1.0, v55
    v_mfma_f32_32x32x16_bf16 v[96:111], a[12:15], a[108:111], v[96:111]
    s_waitcnt lgkmcnt(6)
    v_add_f32 v56, 1.0, v56
    v_add_f32 v57, 1.0, v57
    v_add_f32 v58, 1.0, v58
    v_add_f32 v59, 1.0, v59
    v_add_f32 v60, 1.0, v60
    v_mfma_f32_32x32x16_bf16 v[112:127], a[16:19], a[108:111], v[112:127]
    s_waitcnt lgkmcnt(4)
    ds_read_b128 a[12:15], v4 offset:7168
    ds_read_b128 a[16:19], v4 offset:8192
    v_add_f32 v61, 1.0, v61
    v_add_f32 v62, 1.0, v62
    v_add_f32 v63, 1.0, v63
    v_mfma_f32_32x32x16_bf16 v[128:143], a[20:23], a[108:111], v[128:143]
    s_waitcnt lgkmcnt(5)
    v_mfma_f32_32x32x16_bf16 v[96:111], a[0:3], a[112:115], v[96:111]
    s_waitcnt lgkmcnt(3)
    ds_read_b128 a[20:23], v4 offset:9216
    ds_read_b128 a[0:3], v4 offset:10240
    v_rcp_f32 v48, v48
    v_rcp_f32 v49, v49
    v_mfma_f32_32x32x16_bf16 v[112:127], a[4:7], a[112:115], v[112:127]
    s_waitcnt lgkmcnt(4)
    ds_read_b128 v[200:203], v5 offset:320
    v_rcp_f32 v50, v50
    v_rcp_f32 v51, v51
    v_mul_f32 v16, v16, v48
    v_mfma_f32_32x32x16_bf16 v[128:143], a[8:11], a[112:115], v[128:143]
    s_waitcnt lgkmcnt(4)
    ds_read_b128 a[4:7], v4 offset:11264
    ds_read_b128 a[8:11], v4 offset:12288
    v_rcp_f32 v52, v52
    v_rcp_f32 v53, v53
    v_mfma_f32_32x32x16_bf16 v[96:111], a[12:15], a[116:119], v[96:111]
    s_waitcnt lgkmcnt(5)
    ds_read_b128 v[204:207], v5 offset:336
    v_rcp_f32 v54, v54
    v_rcp_f32 v55, v55
    v_mul_f32 v17, v17, v49
    v_mfma_f32_32x32x16_bf16 v[112:127], a[16:19], a[116:119], v[112:127]
    s_waitcnt lgkmcnt(5)
    ds_read_b128 a[12:15], v4 offset:13312
    ds_read_b128 a[16:19], v4 offset:14336
    v_rcp_f32 v56, v56
    v_rcp_f32 v57, v57
    v_mfma_f32_32x32x16_bf16 v[128:143], a[20:23], a[116:119], v[128:143]
    s_waitcnt lgkmcnt(6)
    ds_read_b128 v[192:195], v5 offset:256
    v_rcp_f32 v58, v58
    v_rcp_f32 v59, v59
    v_mul_f32 v18, v18, v50
    v_mfma_f32_32x32x16_bf16 v[96:111], a[0:3], a[120:123], v[96:111]
    s_waitcnt lgkmcnt(5)
    ds_read_b128 a[20:23], v4 offset:15360
    ds_read_b128 a[0:3], v2 offset:12288
    v_rcp_f32 v60, v60
    v_rcp_f32 v61, v61
    v_mfma_f32_32x32x16_bf16 v[112:127], a[4:7], a[120:123], v[112:127]
    s_waitcnt lgkmcnt(6)
    ds_read_b128 v[196:199], v5 offset:272
    v_rcp_f32 v62, v62
    v_rcp_f32 v63, v63
    v_mul_f32 v19, v19, v51
    v_mfma_f32_32x32x16_bf16 v[128:143], a[8:11], a[120:123], v[128:143]
    s_waitcnt lgkmcnt(5)
    ds_read_b128 a[4:7], v2 offset:13312
    ds_read_b128 a[8:11], v2 offset:14336
    v_mul_f32 v20, v20, v52
    v_mul_f32 v21, v21, v53
    v_mul_f32 v22, v22, v54
    v_mul_f32 v23, v23, v55
    v_mfma_f32_32x32x16_bf16 v[96:111], a[12:15], a[124:127], v[96:111]
    s_waitcnt lgkmcnt(6)
    v_mul_f32 v24, v24, v56
    v_mul_f32 v25, v25, v57
    v_mul_f32 v26, v26, v58
    v_mul_f32 v27, v27, v59
    v_mul_f32 v28, v28, v60
    v_mfma_f32_32x32x16_bf16 v[112:127], a[16:19], a[124:127], v[112:127]
    s_waitcnt lgkmcnt(4)
    ds_read_b128 a[12:15], v2 offset:15360
    ds_read_b128 a[16:19], v2 offset:16384
    v_mul_f32 v29, v29, v61
    v_mul_f32 v30, v30, v62
    v_mul_f32 v31, v31, v63
    v_mfma_f32_32x32x16_bf16 v[128:143], a[20:23], a[124:127], v[128:143]
    s_waitcnt lgkmcnt(5)
    v_pk_fma_f32 v[48:49], v[32:33], v[32:33], s[52:53]
    v_pk_fma_f32 v[50:51], v[34:35], v[34:35], s[52:53]
    v_pk_fma_f32 v[52:53], v[36:37], v[36:37], s[52:53]
    v_pk_fma_f32 v[54:55], v[38:39], v[38:39], s[52:53]
    v_pk_fma_f32 v[56:57], v[40:41], v[40:41], s[52:53]
    v_pk_fma_f32 v[58:59], v[42:43], v[42:43], s[52:53]
    v_pk_fma_f32 v[60:61], v[44:45], v[44:45], s[52:53]
    v_pk_fma_f32 v[62:63], v[46:47], v[46:47], s[52:53]
    v_pk_mul_f32 v[48:49], v[48:49], v[32:33] neg_lo:[1,0] neg_hi:[1,0]
    v_pk_mul_f32 v[50:51], v[50:51], v[34:35] neg_lo:[1,0] neg_hi:[1,0]
    v_pk_mul_f32 v[52:53], v[52:53], v[36:37] neg_lo:[1,0] neg_hi:[1,0]
    v_pk_mul_f32 v[54:55], v[54:55], v[38:39] neg_lo:[1,0] neg_hi:[1,0]
    v_pk_mul_f32 v[56:57], v[56:57], v[40:41] neg_lo:[1,0] neg_hi:[1,0]
    v_pk_mul_f32 v[58:59], v[58:59], v[42:43] neg_lo:[1,0] neg_hi:[1,0]
    v_pk_mul_f32 v[60:61], v[60:61], v[44:45] neg_lo:[1,0] neg_hi:[1,0]
    v_pk_mul_f32 v[62:63], v[62:63], v[46:47] neg_lo:[1,0] neg_hi:[1,0]
    v_mfma_f32_32x32x16_bf16 v[144:159], a[0:3], v[72:75], 0
    s_waitcnt lgkmcnt(3)
    ds_read_b128 a[20:23], v2 offset:17408
    ds_read_b128 a[0:3], v2 offset:18432
    v_exp_f32 v48, v48
    v_exp_f32 v49, v49
    v_mfma_f32_32x32x16_bf16 v[144:159], a[4:7], v[76:79], v[144:159]
    s_waitcnt lgkmcnt(4)
    v_exp_f32 v50, v50
    v_exp_f32 v51, v51
    v_exp_f32 v52, v52
    v_mfma_f32_32x32x16_bf16 v[144:159], a[8:11], v[80:83], v[144:159]
    s_waitcnt lgkmcnt(3)
    ds_read_b128 a[4:7], v2 offset:19456
    ds_read_b128 a[8:11], v2 offset:20480
    v_exp_f32 v53, v53
    v_exp_f32 v54, v54
    v_mfma_f32_32x32x16_bf16 v[144:159], a[12:15], v[84:87], v[144:159]
    s_waitcnt lgkmcnt(4)
    v_exp_f32 v55, v55
    v_exp_f32 v56, v56
    v_exp_f32 v57, v57
    v_mfma_f32_32x32x16_bf16 v[144:159], a[16:19], v[88:91], v[144:159]
    s_waitcnt lgkmcnt(3)
    ds_read_b128 a[12:15], v2 offset:21504
    ds_read_b128 a[16:19], v2 offset:22528
    v_exp_f32 v58, v58
    v_exp_f32 v59, v59
    v_mfma_f32_32x32x16_bf16 v[144:159], a[20:23], v[92:95], v[144:159]
    s_waitcnt lgkmcnt(4)
    v_cvt_pk_bf16_f32 v64, v16, v17
    v_cvt_pk_bf16_f32 v65, v18, v19
    v_cvt_pk_bf16_f32 v66, v20, v21
    v_cvt_pk_bf16_f32 v67, v22, v23
    v_cvt_pk_bf16_f32 v68, v24, v25
    v_cvt_pk_bf16_f32 v69, v26, v27
    v_cvt_pk_bf16_f32 v70, v28, v29
    v_cvt_pk_bf16_f32 v71, v30, v31
    v_exp_f32 v60, v60
    v_exp_f32 v61, v61
    v_exp_f32 v62, v62
    v_exp_f32 v63, v63
    v_pk_add_f32 v[48:49], v[48:49], 1.0 op_sel_hi:[1,0]
    v_pk_add_f32 v[50:51], v[50:51], 1.0 op_sel_hi:[1,0]
    v_pk_add_f32 v[52:53], v[52:53], 1.0 op_sel_hi:[1,0]
    v_pk_add_f32 v[54:55], v[54:55], 1.0 op_sel_hi:[1,0]
    v_pk_add_f32 v[56:57], v[56:57], 1.0 op_sel_hi:[1,0]
    v_pk_add_f32 v[58:59], v[58:59], 1.0 op_sel_hi:[1,0]
    v_pk_add_f32 v[60:61], v[60:61], 1.0 op_sel_hi:[1,0]
    v_pk_add_f32 v[62:63], v[62:63], 1.0 op_sel_hi:[1,0]
    v_mfma_f32_32x32x16_bf16 v[160:175], a[128:131], v[64:67], v[160:175]
    v_rcp_f32 v48, v48
    v_rcp_f32 v49, v49
    v_rcp_f32 v50, v50
    v_mfma_f32_32x32x16_bf16 v[176:191], a[132:135], v[64:67], v[176:191]
    v_rcp_f32 v51, v51
    v_rcp_f32 v52, v52
    v_rcp_f32 v53, v53
    v_mfma_f32_32x32x16_bf16 v[192:207], a[136:139], v[64:67], v[192:207]
    v_rcp_f32 v54, v54
    v_rcp_f32 v55, v55
    v_rcp_f32 v56, v56
    v_mfma_f32_32x32x16_bf16 v[160:175], a[140:143], v[68:71], v[160:175]
    v_rcp_f32 v57, v57
    v_rcp_f32 v58, v58
    v_rcp_f32 v59, v59
    v_mfma_f32_32x32x16_bf16 v[176:191], a[144:147], v[68:71], v[176:191]
    v_rcp_f32 v60, v60
    v_rcp_f32 v61, v61
    v_rcp_f32_e64 v62, v62
    v_mfma_f32_32x32x16_bf16 v[192:207], a[148:151], v[68:71], v[192:207]
    v_cvt_pk_bf16_f32 v96, v96, v97
    v_cvt_pk_bf16_f32 v97, v98, v99
    v_cvt_pk_bf16_f32 v98, v100, v101
    v_cvt_pk_bf16_f32 v99, v102, v103
    v_cvt_pk_bf16_f32 v100, v104, v105
    v_cvt_pk_bf16_f32 v101, v106, v107
    v_cvt_pk_bf16_f32 v102, v108, v109
    v_cvt_pk_bf16_f32 v103, v110, v111
    v_permlane16_swap_b32 v96, v100
    v_permlane16_swap_b32 v97, v101
    v_permlane16_swap_b32 v98, v102
    v_permlane16_swap_b32 v99, v103
    v_rcp_f32_e64 v63, v63
    v_pk_mul_f32 v[32:33], v[32:33], v[48:49]
    v_pk_mul_f32 v[34:35], v[34:35], v[50:51]
    v_pk_mul_f32 v[36:37], v[36:37], v[52:53]
    v_pk_mul_f32 v[38:39], v[38:39], v[54:55]
    v_pk_mul_f32 v[40:41], v[40:41], v[56:57]
    v_pk_mul_f32 v[42:43], v[42:43], v[58:59]
    v_pk_mul_f32 v[44:45], v[44:45], v[60:61]
    v_pk_mul_f32 v[46:47], v[46:47], v[62:63]
    v_pk_fma_f32 v[48:49], v[144:145], v[144:145], s[52:53]
    v_pk_fma_f32 v[50:51], v[146:147], v[146:147], s[52:53]
    v_pk_fma_f32 v[52:53], v[148:149], v[148:149], s[52:53]
    v_pk_fma_f32 v[54:55], v[150:151], v[150:151], s[52:53]
    v_pk_fma_f32 v[56:57], v[152:153], v[152:153], s[52:53]
    v_pk_fma_f32 v[58:59], v[154:155], v[154:155], s[52:53]
    v_pk_fma_f32 v[60:61], v[156:157], v[156:157], s[52:53]
    v_pk_fma_f32 v[62:63], v[158:159], v[158:159], s[52:53]
    v_pk_mul_f32 v[48:49], v[48:49], v[144:145] neg_lo:[1,0] neg_hi:[1,0]
    v_pk_mul_f32 v[50:51], v[50:51], v[146:147] neg_lo:[1,0] neg_hi:[1,0]
    v_pk_mul_f32 v[52:53], v[52:53], v[148:149] neg_lo:[1,0] neg_hi:[1,0]
    v_pk_mul_f32 v[54:55], v[54:55], v[150:151] neg_lo:[1,0] neg_hi:[1,0]
    v_pk_mul_f32 v[56:57], v[56:57], v[152:153] neg_lo:[1,0] neg_hi:[1,0]
    v_pk_mul_f32 v[58:59], v[58:59], v[154:155] neg_lo:[1,0] neg_hi:[1,0]
    v_pk_mul_f32 v[60:61], v[60:61], v[156:157] neg_lo:[1,0] neg_hi:[1,0]
    v_pk_mul_f32 v[62:63], v[62:63], v[158:159] neg_lo:[1,0] neg_hi:[1,0]
    v_mfma_f32_32x32x16_bf16 v[16:31], a[0:3], v[72:75], 0
    s_waitcnt lgkmcnt(3)
    ds_read_b128 a[20:23], v2 offset:23552
    ds_read_b128 a[0:3], v2 offset:24576
    v_exp_f32 v48, v48
    v_exp_f32 v49, v49
    v_mfma_f32_32x32x16_bf16 v[16:31], a[4:7], v[76:79], v[16:31]
    s_waitcnt lgkmcnt(4)
    s_add_u32 s54, s56, 0
    buffer_load_dwordx4 v[208:211], v1, s[24:27], s54 offen offset:0
    buffer_load_dwordx4 v[212:215], v1, s[24:27], s54 offen offset:32
    v_exp_f32 v50, v50
    v_cvt_pk_bf16_f32 v112, v112, v113
    v_mfma_f32_32x32x16_bf16 v[16:31], a[8:11], v[80:83], v[16:31]
    s_waitcnt lgkmcnt(3)
    ds_read_b128 a[4:7], v2 offset:25600
    ds_read_b128 a[8:11], v2 offset:26624
    v_exp_f32 v51, v51
    v_exp_f32 v52, v52
    v_mfma_f32_32x32x16_bf16 v[16:31], a[12:15], v[84:87], v[16:31]
    s_waitcnt lgkmcnt(4)
    v_exp_f32 v53, v53
    v_exp_f32 v54, v54
    v_exp_f32 v55, v55
    v_mfma_f32_32x32x16_bf16 v[16:31], a[16:19], v[88:91], v[16:31]
    s_waitcnt lgkmcnt(3)
    ds_read_b128 a[12:15], v2 offset:27648
    ds_read_b128 a[16:19], v2 offset:28672
    v_exp_f32 v56, v56
    v_exp_f32_e64 v57, v57
    v_mfma_f32_32x32x16_bf16 v[16:31], a[20:23], v[92:95], v[16:31]
    s_waitcnt lgkmcnt(4)
    v_cvt_pk_bf16_f32 v113, v114, v115
    v_cvt_pk_bf16_f32 v114, v116, v117
    v_cvt_pk_bf16_f32 v115, v118, v119
    v_cvt_pk_bf16_f32 v116, v120, v121
    v_cvt_pk_bf16_f32 v117, v122, v123
    v_cvt_pk_bf16_f32 v118, v124, v125
    v_cvt_pk_bf16_f32 v119, v126, v127
    v_permlane16_swap_b32 v112, v116
    v_permlane16_swap_b32 v113, v117
    v_permlane16_swap_b32 v114, v118
    v_permlane16_swap_b32 v115, v119
    v_cvt_pk_bf16_f32 v64, v32, v33
    v_cvt_pk_bf16_f32 v65, v34, v35
    v_cvt_pk_bf16_f32 v66, v36, v37
    v_cvt_pk_bf16_f32 v67, v38, v39
    v_cvt_pk_bf16_f32 v68, v40, v41
    v_cvt_pk_bf16_f32 v69, v42, v43
    v_cvt_pk_bf16_f32 v70, v44, v45
    v_cvt_pk_bf16_f32 v71, v46, v47
    v_exp_f32 v58, v58
    v_exp_f32 v59, v59
    v_exp_f32 v60, v60
    v_exp_f32 v61, v61
    v_exp_f32 v62, v62
    v_exp_f32 v63, v63
    v_pk_add_f32 v[48:49], v[48:49], 1.0 op_sel_hi:[1,0]
    v_pk_add_f32 v[50:51], v[50:51], 1.0 op_sel_hi:[1,0]
    v_pk_add_f32 v[52:53], v[52:53], 1.0 op_sel_hi:[1,0]
    v_pk_add_f32 v[54:55], v[54:55], 1.0 op_sel_hi:[1,0]
    v_pk_add_f32 v[56:57], v[56:57], 1.0 op_sel_hi:[1,0]
    v_pk_add_f32 v[58:59], v[58:59], 1.0 op_sel_hi:[1,0]
    v_pk_add_f32 v[60:61], v[60:61], 1.0 op_sel_hi:[1,0]
    v_pk_add_f32 v[62:63], v[62:63], 1.0 op_sel_hi:[1,0]
    v_mfma_f32_32x32x16_bf16 v[160:175], a[24:27], v[232:235], v[160:175]
    v_rcp_f32 v48, v48
    v_rcp_f32 v49, v49
    v_rcp_f32 v50, v50
    v_mfma_f32_32x32x16_bf16 v[160:175], a[28:31], v[236:239], v[160:175]
    v_rcp_f32 v51, v51
    v_rcp_f32 v52, v52
    v_rcp_f32 v53, v53
    v_mfma_f32_32x32x16_bf16 v[176:191], a[24:27], v[240:243], v[176:191]
    v_rcp_f32 v54, v54
    v_rcp_f32 v55, v55
    v_rcp_f32 v56, v56
    v_mfma_f32_32x32x16_bf16 v[160:175], a[152:155], v[64:67], v[160:175]
    v_rcp_f32 v57, v57
    v_rcp_f32 v58, v58
    v_rcp_f32 v59, v59
    v_mfma_f32_32x32x16_bf16 v[176:191], a[156:159], v[64:67], v[176:191]
    v_rcp_f32 v60, v60
    v_rcp_f32 v61, v61
    v_rcp_f32 v62, v62
    v_mfma_f32_32x32x16_bf16 v[192:207], a[160:163], v[64:67], v[192:207]
    v_rcp_f32 v63, v63
    v_cvt_pk_bf16_f32 v128, v128, v129
    v_cvt_pk_bf16_f32 v129, v130, v131
    v_cvt_pk_bf16_f32 v130, v132, v133
    v_cvt_pk_bf16_f32 v131, v134, v135
    v_mfma_f32_32x32x16_bf16 v[160:175], a[164:167], v[68:71], v[160:175]
    v_cvt_pk_bf16_f32 v132, v136, v137
    v_cvt_pk_bf16_f32 v133, v138, v139
    v_cvt_pk_bf16_f32 v134, v140, v141
    v_cvt_pk_bf16_f32 v135, v142, v143
    v_permlane16_swap_b32 v128, v132
    v_mfma_f32_32x32x16_bf16 v[176:191], a[168:171], v[68:71], v[176:191]
    v_permlane16_swap_b32 v129, v133
    v_permlane16_swap_b32 v130, v134
    v_permlane16_swap_b32 v131, v135
    v_mfma_f32_32x32x16_bf16 v[192:207], a[172:175], v[68:71], v[192:207]
    v_pk_mul_f32 v[144:145], v[144:145], v[48:49]
    v_pk_mul_f32 v[146:147], v[146:147], v[50:51]
    v_pk_mul_f32 v[148:149], v[148:149], v[52:53]
    v_pk_mul_f32 v[150:151], v[150:151], v[54:55]
    v_pk_mul_f32 v[152:153], v[152:153], v[56:57]
    v_pk_mul_f32 v[154:155], v[154:155], v[58:59]
    v_pk_mul_f32 v[156:157], v[156:157], v[60:61]
    v_pk_mul_f32 v[158:159], v[158:159], v[62:63]
    v_pk_fma_f32 v[48:49], v[16:17], v[16:17], s[52:53]
    v_pk_fma_f32 v[50:51], v[18:19], v[18:19], s[52:53]
    v_pk_fma_f32 v[52:53], v[20:21], v[20:21], s[52:53]
    v_pk_fma_f32 v[54:55], v[22:23], v[22:23], s[52:53]
    v_pk_fma_f32 v[56:57], v[24:25], v[24:25], s[52:53]
    v_pk_fma_f32 v[58:59], v[26:27], v[26:27], s[52:53]
    v_pk_fma_f32 v[60:61], v[28:29], v[28:29], s[52:53]
    v_pk_fma_f32 v[62:63], v[30:31], v[30:31], s[52:53]
    v_pk_mul_f32 v[48:49], v[48:49], v[16:17] neg_lo:[1,0] neg_hi:[1,0]
    v_pk_mul_f32 v[50:51], v[50:51], v[18:19] neg_lo:[1,0] neg_hi:[1,0]
    v_pk_mul_f32 v[52:53], v[52:53], v[20:21] neg_lo:[1,0] neg_hi:[1,0]
    v_pk_mul_f32 v[54:55], v[54:55], v[22:23] neg_lo:[1,0] neg_hi:[1,0]
    v_pk_mul_f32 v[56:57], v[56:57], v[24:25] neg_lo:[1,0] neg_hi:[1,0]
    v_pk_mul_f32 v[58:59], v[58:59], v[26:27] neg_lo:[1,0] neg_hi:[1,0]
    v_pk_mul_f32 v[60:61], v[60:61], v[28:29] neg_lo:[1,0] neg_hi:[1,0]
    v_pk_mul_f32 v[62:63], v[62:63], v[30:31] neg_lo:[1,0] neg_hi:[1,0]
L_pf18:
    v_mfma_f32_32x32x16_bf16 v[32:47], a[0:3], v[72:75], 0
    s_waitcnt lgkmcnt(3)
    ds_read_b128 a[20:23], v2 offset:29696
    ds_read_b128 a[0:3], v2 offset:30720
    v_exp_f32 v48, v48
    v_exp_f32 v49, v49
    v_mfma_f32_32x32x16_bf16 v[32:47], a[4:7], v[76:79], v[32:47]
    s_waitcnt lgkmcnt(4)
    buffer_load_dwordx4 v[216:219], v1, s[24:27], s54 offen offset:64
    buffer_load_dwordx4 v[220:223], v1, s[24:27], s54 offen offset:96
    s_mov_b32 s63, L_pf18-L_pc+12288
    v_exp_f32 v50, v50
    v_cvt_pk_bf16_f32 v64, v144, v145
    v_mfma_f32_32x32x16_bf16 v[32:47], a[8:11], v[80:83], v[32:47]
    s_waitcnt lgkmcnt(3)
    ds_read_b128 a[4:7], v2 offset:31744
    ds_read_b128 a[8:11], v2 offset:32768
    v_exp_f32 v51, v51
    v_exp_f32 v52, v52
    v_mfma_f32_32x32x16_bf16 v[32:47], a[12:15], v[84:87], v[32:47]
    s_waitcnt lgkmcnt(4)
    buffer_load_dword v6, v7, s[68:71], s63 offen
    v_exp_f32 v53, v53
    v_exp_f32 v54, v54
    v_cvt_pk_bf16_f32 v65, v146, v147
    v_mfma_f32_32x32x16_bf16 v[32:47], a[16:19], v[88:91], v[32:47]
    s_waitcnt lgkmcnt(3)
    ds_read_b128 a[12:15], v2 offset:33792
    ds_read_b128 a[16:19], v2 offset:34816
    v_exp_f32 v55, v55
    v_exp_f32_e64 v56, v56
    v_mfma_f32_32x32x16_bf16 v[32:47], a[20:23], v[92:95], v[32:47]
    s_waitcnt lgkmcnt(4)
    v_cvt_pk_bf16_f32 v66, v148, v149
    v_cvt_pk_bf16_f32 v67, v150, v151
    v_cvt_pk_bf16_f32 v68, v152, v153
    v_cvt_pk_bf16_f32 v69, v154, v155
    v_cvt_pk_bf16_f32 v70, v156, v157
    v_cvt_pk_bf16_f32 v71, v158, v159
    v_exp_f32 v57, v57
    v_exp_f32 v58, v58
    v_exp_f32 v59, v59
    v_exp_f32 v60, v60
    v_exp_f32 v61, v61
    v_exp_f32 v62, v62
    v_exp_f32_e64 v63, v63
    v_pk_add_f32 v[48:49], v[48:49], 1.0 op_sel_hi:[1,0]
    v_pk_add_f32 v[50:51], v[50:51], 1.0 op_sel_hi:[1,0]
    v_pk_add_f32 v[52:53], v[52:53], 1.0 op_sel_hi:[1,0]
    v_pk_add_f32 v[54:55], v[54:55], 1.0 op_sel_hi:[1,0]
    v_pk_add_f32 v[56:57], v[56:57], 1.0 op_sel_hi:[1,0]
    v_pk_add_f32 v[58:59], v[58:59], 1.0 op_sel_hi:[1,0]
    v_pk_add_f32 v[60:61], v[60:61], 1.0 op_sel_hi:[1,0]
    v_pk_add_f32 v[62:63], v[62:63], 1.0 op_sel_hi:[1,0]
    v_mfma_f32_32x32x16_bf16 v[176:191], a[28:31], v[244:247], v[176:191]
    v_rcp_f32 v48, v48
    v_rcp_f32 v49, v49
    v_rcp_f32 v50, v50
    v_mfma_f32_32x32x16_bf16 v[192:207], a[24:27], v[248:251], v[192:207]
    v_rcp_f32 v51, v51
    v_rcp_f32 v52, v52
    v_rcp_f32 v53, v53
    v_mfma_f32_32x32x16_bf16 v[192:207], a[28:31], v[252:255], v[192:207]
    v_rcp_f32 v54, v54
    v_rcp_f32 v55, v55
    v_rcp_f32 v56, v56
    v_mfma_f32_32x32x16_bf16 v[160:175], a[176:179], v[64:67], v[160:175]
    v_rcp_f32 v57, v57
    v_rcp_f32 v58, v58
    v_rcp_f32 v59, v59
    v_mfma_f32_32x32x16_bf16 v[176:191], a[180:183], v[64:67], v[176:191]
    v_rcp_f32 v60, v60
    v_rcp_f32 v61, v61
    v_rcp_f32 v62, v62
    v_mfma_f32_32x32x16_bf16 v[192:207], a[184:187], v[64:67], v[192:207]
    v_rcp_f32 v63, v63
    v_mfma_f32_32x32x16_bf16 v[160:175], a[188:191], v[68:71], v[160:175]
    v_mfma_f32_32x32x16_bf16 v[176:191], a[192:195], v[68:71], v[176:191]
    v_mfma_f32_32x32x16_bf16 v[192:207], a[196:199], v[68:71], v[192:207]
    v_pk_mul_f32 v[16:17], v[16:17], v[48:49]
    v_pk_mul_f32 v[18:19], v[18:19], v[50:51]
    v_pk_mul_f32 v[20:21], v[20:21], v[52:53]
    v_pk_mul_f32 v[22:23], v[22:23], v[54:55]
    v_pk_mul_f32 v[24:25], v[24:25], v[56:57]
    v_pk_mul_f32 v[26:27], v[26:27], v[58:59]
    v_pk_mul_f32 v[28:29], v[28:29], v[60:61]
    v_pk_mul_f32 v[30:31], v[30:31], v[62:63]
    v_pk_fma_f32 v[48:49], v[32:33], v[32:33], s[52:53]
    v_pk_fma_f32 v[50:51], v[34:35], v[34:35], s[52:53]
    v_pk_fma_f32 v[52:53], v[36:37], v[36:37], s[52:53]
    v_pk_fma_f32 v[54:55], v[38:39], v[38:39], s[52:53]
    v_pk_fma_f32 v[56:57], v[40:41], v[40:41], s[52:53]
    v_pk_fma_f32 v[58:59], v[42:43], v[42:43], s[52:53]
    v_pk_fma_f32 v[60:61], v[44:45], v[44:45], s[52:53]
    v_pk_fma_f32 v[62:63], v[46:47], v[46:47], s[52:53]
    v_pk_mul_f32 v[48:49], v[48:49], v[32:33] neg_lo:[1,0] neg_hi:[1,0]
    v_pk_mul_f32 v[50:51], v[50:51], v[34:35] neg_lo:[1,0] neg_hi:[1,0]
    v_pk_mul_f32 v[52:53], v[52:53], v[36:37] neg_lo:[1,0] neg_hi:[1,0]
    v_pk_mul_f32 v[54:55], v[54:55], v[38:39] neg_lo:[1,0] neg_hi:[1,0]
    v_pk_mul_f32 v[56:57], v[56:57], v[40:41] neg_lo:[1,0] neg_hi:[1,0]
    v_pk_mul_f32 v[58:59], v[58:59], v[42:43] neg_lo:[1,0] neg_hi:[1,0]
    v_pk_mul_f32 v[60:61], v[60:61], v[44:45] neg_lo:[1,0] neg_hi:[1,0]
    v_pk_mul_f32 v[62:63], v[62:63], v[46:47] neg_lo:[1,0] neg_hi:[1,0]
    v_mfma_f32_32x32x16_bf16 v[144:159], a[0:3], v[72:75], 0
    s_waitcnt lgkmcnt(3)
    ds_read_b128 a[20:23], v2 offset:35840
    ds_read_b128 a[0:3], v2 offset:36864
    v_exp_f32 v48, v48
    v_exp_f32 v49, v49
    v_mfma_f32_32x32x16_bf16 v[144:159], a[4:7], v[76:79], v[144:159]
    s_waitcnt lgkmcnt(4)
    v_exp_f32 v50, v50
    v_exp_f32 v51, v51
    v_exp_f32 v52, v52
    v_mfma_f32_32x32x16_bf16 v[144:159], a[8:11], v[80:83], v[144:159]
    s_waitcnt lgkmcnt(3)
    ds_read_b128 a[4:7], v2 offset:37888
    ds_read_b128 a[8:11], v2 offset:38912
    v_exp_f32 v53, v53
    v_exp_f32 v54, v54
    v_mfma_f32_32x32x16_bf16 v[144:159], a[12:15], v[84:87], v[144:159]
    s_waitcnt lgkmcnt(4)
    v_exp_f32 v55, v55
    v_exp_f32 v56, v56
    v_exp_f32 v57, v57
    v_mfma_f32_32x32x16_bf16 v[144:159], a[16:19], v[88:91], v[144:159]
    s_waitcnt lgkmcnt(3)
    ds_read_b128 a[12:15], v2 offset:39936
    ds_read_b128 a[16:19], v2 offset:40960
    v_exp_f32 v58, v58
    v_exp_f32 v59, v59
    v_mfma_f32_32x32x16_bf16 v[144:159], a[20:23], v[92:95], v[144:159]
    s_waitcnt lgkmcnt(4)
    v_cvt_pk_bf16_f32 v64, v16, v17
    v_cvt_pk_bf16_f32 v65, v18, v19
    v_cvt_pk_bf16_f32 v66, v20, v21
    v_cvt_pk_bf16_f32 v67, v22, v23
    v_exp_f32 v60, v60
    v_exp_f32 v61, v61
    v_exp_f32 v62, v62
    v_exp_f32 v63, v63
    v_pk_add_f32 v[48:49], v[48:49], 1.0 op_sel_hi:[1,0]
    v_pk_add_f32 v[50:51], v[50:51], 1.0 op_sel_hi:[1,0]
    v_pk_add_f32 v[52:53], v[52:53], 1.0 op_sel_hi:[1,0]
    v_pk_add_f32 v[54:55], v[54:55], 1.0 op_sel_hi:[1,0]
    v_pk_add_f32 v[56:57], v[56:57], 1.0 op_sel_hi:[1,0]
    v_pk_add_f32 v[58:59], v[58:59], 1.0 op_sel_hi:[1,0]
    v_pk_add_f32 v[60:61], v[60:61], 1.0 op_sel_hi:[1,0]
    v_pk_add_f32 v[62:63], v[62:63], 1.0 op_sel_hi:[1,0]
    v_mfma_f32_32x32x16_bf16 v[160:175], a[200:203], v[64:67], v[160:175]
    buffer_load_dwordx4 v[224:227], v1, s[24:27], s54 offen offset:128
    buffer_load_dwordx4 v[228:231], v1, s[24:27], s54 offen offset:160
    v_cvt_pk_bf16_f32 v68, v24, v25
    v_cvt_pk_bf16_f32 v69, v26, v27
    v_cvt_pk_bf16_f32 v70, v28, v29
    v_cvt_pk_bf16_f32 v71, v30, v31
    v_mfma_f32_32x32x16_bf16 v[176:191], a[204:207], v[64:67], v[176:191]
    v_rcp_f32 v48, v48
    v_rcp_f32 v49, v49
    v_rcp_f32 v50, v50
    v_mfma_f32_32x32x16_bf16 v[192:207], a[208:211], v[64:67], v[192:207]
    v_rcp_f32 v51, v51
    v_rcp_f32 v52, v52
    v_rcp_f32 v53, v53
    v_mfma_f32_32x32x16_bf16 v[160:175], a[212:215], v[68:71], v[160:175]
    v_rcp_f32 v54, v54
    v_rcp_f32 v55, v55
    v_rcp_f32 v56, v56
    v_mfma_f32_32x32x16_bf16 v[176:191], a[216:219], v[68:71], v[176:191]
    v_rcp_f32 v57, v57
    v_rcp_f32 v58, v58
    v_rcp_f32 v59, v59
    v_mfma_f32_32x32x16_bf16 v[192:207], a[220:223], v[68:71], v[192:207]
    v_rcp_f32 v60, v60
    v_rcp_f32 v61, v61
    v_rcp_f32 v62, v62
    v_rcp_f32 v63, v63
    v_pk_mul_f32 v[32:33], v[32:33], v[48:49]
    v_pk_mul_f32 v[34:35], v[34:35], v[50:51]
    v_pk_mul_f32 v[36:37], v[36:37], v[52:53]
    v_pk_mul_f32 v[38:39], v[38:39], v[54:55]
    v_pk_mul_f32 v[40:41], v[40:41], v[56:57]
    v_pk_mul_f32 v[42:43], v[42:43], v[58:59]
    v_pk_mul_f32 v[44:45], v[44:45], v[60:61]
    v_pk_mul_f32 v[46:47], v[46:47], v[62:63]
    v_pk_fma_f32 v[48:49], v[144:145], v[144:145], s[52:53]
    v_pk_fma_f32 v[50:51], v[146:147], v[146:147], s[52:53]
    v_pk_fma_f32 v[52:53], v[148:149], v[148:149], s[52:53]
    v_pk_fma_f32 v[54:55], v[150:151], v[150:151], s[52:53]
    v_pk_fma_f32 v[56:57], v[152:153], v[152:153], s[52:53]
    v_pk_fma_f32 v[58:59], v[154:155], v[154:155], s[52:53]
    v_pk_fma_f32 v[60:61], v[156:157], v[156:157], s[52:53]
    v_pk_fma_f32 v[62:63], v[158:159], v[158:159], s[52:53]
    v_pk_mul_f32 v[48:49], v[48:49], v[144:145] neg_lo:[1,0] neg_hi:[1,0]
    v_pk_mul_f32 v[50:51], v[50:51], v[146:147] neg_lo:[1,0] neg_hi:[1,0]
    v_pk_mul_f32 v[52:53], v[52:53], v[148:149] neg_lo:[1,0] neg_hi:[1,0]
    v_pk_mul_f32 v[54:55], v[54:55], v[150:151] neg_lo:[1,0] neg_hi:[1,0]
    v_pk_mul_f32 v[56:57], v[56:57], v[152:153] neg_lo:[1,0] neg_hi:[1,0]
    v_pk_mul_f32 v[58:59], v[58:59], v[154:155] neg_lo:[1,0] neg_hi:[1,0]
    v_pk_mul_f32 v[60:61], v[60:61], v[156:157] neg_lo:[1,0] neg_hi:[1,0]
    v_pk_mul_f32 v[62:63], v[62:63], v[158:159] neg_lo:[1,0] neg_hi:[1,0]
    v_mfma_f32_32x32x16_bf16 v[16:31], a[0:3], v[72:75], 0
    s_waitcnt lgkmcnt(3)
    ds_read_b128 a[20:23], v2 offset:41984
    ds_read_b128 a[0:3], v2 offset:43008
    v_exp_f32 v48, v48
    v_exp_f32 v49, v49
    v_mfma_f32_32x32x16_bf16 v[16:31], a[4:7], v[76:79], v[16:31]
    s_waitcnt lgkmcnt(4)
    s_add_u32 s55, s56, 98304
    buffer_store_dwordx4 v[96:99], v9, s[28:31], s55 offen offset:0 sc1
    buffer_store_dwordx4 v[112:115], v9, s[28:31], s55 offen offset:64 sc1
    buffer_store_dwordx4 v[128:131], v9, s[28:31], s55 offen offset:128 sc1
    v_exp_f32 v50, v50
    v_mfma_f32_32x32x16_bf16 v[16:31], a[8:11], v[80:83], v[16:31]
    s_waitcnt lgkmcnt(3)
    ds_read_b128 a[4:7], v2 offset:44032
    ds_read_b128 a[8:11], v2 offset:45056
    v_exp_f32 v51, v51
    v_exp_f32 v52, v52
    v_mfma_f32_32x32x16_bf16 v[16:31], a[12:15], v[84:87], v[16:31]
    s_waitcnt lgkmcnt(4)
    ds_read_b128 a[32:35], v3 offset:32768
    ds_read_b128 a[36:39], v3 offset:33792
    ds_read_b128 a[40:43], v3 offset:34816
    v_exp_f32 v53, v53
    v_cvt_pk_bf16_f32 v64, v32, v33
    v_mfma_f32_32x32x16_bf16 v[16:31], a[16:19], v[88:91], v[16:31]
    s_waitcnt lgkmcnt(6)
    ds_read_b128 a[12:15], v2 offset:46080
    ds_read_b128 a[16:19], v2 offset:47104
    v_exp_f32 v54, v54
    v_exp_f32 v55, v55
    v_mfma_f32_32x32x16_bf16 v[16:31], a[20:23], v[92:95], v[16:31]
    s_waitcnt lgkmcnt(7)
    ds_read_b128 a[44:47], v3 offset:35840
    ds_read_b128 a[48:51], v3 offset:36864
    ds_read_b128 a[52:55], v3 offset:37888
    v_cvt_pk_bf16_f32 v65, v34, v35
    v_cvt_pk_bf16_f32 v66, v36, v37
    v_cvt_pk_bf16_f32 v67, v38, v39
    v_exp_f32 v56, v56
    v_exp_f32 v57, v57
    v_exp_f32 v58, v58
    v_exp_f32 v59, v59
    v_exp_f32 v60, v60
    v_exp_f32 v61, v61
    v_exp_f32 v62, v62
    v_exp_f32 v63, v63
    v_pk_add_f32 v[48:49], v[48:49], 1.0 op_sel_hi:[1,0]
    v_pk_add_f32 v[50:51], v[50:51], 1.0 op_sel_hi:[1,0]
    v_pk_add_f32 v[52:53], v[52:53], 1.0 op_sel_hi:[1,0]
    v_pk_add_f32 v[54:55], v[54:55], 1.0 op_sel_hi:[1,0]
    v_pk_add_f32 v[56:57], v[56:57], 1.0 op_sel_hi:[1,0]
    v_pk_add_f32 v[58:59], v[58:59], 1.0 op_sel_hi:[1,0]
    v_pk_add_f32 v[60:61], v[60:61], 1.0 op_sel_hi:[1,0]
    v_pk_add_f32 v[62:63], v[62:63], 1.0 op_sel_hi:[1,0]
    s_waitcnt lgkmcnt(0)
    v_mfma_f32_32x32x16_bf16 v[160:175], a[32:35], v[64:67], v[160:175]
    v_cvt_pk_bf16_f32 v68, v40, v41
    v_cvt_pk_bf16_f32 v69, v42, v43
    v_cvt_pk_bf16_f32 v70, v44, v45
    v_cvt_pk_bf16_f32 v71, v46, v47
    v_rcp_f32 v48, v48
    v_mfma_f32_32x32x16_bf16 v[176:191], a[36:39], v[64:67], v[176:191]
    v_rcp_f32 v49, v49
    v_rcp_f32 v50, v50
    v_rcp_f32 v51, v51
    v_mfma_f32_32x32x16_bf16 v[192:207], a[40:43], v[64:67], v[192:207]
    v_rcp_f32 v52, v52
    v_rcp_f32 v53, v53
    v_rcp_f32 v54, v54
    v_mfma_f32_32x32x16_bf16 v[160:175], a[44:47], v[68:71], v[160:175]
    v_rcp_f32 v55, v55
    v_rcp_f32 v56, v56
    v_rcp_f32 v57, v57
    v_mfma_f32_32x32x16_bf16 v[176:191], a[48:51], v[68:71], v[176:191]
    v_rcp_f32 v58, v58
    v_rcp_f32 v59, v59
    v_rcp_f32 v60, v60
    v_mfma_f32_32x32x16_bf16 v[192:207], a[52:55], v[68:71], v[192:207]
    v_rcp_f32 v61, v61
    v_rcp_f32 v62, v62
    v_rcp_f32_e64 v63, v63
    v_pk_mul_f32 v[144:145], v[144:145], v[48:49]
    v_pk_mul_f32 v[146:147], v[146:147], v[50:51]
    v_pk_mul_f32 v[148:149], v[148:149], v[52:53]
    v_pk_mul_f32 v[150:151], v[150:151], v[54:55]
    v_pk_mul_f32 v[152:153], v[152:153], v[56:57]
    v_pk_mul_f32 v[154:155], v[154:155], v[58:59]
    v_pk_mul_f32 v[156:157], v[156:157], v[60:61]
    v_pk_mul_f32 v[158:159], v[158:159], v[62:63]
    v_pk_fma_f32 v[48:49], v[16:17], v[16:17], s[52:53]
    v_pk_fma_f32 v[50:51], v[18:19], v[18:19], s[52:53]
    v_pk_fma_f32 v[52:53], v[20:21], v[20:21], s[52:53]
    v_pk_fma_f32 v[54:55], v[22:23], v[22:23], s[52:53]
    v_pk_fma_f32 v[56:57], v[24:25], v[24:25], s[52:53]
    v_pk_fma_f32 v[58:59], v[26:27], v[26:27], s[52:53]
    v_pk_fma_f32 v[60:61], v[28:29], v[28:29], s[52:53]
    v_pk_fma_f32 v[62:63], v[30:31], v[30:31], s[52:53]
    v_pk_mul_f32 v[48:49], v[48:49], v[16:17] neg_lo:[1,0] neg_hi:[1,0]
    v_pk_mul_f32 v[50:51], v[50:51], v[18:19] neg_lo:[1,0] neg_hi:[1,0]
    v_pk_mul_f32 v[52:53], v[52:53], v[20:21] neg_lo:[1,0] neg_hi:[1,0]
    v_pk_mul_f32 v[54:55], v[54:55], v[22:23] neg_lo:[1,0] neg_hi:[1,0]
    v_pk_mul_f32 v[56:57], v[56:57], v[24:25] neg_lo:[1,0] neg_hi:[1,0]
    v_pk_mul_f32 v[58:59], v[58:59], v[26:27] neg_lo:[1,0] neg_hi:[1,0]
    v_pk_mul_f32 v[60:61], v[60:61], v[28:29] neg_lo:[1,0] neg_hi:[1,0]
    v_pk_mul_f32 v[62:63], v[62:63], v[30:31] neg_lo:[1,0] neg_hi:[1,0]
    v_mfma_f32_32x32x16_bf16 v[32:47], a[0:3], v[72:75], 0
    ds_read_b128 a[20:23], v2 offset:48128
    ds_read_b128 a[0:3], v2 offset:49152
    v_exp_f32 v48, v48
    v_exp_f32 v49, v49
    v_mfma_f32_32x32x16_bf16 v[32:47], a[4:7], v[76:79], v[32:47]
    ds_read_b128 a[56:59], v3 offset:38912
    ds_read_b128 a[60:63], v3 offset:39936
    v_exp_f32 v50, v50
    v_exp_f32 v51, v51
    v_mfma_f32_32x32x16_bf16 v[32:47], a[8:11], v[80:83], v[32:47]
    ds_read_b128 a[4:7], v2 offset:50176
    ds_read_b128 a[8:11], v2 offset:51200
    v_exp_f32 v52, v52
    v_exp_f32 v53, v53
    v_mfma_f32_32x32x16_bf16 v[32:47], a[12:15], v[84:87], v[32:47]
    ds_read_b128 a[64:67], v3 offset:40960
    ds_read_b128 a[68:71], v3 offset:41984
    v_exp_f32 v54, v54
    v_exp_f32 v55, v55
    v_mfma_f32_32x32x16_bf16 v[32:47], a[16:19], v[88:91], v[32:47]
    s_waitcnt lgkmcnt(7)
    ds_read_b128 a[12:15], v2 offset:52224
    ds_read_b128 a[16:19], v2 offset:53248
    v_exp_f32 v56, v56
    v_exp_f32 v57, v57
    v_mfma_f32_32x32x16_bf16 v[32:47], a[20:23], v[92:95], v[32:47]
    s_waitcnt lgkmcnt(8)
    ds_read_b128 a[72:75], v3 offset:43008
    ds_read_b128 a[76:79], v3 offset:44032
    v_cvt_pk_bf16_f32 v64, v144, v145
    v_cvt_pk_bf16_f32 v65, v146, v147
    v_cvt_pk_bf16_f32 v66, v148, v149
    v_cvt_pk_bf16_f32 v67, v150, v151
    v_exp_f32 v58, v58
    v_exp_f32 v59, v59
    v_exp_f32 v60, v60
    v_exp_f32 v61, v61
    v_exp_f32 v62, v62
    v_exp_f32 v63, v63
    v_pk_add_f32 v[48:49], v[48:49], 1.0 op_sel_hi:[1,0]
    v_pk_add_f32 v[50:51], v[50:51], 1.0 op_sel_hi:[1,0]
    v_pk_add_f32 v[52:53], v[52:53], 1.0 op_sel_hi:[1,0]
    v_pk_add_f32 v[54:55], v[54:55], 1.0 op_sel_hi:[1,0]
    v_pk_add_f32 v[56:57], v[56:57], 1.0 op_sel_hi:[1,0]
    v_pk_add_f32 v[58:59], v[58:59], 1.0 op_sel_hi:[1,0]
    v_pk_add_f32 v[60:61], v[60:61], 1.0 op_sel_hi:[1,0]
    v_pk_add_f32 v[62:63], v[62:63], 1.0 op_sel_hi:[1,0]
    s_waitcnt lgkmcnt(0)
    v_mfma_f32_32x32x16_bf16 v[160:175], a[56:59], v[64:67], v[160:175]
    v_cvt_pk_bf16_f32 v68, v152, v153
    v_cvt_pk_bf16_f32 v69, v154, v155
    v_cvt_pk_bf16_f32 v70, v156, v157
    v_cvt_pk_bf16_f32 v71, v158, v159
    v_rcp_f32 v48, v48
    v_mfma_f32_32x32x16_bf16 v[176:191], a[60:63], v[64:67], v[176:191]
    v_rcp_f32 v49, v49
    v_rcp_f32 v50, v50
    v_rcp_f32 v51, v51
    v_mfma_f32_32x32x16_bf16 v[192:207], a[64:67], v[64:67], v[192:207]
    v_rcp_f32 v52, v52
    v_rcp_f32 v53, v53
    v_rcp_f32 v54, v54
    v_mfma_f32_32x32x16_bf16 v[160:175], a[68:71], v[68:71], v[160:175]
    v_rcp_f32 v55, v55
    v_rcp_f32 v56, v56
    v_rcp_f32 v57, v57
    v_mfma_f32_32x32x16_bf16 v[176:191], a[72:75], v[68:71], v[176:191]
    v_rcp_f32 v58, v58
    v_rcp_f32 v59, v59
    v_rcp_f32 v60, v60
    v_mfma_f32_32x32x16_bf16 v[192:207], a[76:79], v[68:71], v[192:207]
    v_rcp_f32 v61, v61
    v_rcp_f32 v62, v62
    v_rcp_f32_e64 v63, v63
    v_pk_mul_f32 v[16:17], v[16:17], v[48:49]
    v_pk_mul_f32 v[18:19], v[18:19], v[50:51]
    v_pk_mul_f32 v[20:21], v[20:21], v[52:53]
    v_pk_mul_f32 v[22:23], v[22:23], v[54:55]
    v_pk_mul_f32 v[24:25], v[24:25], v[56:57]
    v_pk_mul_f32 v[26:27], v[26:27], v[58:59]
    v_pk_mul_f32 v[28:29], v[28:29], v[60:61]
    v_pk_mul_f32 v[30:31], v[30:31], v[62:63]
    v_pk_fma_f32 v[48:49], v[32:33], v[32:33], s[52:53]
    v_pk_fma_f32 v[50:51], v[34:35], v[34:35], s[52:53]
    v_pk_fma_f32 v[52:53], v[36:37], v[36:37], s[52:53]
    v_pk_fma_f32 v[54:55], v[38:39], v[38:39], s[52:53]
    v_pk_fma_f32 v[56:57], v[40:41], v[40:41], s[52:53]
    v_pk_fma_f32 v[58:59], v[42:43], v[42:43], s[52:53]
    v_pk_fma_f32 v[60:61], v[44:45], v[44:45], s[52:53]
    v_pk_fma_f32 v[62:63], v[46:47], v[46:47], s[52:53]
    v_pk_mul_f32 v[48:49], v[48:49], v[32:33] neg_lo:[1,0] neg_hi:[1,0]
    v_pk_mul_f32 v[50:51], v[50:51], v[34:35] neg_lo:[1,0] neg_hi:[1,0]
    v_pk_mul_f32 v[52:53], v[52:53], v[36:37] neg_lo:[1,0] neg_hi:[1,0]
    v_pk_mul_f32 v[54:55], v[54:55], v[38:39] neg_lo:[1,0] neg_hi:[1,0]
    v_pk_mul_f32 v[56:57], v[56:57], v[40:41] neg_lo:[1,0] neg_hi:[1,0]
    v_pk_mul_f32 v[58:59], v[58:59], v[42:43] neg_lo:[1,0] neg_hi:[1,0]
    v_pk_mul_f32 v[60:61], v[60:61], v[44:45] neg_lo:[1,0] neg_hi:[1,0]
    v_pk_mul_f32 v[62:63], v[62:63], v[46:47] neg_lo:[1,0] neg_hi:[1,0]
    v_mfma_f32_32x32x16_bf16 v[144:159], a[0:3], v[72:75], 0
    ds_read_b128 a[20:23], v2 offset:54272
    ds_read_b128 a[0:3], v2 offset:55296
    v_exp_f32 v48, v48
    v_exp_f32 v49, v49
    v_mfma_f32_32x32x16_bf16 v[144:159], a[4:7], v[76:79], v[144:159]
    ds_read_b128 a[80:83], v3 offset:45056
    ds_read_b128 a[84:87], v3 offset:46080
    v_exp_f32 v50, v50
    v_exp_f32 v51, v51
    v_mfma_f32_32x32x16_bf16 v[144:159], a[8:11], v[80:83], v[144:159]
    ds_read_b128 a[4:7], v2 offset:56320
    ds_read_b128 a[8:11], v2 offset:57344
    v_exp_f32 v52, v52
    v_exp_f32 v53, v53
    v_mfma_f32_32x32x16_bf16 v[144:159], a[12:15], v[84:87], v[144:159]
    ds_read_b128 a[88:91], v3 offset:47104
    ds_read_b128 a[92:95], v3 offset:48128
    v_exp_f32 v54, v54
    v_exp_f32 v55, v55
    v_mfma_f32_32x32x16_bf16 v[144:159], a[16:19], v[88:91], v[144:159]
    s_waitcnt lgkmcnt(7)
    ds_read_b128 a[12:15], v2 offset:58368
    ds_read_b128 a[16:19], v2 offset:59392
    v_exp_f32 v56, v56
    v_exp_f32 v57, v57
    v_mfma_f32_32x32x16_bf16 v[144:159], a[20:23], v[92:95], v[144:159]
    s_waitcnt lgkmcnt(8)
    ds_read_b128 a[96:99], v3 offset:49152
    ds_read_b128 a[100:103], v3 offset:50176
    v_cvt_pk_bf16_f32 v64, v16, v17
    v_cvt_pk_bf16_f32 v65, v18, v19
    v_cvt_pk_bf16_f32 v66, v20, v21
    v_cvt_pk_bf16_f32 v67, v22, v23
    v_exp_f32 v58, v58
    v_exp_f32 v59, v59
    v_exp_f32 v60, v60
    v_exp_f32 v61, v61
    v_exp_f32 v62, v62
    v_exp_f32 v63, v63
    v_pk_add_f32 v[48:49], v[48:49], 1.0 op_sel_hi:[1,0]
    v_pk_add_f32 v[50:51], v[50:51], 1.0 op_sel_hi:[1,0]
    v_pk_add_f32 v[52:53], v[52:53], 1.0 op_sel_hi:[1,0]
    v_pk_add_f32 v[54:55], v[54:55], 1.0 op_sel_hi:[1,0]
    v_pk_add_f32 v[56:57], v[56:57], 1.0 op_sel_hi:[1,0]
    v_pk_add_f32 v[58:59], v[58:59], 1.0 op_sel_hi:[1,0]
    v_pk_add_f32 v[60:61], v[60:61], 1.0 op_sel_hi:[1,0]
    v_pk_add_f32 v[62:63], v[62:63], 1.0 op_sel_hi:[1,0]
    s_waitcnt lgkmcnt(0)
    v_mfma_f32_32x32x16_bf16 v[160:175], a[80:83], v[64:67], v[160:175]
    v_cvt_pk_bf16_f32 v68, v24, v25
    v_cvt_pk_bf16_f32 v69, v26, v27
    v_cvt_pk_bf16_f32 v70, v28, v29
    v_cvt_pk_bf16_f32 v71, v30, v31
    v_rcp_f32 v48, v48
    v_mfma_f32_32x32x16_bf16 v[176:191], a[84:87], v[64:67], v[176:191]
    v_rcp_f32 v49, v49
    v_rcp_f32 v50, v50
    v_rcp_f32 v51, v51
    v_mfma_f32_32x32x16_bf16 v[192:207], a[88:91], v[64:67], v[192:207]
    v_rcp_f32 v52, v52
    v_rcp_f32 v53, v53
    v_rcp_f32 v54, v54
    v_mfma_f32_32x32x16_bf16 v[160:175], a[92:95], v[68:71], v[160:175]
    v_rcp_f32 v55, v55
    v_rcp_f32 v56, v56
    v_rcp_f32 v57, v57
    v_mfma_f32_32x32x16_bf16 v[176:191], a[96:99], v[68:71], v[176:191]
    v_rcp_f32 v58, v58
    v_rcp_f32 v59, v59
    v_rcp_f32 v60, v60
    v_mfma_f32_32x32x16_bf16 v[192:207], a[100:103], v[68:71], v[192:207]
    v_rcp_f32 v61, v61
    v_rcp_f32 v62, v62
    v_rcp_f32_e64 v63, v63
    v_pk_mul_f32 v[32:33], v[32:33], v[48:49]
    v_pk_mul_f32 v[34:35], v[34:35], v[50:51]
    v_pk_mul_f32 v[36:37], v[36:37], v[52:53]
    v_pk_mul_f32 v[38:39], v[38:39], v[54:55]
    v_pk_mul_f32 v[40:41], v[40:41], v[56:57]
    v_pk_mul_f32 v[42:43], v[42:43], v[58:59]
    v_pk_mul_f32 v[44:45], v[44:45], v[60:61]
    v_pk_mul_f32 v[46:47], v[46:47], v[62:63]
    v_pk_fma_f32 v[48:49], v[144:145], v[144:145], s[52:53]
    v_pk_fma_f32 v[50:51], v[146:147], v[146:147], s[52:53]
    v_pk_fma_f32 v[52:53], v[148:149], v[148:149], s[52:53]
    v_pk_fma_f32 v[54:55], v[150:151], v[150:151], s[52:53]
    v_pk_fma_f32 v[56:57], v[152:153], v[152:153], s[52:53]
    v_pk_fma_f32 v[58:59], v[154:155], v[154:155], s[52:53]
    v_pk_fma_f32 v[60:61], v[156:157], v[156:157], s[52:53]
    v_pk_fma_f32 v[62:63], v[158:159], v[158:159], s[52:53]
    v_pk_mul_f32 v[48:49], v[48:49], v[144:145] neg_lo:[1,0] neg_hi:[1,0]
    v_pk_mul_f32 v[50:51], v[50:51], v[146:147] neg_lo:[1,0] neg_hi:[1,0]
    v_pk_mul_f32 v[52:53], v[52:53], v[148:149] neg_lo:[1,0] neg_hi:[1,0]
    v_pk_mul_f32 v[54:55], v[54:55], v[150:151] neg_lo:[1,0] neg_hi:[1,0]
    v_pk_mul_f32 v[56:57], v[56:57], v[152:153] neg_lo:[1,0] neg_hi:[1,0]
    v_pk_mul_f32 v[58:59], v[58:59], v[154:155] neg_lo:[1,0] neg_hi:[1,0]
    v_pk_mul_f32 v[60:61], v[60:61], v[156:157] neg_lo:[1,0] neg_hi:[1,0]
    v_pk_mul_f32 v[62:63], v[62:63], v[158:159] neg_lo:[1,0] neg_hi:[1,0]
    v_mfma_f32_32x32x16_bf16 v[16:31], a[0:3], v[72:75], 0
    ds_read_b128 a[20:23], v2 offset:60416
    ds_read_b128 a[0:3], v2 offset:61440
    v_exp_f32 v48, v48
    v_exp_f32 v49, v49
    v_mfma_f32_32x32x16_bf16 v[16:31], a[4:7], v[76:79], v[16:31]
    ds_read_b128 a[104:107], v3 offset:51200
    ds_read_b128 a[108:111], v3 offset:52224
    ds_read_b128 a[112:115], v3 offset:53248
    v_exp_f32 v50, v50
    v_cvt_pk_bf16_f32 v64, v32, v33
    v_mfma_f32_32x32x16_bf16 v[16:31], a[8:11], v[80:83], v[16:31]
    ds_read_b128 a[4:7], v2 offset:62464
    ds_read_b128 a[8:11], v2 offset:63488
    v_exp_f32 v51, v51
    v_exp_f32 v52, v52
    v_mfma_f32_32x32x16_bf16 v[16:31], a[12:15], v[84:87], v[16:31]
    ds_read_b128 a[116:119], v3 offset:54272
    ds_read_b128 a[120:123], v3 offset:55296
    ds_read_b128 a[124:127], v3 offset:56320
    v_exp_f32 v53, v53
    v_cvt_pk_bf16_f32 v65, v34, v35
    v_mfma_f32_32x32x16_bf16 v[16:31], a[16:19], v[88:91], v[16:31]
    s_waitcnt lgkmcnt(9)
    ds_read_b128 a[12:15], v2 offset:64512
    ds_read_b128 a[16:19], v3 offset:0
    v_exp_f32 v54, v54
    v_exp_f32 v55, v55
    v_mfma_f32_32x32x16_bf16 v[16:31], a[20:23], v[92:95], v[16:31]
    s_waitcnt lgkmcnt(10)
    buffer_load_dwordx2 v[12:13], v2, s[44:47], s58 offen offset:0
    v_cvt_pk_bf16_f32 v66, v36, v37
    v_cvt_pk_bf16_f32 v67, v38, v39
    v_exp_f32 v56, v56
    v_exp_f32 v57, v57
    v_exp_f32 v58, v58
    v_exp_f32 v59, v59
    v_exp_f32 v60, v60
    v_exp_f32 v61, v61
    v_exp_f32 v62, v62
    v_exp_f32 v63, v63
    v_pk_add_f32 v[48:49], v[48:49], 1.0 op_sel_hi:[1,0]
    v_pk_add_f32 v[50:51], v[50:51], 1.0 op_sel_hi:[1,0]
    v_pk_add_f32 v[52:53], v[52:53], 1.0 op_sel_hi:[1,0]
    v_pk_add_f32 v[54:55], v[54:55], 1.0 op_sel_hi:[1,0]
    v_pk_add_f32 v[56:57], v[56:57], 1.0 op_sel_hi:[1,0]
    v_pk_add_f32 v[58:59], v[58:59], 1.0 op_sel_hi:[1,0]
    v_pk_add_f32 v[60:61], v[60:61], 1.0 op_sel_hi:[1,0]
    v_pk_add_f32 v[62:63], v[62:63], 1.0 op_sel_hi:[1,0]
    s_waitcnt lgkmcnt(2)
    v_mfma_f32_32x32x16_bf16 v[160:175], a[104:107], v[64:67], v[160:175]
    v_cvt_pk_bf16_f32 v68, v40, v41
    v_cvt_pk_bf16_f32 v69, v42, v43
    v_cvt_pk_bf16_f32 v70, v44, v45
    v_cvt_pk_bf16_f32 v71, v46, v47
    v_rcp_f32 v48, v48
    v_mfma_f32_32x32x16_bf16 v[176:191], a[108:111], v[64:67], v[176:191]
    buffer_store_dwordx4 v[100:103], v9, s[28:31], s55 offen offset:3072 sc1
    buffer_store_dwordx4 v[116:119], v9, s[28:31], s55 offen offset:3136 sc1
    buffer_store_dwordx4 v[132:135], v9, s[28:31], s55 offen offset:3200 sc1
    v_rcp_f32 v49, v49
    v_mfma_f32_32x32x16_bf16 v[192:207], a[112:115], v[64:67], v[192:207]
    v_rcp_f32 v50, v50
    v_rcp_f32 v51, v51
    v_rcp_f32 v52, v52
    v_mfma_f32_32x32x16_bf16 v[160:175], a[116:119], v[68:71], v[160:175]
    v_rcp_f32 v53, v53
    v_rcp_f32 v54, v54
    v_rcp_f32 v55, v55
    v_mfma_f32_32x32x16_bf16 v[176:191], a[120:123], v[68:71], v[176:191]
    v_rcp_f32 v56, v56
    v_rcp_f32 v57, v57
    v_rcp_f32 v58, v58
    v_mfma_f32_32x32x16_bf16 v[192:207], a[124:127], v[68:71], v[192:207]
    v_rcp_f32 v59, v59
    v_rcp_f32 v60, v60
    v_rcp_f32 v61, v61
    v_rcp_f32 v62, v62
    v_rcp_f32_e64 v63, v63
    v_pk_mul_f32 v[144:145], v[144:145], v[48:49]
    v_pk_mul_f32 v[146:147], v[146:147], v[50:51]
    v_pk_mul_f32 v[148:149], v[148:149], v[52:53]
    v_pk_mul_f32 v[150:151], v[150:151], v[54:55]
    v_pk_mul_f32 v[152:153], v[152:153], v[56:57]
    v_pk_mul_f32 v[154:155], v[154:155], v[58:59]
    v_pk_mul_f32 v[156:157], v[156:157], v[60:61]
    v_pk_mul_f32 v[158:159], v[158:159], v[62:63]
    v_pk_fma_f32 v[48:49], v[16:17], v[16:17], s[52:53]
    v_pk_fma_f32 v[50:51], v[18:19], v[18:19], s[52:53]
    v_pk_fma_f32 v[52:53], v[20:21], v[20:21], s[52:53]
    v_pk_fma_f32 v[54:55], v[22:23], v[22:23], s[52:53]
    v_pk_fma_f32 v[56:57], v[24:25], v[24:25], s[52:53]
    v_pk_fma_f32 v[58:59], v[26:27], v[26:27], s[52:53]
    v_pk_fma_f32 v[60:61], v[28:29], v[28:29], s[52:53]
    v_pk_fma_f32 v[62:63], v[30:31], v[30:31], s[52:53]
    v_pk_mul_f32 v[48:49], v[48:49], v[16:17] neg_lo:[1,0] neg_hi:[1,0]
    v_pk_mul_f32 v[50:51], v[50:51], v[18:19] neg_lo:[1,0] neg_hi:[1,0]
    v_pk_mul_f32 v[52:53], v[52:53], v[20:21] neg_lo:[1,0] neg_hi:[1,0]
    v_pk_mul_f32 v[54:55], v[54:55], v[22:23] neg_lo:[1,0] neg_hi:[1,0]
    v_pk_mul_f32 v[56:57], v[56:57], v[24:25] neg_lo:[1,0] neg_hi:[1,0]
    v_pk_mul_f32 v[58:59], v[58:59], v[26:27] neg_lo:[1,0] neg_hi:[1,0]
    v_pk_mul_f32 v[60:61], v[60:61], v[28:29] neg_lo:[1,0] neg_hi:[1,0]
    v_pk_mul_f32 v[62:63], v[62:63], v[30:31] neg_lo:[1,0] neg_hi:[1,0]
    v_mfma_f32_32x32x16_bf16 v[32:47], a[0:3], v[72:75], 0
    ds_read_b128 a[20:23], v3 offset:1024
    ds_read_b128 a[0:3], v3 offset:2048
    v_exp_f32 v48, v48
    v_exp_f32 v49, v49
    v_mfma_f32_32x32x16_bf16 v[32:47], a[4:7], v[76:79], v[32:47]
    v_exp_f32 v50, v50
    v_exp_f32 v51, v51
    v_exp_f32 v52, v52
    v_mfma_f32_32x32x16_bf16 v[32:47], a[8:11], v[80:83], v[32:47]
    s_waitcnt lgkmcnt(3)
    ds_read_b128 a[4:7], v3 offset:3072
    ds_read_b128 a[8:11], v3 offset:4096
    v_exp_f32 v53, v53
    v_exp_f32 v54, v54
    v_mfma_f32_32x32x16_bf16 v[32:47], a[12:15], v[84:87], v[32:47]
    s_waitcnt lgkmcnt(4)
    v_exp_f32 v55, v55
    v_exp_f32 v56, v56
    v_exp_f32 v57, v57
    v_mfma_f32_32x32x16_bf16 v[32:47], a[16:19], v[88:91], v[32:47]
    s_waitcnt lgkmcnt(3)
    ds_read_b128 a[12:15], v3 offset:5120
    ds_read_b128 a[16:19], v3 offset:6144
    v_exp_f32 v58, v58
    v_exp_f32 v59, v59
    v_mfma_f32_32x32x16_bf16 v[32:47], a[20:23], v[92:95], v[32:47]
    s_waitcnt lgkmcnt(4)
    v_cvt_pk_bf16_f32 v64, v144, v145
    v_cvt_pk_bf16_f32 v65, v146, v147
    v_cvt_pk_bf16_f32 v66, v148, v149
    v_cvt_pk_bf16_f32 v67, v150, v151
    v_exp_f32 v60, v60
    v_exp_f32 v61, v61
    v_exp_f32 v62, v62
    v_exp_f32 v63, v63
    v_pk_add_f32 v[48:49], v[48:49], 1.0 op_sel_hi:[1,0]
    v_pk_add_f32 v[50:51], v[50:51], 1.0 op_sel_hi:[1,0]
    v_pk_add_f32 v[52:53], v[52:53], 1.0 op_sel_hi:[1,0]
    v_pk_add_f32 v[54:55], v[54:55], 1.0 op_sel_hi:[1,0]
    v_pk_add_f32 v[56:57], v[56:57], 1.0 op_sel_hi:[1,0]
    v_pk_add_f32 v[58:59], v[58:59], 1.0 op_sel_hi:[1,0]
    v_pk_add_f32 v[60:61], v[60:61], 1.0 op_sel_hi:[1,0]
    v_pk_add_f32 v[62:63], v[62:63], 1.0 op_sel_hi:[1,0]
    v_mfma_f32_32x32x16_bf16 v[160:175], a[224:227], v[64:67], v[160:175]
    ds_read_b128 v[104:107], v5 offset:64
    v_cvt_pk_bf16_f32 v68, v152, v153
    v_cvt_pk_bf16_f32 v69, v154, v155
    v_cvt_pk_bf16_f32 v70, v156, v157
    v_cvt_pk_bf16_f32 v71, v158, v159
    v_rcp_f32 v48, v48
    v_mfma_f32_32x32x16_bf16 v[176:191], a[228:231], v[64:67], v[176:191]
    ds_read_b128 v[108:111], v5 offset:80
    v_rcp_f32 v49, v49
    v_rcp_f32 v50, v50
    v_mfma_f32_32x32x16_bf16 v[192:207], a[232:235], v[64:67], v[192:207]
    ds_read_b128 v[96:99], v5 offset:0
    v_rcp_f32 v51, v51
    v_rcp_f32 v52, v52
    v_rcp_f32 v53, v53
    v_mfma_f32_32x32x16_bf16 v[160:175], a[236:239], v[68:71], v[160:175]
    ds_read_b128 v[100:103], v5 offset:16
    v_rcp_f32 v54, v54
    v_rcp_f32 v55, v55
    v_mfma_f32_32x32x16_bf16 v[176:191], a[240:243], v[68:71], v[176:191]
    v_rcp_f32 v56, v56
    v_rcp_f32 v57, v57
    v_rcp_f32 v58, v58
    v_mfma_f32_32x32x16_bf16 v[192:207], a[244:247], v[68:71], v[192:207]
    v_rcp_f32 v59, v59
    v_rcp_f32 v60, v60
    v_rcp_f32 v61, v61
    v_rcp_f32 v62, v62
    v_rcp_f32 v63, v63
    v_pk_mul_f32 v[16:17], v[16:17], v[48:49]
    v_pk_mul_f32 v[18:19], v[18:19], v[50:51]
    v_pk_mul_f32 v[20:21], v[20:21], v[52:53]
    v_pk_mul_f32 v[22:23], v[22:23], v[54:55]
    v_pk_mul_f32 v[24:25], v[24:25], v[56:57]
    v_pk_mul_f32 v[26:27], v[26:27], v[58:59]
    v_pk_mul_f32 v[28:29], v[28:29], v[60:61]
    v_pk_mul_f32 v[30:31], v[30:31], v[62:63]
    v_pk_fma_f32 v[48:49], v[32:33], v[32:33], s[52:53]
    v_pk_fma_f32 v[50:51], v[34:35], v[34:35], s[52:53]
    v_pk_fma_f32 v[52:53], v[36:37], v[36:37], s[52:53]
    v_pk_fma_f32 v[54:55], v[38:39], v[38:39], s[52:53]
    v_pk_fma_f32 v[56:57], v[40:41], v[40:41], s[52:53]
    v_pk_fma_f32 v[58:59], v[42:43], v[42:43], s[52:53]
    v_pk_fma_f32 v[60:61], v[44:45], v[44:45], s[52:53]
    v_pk_fma_f32 v[62:63], v[46:47], v[46:47], s[52:53]
    v_pk_mul_f32 v[48:49], v[48:49], v[32:33] neg_lo:[1,0] neg_hi:[1,0]
    v_pk_mul_f32 v[50:51], v[50:51], v[34:35] neg_lo:[1,0] neg_hi:[1,0]
    v_pk_mul_f32 v[52:53], v[52:53], v[36:37] neg_lo:[1,0] neg_hi:[1,0]
    v_pk_mul_f32 v[54:55], v[54:55], v[38:39] neg_lo:[1,0] neg_hi:[1,0]
    v_pk_mul_f32 v[56:57], v[56:57], v[40:41] neg_lo:[1,0] neg_hi:[1,0]
    v_pk_mul_f32 v[58:59], v[58:59], v[42:43] neg_lo:[1,0] neg_hi:[1,0]
    v_pk_mul_f32 v[60:61], v[60:61], v[44:45] neg_lo:[1,0] neg_hi:[1,0]
    v_pk_mul_f32 v[62:63], v[62:63], v[46:47] neg_lo:[1,0] neg_hi:[1,0]
    v_mfma_f32_32x32x16_bf16 v[144:159], a[0:3], v[72:75], 0
    s_waitcnt lgkmcnt(7)
    ds_read_b128 a[20:23], v3 offset:7168
    ds_read_b128 a[0:3], v4 offset:16384
    v_cvt_pk_bf16_f32 v64, v16, v17
    v_cvt_pk_bf16_f32 v65, v18, v19
    v_cvt_pk_bf16_f32 v66, v20, v21
    v_cvt_pk_bf16_f32 v67, v22, v23
    v_mfma_f32_32x32x16_bf16 v[144:159], a[4:7], v[76:79], v[144:159]
    s_waitcnt lgkmcnt(8)
    ds_read_b128 v[120:123], v5 offset:192
    ds_read_b128 v[124:127], v5 offset:208
    v_cvt_pk_bf16_f32 v68, v24, v25
    v_cvt_pk_bf16_f32 v69, v26, v27
    v_cvt_pk_bf16_f32 v70, v28, v29
    v_cvt_pk_bf16_f32 v71, v30, v31
    v_mfma_f32_32x32x16_bf16 v[144:159], a[8:11], v[80:83], v[144:159]
    s_waitcnt lgkmcnt(9)
    ds_read_b128 a[4:7], v4 offset:17408
    ds_read_b128 a[8:11], v4 offset:18432
    v_exp_f32 v48, v48
    v_exp_f32 v49, v49
    v_mfma_f32_32x32x16_bf16 v[144:159], a[12:15], v[84:87], v[144:159]
    s_waitcnt lgkmcnt(10)
    ds_read_b128 v[112:115], v5 offset:128
    ds_read_b128 v[116:119], v5 offset:144
    v_exp_f32 v50, v50
    v_exp_f32 v51, v51
    v_mfma_f32_32x32x16_bf16 v[144:159], a[16:19], v[88:91], v[144:159]
    s_waitcnt lgkmcnt(7)
    ds_read_b128 a[12:15], v4 offset:19456
    ds_read_b128 a[16:19], v3 offset:63488
    v_exp_f32 v52, v52
    v_exp_f32 v53, v53
    v_mfma_f32_32x32x16_bf16 v[144:159], a[20:23], v[92:95], v[144:159]
    s_waitcnt lgkmcnt(8)
    s_waitcnt vmcnt(7)
    s_waitcnt vmcnt(3)
    v_exp_f32 v54, v54
    v_exp_f32 v55, v55
    v_exp_f32 v56, v56
    v_mfma_f32_32x32x16_bf16 v[16:31], a[0:3], v[208:211], 0
    s_waitcnt lgkmcnt(5)
    ds_read_b128 a[20:23], v3 offset:64512
    ds_read_b128 a[0:3], v4 offset:0
    v_exp_f32 v57, v57
    v_exp_f32 v58, v58
    v_mfma_f32_32x32x16_bf16 v[16:31], a[4:7], v[212:215], v[16:31]
    s_waitcnt lgkmcnt(6)
    v_exp_f32 v59, v59
    v_exp_f32 v60, v60
    v_exp_f32 v61, v61
    v_exp_f32 v62, v62
    v_exp_f32 v63, v63
    v_pk_add_f32 v[48:49], v[48:49], 1.0 op_sel_hi:[1,0]
    v_pk_add_f32 v[50:51], v[50:51], 1.0 op_sel_hi:[1,0]
    v_pk_add_f32 v[52:53], v[52:53], 1.0 op_sel_hi:[1,0]
    v_pk_add_f32 v[54:55], v[54:55], 1.0 op_sel_hi:[1,0]
    v_pk_add_f32 v[56:57], v[56:57], 1.0 op_sel_hi:[1,0]
    v_pk_add_f32 v[58:59], v[58:59], 1.0 op_sel_hi:[1,0]
    v_pk_add_f32 v[60:61], v[60:61], 1.0 op_sel_hi:[1,0]
    v_pk_add_f32 v[62:63], v[62:63], 1.0 op_sel_hi:[1,0]
    v_pk_fma_f32 v[16:17], v[16:17], v[12:13], v[12:13] op_sel:[0,0,1] op_sel_hi:[1,0,1]
    v_pk_fma_f32 v[18:19], v[18:19], v[12:13], v[12:13] op_sel:[0,0,1] op_sel_hi:[1,0,1]
    v_pk_fma_f32 v[20:21], v[20:21], v[12:13], v[12:13] op_sel:[0,0,1] op_sel_hi:[1,0,1]
    v_pk_fma_f32 v[22:23], v[22:23], v[12:13], v[12:13] op_sel:[0,0,1] op_sel_hi:[1,0,1]
    v_pk_fma_f32 v[24:25], v[24:25], v[12:13], v[12:13] op_sel:[0,0,1] op_sel_hi:[1,0,1]
    v_pk_fma_f32 v[26:27], v[26:27], v[12:13], v[12:13] op_sel:[0,0,1] op_sel_hi:[1,0,1]
    v_pk_fma_f32 v[28:29], v[28:29], v[12:13], v[12:13] op_sel:[0,0,1] op_sel_hi:[1,0,1]
    v_pk_fma_f32 v[30:31], v[30:31], v[12:13], v[12:13] op_sel:[0,0,1] op_sel_hi:[1,0,1]
    v_cvt_pk_bf16_f32 v72, v16, v17
    v_cvt_pk_bf16_f32 v73, v18, v19
    v_cvt_pk_bf16_f32 v74, v20, v21
    v_cvt_pk_bf16_f32 v75, v22, v23
    v_cvt_pk_bf16_f32 v76, v24, v25
    v_cvt_pk_bf16_f32 v77, v26, v27
    v_cvt_pk_bf16_f32 v78, v28, v29
    v_cvt_pk_bf16_f32 v79, v30, v31
    v_mfma_f32_32x32x16_bf16 v[16:31], a[8:11], v[216:219], 0
    s_waitcnt lgkmcnt(3)
    ds_read_b128 a[4:7], v4 offset:20480
    ds_read_b128 a[8:11], v4 offset:21504
    v_rcp_f32 v48, v48
    v_rcp_f32 v49, v49
    v_mfma_f32_32x32x16_bf16 v[16:31], a[12:15], v[220:223], v[16:31]
    s_waitcnt lgkmcnt(4)
    ds_read_b128 v[136:139], v5 offset:320
    ds_read_b128 v[140:143], v5 offset:336
    v_rcp_f32 v50, v50
    v_rcp_f32 v51, v51
    v_mfma_f32_32x32x16_bf16 v[160:175], a[16:19], v[64:67], v[160:175]
    s_waitcnt lgkmcnt(5)
    ds_read_b128 a[12:15], v4 offset:1024
    ds_read_b128 a[16:19], v4 offset:2048
    v_rcp_f32 v52, v52
    v_rcp_f32 v53, v53
    v_mfma_f32_32x32x16_bf16 v[176:191], a[20:23], v[64:67], v[176:191]
    s_waitcnt lgkmcnt(6)
    ds_read_b128 v[128:131], v5 offset:256
    ds_read_b128 v[132:135], v5 offset:272
    v_rcp_f32 v54, v54
    v_rcp_f32_e64 v55, v55
    v_mfma_f32_32x32x16_bf16 v[192:207], a[0:3], v[64:67], v[192:207]
    s_waitcnt lgkmcnt(7)
    ds_read_b128 a[20:23], v4 offset:3072
    v_pk_fma_f32 v[16:17], v[16:17], v[12:13], v[12:13] op_sel:[0,0,1] op_sel_hi:[1,0,1]
    v_pk_fma_f32 v[18:19], v[18:19], v[12:13], v[12:13] op_sel:[0,0,1] op_sel_hi:[1,0,1]
    v_pk_fma_f32 v[20:21], v[20:21], v[12:13], v[12:13] op_sel:[0,0,1] op_sel_hi:[1,0,1]
    v_pk_fma_f32 v[22:23], v[22:23], v[12:13], v[12:13] op_sel:[0,0,1] op_sel_hi:[1,0,1]
    v_pk_fma_f32 v[24:25], v[24:25], v[12:13], v[12:13] op_sel:[0,0,1] op_sel_hi:[1,0,1]
    v_pk_fma_f32 v[26:27], v[26:27], v[12:13], v[12:13] op_sel:[0,0,1] op_sel_hi:[1,0,1]
    v_pk_fma_f32 v[28:29], v[28:29], v[12:13], v[12:13] op_sel:[0,0,1] op_sel_hi:[1,0,1]
    v_pk_fma_f32 v[30:31], v[30:31], v[12:13], v[12:13] op_sel:[0,0,1] op_sel_hi:[1,0,1]
    v_cvt_pk_bf16_f32 v80, v16, v17
    v_cvt_pk_bf16_f32 v81, v18, v19
    v_cvt_pk_bf16_f32 v82, v20, v21
    v_cvt_pk_bf16_f32 v83, v22, v23
    v_cvt_pk_bf16_f32 v84, v24, v25
    v_cvt_pk_bf16_f32 v85, v26, v27
    v_cvt_pk_bf16_f32 v86, v28, v29
    v_cvt_pk_bf16_f32 v87, v30, v31
L_pf19:
    v_mfma_f32_32x32x16_bf16 v[16:31], a[4:7], v[224:227], 0
    s_waitcnt lgkmcnt(7)
    ds_read_b128 a[0:3], v2 offset:0
    ds_read_b128 a[4:7], v2 offset:1024
    v_rcp_f32 v56, v56
    v_rcp_f32 v57, v57
    v_mfma_f32_32x32x16_bf16 v[16:31], a[8:11], v[228:231], v[16:31]
    s_waitcnt lgkmcnt(6)
    s_mov_b32 s63, L_pf19-L_pc+12288
    buffer_load_dword v6, v7, s[68:71], s63 offen
    v_rcp_f32 v58, v58
    v_rcp_f32 v59, v59
    v_mfma_f32_32x32x16_bf16 v[160:175], a[12:15], v[68:71], v[160:175]
    s_waitcnt lgkmcnt(5)
    ds_read_b128 a[8:11], v2 offset:2048
    ds_read_b128 a[12:15], v2 offset:3072
    v_rcp_f32 v60, v60
    v_rcp_f32 v61, v61
    v_mfma_f32_32x32x16_bf16 v[176:191], a[16:19], v[68:71], v[176:191]
    s_waitcnt lgkmcnt(4)
    v_rcp_f32 v62, v62
    v_rcp_f32_e64 v63, v63
    v_mfma_f32_32x32x16_bf16 v[192:207], a[20:23], v[68:71], v[192:207]
    s_waitcnt lgkmcnt(3)
    ds_read_b128 a[16:19], v2 offset:4096
    v_pk_mul_f32 v[32:33], v[32:33], v[48:49]
    v_pk_mul_f32 v[34:35], v[34:35], v[50:51]
    v_pk_mul_f32 v[36:37], v[36:37], v[52:53]
    v_pk_mul_f32 v[38:39], v[38:39], v[54:55]
    v_pk_mul_f32 v[40:41], v[40:41], v[56:57]
    v_pk_mul_f32 v[42:43], v[42:43], v[58:59]
    v_pk_mul_f32 v[44:45], v[44:45], v[60:61]
    v_pk_mul_f32 v[46:47], v[46:47], v[62:63]
    v_pk_fma_f32 v[16:17], v[16:17], v[12:13], v[12:13] op_sel:[0,0,1] op_sel_hi:[1,0,1]
    v_pk_fma_f32 v[18:19], v[18:19], v[12:13], v[12:13] op_sel:[0,0,1] op_sel_hi:[1,0,1]
    v_pk_fma_f32 v[20:21], v[20:21], v[12:13], v[12:13] op_sel:[0,0,1] op_sel_hi:[1,0,1]
    v_pk_fma_f32 v[22:23], v[22:23], v[12:13], v[12:13] op_sel:[0,0,1] op_sel_hi:[1,0,1]
    v_pk_fma_f32 v[24:25], v[24:25], v[12:13], v[12:13] op_sel:[0,0,1] op_sel_hi:[1,0,1]
    v_pk_fma_f32 v[26:27], v[26:27], v[12:13], v[12:13] op_sel:[0,0,1] op_sel_hi:[1,0,1]
    v_pk_fma_f32 v[28:29], v[28:29], v[12:13], v[12:13] op_sel:[0,0,1] op_sel_hi:[1,0,1]
    v_pk_fma_f32 v[30:31], v[30:31], v[12:13], v[12:13] op_sel:[0,0,1] op_sel_hi:[1,0,1]
    v_cvt_pk_bf16_f32 v88, v16, v17
    v_cvt_pk_bf16_f32 v89, v18, v19
    v_cvt_pk_bf16_f32 v90, v20, v21
    v_cvt_pk_bf16_f32 v91, v22, v23
    v_cvt_pk_bf16_f32 v92, v24, v25
    v_cvt_pk_bf16_f32 v93, v26, v27
    v_cvt_pk_bf16_f32 v94, v28, v29
    v_cvt_pk_bf16_f32 v95, v30, v31
    v_pk_fma_f32 v[48:49], v[144:145], v[144:145], s[52:53]
    v_pk_fma_f32 v[50:51], v[146:147], v[146:147], s[52:53]
    v_pk_fma_f32 v[52:53], v[148:149], v[148:149], s[52:53]
    v_pk_fma_f32 v[54:55], v[150:151], v[150:151], s[52:53]
    v_pk_fma_f32 v[56:57], v[152:153], v[152:153], s[52:53]
    v_pk_fma_f32 v[58:59], v[154:155], v[154:155], s[52:53]
    v_pk_fma_f32 v[60:61], v[156:157], v[156:157], s[52:53]
    v_pk_fma_f32 v[62:63], v[158:159], v[158:159], s[52:53]
    v_pk_mul_f32 v[48:49], v[48:49], v[144:145] neg_lo:[1,0] neg_hi:[1,0]
    v_pk_mul_f32 v[50:51], v[50:51], v[146:147] neg_lo:[1,0] neg_hi:[1,0]
    v_pk_mul_f32 v[52:53], v[52:53], v[148:149] neg_lo:[1,0] neg_hi:[1,0]
    v_pk_mul_f32 v[54:55], v[54:55], v[150:151] neg_lo:[1,0] neg_hi:[1,0]
    v_pk_mul_f32 v[56:57], v[56:57], v[152:153] neg_lo:[1,0] neg_hi:[1,0]
    v_pk_mul_f32 v[58:59], v[58:59], v[154:155] neg_lo:[1,0] neg_hi:[1,0]
    v_pk_mul_f32 v[60:61], v[60:61], v[156:157] neg_lo:[1,0] neg_hi:[1,0]
    v_pk_mul_f32 v[62:63], v[62:63], v[158:159] neg_lo:[1,0] neg_hi:[1,0]
    v_mfma_f32_32x32x16_bf16 v[16:31], a[0:3], v[72:75], 0
    s_waitcnt lgkmcnt(3)
    ds_read_b128 a[20:23], v2 offset:5120
    ds_read_b128 a[0:3], v4 offset:4096
    v_exp_f32 v48, v48
    v_exp_f32 v49, v49
    v_mfma_f32_32x32x16_bf16 v[16:31], a[4:7], v[76:79], v[16:31]
    s_waitcnt lgkmcnt(4)
    v_exp_f32 v50, v50
    v_exp_f32 v51, v51
    v_exp_f32 v52, v52
    v_mfma_f32_32x32x16_bf16 v[16:31], a[8:11], v[80:83], v[16:31]
    s_waitcnt lgkmcnt(3)
    ds_read_b128 a[4:7], v4 offset:5120
    ds_read_b128 a[8:11], v4 offset:6144
    v_exp_f32 v53, v53
    v_exp_f32 v54, v54
    v_mfma_f32_32x32x16_bf16 v[16:31], a[12:15], v[84:87], v[16:31]
    s_waitcnt lgkmcnt(4)
    v_exp_f32 v55, v55
    v_exp_f32 v56, v56
    v_exp_f32 v57, v57
    v_mfma_f32_32x32x16_bf16 v[16:31], a[16:19], v[88:91], v[16:31]
    s_waitcnt lgkmcnt(3)
    ds_read_b128 a[12:15], v4 offset:7168
    ds_read_b128 a[16:19], v4 offset:8192
    v_exp_f32 v58, v58
    v_exp_f32 v59, v59
    v_mfma_f32_32x32x16_bf16 v[16:31], a[20:23], v[92:95], v[16:31]
    s_waitcnt lgkmcnt(4)
    v_cvt_pk_bf16_f32 v64, v32, v33
    v_cvt_pk_bf16_f32 v65, v34, v35
    v_cvt_pk_bf16_f32 v66, v36, v37
    v_cvt_pk_bf16_f32 v67, v38, v39
    v_cvt_pk_bf16_f32 v68, v40, v41
    v_cvt_pk_bf16_f32 v69, v42, v43
    v_cvt_pk_bf16_f32 v70, v44, v45
    v_cvt_pk_bf16_f32 v71, v46, v47
    v_exp_f32 v60, v60
    v_exp_f32 v61, v61
    v_exp_f32 v62, v62
    v_exp_f32 v63, v63
    v_pk_add_f32 v[48:49], v[48:49], 1.0 op_sel_hi:[1,0]
    v_pk_add_f32 v[50:51], v[50:51], 1.0 op_sel_hi:[1,0]
    v_pk_add_f32 v[52:53], v[52:53], 1.0 op_sel_hi:[1,0]
    v_pk_add_f32 v[54:55], v[54:55], 1.0 op_sel_hi:[1,0]
    v_pk_add_f32 v[56:57], v[56:57], 1.0 op_sel_hi:[1,0]
    v_pk_add_f32 v[58:59], v[58:59], 1.0 op_sel_hi:[1,0]
    v_pk_add_f32 v[60:61], v[60:61], 1.0 op_sel_hi:[1,0]
    v_pk_add_f32 v[62:63], v[62:63], 1.0 op_sel_hi:[1,0]
    v_mfma_f32_32x32x16_bf16 v[160:175], a[0:3], v[64:67], v[160:175]
    s_waitcnt lgkmcnt(3)
    ds_read_b128 a[20:23], v4 offset:9216
    ds_read_b128 a[0:3], v2 offset:6144
    v_rcp_f32 v48, v48
    v_rcp_f32 v49, v49
    v_mfma_f32_32x32x16_bf16 v[176:191], a[4:7], v[64:67], v[176:191]
    s_waitcnt lgkmcnt(4)
    v_rcp_f32 v50, v50
    v_rcp_f32 v51, v51
    v_rcp_f32 v52, v52
    v_mfma_f32_32x32x16_bf16 v[192:207], a[8:11], v[64:67], v[192:207]
    s_waitcnt lgkmcnt(3)
    ds_read_b128 a[4:7], v2 offset:7168
    ds_read_b128 a[8:11], v2 offset:8192
    v_rcp_f32 v53, v53
    v_rcp_f32 v54, v54
    v_mfma_f32_32x32x16_bf16 v[160:175], a[12:15], v[68:71], v[160:175]
    s_waitcnt lgkmcnt(4)
    v_rcp_f32 v55, v55
    v_rcp_f32 v56, v56
    v_rcp_f32 v57, v57
    v_mfma_f32_32x32x16_bf16 v[176:191], a[16:19], v[68:71], v[176:191]
    s_waitcnt lgkmcnt(3)
    ds_read_b128 a[12:15], v2 offset:9216
    ds_read_b128 a[16:19], v2 offset:10240
    v_rcp_f32 v58, v58
    v_rcp_f32 v59, v59
    v_mfma_f32_32x32x16_bf16 v[192:207], a[20:23], v[68:71], v[192:207]
    s_waitcnt lgkmcnt(4)
    v_rcp_f32 v60, v60
    v_rcp_f32 v61, v61
    v_rcp_f32 v62, v62
    v_rcp_f32 v63, v63
    v_pk_mul_f32 v[144:145], v[144:145], v[48:49]
    v_pk_mul_f32 v[146:147], v[146:147], v[50:51]
    v_pk_mul_f32 v[148:149], v[148:149], v[52:53]
    v_pk_mul_f32 v[150:151], v[150:151], v[54:55]
    v_pk_mul_f32 v[152:153], v[152:153], v[56:57]
    v_pk_mul_f32 v[154:155], v[154:155], v[58:59]
    v_pk_mul_f32 v[156:157], v[156:157], v[60:61]
    v_pk_mul_f32 v[158:159], v[158:159], v[62:63]
    v_pk_fma_f32 v[48:49], v[16:17], v[16:17], s[52:53]
    v_pk_fma_f32 v[50:51], v[18:19], v[18:19], s[52:53]
    v_pk_fma_f32 v[52:53], v[20:21], v[20:21], s[52:53]
    v_pk_fma_f32 v[54:55], v[22:23], v[22:23], s[52:53]
    v_pk_fma_f32 v[56:57], v[24:25], v[24:25], s[52:53]
    v_pk_fma_f32 v[58:59], v[26:27], v[26:27], s[52:53]
    v_pk_fma_f32 v[60:61], v[28:29], v[28:29], s[52:53]
    v_pk_fma_f32 v[62:63], v[30:31], v[30:31], s[52:53]
    v_pk_mul_f32 v[48:49], v[48:49], v[16:17] neg_lo:[1,0] neg_hi:[1,0]
    v_pk_mul_f32 v[50:51], v[50:51], v[18:19] neg_lo:[1,0] neg_hi:[1,0]
    v_pk_mul_f32 v[52:53], v[52:53], v[20:21] neg_lo:[1,0] neg_hi:[1,0]
    v_pk_mul_f32 v[54:55], v[54:55], v[22:23] neg_lo:[1,0] neg_hi:[1,0]
    v_pk_mul_f32 v[56:57], v[56:57], v[24:25] neg_lo:[1,0] neg_hi:[1,0]
    v_pk_mul_f32 v[58:59], v[58:59], v[26:27] neg_lo:[1,0] neg_hi:[1,0]
    v_pk_mul_f32 v[60:61], v[60:61], v[28:29] neg_lo:[1,0] neg_hi:[1,0]
    v_pk_mul_f32 v[62:63], v[62:63], v[30:31] neg_lo:[1,0] neg_hi:[1,0]
    v_mfma_f32_32x32x16_bf16 v[32:47], a[0:3], v[72:75], 0
    s_waitcnt lgkmcnt(3)
    ds_read_b128 a[20:23], v2 offset:11264
    ds_read_b128 a[0:3], v4 offset:10240
    v_exp_f32 v48, v48
    v_exp_f32 v49, v49
    v_mfma_f32_32x32x16_bf16 v[32:47], a[4:7], v[76:79], v[32:47]
    s_waitcnt lgkmcnt(4)
    v_exp_f32 v50, v50
    v_exp_f32 v51, v51
    v_exp_f32 v52, v52
    v_mfma_f32_32x32x16_bf16 v[32:47], a[8:11], v[80:83], v[32:47]
    s_waitcnt lgkmcnt(3)
    ds_read_b128 a[4:7], v4 offset:11264
    ds_read_b128 a[8:11], v4 offset:12288
    v_exp_f32 v53, v53
    v_exp_f32 v54, v54
    v_mfma_f32_32x32x16_bf16 v[32:47], a[12:15], v[84:87], v[32:47]
    s_waitcnt lgkmcnt(4)
    v_exp_f32 v55, v55
    v_exp_f32 v56, v56
    v_exp_f32 v57, v57
    v_mfma_f32_32x32x16_bf16 v[32:47], a[16:19], v[88:91], v[32:47]
    s_waitcnt lgkmcnt(3)
    ds_read_b128 a[12:15], v4 offset:13312
    ds_read_b128 a[16:19], v4 offset:14336
    v_exp_f32 v58, v58
    v_exp_f32 v59, v59
    v_mfma_f32_32x32x16_bf16 v[32:47], a[20:23], v[92:95], v[32:47]
    s_waitcnt lgkmcnt(4)
    v_cvt_pk_bf16_f32 v64, v144, v145
    v_cvt_pk_bf16_f32 v65, v146, v147
    v_cvt_pk_bf16_f32 v66, v148, v149
    v_cvt_pk_bf16_f32 v67, v150, v151
    v_cvt_pk_bf16_f32 v68, v152, v153
    v_cvt_pk_bf16_f32 v69, v154, v155
    v_cvt_pk_bf16_f32 v70, v156, v157
    v_cvt_pk_bf16_f32 v71, v158, v159
    v_exp_f32 v60, v60
    v_exp_f32 v61, v61
    v_exp_f32 v62, v62
    v_exp_f32 v63, v63
    v_pk_add_f32 v[48:49], v[48:49], 1.0 op_sel_hi:[1,0]
    v_pk_add_f32 v[50:51], v[50:51], 1.0 op_sel_hi:[1,0]
    v_pk_add_f32 v[52:53], v[52:53], 1.0 op_sel_hi:[1,0]
    v_pk_add_f32 v[54:55], v[54:55], 1.0 op_sel_hi:[1,0]
    v_pk_add_f32 v[56:57], v[56:57], 1.0 op_sel_hi:[1,0]
    v_pk_add_f32 v[58:59], v[58:59], 1.0 op_sel_hi:[1,0]
    v_pk_add_f32 v[60:61], v[60:61], 1.0 op_sel_hi:[1,0]
    v_pk_add_f32 v[62:63], v[62:63], 1.0 op_sel_hi:[1,0]
    v_mfma_f32_32x32x16_bf16 v[160:175], a[0:3], v[64:67], v[160:175]
    s_waitcnt lgkmcnt(3)
    ds_read_b128 a[20:23], v4 offset:15360
    ds_read_b128 a[0:3], v2 offset:12288
    v_rcp_f32 v48, v48
    v_rcp_f32 v49, v49
    v_mfma_f32_32x32x16_bf16 v[176:191], a[4:7], v[64:67], v[176:191]
    s_waitcnt lgkmcnt(4)
    v_rcp_f32 v50, v50
    v_rcp_f32 v51, v51
    v_rcp_f32 v52, v52
    v_mfma_f32_32x32x16_bf16 v[192:207], a[8:11], v[64:67], v[192:207]
    s_waitcnt lgkmcnt(3)
    ds_read_b128 a[4:7], v2 offset:13312
    ds_read_b128 a[8:11], v2 offset:14336
    v_rcp_f32 v53, v53
    v_rcp_f32 v54, v54
    v_mfma_f32_32x32x16_bf16 v[160:175], a[12:15], v[68:71], v[160:175]
    s_waitcnt lgkmcnt(4)
    v_rcp_f32 v55, v55
    v_rcp_f32 v56, v56
    v_rcp_f32 v57, v57
    v_mfma_f32_32x32x16_bf16 v[176:191], a[16:19], v[68:71], v[176:191]
    s_waitcnt lgkmcnt(3)
    ds_read_b128 a[12:15], v2 offset:15360
    ds_read_b128 a[16:19], v2 offset:16384
    v_rcp_f32 v58, v58
    v_rcp_f32 v59, v59
    v_mfma_f32_32x32x16_bf16 v[192:207], a[20:23], v[68:71], v[192:207]
    s_waitcnt lgkmcnt(4)
    v_rcp_f32 v60, v60
    v_rcp_f32 v61, v61
    v_rcp_f32 v62, v62
    v_rcp_f32 v63, v63
    v_pk_mul_f32 v[16:17], v[16:17], v[48:49]
    v_pk_mul_f32 v[18:19], v[18:19], v[50:51]
    v_pk_mul_f32 v[20:21], v[20:21], v[52:53]
    v_pk_mul_f32 v[22:23], v[22:23], v[54:55]
    v_pk_mul_f32 v[24:25], v[24:25], v[56:57]
    v_pk_mul_f32 v[26:27], v[26:27], v[58:59]
    v_pk_mul_f32 v[28:29], v[28:29], v[60:61]
    v_pk_mul_f32 v[30:31], v[30:31], v[62:63]
    v_pk_fma_f32 v[48:49], v[32:33], v[32:33], s[52:53]
    v_pk_fma_f32 v[50:51], v[34:35], v[34:35], s[52:53]
    v_pk_fma_f32 v[52:53], v[36:37], v[36:37], s[52:53]
    v_pk_fma_f32 v[54:55], v[38:39], v[38:39], s[52:53]
    v_pk_fma_f32 v[56:57], v[40:41], v[40:41], s[52:53]
    v_pk_fma_f32 v[58:59], v[42:43], v[42:43], s[52:53]
    v_pk_fma_f32 v[60:61], v[44:45], v[44:45], s[52:53]
    v_pk_fma_f32 v[62:63], v[46:47], v[46:47], s[52:53]
    v_pk_mul_f32 v[48:49], v[48:49], v[32:33] neg_lo:[1,0] neg_hi:[1,0]
    v_pk_mul_f32 v[50:51], v[50:51], v[34:35] neg_lo:[1,0] neg_hi:[1,0]
    v_pk_mul_f32 v[52:53], v[52:53], v[36:37] neg_lo:[1,0] neg_hi:[1,0]
    v_pk_mul_f32 v[54:55], v[54:55], v[38:39] neg_lo:[1,0] neg_hi:[1,0]
    v_pk_mul_f32 v[56:57], v[56:57], v[40:41] neg_lo:[1,0] neg_hi:[1,0]
    v_pk_mul_f32 v[58:59], v[58:59], v[42:43] neg_lo:[1,0] neg_hi:[1,0]
    v_pk_mul_f32 v[60:61], v[60:61], v[44:45] neg_lo:[1,0] neg_hi:[1,0]
    v_pk_mul_f32 v[62:63], v[62:63], v[46:47] neg_lo:[1,0] neg_hi:[1,0]
    v_mfma_f32_32x32x16_bf16 v[144:159], a[0:3], v[72:75], 0
    s_waitcnt lgkmcnt(3)
    ds_read_b128 a[20:23], v2 offset:17408
    ds_read_b128 a[0:3], v2 offset:18432
    v_exp_f32 v48, v48
    v_exp_f32 v49, v49
    v_mfma_f32_32x32x16_bf16 v[144:159], a[4:7], v[76:79], v[144:159]
    s_waitcnt lgkmcnt(4)
    v_exp_f32 v50, v50
    v_exp_f32 v51, v51
    v_exp_f32 v52, v52
    v_mfma_f32_32x32x16_bf16 v[144:159], a[8:11], v[80:83], v[144:159]
    s_waitcnt lgkmcnt(3)
    ds_read_b128 a[4:7], v2 offset:19456
    ds_read_b128 a[8:11], v2 offset:20480
    v_exp_f32 v53, v53
    v_exp_f32 v54, v54
    v_mfma_f32_32x32x16_bf16 v[144:159], a[12:15], v[84:87], v[144:159]
    s_waitcnt lgkmcnt(4)
    v_exp_f32 v55, v55
    v_exp_f32 v56, v56
    v_exp_f32 v57, v57
    v_mfma_f32_32x32x16_bf16 v[144:159], a[16:19], v[88:91], v[144:159]
    s_waitcnt lgkmcnt(3)
    ds_read_b128 a[12:15], v2 offset:21504
    ds_read_b128 a[16:19], v2 offset:22528
    v_exp_f32 v58, v58
    v_exp_f32 v59, v59
    v_mfma_f32_32x32x16_bf16 v[144:159], a[20:23], v[92:95], v[144:159]
    s_waitcnt lgkmcnt(4)
    v_cvt_pk_bf16_f32 v64, v16, v17
    v_cvt_pk_bf16_f32 v65, v18, v19
    v_cvt_pk_bf16_f32 v66, v20, v21
    v_cvt_pk_bf16_f32 v67, v22, v23
    v_cvt_pk_bf16_f32 v68, v24, v25
    v_cvt_pk_bf16_f32 v69, v26, v27
    v_cvt_pk_bf16_f32 v70, v28, v29
    v_cvt_pk_bf16_f32 v71, v30, v31
    v_exp_f32 v60, v60
    v_exp_f32 v61, v61
    v_exp_f32 v62, v62
    v_exp_f32 v63, v63
    v_pk_add_f32 v[48:49], v[48:49], 1.0 op_sel_hi:[1,0]
    v_pk_add_f32 v[50:51], v[50:51], 1.0 op_sel_hi:[1,0]
    v_pk_add_f32 v[52:53], v[52:53], 1.0 op_sel_hi:[1,0]
    v_pk_add_f32 v[54:55], v[54:55], 1.0 op_sel_hi:[1,0]
    v_pk_add_f32 v[56:57], v[56:57], 1.0 op_sel_hi:[1,0]
    v_pk_add_f32 v[58:59], v[58:59], 1.0 op_sel_hi:[1,0]
    v_pk_add_f32 v[60:61], v[60:61], 1.0 op_sel_hi:[1,0]
    v_pk_add_f32 v[62:63], v[62:63], 1.0 op_sel_hi:[1,0]
    v_mfma_f32_32x32x16_bf16 v[96:111], a[128:131], v[64:67], v[96:111]
    v_rcp_f32 v48, v48
    v_rcp_f32 v49, v49
    v_rcp_f32 v50, v50
    v_mfma_f32_32x32x16_bf16 v[112:127], a[132:135], v[64:67], v[112:127]
    v_rcp_f32 v51, v51
    v_rcp_f32 v52, v52
    v_rcp_f32 v53, v53
    v_mfma_f32_32x32x16_bf16 v[128:143], a[136:139], v[64:67], v[128:143]
    v_rcp_f32 v54, v54
    v_rcp_f32 v55, v55
    v_rcp_f32 v56, v56
    v_mfma_f32_32x32x16_bf16 v[96:111], a[140:143], v[68:71], v[96:111]
    v_rcp_f32 v57, v57
    v_rcp_f32 v58, v58
    v_rcp_f32 v59, v59
    v_mfma_f32_32x32x16_bf16 v[112:127], a[144:147], v[68:71], v[112:127]
    v_rcp_f32 v60, v60
    v_rcp_f32 v61, v61
    v_rcp_f32_e64 v62, v62
    v_mfma_f32_32x32x16_bf16 v[128:143], a[148:151], v[68:71], v[128:143]
    v_cvt_pk_bf16_f32 v160, v160, v161
    v_cvt_pk_bf16_f32 v161, v162, v163
    v_cvt_pk_bf16_f32 v162, v164, v165
    v_cvt_pk_bf16_f32 v163, v166, v167
    v_cvt_pk_bf16_f32 v164, v168, v169
    v_cvt_pk_bf16_f32 v165, v170, v171
    v_cvt_pk_bf16_f32 v166, v172, v173
    v_cvt_pk_bf16_f32 v167, v174, v175
    v_permlane16_swap_b32 v160, v164
    v_permlane16_swap_b32 v161, v165
    v_permlane16_swap_b32 v162, v166
    v_permlane16_swap_b32 v163, v167
    v_rcp_f32_e64 v63, v63
    v_pk_mul_f32 v[32:33], v[32:33], v[48:49]
    v_pk_mul_f32 v[34:35], v[34:35], v[50:51]
    v_pk_mul_f32 v[36:37], v[36:37], v[52:53]
    v_pk_mul_f32 v[38:39], v[38:39], v[54:55]
    v_pk_mul_f32 v[40:41], v[40:41], v[56:57]
    v_pk_mul_f32 v[42:43], v[42:43], v[58:59]
    v_pk_mul_f32 v[44:45], v[44:45], v[60:61]
    v_pk_mul_f32 v[46:47], v[46:47], v[62:63]
    v_pk_fma_f32 v[48:49], v[144:145], v[144:145], s[52:53]
    v_pk_fma_f32 v[50:51], v[146:147], v[146:147], s[52:53]
    v_pk_fma_f32 v[52:53], v[148:149], v[148:149], s[52:53]
    v_pk_fma_f32 v[54:55], v[150:151], v[150:151], s[52:53]
    v_pk_fma_f32 v[56:57], v[152:153], v[152:153], s[52:53]
    v_pk_fma_f32 v[58:59], v[154:155], v[154:155], s[52:53]
    v_pk_fma_f32 v[60:61], v[156:157], v[156:157], s[52:53]
    v_pk_fma_f32 v[62:63], v[158:159], v[158:159], s[52:53]
    v_pk_mul_f32 v[48:49], v[48:49], v[144:145] neg_lo:[1,0] neg_hi:[1,0]
    v_pk_mul_f32 v[50:51], v[50:51], v[146:147] neg_lo:[1,0] neg_hi:[1,0]
    v_pk_mul_f32 v[52:53], v[52:53], v[148:149] neg_lo:[1,0] neg_hi:[1,0]
    v_pk_mul_f32 v[54:55], v[54:55], v[150:151] neg_lo:[1,0] neg_hi:[1,0]
    v_pk_mul_f32 v[56:57], v[56:57], v[152:153] neg_lo:[1,0] neg_hi:[1,0]
    v_pk_mul_f32 v[58:59], v[58:59], v[154:155] neg_lo:[1,0] neg_hi:[1,0]
    v_pk_mul_f32 v[60:61], v[60:61], v[156:157] neg_lo:[1,0] neg_hi:[1,0]
    v_pk_mul_f32 v[62:63], v[62:63], v[158:159] neg_lo:[1,0] neg_hi:[1,0]
    v_mfma_f32_32x32x16_bf16 v[16:31], a[0:3], v[72:75], 0
    s_waitcnt lgkmcnt(3)
    ds_read_b128 a[20:23], v2 offset:23552
    ds_read_b128 a[0:3], v2 offset:24576
    v_exp_f32 v48, v48
    v_exp_f32 v49, v49
    v_mfma_f32_32x32x16_bf16 v[16:31], a[4:7], v[76:79], v[16:31]
    s_waitcnt lgkmcnt(4)
    v_exp_f32 v50, v50
    v_exp_f32 v51, v51
    v_exp_f32 v52, v52
    v_mfma_f32_32x32x16_bf16 v[16:31], a[8:11], v[80:83], v[16:31]
    s_waitcnt lgkmcnt(3)
    ds_read_b128 a[4:7], v2 offset:25600
    ds_read_b128 a[8:11], v2 offset:26624
    v_exp_f32 v53, v53
    v_exp_f32 v54, v54
    v_mfma_f32_32x32x16_bf16 v[16:31], a[12:15], v[84:87], v[16:31]
    s_waitcnt lgkmcnt(4)
    v_exp_f32 v55, v55
    v_exp_f32 v56, v56
    v_exp_f32 v57, v57
    v_mfma_f32_32x32x16_bf16 v[16:31], a[16:19], v[88:91], v[16:31]
    s_waitcnt lgkmcnt(3)
    ds_read_b128 a[12:15], v2 offset:27648
    ds_read_b128 a[16:19], v2 offset:28672
    v_exp_f32 v58, v58
    v_exp_f32 v59, v59
    v_mfma_f32_32x32x16_bf16 v[16:31], a[20:23], v[92:95], v[16:31]
    s_waitcnt lgkmcnt(4)
    v_cvt_pk_bf16_f32 v176, v176, v177
    v_cvt_pk_bf16_f32 v177, v178, v179
    v_cvt_pk_bf16_f32 v178, v180, v181
    v_cvt_pk_bf16_f32 v179, v182, v183
    v_cvt_pk_bf16_f32 v180, v184, v185
    v_cvt_pk_bf16_f32 v181, v186, v187
    v_cvt_pk_bf16_f32 v182, v188, v189
    v_cvt_pk_bf16_f32 v183, v190, v191
    v_permlane16_swap_b32 v176, v180
    v_permlane16_swap_b32 v177, v181
    v_permlane16_swap_b32 v178, v182
    v_permlane16_swap_b32 v179, v183
    v_cvt_pk_bf16_f32 v64, v32, v33
    v_cvt_pk_bf16_f32 v65, v34, v35
    v_cvt_pk_bf16_f32 v66, v36, v37
    v_cvt_pk_bf16_f32 v67, v38, v39
    v_cvt_pk_bf16_f32 v68, v40, v41
    v_cvt_pk_bf16_f32 v69, v42, v43
    v_cvt_pk_bf16_f32 v70, v44, v45
    v_cvt_pk_bf16_f32 v71, v46, v47
    v_exp_f32 v60, v60
    v_exp_f32 v61, v61
    v_exp_f32 v62, v62
    v_exp_f32 v63, v63
    v_pk_add_f32 v[48:49], v[48:49], 1.0 op_sel_hi:[1,0]
    v_pk_add_f32 v[50:51], v[50:51], 1.0 op_sel_hi:[1,0]
    v_pk_add_f32 v[52:53], v[52:53], 1.0 op_sel_hi:[1,0]
    v_pk_add_f32 v[54:55], v[54:55], 1.0 op_sel_hi:[1,0]
    v_pk_add_f32 v[56:57], v[56:57], 1.0 op_sel_hi:[1,0]
    v_pk_add_f32 v[58:59], v[58:59], 1.0 op_sel_hi:[1,0]
    v_pk_add_f32 v[60:61], v[60:61], 1.0 op_sel_hi:[1,0]
    v_pk_add_f32 v[62:63], v[62:63], 1.0 op_sel_hi:[1,0]
    v_mfma_f32_32x32x16_bf16 v[96:111], a[24:27], v[208:211], v[96:111]
    v_rcp_f32 v48, v48
    v_rcp_f32 v49, v49
    v_rcp_f32 v50, v50
    v_mfma_f32_32x32x16_bf16 v[96:111], a[28:31], v[212:215], v[96:111]
    v_rcp_f32 v51, v51
    v_rcp_f32 v52, v52
    v_rcp_f32 v53, v53
    v_mfma_f32_32x32x16_bf16 v[112:127], a[24:27], v[216:219], v[112:127]
    v_rcp_f32 v54, v54
    v_rcp_f32 v55, v55
    v_rcp_f32 v56, v56
    v_mfma_f32_32x32x16_bf16 v[96:111], a[152:155], v[64:67], v[96:111]
    v_rcp_f32 v57, v57
    v_rcp_f32 v58, v58
    v_rcp_f32 v59, v59
    v_mfma_f32_32x32x16_bf16 v[112:127], a[156:159], v[64:67], v[112:127]
    v_rcp_f32 v60, v60
    v_rcp_f32 v61, v61
    v_rcp_f32 v62, v62
    v_mfma_f32_32x32x16_bf16 v[128:143], a[160:163], v[64:67], v[128:143]
    v_rcp_f32 v63, v63
    v_cvt_pk_bf16_f32 v192, v192, v193
    v_cvt_pk_bf16_f32 v193, v194, v195
    v_cvt_pk_bf16_f32 v194, v196, v197
    v_cvt_pk_bf16_f32 v195, v198, v199
    v_mfma_f32_32x32x16_bf16 v[96:111], a[164:167], v[68:71], v[96:111]
    v_cvt_pk_bf16_f32 v196, v200, v201
    v_cvt_pk_bf16_f32 v197, v202, v203
    v_cvt_pk_bf16_f32 v198, v204, v205
    v_cvt_pk_bf16_f32 v199, v206, v207
    v_permlane16_swap_b32 v192, v196
    v_mfma_f32_32x32x16_bf16 v[112:127], a[168:171], v[68:71], v[112:127]
    v_permlane16_swap_b32 v193, v197
    v_permlane16_swap_b32 v194, v198
    v_permlane16_swap_b32 v195, v199
    v_mfma_f32_32x32x16_bf16 v[128:143], a[172:175], v[68:71], v[128:143]
    v_pk_mul_f32 v[144:145], v[144:145], v[48:49]
    v_pk_mul_f32 v[146:147], v[146:147], v[50:51]
    v_pk_mul_f32 v[148:149], v[148:149], v[52:53]
    v_pk_mul_f32 v[150:151], v[150:151], v[54:55]
    v_pk_mul_f32 v[152:153], v[152:153], v[56:57]
    v_pk_mul_f32 v[154:155], v[154:155], v[58:59]
    v_pk_mul_f32 v[156:157], v[156:157], v[60:61]
    v_pk_mul_f32 v[158:159], v[158:159], v[62:63]
    v_pk_fma_f32 v[48:49], v[16:17], v[16:17], s[52:53]
    v_pk_fma_f32 v[50:51], v[18:19], v[18:19], s[52:53]
    v_pk_fma_f32 v[52:53], v[20:21], v[20:21], s[52:53]
    v_pk_fma_f32 v[54:55], v[22:23], v[22:23], s[52:53]
    v_pk_fma_f32 v[56:57], v[24:25], v[24:25], s[52:53]
    v_pk_fma_f32 v[58:59], v[26:27], v[26:27], s[52:53]
    v_pk_fma_f32 v[60:61], v[28:29], v[28:29], s[52:53]
    v_pk_fma_f32 v[62:63], v[30:31], v[30:31], s[52:53]
    v_pk_mul_f32 v[48:49], v[48:49], v[16:17] neg_lo:[1,0] neg_hi:[1,0]
    v_pk_mul_f32 v[50:51], v[50:51], v[18:19] neg_lo:[1,0] neg_hi:[1,0]
    v_pk_mul_f32 v[52:53], v[52:53], v[20:21] neg_lo:[1,0] neg_hi:[1,0]
    v_pk_mul_f32 v[54:55], v[54:55], v[22:23] neg_lo:[1,0] neg_hi:[1,0]
    v_pk_mul_f32 v[56:57], v[56:57], v[24:25] neg_lo:[1,0] neg_hi:[1,0]
    v_pk_mul_f32 v[58:59], v[58:59], v[26:27] neg_lo:[1,0] neg_hi:[1,0]
    v_pk_mul_f32 v[60:61], v[60:61], v[28:29] neg_lo:[1,0] neg_hi:[1,0]
    v_pk_mul_f32 v[62:63], v[62:63], v[30:31] neg_lo:[1,0] neg_hi:[1,0]
    v_mfma_f32_32x32x16_bf16 v[32:47], a[0:3], v[72:75], 0
    s_waitcnt lgkmcnt(3)
    ds_read_b128 a[20:23], v2 offset:29696
    ds_read_b128 a[0:3], v2 offset:30720
    v_exp_f32 v48, v48
    v_exp_f32 v49, v49
    v_mfma_f32_32x32x16_bf16 v[32:47], a[4:7], v[76:79], v[32:47]
    s_waitcnt lgkmcnt(4)
    v_exp_f32 v50, v50
    v_exp_f32 v51, v51
    v_exp_f32 v52, v52
    v_mfma_f32_32x32x16_bf16 v[32:47], a[8:11], v[80:83], v[32:47]
    s_waitcnt lgkmcnt(3)
    ds_read_b128 a[4:7], v2 offset:31744
    ds_read_b128 a[8:11], v2 offset:32768
    v_exp_f32 v53, v53
    v_exp_f32 v54, v54
    v_mfma_f32_32x32x16_bf16 v[32:47], a[12:15], v[84:87], v[32:47]
    s_waitcnt lgkmcnt(4)
    v_exp_f32 v55, v55
    v_exp_f32 v56, v56
    v_exp_f32 v57, v57
    v_mfma_f32_32x32x16_bf16 v[32:47], a[16:19], v[88:91], v[32:47]
    s_waitcnt lgkmcnt(3)
    ds_read_b128 a[12:15], v2 offset:33792
    ds_read_b128 a[16:19], v2 offset:34816
    v_exp_f32 v58, v58
    v_exp_f32 v59, v59
    v_mfma_f32_32x32x16_bf16 v[32:47], a[20:23], v[92:95], v[32:47]
    s_waitcnt lgkmcnt(4)
    v_cvt_pk_bf16_f32 v64, v144, v145
    v_cvt_pk_bf16_f32 v65, v146, v147
    v_cvt_pk_bf16_f32 v66, v148, v149
    v_cvt_pk_bf16_f32 v67, v150, v151
    v_cvt_pk_bf16_f32 v68, v152, v153
    v_cvt_pk_bf16_f32 v69, v154, v155
    v_cvt_pk_bf16_f32 v70, v156, v157
    v_cvt_pk_bf16_f32 v71, v158, v159
    v_exp_f32 v60, v60
    v_exp_f32 v61, v61
    v_exp_f32 v62, v62
    v_exp_f32 v63, v63
    v_pk_add_f32 v[48:49], v[48:49], 1.0 op_sel_hi:[1,0]
    v_pk_add_f32 v[50:51], v[50:51], 1.0 op_sel_hi:[1,0]
    v_pk_add_f32 v[52:53], v[52:53], 1.0 op_sel_hi:[1,0]
    v_pk_add_f32 v[54:55], v[54:55], 1.0 op_sel_hi:[1,0]
    v_pk_add_f32 v[56:57], v[56:57], 1.0 op_sel_hi:[1,0]
    v_pk_add_f32 v[58:59], v[58:59], 1.0 op_sel_hi:[1,0]
    v_pk_add_f32 v[60:61], v[60:61], 1.0 op_sel_hi:[1,0]
    v_pk_add_f32 v[62:63], v[62:63], 1.0 op_sel_hi:[1,0]
    v_mfma_f32_32x32x16_bf16 v[112:127], a[28:31], v[220:223], v[112:127]
    v_rcp_f32 v48, v48
    v_rcp_f32 v49, v49
    v_rcp_f32 v50, v50
    v_mfma_f32_32x32x16_bf16 v[128:143], a[24:27], v[224:227], v[128:143]
    v_rcp_f32 v51, v51
    v_rcp_f32 v52, v52
    v_rcp_f32 v53, v53
    v_mfma_f32_32x32x16_bf16 v[128:143], a[28:31], v[228:231], v[128:143]
    v_rcp_f32 v54, v54
    v_rcp_f32 v55, v55
    v_rcp_f32 v56, v56
    v_mfma_f32_32x32x16_bf16 v[96:111], a[176:179], v[64:67], v[96:111]
    v_rcp_f32 v57, v57
    v_rcp_f32 v58, v58
    v_rcp_f32 v59, v59
    v_mfma_f32_32x32x16_bf16 v[112:127], a[180:183], v[64:67], v[112:127]
    v_rcp_f32 v60, v60
    v_rcp_f32 v61, v61
    v_rcp_f32 v62, v62
    v_mfma_f32_32x32x16_bf16 v[128:143], a[184:187], v[64:67], v[128:143]
    v_rcp_f32 v63, v63
    v_mfma_f32_32x32x16_bf16 v[96:111], a[188:191], v[68:71], v[96:111]
    v_mfma_f32_32x32x16_bf16 v[112:127], a[192:195], v[68:71], v[112:127]
    v_mfma_f32_32x32x16_bf16 v[128:143], a[196:199], v[68:71], v[128:143]
    v_pk_mul_f32 v[16:17], v[16:17], v[48:49]
    v_pk_mul_f32 v[18:19], v[18:19], v[50:51]
    v_pk_mul_f32 v[20:21], v[20:21], v[52:53]
    v_pk_mul_f32 v[22:23], v[22:23], v[54:55]
    v_pk_mul_f32 v[24:25], v[24:25], v[56:57]
    v_pk_mul_f32 v[26:27], v[26:27], v[58:59]
    v_pk_mul_f32 v[28:29], v[28:29], v[60:61]
    v_pk_mul_f32 v[30:31], v[30:31], v[62:63]
    v_pk_fma_f32 v[48:49], v[32:33], v[32:33], s[52:53]
    v_pk_fma_f32 v[50:51], v[34:35], v[34:35], s[52:53]
    v_pk_fma_f32 v[52:53], v[36:37], v[36:37], s[52:53]
    v_pk_fma_f32 v[54:55], v[38:39], v[38:39], s[52:53]
    v_pk_fma_f32 v[56:57], v[40:41], v[40:41], s[52:53]
    v_pk_fma_f32 v[58:59], v[42:43], v[42:43], s[52:53]
    v_pk_fma_f32 v[60:61], v[44:45], v[44:45], s[52:53]
    v_pk_fma_f32 v[62:63], v[46:47], v[46:47], s[52:53]
    v_pk_mul_f32 v[48:49], v[48:49], v[32:33] neg_lo:[1,0] neg_hi:[1,0]
    v_pk_mul_f32 v[50:51], v[50:51], v[34:35] neg_lo:[1,0] neg_hi:[1,0]
    v_pk_mul_f32 v[52:53], v[52:53], v[36:37] neg_lo:[1,0] neg_hi:[1,0]
    v_pk_mul_f32 v[54:55], v[54:55], v[38:39] neg_lo:[1,0] neg_hi:[1,0]
    v_pk_mul_f32 v[56:57], v[56:57], v[40:41] neg_lo:[1,0] neg_hi:[1,0]
    v_pk_mul_f32 v[58:59], v[58:59], v[42:43] neg_lo:[1,0] neg_hi:[1,0]
    v_pk_mul_f32 v[60:61], v[60:61], v[44:45] neg_lo:[1,0] neg_hi:[1,0]
    v_pk_mul_f32 v[62:63], v[62:63], v[46:47] neg_lo:[1,0] neg_hi:[1,0]
    v_mfma_f32_32x32x16_bf16 v[144:159], a[0:3], v[72:75], 0
    s_waitcnt lgkmcnt(3)
    ds_read_b128 a[20:23], v2 offset:35840
    ds_read_b128 a[0:3], v2 offset:36864
    v_exp_f32 v48, v48
    v_exp_f32 v49, v49
    v_mfma_f32_32x32x16_bf16 v[144:159], a[4:7], v[76:79], v[144:159]
    s_waitcnt lgkmcnt(4)
    v_exp_f32 v50, v50
    v_exp_f32 v51, v51
    v_exp_f32 v52, v52
    v_mfma_f32_32x32x16_bf16 v[144:159], a[8:11], v[80:83], v[144:159]
    s_waitcnt lgkmcnt(3)
    ds_read_b128 a[4:7], v2 offset:37888
    ds_read_b128 a[8:11], v2 offset:38912
    v_exp_f32 v53, v53
    v_exp_f32 v54, v54
    v_mfma_f32_32x32x16_bf16 v[144:159], a[12:15], v[84:87], v[144:159]
    s_waitcnt lgkmcnt(4)
    v_exp_f32 v55, v55
    v_exp_f32 v56, v56
    v_exp_f32 v57, v57
    v_mfma_f32_32x32x16_bf16 v[144:159], a[16:19], v[88:91], v[144:159]
    s_waitcnt lgkmcnt(3)
    ds_read_b128 a[12:15], v2 offset:39936
    ds_read_b128 a[16:19], v2 offset:40960
    v_exp_f32 v58, v58
    v_exp_f32 v59, v59
    v_mfma_f32_32x32x16_bf16 v[144:159], a[20:23], v[92:95], v[144:159]
    s_waitcnt lgkmcnt(4)
    v_cvt_pk_bf16_f32 v64, v16, v17
    v_cvt_pk_bf16_f32 v65, v18, v19
    v_cvt_pk_bf16_f32 v66, v20, v21
    v_cvt_pk_bf16_f32 v67, v22, v23
    v_exp_f32 v60, v60
    v_exp_f32 v61, v61
    v_exp_f32 v62, v62
    v_exp_f32 v63, v63
    v_pk_add_f32 v[48:49], v[48:49], 1.0 op_sel_hi:[1,0]
    v_pk_add_f32 v[50:51], v[50:51], 1.0 op_sel_hi:[1,0]
    v_pk_add_f32 v[52:53], v[52:53], 1.0 op_sel_hi:[1,0]
    v_pk_add_f32 v[54:55], v[54:55], 1.0 op_sel_hi:[1,0]
    v_pk_add_f32 v[56:57], v[56:57], 1.0 op_sel_hi:[1,0]
    v_pk_add_f32 v[58:59], v[58:59], 1.0 op_sel_hi:[1,0]
    v_pk_add_f32 v[60:61], v[60:61], 1.0 op_sel_hi:[1,0]
    v_pk_add_f32 v[62:63], v[62:63], 1.0 op_sel_hi:[1,0]
    v_mfma_f32_32x32x16_bf16 v[96:111], a[200:203], v[64:67], v[96:111]
    v_cvt_pk_bf16_f32 v68, v24, v25
    v_cvt_pk_bf16_f32 v69, v26, v27
    v_cvt_pk_bf16_f32 v70, v28, v29
    v_cvt_pk_bf16_f32 v71, v30, v31
    v_rcp_f32 v48, v48
    v_mfma_f32_32x32x16_bf16 v[112:127], a[204:207], v[64:67], v[112:127]
    v_rcp_f32 v49, v49
    v_rcp_f32 v50, v50
    v_rcp_f32 v51, v51
    v_mfma_f32_32x32x16_bf16 v[128:143], a[208:211], v[64:67], v[128:143]
    v_rcp_f32 v52, v52
    v_rcp_f32 v53, v53
    v_rcp_f32 v54, v54
    v_mfma_f32_32x32x16_bf16 v[96:111], a[212:215], v[68:71], v[96:111]
    v_rcp_f32 v55, v55
    v_rcp_f32 v56, v56
    v_rcp_f32 v57, v57
    v_mfma_f32_32x32x16_bf16 v[112:127], a[216:219], v[68:71], v[112:127]
    v_rcp_f32 v58, v58
    v_rcp_f32 v59, v59
    v_rcp_f32 v60, v60
    v_mfma_f32_32x32x16_bf16 v[128:143], a[220:223], v[68:71], v[128:143]
    v_rcp_f32 v61, v61
    v_rcp_f32 v62, v62
    v_rcp_f32 v63, v63
    v_pk_mul_f32 v[32:33], v[32:33], v[48:49]
    v_pk_mul_f32 v[34:35], v[34:35], v[50:51]
    v_pk_mul_f32 v[36:37], v[36:37], v[52:53]
    v_pk_mul_f32 v[38:39], v[38:39], v[54:55]
    v_pk_mul_f32 v[40:41], v[40:41], v[56:57]
    v_pk_mul_f32 v[42:43], v[42:43], v[58:59]
    v_pk_mul_f32 v[44:45], v[44:45], v[60:61]
    v_pk_mul_f32 v[46:47], v[46:47], v[62:63]
    v_pk_fma_f32 v[48:49], v[144:145], v[144:145], s[52:53]
    v_pk_fma_f32 v[50:51], v[146:147], v[146:147], s[52:53]
    v_pk_fma_f32 v[52:53], v[148:149], v[148:149], s[52:53]
    v_pk_fma_f32 v[54:55], v[150:151], v[150:151], s[52:53]
    v_pk_fma_f32 v[56:57], v[152:153], v[152:153], s[52:53]
    v_pk_fma_f32 v[58:59], v[154:155], v[154:155], s[52:53]
    v_pk_fma_f32 v[60:61], v[156:157], v[156:157], s[52:53]
    v_pk_fma_f32 v[62:63], v[158:159], v[158:159], s[52:53]
    v_pk_mul_f32 v[48:49], v[48:49], v[144:145] neg_lo:[1,0] neg_hi:[1,0]
    v_pk_mul_f32 v[50:51], v[50:51], v[146:147] neg_lo:[1,0] neg_hi:[1,0]
    v_pk_mul_f32 v[52:53], v[52:53], v[148:149] neg_lo:[1,0] neg_hi:[1,0]
    v_pk_mul_f32 v[54:55], v[54:55], v[150:151] neg_lo:[1,0] neg_hi:[1,0]
    v_pk_mul_f32 v[56:57], v[56:57], v[152:153] neg_lo:[1,0] neg_hi:[1,0]
    v_pk_mul_f32 v[58:59], v[58:59], v[154:155] neg_lo:[1,0] neg_hi:[1,0]
    v_pk_mul_f32 v[60:61], v[60:61], v[156:157] neg_lo:[1,0] neg_hi:[1,0]
    v_pk_mul_f32 v[62:63], v[62:63], v[158:159] neg_lo:[1,0] neg_hi:[1,0]
    v_mfma_f32_32x32x16_bf16 v[16:31], a[0:3], v[72:75], 0
    s_waitcnt lgkmcnt(3)
    ds_read_b128 a[20:23], v2 offset:41984
    ds_read_b128 a[0:3], v2 offset:43008
    v_exp_f32 v48, v48
    v_exp_f32 v49, v49
    v_mfma_f32_32x32x16_bf16 v[16:31], a[4:7], v[76:79], v[16:31]
    s_waitcnt lgkmcnt(4)
    s_add_u32 s55, s56, 24576
    buffer_store_dwordx4 v[160:163], v9, s[28:31], s55 offen offset:0 sc1
    buffer_store_dwordx4 v[176:179], v9, s[28:31], s55 offen offset:64 sc1
    buffer_store_dwordx4 v[192:195], v9, s[28:31], s55 offen offset:128 sc1
    v_exp_f32 v50, v50
    v_mfma_f32_32x32x16_bf16 v[16:31], a[8:11], v[80:83], v[16:31]
    s_waitcnt lgkmcnt(3)
    ds_read_b128 a[4:7], v2 offset:44032
    ds_read_b128 a[8:11], v2 offset:45056
    v_exp_f32 v51, v51
    v_exp_f32 v52, v52
    v_mfma_f32_32x32x16_bf16 v[16:31], a[12:15], v[84:87], v[16:31]
    s_waitcnt lgkmcnt(4)
    v_exp_f32 v53, v53
    v_exp_f32 v54, v54
    v_exp_f32 v55, v55
    v_mfma_f32_32x32x16_bf16 v[16:31], a[16:19], v[88:91], v[16:31]
    s_waitcnt lgkmcnt(3)
    ds_read_b128 a[12:15], v2 offset:46080
    ds_read_b128 a[16:19], v2 offset:47104
    v_exp_f32 v56, v56
    v_exp_f32 v57, v57
    v_mfma_f32_32x32x16_bf16 v[16:31], a[20:23], v[92:95], v[16:31]
    s_waitcnt lgkmcnt(4)
    v_cvt_pk_bf16_f32 v64, v32, v33
    v_cvt_pk_bf16_f32 v65, v34, v35
    v_cvt_pk_bf16_f32 v66, v36, v37
    v_cvt_pk_bf16_f32 v67, v38, v39
    v_exp_f32 v58, v58
    v_exp_f32 v59, v59
    v_exp_f32 v60, v60
    v_exp_f32 v61, v61
    v_exp_f32 v62, v62
    v_exp_f32 v63, v63
    v_pk_add_f32 v[48:49], v[48:49], 1.0 op_sel_hi:[1,0]
    v_pk_add_f32 v[50:51], v[50:51], 1.0 op_sel_hi:[1,0]
    v_pk_add_f32 v[52:53], v[52:53], 1.0 op_sel_hi:[1,0]
    v_pk_add_f32 v[54:55], v[54:55], 1.0 op_sel_hi:[1,0]
    v_pk_add_f32 v[56:57], v[56:57], 1.0 op_sel_hi:[1,0]
    v_pk_add_f32 v[58:59], v[58:59], 1.0 op_sel_hi:[1,0]
    v_pk_add_f32 v[60:61], v[60:61], 1.0 op_sel_hi:[1,0]
    v_pk_add_f32 v[62:63], v[62:63], 1.0 op_sel_hi:[1,0]
    v_mfma_f32_32x32x16_bf16 v[96:111], a[32:35], v[64:67], v[96:111]
    v_cvt_pk_bf16_f32 v68, v40, v41
    v_cvt_pk_bf16_f32 v69, v42, v43
    v_cvt_pk_bf16_f32 v70, v44, v45
    v_cvt_pk_bf16_f32 v71, v46, v47
    v_rcp_f32 v48, v48
    v_mfma_f32_32x32x16_bf16 v[112:127], a[36:39], v[64:67], v[112:127]
    v_rcp_f32 v49, v49
    v_rcp_f32 v50, v50
    v_rcp_f32 v51, v51
    v_mfma_f32_32x32x16_bf16 v[128:143], a[40:43], v[64:67], v[128:143]
    v_rcp_f32 v52, v52
    v_rcp_f32 v53, v53
    v_rcp_f32 v54, v54
    v_mfma_f32_32x32x16_bf16 v[96:111], a[44:47], v[68:71], v[96:111]
    v_rcp_f32 v55, v55
    v_rcp_f32 v56, v56
    v_rcp_f32 v57, v57
    v_mfma_f32_32x32x16_bf16 v[112:127], a[48:51], v[68:71], v[112:127]
    v_rcp_f32 v58, v58
    v_rcp_f32 v59, v59
    v_rcp_f32 v60, v60
    v_mfma_f32_32x32x16_bf16 v[128:143], a[52:55], v[68:71], v[128:143]
    v_rcp_f32 v61, v61
    v_rcp_f32 v62, v62
    v_rcp_f32 v63, v63
    v_pk_mul_f32 v[144:145], v[144:145], v[48:49]
    v_pk_mul_f32 v[146:147], v[146:147], v[50:51]
    v_pk_mul_f32 v[148:149], v[148:149], v[52:53]
    v_pk_mul_f32 v[150:151], v[150:151], v[54:55]
    v_pk_mul_f32 v[152:153], v[152:153], v[56:57]
    v_pk_mul_f32 v[154:155], v[154:155], v[58:59]
    v_pk_mul_f32 v[156:157], v[156:157], v[60:61]
    v_pk_mul_f32 v[158:159], v[158:159], v[62:63]
    v_pk_fma_f32 v[48:49], v[16:17], v[16:17], s[52:53]
    v_pk_fma_f32 v[50:51], v[18:19], v[18:19], s[52:53]
    v_pk_fma_f32 v[52:53], v[20:21], v[20:21], s[52:53]
    v_pk_fma_f32 v[54:55], v[22:23], v[22:23], s[52:53]
    v_pk_fma_f32 v[56:57], v[24:25], v[24:25], s[52:53]
    v_pk_fma_f32 v[58:59], v[26:27], v[26:27], s[52:53]
    v_pk_fma_f32 v[60:61], v[28:29], v[28:29], s[52:53]
    v_pk_fma_f32 v[62:63], v[30:31], v[30:31], s[52:53]
    v_pk_mul_f32 v[48:49], v[48:49], v[16:17] neg_lo:[1,0] neg_hi:[1,0]
    v_pk_mul_f32 v[50:51], v[50:51], v[18:19] neg_lo:[1,0] neg_hi:[1,0]
    v_pk_mul_f32 v[52:53], v[52:53], v[20:21] neg_lo:[1,0] neg_hi:[1,0]
    v_pk_mul_f32 v[54:55], v[54:55], v[22:23] neg_lo:[1,0] neg_hi:[1,0]
    v_pk_mul_f32 v[56:57], v[56:57], v[24:25] neg_lo:[1,0] neg_hi:[1,0]
    v_pk_mul_f32 v[58:59], v[58:59], v[26:27] neg_lo:[1,0] neg_hi:[1,0]
    v_pk_mul_f32 v[60:61], v[60:61], v[28:29] neg_lo:[1,0] neg_hi:[1,0]
    v_pk_mul_f32 v[62:63], v[62:63], v[30:31] neg_lo:[1,0] neg_hi:[1,0]
    v_mfma_f32_32x32x16_bf16 v[32:47], a[0:3], v[72:75], 0
    s_waitcnt lgkmcnt(3)
    ds_read_b128 a[20:23], v2 offset:48128
    ds_read_b128 a[0:3], v2 offset:49152
    v_exp_f32 v48, v48
    v_exp_f32 v49, v49
    v_mfma_f32_32x32x16_bf16 v[32:47], a[4:7], v[76:79], v[32:47]
    s_waitcnt lgkmcnt(4)
    v_exp_f32 v50, v50
    v_exp_f32 v51, v51
    v_exp_f32 v52, v52
    v_mfma_f32_32x32x16_bf16 v[32:47], a[8:11], v[80:83], v[32:47]
    s_waitcnt lgkmcnt(3)
    ds_read_b128 a[4:7], v2 offset:50176
    ds_read_b128 a[8:11], v2 offset:51200
    v_exp_f32 v53, v53
    v_exp_f32 v54, v54
    v_mfma_f32_32x32x16_bf16 v[32:47], a[12:15], v[84:87], v[32:47]
    s_waitcnt lgkmcnt(4)
    v_exp_f32 v55, v55
    v_exp_f32 v56, v56
    v_exp_f32 v57, v57
    v_mfma_f32_32x32x16_bf16 v[32:47], a[16:19], v[88:91], v[32:47]
    s_waitcnt lgkmcnt(3)
    ds_read_b128 a[12:15], v2 offset:52224
    ds_read_b128 a[16:19], v2 offset:53248
    v_exp_f32 v58, v58
    v_exp_f32 v59, v59
    v_mfma_f32_32x32x16_bf16 v[32:47], a[20:23], v[92:95], v[32:47]
    s_waitcnt lgkmcnt(4)
    v_cvt_pk_bf16_f32 v64, v144, v145
    v_cvt_pk_bf16_f32 v65, v146, v147
    v_cvt_pk_bf16_f32 v66, v148, v149
    v_cvt_pk_bf16_f32 v67, v150, v151
    v_exp_f32 v60, v60
    v_exp_f32 v61, v61
    v_exp_f32 v62, v62
    v_exp_f32 v63, v63
    v_pk_add_f32 v[48:49], v[48:49], 1.0 op_sel_hi:[1,0]
    v_pk_add_f32 v[50:51], v[50:51], 1.0 op_sel_hi:[1,0]
    v_pk_add_f32 v[52:53], v[52:53], 1.0 op_sel_hi:[1,0]
    v_pk_add_f32 v[54:55], v[54:55], 1.0 op_sel_hi:[1,0]
    v_pk_add_f32 v[56:57], v[56:57], 1.0 op_sel_hi:[1,0]
    v_pk_add_f32 v[58:59], v[58:59], 1.0 op_sel_hi:[1,0]
    v_pk_add_f32 v[60:61], v[60:61], 1.0 op_sel_hi:[1,0]
    v_pk_add_f32 v[62:63], v[62:63], 1.0 op_sel_hi:[1,0]
L_pf20:
    v_mfma_f32_32x32x16_bf16 v[96:111], a[56:59], v[64:67], v[96:111]
    s_mov_b32 s63, L_pf20-L_pc+12288
    buffer_load_dword v6, v7, s[68:71], s63 offen
    v_cvt_pk_bf16_f32 v68, v152, v153
    v_cvt_pk_bf16_f32 v69, v154, v155
    v_cvt_pk_bf16_f32 v70, v156, v157
    v_cvt_pk_bf16_f32 v71, v158, v159
    v_mfma_f32_32x32x16_bf16 v[112:127], a[60:63], v[64:67], v[112:127]
    v_rcp_f32 v48, v48
    v_rcp_f32 v49, v49
    v_rcp_f32 v50, v50
    v_mfma_f32_32x32x16_bf16 v[128:143], a[64:67], v[64:67], v[128:143]
    v_rcp_f32 v51, v51
    v_rcp_f32 v52, v52
    v_rcp_f32 v53, v53
    v_mfma_f32_32x32x16_bf16 v[96:111], a[68:71], v[68:71], v[96:111]
    v_rcp_f32 v54, v54
    v_rcp_f32 v55, v55
    v_rcp_f32 v56, v56
    v_mfma_f32_32x32x16_bf16 v[112:127], a[72:75], v[68:71], v[112:127]
    v_rcp_f32 v57, v57
    v_rcp_f32 v58, v58
    v_rcp_f32 v59, v59
    v_mfma_f32_32x32x16_bf16 v[128:143], a[76:79], v[68:71], v[128:143]
    v_rcp_f32 v60, v60
    v_rcp_f32 v61, v61
    v_rcp_f32 v62, v62
    v_rcp_f32 v63, v63
    v_pk_mul_f32 v[16:17], v[16:17], v[48:49]
    v_pk_mul_f32 v[18:19], v[18:19], v[50:51]
    v_pk_mul_f32 v[20:21], v[20:21], v[52:53]
    v_pk_mul_f32 v[22:23], v[22:23], v[54:55]
    v_pk_mul_f32 v[24:25], v[24:25], v[56:57]
    v_pk_mul_f32 v[26:27], v[26:27], v[58:59]
    v_pk_mul_f32 v[28:29], v[28:29], v[60:61]
    v_pk_mul_f32 v[30:31], v[30:31], v[62:63]
    v_pk_fma_f32 v[48:49], v[32:33], v[32:33], s[52:53]
    v_pk_fma_f32 v[50:51], v[34:35], v[34:35], s[52:53]
    v_pk_fma_f32 v[52:53], v[36:37], v[36:37], s[52:53]
    v_pk_fma_f32 v[54:55], v[38:39], v[38:39], s[52:53]
    v_pk_fma_f32 v[56:57], v[40:41], v[40:41], s[52:53]
    v_pk_fma_f32 v[58:59], v[42:43], v[42:43], s[52:53]
    v_pk_fma_f32 v[60:61], v[44:45], v[44:45], s[52:53]
    v_pk_fma_f32 v[62:63], v[46:47], v[46:47], s[52:53]
    v_pk_mul_f32 v[48:49], v[48:49], v[32:33] neg_lo:[1,0] neg_hi:[1,0]
    v_pk_mul_f32 v[50:51], v[50:51], v[34:35] neg_lo:[1,0] neg_hi:[1,0]
    v_pk_mul_f32 v[52:53], v[52:53], v[36:37] neg_lo:[1,0] neg_hi:[1,0]
    v_pk_mul_f32 v[54:55], v[54:55], v[38:39] neg_lo:[1,0] neg_hi:[1,0]
    v_pk_mul_f32 v[56:57], v[56:57], v[40:41] neg_lo:[1,0] neg_hi:[1,0]
    v_pk_mul_f32 v[58:59], v[58:59], v[42:43] neg_lo:[1,0] neg_hi:[1,0]
    v_pk_mul_f32 v[60:61], v[60:61], v[44:45] neg_lo:[1,0] neg_hi:[1,0]
    v_pk_mul_f32 v[62:63], v[62:63], v[46:47] neg_lo:[1,0] neg_hi:[1,0]
    v_mfma_f32_32x32x16_bf16 v[144:159], a[0:3], v[72:75], 0
    s_waitcnt lgkmcnt(3)
    ds_read_b128 a[20:23], v2 offset:54272
    ds_read_b128 a[0:3], v2 offset:55296
    v_exp_f32 v48, v48
    v_exp_f32 v49, v49
    v_mfma_f32_32x32x16_bf16 v[144:159], a[4:7], v[76:79], v[144:159]
    s_waitcnt lgkmcnt(4)
    v_exp_f32 v50, v50
    v_exp_f32 v51, v51
    v_exp_f32 v52, v52
    v_mfma_f32_32x32x16_bf16 v[144:159], a[8:11], v[80:83], v[144:159]
    s_waitcnt lgkmcnt(3)
    ds_read_b128 a[4:7], v2 offset:56320
    ds_read_b128 a[8:11], v2 offset:57344
    v_exp_f32 v53, v53
    v_exp_f32 v54, v54
    v_mfma_f32_32x32x16_bf16 v[144:159], a[12:15], v[84:87], v[144:159]
    s_waitcnt lgkmcnt(4)
    v_exp_f32 v55, v55
    v_exp_f32 v56, v56
    v_exp_f32 v57, v57
    v_mfma_f32_32x32x16_bf16 v[144:159], a[16:19], v[88:91], v[144:159]
    s_waitcnt lgkmcnt(3)
    ds_read_b128 a[12:15], v2 offset:58368
    ds_read_b128 a[16:19], v2 offset:59392
    v_exp_f32 v58, v58
    v_exp_f32 v59, v59
    v_mfma_f32_32x32x16_bf16 v[144:159], a[20:23], v[92:95], v[144:159]
    s_waitcnt lgkmcnt(4)
    v_cvt_pk_bf16_f32 v64, v16, v17
    v_cvt_pk_bf16_f32 v65, v18, v19
    v_cvt_pk_bf16_f32 v66, v20, v21
    v_cvt_pk_bf16_f32 v67, v22, v23
    v_exp_f32 v60, v60
    v_exp_f32 v61, v61
    v_exp_f32 v62, v62
    v_exp_f32 v63, v63
    v_pk_add_f32 v[48:49], v[48:49], 1.0 op_sel_hi:[1,0]
    v_pk_add_f32 v[50:51], v[50:51], 1.0 op_sel_hi:[1,0]
    v_pk_add_f32 v[52:53], v[52:53], 1.0 op_sel_hi:[1,0]
    v_pk_add_f32 v[54:55], v[54:55], 1.0 op_sel_hi:[1,0]
    v_pk_add_f32 v[56:57], v[56:57], 1.0 op_sel_hi:[1,0]
    v_pk_add_f32 v[58:59], v[58:59], 1.0 op_sel_hi:[1,0]
    v_pk_add_f32 v[60:61], v[60:61], 1.0 op_sel_hi:[1,0]
    v_pk_add_f32 v[62:63], v[62:63], 1.0 op_sel_hi:[1,0]
    v_mfma_f32_32x32x16_bf16 v[96:111], a[80:83], v[64:67], v[96:111]
    v_cvt_pk_bf16_f32 v68, v24, v25
    v_cvt_pk_bf16_f32 v69, v26, v27
    v_cvt_pk_bf16_f32 v70, v28, v29
    v_cvt_pk_bf16_f32 v71, v30, v31
    v_rcp_f32 v48, v48
    v_mfma_f32_32x32x16_bf16 v[112:127], a[84:87], v[64:67], v[112:127]
    v_rcp_f32 v49, v49
    v_rcp_f32 v50, v50
    v_rcp_f32 v51, v51
    v_mfma_f32_32x32x16_bf16 v[128:143], a[88:91], v[64:67], v[128:143]
    v_rcp_f32 v52, v52
    v_rcp_f32 v53, v53
    v_rcp_f32 v54, v54
    v_mfma_f32_32x32x16_bf16 v[96:111], a[92:95], v[68:71], v[96:111]
    v_rcp_f32 v55, v55
    v_rcp_f32 v56, v56
    v_rcp_f32 v57, v57
    v_mfma_f32_32x32x16_bf16 v[112:127], a[96:99], v[68:71], v[112:127]
    v_rcp_f32 v58, v58
    v_rcp_f32 v59, v59
    v_rcp_f32 v60, v60
    v_mfma_f32_32x32x16_bf16 v[128:143], a[100:103], v[68:71], v[128:143]
    v_rcp_f32 v61, v61
    v_rcp_f32 v62, v62
    v_rcp_f32 v63, v63
    v_pk_mul_f32 v[32:33], v[32:33], v[48:49]
    v_pk_mul_f32 v[34:35], v[34:35], v[50:51]
    v_pk_mul_f32 v[36:37], v[36:37], v[52:53]
    v_pk_mul_f32 v[38:39], v[38:39], v[54:55]
    v_pk_mul_f32 v[40:41], v[40:41], v[56:57]
    v_pk_mul_f32 v[42:43], v[42:43], v[58:59]
    v_pk_mul_f32 v[44:45], v[44:45], v[60:61]
    v_pk_mul_f32 v[46:47], v[46:47], v[62:63]
    v_pk_fma_f32 v[48:49], v[144:145], v[144:145], s[52:53]
    v_pk_fma_f32 v[50:51], v[146:147], v[146:147], s[52:53]
    v_pk_fma_f32 v[52:53], v[148:149], v[148:149], s[52:53]
    v_pk_fma_f32 v[54:55], v[150:151], v[150:151], s[52:53]
    v_pk_fma_f32 v[56:57], v[152:153], v[152:153], s[52:53]
    v_pk_fma_f32 v[58:59], v[154:155], v[154:155], s[52:53]
    v_pk_fma_f32 v[60:61], v[156:157], v[156:157], s[52:53]
    v_pk_fma_f32 v[62:63], v[158:159], v[158:159], s[52:53]
    v_pk_mul_f32 v[48:49], v[48:49], v[144:145] neg_lo:[1,0] neg_hi:[1,0]
    v_pk_mul_f32 v[50:51], v[50:51], v[146:147] neg_lo:[1,0] neg_hi:[1,0]
    v_pk_mul_f32 v[52:53], v[52:53], v[148:149] neg_lo:[1,0] neg_hi:[1,0]
    v_pk_mul_f32 v[54:55], v[54:55], v[150:151] neg_lo:[1,0] neg_hi:[1,0]
    v_pk_mul_f32 v[56:57], v[56:57], v[152:153] neg_lo:[1,0] neg_hi:[1,0]
    v_pk_mul_f32 v[58:59], v[58:59], v[154:155] neg_lo:[1,0] neg_hi:[1,0]
    v_pk_mul_f32 v[60:61], v[60:61], v[156:157] neg_lo:[1,0] neg_hi:[1,0]
    v_pk_mul_f32 v[62:63], v[62:63], v[158:159] neg_lo:[1,0] neg_hi:[1,0]
    v_mfma_f32_32x32x16_bf16 v[16:31], a[0:3], v[72:75], 0
    s_waitcnt lgkmcnt(3)
    ds_read_b128 a[20:23], v2 offset:60416
    ds_read_b128 a[0:3], v2 offset:61440
    v_exp_f32 v48, v48
    v_exp_f32 v49, v49
    v_mfma_f32_32x32x16_bf16 v[16:31], a[4:7], v[76:79], v[16:31]
    s_waitcnt lgkmcnt(4)
    v_exp_f32 v50, v50
    v_exp_f32 v51, v51
    v_exp_f32 v52, v52
    v_mfma_f32_32x32x16_bf16 v[16:31], a[8:11], v[80:83], v[16:31]
    s_waitcnt lgkmcnt(3)
    ds_read_b128 a[4:7], v2 offset:62464
    ds_read_b128 a[8:11], v2 offset:63488
    v_exp_f32 v53, v53
    v_exp_f32 v54, v54
    v_mfma_f32_32x32x16_bf16 v[16:31], a[12:15], v[84:87], v[16:31]
    s_waitcnt lgkmcnt(4)
    v_exp_f32 v55, v55
    v_exp_f32 v56, v56
    v_exp_f32 v57, v57
    v_mfma_f32_32x32x16_bf16 v[16:31], a[16:19], v[88:91], v[16:31]
    s_waitcnt lgkmcnt(3)
    ds_read_b128 a[12:15], v2 offset:64512
    ds_read_b128 a[16:19], v3 offset:0
    v_exp_f32 v58, v58
    v_exp_f32 v59, v59
    v_mfma_f32_32x32x16_bf16 v[16:31], a[20:23], v[92:95], v[16:31]
    s_waitcnt lgkmcnt(4)
    v_cvt_pk_bf16_f32 v64, v32, v33
    v_cvt_pk_bf16_f32 v65, v34, v35
    v_cvt_pk_bf16_f32 v66, v36, v37
    v_cvt_pk_bf16_f32 v67, v38, v39
    v_exp_f32 v60, v60
    v_exp_f32 v61, v61
    v_exp_f32 v62, v62
    v_exp_f32 v63, v63
    v_pk_add_f32 v[48:49], v[48:49], 1.0 op_sel_hi:[1,0]
    v_pk_add_f32 v[50:51], v[50:51], 1.0 op_sel_hi:[1,0]
    v_pk_add_f32 v[52:53], v[52:53], 1.0 op_sel_hi:[1,0]
    v_pk_add_f32 v[54:55], v[54:55], 1.0 op_sel_hi:[1,0]
    v_pk_add_f32 v[56:57], v[56:57], 1.0 op_sel_hi:[1,0]
    v_pk_add_f32 v[58:59], v[58:59], 1.0 op_sel_hi:[1,0]
    v_pk_add_f32 v[60:61], v[60:61], 1.0 op_sel_hi:[1,0]
    v_pk_add_f32 v[62:63], v[62:63], 1.0 op_sel_hi:[1,0]
    v_mfma_f32_32x32x16_bf16 v[96:111], a[104:107], v[64:67], v[96:111]
    v_cvt_pk_bf16_f32 v68, v40, v41
    v_cvt_pk_bf16_f32 v69, v42, v43
    v_cvt_pk_bf16_f32 v70, v44, v45
    v_cvt_pk_bf16_f32 v71, v46, v47
    v_rcp_f32 v48, v48
    v_mfma_f32_32x32x16_bf16 v[112:127], a[108:111], v[64:67], v[112:127]
    buffer_store_dwordx4 v[164:167], v9, s[28:31], s55 offen offset:3072 sc1
    buffer_store_dwordx4 v[180:183], v9, s[28:31], s55 offen offset:3136 sc1
    buffer_store_dwordx4 v[196:199], v9, s[28:31], s55 offen offset:3200 sc1
    v_rcp_f32 v49, v49
    v_mfma_f32_32x32x16_bf16 v[128:143], a[112:115], v[64:67], v[128:143]
    v_rcp_f32 v50, v50
    v_rcp_f32 v51, v51
    v_rcp_f32 v52, v52
    v_mfma_f32_32x32x16_bf16 v[96:111], a[116:119], v[68:71], v[96:111]
    v_rcp_f32 v53, v53
    v_rcp_f32 v54, v54
    v_rcp_f32 v55, v55
    v_mfma_f32_32x32x16_bf16 v[112:127], a[120:123], v[68:71], v[112:127]
    v_rcp_f32 v56, v56
    v_rcp_f32 v57, v57
    v_rcp_f32 v58, v58
    v_mfma_f32_32x32x16_bf16 v[128:143], a[124:127], v[68:71], v[128:143]
    v_rcp_f32 v59, v59
    v_rcp_f32 v60, v60
    v_rcp_f32 v61, v61
    v_rcp_f32 v62, v62
    v_rcp_f32 v63, v63
    v_pk_mul_f32 v[144:145], v[144:145], v[48:49]
    v_pk_mul_f32 v[146:147], v[146:147], v[50:51]
    v_pk_mul_f32 v[148:149], v[148:149], v[52:53]
    v_pk_mul_f32 v[150:151], v[150:151], v[54:55]
    v_pk_mul_f32 v[152:153], v[152:153], v[56:57]
    v_pk_mul_f32 v[154:155], v[154:155], v[58:59]
    v_pk_mul_f32 v[156:157], v[156:157], v[60:61]
    v_pk_mul_f32 v[158:159], v[158:159], v[62:63]
    v_pk_fma_f32 v[48:49], v[16:17], v[16:17], s[52:53]
    v_pk_fma_f32 v[50:51], v[18:19], v[18:19], s[52:53]
    v_pk_fma_f32 v[52:53], v[20:21], v[20:21], s[52:53]
    v_pk_fma_f32 v[54:55], v[22:23], v[22:23], s[52:53]
    v_pk_fma_f32 v[56:57], v[24:25], v[24:25], s[52:53]
    v_pk_fma_f32 v[58:59], v[26:27], v[26:27], s[52:53]
    v_pk_fma_f32 v[60:61], v[28:29], v[28:29], s[52:53]
    v_pk_fma_f32 v[62:63], v[30:31], v[30:31], s[52:53]
    v_pk_mul_f32 v[48:49], v[48:49], v[16:17] neg_lo:[1,0] neg_hi:[1,0]
    v_pk_mul_f32 v[50:51], v[50:51], v[18:19] neg_lo:[1,0] neg_hi:[1,0]
    v_pk_mul_f32 v[52:53], v[52:53], v[20:21] neg_lo:[1,0] neg_hi:[1,0]
    v_pk_mul_f32 v[54:55], v[54:55], v[22:23] neg_lo:[1,0] neg_hi:[1,0]
    v_pk_mul_f32 v[56:57], v[56:57], v[24:25] neg_lo:[1,0] neg_hi:[1,0]
    v_pk_mul_f32 v[58:59], v[58:59], v[26:27] neg_lo:[1,0] neg_hi:[1,0]
    v_pk_mul_f32 v[60:61], v[60:61], v[28:29] neg_lo:[1,0] neg_hi:[1,0]
    v_pk_mul_f32 v[62:63], v[62:63], v[30:31] neg_lo:[1,0] neg_hi:[1,0]
    v_mfma_f32_32x32x16_bf16 v[32:47], a[0:3], v[72:75], 0
    s_waitcnt lgkmcnt(3)
    ds_read_b128 a[20:23], v3 offset:1024
    ds_read_b128 a[0:3], v3 offset:2048
    v_exp_f32 v48, v48
    v_exp_f32 v49, v49
    v_mfma_f32_32x32x16_bf16 v[32:47], a[4:7], v[76:79], v[32:47]
    s_waitcnt lgkmcnt(4)
    v_exp_f32 v50, v50
    v_exp_f32 v51, v51
    v_exp_f32 v52, v52
    v_mfma_f32_32x32x16_bf16 v[32:47], a[8:11], v[80:83], v[32:47]
    s_waitcnt lgkmcnt(3)
    ds_read_b128 a[4:7], v3 offset:3072
    ds_read_b128 a[8:11], v3 offset:4096
    v_exp_f32 v53, v53
    v_exp_f32 v54, v54
    v_mfma_f32_32x32x16_bf16 v[32:47], a[12:15], v[84:87], v[32:47]
    s_waitcnt lgkmcnt(4)
    v_exp_f32 v55, v55
    v_exp_f32 v56, v56
    v_exp_f32 v57, v57
    v_mfma_f32_32x32x16_bf16 v[32:47], a[16:19], v[88:91], v[32:47]
    s_waitcnt lgkmcnt(3)
    ds_read_b128 a[12:15], v3 offset:5120
    ds_read_b128 a[16:19], v3 offset:6144
    v_exp_f32 v58, v58
    v_exp_f32 v59, v59
    v_mfma_f32_32x32x16_bf16 v[32:47], a[20:23], v[92:95], v[32:47]
    s_waitcnt lgkmcnt(4)
    v_cvt_pk_bf16_f32 v64, v144, v145
    v_cvt_pk_bf16_f32 v65, v146, v147
    v_cvt_pk_bf16_f32 v66, v148, v149
    v_cvt_pk_bf16_f32 v67, v150, v151
    v_exp_f32 v60, v60
    v_exp_f32 v61, v61
    v_exp_f32 v62, v62
    v_exp_f32 v63, v63
    v_pk_add_f32 v[48:49], v[48:49], 1.0 op_sel_hi:[1,0]
    v_pk_add_f32 v[50:51], v[50:51], 1.0 op_sel_hi:[1,0]
    v_pk_add_f32 v[52:53], v[52:53], 1.0 op_sel_hi:[1,0]
    v_pk_add_f32 v[54:55], v[54:55], 1.0 op_sel_hi:[1,0]
    v_pk_add_f32 v[56:57], v[56:57], 1.0 op_sel_hi:[1,0]
    v_pk_add_f32 v[58:59], v[58:59], 1.0 op_sel_hi:[1,0]
    v_pk_add_f32 v[60:61], v[60:61], 1.0 op_sel_hi:[1,0]
    v_pk_add_f32 v[62:63], v[62:63], 1.0 op_sel_hi:[1,0]
    v_mfma_f32_32x32x16_bf16 v[96:111], a[224:227], v[64:67], v[96:111]
    v_cvt_pk_bf16_f32 v68, v152, v153
    v_cvt_pk_bf16_f32 v69, v154, v155
    v_cvt_pk_bf16_f32 v70, v156, v157
    v_cvt_pk_bf16_f32 v71, v158, v159
    v_rcp_f32 v48, v48
    v_mfma_f32_32x32x16_bf16 v[112:127], a[228:231], v[64:67], v[112:127]
    v_rcp_f32 v49, v49
    v_rcp_f32 v50, v50
    v_rcp_f32 v51, v51
    v_mfma_f32_32x32x16_bf16 v[128:143], a[232:235], v[64:67], v[128:143]
    v_rcp_f32 v52, v52
    v_rcp_f32 v53, v53
    v_rcp_f32 v54, v54
    v_mfma_f32_32x32x16_bf16 v[96:111], a[236:239], v[68:71], v[96:111]
    v_rcp_f32 v55, v55
    v_rcp_f32 v56, v56
    v_rcp_f32 v57, v57
    v_mfma_f32_32x32x16_bf16 v[112:127], a[240:243], v[68:71], v[112:127]
    v_rcp_f32 v58, v58
    v_rcp_f32 v59, v59
    v_rcp_f32 v60, v60
    v_mfma_f32_32x32x16_bf16 v[128:143], a[244:247], v[68:71], v[128:143]
    v_rcp_f32 v61, v61
    v_rcp_f32 v62, v62
    v_rcp_f32 v63, v63
    v_pk_mul_f32 v[16:17], v[16:17], v[48:49]
    v_pk_mul_f32 v[18:19], v[18:19], v[50:51]
    v_pk_mul_f32 v[20:21], v[20:21], v[52:53]
    v_pk_mul_f32 v[22:23], v[22:23], v[54:55]
    v_pk_mul_f32 v[24:25], v[24:25], v[56:57]
    v_pk_mul_f32 v[26:27], v[26:27], v[58:59]
    v_pk_mul_f32 v[28:29], v[28:29], v[60:61]
    v_pk_mul_f32 v[30:31], v[30:31], v[62:63]
    v_pk_fma_f32 v[48:49], v[32:33], v[32:33], s[52:53]
    v_pk_fma_f32 v[50:51], v[34:35], v[34:35], s[52:53]
    v_pk_fma_f32 v[52:53], v[36:37], v[36:37], s[52:53]
    v_pk_fma_f32 v[54:55], v[38:39], v[38:39], s[52:53]
    v_pk_fma_f32 v[56:57], v[40:41], v[40:41], s[52:53]
    v_pk_fma_f32 v[58:59], v[42:43], v[42:43], s[52:53]
    v_pk_fma_f32 v[60:61], v[44:45], v[44:45], s[52:53]
    v_pk_fma_f32 v[62:63], v[46:47], v[46:47], s[52:53]
    v_pk_mul_f32 v[48:49], v[48:49], v[32:33] neg_lo:[1,0] neg_hi:[1,0]
    v_pk_mul_f32 v[50:51], v[50:51], v[34:35] neg_lo:[1,0] neg_hi:[1,0]
    v_pk_mul_f32 v[52:53], v[52:53], v[36:37] neg_lo:[1,0] neg_hi:[1,0]
    v_pk_mul_f32 v[54:55], v[54:55], v[38:39] neg_lo:[1,0] neg_hi:[1,0]
    v_pk_mul_f32 v[56:57], v[56:57], v[40:41] neg_lo:[1,0] neg_hi:[1,0]
    v_pk_mul_f32 v[58:59], v[58:59], v[42:43] neg_lo:[1,0] neg_hi:[1,0]
    v_pk_mul_f32 v[60:61], v[60:61], v[44:45] neg_lo:[1,0] neg_hi:[1,0]
    v_pk_mul_f32 v[62:63], v[62:63], v[46:47] neg_lo:[1,0] neg_hi:[1,0]
    v_mfma_f32_32x32x16_bf16 v[144:159], a[0:3], v[72:75], 0
    s_waitcnt lgkmcnt(3)
    ds_read_b128 a[20:23], v3 offset:7168
    ds_read_b128 a[0:3], v3 offset:63488
    v_exp_f32 v48, v48
    v_exp_f32 v49, v49
    v_mfma_f32_32x32x16_bf16 v[144:159], a[4:7], v[76:79], v[144:159]
    s_waitcnt lgkmcnt(4)
    v_exp_f32 v50, v50
    v_exp_f32 v51, v51
    v_exp_f32 v52, v52
    v_mfma_f32_32x32x16_bf16 v[144:159], a[8:11], v[80:83], v[144:159]
    s_waitcnt lgkmcnt(3)
    ds_read_b128 a[4:7], v3 offset:64512
    ds_read_b128 a[8:11], v4 offset:0
    v_exp_f32 v53, v53
    v_exp_f32 v54, v54
    v_mfma_f32_32x32x16_bf16 v[144:159], a[12:15], v[84:87], v[144:159]
    s_waitcnt lgkmcnt(4)
    v_exp_f32 v55, v55
    v_exp_f32 v56, v56
    v_exp_f32 v57, v57
    v_mfma_f32_32x32x16_bf16 v[144:159], a[16:19], v[88:91], v[144:159]
    s_waitcnt lgkmcnt(3)
    ds_read_b128 a[12:15], v4 offset:1024
    ds_read_b128 a[16:19], v4 offset:2048
    v_exp_f32 v58, v58
    v_exp_f32 v59, v59
    v_mfma_f32_32x32x16_bf16 v[144:159], a[20:23], v[92:95], v[144:159]
    s_waitcnt lgkmcnt(4)
    v_cvt_pk_bf16_f32 v64, v16, v17
    v_cvt_pk_bf16_f32 v65, v18, v19
    v_cvt_pk_bf16_f32 v66, v20, v21
    v_cvt_pk_bf16_f32 v67, v22, v23
    v_cvt_pk_bf16_f32 v68, v24, v25
    v_cvt_pk_bf16_f32 v69, v26, v27
    v_cvt_pk_bf16_f32 v70, v28, v29
    v_cvt_pk_bf16_f32 v71, v30, v31
    v_exp_f32 v60, v60
    v_exp_f32 v61, v61
    v_exp_f32 v62, v62
    v_exp_f32 v63, v63
    v_pk_add_f32 v[48:49], v[48:49], 1.0 op_sel_hi:[1,0]
    v_pk_add_f32 v[50:51], v[50:51], 1.0 op_sel_hi:[1,0]
    v_pk_add_f32 v[52:53], v[52:53], 1.0 op_sel_hi:[1,0]
    v_pk_add_f32 v[54:55], v[54:55], 1.0 op_sel_hi:[1,0]
    v_pk_add_f32 v[56:57], v[56:57], 1.0 op_sel_hi:[1,0]
    v_pk_add_f32 v[58:59], v[58:59], 1.0 op_sel_hi:[1,0]
    v_pk_add_f32 v[60:61], v[60:61], 1.0 op_sel_hi:[1,0]
    v_pk_add_f32 v[62:63], v[62:63], 1.0 op_sel_hi:[1,0]
    v_mfma_f32_32x32x16_bf16 v[96:111], a[0:3], v[64:67], v[96:111]
    s_waitcnt lgkmcnt(3)
    ds_read_b128 a[20:23], v4 offset:3072
    ds_read_b128 a[0:3], v4 offset:4096
    v_rcp_f32 v48, v48
    v_rcp_f32 v49, v49
    v_mfma_f32_32x32x16_bf16 v[112:127], a[4:7], v[64:67], v[112:127]
    s_waitcnt lgkmcnt(4)
    v_rcp_f32 v50, v50
    v_rcp_f32 v51, v51
    v_rcp_f32 v52, v52
    v_mfma_f32_32x32x16_bf16 v[128:143], a[8:11], v[64:67], v[128:143]
    s_waitcnt lgkmcnt(3)
    ds_read_b128 a[4:7], v4 offset:5120
    ds_read_b128 a[8:11], v4 offset:6144
    v_rcp_f32 v53, v53
    v_rcp_f32 v54, v54
    v_mfma_f32_32x32x16_bf16 v[96:111], a[12:15], v[68:71], v[96:111]
    s_waitcnt lgkmcnt(4)
    v_rcp_f32 v55, v55
    v_rcp_f32 v56, v56
    v_rcp_f32 v57, v57
    v_mfma_f32_32x32x16_bf16 v[112:127], a[16:19], v[68:71], v[112:127]
    s_waitcnt lgkmcnt(3)
    ds_read_b128 a[12:15], v4 offset:7168
    ds_read_b128 a[16:19], v4 offset:8192
    v_rcp_f32 v58, v58
    v_rcp_f32 v59, v59
    v_mfma_f32_32x32x16_bf16 v[128:143], a[20:23], v[68:71], v[128:143]
    s_waitcnt lgkmcnt(4)
    v_rcp_f32 v60, v60
    v_rcp_f32 v61, v61
    v_rcp_f32 v62, v62
    v_rcp_f32 v63, v63
    v_pk_mul_f32 v[32:33], v[32:33], v[48:49]
    v_pk_mul_f32 v[34:35], v[34:35], v[50:51]
    v_pk_mul_f32 v[36:37], v[36:37], v[52:53]
    v_pk_mul_f32 v[38:39], v[38:39], v[54:55]
    v_pk_mul_f32 v[40:41], v[40:41], v[56:57]
    v_pk_mul_f32 v[42:43], v[42:43], v[58:59]
    v_pk_mul_f32 v[44:45], v[44:45], v[60:61]
    v_pk_mul_f32 v[46:47], v[46:47], v[62:63]
    v_pk_fma_f32 v[48:49], v[144:145], v[144:145], s[52:53]
    v_pk_fma_f32 v[50:51], v[146:147], v[146:147], s[52:53]
    v_pk_fma_f32 v[52:53], v[148:149], v[148:149], s[52:53]
    v_pk_fma_f32 v[54:55], v[150:151], v[150:151], s[52:53]
    v_pk_fma_f32 v[56:57], v[152:153], v[152:153], s[52:53]
    v_pk_fma_f32 v[58:59], v[154:155], v[154:155], s[52:53]
    v_pk_fma_f32 v[60:61], v[156:157], v[156:157], s[52:53]
    v_pk_fma_f32 v[62:63], v[158:159], v[158:159], s[52:53]
    v_pk_mul_f32 v[48:49], v[48:49], v[144:145] neg_lo:[1,0] neg_hi:[1,0]
    v_pk_mul_f32 v[50:51], v[50:51], v[146:147] neg_lo:[1,0] neg_hi:[1,0]
    v_pk_mul_f32 v[52:53], v[52:53], v[148:149] neg_lo:[1,0] neg_hi:[1,0]
    v_pk_mul_f32 v[54:55], v[54:55], v[150:151] neg_lo:[1,0] neg_hi:[1,0]
    v_pk_mul_f32 v[56:57], v[56:57], v[152:153] neg_lo:[1,0] neg_hi:[1,0]
    v_pk_mul_f32 v[58:59], v[58:59], v[154:155] neg_lo:[1,0] neg_hi:[1,0]
    v_pk_mul_f32 v[60:61], v[60:61], v[156:157] neg_lo:[1,0] neg_hi:[1,0]
    v_pk_mul_f32 v[62:63], v[62:63], v[158:159] neg_lo:[1,0] neg_hi:[1,0]
    v_cvt_pk_bf16_f32 v64, v32, v33
    v_cvt_pk_bf16_f32 v65, v34, v35
    v_cvt_pk_bf16_f32 v66, v36, v37
    v_cvt_pk_bf16_f32 v67, v38, v39
    v_cvt_pk_bf16_f32 v68, v40, v41
    v_cvt_pk_bf16_f32 v69, v42, v43
    v_cvt_pk_bf16_f32 v70, v44, v45
    v_cvt_pk_bf16_f32 v71, v46, v47
    v_exp_f32 v48, v48
    v_exp_f32 v49, v49
    v_exp_f32 v50, v50
    v_exp_f32 v51, v51
    v_exp_f32 v52, v52
    v_exp_f32 v53, v53
    v_exp_f32 v54, v54
    v_exp_f32 v55, v55
    v_exp_f32 v56, v56
    v_exp_f32 v57, v57
    v_exp_f32 v58, v58
    v_exp_f32 v59, v59
    v_exp_f32 v60, v60
    v_exp_f32 v61, v61
    v_exp_f32 v62, v62
    v_exp_f32 v63, v63
    v_pk_add_f32 v[48:49], v[48:49], 1.0 op_sel_hi:[1,0]
    v_pk_add_f32 v[50:51], v[50:51], 1.0 op_sel_hi:[1,0]
    v_pk_add_f32 v[52:53], v[52:53], 1.0 op_sel_hi:[1,0]
    v_pk_add_f32 v[54:55], v[54:55], 1.0 op_sel_hi:[1,0]
    v_pk_add_f32 v[56:57], v[56:57], 1.0 op_sel_hi:[1,0]
    v_pk_add_f32 v[58:59], v[58:59], 1.0 op_sel_hi:[1,0]
    v_pk_add_f32 v[60:61], v[60:61], 1.0 op_sel_hi:[1,0]
    v_pk_add_f32 v[62:63], v[62:63], 1.0 op_sel_hi:[1,0]
    v_mfma_f32_32x32x16_bf16 v[96:111], a[0:3], v[64:67], v[96:111]
    s_waitcnt lgkmcnt(3)
    ds_read_b128 a[20:23], v4 offset:9216
    ds_read_b128 a[0:3], v4 offset:10240
    v_rcp_f32 v48, v48
    v_rcp_f32 v49, v49
    v_mfma_f32_32x32x16_bf16 v[112:127], a[4:7], v[64:67], v[112:127]
    s_waitcnt lgkmcnt(4)
    v_rcp_f32 v50, v50
    v_rcp_f32 v51, v51
    v_rcp_f32 v52, v52
    v_mfma_f32_32x32x16_bf16 v[128:143], a[8:11], v[64:67], v[128:143]
    s_waitcnt lgkmcnt(3)
    ds_read_b128 a[4:7], v4 offset:11264
    ds_read_b128 a[8:11], v4 offset:12288
    v_rcp_f32 v53, v53
    v_rcp_f32 v54, v54
    v_mfma_f32_32x32x16_bf16 v[96:111], a[12:15], v[68:71], v[96:111]
    s_waitcnt lgkmcnt(4)
    v_rcp_f32 v55, v55
    v_rcp_f32 v56, v56
    v_rcp_f32 v57, v57
    v_mfma_f32_32x32x16_bf16 v[112:127], a[16:19], v[68:71], v[112:127]
    s_waitcnt lgkmcnt(3)
    ds_read_b128 a[12:15], v4 offset:13312
    ds_read_b128 a[16:19], v4 offset:14336
    v_rcp_f32 v58, v58
    v_rcp_f32 v59, v59
    v_mfma_f32_32x32x16_bf16 v[128:143], a[20:23], v[68:71], v[128:143]
    s_waitcnt lgkmcnt(4)
    v_rcp_f32 v60, v60
    v_rcp_f32 v61, v61
    v_rcp_f32 v62, v62
    v_rcp_f32 v63, v63
    v_pk_mul_f32 v[144:145], v[144:145], v[48:49]
    v_pk_mul_f32 v[146:147], v[146:147], v[50:51]
    v_pk_mul_f32 v[148:149], v[148:149], v[52:53]
    v_pk_mul_f32 v[150:151], v[150:151], v[54:55]
    v_pk_mul_f32 v[152:153], v[152:153], v[56:57]
    v_pk_mul_f32 v[154:155], v[154:155], v[58:59]
    v_pk_mul_f32 v[156:157], v[156:157], v[60:61]
    v_pk_mul_f32 v[158:159], v[158:159], v[62:63]
    v_cvt_pk_bf16_f32 v64, v144, v145
    v_cvt_pk_bf16_f32 v65, v146, v147
    v_cvt_pk_bf16_f32 v66, v148, v149
    v_cvt_pk_bf16_f32 v67, v150, v151
    v_cvt_pk_bf16_f32 v68, v152, v153
    v_cvt_pk_bf16_f32 v69, v154, v155
    v_cvt_pk_bf16_f32 v70, v156, v157
    v_cvt_pk_bf16_f32 v71, v158, v159
    v_mfma_f32_32x32x16_bf16 v[96:111], a[0:3], v[64:67], v[96:111]
    s_waitcnt lgkmcnt(3)
    ds_read_b128 a[20:23], v4 offset:15360
    v_mfma_f32_32x32x16_bf16 v[112:127], a[4:7], v[64:67], v[112:127]
    s_waitcnt lgkmcnt(3)
    v_mfma_f32_32x32x16_bf16 v[128:143], a[8:11], v[64:67], v[128:143]
    s_waitcnt lgkmcnt(2)
    v_mfma_f32_32x32x16_bf16 v[96:111], a[12:15], v[68:71], v[96:111]
    s_waitcnt lgkmcnt(1)
    v_mfma_f32_32x32x16_bf16 v[112:127], a[16:19], v[68:71], v[112:127]
    s_waitcnt lgkmcnt(0)
    v_mfma_f32_32x32x16_bf16 v[128:143], a[20:23], v[68:71], v[128:143]
    s_add_u32 s55, s56, 0
    v_cvt_pk_bf16_f32 v96, v96, v97
    v_cvt_pk_bf16_f32 v97, v98, v99
    v_cvt_pk_bf16_f32 v98, v100, v101
    v_cvt_pk_bf16_f32 v99, v102, v103
    v_cvt_pk_bf16_f32 v100, v104, v105
    v_cvt_pk_bf16_f32 v101, v106, v107
    v_cvt_pk_bf16_f32 v102, v108, v109
    v_cvt_pk_bf16_f32 v103, v110, v111
    v_permlane16_swap_b32 v96, v100
    v_permlane16_swap_b32 v97, v101
    v_permlane16_swap_b32 v98, v102
    v_permlane16_swap_b32 v99, v103
    v_cvt_pk_bf16_f32 v112, v112, v113
    v_cvt_pk_bf16_f32 v113, v114, v115
    v_cvt_pk_bf16_f32 v114, v116, v117
    v_cvt_pk_bf16_f32 v115, v118, v119
    v_cvt_pk_bf16_f32 v116, v120, v121
    v_cvt_pk_bf16_f32 v117, v122, v123
    v_cvt_pk_bf16_f32 v118, v124, v125
    v_cvt_pk_bf16_f32 v119, v126, v127
    v_permlane16_swap_b32 v112, v116
    v_permlane16_swap_b32 v113, v117
    v_permlane16_swap_b32 v114, v118
    v_permlane16_swap_b32 v115, v119
    v_cvt_pk_bf16_f32 v128, v128, v129
    v_cvt_pk_bf16_f32 v129, v130, v131
    v_cvt_pk_bf16_f32 v130, v132, v133
    v_cvt_pk_bf16_f32 v131, v134, v135
    v_cvt_pk_bf16_f32 v132, v136, v137
    v_cvt_pk_bf16_f32 v133, v138, v139
    v_cvt_pk_bf16_f32 v134, v140, v141
    v_cvt_pk_bf16_f32 v135, v142, v143
    v_permlane16_swap_b32 v128, v132
    v_permlane16_swap_b32 v129, v133
    v_permlane16_swap_b32 v130, v134
    v_permlane16_swap_b32 v131, v135
    buffer_store_dwordx4 v[96:99], v9, s[28:31], s55 offen offset:0 sc1
    buffer_store_dwordx4 v[112:115], v9, s[28:31], s55 offen offset:64 sc1
    buffer_store_dwordx4 v[128:131], v9, s[28:31], s55 offen offset:128 sc1
    buffer_store_dwordx4 v[100:103], v9, s[28:31], s55 offen offset:3072 sc1
    buffer_store_dwordx4 v[116:119], v9, s[28:31], s55 offen offset:3136 sc1
    buffer_store_dwordx4 v[132:135], v9, s[28:31], s55 offen offset:3200 sc1
L_end:
    s_endpgm
.section .rodata,"a"
.p2align 6
.amdhsa_kernel standalone__modern_conv_block_convnext_v2__vision_kernel
  .amdhsa_next_free_vgpr 512
  .amdhsa_next_free_sgpr 102
  .amdhsa_accum_offset 256
  .amdhsa_group_segment_fixed_size 0
  .amdhsa_kernarg_size 72
  .amdhsa_user_sgpr_count 2
  .amdhsa_user_sgpr_kernarg_segment_ptr 1
  .amdhsa_system_sgpr_workgroup_id_x 1
  .amdhsa_float_denorm_mode_32 3
.end_amdhsa_kernel
```
